```python
import torch

def _softmax(x, axis=-1):
    return torch.softmax(x, dim=axis)
def _gelu(x):
    return torch.nn.functional.gelu(x, approximate="tanh")
def _silu(x):
    return torch.nn.functional.silu(x)
def _sigmoid(x):
    return torch.sigmoid(x)
def _layernorm(x, axis=-1, eps=1e-5):
    m = x.mean(dim=axis, keepdim=True)
    v = x.var(dim=axis, keepdim=True, unbiased=False)
    return (x - m) / torch.sqrt(v + eps)
def _scatter_add(tgt, idx, src, axis=0):
    return tgt.clone().index_add_(axis, idx, src)
def _segment_sum(src, seg, n):
    out = torch.zeros((n,) + src.shape[1:], dtype=src.dtype)
    return out.index_add_(0, seg, src)
def _pad(x, pw):
    flat = tuple(v for pair in reversed(pw) for v in pair)
    return torch.nn.functional.pad(x, flat)

kernel_name = 'standalone__window_attn_swin__vision'

def setup_inputs():

    _w = (lambda a: (lambda t: t.to(torch.bfloat16) if t.is_floating_point() else t)(torch.as_tensor(a)))
    H = W = 512
    C = 192
    ws = 8
    nh = 4
    shift = ws // 2
    coords = torch.stack(torch.meshgrid(torch.arange(ws), torch.arange(ws), indexing='ij'), 0).reshape(2, -1)
    rel = coords[:, :, None] - coords[:, None, :]
    rel[0] += ws - 1
    rel[1] += ws - 1
    rel[0] *= 2 * ws - 1
    rp_idx = rel.sum(0).to(torch.int64)
    img_mask = torch.zeros((1, H, W, 1), dtype=float)
    cnt = 0
    for hs in (slice(0, H - ws), slice(H - ws, H - shift), slice(H - shift, H)):
        for vs in (slice(0, W - ws), slice(W - ws, W - shift), slice(W - shift, W)):
            img_mask[:, hs, vs, :] = cnt
            cnt += 1
    mw = img_mask.reshape(1, H // ws, ws, W // ws, ws, 1).permute(0, 1, 3, 2, 4, 5).reshape(-1, ws * ws)
    am = mw[:, :, None] - mw[:, None, :]
    attn_mask = torch.where(am != 0, -100.0, 0.0).to(float)
    return {
        "x": _w((lambda *s: torch.randn(*s, dtype=torch.bfloat16) * 1.6)(1, H, W, C)),
        "wqkv": _w((lambda *s: torch.randn(*s, dtype=torch.bfloat16) * 1.6)(C, 3 * C) * 0.02),
        "wo": _w((lambda *s: torch.randn(*s, dtype=torch.bfloat16) * 0.05)(C, C) * 0.02),
        "rpb": _w((lambda *s: torch.randn(*s, dtype=torch.bfloat16) * 0.2)((2 * ws - 1) * (2 * ws - 1), nh)),
        "rp_idx": _w(rp_idx),
        "attn_mask": _w(attn_mask),
    }

def reference(x, wqkv, wo, rpb, rp_idx, attn_mask):
    B, H, W, C = x.shape
    N = rp_idx.shape[0]
    ws = int(round(N ** 0.5))
    nh = rpb.shape[-1]
    hd = C // nh
    shift = ws // 2
    xs = torch.roll(x, (-shift, -shift), (1, 2))
    nWh = H // ws
    nWw = W // ws
    xw = (lambda x, *d: x.permute(*d))(xs.reshape(B, nWh, ws, nWw, ws, C), 0, 1, 3, 2, 4, 5).reshape(B * nWh * nWw, N, C)
    qkv = (lambda x, *d: x.permute(*d))(torch.einsum('wnc,cd->wnd', xw, wqkv).reshape(-1, N, 3, nh, hd), 2, 0, 3, 1, 4)
    q, k, v = qkv[0], qkv[1], qkv[2]
    attn = torch.einsum('whid,whjd->whij', q, k) * (hd ** -0.5)
    bias = (lambda x, *d: x.permute(*d))(rpb[rp_idx.reshape(-1)].reshape(N, N, nh), 2, 0, 1)
    attn = attn + bias[None, :, :, :]
    attn = (attn.reshape(B, nWh * nWw, nh, N, N) + attn_mask[None, :, None, :, :]).reshape(-1, nh, N, N)
    attn = _softmax(attn, axis=-1)
    out = (lambda x, *d: x.permute(*d))(torch.einsum('whij,whjd->whid', attn, v), 0, 2, 1, 3).reshape(-1, N, C)
    out = torch.einsum('wnc,cd->wnd', out, wo)
    out = (lambda x, *d: x.permute(*d))(out.reshape(B, nWh, nWw, ws, ws, C), 0, 1, 3, 2, 4, 5).reshape(B, H, W, C)
    return torch.roll(out, (shift, shift), (1, 2))
```

```asm
; @launch grid=(256,1,1) block=(256,1,1) lds=163840
.amdgcn_target "amdgcn-amd-amdhsa--gfx950"
.text
.globl standalone__window_attn_swin__vision_kernel
.p2align 8
.type standalone__window_attn_swin__vision_kernel,@function
standalone__window_attn_swin__vision_kernel:
  s_cmpk_ge_u32 s2, 256
  s_cbranch_scc1 L_end
  s_load_dwordx2 s[8:9], s[0:1], 0
  s_load_dwordx2 s[20:21], s[0:1], 24
  s_load_dwordx2 s[12:13], s[0:1], 8
  s_load_dwordx2 s[16:17], s[0:1], 16
  s_load_dwordx2 s[24:25], s[0:1], 48
  v_lshrrev_b32 v62, 6, v0
  s_lshr_b32 s49, s2, 3
  v_readfirstlane_b32 s3, v62
  s_getpc_b64 s[50:51]
  v_and_b32 v62, 7, v0
  v_lshl_add_u32 v62, s49, 3, v62
  v_lshlrev_b32 v62, 7, v62
  v_min_u32 v62, L_safe-standalone__window_attn_swin__vision_kernel-256, v62
  v_mov_b32 v53, s51
  v_add_co_u32 v52, vcc, s50, v62
  s_and_b32 s47, s2, 63
  s_lshr_b32 s48, s2, 6
  v_addc_co_u32 v53, vcc, 0, v53, vcc
  global_load_dword v88, v[52:53], off
  v_bfe_u32 v54, v0, 3, 4
  v_and_b32 v11, 7, v0
  v_lshrrev_b32 v61, 1, v54
  v_lshlrev_b32 v68, 2, v54
  v_and_b32 v68, 4, v68
  v_xor_b32 v61, v61, v68
  v_xor_b32 v61, v11, v61
  v_and_b32 v53, 7, v54
  s_lshl_b32 s5, s47, 3
  s_add_u32 s5, s5, 4
  v_add_u32 v68, s5, v53
  v_and_b32 v68, 511, v68
  v_mul_u32_u24 v68, 0x180, v68
  v_lshl_add_u32 v6, v61, 4, v68
  v_and_b32 v55, 63, v0
  v_lshlrev_b32 v52, 4, v55
  s_mov_b32 s57, 196608
  s_lshl_b32 s56, s48, 3
  s_add_u32 s56, s56, s3
  s_add_u32 s5, s56, 484
  s_mul_i32 s31, s5, s57
  s_add_u32 s5, s5, 4
  s_and_b32 s5, s5, 511
  s_mul_i32 s32, s5, s57
  s_lshl_b32 s46, s3, 10
  s_lshl_b32 s5, s3, 11
  s_add_u32 m0, s5, 147456
  s_mov_b32 s11, 0x20000
  s_mov_b32 s10, 100663296
  s_mov_b32 s23, s11
  s_movk_i32 s22, 1800
  s_waitcnt lgkmcnt(0)
  buffer_load_dwordx4 v52, s[20:23], 0 offen lds
  buffer_load_dwordx4 v52, s[20:23], 0 offen offset:1024 lds
  s_add_u32 m0, s46, 0
  v_and_b32 v61, 2, v54
  buffer_load_dwordx4 v6, s[8:11], s31 offen offset:0 nt lds
  s_add_u32 m0, s46, 8064
  v_lshrrev_b32 v68, 1, v54
  buffer_load_dwordx4 v6, s[8:11], s31 offen offset:128 nt lds
  s_add_u32 m0, s46, 16128
  v_and_b32 v68, 4, v68
  buffer_load_dwordx4 v6, s[8:11], s31 offen offset:256 nt lds
  s_add_u32 m0, s46, 4096
  v_or_b32 v68, v61, v68
  buffer_load_dwordx4 v6, s[8:11], s32 offen offset:0 nt lds
  s_add_u32 m0, s46, 12160
  v_xor_b32 v68, v11, v68
  buffer_load_dwordx4 v6, s[8:11], s32 offen offset:128 nt lds
  s_add_u32 m0, s46, 20224
  v_lshlrev_b32 v68, 4, v68
  buffer_load_dwordx4 v6, s[8:11], s32 offen offset:256 nt lds
  v_mul_u32_u24 v54, 1152, v53
  v_add_u32 v52, v68, v54
  s_mul_i32 s44, s3, 9216
  s_mov_b32 s15, s11
  s_mov_b32 s14, 221184
  s_add_u32 s5, s44, 0
  s_add_u32 m0, s46, 24576
  s_nop 0
  buffer_load_dwordx4 v52, s[12:15], s5 offen offset:0 lds
  s_add_u32 m0, s46, 32640
  s_nop 0
  buffer_load_dwordx4 v52, s[12:15], s5 offen offset:128 lds
  s_add_u32 m0, s46, 40704
  s_nop 0
  buffer_load_dwordx4 v52, s[12:15], s5 offen offset:256 lds
  s_add_u32 s5, s44, 36864
  s_add_u32 m0, s46, 28672
  s_nop 0
  buffer_load_dwordx4 v52, s[12:15], s5 offen offset:0 lds
  s_add_u32 m0, s46, 36736
  s_nop 0
  buffer_load_dwordx4 v52, s[12:15], s5 offen offset:128 lds
  s_add_u32 m0, s46, 44800
  s_nop 0
  buffer_load_dwordx4 v52, s[12:15], s5 offen offset:256 lds
  s_mov_b32 s19, s11
  s_mov_b32 s18, 73728
  s_lshl_b32 s49, s49, 2
  s_add_u32 s49, s49, s3
  s_mul_i32 s49, s49, 2304
  s_cmp_ge_u32 s49, s14
  s_cselect_b64 s[52:53], s[16:17], s[12:13]
  s_cselect_b64 s[54:55], s[18:19], s[14:15]
  s_cselect_b32 s5, s14, 0
  s_sub_u32 s49, s49, s5
  v_min_u32 v54, 17, v55
  v_lshlrev_b32 v54, 7, v54
  buffer_load_dword v83, v54, s[52:55], s49 offen
  v_lshlrev_b32 v61, 1, v61
  v_xor_b32 v61, v11, v61
  v_mul_u32_u24 v68, 0x180, v53
  v_lshl_add_u32 v54, v61, 4, v68
  s_mul_i32 s45, s3, 3072
  s_mov_b32 s10, 95158272
  s_mov_b32 s27, s11
  s_mov_b32 s26, 100663296
  v_and_b32 v11, 15, v55
  v_lshrrev_b32 v53, 4, v55
  v_lshrrev_b32 v62, 1, v11
  v_lshlrev_b32 v61, 2, v11
  v_and_b32 v61, 4, v61
  v_xor_b32 v62, v62, v61
  v_xor_b32 v62, v53, v62
  v_lshlrev_b32 v62, 4, v62
  v_lshl_add_u32 v0, v11, 7, v62
  v_xor_b32 v1, 64, v0
  v_subrev_u32 v2, s46, v0
  s_add_u32 s28, s46, 24576
  s_add_u32 s29, s46, 49152
  s_mov_b32 s30, s46
  s_and_b32 s4, s3, 1
  v_lshlrev_b32 v62, 4, v11
  v_lshl_add_u32 v61, v53, 10, v62
  s_lshl_b32 s5, s4, 8
  s_add_u32 s5, s5, 73728
  v_add_u32 v3, s5, v61
  v_xor_b32 v4, 0x100, v3
  s_mul_i32 s5, s3, 6144
  s_add_u32 s6, s5, 98304
  s_add_u32 s5, s5, 73728
  s_xor_b32 s41, s5, s6
  v_lshl_add_u32 v61, v53, 2, v62
  v_add_u32 v5, s5, v61
  s_lshl_b32 s5, s47, 3
  s_add_u32 s5, s5, 4
  v_and_b32 v60, 7, v11
  v_add_u32 v62, s5, v60
  v_and_b32 v62, 511, v62
  v_mul_u32_u24 v62, 0x180, v62
  v_lshrrev_b32 v63, 3, v11
  v_mul_u32_u24 v61, s57, v63
  v_add_u32 v62, v62, v61
  v_lshl_add_u32 v62, v53, 4, v62
  s_lshr_b32 s49, s3, 1
  s_lshl_b32 s5, s49, 6
  s_add_u32 s6, s5, 256
  v_add_u32 v8, s6, v62
  s_lshl_b32 s6, s4, 7
  s_add_u32 s5, s5, s6
  v_add_u32 v7, s5, v62
  s_lshl_b32 s5, s48, 3
  s_xor_b32 s6, s4, 0
  s_lshl_b32 s6, s6, 1
  s_sub_u32 s7, s6, s3
  s_sub_u32 s7, s7, 96
  s_mul_i32 s37, s7, s57
  s_add_u32 s6, s6, s5
  s_add_u32 s6, s6, 484
  s_and_b32 s6, s6, 511
  s_mul_i32 s33, s6, s57
  s_xor_b32 s6, s4, 1
  s_lshl_b32 s6, s6, 1
  s_sub_u32 s7, s6, s3
  s_sub_u32 s7, s7, 96
  s_mul_i32 s38, s7, s57
  s_add_u32 s6, s6, s5
  s_add_u32 s6, s6, 484
  s_and_b32 s6, s6, 511
  s_mul_i32 s34, s6, s57
  s_xor_b32 s6, s4, 2
  s_lshl_b32 s6, s6, 1
  s_sub_u32 s7, s6, s3
  s_sub_u32 s7, s7, 96
  s_mul_i32 s39, s7, s57
  s_add_u32 s6, s6, s5
  s_add_u32 s6, s6, 484
  s_and_b32 s6, s6, 511
  s_mul_i32 s35, s6, s57
  s_xor_b32 s6, s4, 3
  s_lshl_b32 s6, s6, 1
  s_sub_u32 s7, s6, s3
  s_sub_u32 s7, s7, 96
  s_mul_i32 s40, s7, s57
  s_add_u32 s6, s6, s5
  s_add_u32 s6, s6, 484
  s_and_b32 s6, s6, 511
  s_mul_i32 s36, s6, s57
  s_add_u32 s5, s56, 4
  s_mul_i32 s31, s5, s57
  s_add_u32 s5, s56, 8
  s_mul_i32 s32, s5, s57
  s_lshl_b32 s43, s57, 5
  s_mov_b32 s42, 0x3e553b95
  v_and_b32 v67, 1, v53
  v_lshrrev_b32 v66, 1, v53
  v_lshrrev_b32 v62, 2, v11
  v_lshl_add_u32 v61, v67, 1, v63
  v_lshl_add_u32 v62, v53, 3, v62
  v_lshlrev_b32 v62, 7, v62
  v_lshl_add_u32 v62, v61, 5, v62
  v_and_b32 v69, 3, v11
  v_lshl_add_u32 v62, v69, 3, v62
  s_mul_i32 s5, s3, 3
  s_and_b32 s6, s5, 3
  s_lshl_b32 s6, s6, 5
  s_lshr_b32 s7, s5, 2
  s_lshl_b32 s7, s7, 13
  s_add_u32 s7, s7, 24576
  v_xor_b32 v61, s6, v62
  v_add_u32 v65, s7, v61
  v_add_u32 v59, 73728, v65
  s_add_u32 s5, s5, 1
  s_and_b32 s6, s5, 3
  s_lshl_b32 s6, s6, 5
  s_lshr_b32 s7, s5, 2
  s_lshl_b32 s7, s7, 13
  s_add_u32 s7, s7, 24576
  v_xor_b32 v61, s6, v62
  v_add_u32 v82, s7, v61
  v_add_u32 v57, 73728, v82
  s_add_u32 s5, s5, 1
  s_and_b32 s6, s5, 3
  s_lshl_b32 s6, s6, 5
  s_lshr_b32 s7, s5, 2
  s_lshl_b32 s7, s7, 13
  s_add_u32 s7, s7, 24576
  v_xor_b32 v61, s6, v62
  v_add_u32 v56, s7, v61
  v_add_u32 v53, 73728, v56
  v_bfe_u32 v62, v11, 2, 1
  v_lshl_add_u32 v62, v63, 2, v62
  v_lshl_add_u32 v62, v67, 1, v62
  v_lshl_add_u32 v62, v66, 4, v62
  v_xor_b32 v61, s49, v67
  v_lshl_add_u32 v62, v62, 1, v61
  v_lshl_add_u32 v62, v62, 2, v69
  v_lshlrev_b32 v62, 4, v62
  s_lshl_b32 s5, s4, 13
  v_add_u32 v55, s5, v62
  v_add_u32 v58, 16384, v62
  v_add_u32 v11, 98304, v55
  v_add_u32 v64, 98304, v58
  v_cmp_gt_u32 vcc, 2, v69
  v_mov_b32 v62, 0x3f803f80
  v_mov_b32 v61, 0x44444444
  v_cndmask_b32 v62, 0, v62, vcc
  v_cmp_eq_u32 vcc, 1, v69
  v_mov_b32 v68, 0xeeeeeeee
  v_accvgpr_write_b32 a240, v62
  v_accvgpr_write_b32 a241, v62
  v_accvgpr_write_b32 a242, v62
  v_accvgpr_write_b32 a243, v62
  v_cndmask_b32 v10, v61, v68, vcc
  v_mov_b32 v9, 1.0
  v_mov_b64 v[14:15], 0
  v_mov_b64 v[20:21], 0
  v_sub_u32 v62, v63, v66
  v_mul_i32_i24 v62, 15, v62
  v_lshlrev_b32 v61, 2, v67
  v_sub_u32 v68, v60, v61
  v_add3_u32 v62, v62, v68, 19
  s_mul_i32 s5, s3, 2050
  s_add_u32 s5, s5, 147456
  v_lshl_add_u32 v63, v62, 3, s5
  v_mov_b64 v[24:25], 0
  v_mov_b64 v[26:27], 0
  v_mov_b64 v[28:29], 0
  v_mov_b64 v[30:31], 0
  v_mov_b64 v[32:33], 0
  v_mov_b64 v[34:35], 0
  v_mov_b64 v[36:37], 0
  v_mov_b64 v[38:39], 0
  v_mov_b64 v[40:41], 0
  v_mov_b64 v[42:43], 0
  v_mov_b64 v[44:45], 0
  v_mov_b64 v[46:47], 0
  v_mov_b64 v[48:49], 0
  v_mov_b64 v[50:51], 0
  v_xor_b32 v62, v61, v60
  s_cmp_eq_u32 s47, 63
  s_cselect_b32 s5, 4, 0
  v_and_b32 v62, s5, v62
  v_cmp_eq_u32 vcc, 0, v62
  s_cmp_eq_u32 s48, 3
  s_cselect_b32 s5, 0xc31044fe, 0
  v_mov_b32 v89, s5
  v_mov_b32 v60, 0xc31044fe
  v_cndmask_b32 v89, 0, v89, vcc
  v_cndmask_b32 v60, v60, 0, vcc
  s_waitcnt vmcnt(13)
  ds_read_u16_d16_hi v24, v63 offset:24
  ds_read_u16_d16_hi v25, v63 offset:16
  ds_read_u16_d16_hi v26, v63 offset:8
  ds_read_u16_d16_hi v27, v63 offset:0
  ds_read_u16_d16_hi v28, v63 offset:264
  ds_read_u16_d16_hi v29, v63 offset:256
  ds_read_u16_d16_hi v30, v63 offset:248
  ds_read_u16_d16_hi v31, v63 offset:240
  ds_read_u16_d16_hi v32, v63 offset:504
  ds_read_u16_d16_hi v33, v63 offset:496
  ds_read_u16_d16_hi v34, v63 offset:488
  ds_read_u16_d16_hi v35, v63 offset:480
  ds_read_u16_d16_hi v36, v63 offset:744
  ds_read_u16_d16_hi v37, v63 offset:736
  ds_read_u16_d16_hi v38, v63 offset:728
  ds_read_u16_d16_hi v39, v63 offset:720
  ds_read_u16_d16_hi v40, v63 offset:984
  ds_read_u16_d16_hi v41, v63 offset:976
  ds_read_u16_d16_hi v42, v63 offset:968
  ds_read_u16_d16_hi v43, v63 offset:960
  ds_read_u16_d16_hi v44, v63 offset:1224
  ds_read_u16_d16_hi v45, v63 offset:1216
  ds_read_u16_d16_hi v46, v63 offset:1208
  ds_read_u16_d16_hi v47, v63 offset:1200
  ds_read_u16_d16_hi v48, v63 offset:1464
  ds_read_u16_d16_hi v49, v63 offset:1456
  ds_read_u16_d16_hi v50, v63 offset:1448
  ds_read_u16_d16_hi v51, v63 offset:1440
  s_mov_b32 s5, 0x3fb8aa3b
  s_waitcnt lgkmcnt(15)
  v_fma_f32 v24, v24, s5, v60
  v_fma_f32 v25, v25, s5, v60
  v_fma_f32 v26, v26, s5, v60
  v_fma_f32 v27, v27, s5, v60
  v_fma_f32 v28, v28, s5, v60
  v_fma_f32 v29, v29, s5, v60
  v_fma_f32 v30, v30, s5, v60
  v_fma_f32 v31, v31, s5, v60
  v_fma_f32 v32, v32, s5, v60
  v_fma_f32 v33, v33, s5, v60
  v_fma_f32 v34, v34, s5, v60
  v_fma_f32 v35, v35, s5, v60
  v_fma_f32 v36, v36, s5, v60
  s_waitcnt lgkmcnt(14)
  v_fma_f32 v37, v37, s5, v60
  s_waitcnt lgkmcnt(13)
  v_fma_f32 v38, v38, s5, v60
  s_waitcnt lgkmcnt(12)
  v_fma_f32 v39, v39, s5, v60
  s_waitcnt lgkmcnt(11)
  v_fma_f32 v40, v40, s5, v60
  s_waitcnt lgkmcnt(10)
  v_fma_f32 v41, v41, s5, v60
  s_waitcnt lgkmcnt(9)
  v_fma_f32 v42, v42, s5, v60
  s_waitcnt lgkmcnt(8)
  v_fma_f32 v43, v43, s5, v60
  s_waitcnt lgkmcnt(7)
  v_fma_f32 v44, v44, s5, v60
  s_waitcnt lgkmcnt(6)
  v_fma_f32 v45, v45, s5, v60
  s_waitcnt lgkmcnt(5)
  v_fma_f32 v46, v46, s5, v60
  s_waitcnt lgkmcnt(4)
  v_fma_f32 v47, v47, s5, v60
  s_waitcnt lgkmcnt(3)
  v_fma_f32 v48, v48, s5, v60
  s_waitcnt lgkmcnt(2)
  v_fma_f32 v49, v49, s5, v60
  s_waitcnt lgkmcnt(1)
  v_fma_f32 v50, v50, s5, v60
  s_waitcnt lgkmcnt(0)
  v_fma_f32 v51, v51, s5, v60
  v_add_f32 v66, v89, v48
  v_add_f32 v67, v89, v49
  v_add_f32 v68, v89, v50
  v_add_f32 v69, v89, v51
  v_add_f32 v74, v89, v44
  v_add_f32 v75, v89, v45
  v_add_f32 v76, v89, v46
  v_add_f32 v77, v89, v47
  v_add_f32 v70, v89, v40
  v_add_f32 v71, v89, v41
  v_add_f32 v72, v89, v42
  v_add_f32 v73, v89, v43
  v_add_f32 v60, v89, v32
  v_add_f32 v61, v89, v33
  v_add_f32 v62, v89, v34
  v_add_f32 v63, v89, v35
  v_add_f32 v84, v89, v28
  v_add_f32 v85, v89, v29
  v_add_f32 v86, v89, v30
  v_add_f32 v87, v89, v31
  v_add_f32 v78, v89, v24
  v_add_f32 v79, v89, v25
  v_add_f32 v80, v89, v26
  v_add_f32 v81, v89, v27
  s_add_u32 s5, s44, 73728
  s_add_u32 m0, s46, 49152
  s_nop 0
  buffer_load_dwordx4 v52, s[12:15], s5 offen offset:0 lds
  s_add_u32 m0, s46, 57216
  s_nop 0
  buffer_load_dwordx4 v52, s[12:15], s5 offen offset:128 lds
  s_add_u32 m0, s46, 65280
  s_nop 0
  buffer_load_dwordx4 v52, s[12:15], s5 offen offset:256 lds
  s_add_u32 s5, s44, 110592
  s_add_u32 m0, s46, 53248
  s_nop 0
  buffer_load_dwordx4 v52, s[12:15], s5 offen offset:0 lds
  s_add_u32 m0, s46, 61312
  s_nop 0
  buffer_load_dwordx4 v52, s[12:15], s5 offen offset:128 lds
  s_add_u32 m0, s46, 69376
  s_nop 0
  buffer_load_dwordx4 v52, s[12:15], s5 offen offset:256 lds
  s_waitcnt vmcnt(13)
  s_barrier
  ds_read_b128 a[144:147], v0 offset:0
  ds_read_b128 a[168:171], v0 offset:2048
  ds_read_b128 a[192:195], v0 offset:4096
  ds_read_b128 a[216:219], v0 offset:6144
  ds_read_b128 a[148:151], v1 offset:0
  ds_read_b128 a[172:175], v1 offset:2048
  ds_read_b128 a[196:199], v1 offset:4096
  ds_read_b128 a[220:223], v1 offset:6144
  ds_read_b128 a[152:155], v0 offset:8192
  ds_read_b128 a[176:179], v0 offset:10240
  ds_read_b128 a[200:203], v0 offset:12288
  ds_read_b128 a[224:227], v0 offset:14336
  ds_read_b128 a[156:159], v1 offset:8192
  ds_read_b128 a[180:183], v1 offset:10240
  ds_read_b128 a[204:207], v1 offset:12288
  ds_read_b128 a[228:231], v1 offset:14336
  ds_read_b128 a[160:163], v0 offset:16384
  ds_read_b128 a[184:187], v0 offset:18432
  ds_read_b128 a[208:211], v0 offset:20480
  ds_read_b128 a[232:235], v0 offset:22528
  ds_read_b128 a[164:167], v1 offset:16384
  ds_read_b128 a[188:191], v1 offset:18432
  ds_read_b128 a[212:215], v1 offset:20480
  ds_read_b128 a[236:239], v1 offset:22528
  s_waitcnt vmcnt(7)
  s_barrier
  s_add_u32 s5, s44, 147456
  s_add_u32 m0, s46, 73728
  s_nop 0
  buffer_load_dwordx4 v52, s[12:15], s5 offen offset:0 lds
  s_add_u32 m0, s46, 81792
  s_nop 0
  buffer_load_dwordx4 v52, s[12:15], s5 offen offset:128 lds
  s_add_u32 m0, s46, 89856
  s_nop 0
  buffer_load_dwordx4 v52, s[12:15], s5 offen offset:256 lds
  ds_read_b64_tr_b16 v[184:185], v65 offset:0
  ds_read_b64_tr_b16 v[186:187], v65 offset:512
  ds_read_b64_tr_b16 v[196:197], v65 offset:4096
  ds_read_b64_tr_b16 v[198:199], v65 offset:4608
  s_add_u32 s5, s44, 184320
  s_add_u32 m0, s46, 77824
  s_nop 0
  buffer_load_dwordx4 v52, s[12:15], s5 offen offset:0 lds
  s_add_u32 m0, s46, 85888
  s_nop 0
  buffer_load_dwordx4 v52, s[12:15], s5 offen offset:128 lds
  s_add_u32 m0, s46, 93952
  s_nop 0
  buffer_load_dwordx4 v52, s[12:15], s5 offen offset:256 lds
  ds_read_b64_tr_b16 v[188:189], v82 offset:0
  ds_read_b64_tr_b16 v[190:191], v82 offset:512
  ds_read_b64_tr_b16 v[200:201], v82 offset:4096
  ds_read_b64_tr_b16 v[202:203], v82 offset:4608
  ds_read_b64_tr_b16 v[192:193], v56 offset:0
  ds_read_b64_tr_b16 v[194:195], v56 offset:512
  ds_read_b64_tr_b16 v[204:205], v56 offset:4096
  ds_read_b64_tr_b16 v[206:207], v56 offset:4608
  s_waitcnt lgkmcnt(10)
  v_mfma_f32_16x16x32_bf16 v[100:103], v[184:187], a[144:147], 0
  s_waitcnt lgkmcnt(8)
  v_mfma_f32_16x16x32_bf16 v[100:103], v[196:199], a[148:151], v[100:103]
  s_waitcnt lgkmcnt(6)
  v_mfma_f32_16x16x32_bf16 v[116:119], v[188:191], a[144:147], 0
  s_waitcnt lgkmcnt(4)
  v_mfma_f32_16x16x32_bf16 v[116:119], v[200:203], a[148:151], v[116:119]
  s_waitcnt lgkmcnt(2)
  v_mfma_f32_16x16x32_bf16 v[112:115], v[192:195], a[144:147], 0
  s_waitcnt lgkmcnt(0)
  v_mfma_f32_16x16x32_bf16 v[112:115], v[204:207], a[148:151], v[112:115]
  v_mfma_f32_16x16x32_bf16 v[128:131], v[184:187], a[168:171], 0
  v_mfma_f32_16x16x32_bf16 v[128:131], v[196:199], a[172:175], v[128:131]
  v_mfma_f32_16x16x32_bf16 v[132:135], v[188:191], a[168:171], 0
  v_mfma_f32_16x16x32_bf16 v[132:135], v[200:203], a[172:175], v[132:135]
  s_add_u32 s5, s44, 384
  s_add_u32 m0, s46, 98304
  v_mfma_f32_16x16x32_bf16 v[96:99], v[192:195], a[168:171], 0
  buffer_load_dwordx4 v52, s[12:15], s5 offen offset:0 lds
  v_mfma_f32_16x16x32_bf16 v[96:99], v[204:207], a[172:175], v[96:99]
  s_add_u32 m0, s46, 106368
  v_mfma_f32_16x16x32_bf16 v[120:123], v[184:187], a[192:195], 0
  buffer_load_dwordx4 v52, s[12:15], s5 offen offset:128 lds
  v_mfma_f32_16x16x32_bf16 v[120:123], v[196:199], a[196:199], v[120:123]
  s_add_u32 m0, s46, 114432
  v_mfma_f32_16x16x32_bf16 v[124:127], v[188:191], a[192:195], 0
  buffer_load_dwordx4 v52, s[12:15], s5 offen offset:256 lds
  v_mfma_f32_16x16x32_bf16 v[124:127], v[200:203], a[196:199], v[124:127]
  s_waitcnt vmcnt(9) lgkmcnt(0)
  s_barrier
  v_mfma_f32_16x16x32_bf16 v[108:111], v[192:195], a[192:195], 0
  s_add_u32 s5, s44, 37248
  s_add_u32 m0, s46, 102400
  ds_read_b64_tr_b16 v[208:209], v65 offset:24576
  v_mfma_f32_16x16x32_bf16 v[108:111], v[204:207], a[196:199], v[108:111]
  buffer_load_dwordx4 v52, s[12:15], s5 offen offset:0 lds
  v_mfma_f32_16x16x32_bf16 v[92:95], v[184:187], a[216:219], 0
  s_add_u32 m0, s46, 110464
  ds_read_b64_tr_b16 v[210:211], v65 offset:25088
  ds_read_b64_tr_b16 v[220:221], v65 offset:28672
  v_mfma_f32_16x16x32_bf16 v[92:95], v[196:199], a[220:223], v[92:95]
  buffer_load_dwordx4 v52, s[12:15], s5 offen offset:128 lds
  v_mfma_f32_16x16x32_bf16 v[104:107], v[188:191], a[216:219], 0
  s_add_u32 m0, s46, 118528
  ds_read_b64_tr_b16 v[222:223], v65 offset:29184
  ds_read_b64_tr_b16 v[212:213], v82 offset:24576
  v_mfma_f32_16x16x32_bf16 v[104:107], v[200:203], a[220:223], v[104:107]
  buffer_load_dwordx4 v52, s[12:15], s5 offen offset:256 lds
  v_mfma_f32_16x16x32_bf16 v[88:91], v[192:195], a[216:219], 0
  ds_read_b64_tr_b16 v[214:215], v82 offset:25088
  ds_read_b64_tr_b16 v[224:225], v82 offset:28672
  v_mfma_f32_16x16x32_bf16 v[88:91], v[204:207], a[220:223], v[88:91]
  ds_read_b64_tr_b16 v[226:227], v82 offset:29184
  ds_read_b64_tr_b16 v[216:217], v56 offset:24576
  s_waitcnt lgkmcnt(7)
  v_mfma_f32_16x16x32_bf16 v[100:103], v[208:211], a[152:155], v[100:103]
  ds_read_b64_tr_b16 v[218:219], v56 offset:25088
  ds_read_b64_tr_b16 v[228:229], v56 offset:28672
  s_waitcnt lgkmcnt(7)
  v_mfma_f32_16x16x32_bf16 v[100:103], v[220:223], a[156:159], v[100:103]
  ds_read_b64_tr_b16 v[230:231], v56 offset:29184
  s_waitcnt lgkmcnt(6)
  v_mfma_f32_16x16x32_bf16 v[116:119], v[212:215], a[152:155], v[116:119]
  s_waitcnt lgkmcnt(4)
  v_mfma_f32_16x16x32_bf16 v[116:119], v[224:227], a[156:159], v[116:119]
  s_waitcnt lgkmcnt(2)
  v_mfma_f32_16x16x32_bf16 v[112:115], v[216:219], a[152:155], v[112:115]
  s_waitcnt lgkmcnt(0)
  v_mfma_f32_16x16x32_bf16 v[112:115], v[228:231], a[156:159], v[112:115]
  v_mfma_f32_16x16x32_bf16 v[128:131], v[208:211], a[176:179], v[128:131]
  v_mfma_f32_16x16x32_bf16 v[128:131], v[220:223], a[180:183], v[128:131]
  v_mfma_f32_16x16x32_bf16 v[132:135], v[212:215], a[176:179], v[132:135]
  v_mfma_f32_16x16x32_bf16 v[132:135], v[224:227], a[180:183], v[132:135]
  s_add_u32 s5, s44, 74112
  s_add_u32 m0, s46, 122880
  v_mfma_f32_16x16x32_bf16 v[96:99], v[216:219], a[176:179], v[96:99]
  buffer_load_dwordx4 v52, s[12:15], s5 offen offset:0 lds
  v_mfma_f32_16x16x32_bf16 v[96:99], v[228:231], a[180:183], v[96:99]
  s_add_u32 m0, s46, 130944
  v_mfma_f32_16x16x32_bf16 v[120:123], v[208:211], a[200:203], v[120:123]
  buffer_load_dwordx4 v52, s[12:15], s5 offen offset:128 lds
  v_mfma_f32_16x16x32_bf16 v[120:123], v[220:223], a[204:207], v[120:123]
  s_add_u32 m0, s46, 139008
  v_mfma_f32_16x16x32_bf16 v[124:127], v[212:215], a[200:203], v[124:127]
  buffer_load_dwordx4 v52, s[12:15], s5 offen offset:256 lds
  v_mfma_f32_16x16x32_bf16 v[124:127], v[224:227], a[204:207], v[124:127]
  s_waitcnt vmcnt(9) lgkmcnt(0)
  s_barrier
  v_mfma_f32_16x16x32_bf16 v[108:111], v[216:219], a[200:203], v[108:111]
  s_add_u32 s5, s44, 110976
  s_add_u32 m0, s46, 126976
  ds_read_b64_tr_b16 v[232:233], v65 offset:49152
  v_mfma_f32_16x16x32_bf16 v[108:111], v[228:231], a[204:207], v[108:111]
  buffer_load_dwordx4 v52, s[12:15], s5 offen offset:0 lds
  v_mfma_f32_16x16x32_bf16 v[92:95], v[208:211], a[224:227], v[92:95]
  s_add_u32 m0, s46, 135040
  ds_read_b64_tr_b16 v[234:235], v65 offset:49664
  ds_read_b64_tr_b16 v[244:245], v65 offset:53248
  v_mfma_f32_16x16x32_bf16 v[92:95], v[220:223], a[228:231], v[92:95]
  buffer_load_dwordx4 v52, s[12:15], s5 offen offset:128 lds
  v_mfma_f32_16x16x32_bf16 v[104:107], v[212:215], a[224:227], v[104:107]
  s_add_u32 m0, s46, 143104
  ds_read_b64_tr_b16 v[246:247], v65 offset:53760
  ds_read_b64_tr_b16 v[236:237], v82 offset:49152
  v_mfma_f32_16x16x32_bf16 v[104:107], v[224:227], a[228:231], v[104:107]
  buffer_load_dwordx4 v52, s[12:15], s5 offen offset:256 lds
  v_mfma_f32_16x16x32_bf16 v[88:91], v[216:219], a[224:227], v[88:91]
  ds_read_b64_tr_b16 v[238:239], v82 offset:49664
  ds_read_b64_tr_b16 v[248:249], v82 offset:53248
  v_mfma_f32_16x16x32_bf16 v[88:91], v[228:231], a[228:231], v[88:91]
  ds_read_b64_tr_b16 v[250:251], v82 offset:53760
  ds_read_b64_tr_b16 v[240:241], v56 offset:49152
  s_waitcnt lgkmcnt(7)
  v_mfma_f32_16x16x32_bf16 v[100:103], v[232:235], a[160:163], v[100:103]
  ds_read_b64_tr_b16 v[242:243], v56 offset:49664
  ds_read_b64_tr_b16 v[252:253], v56 offset:53248
  s_waitcnt lgkmcnt(7)
  v_mfma_f32_16x16x32_bf16 v[100:103], v[244:247], a[164:167], v[100:103]
  ds_read_b64_tr_b16 v[254:255], v56 offset:53760
  s_waitcnt lgkmcnt(6)
  v_mfma_f32_16x16x32_bf16 v[116:119], v[236:239], a[160:163], v[116:119]
  s_waitcnt lgkmcnt(4)
  v_mfma_f32_16x16x32_bf16 v[116:119], v[248:251], a[164:167], v[116:119]
  s_waitcnt lgkmcnt(2)
  v_mfma_f32_16x16x32_bf16 v[112:115], v[240:243], a[160:163], v[112:115]
  v_mul_f32 v100, s42, v100
  v_mul_f32 v101, s42, v101
  s_waitcnt lgkmcnt(0)
  v_mfma_f32_16x16x32_bf16 v[112:115], v[252:255], a[164:167], v[112:115]
  v_mul_f32 v102, s42, v102
  v_mul_f32 v103, s42, v103
  v_mfma_f32_16x16x32_bf16 v[128:131], v[232:235], a[184:187], v[128:131]
  v_cvt_pk_bf16_f32 v12, v100, v101
  v_cvt_pk_bf16_f32 v13, v102, v103
  v_mfma_f32_16x16x32_bf16 v[128:131], v[244:247], a[188:191], v[128:131]
  v_mul_f32 v116, s42, v116
  v_mul_f32 v117, s42, v117
  v_mfma_f32_16x16x32_bf16 v[132:135], v[236:239], a[184:187], v[132:135]
  v_mul_f32 v118, s42, v118
  v_mul_f32 v119, s42, v119
  v_mfma_f32_16x16x32_bf16 v[132:135], v[248:251], a[188:191], v[132:135]
  s_add_u32 s5, s44, 147840
  s_add_u32 m0, s46, 24576
  v_cvt_pk_bf16_f32 v100, v116, v117
  v_mfma_f32_16x16x32_bf16 v[96:99], v[240:243], a[184:187], v[96:99]
  buffer_load_dwordx4 v52, s[12:15], s5 offen offset:0 lds
  v_mfma_f32_16x16x32_bf16 v[96:99], v[252:255], a[188:191], v[96:99]
  s_add_u32 m0, s46, 32640
  v_cvt_pk_bf16_f32 v101, v118, v119
  v_mul_f32 v112, s42, v112
  v_mfma_f32_16x16x32_bf16 v[120:123], v[232:235], a[208:211], v[120:123]
  buffer_load_dwordx4 v52, s[12:15], s5 offen offset:128 lds
  v_mfma_f32_16x16x32_bf16 v[120:123], v[244:247], a[212:215], v[120:123]
  s_add_u32 m0, s46, 40704
  v_mul_f32 v113, s42, v113
  v_mul_f32 v114, s42, v114
  v_mfma_f32_16x16x32_bf16 v[124:127], v[236:239], a[208:211], v[124:127]
  buffer_load_dwordx4 v52, s[12:15], s5 offen offset:256 lds
  v_mfma_f32_16x16x32_bf16 v[124:127], v[248:251], a[212:215], v[124:127]
  s_waitcnt vmcnt(9) lgkmcnt(0)
  s_barrier
  v_mfma_f32_16x16x32_bf16 v[108:111], v[240:243], a[208:211], v[108:111]
  s_add_u32 s5, s44, 184704
  s_add_u32 m0, s46, 28672
  ds_read_b64_tr_b16 a[0:1], v59 offset:0
  v_mfma_f32_16x16x32_bf16 v[108:111], v[252:255], a[212:215], v[108:111]
  buffer_load_dwordx4 v52, s[12:15], s5 offen offset:0 lds
  v_mfma_f32_16x16x32_bf16 v[92:95], v[232:235], a[232:235], v[92:95]
  s_add_u32 m0, s46, 36736
  ds_read_b64_tr_b16 a[2:3], v59 offset:512
  ds_read_b64_tr_b16 a[12:13], v59 offset:4096
  v_mfma_f32_16x16x32_bf16 v[92:95], v[244:247], a[236:239], v[92:95]
  buffer_load_dwordx4 v52, s[12:15], s5 offen offset:128 lds
  v_mfma_f32_16x16x32_bf16 v[104:107], v[236:239], a[232:235], v[104:107]
  s_add_u32 m0, s46, 44800
  ds_read_b64_tr_b16 a[14:15], v59 offset:4608
  ds_read_b64_tr_b16 a[4:5], v57 offset:0
  v_mfma_f32_16x16x32_bf16 v[104:107], v[248:251], a[236:239], v[104:107]
  buffer_load_dwordx4 v52, s[12:15], s5 offen offset:256 lds
  v_mfma_f32_16x16x32_bf16 v[88:91], v[240:243], a[232:235], v[88:91]
  ds_read_b64_tr_b16 a[6:7], v57 offset:512
  ds_read_b64_tr_b16 a[16:17], v57 offset:4096
  v_mfma_f32_16x16x32_bf16 v[88:91], v[252:255], a[236:239], v[88:91]
  ds_read_b64_tr_b16 a[18:19], v57 offset:4608
  ds_read_b64_tr_b16 a[8:9], v53 offset:0
  s_waitcnt lgkmcnt(7)
  v_mfma_f32_16x16x32_bf16 v[178:181], a[0:3], a[144:147], 0
  ds_read_b64_tr_b16 a[10:11], v53 offset:512
  ds_read_b64_tr_b16 a[20:21], v53 offset:4096
  s_waitcnt lgkmcnt(7)
  v_mfma_f32_16x16x32_bf16 v[178:181], a[12:15], a[148:151], v[178:181]
  ds_read_b64_tr_b16 a[22:23], v53 offset:4608
  v_mul_f32 v115, s42, v115
  s_waitcnt lgkmcnt(6)
  v_mfma_f32_16x16x32_bf16 v[148:151], a[4:7], a[144:147], 0
  v_cvt_pk_bf16_f32 v102, v112, v113
  v_cvt_pk_bf16_f32 v103, v114, v115
  s_waitcnt lgkmcnt(4)
  v_mfma_f32_16x16x32_bf16 v[148:151], a[16:19], a[148:151], v[148:151]
  v_mul_f32 v128, s42, v128
  v_mul_f32 v129, s42, v129
  s_waitcnt lgkmcnt(2)
  v_mfma_f32_16x16x32_bf16 v[164:167], a[8:11], a[144:147], 0
  v_mul_f32 v130, s42, v130
  v_mul_f32 v131, s42, v131
  s_waitcnt lgkmcnt(0)
  v_mfma_f32_16x16x32_bf16 v[164:167], a[20:23], a[148:151], v[164:167]
  v_cvt_pk_bf16_f32 v112, v128, v129
  v_cvt_pk_bf16_f32 v113, v130, v131
  v_mfma_f32_16x16x32_bf16 v[116:119], a[0:3], a[168:171], 0
  v_mul_f32 v132, s42, v132
  v_mul_f32 v133, s42, v133
  v_mfma_f32_16x16x32_bf16 v[116:119], a[12:15], a[172:175], v[116:119]
  v_mul_f32 v134, s42, v134
  v_mul_f32 v135, s42, v135
  v_mfma_f32_16x16x32_bf16 v[152:155], a[4:7], a[168:171], 0
  v_cvt_pk_bf16_f32 v114, v132, v133
  v_cvt_pk_bf16_f32 v115, v134, v135
  v_mfma_f32_16x16x32_bf16 v[152:155], a[16:19], a[172:175], v[152:155]
  s_add_u32 s5, s44, 768
  s_add_u32 m0, s46, 49152
  v_mul_f32 v96, s42, v96
  v_mfma_f32_16x16x32_bf16 v[172:175], a[8:11], a[168:171], 0
  buffer_load_dwordx4 v52, s[12:15], s5 offen offset:0 lds
  v_mfma_f32_16x16x32_bf16 v[172:175], a[20:23], a[172:175], v[172:175]
  s_add_u32 m0, s46, 57216
  v_mul_f32 v97, s42, v97
  v_mul_f32 v98, s42, v98
  v_mfma_f32_16x16x32_bf16 v[136:139], a[0:3], a[192:195], 0
  buffer_load_dwordx4 v52, s[12:15], s5 offen offset:128 lds
  v_mfma_f32_16x16x32_bf16 v[136:139], a[12:15], a[196:199], v[136:139]
  s_add_u32 m0, s46, 65280
  v_mul_f32 v99, s42, v99
  v_cvt_pk_bf16_f32 v16, v96, v97
  v_mfma_f32_16x16x32_bf16 v[160:163], a[4:7], a[192:195], 0
  buffer_load_dwordx4 v52, s[12:15], s5 offen offset:256 lds
  v_mfma_f32_16x16x32_bf16 v[160:163], a[16:19], a[196:199], v[160:163]
  s_waitcnt vmcnt(9) lgkmcnt(0)
  s_barrier
  v_mfma_f32_16x16x32_bf16 v[156:159], a[8:11], a[192:195], 0
  s_add_u32 s5, s44, 37632
  s_add_u32 m0, s46, 53248
  ds_read_b64_tr_b16 a[24:25], v59 offset:24576
  v_mfma_f32_16x16x32_bf16 v[156:159], a[20:23], a[196:199], v[156:159]
  buffer_load_dwordx4 v52, s[12:15], s5 offen offset:0 lds
  v_mfma_f32_16x16x32_bf16 v[168:171], a[0:3], a[216:219], 0
  s_add_u32 m0, s46, 61312
  ds_read_b64_tr_b16 a[26:27], v59 offset:25088
  ds_read_b64_tr_b16 a[36:37], v59 offset:28672
  v_mfma_f32_16x16x32_bf16 v[168:171], a[12:15], a[220:223], v[168:171]
  buffer_load_dwordx4 v52, s[12:15], s5 offen offset:128 lds
  v_mfma_f32_16x16x32_bf16 v[144:147], a[4:7], a[216:219], 0
  s_add_u32 m0, s46, 69376
  ds_read_b64_tr_b16 a[38:39], v59 offset:29184
  ds_read_b64_tr_b16 a[28:29], v57 offset:24576
  v_mfma_f32_16x16x32_bf16 v[144:147], a[16:19], a[220:223], v[144:147]
  buffer_load_dwordx4 v52, s[12:15], s5 offen offset:256 lds
  v_mfma_f32_16x16x32_bf16 v[140:143], a[8:11], a[216:219], 0
  ds_read_b64_tr_b16 a[30:31], v57 offset:25088
  ds_read_b64_tr_b16 a[40:41], v57 offset:28672
  v_mfma_f32_16x16x32_bf16 v[140:143], a[20:23], a[220:223], v[140:143]
  ds_read_b64_tr_b16 a[42:43], v57 offset:29184
  ds_read_b64_tr_b16 a[32:33], v53 offset:24576
  s_waitcnt lgkmcnt(7)
  v_mfma_f32_16x16x32_bf16 v[178:181], a[24:27], a[152:155], v[178:181]
  ds_read_b64_tr_b16 a[34:35], v53 offset:25088
  ds_read_b64_tr_b16 a[44:45], v53 offset:28672
  s_waitcnt lgkmcnt(7)
  v_mfma_f32_16x16x32_bf16 v[178:181], a[36:39], a[156:159], v[178:181]
  ds_read_b64_tr_b16 a[46:47], v53 offset:29184
  v_cvt_pk_bf16_f32 v17, v98, v99
  s_waitcnt lgkmcnt(6)
  v_mfma_f32_16x16x32_bf16 v[148:151], a[28:31], a[152:155], v[148:151]
  v_mul_f32 v120, s42, v120
  v_mul_f32 v121, s42, v121
  s_waitcnt lgkmcnt(4)
  v_mfma_f32_16x16x32_bf16 v[148:151], a[40:43], a[156:159], v[148:151]
  v_mul_f32 v122, s42, v122
  v_mul_f32 v123, s42, v123
  s_waitcnt lgkmcnt(2)
  v_mfma_f32_16x16x32_bf16 v[164:167], a[32:35], a[152:155], v[164:167]
  v_cvt_pk_bf16_f32 v18, v120, v121
  v_cvt_pk_bf16_f32 v19, v122, v123
  s_waitcnt lgkmcnt(0)
  v_mfma_f32_16x16x32_bf16 v[164:167], a[44:47], a[156:159], v[164:167]
  v_mul_f32 v124, s42, v124
  v_mul_f32 v125, s42, v125
  v_mfma_f32_16x16x32_bf16 v[116:119], a[24:27], a[176:179], v[116:119]
  v_mul_f32 v126, s42, v126
  v_mul_f32 v127, s42, v127
  v_mfma_f32_16x16x32_bf16 v[116:119], a[36:39], a[180:183], v[116:119]
  v_cvt_pk_bf16_f32 v130, v124, v125
  v_cvt_pk_bf16_f32 v131, v126, v127
  v_mfma_f32_16x16x32_bf16 v[152:155], a[28:31], a[176:179], v[152:155]
  v_mul_f32 v108, s42, v108
  v_mul_f32 v109, s42, v109
  v_mfma_f32_16x16x32_bf16 v[152:155], a[40:43], a[180:183], v[152:155]
  s_add_u32 s5, s44, 74496
  s_add_u32 m0, s46, 73728
  v_mul_f32 v110, s42, v110
  v_mfma_f32_16x16x32_bf16 v[172:175], a[32:35], a[176:179], v[172:175]
  buffer_load_dwordx4 v52, s[12:15], s5 offen offset:0 lds
  v_mfma_f32_16x16x32_bf16 v[172:175], a[44:47], a[180:183], v[172:175]
  s_add_u32 m0, s46, 81792
  v_mul_f32 v111, s42, v111
  v_cvt_pk_bf16_f32 v132, v108, v109
  v_mfma_f32_16x16x32_bf16 v[136:139], a[24:27], a[200:203], v[136:139]
  buffer_load_dwordx4 v52, s[12:15], s5 offen offset:128 lds
  v_mfma_f32_16x16x32_bf16 v[136:139], a[36:39], a[204:207], v[136:139]
  s_add_u32 m0, s46, 89856
  v_cvt_pk_bf16_f32 v133, v110, v111
  v_mul_f32 v92, s42, v92
  v_mfma_f32_16x16x32_bf16 v[160:163], a[28:31], a[200:203], v[160:163]
  buffer_load_dwordx4 v52, s[12:15], s5 offen offset:256 lds
  v_mfma_f32_16x16x32_bf16 v[160:163], a[40:43], a[204:207], v[160:163]
  s_waitcnt vmcnt(9) lgkmcnt(0)
  s_barrier
  v_mfma_f32_16x16x32_bf16 v[156:159], a[32:35], a[200:203], v[156:159]
  s_add_u32 s5, s44, 111360
  s_add_u32 m0, s46, 77824
  ds_read_b64_tr_b16 a[48:49], v65 offset:0
  v_mfma_f32_16x16x32_bf16 v[156:159], a[44:47], a[204:207], v[156:159]
  buffer_load_dwordx4 v52, s[12:15], s5 offen offset:0 lds
  v_mfma_f32_16x16x32_bf16 v[168:171], a[24:27], a[224:227], v[168:171]
  s_add_u32 m0, s46, 85888
  ds_read_b64_tr_b16 a[50:51], v65 offset:512
  ds_read_b64_tr_b16 a[60:61], v65 offset:4096
  v_mfma_f32_16x16x32_bf16 v[168:171], a[36:39], a[228:231], v[168:171]
  buffer_load_dwordx4 v52, s[12:15], s5 offen offset:128 lds
  v_mfma_f32_16x16x32_bf16 v[144:147], a[28:31], a[224:227], v[144:147]
  s_add_u32 m0, s46, 93952
  ds_read_b64_tr_b16 a[62:63], v65 offset:4608
  ds_read_b64_tr_b16 a[52:53], v82 offset:0
  v_mfma_f32_16x16x32_bf16 v[144:147], a[40:43], a[228:231], v[144:147]
  buffer_load_dwordx4 v52, s[12:15], s5 offen offset:256 lds
  v_mfma_f32_16x16x32_bf16 v[140:143], a[32:35], a[224:227], v[140:143]
  ds_read_b64_tr_b16 a[54:55], v82 offset:512
  ds_read_b64_tr_b16 a[64:65], v82 offset:4096
  v_mfma_f32_16x16x32_bf16 v[140:143], a[44:47], a[228:231], v[140:143]
  ds_read_b64_tr_b16 a[66:67], v82 offset:4608
  ds_read_b64_tr_b16 a[56:57], v56 offset:0
  s_waitcnt lgkmcnt(7)
  v_mfma_f32_16x16x32_bf16 v[178:181], a[48:51], a[160:163], v[178:181]
  ds_read_b64_tr_b16 a[58:59], v56 offset:512
  ds_read_b64_tr_b16 a[68:69], v56 offset:4096
  s_waitcnt lgkmcnt(7)
  v_mfma_f32_16x16x32_bf16 v[178:181], a[60:63], a[164:167], v[178:181]
  ds_read_b64_tr_b16 a[70:71], v56 offset:4608
  v_mul_f32 v93, s42, v93
  s_waitcnt lgkmcnt(6)
  v_mfma_f32_16x16x32_bf16 v[148:151], a[52:55], a[160:163], v[148:151]
  v_mul_f32 v94, s42, v94
  v_mul_f32 v95, s42, v95
  s_waitcnt lgkmcnt(4)
  v_mfma_f32_16x16x32_bf16 v[148:151], a[64:67], a[164:167], v[148:151]
  v_cvt_pk_bf16_f32 v176, v92, v93
  v_cvt_pk_bf16_f32 v177, v94, v95
  s_waitcnt lgkmcnt(2)
  v_mfma_f32_16x16x32_bf16 v[164:167], a[56:59], a[160:163], v[164:167]
  v_cvt_pk_bf16_f32 v124, v178, v179
  v_cvt_pk_bf16_f32 v125, v180, v181
  s_waitcnt lgkmcnt(0)
  v_mfma_f32_16x16x32_bf16 v[164:167], a[68:71], a[164:167], v[164:167]
  v_mul_f32 v104, s42, v104
  v_mul_f32 v105, s42, v105
  v_mfma_f32_16x16x32_bf16 v[116:119], a[48:51], a[184:187], v[116:119]
  v_cvt_pk_bf16_f32 v126, v148, v149
  v_cvt_pk_bf16_f32 v127, v150, v151
  v_mfma_f32_16x16x32_bf16 v[116:119], a[60:63], a[188:191], v[116:119]
  v_mul_f32 v106, s42, v106
  v_mul_f32 v107, s42, v107
  v_mfma_f32_16x16x32_bf16 v[152:155], a[52:55], a[184:187], v[152:155]
  v_cvt_pk_bf16_f32 v128, v164, v165
  v_cvt_pk_bf16_f32 v129, v166, v167
  v_mfma_f32_16x16x32_bf16 v[152:155], a[64:67], a[188:191], v[152:155]
  s_add_u32 s5, s44, 148224
  s_add_u32 m0, s46, 98304
  v_cvt_pk_bf16_f32 v178, v104, v105
  v_mfma_f32_16x16x32_bf16 v[172:175], a[56:59], a[184:187], v[172:175]
  buffer_load_dwordx4 v52, s[12:15], s5 offen offset:0 lds
  v_cvt_pk_bf16_f32 v148, v116, v117
  v_mfma_f32_16x16x32_bf16 v[172:175], a[68:71], a[188:191], v[172:175]
  s_add_u32 m0, s46, 106368
  v_cvt_pk_bf16_f32 v149, v118, v119
  v_cvt_pk_bf16_f32 v179, v106, v107
  v_mfma_f32_16x16x32_bf16 v[136:139], a[48:51], a[208:211], v[136:139]
  buffer_load_dwordx4 v52, s[12:15], s5 offen offset:128 lds
  v_cvt_pk_bf16_f32 v150, v152, v153
  v_mfma_f32_16x16x32_bf16 v[136:139], a[60:63], a[212:215], v[136:139]
  s_add_u32 m0, s46, 114432
  v_cvt_pk_bf16_f32 v151, v154, v155
  v_mul_f32 v88, s42, v88
  v_mfma_f32_16x16x32_bf16 v[160:163], a[52:55], a[208:211], v[160:163]
  buffer_load_dwordx4 v52, s[12:15], s5 offen offset:256 lds
  v_cvt_pk_bf16_f32 v152, v172, v173
  v_mfma_f32_16x16x32_bf16 v[160:163], a[64:67], a[212:215], v[160:163]
  s_waitcnt vmcnt(9) lgkmcnt(0)
  s_barrier
  v_mfma_f32_16x16x32_bf16 v[156:159], a[56:59], a[208:211], v[156:159]
  s_add_u32 s5, s44, 185088
  s_add_u32 m0, s46, 102400
  ds_read_b64_tr_b16 a[72:73], v65 offset:24576
  v_cvt_pk_bf16_f32 v134, v136, v137
  v_mfma_f32_16x16x32_bf16 v[156:159], a[68:71], a[212:215], v[156:159]
  buffer_load_dwordx4 v52, s[12:15], s5 offen offset:0 lds
  v_cvt_pk_bf16_f32 v135, v138, v139
  v_mfma_f32_16x16x32_bf16 v[168:171], a[48:51], a[232:235], v[168:171]
  s_add_u32 m0, s46, 110464
  ds_read_b64_tr_b16 a[74:75], v65 offset:25088
  ds_read_b64_tr_b16 a[84:85], v65 offset:28672
  v_cvt_pk_bf16_f32 v136, v160, v161
  v_mfma_f32_16x16x32_bf16 v[168:171], a[60:63], a[236:239], v[168:171]
  buffer_load_dwordx4 v52, s[12:15], s5 offen offset:128 lds
  v_cvt_pk_bf16_f32 v137, v162, v163
  v_mfma_f32_16x16x32_bf16 v[144:147], a[52:55], a[232:235], v[144:147]
  s_add_u32 m0, s46, 118528
  ds_read_b64_tr_b16 a[86:87], v65 offset:29184
  ds_read_b64_tr_b16 a[76:77], v82 offset:24576
  v_cvt_pk_bf16_f32 v153, v174, v175
  v_mfma_f32_16x16x32_bf16 v[144:147], a[64:67], a[236:239], v[144:147]
  buffer_load_dwordx4 v52, s[12:15], s5 offen offset:256 lds
  v_cvt_pk_bf16_f32 v138, v156, v157
  v_mfma_f32_16x16x32_bf16 v[140:143], a[56:59], a[232:235], v[140:143]
  ds_read_b64_tr_b16 a[78:79], v82 offset:25088
  ds_read_b64_tr_b16 a[88:89], v82 offset:28672
  v_cvt_pk_bf16_f32 v160, v168, v169
  v_mfma_f32_16x16x32_bf16 v[140:143], a[68:71], a[236:239], v[140:143]
  ds_read_b64_tr_b16 a[90:91], v82 offset:29184
  ds_read_b64_tr_b16 a[80:81], v56 offset:24576
  v_cvt_pk_bf16_f32 v161, v170, v171
  v_mfma_f32_16x16x32_bf16 v[116:119], v[126:129], v[100:103], v[36:39]
  ds_read_b64_tr_b16 a[82:83], v56 offset:25088
  ds_read_b64_tr_b16 a[92:93], v56 offset:28672
  v_cvt_pk_bf16_f32 v162, v144, v145
  v_mfma_f32_16x16x32_bf16 v[116:119], v[124:127], v[12:15], v[116:119]
  ds_read_b64_tr_b16 a[94:95], v56 offset:29184
  v_cvt_pk_bf16_f32 v163, v146, v147
  v_cvt_pk_bf16_f32 v139, v158, v159
  v_mfma_f32_16x16x32_bf16 v[120:123], v[150:153], v[100:103], v[32:35]
  v_cvt_pk_bf16_f32 v164, v140, v141
  v_cvt_pk_bf16_f32 v165, v142, v143
  v_mfma_f32_16x16x32_bf16 v[120:123], v[148:151], v[12:15], v[120:123]
  v_mul_f32 v89, s42, v89
  v_mul_f32 v90, s42, v90
  v_mfma_f32_16x16x32_bf16 v[154:157], v[136:139], v[100:103], v[84:87]
  v_mul_f32 v91, s42, v91
  v_cvt_pk_bf16_f32 v22, v88, v89
  v_mfma_f32_16x16x32_bf16 v[154:157], v[134:137], v[12:15], v[154:157]
  v_cvt_pk_bf16_f32 v23, v90, v91
  v_mfma_f32_16x16x32_bf16 v[144:147], v[162:165], v[100:103], v[78:81]
  v_exp_f32 v116, v116
  v_mfma_f32_16x16x32_bf16 v[144:147], v[160:163], v[12:15], v[144:147]
  v_exp_f32 v117, v117
  v_mfma_f32_16x16x32_bf16 v[88:91], v[124:127], v[112:115], v[40:43]
  v_exp_f32 v118, v118
  v_mfma_f32_16x16x32_bf16 v[88:91], v[126:129], v[14:17], v[88:91]
  v_exp_f32 v119, v119
  v_mfma_f32_16x16x32_bf16 v[92:95], v[148:151], v[112:115], v[36:39]
  s_add_u32 m0, s28, 0
  v_cvt_pk_bf16_f32 v116, v116, v117
  v_cvt_pk_bf16_f32 v117, v118, v119
  v_mfma_f32_16x16x32_bf16 v[92:95], v[150:153], v[14:17], v[92:95]
  buffer_load_dwordx4 v6, s[8:11], s31 offen offset:0 nt lds
  v_mfma_f32_16x16x32_bf16 v[140:143], v[134:137], v[112:115], v[60:63]
  s_add_u32 m0, s28, 8064
  v_exp_f32 v120, v120
  v_mfma_f32_16x16x32_bf16 v[140:143], v[136:139], v[14:17], v[140:143]
  buffer_load_dwordx4 v6, s[8:11], s31 offen offset:128 nt lds
  v_mfma_f32_16x16x32_bf16 v[60:63], v[160:163], v[112:115], v[84:87]
  s_add_u32 m0, s28, 16128
  v_exp_f32 v121, v121
  v_mfma_f32_16x16x32_bf16 v[60:63], v[162:165], v[14:17], v[60:63]
  buffer_load_dwordx4 v6, s[8:11], s31 offen offset:256 nt lds
  v_mfma_f32_16x16x32_bf16 v[96:99], v[126:129], v[130:133], v[74:77]
  s_waitcnt vmcnt(9) lgkmcnt(0)
  s_barrier
  v_mfma_f32_16x16x32_bf16 v[96:99], v[124:127], v[18:21], v[96:99]
  s_add_u32 m0, s28, 4096
  ds_read_b64_tr_b16 a[96:97], v65 offset:49152
  ds_read_b64_tr_b16 a[98:99], v65 offset:49664
  v_mfma_f32_16x16x32_bf16 v[100:103], v[150:153], v[130:133], v[70:73]
  buffer_load_dwordx4 v6, s[8:11], s32 offen offset:0 nt lds
  v_mfma_f32_16x16x32_bf16 v[100:103], v[148:151], v[18:21], v[100:103]
  s_add_u32 m0, s28, 12160
  ds_read_b64_tr_b16 a[108:109], v65 offset:53248
  ds_read_b64_tr_b16 a[110:111], v65 offset:53760
  v_mfma_f32_16x16x32_bf16 v[104:107], v[136:139], v[130:133], v[36:39]
  buffer_load_dwordx4 v6, s[8:11], s32 offen offset:128 nt lds
  v_mfma_f32_16x16x32_bf16 v[104:107], v[134:137], v[18:21], v[104:107]
  s_add_u32 m0, s28, 20224
  ds_read_b64_tr_b16 a[100:101], v82 offset:49152
  ds_read_b64_tr_b16 a[102:103], v82 offset:49664
  v_mfma_f32_16x16x32_bf16 v[84:87], v[162:165], v[130:133], v[32:35]
  buffer_load_dwordx4 v6, s[8:11], s32 offen offset:256 nt lds
  v_mfma_f32_16x16x32_bf16 v[84:87], v[160:163], v[18:21], v[84:87]
  ds_read_b64_tr_b16 a[112:113], v82 offset:53248
  ds_read_b64_tr_b16 a[114:115], v82 offset:53760
  v_mfma_f32_16x16x32_bf16 v[108:111], v[124:127], v[176:179], v[66:69]
  ds_read_b64_tr_b16 a[104:105], v56 offset:49152
  ds_read_b64_tr_b16 a[106:107], v56 offset:49664
  v_mfma_f32_16x16x32_bf16 v[108:111], v[126:129], v[20:23], v[108:111]
  ds_read_b64_tr_b16 a[116:117], v56 offset:53248
  ds_read_b64_tr_b16 a[118:119], v56 offset:53760
  v_mfma_f32_16x16x32_bf16 v[112:115], v[148:151], v[176:179], v[74:77]
  v_exp_f32 v122, v122
  v_mfma_f32_16x16x32_bf16 v[112:115], v[150:153], v[20:23], v[112:115]
  v_exp_f32 v123, v123
  v_mfma_f32_16x16x32_bf16 v[70:73], v[134:137], v[176:179], v[40:43]
  v_cvt_pk_bf16_f32 v118, v120, v121
  v_cvt_pk_bf16_f32 v119, v122, v123
  v_mfma_f32_16x16x32_bf16 v[70:73], v[136:139], v[20:23], v[70:73]
  v_exp_f32 v154, v154
  v_mfma_f32_16x16x32_bf16 v[78:81], v[160:163], v[176:179], v[36:39]
  v_exp_f32 v155, v155
  v_mfma_f32_16x16x32_bf16 v[78:81], v[162:165], v[20:23], v[78:81]
  v_exp_f32 v156, v156
  v_mfma_f32_16x16x32_bf16 v[66:69], a[144:147], a[72:75], 0
  v_add_u32 v0, s28, v2
  v_xor_b32 v1, 64, v0
  v_mfma_f32_16x16x32_bf16 v[66:69], a[148:151], a[84:87], v[66:69]
  v_exp_f32 v157, v157
  v_mfma_f32_16x16x32_bf16 v[74:77], a[144:147], a[76:79], 0
  v_cvt_pk_bf16_f32 v120, v154, v155
  v_cvt_pk_bf16_f32 v121, v156, v157
  v_mfma_f32_16x16x32_bf16 v[74:77], a[148:151], a[88:91], v[74:77]
  v_exp_f32 v144, v144
  v_mfma_f32_16x16x32_bf16 v[124:127], a[144:147], a[80:83], 0
  v_exp_f32 v145, v145
  v_mfma_f32_16x16x32_bf16 v[124:127], a[148:151], a[92:95], v[124:127]
  v_exp_f32 v146, v146
  v_mfma_f32_16x16x32_bf16 v[132:135], a[168:171], a[72:75], 0
  v_exp_f32 v147, v147
  v_mfma_f32_16x16x32_bf16 v[132:135], a[172:175], a[84:87], v[132:135]
  v_cvt_pk_bf16_f32 v122, v144, v145
  v_cvt_pk_bf16_f32 v123, v146, v147
  v_mfma_f32_16x16x32_bf16 v[136:139], a[168:171], a[76:79], 0
  v_exp_f32 v88, v88
  v_mfma_f32_16x16x32_bf16 v[136:139], a[172:175], a[88:91], v[136:139]
  s_add_u32 s5, s45, 0
  s_add_u32 m0, s46, 122880
  v_mfma_f32_16x16x32_bf16 v[128:131], a[168:171], a[80:83], 0
  buffer_load_dwordx4 v54, s[16:19], s5 offen offset:0 lds
  v_mfma_f32_16x16x32_bf16 v[128:131], a[172:175], a[92:95], v[128:131]
  s_add_u32 m0, s46, 130944
  v_exp_f32 v89, v89
  s_waitcnt lgkmcnt(10)
  v_mfma_f32_16x16x32_bf16 v[66:69], a[152:155], a[96:99], v[66:69]
  buffer_load_dwordx4 v54, s[16:19], s5 offen offset:128 lds
  s_waitcnt lgkmcnt(8)
  v_mfma_f32_16x16x32_bf16 v[66:69], a[156:159], a[108:111], v[66:69]
  s_add_u32 m0, s46, 139008
  v_exp_f32 v90, v90
  s_waitcnt lgkmcnt(6)
  v_mfma_f32_16x16x32_bf16 v[74:77], a[152:155], a[100:103], v[74:77]
  buffer_load_dwordx4 v54, s[16:19], s5 offen offset:256 lds
  s_waitcnt lgkmcnt(4)
  v_mfma_f32_16x16x32_bf16 v[74:77], a[156:159], a[112:115], v[74:77]
  s_waitcnt vmcnt(9) lgkmcnt(0)
  s_barrier
  v_mfma_f32_16x16x32_bf16 v[124:127], a[152:155], a[104:107], v[124:127]
  s_add_u32 s5, s45, 12288
  s_add_u32 m0, s46, 126976
  ds_read_b64_tr_b16 a[120:121], v59 offset:0
  v_mfma_f32_16x16x32_bf16 v[124:127], a[156:159], a[116:119], v[124:127]
  buffer_load_dwordx4 v54, s[16:19], s5 offen offset:0 lds
  v_mfma_f32_16x16x32_bf16 v[132:135], a[176:179], a[96:99], v[132:135]
  s_add_u32 m0, s46, 135040
  ds_read_b64_tr_b16 a[122:123], v59 offset:512
  ds_read_b64_tr_b16 a[132:133], v59 offset:4096
  v_mfma_f32_16x16x32_bf16 v[132:135], a[180:183], a[108:111], v[132:135]
  buffer_load_dwordx4 v54, s[16:19], s5 offen offset:128 lds
  v_mfma_f32_16x16x32_bf16 v[136:139], a[176:179], a[100:103], v[136:139]
  s_add_u32 m0, s46, 143104
  ds_read_b64_tr_b16 a[134:135], v59 offset:4608
  ds_read_b64_tr_b16 a[124:125], v57 offset:0
  v_mfma_f32_16x16x32_bf16 v[136:139], a[180:183], a[112:115], v[136:139]
  buffer_load_dwordx4 v54, s[16:19], s5 offen offset:256 lds
  v_mfma_f32_16x16x32_bf16 v[128:131], a[176:179], a[104:107], v[128:131]
  ds_read_b64_tr_b16 a[126:127], v57 offset:512
  ds_read_b64_tr_b16 a[136:137], v57 offset:4096
  v_mfma_f32_16x16x32_bf16 v[128:131], a[180:183], a[116:119], v[128:131]
  ds_read_b64_tr_b16 a[138:139], v57 offset:4608
  ds_read_b64_tr_b16 a[128:129], v53 offset:0
  s_waitcnt lgkmcnt(7)
  v_mfma_f32_16x16x32_bf16 v[66:69], a[160:163], a[120:123], v[66:69]
  ds_read_b64_tr_b16 a[130:131], v53 offset:512
  ds_read_b64_tr_b16 a[140:141], v53 offset:4096
  s_waitcnt lgkmcnt(7)
  v_mfma_f32_16x16x32_bf16 v[66:69], a[164:167], a[132:135], v[66:69]
  ds_read_b64_tr_b16 a[142:143], v53 offset:4608
  s_waitcnt lgkmcnt(6)
  v_mfma_f32_16x16x32_bf16 v[74:77], a[160:163], a[124:127], v[74:77]
  v_exp_f32 v91, v91
  s_waitcnt lgkmcnt(4)
  v_mfma_f32_16x16x32_bf16 v[74:77], a[164:167], a[136:139], v[74:77]
  v_cvt_pk_bf16_f32 v88, v88, v89
  v_cvt_pk_bf16_f32 v89, v90, v91
  s_waitcnt lgkmcnt(2)
  v_mfma_f32_16x16x32_bf16 v[124:127], a[160:163], a[128:131], v[124:127]
  v_cvt_pk_bf16_f32 v148, v66, v67
  v_cvt_pk_bf16_f32 v149, v68, v69
  s_waitcnt lgkmcnt(0)
  v_mfma_f32_16x16x32_bf16 v[124:127], a[164:167], a[140:143], v[124:127]
  v_exp_f32 v92, v92
  v_mfma_f32_16x16x32_bf16 v[132:135], a[184:187], a[120:123], v[132:135]
  v_cvt_pk_bf16_f32 v66, v74, v75
  v_cvt_pk_bf16_f32 v67, v76, v77
  v_mfma_f32_16x16x32_bf16 v[132:135], a[188:191], a[132:135], v[132:135]
  v_exp_f32 v93, v93
  v_mfma_f32_16x16x32_bf16 v[136:139], a[184:187], a[124:127], v[136:139]
  v_cvt_pk_bf16_f32 v144, v124, v125
  v_cvt_pk_bf16_f32 v145, v126, v127
  v_mfma_f32_16x16x32_bf16 v[136:139], a[188:191], a[136:139], v[136:139]
  v_exp_f32 v94, v94
  v_mfma_f32_16x16x32_bf16 v[128:131], a[184:187], a[128:131], v[128:131]
  v_cvt_pk_bf16_f32 v150, v132, v133
  v_cvt_pk_bf16_f32 v151, v134, v135
  v_mfma_f32_16x16x32_bf16 v[128:131], a[188:191], a[140:143], v[128:131]
  v_exp_f32 v95, v95
  v_mfma_f32_16x16x32_bf16 v[74:77], a[192:195], a[72:75], 0
  v_cvt_pk_bf16_f32 v68, v136, v137
  v_cvt_pk_bf16_f32 v69, v138, v139
  v_mfma_f32_16x16x32_bf16 v[74:77], a[196:199], a[84:87], v[74:77]
  v_cvt_pk_bf16_f32 v90, v92, v93
  v_cvt_pk_bf16_f32 v91, v94, v95
  v_mfma_f32_16x16x32_bf16 v[74:77], a[200:203], a[96:99], v[74:77]
  v_cvt_pk_bf16_f32 v146, v128, v129
  v_cvt_pk_bf16_f32 v147, v130, v131
  v_mfma_f32_16x16x32_bf16 v[74:77], a[204:207], a[108:111], v[74:77]
  v_exp_f32 v140, v140
  v_mfma_f32_16x16x32_bf16 v[74:77], a[208:211], a[120:123], v[74:77]
  v_exp_f32 v141, v141
  v_mfma_f32_16x16x32_bf16 v[74:77], a[212:215], a[132:135], v[74:77]
  v_exp_f32 v142, v142
  v_mfma_f32_16x16x32_bf16 v[124:127], a[192:195], a[76:79], 0
  v_exp_f32 v143, v143
  v_mfma_f32_16x16x32_bf16 v[124:127], a[196:199], a[88:91], v[124:127]
  v_cvt_pk_bf16_f32 v92, v140, v141
  v_cvt_pk_bf16_f32 v93, v142, v143
  v_mfma_f32_16x16x32_bf16 v[124:127], a[200:203], a[100:103], v[124:127]
  v_cvt_pk_bf16_f32 v152, v74, v75
  v_cvt_pk_bf16_f32 v153, v76, v77
  v_mfma_f32_16x16x32_bf16 v[124:127], a[204:207], a[112:115], v[124:127]
  v_exp_f32 v60, v60
  v_mfma_f32_16x16x32_bf16 v[124:127], a[208:211], a[124:127], v[124:127]
  v_exp_f32 v61, v61
  v_mfma_f32_16x16x32_bf16 v[124:127], a[212:215], a[136:139], v[124:127]
  v_exp_f32 v62, v62
  v_mfma_f32_16x16x32_bf16 v[74:77], a[192:195], a[80:83], 0
  v_exp_f32 v63, v63
  v_mfma_f32_16x16x32_bf16 v[74:77], a[196:199], a[92:95], v[74:77]
  v_cvt_pk_bf16_f32 v94, v60, v61
  v_cvt_pk_bf16_f32 v95, v62, v63
  v_mfma_f32_16x16x32_bf16 v[74:77], a[200:203], a[104:107], v[74:77]
  v_cvt_pk_bf16_f32 v178, v124, v125
  v_cvt_pk_bf16_f32 v179, v126, v127
  v_mfma_f32_16x16x32_bf16 v[74:77], a[204:207], a[116:119], v[74:77]
  v_exp_f32 v96, v96
  v_mfma_f32_16x16x32_bf16 v[74:77], a[208:211], a[128:131], v[74:77]
  v_exp_f32 v97, v97
  v_mfma_f32_16x16x32_bf16 v[74:77], a[212:215], a[140:143], v[74:77]
  v_exp_f32 v98, v98
  v_mfma_f32_16x16x32_bf16 v[60:63], a[216:219], a[72:75], 0
  v_exp_f32 v99, v99
  v_mfma_f32_16x16x32_bf16 v[60:63], a[220:223], a[84:87], v[60:63]
  v_cvt_pk_bf16_f32 v96, v96, v97
  v_cvt_pk_bf16_f32 v97, v98, v99
  v_mfma_f32_16x16x32_bf16 v[60:63], a[224:227], a[96:99], v[60:63]
  v_cvt_pk_bf16_f32 v170, v74, v75
  v_cvt_pk_bf16_f32 v171, v76, v77
  v_mfma_f32_16x16x32_bf16 v[60:63], a[228:231], a[108:111], v[60:63]
  v_exp_f32 v100, v100
  v_mfma_f32_16x16x32_bf16 v[60:63], a[232:235], a[120:123], v[60:63]
  v_exp_f32 v101, v101
  v_mfma_f32_16x16x32_bf16 v[60:63], a[236:239], a[132:135], v[60:63]
  v_exp_f32 v102, v102
  v_mfma_f32_16x16x32_bf16 v[74:77], a[216:219], a[76:79], 0
  v_exp_f32 v103, v103
  v_mfma_f32_16x16x32_bf16 v[74:77], a[220:223], a[88:91], v[74:77]
  v_cvt_pk_bf16_f32 v98, v100, v101
  v_cvt_pk_bf16_f32 v99, v102, v103
  v_mfma_f32_16x16x32_bf16 v[74:77], a[224:227], a[100:103], v[74:77]
  v_cvt_pk_bf16_f32 v154, v60, v61
  v_cvt_pk_bf16_f32 v155, v62, v63
  v_mfma_f32_16x16x32_bf16 v[74:77], a[228:231], a[112:115], v[74:77]
  v_exp_f32 v104, v104
  v_mfma_f32_16x16x32_bf16 v[74:77], a[232:235], a[124:127], v[74:77]
  v_exp_f32 v105, v105
  v_mfma_f32_16x16x32_bf16 v[74:77], a[236:239], a[136:139], v[74:77]
  v_exp_f32 v106, v106
  v_mfma_f32_16x16x32_bf16 v[60:63], a[216:219], a[80:83], 0
  v_exp_f32 v107, v107
  v_mfma_f32_16x16x32_bf16 v[60:63], a[220:223], a[92:95], v[60:63]
  v_cvt_pk_bf16_f32 v100, v104, v105
  v_cvt_pk_bf16_f32 v101, v106, v107
  v_mfma_f32_16x16x32_bf16 v[60:63], a[224:227], a[104:107], v[60:63]
  v_cvt_pk_bf16_f32 v180, v74, v75
  v_cvt_pk_bf16_f32 v181, v76, v77
  v_mfma_f32_16x16x32_bf16 v[60:63], a[228:231], a[116:119], v[60:63]
  v_mov_b64 v[174:175], 0
  v_mfma_f32_16x16x32_bf16 v[60:63], a[232:235], a[128:131], v[60:63]
  v_exp_f32 v84, v84
  v_mfma_f32_16x16x32_bf16 v[60:63], a[236:239], a[140:143], v[60:63]
  v_exp_f32 v85, v85
  v_smfmac_f32_16x16x64_bf16 v[174:177], a[240:243], v[116:123], v10
  v_exp_f32 v86, v86
  v_mfma_f32_16x16x32_bf16 v[166:169], v[152:155], v[120:123], 0
  v_exp_f32 v87, v87
  v_mfma_f32_16x16x32_bf16 v[166:169], v[148:151], v[116:119], v[166:169]
  v_cvt_pk_bf16_f32 v172, v60, v61
  v_cvt_pk_bf16_f32 v173, v62, v63
  v_mfma_f32_16x16x32_bf16 v[134:137], v[66:69], v[116:119], 0
  v_cvt_pk_bf16_f32 v102, v84, v85
  v_cvt_pk_bf16_f32 v103, v86, v87
  v_mfma_f32_16x16x32_bf16 v[134:137], v[178:181], v[120:123], v[134:137]
  v_mov_b64 v[60:61], 0
  v_mfma_f32_16x16x32_bf16 v[138:141], v[170:173], v[120:123], 0
  v_exp_f32 v108, v108
  v_mfma_f32_16x16x32_bf16 v[138:141], v[144:147], v[116:119], v[138:141]
  v_exp_f32 v109, v109
  v_smfmac_f32_16x16x64_bf16 v[60:63], a[240:243], v[88:95], v10
  v_exp_f32 v110, v110
  v_mfma_f32_16x16x32_bf16 v[118:121], v[152:155], v[92:95], 0
  v_exp_f32 v111, v111
  v_mfma_f32_16x16x32_bf16 v[118:121], v[148:151], v[88:91], v[118:121]
  v_cvt_pk_bf16_f32 v108, v108, v109
  v_cvt_pk_bf16_f32 v109, v110, v111
  v_mfma_f32_16x16x32_bf16 v[122:125], v[66:69], v[88:91], 0
  v_exp_f32 v112, v112
  v_mfma_f32_16x16x32_bf16 v[122:125], v[178:181], v[92:95], v[122:125]
  v_mov_b64 v[74:75], 0
  v_mfma_f32_16x16x32_bf16 v[126:129], v[170:173], v[92:95], 0
  v_exp_f32 v113, v113
  v_mfma_f32_16x16x32_bf16 v[126:129], v[144:147], v[88:91], v[126:129]
  v_exp_f32 v114, v114
  v_smfmac_f32_16x16x64_bf16 v[74:77], a[240:243], v[96:103], v10
  v_exp_f32 v115, v115
  v_mfma_f32_16x16x32_bf16 v[104:107], v[152:155], v[100:103], 0
  v_cvt_pk_bf16_f32 v110, v112, v113
  v_cvt_pk_bf16_f32 v111, v114, v115
  v_exp_f32 v70, v70
  v_exp_f32 v71, v71
  v_exp_f32 v72, v72
  v_exp_f32 v73, v73
  v_cvt_pk_bf16_f32 v112, v70, v71
  v_cvt_pk_bf16_f32 v113, v72, v73
  v_exp_f32 v78, v78
  v_exp_f32 v79, v79
  v_exp_f32 v80, v80
  v_exp_f32 v81, v81
  v_cvt_pk_bf16_f32 v114, v78, v79
  v_cvt_pk_bf16_f32 v115, v80, v81
  v_mfma_f32_16x16x32_bf16 v[104:107], v[148:151], v[96:99], v[104:107]
  s_waitcnt vmcnt(9) lgkmcnt(0)
  s_barrier
  v_mfma_f32_16x16x32_bf16 v[90:93], v[66:69], v[96:99], 0
  s_add_u32 s5, s45, 24576
  v_mov_b64 v[70:71], 0
  s_add_u32 m0, s46, 0
  v_mfma_f32_16x16x32_bf16 v[90:93], v[178:181], v[100:103], v[90:93]
  ds_read_b128 a[252:255], v0 offset:0
  ds_read_b128 a[248:251], v1 offset:0
  v_mfma_f32_16x16x32_bf16 v[82:85], v[170:173], v[100:103], 0
  ds_read_b128 v[162:165], v0 offset:8192
  ds_read_b128 v[130:133], v1 offset:8192
  v_mfma_f32_16x16x32_bf16 v[82:85], v[144:147], v[96:99], v[82:85]
  ds_read_b128 v[158:161], v0 offset:16384
  ds_read_b128 v[100:103], v1 offset:16384
  v_smfmac_f32_16x16x64_bf16 v[70:73], a[240:243], v[108:115], v10
  buffer_load_dwordx4 v54, s[16:19], s5 offen offset:0 lds
  v_mfma_f32_16x16x32_bf16 v[78:81], v[152:155], v[112:115], 0
  s_add_u32 m0, s46, 8064
  v_add_f32 v174, v174, v175
  v_mfma_f32_16x16x32_bf16 v[78:81], v[148:151], v[108:111], v[78:81]
  buffer_load_dwordx4 v54, s[16:19], s5 offen offset:128 lds
  v_mfma_f32_16x16x32_bf16 v[86:89], v[66:69], v[108:111], 0
  s_add_u32 m0, s46, 16128
  v_rcp_f32 v176, v174
  v_mfma_f32_16x16x32_bf16 v[86:89], v[178:181], v[112:115], v[86:89]
  buffer_load_dwordx4 v54, s[16:19], s5 offen offset:256 lds
  v_mfma_f32_16x16x32_bf16 v[66:69], v[170:173], v[112:115], 0
  s_add_u32 s5, s45, 36864
  s_add_u32 m0, s46, 4096
  v_max3_f32 v9, v174, v176, v9
  v_mfma_f32_16x16x32_bf16 v[66:69], v[144:147], v[108:111], v[66:69]
  s_waitcnt lgkmcnt(0)
  v_mul_f32 v166, v176, v166
  v_mul_f32 v167, v176, v167
  v_mfma_f32_16x16x32_bf16 v[108:111], v[184:187], a[252:255], 0
  buffer_load_dwordx4 v54, s[16:19], s5 offen offset:0 lds
  v_mfma_f32_16x16x32_bf16 v[108:111], v[196:199], a[248:251], v[108:111]
  s_add_u32 m0, s46, 12160
  v_mul_f32 v168, v176, v168
  v_mul_f32 v169, v176, v169
  v_mfma_f32_16x16x32_bf16 v[108:111], v[208:211], v[162:165], v[108:111]
  buffer_load_dwordx4 v54, s[16:19], s5 offen offset:128 lds
  v_mfma_f32_16x16x32_bf16 v[108:111], v[220:223], v[130:133], v[108:111]
  v_cvt_pk_bf16_f32 v166, v166, v167
  v_cvt_pk_bf16_f32 v167, v168, v169
  v_mfma_f32_16x16x32_bf16 v[108:111], v[232:235], v[158:161], v[108:111]
  s_add_u32 m0, s46, 20224
  ds_write_b32 v5, v166 offset:0
  v_mfma_f32_16x16x32_bf16 v[108:111], v[244:247], v[100:103], v[108:111]
  buffer_load_dwordx4 v54, s[16:19], s5 offen offset:256 lds
  v_mfma_f32_16x16x32_bf16 v[96:99], v[248:251], v[100:103], 0
  ds_write_b32 v5, v167 offset:1024
  v_mfma_f32_16x16x32_bf16 v[96:99], v[236:239], v[158:161], v[96:99]
  v_mul_f32 v134, v176, v134
  v_mul_f32 v135, v176, v135
  v_mfma_f32_16x16x32_bf16 v[96:99], v[224:227], v[130:133], v[96:99]
  v_mul_f32 v108, s42, v108
  v_mul_f32 v109, s42, v109
  v_mfma_f32_16x16x32_bf16 v[96:99], v[212:215], v[162:165], v[96:99]
  v_mul_f32 v110, s42, v110
  v_mul_f32 v111, s42, v111
  v_mfma_f32_16x16x32_bf16 v[96:99], v[200:203], a[248:251], v[96:99]
  v_cvt_pk_bf16_f32 v12, v108, v109
  v_cvt_pk_bf16_f32 v13, v110, v111
  v_mfma_f32_16x16x32_bf16 v[96:99], v[188:191], a[252:255], v[96:99]
  v_mul_f32 v136, v176, v136
  v_mul_f32 v137, v176, v137
  v_mfma_f32_16x16x32_bf16 v[112:115], v[192:195], a[252:255], 0
  v_cvt_pk_bf16_f32 v134, v134, v135
  v_cvt_pk_bf16_f32 v135, v136, v137
  v_mfma_f32_16x16x32_bf16 v[112:115], v[204:207], a[248:251], v[112:115]
  ds_write_b32 v5, v134 offset:2048
  v_mfma_f32_16x16x32_bf16 v[112:115], v[216:219], v[162:165], v[112:115]
  v_mul_f32 v96, s42, v96
  v_mul_f32 v97, s42, v97
  v_mfma_f32_16x16x32_bf16 v[112:115], v[228:231], v[130:133], v[112:115]
  v_mul_f32 v98, s42, v98
  v_mul_f32 v99, s42, v99
  v_mfma_f32_16x16x32_bf16 v[112:115], v[240:243], v[158:161], v[112:115]
  v_cvt_pk_bf16_f32 v94, v96, v97
  v_cvt_pk_bf16_f32 v95, v98, v99
  v_mfma_f32_16x16x32_bf16 v[112:115], v[252:255], v[100:103], v[112:115]
  ds_write_b32 v5, v135 offset:3072
  v_mfma_f32_16x16x32_bf16 v[108:111], a[60:63], v[100:103], 0
  v_mul_f32 v138, v176, v138
  v_mul_f32 v139, v176, v139
  v_mfma_f32_16x16x32_bf16 v[108:111], a[48:51], v[158:161], v[108:111]
  v_mul_f32 v140, v176, v140
  v_mul_f32 v141, v176, v141
  v_mfma_f32_16x16x32_bf16 v[108:111], a[36:39], v[130:133], v[108:111]
  v_mul_f32 v112, s42, v112
  v_mul_f32 v113, s42, v113
  v_mfma_f32_16x16x32_bf16 v[108:111], a[24:27], v[162:165], v[108:111]
  v_mul_f32 v114, s42, v114
  v_mul_f32 v115, s42, v115
  v_mfma_f32_16x16x32_bf16 v[108:111], a[12:15], a[248:251], v[108:111]
  v_cvt_pk_bf16_f32 v96, v112, v113
  v_cvt_pk_bf16_f32 v97, v114, v115
  v_mfma_f32_16x16x32_bf16 v[108:111], a[0:3], a[252:255], v[108:111]
  v_cvt_pk_bf16_f32 v138, v138, v139
  v_cvt_pk_bf16_f32 v139, v140, v141
  v_mfma_f32_16x16x32_bf16 v[134:137], a[4:7], a[252:255], 0
  ds_write_b32 v5, v138 offset:4096
  v_mfma_f32_16x16x32_bf16 v[134:137], a[16:19], a[248:251], v[134:137]
  ds_write_b32 v5, v139 offset:5120
  v_mfma_f32_16x16x32_bf16 v[134:137], a[28:31], v[162:165], v[134:137]
  v_cvt_pk_bf16_f32 v112, v108, v109
  v_cvt_pk_bf16_f32 v113, v110, v111
  v_mfma_f32_16x16x32_bf16 v[134:137], a[40:43], v[130:133], v[134:137]
  v_add_f32 v60, v60, v61
  v_mfma_f32_16x16x32_bf16 v[134:137], a[52:55], v[158:161], v[134:137]
  v_rcp_f32 v62, v60
  v_mfma_f32_16x16x32_bf16 v[134:137], a[64:67], v[100:103], v[134:137]
  v_max3_f32 v9, v60, v62, v9
  v_mul_f32 v118, v62, v118
  v_mfma_f32_16x16x32_bf16 v[108:111], a[68:71], v[100:103], 0
  s_waitcnt vmcnt(12) lgkmcnt(0)
  s_barrier
  v_mfma_f32_16x16x32_bf16 v[108:111], a[56:59], v[158:161], v[108:111]
  s_add_u32 s5, s45, 49152
  s_add_u32 m0, s46, 98304
  v_mul_f32 v119, v62, v119
  v_mfma_f32_16x16x32_bf16 v[108:111], a[44:47], v[130:133], v[108:111]
  v_cvt_pk_bf16_f32 v114, v134, v135
  v_cvt_pk_bf16_f32 v115, v136, v137
  v_mfma_f32_16x16x32_bf16 v[108:111], a[32:35], v[162:165], v[108:111]
  buffer_load_dwordx4 v54, s[16:19], s5 offen offset:0 lds
  v_mfma_f32_16x16x32_bf16 v[108:111], a[20:23], a[248:251], v[108:111]
  s_add_u32 m0, s46, 106368
  v_mul_f32 v120, v62, v120
  v_mul_f32 v121, v62, v121
  v_mfma_f32_16x16x32_bf16 v[108:111], a[8:11], a[252:255], v[108:111]
  buffer_load_dwordx4 v54, s[16:19], s5 offen offset:128 lds
  v_mfma_f32_16x16x32_bf16 v[138:141], a[252:255], a[72:75], 0
  v_cvt_pk_bf16_f32 v118, v118, v119
  v_cvt_pk_bf16_f32 v119, v120, v121
  v_mfma_f32_16x16x32_bf16 v[138:141], a[248:251], a[84:87], v[138:141]
  s_add_u32 m0, s46, 114432
  ds_write_b32 v5, v118 offset:256
  v_mfma_f32_16x16x32_bf16 v[138:141], v[162:165], a[96:99], v[138:141]
  v_cvt_pk_bf16_f32 v116, v108, v109
  v_cvt_pk_bf16_f32 v117, v110, v111
  v_mfma_f32_16x16x32_bf16 v[138:141], v[130:133], a[108:111], v[138:141]
  buffer_load_dwordx4 v54, s[16:19], s5 offen offset:256 lds
  v_mfma_f32_16x16x32_bf16 v[138:141], v[158:161], a[120:123], v[138:141]
  s_add_u32 s5, s45, 61440
  s_add_u32 m0, s46, 102400
  v_mfma_f32_16x16x32_bf16 v[138:141], v[100:103], a[132:135], v[138:141]
  buffer_load_dwordx4 v54, s[16:19], s5 offen offset:0 lds
  v_mfma_f32_16x16x32_bf16 v[150:153], v[100:103], a[136:139], 0
  s_waitcnt vmcnt(10) lgkmcnt(0)
  s_barrier
  v_mfma_f32_16x16x32_bf16 v[150:153], v[158:161], a[124:127], v[150:153]
  s_add_u32 m0, s46, 110464
  ds_read_b64_tr_b16 a[144:145], v11 offset:24576
  ds_read_b64_tr_b16 a[146:147], v11 offset:25600
  v_mfma_f32_16x16x32_bf16 v[150:153], v[130:133], a[112:115], v[150:153]
  v_cvt_pk_bf16_f32 v52, v138, v139
  v_cvt_pk_bf16_f32 v53, v140, v141
  v_mfma_f32_16x16x32_bf16 v[150:153], v[162:165], a[100:103], v[150:153]
  ds_read_b128 v[134:137], v0 offset:2048
  ds_read_b128 v[154:157], v1 offset:2048
  v_mfma_f32_16x16x32_bf16 v[150:153], a[248:251], a[88:91], v[150:153]
  ds_read_b128 v[138:141], v0 offset:10240
  ds_read_b128 v[108:111], v1 offset:10240
  v_mfma_f32_16x16x32_bf16 v[150:153], a[252:255], a[76:79], v[150:153]
  ds_read_b128 a[244:247], v0 offset:18432
  ds_read_b128 v[146:149], v1 offset:18432
  v_mfma_f32_16x16x32_bf16 v[142:145], a[252:255], a[80:83], 0
  buffer_load_dwordx4 v54, s[16:19], s5 offen offset:128 lds
  v_mfma_f32_16x16x32_bf16 v[142:145], a[248:251], a[92:95], v[142:145]
  s_add_u32 m0, s46, 118528
  ds_read_b64_tr_b16 a[148:149], v11 offset:24584
  ds_read_b64_tr_b16 a[150:151], v11 offset:25608
  v_mfma_f32_16x16x32_bf16 v[142:145], v[162:165], a[104:107], v[142:145]
  v_cvt_pk_bf16_f32 v56, v150, v151
  v_cvt_pk_bf16_f32 v57, v152, v153
  v_mfma_f32_16x16x32_bf16 v[142:145], v[130:133], a[116:119], v[142:145]
  buffer_load_dwordx4 v54, s[16:19], s5 offen offset:256 lds
  v_mfma_f32_16x16x32_bf16 v[142:145], v[158:161], a[128:131], v[142:145]
  s_add_u32 s31, s31, s43
  ds_read_b64_tr_b16 a[152:153], v64 offset:24576
  ds_read_b64_tr_b16 a[154:155], v64 offset:25600
  v_mfma_f32_16x16x32_bf16 v[142:145], v[100:103], a[140:143], v[142:145]
  s_waitcnt lgkmcnt(4)
  ds_read_b64_tr_b16 a[156:157], v64 offset:24584
  ds_read_b64_tr_b16 a[158:159], v64 offset:25608
  v_mfma_f32_16x16x32_bf16 v[100:103], v[184:187], v[134:137], 0
  s_add_u32 s32, s32, s43
  ds_read_b64_tr_b16 a[160:161], v11 offset:28672
  ds_read_b64_tr_b16 a[162:163], v11 offset:29696
  v_mfma_f32_16x16x32_bf16 v[100:103], v[196:199], v[154:157], v[100:103]
  s_add_u32 m0, s29, 0
  ds_read_b64_tr_b16 a[164:165], v11 offset:28680
  ds_read_b64_tr_b16 a[166:167], v11 offset:29704
  v_mfma_f32_16x16x32_bf16 v[100:103], v[208:211], v[138:141], v[100:103]
  v_cvt_pk_bf16_f32 v60, v142, v143
  v_cvt_pk_bf16_f32 v61, v144, v145
  v_mfma_f32_16x16x32_bf16 v[100:103], v[220:223], v[108:111], v[100:103]
  buffer_load_dwordx4 v6, s[8:11], s31 offen offset:0 nt lds
  v_mfma_f32_16x16x32_bf16 v[100:103], v[232:235], a[244:247], v[100:103]
  ds_read_b64_tr_b16 a[168:169], v64 offset:28672
  ds_read_b64_tr_b16 a[170:171], v64 offset:29696
  v_mfma_f32_16x16x32_bf16 v[100:103], v[244:247], v[146:149], v[100:103]
  s_add_u32 m0, s29, 8064
  ds_read_b64_tr_b16 a[172:173], v64 offset:28680
  ds_read_b64_tr_b16 a[174:175], v64 offset:29704
  v_mfma_f32_16x16x32_bf16 v[130:133], v[248:251], v[146:149], 0
  buffer_load_dwordx4 v6, s[8:11], s31 offen offset:128 nt lds
  v_mfma_f32_16x16x32_bf16 v[130:133], v[236:239], a[244:247], v[130:133]
  ds_write_b32 v5, v119 offset:1280
  v_mfma_f32_16x16x32_bf16 v[130:133], v[224:227], v[108:111], v[130:133]
  v_mul_f32 v100, s42, v100
  v_mul_f32 v101, s42, v101
  v_mfma_f32_16x16x32_bf16 v[130:133], v[212:215], v[138:141], v[130:133]
  s_add_u32 m0, s29, 16128
  v_mul_f32 v102, s42, v102
  v_mul_f32 v103, s42, v103
  v_mfma_f32_16x16x32_bf16 v[130:133], v[200:203], v[154:157], v[130:133]
  v_cvt_pk_bf16_f32 v98, v100, v101
  v_cvt_pk_bf16_f32 v99, v102, v103
  v_mfma_f32_16x16x32_bf16 v[130:133], v[188:191], v[134:137], v[130:133]
  buffer_load_dwordx4 v6, s[8:11], s31 offen offset:256 nt lds
  v_mfma_f32_16x16x32_bf16 v[118:121], v[192:195], v[134:137], 0
  v_mul_f32 v122, v62, v122
  v_mul_f32 v123, v62, v123
  v_mfma_f32_16x16x32_bf16 v[118:121], v[204:207], v[154:157], v[118:121]
  s_add_u32 m0, s29, 4096
  v_mul_f32 v124, v62, v124
  v_mul_f32 v125, v62, v125
  v_mfma_f32_16x16x32_bf16 v[118:121], v[216:219], v[138:141], v[118:121]
  v_mul_f32 v130, s42, v130
  v_mul_f32 v131, s42, v131
  v_mfma_f32_16x16x32_bf16 v[118:121], v[228:231], v[108:111], v[118:121]
  v_mul_f32 v132, s42, v132
  v_mul_f32 v133, s42, v133
  v_mfma_f32_16x16x32_bf16 v[118:121], v[240:243], a[244:247], v[118:121]
  v_cvt_pk_bf16_f32 v100, v130, v131
  v_cvt_pk_bf16_f32 v101, v132, v133
  v_mfma_f32_16x16x32_bf16 v[118:121], v[252:255], v[146:149], v[118:121]
  buffer_load_dwordx4 v6, s[8:11], s32 offen offset:0 nt lds
  v_mfma_f32_16x16x32_bf16 v[142:145], a[60:63], v[146:149], 0
  s_waitcnt vmcnt(10) lgkmcnt(0)
  s_barrier
  v_mfma_f32_16x16x32_bf16 v[142:145], a[48:51], a[244:247], v[142:145]
  s_add_u32 m0, s29, 12160
  ds_read_b64_tr_b16 a[176:177], v55 offset:0
  ds_read_b64_tr_b16 a[178:179], v55 offset:1024
  v_mfma_f32_16x16x32_bf16 v[142:145], a[36:39], v[108:111], v[142:145]
  v_mul_f32 v118, s42, v118
  v_mul_f32 v119, s42, v119
  v_mfma_f32_16x16x32_bf16 v[142:145], a[24:27], v[138:141], v[142:145]
  v_mul_f32 v120, s42, v120
  v_mul_f32 v121, s42, v121
  v_mfma_f32_16x16x32_bf16 v[142:145], a[12:15], v[154:157], v[142:145]
  v_cvt_pk_bf16_f32 v16, v118, v119
  v_cvt_pk_bf16_f32 v17, v120, v121
  v_mfma_f32_16x16x32_bf16 v[142:145], a[0:3], v[134:137], v[142:145]
  buffer_load_dwordx4 v6, s[8:11], s32 offen offset:128 nt lds
  v_mfma_f32_16x16x32_bf16 v[130:133], a[4:7], v[134:137], 0
  s_add_u32 m0, s29, 20224
  ds_read_b64_tr_b16 a[180:181], v55 offset:8
  ds_read_b64_tr_b16 a[182:183], v55 offset:1032
  v_mfma_f32_16x16x32_bf16 v[130:133], a[16:19], v[154:157], v[130:133]
  buffer_load_dwordx4 v6, s[8:11], s32 offen offset:256 nt lds
  v_mfma_f32_16x16x32_bf16 v[130:133], a[28:31], v[138:141], v[130:133]
  s_add_u32 s31, s31, s43
  v_cvt_pk_bf16_f32 v118, v142, v143
  v_cvt_pk_bf16_f32 v119, v144, v145
  v_mfma_f32_16x16x32_bf16 v[130:133], a[40:43], v[108:111], v[130:133]
  s_add_u32 s32, s32, s43
  ds_read_b64_tr_b16 a[184:185], v58 offset:0
  ds_read_b64_tr_b16 a[186:187], v58 offset:1024
  v_mfma_f32_16x16x32_bf16 v[130:133], a[52:55], a[244:247], v[130:133]
  ds_read_b64_tr_b16 a[188:189], v58 offset:8
  ds_read_b64_tr_b16 a[190:191], v58 offset:1032
  v_mfma_f32_16x16x32_bf16 v[130:133], a[64:67], v[146:149], v[130:133]
  ds_read_b64_tr_b16 a[192:193], v55 offset:4096
  ds_read_b64_tr_b16 a[194:195], v55 offset:5120
  v_mfma_f32_16x16x32_bf16 v[142:145], a[68:71], v[146:149], 0
  ds_read_b64_tr_b16 a[196:197], v55 offset:4104
  ds_read_b64_tr_b16 a[198:199], v55 offset:5128
  v_mfma_f32_16x16x32_bf16 v[142:145], a[56:59], a[244:247], v[142:145]
  ds_read_b64_tr_b16 a[200:201], v58 offset:4096
  ds_read_b64_tr_b16 a[202:203], v58 offset:5120
  v_mfma_f32_16x16x32_bf16 v[142:145], a[44:47], v[108:111], v[142:145]
  v_cvt_pk_bf16_f32 v120, v130, v131
  v_cvt_pk_bf16_f32 v121, v132, v133
  v_mfma_f32_16x16x32_bf16 v[142:145], a[32:35], v[138:141], v[142:145]
  ds_read_b64_tr_b16 a[204:205], v58 offset:4104
  ds_read_b64_tr_b16 a[206:207], v58 offset:5128
  v_mfma_f32_16x16x32_bf16 v[142:145], a[20:23], v[154:157], v[142:145]
  v_cvt_pk_bf16_f32 v122, v122, v123
  v_cvt_pk_bf16_f32 v123, v124, v125
  v_mfma_f32_16x16x32_bf16 v[142:145], a[8:11], v[134:137], v[142:145]
  ds_write_b32 v5, v122 offset:2304
  v_mfma_f32_16x16x32_bf16 v[130:133], v[134:137], a[72:75], 0
  ds_write_b32 v5, v123 offset:3328
  v_mfma_f32_16x16x32_bf16 v[130:133], v[154:157], a[84:87], v[130:133]
  v_mul_f32 v126, v62, v126
  v_mul_f32 v127, v62, v127
  v_mfma_f32_16x16x32_bf16 v[130:133], v[138:141], a[96:99], v[130:133]
  v_cvt_pk_bf16_f32 v122, v142, v143
  v_cvt_pk_bf16_f32 v123, v144, v145
  v_mfma_f32_16x16x32_bf16 v[130:133], v[108:111], a[108:111], v[130:133]
  v_mul_f32 v128, v62, v128
  v_mul_f32 v129, v62, v129
  v_mfma_f32_16x16x32_bf16 v[130:133], a[244:247], a[120:123], v[130:133]
  v_cvt_pk_bf16_f32 v126, v126, v127
  v_cvt_pk_bf16_f32 v127, v128, v129
  v_mfma_f32_16x16x32_bf16 v[130:133], v[146:149], a[132:135], v[130:133]
  ds_write_b32 v5, v126 offset:4352
  v_mfma_f32_16x16x32_bf16 v[162:165], v[146:149], a[136:139], 0
  ds_write_b32 v5, v127 offset:5376
  v_mfma_f32_16x16x32_bf16 v[162:165], a[244:247], a[124:127], v[162:165]
  v_add_f32 v74, v74, v75
  v_mfma_f32_16x16x32_bf16 v[162:165], v[108:111], a[112:115], v[162:165]
  v_cvt_pk_bf16_f32 v54, v130, v131
  v_cvt_pk_bf16_f32 v55, v132, v133
  v_mfma_f32_16x16x32_bf16 v[162:165], v[138:141], a[100:103], v[162:165]
  ds_read_b128 v[142:145], v0 offset:4096
  ds_read_b128 v[166:169], v1 offset:4096
  v_mfma_f32_16x16x32_bf16 v[162:165], v[154:157], a[88:91], v[162:165]
  ds_read_b128 v[150:153], v0 offset:12288
  ds_read_b128 v[174:177], v1 offset:12288
  v_mfma_f32_16x16x32_bf16 v[162:165], v[134:137], a[76:79], v[162:165]
  ds_read_b128 v[170:173], v0 offset:20480
  ds_read_b128 v[158:161], v1 offset:20480
  v_mfma_f32_16x16x32_bf16 v[124:127], v[134:137], a[80:83], 0
  s_waitcnt vmcnt(6) lgkmcnt(0)
  s_barrier
  v_mfma_f32_16x16x32_bf16 v[124:127], v[154:157], a[92:95], v[124:127]
  ds_read_b64_tr_b16 a[208:209], v11 offset:0
  ds_read_b64_tr_b16 a[210:211], v11 offset:1024
  v_mfma_f32_16x16x32_bf16 v[124:127], v[138:141], a[104:107], v[124:127]
  v_cvt_pk_bf16_f32 v58, v162, v163
  v_cvt_pk_bf16_f32 v59, v164, v165
  v_mfma_f32_16x16x32_bf16 v[124:127], v[108:111], a[116:119], v[124:127]
  ds_read_b64_tr_b16 a[212:213], v11 offset:8
  ds_read_b64_tr_b16 a[214:215], v11 offset:1032
  v_mfma_f32_16x16x32_bf16 v[124:127], a[244:247], a[128:131], v[124:127]
  ds_read_b64_tr_b16 a[216:217], v64 offset:0
  ds_read_b64_tr_b16 a[218:219], v64 offset:1024
  v_mfma_f32_16x16x32_bf16 v[124:127], v[146:149], a[140:143], v[124:127]
  ds_read_b64_tr_b16 a[220:221], v64 offset:8
  ds_read_b64_tr_b16 a[222:223], v64 offset:1032
  v_mfma_f32_16x16x32_bf16 v[128:131], v[184:187], v[142:145], 0
  ds_read_b64_tr_b16 a[224:225], v11 offset:4096
  ds_read_b64_tr_b16 a[226:227], v11 offset:5120
  v_mfma_f32_16x16x32_bf16 v[128:131], v[196:199], v[166:169], v[128:131]
  ds_read_b64_tr_b16 a[228:229], v11 offset:4104
  ds_read_b64_tr_b16 a[230:231], v11 offset:5128
  v_mfma_f32_16x16x32_bf16 v[128:131], v[208:211], v[150:153], v[128:131]
  v_cvt_pk_bf16_f32 v62, v124, v125
  v_cvt_pk_bf16_f32 v63, v126, v127
  v_mfma_f32_16x16x32_bf16 v[128:131], v[220:223], v[174:177], v[128:131]
  ds_read_b64_tr_b16 a[232:233], v64 offset:4096
  ds_read_b64_tr_b16 a[234:235], v64 offset:5120
  v_mfma_f32_16x16x32_bf16 v[128:131], v[232:235], v[170:173], v[128:131]
  ds_read_b64_tr_b16 a[236:237], v64 offset:4104
  ds_read_b64_tr_b16 a[238:239], v64 offset:5128
  v_mfma_f32_16x16x32_bf16 v[128:131], v[244:247], v[158:161], v[128:131]
  v_rcp_f32 v76, v74
  v_mfma_f32_16x16x32_bf16 v[108:111], v[248:251], v[158:161], 0
  v_max3_f32 v9, v74, v76, v9
  v_mul_f32 v104, v76, v104
  v_mfma_f32_16x16x32_bf16 v[108:111], v[236:239], v[170:173], v[108:111]
  v_mul_f32 v105, v76, v105
  v_mul_f32 v106, v76, v106
  v_mfma_f32_16x16x32_bf16 v[108:111], v[224:227], v[174:177], v[108:111]
  v_mul_f32 v128, s42, v128
  v_mul_f32 v129, s42, v129
  v_mfma_f32_16x16x32_bf16 v[108:111], v[212:215], v[150:153], v[108:111]
  v_mul_f32 v130, s42, v130
  v_mul_f32 v131, s42, v131
  v_mfma_f32_16x16x32_bf16 v[108:111], v[200:203], v[166:169], v[108:111]
  v_cvt_pk_bf16_f32 v18, v128, v129
  v_cvt_pk_bf16_f32 v19, v130, v131
  v_mfma_f32_16x16x32_bf16 v[108:111], v[188:191], v[142:145], v[108:111]
  v_mul_f32 v107, v76, v107
  v_cvt_pk_bf16_f32 v104, v104, v105
  v_mfma_f32_16x16x32_bf16 v[72:75], v[192:195], v[142:145], 0
  v_cvt_pk_bf16_f32 v105, v106, v107
  v_mfma_f32_16x16x32_bf16 v[72:75], v[204:207], v[166:169], v[72:75]
  ds_write_b32 v5, v104 offset:512
  v_mfma_f32_16x16x32_bf16 v[72:75], v[216:219], v[150:153], v[72:75]
  v_mul_f32 v108, s42, v108
  v_mul_f32 v109, s42, v109
  v_mfma_f32_16x16x32_bf16 v[72:75], v[228:231], v[174:177], v[72:75]
  v_mul_f32 v110, s42, v110
  v_mul_f32 v111, s42, v111
  v_mfma_f32_16x16x32_bf16 v[72:75], v[240:243], v[170:173], v[72:75]
  v_cvt_pk_bf16_f32 v130, v108, v109
  v_cvt_pk_bf16_f32 v131, v110, v111
  v_mfma_f32_16x16x32_bf16 v[72:75], v[252:255], v[158:161], v[72:75]
  ds_write_b32 v5, v105 offset:1536
  v_mfma_f32_16x16x32_bf16 v[106:109], a[60:63], v[158:161], 0
  v_mul_f32 v90, v76, v90
  v_mul_f32 v91, v76, v91
  v_mfma_f32_16x16x32_bf16 v[106:109], a[48:51], v[170:173], v[106:109]
  v_mul_f32 v92, v76, v92
  v_mul_f32 v93, v76, v93
  v_mfma_f32_16x16x32_bf16 v[106:109], a[36:39], v[174:177], v[106:109]
  v_mul_f32 v72, s42, v72
  v_mul_f32 v73, s42, v73
  v_mfma_f32_16x16x32_bf16 v[106:109], a[24:27], v[150:153], v[106:109]
  v_mul_f32 v74, s42, v74
  v_mul_f32 v75, s42, v75
  v_mfma_f32_16x16x32_bf16 v[106:109], a[12:15], v[166:169], v[106:109]
  v_cvt_pk_bf16_f32 v132, v72, v73
  v_cvt_pk_bf16_f32 v133, v74, v75
  v_mfma_f32_16x16x32_bf16 v[106:109], a[0:3], v[142:145], v[106:109]
  v_cvt_pk_bf16_f32 v90, v90, v91
  v_cvt_pk_bf16_f32 v91, v92, v93
  v_mfma_f32_16x16x32_bf16 v[72:75], a[4:7], v[142:145], 0
  ds_write_b32 v5, v90 offset:2560
  v_mfma_f32_16x16x32_bf16 v[72:75], a[16:19], v[166:169], v[72:75]
  ds_write_b32 v5, v91 offset:3584
  v_mfma_f32_16x16x32_bf16 v[72:75], a[28:31], v[150:153], v[72:75]
  v_cvt_pk_bf16_f32 v124, v106, v107
  v_cvt_pk_bf16_f32 v125, v108, v109
  v_mfma_f32_16x16x32_bf16 v[72:75], a[40:43], v[174:177], v[72:75]
  v_mul_f32 v82, v76, v82
  v_mul_f32 v83, v76, v83
  v_mfma_f32_16x16x32_bf16 v[72:75], a[52:55], v[170:173], v[72:75]
  v_mul_f32 v84, v76, v84
  v_mul_f32 v85, v76, v85
  v_mfma_f32_16x16x32_bf16 v[72:75], a[64:67], v[158:161], v[72:75]
  v_cvt_pk_bf16_f32 v82, v82, v83
  v_cvt_pk_bf16_f32 v83, v84, v85
  v_mfma_f32_16x16x32_bf16 v[90:93], a[68:71], v[158:161], 0
  ds_write_b32 v5, v82 offset:4608
  v_mfma_f32_16x16x32_bf16 v[90:93], a[56:59], v[170:173], v[90:93]
  ds_write_b32 v5, v83 offset:5632
  v_mfma_f32_16x16x32_bf16 v[90:93], a[44:47], v[174:177], v[90:93]
  v_cvt_pk_bf16_f32 v126, v72, v73
  v_cvt_pk_bf16_f32 v127, v74, v75
  v_mfma_f32_16x16x32_bf16 v[90:93], a[32:35], v[150:153], v[90:93]
  s_add_u32 m0, s30, 0
  v_add_f32 v70, v70, v71
  v_mfma_f32_16x16x32_bf16 v[90:93], a[20:23], v[166:169], v[90:93]
  buffer_load_dwordx4 v6, s[8:11], s31 offen offset:0 nt lds
  v_mfma_f32_16x16x32_bf16 v[90:93], a[8:11], v[142:145], v[90:93]
  v_rcp_f32 v72, v70
  v_mfma_f32_16x16x32_bf16 v[82:85], v[142:145], a[72:75], 0
  v_max3_f32 v9, v70, v72, v9
  v_mul_f32 v78, v72, v78
  v_mfma_f32_16x16x32_bf16 v[82:85], v[166:169], a[84:87], v[82:85]
  s_add_u32 m0, s30, 8064
  v_mul_f32 v79, v72, v79
  v_mul_f32 v80, v72, v80
  v_mfma_f32_16x16x32_bf16 v[82:85], v[150:153], a[96:99], v[82:85]
  v_cvt_pk_bf16_f32 v128, v90, v91
  v_cvt_pk_bf16_f32 v129, v92, v93
  v_mfma_f32_16x16x32_bf16 v[82:85], v[174:177], a[108:111], v[82:85]
  buffer_load_dwordx4 v6, s[8:11], s31 offen offset:128 nt lds
  v_mfma_f32_16x16x32_bf16 v[82:85], v[170:173], a[120:123], v[82:85]
  v_mul_f32 v81, v72, v81
  v_cvt_pk_bf16_f32 v78, v78, v79
  v_mfma_f32_16x16x32_bf16 v[82:85], v[158:161], a[132:135], v[82:85]
  s_add_u32 m0, s30, 16128
  v_cvt_pk_bf16_f32 v79, v80, v81
  v_mfma_f32_16x16x32_bf16 v[74:77], v[158:161], a[136:139], 0
  buffer_load_dwordx4 v6, s[8:11], s31 offen offset:256 nt lds
  v_mfma_f32_16x16x32_bf16 v[74:77], v[170:173], a[124:127], v[74:77]
  ds_write_b32 v5, v78 offset:768
  v_mfma_f32_16x16x32_bf16 v[74:77], v[174:177], a[112:115], v[74:77]
  v_cvt_pk_bf16_f32 v102, v82, v83
  v_cvt_pk_bf16_f32 v103, v84, v85
  v_mfma_f32_16x16x32_bf16 v[74:77], v[150:153], a[100:103], v[74:77]
  s_add_u32 m0, s30, 4096
  ds_read_b128 v[134:137], v0 offset:6144
  ds_read_b128 a[248:251], v1 offset:6144
  v_mfma_f32_16x16x32_bf16 v[74:77], v[166:169], a[88:91], v[74:77]
  ds_read_b128 a[244:247], v0 offset:14336
  ds_read_b128 v[162:165], v1 offset:14336
  v_mfma_f32_16x16x32_bf16 v[74:77], v[142:145], a[76:79], v[74:77]
  ds_read_b128 v[138:141], v0 offset:22528
  ds_read_b128 a[252:255], v1 offset:22528
  v_mfma_f32_16x16x32_bf16 v[80:83], v[142:145], a[80:83], 0
  buffer_load_dwordx4 v6, s[8:11], s32 offen offset:0 nt lds
  v_mfma_f32_16x16x32_bf16 v[80:83], v[166:169], a[92:95], v[80:83]
  s_add_u32 m0, s30, 12160
  ds_write_b32 v5, v79 offset:1792
  v_mfma_f32_16x16x32_bf16 v[80:83], v[150:153], a[104:107], v[80:83]
  v_cvt_pk_bf16_f32 v106, v74, v75
  v_cvt_pk_bf16_f32 v107, v76, v77
  v_mfma_f32_16x16x32_bf16 v[80:83], v[174:177], a[116:119], v[80:83]
  buffer_load_dwordx4 v6, s[8:11], s32 offen offset:128 nt lds
  v_mfma_f32_16x16x32_bf16 v[80:83], v[170:173], a[128:131], v[80:83]
  v_mul_f32 v86, v72, v86
  v_mul_f32 v87, v72, v87
  v_mfma_f32_16x16x32_bf16 v[80:83], v[158:161], a[140:143], v[80:83]
  s_waitcnt lgkmcnt(1)
  s_add_u32 m0, s30, 20224
  v_mul_f32 v88, v72, v88
  v_mfma_f32_16x16x32_bf16 v[90:93], a[0:3], v[134:137], 0
  buffer_load_dwordx4 v6, s[8:11], s32 offen offset:256 nt lds
  v_mfma_f32_16x16x32_bf16 v[90:93], a[12:15], a[248:251], v[90:93]
  s_add_u32 s31, s31, s43
  v_mul_f32 v89, v72, v89
  v_cvt_pk_bf16_f32 v86, v86, v87
  v_mfma_f32_16x16x32_bf16 v[90:93], a[24:27], a[244:247], v[90:93]
  s_add_u32 s32, s32, s43
  v_cvt_pk_bf16_f32 v110, v80, v81
  v_cvt_pk_bf16_f32 v111, v82, v83
  v_mfma_f32_16x16x32_bf16 v[90:93], a[36:39], v[162:165], v[90:93]
  s_mov_b32 s5, s28
  v_cvt_pk_bf16_f32 v87, v88, v89
  v_mfma_f32_16x16x32_bf16 v[90:93], a[48:51], v[138:141], v[90:93]
  s_mov_b32 s28, s29
  ds_write_b32 v5, v86 offset:2816
  v_mfma_f32_16x16x32_bf16 v[90:93], a[60:63], a[252:255], v[90:93]
  s_mov_b32 s29, s30
  ds_write_b32 v5, v87 offset:3840
  v_mfma_f32_16x16x32_bf16 v[74:77], a[64:67], a[252:255], 0
  s_mov_b32 s30, s5
  v_mul_f32 v66, v72, v66
  v_mul_f32 v67, v72, v67
  v_mfma_f32_16x16x32_bf16 v[74:77], a[52:55], v[138:141], v[74:77]
  v_add_u32 v0, s28, v2
  v_xor_b32 v1, 64, v0
  v_mfma_f32_16x16x32_bf16 v[74:77], a[40:43], v[162:165], v[74:77]
  v_cvt_pk_bf16_f32 v154, v90, v91
  v_cvt_pk_bf16_f32 v155, v92, v93
  v_mfma_f32_16x16x32_bf16 v[74:77], a[28:31], a[244:247], v[74:77]
  v_mul_f32 v68, v72, v68
  v_mul_f32 v69, v72, v69
  v_mfma_f32_16x16x32_bf16 v[74:77], a[16:19], a[248:251], v[74:77]
  v_cvt_pk_bf16_f32 v66, v66, v67
  v_cvt_pk_bf16_f32 v67, v68, v69
  v_mfma_f32_16x16x32_bf16 v[74:77], a[4:7], v[134:137], v[74:77]
  ds_write_b32 v5, v66 offset:4864
  v_mfma_f32_16x16x32_bf16 v[70:73], a[8:11], v[134:137], 0
  ds_write_b32 v5, v67 offset:5888
  v_mfma_f32_16x16x32_bf16 v[70:73], a[20:23], a[248:251], v[70:73]
  v_xor_b32 v5, s41, v5
  v_mfma_f32_16x16x32_bf16 v[70:73], a[32:35], a[244:247], v[70:73]
  v_cvt_pk_bf16_f32 v156, v74, v75
  v_cvt_pk_bf16_f32 v157, v76, v77
  v_mfma_f32_16x16x32_bf16 v[70:73], a[44:47], v[162:165], v[70:73]
  s_waitcnt vmcnt(6) lgkmcnt(0)
  s_barrier
  v_mfma_f32_16x16x32_bf16 v[70:73], a[56:59], v[138:141], v[70:73]
  v_mfma_f32_16x16x32_bf16 v[70:73], a[68:71], a[252:255], v[70:73]
  v_mfma_f32_16x16x32_bf16 v[86:89], v[114:117], v[94:97], v[36:39]
  v_mfma_f32_16x16x32_bf16 v[86:89], v[112:115], v[12:15], v[86:89]
  v_mfma_f32_16x16x32_bf16 v[90:93], v[120:123], v[94:97], v[32:35]
  v_cvt_pk_bf16_f32 v158, v70, v71
  v_cvt_pk_bf16_f32 v159, v72, v73
  v_mfma_f32_16x16x32_bf16 v[90:93], v[118:121], v[12:15], v[90:93]
  v_mfma_f32_16x16x32_bf16 v[142:145], v[126:129], v[94:97], v[28:31]
  v_exp_f32 v86, v86
  v_mfma_f32_16x16x32_bf16 v[142:145], v[124:127], v[12:15], v[142:145]
  v_exp_f32 v87, v87
  v_mfma_f32_16x16x32_bf16 v[146:149], v[156:159], v[94:97], v[24:27]
  v_exp_f32 v88, v88
  v_mfma_f32_16x16x32_bf16 v[146:149], v[154:157], v[12:15], v[146:149]
  v_exp_f32 v89, v89
  v_mfma_f32_16x16x32_bf16 v[78:81], v[112:115], v[98:101], v[40:43]
  v_cvt_pk_bf16_f32 v86, v86, v87
  v_cvt_pk_bf16_f32 v87, v88, v89
  v_mfma_f32_16x16x32_bf16 v[78:81], v[114:117], v[14:17], v[78:81]
  v_exp_f32 v90, v90
  v_mfma_f32_16x16x32_bf16 v[82:85], v[118:121], v[98:101], v[36:39]
  v_exp_f32 v91, v91
  v_mfma_f32_16x16x32_bf16 v[82:85], v[120:123], v[14:17], v[82:85]
  v_exp_f32 v92, v92
  v_mfma_f32_16x16x32_bf16 v[64:67], v[124:127], v[98:101], v[32:35]
  v_exp_f32 v93, v93
  v_mfma_f32_16x16x32_bf16 v[64:67], v[126:129], v[14:17], v[64:67]
  v_cvt_pk_bf16_f32 v88, v90, v91
  v_cvt_pk_bf16_f32 v89, v92, v93
  v_mfma_f32_16x16x32_bf16 v[166:169], v[154:157], v[98:101], v[28:31]
  v_exp_f32 v142, v142
  v_mfma_f32_16x16x32_bf16 v[166:169], v[156:159], v[14:17], v[166:169]
  v_exp_f32 v143, v143
  v_mfma_f32_16x16x32_bf16 v[70:73], v[114:117], v[130:133], v[44:47]
  v_exp_f32 v144, v144
  v_mfma_f32_16x16x32_bf16 v[70:73], v[112:115], v[18:21], v[70:73]
  v_exp_f32 v145, v145
  v_mfma_f32_16x16x32_bf16 v[74:77], v[120:123], v[130:133], v[40:43]
  v_cvt_pk_bf16_f32 v90, v142, v143
  v_cvt_pk_bf16_f32 v91, v144, v145
  v_mfma_f32_16x16x32_bf16 v[74:77], v[118:121], v[18:21], v[74:77]
  v_exp_f32 v146, v146
  v_mfma_f32_16x16x32_bf16 v[150:153], v[126:129], v[130:133], v[36:39]
  v_exp_f32 v147, v147
  v_mfma_f32_16x16x32_bf16 v[150:153], v[124:127], v[18:21], v[150:153]
  v_exp_f32 v148, v148
  v_mfma_f32_16x16x32_bf16 v[142:145], v[156:159], v[130:133], v[32:35]
  v_exp_f32 v149, v149
  v_mfma_f32_16x16x32_bf16 v[142:145], v[154:157], v[18:21], v[142:145]
  v_cvt_pk_bf16_f32 v92, v146, v147
  v_cvt_pk_bf16_f32 v93, v148, v149
  v_mfma_f32_16x16x32_bf16 v[170:173], v[244:247], a[252:255], 0
  v_exp_f32 v78, v78
  v_mfma_f32_16x16x32_bf16 v[170:173], v[232:235], v[138:141], v[170:173]
  v_exp_f32 v79, v79
  v_mfma_f32_16x16x32_bf16 v[170:173], v[220:223], v[162:165], v[170:173]
  v_exp_f32 v80, v80
  v_mfma_f32_16x16x32_bf16 v[170:173], v[208:211], a[244:247], v[170:173]
  v_exp_f32 v81, v81
  v_mfma_f32_16x16x32_bf16 v[170:173], v[196:199], a[248:251], v[170:173]
  v_cvt_pk_bf16_f32 v78, v78, v79
  v_cvt_pk_bf16_f32 v79, v80, v81
  v_mfma_f32_16x16x32_bf16 v[170:173], v[184:187], v[134:137], v[170:173]
  v_exp_f32 v82, v82
  v_mfma_f32_16x16x32_bf16 v[94:97], v[188:191], v[134:137], 0
  v_exp_f32 v83, v83
  v_mfma_f32_16x16x32_bf16 v[94:97], v[200:203], a[248:251], v[94:97]
  v_exp_f32 v84, v84
  v_mfma_f32_16x16x32_bf16 v[94:97], v[212:215], a[244:247], v[94:97]
  v_mul_f32 v170, s42, v170
  v_mul_f32 v171, s42, v171
  v_mfma_f32_16x16x32_bf16 v[94:97], v[224:227], v[162:165], v[94:97]
  v_mul_f32 v172, s42, v172
  v_mul_f32 v173, s42, v173
  v_mfma_f32_16x16x32_bf16 v[94:97], v[236:239], v[138:141], v[94:97]
  v_cvt_pk_bf16_f32 v130, v170, v171
  v_cvt_pk_bf16_f32 v131, v172, v173
  v_mfma_f32_16x16x32_bf16 v[94:97], v[248:251], a[252:255], v[94:97]
  v_exp_f32 v85, v85
  v_mfma_f32_16x16x32_bf16 v[98:101], v[252:255], a[252:255], 0
  v_cvt_pk_bf16_f32 v80, v82, v83
  v_cvt_pk_bf16_f32 v81, v84, v85
  v_mfma_f32_16x16x32_bf16 v[98:101], v[240:243], v[138:141], v[98:101]
  v_exp_f32 v64, v64
  v_mfma_f32_16x16x32_bf16 v[98:101], v[228:231], v[162:165], v[98:101]
  v_mul_f32 v94, s42, v94
  v_mul_f32 v95, s42, v95
  v_mfma_f32_16x16x32_bf16 v[98:101], v[216:219], a[244:247], v[98:101]
  v_mul_f32 v96, s42, v96
  v_mul_f32 v97, s42, v97
  v_mfma_f32_16x16x32_bf16 v[98:101], v[204:207], a[248:251], v[98:101]
  v_cvt_pk_bf16_f32 v132, v94, v95
  v_cvt_pk_bf16_f32 v133, v96, v97
  v_mfma_f32_16x16x32_bf16 v[98:101], v[192:195], v[134:137], v[98:101]
  v_exp_f32 v65, v65
  v_mfma_f32_16x16x32_bf16 v[170:173], v[134:137], a[72:75], 0
  v_exp_f32 v66, v66
  v_mfma_f32_16x16x32_bf16 v[170:173], a[248:251], a[84:87], v[170:173]
  v_exp_f32 v67, v67
  v_mfma_f32_16x16x32_bf16 v[170:173], a[244:247], a[96:99], v[170:173]
  v_mul_f32 v98, s42, v98
  v_mul_f32 v99, s42, v99
  v_mfma_f32_16x16x32_bf16 v[170:173], v[162:165], a[108:111], v[170:173]
  v_mul_f32 v100, s42, v100
  v_mul_f32 v101, s42, v101
  v_mfma_f32_16x16x32_bf16 v[170:173], v[138:141], a[120:123], v[170:173]
  v_cvt_pk_bf16_f32 v22, v98, v99
  v_cvt_pk_bf16_f32 v23, v100, v101
  v_mfma_f32_16x16x32_bf16 v[170:173], a[252:255], a[132:135], v[170:173]
  v_cvt_pk_bf16_f32 v82, v64, v65
  v_cvt_pk_bf16_f32 v83, v66, v67
  v_mfma_f32_16x16x32_bf16 v[94:97], v[112:115], v[130:133], v[48:51]
  v_exp_f32 v166, v166
  v_mfma_f32_16x16x32_bf16 v[94:97], v[114:117], v[20:23], v[94:97]
  v_exp_f32 v167, v167
  v_mfma_f32_16x16x32_bf16 v[98:101], v[118:121], v[130:133], v[44:47]
  v_cvt_pk_bf16_f32 v104, v170, v171
  v_cvt_pk_bf16_f32 v105, v172, v173
  v_mfma_f32_16x16x32_bf16 v[98:101], v[120:123], v[20:23], v[98:101]
  v_exp_f32 v168, v168
  v_mfma_f32_16x16x32_bf16 v[146:149], v[124:127], v[130:133], v[40:43]
  v_exp_f32 v169, v169
  v_mfma_f32_16x16x32_bf16 v[146:149], v[126:129], v[20:23], v[146:149]
  v_cvt_pk_bf16_f32 v84, v166, v167
  v_cvt_pk_bf16_f32 v85, v168, v169
  v_mfma_f32_16x16x32_bf16 v[64:67], v[154:157], v[130:133], v[36:39]
  v_exp_f32 v70, v70
  v_mfma_f32_16x16x32_bf16 v[64:67], v[156:159], v[20:23], v[64:67]
  v_exp_f32 v71, v71
  v_mfma_f32_16x16x32_bf16 v[130:133], a[252:255], a[136:139], 0
  v_exp_f32 v72, v72
  v_mfma_f32_16x16x32_bf16 v[130:133], v[138:141], a[124:127], v[130:133]
  v_exp_f32 v73, v73
  v_mfma_f32_16x16x32_bf16 v[130:133], v[162:165], a[112:115], v[130:133]
  v_cvt_pk_bf16_f32 v70, v70, v71
  v_cvt_pk_bf16_f32 v71, v72, v73
  v_mfma_f32_16x16x32_bf16 v[130:133], a[244:247], a[100:103], v[130:133]
  ds_read_b128 v[114:117], v3 offset:0
  ds_read_b128 v[118:121], v3 offset:4096
  v_mfma_f32_16x16x32_bf16 v[130:133], a[248:251], a[88:91], v[130:133]
  ds_read_b128 v[122:125], v3 offset:8192
  ds_read_b128 v[126:129], v3 offset:12288
  v_mfma_f32_16x16x32_bf16 v[130:133], v[134:137], a[76:79], v[130:133]
  ds_read_b128 v[154:157], v3 offset:16384
  ds_read_b128 v[158:161], v3 offset:20480
  v_mfma_f32_16x16x32_bf16 v[170:173], v[134:137], a[80:83], 0
  v_exp_f32 v74, v74
  v_mfma_f32_16x16x32_bf16 v[170:173], a[248:251], a[92:95], v[170:173]
  v_exp_f32 v75, v75
  v_mfma_f32_16x16x32_bf16 v[170:173], a[244:247], a[104:107], v[170:173]
  v_cvt_pk_bf16_f32 v108, v130, v131
  v_cvt_pk_bf16_f32 v109, v132, v133
  v_mfma_f32_16x16x32_bf16 v[170:173], v[162:165], a[116:119], v[170:173]
  v_exp_f32 v76, v76
  v_mfma_f32_16x16x32_bf16 v[170:173], v[138:141], a[128:131], v[170:173]
  v_exp_f32 v77, v77
  v_mfma_f32_16x16x32_bf16 v[170:173], a[252:255], a[140:143], v[170:173]
  s_waitcnt lgkmcnt(0)
  s_nop 3
.p2align 6
L_loop:
  v_mfma_f32_16x16x32_bf16 v[166:169], a[144:147], v[114:117], 0
  v_cvt_pk_bf16_f32 v72, v74, v75
  v_cvt_pk_bf16_f32 v73, v76, v77
  v_mfma_f32_16x16x32_bf16 v[166:169], a[160:163], v[118:121], v[166:169]
  v_exp_f32 v150, v150
  v_mfma_f32_16x16x32_bf16 v[166:169], a[176:179], v[122:125], v[166:169]
  v_cvt_pk_bf16_f32 v112, v170, v171
  v_cvt_pk_bf16_f32 v113, v172, v173
  v_mfma_f32_16x16x32_bf16 v[166:169], a[192:195], v[126:129], v[166:169]
  v_exp_f32 v151, v151
  v_mfma_f32_16x16x32_bf16 v[166:169], a[208:211], v[154:157], v[166:169]
  v_exp_f32 v152, v152
  v_mfma_f32_16x16x32_bf16 v[166:169], a[224:227], v[158:161], v[166:169]
  v_exp_f32 v153, v153
  v_mfma_f32_16x16x32_bf16 v[170:173], a[228:231], v[158:161], 0
  v_cvt_pk_bf16_f32 v74, v150, v151
  v_cvt_pk_bf16_f32 v75, v152, v153
  v_mfma_f32_16x16x32_bf16 v[170:173], a[212:215], v[154:157], v[170:173]
  v_exp_f32 v142, v142
  v_mfma_f32_16x16x32_bf16 v[170:173], a[196:199], v[126:129], v[170:173]
  v_cvt_pk_bf16_f32 v166, v166, v167
  v_cvt_pk_bf16_f32 v167, v168, v169
  v_mfma_f32_16x16x32_bf16 v[170:173], a[180:183], v[122:125], v[170:173]
  v_exp_f32 v143, v143
  v_mfma_f32_16x16x32_bf16 v[170:173], a[164:167], v[118:121], v[170:173]
  v_exp_f32 v144, v144
  v_mfma_f32_16x16x32_bf16 v[170:173], a[148:151], v[114:117], v[170:173]
  ds_read_b128 v[130:133], v4 offset:0
  ds_read_b128 v[134:137], v4 offset:4096
  v_mfma_f32_16x16x32_bf16 v[162:165], a[152:155], v[114:117], 0
  v_exp_f32 v145, v145
  v_mfma_f32_16x16x32_bf16 v[162:165], a[168:171], v[118:121], v[162:165]
  ds_read_b128 v[138:141], v4 offset:8192
  ds_read_b128 v[150:153], v4 offset:12288
  v_mfma_f32_16x16x32_bf16 v[162:165], a[184:187], v[122:125], v[162:165]
  v_cvt_pk_bf16_f32 v168, v170, v171
  v_cvt_pk_bf16_f32 v169, v172, v173
  v_mfma_f32_16x16x32_bf16 v[162:165], a[200:203], v[126:129], v[162:165]
  buffer_store_dwordx4 v[166:169], v7, s[24:27], s33 offen nt
  v_cvt_pk_bf16_f32 v76, v142, v143
  v_cvt_pk_bf16_f32 v77, v144, v145
  v_mfma_f32_16x16x32_bf16 v[162:165], a[216:219], v[154:157], v[162:165]
  v_exp_f32 v94, v94
  v_mfma_f32_16x16x32_bf16 v[162:165], a[232:235], v[158:161], v[162:165]
  ds_read_b128 v[142:145], v4 offset:16384
  ds_read_b128 v[166:169], v4 offset:20480
  v_mfma_f32_16x16x32_bf16 v[170:173], a[236:239], v[158:161], 0
  v_exp_f32 v95, v95
  v_mfma_f32_16x16x32_bf16 v[170:173], a[220:223], v[154:157], v[170:173]
  v_exp_f32 v96, v96
  v_mfma_f32_16x16x32_bf16 v[170:173], a[204:207], v[126:129], v[170:173]
  v_cvt_pk_bf16_f32 v162, v162, v163
  v_cvt_pk_bf16_f32 v163, v164, v165
  v_mfma_f32_16x16x32_bf16 v[170:173], a[188:191], v[122:125], v[170:173]
  v_exp_f32 v97, v97
  v_mfma_f32_16x16x32_bf16 v[170:173], a[172:175], v[118:121], v[170:173]
  v_cvt_pk_bf16_f32 v94, v94, v95
  v_cvt_pk_bf16_f32 v95, v96, v97
  v_mfma_f32_16x16x32_bf16 v[170:173], a[156:159], v[114:117], v[170:173]
  s_waitcnt lgkmcnt(0)
  ds_read_b128 a[244:247], v3 offset:512
  ds_read_b128 a[248:251], v3 offset:4608
  v_mfma_f32_16x16x32_bf16 v[126:129], a[144:147], v[130:133], 0
  v_exp_f32 v98, v98
  v_mfma_f32_16x16x32_bf16 v[126:129], a[160:163], v[134:137], v[126:129]
  ds_read_b128 a[252:255], v3 offset:8704
  ds_read_b128 v[114:117], v3 offset:12800
  v_mfma_f32_16x16x32_bf16 v[126:129], a[176:179], v[138:141], v[126:129]
  v_cvt_pk_bf16_f32 v164, v170, v171
  v_cvt_pk_bf16_f32 v165, v172, v173
  v_mfma_f32_16x16x32_bf16 v[126:129], a[192:195], v[150:153], v[126:129]
  buffer_store_dwordx4 v[162:165], v8, s[24:27], s33 offen nt
  v_exp_f32 v99, v99
  v_mfma_f32_16x16x32_bf16 v[126:129], a[208:211], v[142:145], v[126:129]
  v_exp_f32 v100, v100
  v_mfma_f32_16x16x32_bf16 v[126:129], a[224:227], v[166:169], v[126:129]
  ds_read_b128 v[118:121], v3 offset:16896
  ds_read_b128 v[122:125], v3 offset:20992
  v_mfma_f32_16x16x32_bf16 v[154:157], a[228:231], v[166:169], 0
  v_exp_f32 v101, v101
  v_mfma_f32_16x16x32_bf16 v[154:157], a[212:215], v[142:145], v[154:157]
  v_cvt_pk_bf16_f32 v96, v98, v99
  v_cvt_pk_bf16_f32 v97, v100, v101
  v_mfma_f32_16x16x32_bf16 v[154:157], a[196:199], v[150:153], v[154:157]
  v_cvt_pk_bf16_f32 v126, v126, v127
  v_cvt_pk_bf16_f32 v127, v128, v129
  v_mfma_f32_16x16x32_bf16 v[154:157], a[180:183], v[138:141], v[154:157]
  v_exp_f32 v146, v146
  v_mfma_f32_16x16x32_bf16 v[154:157], a[164:167], v[134:137], v[154:157]
  v_exp_f32 v147, v147
  v_mfma_f32_16x16x32_bf16 v[154:157], a[148:151], v[130:133], v[154:157]
  s_waitcnt lgkmcnt(0)
  v_exp_f32 v148, v148
  v_mfma_f32_16x16x32_bf16 v[134:137], a[144:147], a[244:247], 0
  v_exp_f32 v149, v149
  v_mfma_f32_16x16x32_bf16 v[134:137], a[160:163], a[248:251], v[134:137]
  v_cvt_pk_bf16_f32 v98, v146, v147
  v_cvt_pk_bf16_f32 v99, v148, v149
  v_mfma_f32_16x16x32_bf16 v[134:137], a[176:179], a[252:255], v[134:137]
  v_cvt_pk_bf16_f32 v128, v154, v155
  v_cvt_pk_bf16_f32 v129, v156, v157
  v_mfma_f32_16x16x32_bf16 v[134:137], a[192:195], v[114:117], v[134:137]
  buffer_store_dwordx4 v[126:129], v7, s[24:27], s34 offen nt
  v_exp_f32 v64, v64
  v_mfma_f32_16x16x32_bf16 v[134:137], a[208:211], v[118:121], v[134:137]
  v_exp_f32 v65, v65
  v_mfma_f32_16x16x32_bf16 v[134:137], a[224:227], v[122:125], v[134:137]
  v_exp_f32 v66, v66
  v_mfma_f32_16x16x32_bf16 v[146:149], a[228:231], v[122:125], 0
  v_exp_f32 v67, v67
  v_mfma_f32_16x16x32_bf16 v[146:149], a[212:215], v[118:121], v[146:149]
  v_cvt_pk_bf16_f32 v100, v64, v65
  v_cvt_pk_bf16_f32 v101, v66, v67
  v_mfma_f32_16x16x32_bf16 v[146:149], a[196:199], v[114:117], v[146:149]
  v_cvt_pk_bf16_f32 v134, v134, v135
  v_cvt_pk_bf16_f32 v135, v136, v137
  v_mfma_f32_16x16x32_bf16 v[146:149], a[180:183], a[252:255], v[146:149]
  v_mfma_f32_16x16x32_bf16 v[146:149], a[164:167], a[248:251], v[146:149]
  v_mfma_f32_16x16x32_bf16 v[146:149], a[148:151], a[244:247], v[146:149]
  ds_read_b128 v[64:67], v4 offset:512
  ds_read_b128 v[126:129], v4 offset:4608
  v_mfma_f32_16x16x32_bf16 v[142:145], a[152:155], a[244:247], 0
  v_mfma_f32_16x16x32_bf16 v[142:145], a[168:171], a[248:251], v[142:145]
  ds_read_b128 v[130:133], v4 offset:8704
  ds_read_b128 v[138:141], v4 offset:12800
  v_mfma_f32_16x16x32_bf16 v[142:145], a[184:187], a[252:255], v[142:145]
  v_cvt_pk_bf16_f32 v136, v146, v147
  v_cvt_pk_bf16_f32 v137, v148, v149
  v_mfma_f32_16x16x32_bf16 v[142:145], a[200:203], v[114:117], v[142:145]
  buffer_store_dwordx4 v[134:137], v7, s[24:27], s35 offen nt
  v_mfma_f32_16x16x32_bf16 v[142:145], a[216:219], v[118:121], v[142:145]
  v_mfma_f32_16x16x32_bf16 v[142:145], a[232:235], v[122:125], v[142:145]
  ds_read_b128 v[146:149], v4 offset:16896
  ds_read_b128 v[134:137], v4 offset:20992
  v_mfma_f32_16x16x32_bf16 v[150:153], a[236:239], v[122:125], 0
  v_mfma_f32_16x16x32_bf16 v[150:153], a[220:223], v[118:121], v[150:153]
  v_mfma_f32_16x16x32_bf16 v[150:153], a[204:207], v[114:117], v[150:153]
  v_cvt_pk_bf16_f32 v142, v142, v143
  v_cvt_pk_bf16_f32 v143, v144, v145
  v_mfma_f32_16x16x32_bf16 v[150:153], a[188:191], a[252:255], v[150:153]
  v_mfma_f32_16x16x32_bf16 v[150:153], a[172:175], a[248:251], v[150:153]
  v_mfma_f32_16x16x32_bf16 v[150:153], a[156:159], a[244:247], v[150:153]
  s_waitcnt lgkmcnt(0)
  v_mfma_f32_16x16x32_bf16 v[114:117], a[144:147], v[64:67], 0
  v_xor_b32 v3, 40960, v3
  v_xor_b32 v4, 40960, v4
  v_mfma_f32_16x16x32_bf16 v[114:117], a[160:163], v[126:129], v[114:117]
  v_mfma_f32_16x16x32_bf16 v[114:117], a[176:179], v[130:133], v[114:117]
  v_cvt_pk_bf16_f32 v144, v150, v151
  v_cvt_pk_bf16_f32 v145, v152, v153
  v_mfma_f32_16x16x32_bf16 v[114:117], a[192:195], v[138:141], v[114:117]
  buffer_store_dwordx4 v[142:145], v8, s[24:27], s35 offen nt
  v_mfma_f32_16x16x32_bf16 v[114:117], a[208:211], v[146:149], v[114:117]
  v_mfma_f32_16x16x32_bf16 v[114:117], a[224:227], v[134:137], v[114:117]
  v_mfma_f32_16x16x32_bf16 v[122:125], a[228:231], v[134:137], 0
  v_mfma_f32_16x16x32_bf16 v[122:125], a[212:215], v[146:149], v[122:125]
  v_mfma_f32_16x16x32_bf16 v[122:125], a[196:199], v[138:141], v[122:125]
  v_cvt_pk_bf16_f32 v114, v114, v115
  v_cvt_pk_bf16_f32 v115, v116, v117
  v_mfma_f32_16x16x32_bf16 v[122:125], a[180:183], v[130:133], v[122:125]
  v_mov_b64 v[150:151], 0
  v_mfma_f32_16x16x32_bf16 v[122:125], a[164:167], v[126:129], v[122:125]
  v_mfma_f32_16x16x32_bf16 v[122:125], a[148:151], v[64:67], v[122:125]
  v_smfmac_f32_16x16x64_bf16 v[150:153], a[240:243], v[86:93], v10
  v_mfma_f32_16x16x32_bf16 v[118:121], v[102:105], v[90:93], 0
  v_mfma_f32_16x16x32_bf16 v[118:121], v[52:55], v[86:89], v[118:121]
  v_cvt_pk_bf16_f32 v116, v122, v123
  v_cvt_pk_bf16_f32 v117, v124, v125
  v_mfma_f32_16x16x32_bf16 v[158:161], v[56:59], v[86:89], 0
  buffer_store_dwordx4 v[114:117], v7, s[24:27], s36 offen nt
  v_mfma_f32_16x16x32_bf16 v[158:161], v[106:109], v[90:93], v[158:161]
  v_mov_b64 v[64:65], 0
  v_mfma_f32_16x16x32_bf16 v[154:157], v[110:113], v[90:93], 0
  v_add_f32 v150, v150, v151
  v_mfma_f32_16x16x32_bf16 v[154:157], v[60:63], v[86:89], v[154:157]
  v_rcp_f32 v152, v150
  v_smfmac_f32_16x16x64_bf16 v[64:67], a[240:243], v[78:85], v10
  v_max3_f32 v9, v150, v152, v9
  v_mul_f32 v118, v152, v118
  v_mfma_f32_16x16x32_bf16 v[146:149], v[102:105], v[82:85], 0
  v_mul_f32 v119, v152, v119
  v_mul_f32 v120, v152, v120
  v_mfma_f32_16x16x32_bf16 v[146:149], v[52:55], v[78:81], v[146:149]
  v_mul_f32 v121, v152, v121
  v_cvt_pk_bf16_f32 v118, v118, v119
  v_mfma_f32_16x16x32_bf16 v[142:145], v[56:59], v[78:81], 0
  v_cvt_pk_bf16_f32 v119, v120, v121
  v_mfma_f32_16x16x32_bf16 v[142:145], v[106:109], v[82:85], v[142:145]
  v_mov_b64 v[114:115], 0
  v_mfma_f32_16x16x32_bf16 v[138:141], v[110:113], v[82:85], 0
  ds_write_b32 v5, v118 offset:0
  v_mfma_f32_16x16x32_bf16 v[138:141], v[60:63], v[78:81], v[138:141]
  ds_write_b32 v5, v119 offset:1024
  v_smfmac_f32_16x16x64_bf16 v[114:117], a[240:243], v[70:77], v10
  v_mul_f32 v158, v152, v158
  v_mul_f32 v159, v152, v159
  v_mfma_f32_16x16x32_bf16 v[134:137], v[102:105], v[74:77], 0
  v_mul_f32 v160, v152, v160
  v_mul_f32 v161, v152, v161
  v_mfma_f32_16x16x32_bf16 v[134:137], v[52:55], v[70:73], v[134:137]
  v_cvt_pk_bf16_f32 v158, v158, v159
  v_cvt_pk_bf16_f32 v159, v160, v161
  v_mfma_f32_16x16x32_bf16 v[122:125], v[56:59], v[70:73], 0
  ds_read_b128 v[126:129], v0 offset:0
  ds_read_b128 a[244:247], v1 offset:0
  v_mfma_f32_16x16x32_bf16 v[122:125], v[106:109], v[74:77], v[122:125]
  v_mov_b64 v[78:79], 0
  v_mfma_f32_16x16x32_bf16 v[118:121], v[110:113], v[74:77], 0
  ds_read_b128 v[130:133], v0 offset:8192
  ds_read_b128 a[248:251], v1 offset:8192
  v_mfma_f32_16x16x32_bf16 v[118:121], v[60:63], v[70:73], v[118:121]
  ds_write_b32 v5, v158 offset:2048
  v_smfmac_f32_16x16x64_bf16 v[78:81], a[240:243], v[94:101], v10
  ds_read_b128 v[74:77], v0 offset:16384
  ds_read_b128 a[252:255], v1 offset:16384
  v_mfma_f32_16x16x32_bf16 v[90:93], v[102:105], v[98:101], 0
  ds_write_b32 v5, v159 offset:3072
  v_mfma_f32_16x16x32_bf16 v[90:93], v[52:55], v[94:97], v[90:93]
  v_mul_f32 v154, v152, v154
  v_mul_f32 v155, v152, v155
  v_mfma_f32_16x16x32_bf16 v[86:89], v[56:59], v[94:97], 0
  v_mul_f32 v156, v152, v156
  v_mul_f32 v157, v152, v157
  v_mfma_f32_16x16x32_bf16 v[86:89], v[106:109], v[98:101], v[86:89]
  v_cvt_pk_bf16_f32 v154, v154, v155
  v_cvt_pk_bf16_f32 v155, v156, v157
  v_mfma_f32_16x16x32_bf16 v[82:85], v[110:113], v[98:101], 0
  ds_write_b32 v5, v154 offset:4096
  v_mfma_f32_16x16x32_bf16 v[82:85], v[60:63], v[94:97], v[82:85]
  s_waitcnt lgkmcnt(2)
  ds_write_b32 v5, v155 offset:5120
  v_mfma_f32_16x16x32_bf16 v[68:71], v[184:187], v[126:129], 0
  v_add_f32 v64, v64, v65
  v_mfma_f32_16x16x32_bf16 v[68:71], v[196:199], a[244:247], v[68:71]
  v_rcp_f32 v66, v64
  v_mfma_f32_16x16x32_bf16 v[68:71], v[208:211], v[130:133], v[68:71]
  v_max3_f32 v9, v64, v66, v9
  v_mul_f32 v146, v66, v146
  v_mfma_f32_16x16x32_bf16 v[68:71], v[220:223], a[248:251], v[68:71]
  s_add_u32 m0, s30, 0
  v_mul_f32 v147, v66, v147
  v_mul_f32 v148, v66, v148
  v_mfma_f32_16x16x32_bf16 v[68:71], v[232:235], v[74:77], v[68:71]
  buffer_load_dwordx4 v6, s[8:11], s31 offen offset:0 nt lds
  v_mfma_f32_16x16x32_bf16 v[68:71], v[244:247], a[252:255], v[68:71]
  v_mul_f32 v149, v66, v149
  v_cvt_pk_bf16_f32 v146, v146, v147
  v_mfma_f32_16x16x32_bf16 v[56:59], v[248:251], a[252:255], 0
  v_cvt_pk_bf16_f32 v147, v148, v149
  v_mfma_f32_16x16x32_bf16 v[56:59], v[236:239], v[74:77], v[56:59]
  ds_write_b32 v5, v146 offset:256
  v_mfma_f32_16x16x32_bf16 v[56:59], v[224:227], a[248:251], v[56:59]
  v_mul_f32 v68, s42, v68
  v_mul_f32 v69, s42, v69
  v_mfma_f32_16x16x32_bf16 v[56:59], v[212:215], v[130:133], v[56:59]
  v_mul_f32 v70, s42, v70
  v_mul_f32 v71, s42, v71
  v_mfma_f32_16x16x32_bf16 v[56:59], v[200:203], a[244:247], v[56:59]
  v_cvt_pk_bf16_f32 v12, v68, v69
  v_cvt_pk_bf16_f32 v13, v70, v71
  v_mfma_f32_16x16x32_bf16 v[56:59], v[188:191], v[126:129], v[56:59]
  ds_write_b32 v5, v147 offset:1280
  v_mfma_f32_16x16x32_bf16 v[52:55], v[192:195], v[126:129], 0
  v_mul_f32 v142, v66, v142
  v_mul_f32 v143, v66, v143
  v_mfma_f32_16x16x32_bf16 v[52:55], v[204:207], a[244:247], v[52:55]
  v_mul_f32 v144, v66, v144
  v_mul_f32 v145, v66, v145
  v_mfma_f32_16x16x32_bf16 v[52:55], v[216:219], v[130:133], v[52:55]
  v_mul_f32 v56, s42, v56
  v_mul_f32 v57, s42, v57
  v_mfma_f32_16x16x32_bf16 v[52:55], v[228:231], a[248:251], v[52:55]
  s_add_u32 m0, s30, 8064
  v_mul_f32 v58, s42, v58
  v_mul_f32 v59, s42, v59
  v_mfma_f32_16x16x32_bf16 v[52:55], v[240:243], v[74:77], v[52:55]
  v_cvt_pk_bf16_f32 v70, v56, v57
  v_cvt_pk_bf16_f32 v71, v58, v59
  v_mfma_f32_16x16x32_bf16 v[52:55], v[252:255], a[252:255], v[52:55]
  buffer_load_dwordx4 v6, s[8:11], s31 offen offset:128 nt lds
  v_mfma_f32_16x16x32_bf16 v[60:63], a[60:63], a[252:255], 0
  v_cvt_pk_bf16_f32 v142, v142, v143
  v_cvt_pk_bf16_f32 v143, v144, v145
  v_mfma_f32_16x16x32_bf16 v[60:63], a[48:51], v[74:77], v[60:63]
  ds_write_b32 v5, v142 offset:2304
  v_mfma_f32_16x16x32_bf16 v[60:63], a[36:39], a[248:251], v[60:63]
  v_mul_f32 v52, s42, v52
  v_mul_f32 v53, s42, v53
  v_mfma_f32_16x16x32_bf16 v[60:63], a[24:27], v[130:133], v[60:63]
  v_mul_f32 v54, s42, v54
  v_mul_f32 v55, s42, v55
  v_mfma_f32_16x16x32_bf16 v[60:63], a[12:15], a[244:247], v[60:63]
  v_cvt_pk_bf16_f32 v72, v52, v53
  v_cvt_pk_bf16_f32 v73, v54, v55
  v_mfma_f32_16x16x32_bf16 v[60:63], a[0:3], v[126:129], v[60:63]
  ds_write_b32 v5, v143 offset:3328
  v_mfma_f32_16x16x32_bf16 v[56:59], a[4:7], v[126:129], 0
  v_mul_f32 v138, v66, v138
  v_mul_f32 v139, v66, v139
  v_mfma_f32_16x16x32_bf16 v[56:59], a[16:19], a[244:247], v[56:59]
  v_mul_f32 v140, v66, v140
  v_mul_f32 v141, v66, v141
  v_mfma_f32_16x16x32_bf16 v[56:59], a[28:31], v[130:133], v[56:59]
  v_cvt_pk_bf16_f32 v64, v60, v61
  v_cvt_pk_bf16_f32 v65, v62, v63
  v_mfma_f32_16x16x32_bf16 v[56:59], a[40:43], a[248:251], v[56:59]
  s_add_u32 m0, s30, 16128
  v_cvt_pk_bf16_f32 v138, v138, v139
  v_cvt_pk_bf16_f32 v139, v140, v141
  v_mfma_f32_16x16x32_bf16 v[56:59], a[52:55], v[74:77], v[56:59]
  buffer_load_dwordx4 v6, s[8:11], s31 offen offset:256 nt lds
  v_mfma_f32_16x16x32_bf16 v[56:59], a[64:67], a[252:255], v[56:59]
  ds_write_b32 v5, v138 offset:4352
  v_mfma_f32_16x16x32_bf16 v[60:63], a[68:71], a[252:255], 0
  ds_write_b32 v5, v139 offset:5376
  v_mfma_f32_16x16x32_bf16 v[60:63], a[56:59], v[74:77], v[60:63]
  v_add_f32 v114, v114, v115
  v_mfma_f32_16x16x32_bf16 v[60:63], a[44:47], a[248:251], v[60:63]
  v_cvt_pk_bf16_f32 v66, v56, v57
  v_cvt_pk_bf16_f32 v67, v58, v59
  v_mfma_f32_16x16x32_bf16 v[60:63], a[32:35], v[130:133], v[60:63]
  v_rcp_f32 v116, v114
  v_mfma_f32_16x16x32_bf16 v[60:63], a[20:23], a[244:247], v[60:63]
  v_max3_f32 v9, v114, v116, v9
  v_mul_f32 v134, v116, v134
  v_mfma_f32_16x16x32_bf16 v[60:63], a[8:11], v[126:129], v[60:63]
  v_mul_f32 v135, v116, v135
  v_mul_f32 v136, v116, v136
  v_mfma_f32_16x16x32_bf16 v[54:57], v[126:129], a[72:75], 0
  v_mul_f32 v137, v116, v137
  v_cvt_pk_bf16_f32 v134, v134, v135
  v_mfma_f32_16x16x32_bf16 v[54:57], a[244:247], a[84:87], v[54:57]
  v_cvt_pk_bf16_f32 v135, v136, v137
  v_mfma_f32_16x16x32_bf16 v[54:57], v[130:133], a[96:99], v[54:57]
  v_cvt_pk_bf16_f32 v68, v60, v61
  v_cvt_pk_bf16_f32 v69, v62, v63
  v_mfma_f32_16x16x32_bf16 v[54:57], a[248:251], a[108:111], v[54:57]
  s_add_u32 m0, s30, 4096
  ds_write_b32 v5, v134 offset:512
  v_mfma_f32_16x16x32_bf16 v[54:57], v[74:77], a[120:123], v[54:57]
  buffer_load_dwordx4 v6, s[8:11], s32 offen offset:0 nt lds
  v_mfma_f32_16x16x32_bf16 v[54:57], a[252:255], a[132:135], v[54:57]
  ds_write_b32 v5, v135 offset:1536
  v_mfma_f32_16x16x32_bf16 v[58:61], a[252:255], a[136:139], 0
  v_mul_f32 v122, v116, v122
  v_mul_f32 v123, v116, v123
  v_mfma_f32_16x16x32_bf16 v[58:61], v[74:77], a[124:127], v[58:61]
  ds_read_b128 v[94:97], v0 offset:2048
  ds_read_b128 v[98:101], v1 offset:2048
  v_mfma_f32_16x16x32_bf16 v[58:61], a[248:251], a[112:115], v[58:61]
  v_cvt_pk_bf16_f32 v52, v54, v55
  v_cvt_pk_bf16_f32 v53, v56, v57
  v_mfma_f32_16x16x32_bf16 v[58:61], v[130:133], a[100:103], v[58:61]
  ds_read_b128 v[106:109], v0 offset:10240
  ds_read_b128 v[102:105], v1 offset:10240
  v_mfma_f32_16x16x32_bf16 v[58:61], a[244:247], a[88:91], v[58:61]
  v_mul_f32 v124, v116, v124
  v_mul_f32 v125, v116, v125
  v_mfma_f32_16x16x32_bf16 v[58:61], v[126:129], a[76:79], v[58:61]
  ds_read_b128 v[134:137], v0 offset:18432
  ds_read_b128 v[138:141], v1 offset:18432
  v_mfma_f32_16x16x32_bf16 v[110:113], v[126:129], a[80:83], 0
  v_cvt_pk_bf16_f32 v122, v122, v123
  v_cvt_pk_bf16_f32 v123, v124, v125
  v_mfma_f32_16x16x32_bf16 v[110:113], a[244:247], a[92:95], v[110:113]
  ds_write_b32 v5, v122 offset:2560
  v_mfma_f32_16x16x32_bf16 v[110:113], v[130:133], a[104:107], v[110:113]
  v_cvt_pk_bf16_f32 v56, v58, v59
  v_cvt_pk_bf16_f32 v57, v60, v61
  v_mfma_f32_16x16x32_bf16 v[110:113], a[248:251], a[116:119], v[110:113]
  s_add_u32 m0, s30, 12160
  ds_write_b32 v5, v123 offset:3584
  v_mfma_f32_16x16x32_bf16 v[110:113], v[74:77], a[128:131], v[110:113]
  buffer_load_dwordx4 v6, s[8:11], s32 offen offset:128 nt lds
  v_mfma_f32_16x16x32_bf16 v[110:113], a[252:255], a[140:143], v[110:113]
  s_waitcnt lgkmcnt(2)
  v_mul_f32 v118, v116, v118
  v_mul_f32 v119, v116, v119
  v_mfma_f32_16x16x32_bf16 v[122:125], v[184:187], v[94:97], 0
  v_mul_f32 v120, v116, v120
  v_mul_f32 v121, v116, v121
  v_mfma_f32_16x16x32_bf16 v[122:125], v[196:199], v[98:101], v[122:125]
  v_cvt_pk_bf16_f32 v118, v118, v119
  v_cvt_pk_bf16_f32 v119, v120, v121
  v_mfma_f32_16x16x32_bf16 v[122:125], v[208:211], v[106:109], v[122:125]
  v_cvt_pk_bf16_f32 v60, v110, v111
  v_cvt_pk_bf16_f32 v61, v112, v113
  v_mfma_f32_16x16x32_bf16 v[122:125], v[220:223], v[102:105], v[122:125]
  ds_write_b32 v5, v118 offset:4608
  v_mfma_f32_16x16x32_bf16 v[122:125], v[232:235], v[134:137], v[122:125]
  ds_write_b32 v5, v119 offset:5632
  v_mfma_f32_16x16x32_bf16 v[122:125], v[244:247], v[138:141], v[122:125]
  v_add_f32 v78, v78, v79
  v_mfma_f32_16x16x32_bf16 v[114:117], v[248:251], v[138:141], 0
  v_rcp_f32 v80, v78
  v_mfma_f32_16x16x32_bf16 v[114:117], v[236:239], v[134:137], v[114:117]
  v_max3_f32 v9, v78, v80, v9
  v_mul_f32 v90, v80, v90
  v_mfma_f32_16x16x32_bf16 v[114:117], v[224:227], v[102:105], v[114:117]
  v_mul_f32 v122, s42, v122
  v_mul_f32 v123, s42, v123
  v_mfma_f32_16x16x32_bf16 v[114:117], v[212:215], v[106:109], v[114:117]
  s_add_u32 m0, s30, 20224
  v_mul_f32 v124, s42, v124
  v_mul_f32 v125, s42, v125
  v_mfma_f32_16x16x32_bf16 v[114:117], v[200:203], v[98:101], v[114:117]
  v_cvt_pk_bf16_f32 v74, v122, v123
  v_cvt_pk_bf16_f32 v75, v124, v125
  v_mfma_f32_16x16x32_bf16 v[114:117], v[188:191], v[94:97], v[114:117]
  buffer_load_dwordx4 v6, s[8:11], s32 offen offset:256 nt lds
  v_mfma_f32_16x16x32_bf16 v[110:113], v[192:195], v[94:97], 0
  s_add_u32 s33, s31, s37
  v_mul_f32 v91, v80, v91
  v_mul_f32 v92, v80, v92
  v_mfma_f32_16x16x32_bf16 v[110:113], v[204:207], v[98:101], v[110:113]
  s_add_u32 s34, s31, s38
  v_mul_f32 v93, v80, v93
  v_cvt_pk_bf16_f32 v90, v90, v91
  v_mfma_f32_16x16x32_bf16 v[110:113], v[216:219], v[106:109], v[110:113]
  s_add_u32 s35, s31, s39
  v_mul_f32 v114, s42, v114
  v_mul_f32 v115, s42, v115
  v_mfma_f32_16x16x32_bf16 v[110:113], v[228:231], v[102:105], v[110:113]
  s_add_u32 s36, s31, s40
  v_mul_f32 v116, s42, v116
  v_mul_f32 v117, s42, v117
  v_mfma_f32_16x16x32_bf16 v[110:113], v[240:243], v[134:137], v[110:113]
  s_add_u32 s31, s31, s43
  v_cvt_pk_bf16_f32 v76, v114, v115
  v_cvt_pk_bf16_f32 v77, v116, v117
  v_mfma_f32_16x16x32_bf16 v[110:113], v[252:255], v[138:141], v[110:113]
  s_add_u32 s32, s32, s43
  v_cvt_pk_bf16_f32 v91, v92, v93
  v_mfma_f32_16x16x32_bf16 v[114:117], a[60:63], v[138:141], 0
  s_mov_b32 s5, s28
  ds_write_b32 v5, v90 offset:768
  v_mfma_f32_16x16x32_bf16 v[114:117], a[48:51], v[134:137], v[114:117]
  s_mov_b32 s28, s29
  ds_write_b32 v5, v91 offset:1792
  v_mfma_f32_16x16x32_bf16 v[114:117], a[36:39], v[102:105], v[114:117]
  s_mov_b32 s29, s30
  v_mul_f32 v110, s42, v110
  v_mul_f32 v111, s42, v111
  v_mfma_f32_16x16x32_bf16 v[114:117], a[24:27], v[106:109], v[114:117]
  s_mov_b32 s30, s5
  v_mul_f32 v112, s42, v112
  v_mul_f32 v113, s42, v113
  v_mfma_f32_16x16x32_bf16 v[114:117], a[12:15], v[98:101], v[114:117]
  v_cvt_pk_bf16_f32 v16, v110, v111
  v_cvt_pk_bf16_f32 v17, v112, v113
  v_mfma_f32_16x16x32_bf16 v[114:117], a[0:3], v[94:97], v[114:117]
  v_mul_f32 v86, v80, v86
  v_mul_f32 v87, v80, v87
  v_mfma_f32_16x16x32_bf16 v[90:93], a[4:7], v[94:97], 0
  v_mul_f32 v88, v80, v88
  v_mul_f32 v89, v80, v89
  v_mfma_f32_16x16x32_bf16 v[90:93], a[16:19], v[98:101], v[90:93]
  v_cvt_pk_bf16_f32 v86, v86, v87
  v_cvt_pk_bf16_f32 v87, v88, v89
  v_mfma_f32_16x16x32_bf16 v[90:93], a[28:31], v[106:109], v[90:93]
  v_cvt_pk_bf16_f32 v112, v114, v115
  v_cvt_pk_bf16_f32 v113, v116, v117
  v_mfma_f32_16x16x32_bf16 v[90:93], a[40:43], v[102:105], v[90:93]
  ds_write_b32 v5, v86 offset:2816
  v_mfma_f32_16x16x32_bf16 v[90:93], a[52:55], v[134:137], v[90:93]
  ds_write_b32 v5, v87 offset:3840
  v_mfma_f32_16x16x32_bf16 v[90:93], a[64:67], v[138:141], v[90:93]
  v_mul_f32 v82, v80, v82
  v_mul_f32 v83, v80, v83
  v_mfma_f32_16x16x32_bf16 v[86:89], a[68:71], v[138:141], 0
  v_mul_f32 v84, v80, v84
  v_mul_f32 v85, v80, v85
  v_mfma_f32_16x16x32_bf16 v[86:89], a[56:59], v[134:137], v[86:89]
  v_cvt_pk_bf16_f32 v82, v82, v83
  v_cvt_pk_bf16_f32 v83, v84, v85
  v_mfma_f32_16x16x32_bf16 v[86:89], a[44:47], v[102:105], v[86:89]
  v_cvt_pk_bf16_f32 v114, v90, v91
  v_cvt_pk_bf16_f32 v115, v92, v93
  v_mfma_f32_16x16x32_bf16 v[86:89], a[32:35], v[106:109], v[86:89]
  ds_write_b32 v5, v82 offset:4864
  v_mfma_f32_16x16x32_bf16 v[86:89], a[20:23], v[98:101], v[86:89]
  ds_write_b32 v5, v83 offset:5888
  v_mfma_f32_16x16x32_bf16 v[86:89], a[8:11], v[94:97], v[86:89]
  v_xor_b32 v5, s41, v5
  v_mfma_f32_16x16x32_bf16 v[122:125], v[94:97], a[72:75], 0
  v_mfma_f32_16x16x32_bf16 v[122:125], v[98:101], a[84:87], v[122:125]
  v_mfma_f32_16x16x32_bf16 v[122:125], v[106:109], a[96:99], v[122:125]
  v_cvt_pk_bf16_f32 v116, v86, v87
  v_cvt_pk_bf16_f32 v117, v88, v89
  v_mfma_f32_16x16x32_bf16 v[122:125], v[102:105], a[108:111], v[122:125]
  v_mfma_f32_16x16x32_bf16 v[122:125], v[134:137], a[120:123], v[122:125]
  v_mfma_f32_16x16x32_bf16 v[122:125], v[138:141], a[132:135], v[122:125]
  v_mfma_f32_16x16x32_bf16 v[118:121], v[138:141], a[136:139], 0
  v_mfma_f32_16x16x32_bf16 v[118:121], v[134:137], a[124:127], v[118:121]
  ds_read_b128 v[78:81], v0 offset:4096
  ds_read_b128 v[82:85], v1 offset:4096
  v_mfma_f32_16x16x32_bf16 v[118:121], v[102:105], a[112:115], v[118:121]
  v_cvt_pk_bf16_f32 v54, v122, v123
  v_cvt_pk_bf16_f32 v55, v124, v125
  v_mfma_f32_16x16x32_bf16 v[118:121], v[106:109], a[100:103], v[118:121]
  ds_read_b128 v[90:93], v0 offset:12288
  ds_read_b128 v[86:89], v1 offset:12288
  v_mfma_f32_16x16x32_bf16 v[118:121], v[98:101], a[88:91], v[118:121]
  v_mfma_f32_16x16x32_bf16 v[118:121], v[94:97], a[76:79], v[118:121]
  ds_read_b128 v[124:127], v0 offset:20480
  ds_read_b128 v[142:145], v1 offset:20480
  v_mfma_f32_16x16x32_bf16 v[128:131], v[94:97], a[80:83], 0
  v_mfma_f32_16x16x32_bf16 v[128:131], v[98:101], a[92:95], v[128:131]
  v_mfma_f32_16x16x32_bf16 v[128:131], v[106:109], a[104:107], v[128:131]
  v_cvt_pk_bf16_f32 v58, v118, v119
  v_cvt_pk_bf16_f32 v59, v120, v121
  v_mfma_f32_16x16x32_bf16 v[128:131], v[102:105], a[116:119], v[128:131]
  v_mfma_f32_16x16x32_bf16 v[128:131], v[134:137], a[128:131], v[128:131]
  v_mfma_f32_16x16x32_bf16 v[128:131], v[138:141], a[140:143], v[128:131]
  s_waitcnt lgkmcnt(0)
  v_mfma_f32_16x16x32_bf16 v[104:107], v[184:187], v[78:81], 0
  v_mfma_f32_16x16x32_bf16 v[104:107], v[196:199], v[82:85], v[104:107]
  v_mfma_f32_16x16x32_bf16 v[104:107], v[208:211], v[90:93], v[104:107]
  v_cvt_pk_bf16_f32 v62, v128, v129
  v_cvt_pk_bf16_f32 v63, v130, v131
  v_mfma_f32_16x16x32_bf16 v[104:107], v[220:223], v[86:89], v[104:107]
  v_mfma_f32_16x16x32_bf16 v[104:107], v[232:235], v[124:127], v[104:107]
  v_mfma_f32_16x16x32_bf16 v[104:107], v[244:247], v[142:145], v[104:107]
  v_mfma_f32_16x16x32_bf16 v[96:99], v[248:251], v[142:145], 0
  v_mfma_f32_16x16x32_bf16 v[96:99], v[236:239], v[124:127], v[96:99]
  v_mfma_f32_16x16x32_bf16 v[96:99], v[224:227], v[86:89], v[96:99]
  v_mul_f32 v104, s42, v104
  v_mul_f32 v105, s42, v105
  v_mfma_f32_16x16x32_bf16 v[96:99], v[212:215], v[90:93], v[96:99]
  v_mul_f32 v106, s42, v106
  v_mul_f32 v107, s42, v107
  v_mfma_f32_16x16x32_bf16 v[96:99], v[200:203], v[82:85], v[96:99]
  v_cvt_pk_bf16_f32 v18, v104, v105
  v_cvt_pk_bf16_f32 v19, v106, v107
  v_mfma_f32_16x16x32_bf16 v[96:99], v[188:191], v[78:81], v[96:99]
  v_mfma_f32_16x16x32_bf16 v[100:103], v[192:195], v[78:81], 0
  v_mfma_f32_16x16x32_bf16 v[100:103], v[204:207], v[82:85], v[100:103]
  v_mfma_f32_16x16x32_bf16 v[100:103], v[216:219], v[90:93], v[100:103]
  v_mul_f32 v96, s42, v96
  v_mul_f32 v97, s42, v97
  v_mfma_f32_16x16x32_bf16 v[100:103], v[228:231], v[86:89], v[100:103]
  v_mul_f32 v98, s42, v98
  v_mul_f32 v99, s42, v99
  v_mfma_f32_16x16x32_bf16 v[100:103], v[240:243], v[124:127], v[100:103]
  v_cvt_pk_bf16_f32 v94, v96, v97
  v_cvt_pk_bf16_f32 v95, v98, v99
  v_mfma_f32_16x16x32_bf16 v[100:103], v[252:255], v[142:145], v[100:103]
  v_mfma_f32_16x16x32_bf16 v[104:107], a[60:63], v[142:145], 0
  v_mfma_f32_16x16x32_bf16 v[104:107], a[48:51], v[124:127], v[104:107]
  v_mfma_f32_16x16x32_bf16 v[104:107], a[36:39], v[86:89], v[104:107]
  v_mul_f32 v100, s42, v100
  v_mul_f32 v101, s42, v101
  v_mfma_f32_16x16x32_bf16 v[104:107], a[24:27], v[90:93], v[104:107]
  v_mul_f32 v102, s42, v102
  v_mul_f32 v103, s42, v103
  v_mfma_f32_16x16x32_bf16 v[104:107], a[12:15], v[82:85], v[104:107]
  v_cvt_pk_bf16_f32 v96, v100, v101
  v_cvt_pk_bf16_f32 v97, v102, v103
  v_mfma_f32_16x16x32_bf16 v[104:107], a[0:3], v[78:81], v[104:107]
  v_mfma_f32_16x16x32_bf16 v[108:111], a[4:7], v[78:81], 0
  v_mfma_f32_16x16x32_bf16 v[108:111], a[16:19], v[82:85], v[108:111]
  v_mfma_f32_16x16x32_bf16 v[108:111], a[28:31], v[90:93], v[108:111]
  v_cvt_pk_bf16_f32 v118, v104, v105
  v_cvt_pk_bf16_f32 v119, v106, v107
  v_mfma_f32_16x16x32_bf16 v[108:111], a[40:43], v[86:89], v[108:111]
  v_mfma_f32_16x16x32_bf16 v[108:111], a[52:55], v[124:127], v[108:111]
  v_mfma_f32_16x16x32_bf16 v[108:111], a[64:67], v[142:145], v[108:111]
  v_mfma_f32_16x16x32_bf16 v[98:101], a[68:71], v[142:145], 0
  v_mfma_f32_16x16x32_bf16 v[98:101], a[56:59], v[124:127], v[98:101]
  v_mfma_f32_16x16x32_bf16 v[98:101], a[44:47], v[86:89], v[98:101]
  v_cvt_pk_bf16_f32 v120, v108, v109
  v_cvt_pk_bf16_f32 v121, v110, v111
  v_mfma_f32_16x16x32_bf16 v[98:101], a[32:35], v[90:93], v[98:101]
  v_mfma_f32_16x16x32_bf16 v[98:101], a[20:23], v[82:85], v[98:101]
  v_mfma_f32_16x16x32_bf16 v[98:101], a[8:11], v[78:81], v[98:101]
  v_mfma_f32_16x16x32_bf16 v[104:107], v[78:81], a[72:75], 0
  v_mfma_f32_16x16x32_bf16 v[104:107], v[82:85], a[84:87], v[104:107]
  v_mfma_f32_16x16x32_bf16 v[104:107], v[90:93], a[96:99], v[104:107]
  v_cvt_pk_bf16_f32 v122, v98, v99
  v_cvt_pk_bf16_f32 v123, v100, v101
  v_mfma_f32_16x16x32_bf16 v[104:107], v[86:89], a[108:111], v[104:107]
  v_mfma_f32_16x16x32_bf16 v[104:107], v[124:127], a[120:123], v[104:107]
  v_mfma_f32_16x16x32_bf16 v[104:107], v[142:145], a[132:135], v[104:107]
  v_mfma_f32_16x16x32_bf16 v[98:101], v[142:145], a[136:139], 0
  v_mfma_f32_16x16x32_bf16 v[98:101], v[124:127], a[124:127], v[98:101]
  ds_read_b128 a[252:255], v0 offset:6144
  ds_read_b128 a[248:251], v1 offset:6144
  v_mfma_f32_16x16x32_bf16 v[98:101], v[86:89], a[112:115], v[98:101]
  v_cvt_pk_bf16_f32 v102, v104, v105
  v_cvt_pk_bf16_f32 v103, v106, v107
  v_mfma_f32_16x16x32_bf16 v[98:101], v[90:93], a[100:103], v[98:101]
  ds_read_b128 v[138:141], v0 offset:14336
  ds_read_b128 v[130:133], v1 offset:14336
  v_mfma_f32_16x16x32_bf16 v[98:101], v[82:85], a[88:91], v[98:101]
  v_mfma_f32_16x16x32_bf16 v[98:101], v[78:81], a[76:79], v[98:101]
  ds_read_b128 v[134:137], v0 offset:22528
  ds_read_b128 a[244:247], v1 offset:22528
  v_mfma_f32_16x16x32_bf16 v[146:149], v[78:81], a[80:83], 0
  v_mfma_f32_16x16x32_bf16 v[146:149], v[82:85], a[92:95], v[146:149]
  v_mfma_f32_16x16x32_bf16 v[146:149], v[90:93], a[104:107], v[146:149]
  v_cvt_pk_bf16_f32 v106, v98, v99
  v_cvt_pk_bf16_f32 v107, v100, v101
  v_mfma_f32_16x16x32_bf16 v[146:149], v[86:89], a[116:119], v[146:149]
  v_mfma_f32_16x16x32_bf16 v[146:149], v[124:127], a[128:131], v[146:149]
  v_mfma_f32_16x16x32_bf16 v[146:149], v[142:145], a[140:143], v[146:149]
  s_waitcnt lgkmcnt(0)
  v_mfma_f32_16x16x32_bf16 v[78:81], a[0:3], a[252:255], 0
  v_add_u32 v0, s28, v2
  v_xor_b32 v1, 64, v0
  v_mfma_f32_16x16x32_bf16 v[78:81], a[12:15], a[248:251], v[78:81]
  v_mfma_f32_16x16x32_bf16 v[78:81], a[24:27], v[138:141], v[78:81]
  v_cvt_pk_bf16_f32 v110, v146, v147
  v_cvt_pk_bf16_f32 v111, v148, v149
  v_mfma_f32_16x16x32_bf16 v[78:81], a[36:39], v[130:133], v[78:81]
  v_mfma_f32_16x16x32_bf16 v[78:81], a[48:51], v[134:137], v[78:81]
  s_waitcnt vmcnt(12)
  s_barrier
  v_mfma_f32_16x16x32_bf16 v[78:81], a[60:63], a[244:247], v[78:81]
  v_mfma_f32_16x16x32_bf16 v[82:85], a[64:67], a[244:247], 0
  v_mfma_f32_16x16x32_bf16 v[82:85], a[52:55], v[134:137], v[82:85]
  v_mfma_f32_16x16x32_bf16 v[82:85], a[40:43], v[130:133], v[82:85]
  v_cvt_pk_bf16_f32 v124, v78, v79
  v_cvt_pk_bf16_f32 v125, v80, v81
  v_mfma_f32_16x16x32_bf16 v[82:85], a[28:31], v[138:141], v[82:85]
  v_mfma_f32_16x16x32_bf16 v[82:85], a[16:19], a[248:251], v[82:85]
  v_mfma_f32_16x16x32_bf16 v[82:85], a[4:7], a[252:255], v[82:85]
  v_mfma_f32_16x16x32_bf16 v[78:81], a[8:11], a[252:255], 0
  v_mfma_f32_16x16x32_bf16 v[78:81], a[20:23], a[248:251], v[78:81]
  v_mfma_f32_16x16x32_bf16 v[78:81], a[32:35], v[138:141], v[78:81]
  v_cvt_pk_bf16_f32 v126, v82, v83
  v_cvt_pk_bf16_f32 v127, v84, v85
  v_mfma_f32_16x16x32_bf16 v[78:81], a[44:47], v[130:133], v[78:81]
  v_mfma_f32_16x16x32_bf16 v[78:81], a[56:59], v[134:137], v[78:81]
  v_mfma_f32_16x16x32_bf16 v[78:81], a[68:71], a[244:247], v[78:81]
  v_mfma_f32_16x16x32_bf16 v[86:89], v[66:69], v[70:73], v[36:39]
  v_mfma_f32_16x16x32_bf16 v[86:89], v[64:67], v[12:15], v[86:89]
  v_mfma_f32_16x16x32_bf16 v[90:93], v[114:117], v[70:73], v[32:35]
  v_cvt_pk_bf16_f32 v128, v78, v79
  v_cvt_pk_bf16_f32 v129, v80, v81
  v_mfma_f32_16x16x32_bf16 v[90:93], v[112:115], v[12:15], v[90:93]
  v_mfma_f32_16x16x32_bf16 v[142:145], v[120:123], v[70:73], v[28:31]
  v_exp_f32 v86, v86
  v_mfma_f32_16x16x32_bf16 v[142:145], v[118:121], v[12:15], v[142:145]
  v_exp_f32 v87, v87
  v_mfma_f32_16x16x32_bf16 v[146:149], v[126:129], v[70:73], v[24:27]
  v_exp_f32 v88, v88
  v_mfma_f32_16x16x32_bf16 v[146:149], v[124:127], v[12:15], v[146:149]
  v_exp_f32 v89, v89
  v_mfma_f32_16x16x32_bf16 v[78:81], v[64:67], v[74:77], v[40:43]
  v_cvt_pk_bf16_f32 v86, v86, v87
  v_cvt_pk_bf16_f32 v87, v88, v89
  v_mfma_f32_16x16x32_bf16 v[78:81], v[66:69], v[14:17], v[78:81]
  v_exp_f32 v90, v90
  v_mfma_f32_16x16x32_bf16 v[82:85], v[112:115], v[74:77], v[36:39]
  v_exp_f32 v91, v91
  v_mfma_f32_16x16x32_bf16 v[82:85], v[114:117], v[14:17], v[82:85]
  v_exp_f32 v92, v92
  v_mfma_f32_16x16x32_bf16 v[98:101], v[118:121], v[74:77], v[32:35]
  v_exp_f32 v93, v93
  v_mfma_f32_16x16x32_bf16 v[98:101], v[120:123], v[14:17], v[98:101]
  v_cvt_pk_bf16_f32 v88, v90, v91
  v_cvt_pk_bf16_f32 v89, v92, v93
  v_mfma_f32_16x16x32_bf16 v[154:157], v[124:127], v[74:77], v[28:31]
  v_exp_f32 v142, v142
  v_mfma_f32_16x16x32_bf16 v[154:157], v[126:129], v[14:17], v[154:157]
  v_exp_f32 v143, v143
  v_mfma_f32_16x16x32_bf16 v[70:73], v[66:69], v[94:97], v[44:47]
  v_exp_f32 v144, v144
  v_mfma_f32_16x16x32_bf16 v[70:73], v[64:67], v[18:21], v[70:73]
  v_exp_f32 v145, v145
  v_mfma_f32_16x16x32_bf16 v[74:77], v[114:117], v[94:97], v[40:43]
  v_cvt_pk_bf16_f32 v90, v142, v143
  v_cvt_pk_bf16_f32 v91, v144, v145
  v_mfma_f32_16x16x32_bf16 v[74:77], v[112:115], v[18:21], v[74:77]
  v_exp_f32 v146, v146
  v_mfma_f32_16x16x32_bf16 v[150:153], v[120:123], v[94:97], v[36:39]
  v_exp_f32 v147, v147
  v_mfma_f32_16x16x32_bf16 v[150:153], v[118:121], v[18:21], v[150:153]
  v_exp_f32 v148, v148
  v_mfma_f32_16x16x32_bf16 v[142:145], v[126:129], v[94:97], v[32:35]
  v_exp_f32 v149, v149
  v_mfma_f32_16x16x32_bf16 v[142:145], v[124:127], v[18:21], v[142:145]
  v_cvt_pk_bf16_f32 v92, v146, v147
  v_cvt_pk_bf16_f32 v93, v148, v149
  v_mfma_f32_16x16x32_bf16 v[160:163], v[244:247], a[244:247], 0
  v_exp_f32 v78, v78
  v_mfma_f32_16x16x32_bf16 v[160:163], v[232:235], v[134:137], v[160:163]
  v_exp_f32 v79, v79
  v_mfma_f32_16x16x32_bf16 v[160:163], v[220:223], v[130:133], v[160:163]
  v_exp_f32 v80, v80
  v_mfma_f32_16x16x32_bf16 v[160:163], v[208:211], v[138:141], v[160:163]
  v_exp_f32 v81, v81
  v_mfma_f32_16x16x32_bf16 v[160:163], v[196:199], a[248:251], v[160:163]
  v_cvt_pk_bf16_f32 v78, v78, v79
  v_cvt_pk_bf16_f32 v79, v80, v81
  v_mfma_f32_16x16x32_bf16 v[160:163], v[184:187], a[252:255], v[160:163]
  v_exp_f32 v82, v82
  v_mfma_f32_16x16x32_bf16 v[94:97], v[188:191], a[252:255], 0
  v_exp_f32 v83, v83
  v_mfma_f32_16x16x32_bf16 v[94:97], v[200:203], a[248:251], v[94:97]
  v_exp_f32 v84, v84
  v_mfma_f32_16x16x32_bf16 v[94:97], v[212:215], v[138:141], v[94:97]
  v_mul_f32 v160, s42, v160
  v_mul_f32 v161, s42, v161
  v_mfma_f32_16x16x32_bf16 v[94:97], v[224:227], v[130:133], v[94:97]
  v_mul_f32 v162, s42, v162
  v_mul_f32 v163, s42, v163
  v_mfma_f32_16x16x32_bf16 v[94:97], v[236:239], v[134:137], v[94:97]
  v_cvt_pk_bf16_f32 v158, v160, v161
  v_cvt_pk_bf16_f32 v159, v162, v163
  v_mfma_f32_16x16x32_bf16 v[94:97], v[248:251], a[244:247], v[94:97]
  v_exp_f32 v85, v85
  v_mfma_f32_16x16x32_bf16 v[146:149], v[252:255], a[244:247], 0
  v_cvt_pk_bf16_f32 v80, v82, v83
  v_cvt_pk_bf16_f32 v81, v84, v85
  v_mfma_f32_16x16x32_bf16 v[146:149], v[240:243], v[134:137], v[146:149]
  v_exp_f32 v98, v98
  v_mfma_f32_16x16x32_bf16 v[146:149], v[228:231], v[130:133], v[146:149]
  v_mul_f32 v94, s42, v94
  v_mul_f32 v95, s42, v95
  v_mfma_f32_16x16x32_bf16 v[146:149], v[216:219], v[138:141], v[146:149]
  v_mul_f32 v96, s42, v96
  v_mul_f32 v97, s42, v97
  v_mfma_f32_16x16x32_bf16 v[146:149], v[204:207], a[248:251], v[146:149]
  v_cvt_pk_bf16_f32 v160, v94, v95
  v_cvt_pk_bf16_f32 v161, v96, v97
  v_mfma_f32_16x16x32_bf16 v[146:149], v[192:195], a[252:255], v[146:149]
  v_exp_f32 v99, v99
  v_mfma_f32_16x16x32_bf16 v[162:165], a[252:255], a[72:75], 0
  v_exp_f32 v100, v100
  v_mfma_f32_16x16x32_bf16 v[162:165], a[248:251], a[84:87], v[162:165]
  v_exp_f32 v101, v101
  v_mfma_f32_16x16x32_bf16 v[162:165], v[138:141], a[96:99], v[162:165]
  v_mul_f32 v146, s42, v146
  v_mul_f32 v147, s42, v147
  v_mfma_f32_16x16x32_bf16 v[162:165], v[130:133], a[108:111], v[162:165]
  v_mul_f32 v148, s42, v148
  v_mul_f32 v149, s42, v149
  v_mfma_f32_16x16x32_bf16 v[162:165], v[134:137], a[120:123], v[162:165]
  v_cvt_pk_bf16_f32 v22, v146, v147
  v_cvt_pk_bf16_f32 v23, v148, v149
  v_mfma_f32_16x16x32_bf16 v[162:165], a[244:247], a[132:135], v[162:165]
  v_cvt_pk_bf16_f32 v82, v98, v99
  v_cvt_pk_bf16_f32 v83, v100, v101
  v_mfma_f32_16x16x32_bf16 v[94:97], v[64:67], v[158:161], v[48:51]
  v_exp_f32 v154, v154
  v_mfma_f32_16x16x32_bf16 v[94:97], v[66:69], v[20:23], v[94:97]
  v_exp_f32 v155, v155
  v_mfma_f32_16x16x32_bf16 v[98:101], v[112:115], v[158:161], v[44:47]
  v_cvt_pk_bf16_f32 v104, v162, v163
  v_cvt_pk_bf16_f32 v105, v164, v165
  v_mfma_f32_16x16x32_bf16 v[98:101], v[114:117], v[20:23], v[98:101]
  v_exp_f32 v156, v156
  v_mfma_f32_16x16x32_bf16 v[146:149], v[118:121], v[158:161], v[40:43]
  v_exp_f32 v157, v157
  v_mfma_f32_16x16x32_bf16 v[146:149], v[120:123], v[20:23], v[146:149]
  v_cvt_pk_bf16_f32 v84, v154, v155
  v_cvt_pk_bf16_f32 v85, v156, v157
  v_mfma_f32_16x16x32_bf16 v[64:67], v[124:127], v[158:161], v[36:39]
  v_exp_f32 v70, v70
  v_mfma_f32_16x16x32_bf16 v[64:67], v[126:129], v[20:23], v[64:67]
  v_exp_f32 v71, v71
  v_mfma_f32_16x16x32_bf16 v[162:165], a[244:247], a[136:139], 0
  v_exp_f32 v72, v72
  v_mfma_f32_16x16x32_bf16 v[162:165], v[134:137], a[124:127], v[162:165]
  ds_read_b128 v[114:117], v3 offset:0
  ds_read_b128 v[118:121], v3 offset:4096
  v_mfma_f32_16x16x32_bf16 v[162:165], v[130:133], a[112:115], v[162:165]
  v_exp_f32 v73, v73
  v_mfma_f32_16x16x32_bf16 v[162:165], v[138:141], a[100:103], v[162:165]
  ds_read_b128 v[122:125], v3 offset:8192
  ds_read_b128 v[126:129], v3 offset:12288
  v_mfma_f32_16x16x32_bf16 v[162:165], a[248:251], a[88:91], v[162:165]
  v_cvt_pk_bf16_f32 v70, v70, v71
  v_cvt_pk_bf16_f32 v71, v72, v73
  v_mfma_f32_16x16x32_bf16 v[162:165], a[252:255], a[76:79], v[162:165]
  ds_read_b128 v[154:157], v3 offset:16384
  ds_read_b128 v[158:161], v3 offset:20480
  v_mfma_f32_16x16x32_bf16 v[170:173], a[252:255], a[80:83], 0
  v_exp_f32 v74, v74
  v_mfma_f32_16x16x32_bf16 v[170:173], a[248:251], a[92:95], v[170:173]
  v_exp_f32 v75, v75
  v_mfma_f32_16x16x32_bf16 v[170:173], v[138:141], a[104:107], v[170:173]
  v_cvt_pk_bf16_f32 v108, v162, v163
  v_cvt_pk_bf16_f32 v109, v164, v165
  v_mfma_f32_16x16x32_bf16 v[170:173], v[130:133], a[116:119], v[170:173]
  s_cmp_lt_u32 s31, 106954752
  v_exp_f32 v76, v76
  v_mfma_f32_16x16x32_bf16 v[170:173], v[134:137], a[128:131], v[170:173]
  s_waitcnt lgkmcnt(0)
  v_exp_f32 v77, v77
  v_mfma_f32_16x16x32_bf16 v[170:173], a[244:247], a[140:143], v[170:173]
  s_cbranch_scc1 L_loop
L_epi:
  v_mfma_f32_16x16x32_bf16 v[134:137], a[144:147], v[114:117], 0
  v_cvt_pk_bf16_f32 v72, v74, v75
  v_cvt_pk_bf16_f32 v73, v76, v77
  v_mfma_f32_16x16x32_bf16 v[134:137], a[160:163], v[118:121], v[134:137]
  v_exp_f32 v150, v150
  v_mfma_f32_16x16x32_bf16 v[134:137], a[176:179], v[122:125], v[134:137]
  v_cvt_pk_bf16_f32 v112, v170, v171
  v_cvt_pk_bf16_f32 v113, v172, v173
  v_mfma_f32_16x16x32_bf16 v[134:137], a[192:195], v[126:129], v[134:137]
  v_exp_f32 v151, v151
  v_mfma_f32_16x16x32_bf16 v[134:137], a[208:211], v[154:157], v[134:137]
  v_exp_f32 v152, v152
  v_mfma_f32_16x16x32_bf16 v[134:137], a[224:227], v[158:161], v[134:137]
  v_exp_f32 v153, v153
  v_mfma_f32_16x16x32_bf16 v[138:141], a[228:231], v[158:161], 0
  v_cvt_pk_bf16_f32 v74, v150, v151
  v_cvt_pk_bf16_f32 v75, v152, v153
  v_mfma_f32_16x16x32_bf16 v[138:141], a[212:215], v[154:157], v[138:141]
  v_exp_f32 v142, v142
  v_mfma_f32_16x16x32_bf16 v[138:141], a[196:199], v[126:129], v[138:141]
  v_cvt_pk_bf16_f32 v134, v134, v135
  v_cvt_pk_bf16_f32 v135, v136, v137
  v_mfma_f32_16x16x32_bf16 v[138:141], a[180:183], v[122:125], v[138:141]
  v_exp_f32 v143, v143
  v_mfma_f32_16x16x32_bf16 v[138:141], a[164:167], v[118:121], v[138:141]
  v_exp_f32 v144, v144
  v_mfma_f32_16x16x32_bf16 v[138:141], a[148:151], v[114:117], v[138:141]
  v_exp_f32 v145, v145
  v_mfma_f32_16x16x32_bf16 v[130:133], a[152:155], v[114:117], 0
  v_cvt_pk_bf16_f32 v76, v142, v143
  v_cvt_pk_bf16_f32 v77, v144, v145
  v_mfma_f32_16x16x32_bf16 v[130:133], a[168:171], v[118:121], v[130:133]
  ds_read_b128 a[244:247], v4 offset:0
  ds_read_b128 a[248:251], v4 offset:4096
  v_mfma_f32_16x16x32_bf16 v[130:133], a[184:187], v[122:125], v[130:133]
  v_cvt_pk_bf16_f32 v136, v138, v139
  v_cvt_pk_bf16_f32 v137, v140, v141
  v_mfma_f32_16x16x32_bf16 v[130:133], a[200:203], v[126:129], v[130:133]
  buffer_store_dwordx4 v[134:137], v7, s[24:27], s33 offen nt
  v_exp_f32 v94, v94
  v_mfma_f32_16x16x32_bf16 v[130:133], a[216:219], v[154:157], v[130:133]
  v_exp_f32 v95, v95
  v_mfma_f32_16x16x32_bf16 v[130:133], a[232:235], v[158:161], v[130:133]
  ds_read_b128 a[252:255], v4 offset:8192
  ds_read_b128 v[134:137], v4 offset:12288
  v_mfma_f32_16x16x32_bf16 v[150:153], a[236:239], v[158:161], 0
  v_exp_f32 v96, v96
  v_mfma_f32_16x16x32_bf16 v[150:153], a[220:223], v[154:157], v[150:153]
  ds_read_b128 v[138:141], v4 offset:16384
  ds_read_b128 v[142:145], v4 offset:20480
  v_mfma_f32_16x16x32_bf16 v[150:153], a[204:207], v[126:129], v[150:153]
  v_cvt_pk_bf16_f32 v130, v130, v131
  v_cvt_pk_bf16_f32 v131, v132, v133
  v_mfma_f32_16x16x32_bf16 v[150:153], a[188:191], v[122:125], v[150:153]
  v_exp_f32 v97, v97
  v_mfma_f32_16x16x32_bf16 v[150:153], a[172:175], v[118:121], v[150:153]
  v_cvt_pk_bf16_f32 v94, v94, v95
  v_cvt_pk_bf16_f32 v95, v96, v97
  v_mfma_f32_16x16x32_bf16 v[150:153], a[156:159], v[114:117], v[150:153]
  s_waitcnt lgkmcnt(0)
  v_exp_f32 v98, v98
  v_mfma_f32_16x16x32_bf16 v[118:121], a[144:147], a[244:247], 0
  v_exp_f32 v99, v99
  v_mfma_f32_16x16x32_bf16 v[118:121], a[160:163], a[248:251], v[118:121]
  v_exp_f32 v100, v100
  v_mfma_f32_16x16x32_bf16 v[118:121], a[176:179], a[252:255], v[118:121]
  v_cvt_pk_bf16_f32 v132, v150, v151
  v_cvt_pk_bf16_f32 v133, v152, v153
  v_mfma_f32_16x16x32_bf16 v[118:121], a[192:195], v[134:137], v[118:121]
  buffer_store_dwordx4 v[130:133], v8, s[24:27], s33 offen nt
  v_exp_f32 v101, v101
  v_mfma_f32_16x16x32_bf16 v[118:121], a[208:211], v[138:141], v[118:121]
  s_add_u32 s33, s33, s43
  v_cvt_pk_bf16_f32 v96, v98, v99
  v_cvt_pk_bf16_f32 v97, v100, v101
  v_mfma_f32_16x16x32_bf16 v[118:121], a[224:227], v[142:145], v[118:121]
  v_exp_f32 v146, v146
  v_mfma_f32_16x16x32_bf16 v[114:117], a[228:231], v[142:145], 0
  v_exp_f32 v147, v147
  v_mfma_f32_16x16x32_bf16 v[114:117], a[212:215], v[138:141], v[114:117]
  v_exp_f32 v148, v148
  v_mfma_f32_16x16x32_bf16 v[114:117], a[196:199], v[134:137], v[114:117]
  v_cvt_pk_bf16_f32 v118, v118, v119
  v_cvt_pk_bf16_f32 v119, v120, v121
  v_mfma_f32_16x16x32_bf16 v[114:117], a[180:183], a[252:255], v[114:117]
  v_mov_b64 v[130:131], 0
  v_mfma_f32_16x16x32_bf16 v[114:117], a[164:167], a[248:251], v[114:117]
  v_exp_f32 v149, v149
  v_mfma_f32_16x16x32_bf16 v[114:117], a[148:151], a[244:247], v[114:117]
  v_cvt_pk_bf16_f32 v98, v146, v147
  v_cvt_pk_bf16_f32 v99, v148, v149
  v_smfmac_f32_16x16x64_bf16 v[130:133], a[240:243], v[86:93], v10
  v_exp_f32 v64, v64
  v_mfma_f32_16x16x32_bf16 v[134:137], v[102:105], v[90:93], 0
  v_exp_f32 v65, v65
  v_mfma_f32_16x16x32_bf16 v[134:137], v[52:55], v[86:89], v[134:137]
  v_cvt_pk_bf16_f32 v120, v114, v115
  v_cvt_pk_bf16_f32 v121, v116, v117
  v_mfma_f32_16x16x32_bf16 v[146:149], v[56:59], v[86:89], 0
  buffer_store_dwordx4 v[118:121], v7, s[24:27], s34 offen nt
  v_exp_f32 v66, v66
  v_mfma_f32_16x16x32_bf16 v[146:149], v[106:109], v[90:93], v[146:149]
  s_add_u32 s34, s34, s43
  v_mov_b64 v[114:115], 0
  v_mfma_f32_16x16x32_bf16 v[138:141], v[110:113], v[90:93], 0
  v_exp_f32 v67, v67
  v_mfma_f32_16x16x32_bf16 v[138:141], v[60:63], v[86:89], v[138:141]
  v_cvt_pk_bf16_f32 v100, v64, v65
  v_cvt_pk_bf16_f32 v101, v66, v67
  v_smfmac_f32_16x16x64_bf16 v[114:117], a[240:243], v[78:85], v10
  v_add_f32 v130, v130, v131
  v_mfma_f32_16x16x32_bf16 v[126:129], v[102:105], v[82:85], 0
  v_rcp_f32 v132, v130
  v_mfma_f32_16x16x32_bf16 v[126:129], v[52:55], v[78:81], v[126:129]
  v_max3_f32 v9, v130, v132, v9
  v_mul_f32 v134, v132, v134
  v_mfma_f32_16x16x32_bf16 v[122:125], v[56:59], v[78:81], 0
  v_mul_f32 v135, v132, v135
  v_mul_f32 v136, v132, v136
  v_mfma_f32_16x16x32_bf16 v[122:125], v[106:109], v[82:85], v[122:125]
  v_mov_b64 v[86:87], 0
  v_mul_f32 v137, v132, v137
  v_mfma_f32_16x16x32_bf16 v[118:121], v[110:113], v[82:85], 0
  v_cvt_pk_bf16_f32 v134, v134, v135
  v_cvt_pk_bf16_f32 v135, v136, v137
  v_mfma_f32_16x16x32_bf16 v[118:121], v[60:63], v[78:81], v[118:121]
  ds_write_b32 v5, v134 offset:0
  v_smfmac_f32_16x16x64_bf16 v[86:89], a[240:243], v[70:77], v10
  ds_write_b32 v5, v135 offset:1024
  v_mfma_f32_16x16x32_bf16 v[90:93], v[102:105], v[74:77], 0
  v_mul_f32 v146, v132, v146
  v_mul_f32 v147, v132, v147
  v_mfma_f32_16x16x32_bf16 v[90:93], v[52:55], v[70:73], v[90:93]
  v_mul_f32 v148, v132, v148
  v_mul_f32 v149, v132, v149
  v_mfma_f32_16x16x32_bf16 v[82:85], v[56:59], v[70:73], 0
  v_cvt_pk_bf16_f32 v146, v146, v147
  v_cvt_pk_bf16_f32 v147, v148, v149
  v_mfma_f32_16x16x32_bf16 v[82:85], v[106:109], v[74:77], v[82:85]
  v_mov_b64 v[64:65], 0
  v_mfma_f32_16x16x32_bf16 v[78:81], v[110:113], v[74:77], 0
  ds_read_b128 a[244:247], v3 offset:512
  ds_read_b128 a[248:251], v3 offset:4608
  v_mfma_f32_16x16x32_bf16 v[78:81], v[60:63], v[70:73], v[78:81]
  ds_write_b32 v5, v146 offset:2048
  v_smfmac_f32_16x16x64_bf16 v[64:67], a[240:243], v[94:101], v10
  ds_read_b128 a[252:255], v3 offset:8704
  ds_read_b128 v[134:137], v3 offset:12800
  v_mfma_f32_16x16x32_bf16 v[72:75], v[102:105], v[98:101], 0
  ds_write_b32 v5, v147 offset:3072
  v_mfma_f32_16x16x32_bf16 v[72:75], v[52:55], v[94:97], v[72:75]
  ds_read_b128 v[142:145], v3 offset:16896
  ds_read_b128 v[102:105], v3 offset:20992
  v_mfma_f32_16x16x32_bf16 v[68:71], v[56:59], v[94:97], 0
  v_mul_f32 v138, v132, v138
  v_mul_f32 v139, v132, v139
  v_mfma_f32_16x16x32_bf16 v[68:71], v[106:109], v[98:101], v[68:71]
  v_mul_f32 v140, v132, v140
  v_mul_f32 v141, v132, v141
  v_mfma_f32_16x16x32_bf16 v[52:55], v[110:113], v[98:101], 0
  v_cvt_pk_bf16_f32 v138, v138, v139
  v_cvt_pk_bf16_f32 v139, v140, v141
  v_mfma_f32_16x16x32_bf16 v[52:55], v[60:63], v[94:97], v[52:55]
  s_waitcnt lgkmcnt(0)
  ds_write_b32 v5, v138 offset:4096
  v_mfma_f32_16x16x32_bf16 v[98:101], a[144:147], a[244:247], 0
  ds_write_b32 v5, v139 offset:5120
  v_mfma_f32_16x16x32_bf16 v[98:101], a[160:163], a[248:251], v[98:101]
  v_add_f32 v114, v114, v115
  v_mfma_f32_16x16x32_bf16 v[98:101], a[176:179], a[252:255], v[98:101]
  v_rcp_f32 v116, v114
  v_mfma_f32_16x16x32_bf16 v[98:101], a[192:195], v[134:137], v[98:101]
  v_max3_f32 v9, v114, v116, v9
  v_mul_f32 v126, v116, v126
  v_mfma_f32_16x16x32_bf16 v[98:101], a[208:211], v[142:145], v[98:101]
  v_mul_f32 v127, v116, v127
  v_mul_f32 v128, v116, v128
  v_mfma_f32_16x16x32_bf16 v[98:101], a[224:227], v[102:105], v[98:101]
  v_mul_f32 v129, v116, v129
  v_cvt_pk_bf16_f32 v126, v126, v127
  v_mfma_f32_16x16x32_bf16 v[94:97], a[228:231], v[102:105], 0
  v_cvt_pk_bf16_f32 v127, v128, v129
  v_mfma_f32_16x16x32_bf16 v[94:97], a[212:215], v[142:145], v[94:97]
  ds_write_b32 v5, v126 offset:256
  v_mfma_f32_16x16x32_bf16 v[94:97], a[196:199], v[134:137], v[94:97]
  v_cvt_pk_bf16_f32 v98, v98, v99
  v_cvt_pk_bf16_f32 v99, v100, v101
  v_mfma_f32_16x16x32_bf16 v[94:97], a[180:183], a[252:255], v[94:97]
  ds_write_b32 v5, v127 offset:1280
  v_mfma_f32_16x16x32_bf16 v[94:97], a[164:167], a[248:251], v[94:97]
  v_mul_f32 v122, v116, v122
  v_mul_f32 v123, v116, v123
  v_mfma_f32_16x16x32_bf16 v[94:97], a[148:151], a[244:247], v[94:97]
  v_mul_f32 v124, v116, v124
  v_mul_f32 v125, v116, v125
  v_mfma_f32_16x16x32_bf16 v[60:63], a[152:155], a[244:247], 0
  v_cvt_pk_bf16_f32 v122, v122, v123
  v_cvt_pk_bf16_f32 v123, v124, v125
  v_mfma_f32_16x16x32_bf16 v[60:63], a[168:171], a[248:251], v[60:63]
  ds_read_b128 v[56:59], v4 offset:512
  ds_read_b128 v[106:109], v4 offset:4608
  v_mfma_f32_16x16x32_bf16 v[60:63], a[184:187], a[252:255], v[60:63]
  v_cvt_pk_bf16_f32 v100, v94, v95
  v_cvt_pk_bf16_f32 v101, v96, v97
  v_mfma_f32_16x16x32_bf16 v[60:63], a[200:203], v[134:137], v[60:63]
  buffer_store_dwordx4 v[98:101], v7, s[24:27], s35 offen nt
  v_mfma_f32_16x16x32_bf16 v[60:63], a[216:219], v[142:145], v[60:63]
  ds_write_b32 v5, v122 offset:2304
  v_mfma_f32_16x16x32_bf16 v[60:63], a[232:235], v[102:105], v[60:63]
  ds_read_b128 v[110:113], v4 offset:8704
  ds_read_b128 v[98:101], v4 offset:12800
  v_mfma_f32_16x16x32_bf16 v[130:133], a[236:239], v[102:105], 0
  ds_write_b32 v5, v123 offset:3328
  v_mfma_f32_16x16x32_bf16 v[130:133], a[220:223], v[142:145], v[130:133]
  ds_read_b128 v[126:129], v4 offset:16896
  ds_read_b128 v[94:97], v4 offset:20992
  v_mfma_f32_16x16x32_bf16 v[130:133], a[204:207], v[134:137], v[130:133]
  v_cvt_pk_bf16_f32 v60, v60, v61
  v_cvt_pk_bf16_f32 v61, v62, v63
  v_mfma_f32_16x16x32_bf16 v[130:133], a[188:191], a[252:255], v[130:133]
  v_xor_b32 v3, 40960, v3
  v_xor_b32 v4, 40960, v4
  v_mfma_f32_16x16x32_bf16 v[130:133], a[172:175], a[248:251], v[130:133]
  v_mul_f32 v118, v116, v118
  v_mul_f32 v119, v116, v119
  v_mfma_f32_16x16x32_bf16 v[130:133], a[156:159], a[244:247], v[130:133]
  s_waitcnt lgkmcnt(0)
  v_mul_f32 v120, v116, v120
  v_mul_f32 v121, v116, v121
  v_mfma_f32_16x16x32_bf16 v[122:125], a[144:147], v[56:59], 0
  v_cvt_pk_bf16_f32 v118, v118, v119
  v_cvt_pk_bf16_f32 v119, v120, v121
  v_mfma_f32_16x16x32_bf16 v[122:125], a[160:163], v[106:109], v[122:125]
  ds_write_b32 v5, v118 offset:4352
  v_mfma_f32_16x16x32_bf16 v[122:125], a[176:179], v[110:113], v[122:125]
  v_cvt_pk_bf16_f32 v62, v130, v131
  v_cvt_pk_bf16_f32 v63, v132, v133
  v_mfma_f32_16x16x32_bf16 v[122:125], a[192:195], v[98:101], v[122:125]
  buffer_store_dwordx4 v[60:63], v8, s[24:27], s35 offen nt
  v_mfma_f32_16x16x32_bf16 v[122:125], a[208:211], v[126:129], v[122:125]
  s_add_u32 s35, s35, s43
  ds_write_b32 v5, v119 offset:5376
  v_mfma_f32_16x16x32_bf16 v[122:125], a[224:227], v[94:97], v[122:125]
  s_waitcnt lgkmcnt(0)
  s_barrier
  v_mfma_f32_16x16x32_bf16 v[114:117], a[228:231], v[94:97], 0
  ds_read_b128 a[244:247], v3 offset:0
  ds_read_b128 a[252:255], v3 offset:4096
  v_mfma_f32_16x16x32_bf16 v[114:117], a[212:215], v[126:129], v[114:117]
  ds_read_b128 v[60:63], v3 offset:8192
  ds_read_b128 v[94:97], v3 offset:12288
  v_mfma_f32_16x16x32_bf16 v[114:117], a[196:199], v[98:101], v[114:117]
  v_cvt_pk_bf16_f32 v122, v122, v123
  v_cvt_pk_bf16_f32 v123, v124, v125
  v_mfma_f32_16x16x32_bf16 v[114:117], a[180:183], v[110:113], v[114:117]
  ds_read_b128 v[98:101], v3 offset:16384
  ds_read_b128 v[102:105], v3 offset:20480
  v_mfma_f32_16x16x32_bf16 v[114:117], a[164:167], v[106:109], v[114:117]
  v_add_f32 v86, v86, v87
  v_mfma_f32_16x16x32_bf16 v[114:117], a[148:151], v[56:59], v[114:117]
  s_waitcnt lgkmcnt(0)
  v_rcp_f32 v88, v86
  v_mfma_f32_16x16x32_bf16 v[106:109], a[144:147], a[244:247], 0
  v_max3_f32 v9, v86, v88, v9
  v_mul_f32 v90, v88, v90
  v_mfma_f32_16x16x32_bf16 v[106:109], a[160:163], a[252:255], v[106:109]
  v_mul_f32 v91, v88, v91
  v_mul_f32 v92, v88, v92
  v_mfma_f32_16x16x32_bf16 v[106:109], a[176:179], v[60:63], v[106:109]
  v_cvt_pk_bf16_f32 v124, v114, v115
  v_cvt_pk_bf16_f32 v125, v116, v117
  v_mfma_f32_16x16x32_bf16 v[106:109], a[192:195], v[94:97], v[106:109]
  buffer_store_dwordx4 v[122:125], v7, s[24:27], s36 offen nt
  v_mul_f32 v93, v88, v93
  v_cvt_pk_bf16_f32 v90, v90, v91
  v_mfma_f32_16x16x32_bf16 v[106:109], a[208:211], v[98:101], v[106:109]
  s_add_u32 s36, s36, s43
  v_cvt_pk_bf16_f32 v91, v92, v93
  v_mfma_f32_16x16x32_bf16 v[106:109], a[224:227], v[102:105], v[106:109]
  ds_write_b32 v5, v90 offset:512
  v_mfma_f32_16x16x32_bf16 v[56:59], a[228:231], v[102:105], 0
  ds_write_b32 v5, v91 offset:1536
  v_mfma_f32_16x16x32_bf16 v[56:59], a[212:215], v[98:101], v[56:59]
  v_mul_f32 v82, v88, v82
  v_mul_f32 v83, v88, v83
  v_mfma_f32_16x16x32_bf16 v[56:59], a[196:199], v[94:97], v[56:59]
  v_cvt_pk_bf16_f32 v106, v106, v107
  v_cvt_pk_bf16_f32 v107, v108, v109
  v_mfma_f32_16x16x32_bf16 v[56:59], a[180:183], v[60:63], v[56:59]
  v_mul_f32 v84, v88, v84
  v_mul_f32 v85, v88, v85
  v_mfma_f32_16x16x32_bf16 v[56:59], a[164:167], a[252:255], v[56:59]
  v_cvt_pk_bf16_f32 v82, v82, v83
  v_cvt_pk_bf16_f32 v83, v84, v85
  v_mfma_f32_16x16x32_bf16 v[56:59], a[148:151], a[244:247], v[56:59]
  ds_write_b32 v5, v82 offset:2560
  v_mfma_f32_16x16x32_bf16 v[110:113], a[152:155], a[244:247], 0
  ds_write_b32 v5, v83 offset:3584
  v_mfma_f32_16x16x32_bf16 v[110:113], a[168:171], a[252:255], v[110:113]
  v_mul_f32 v78, v88, v78
  v_mul_f32 v79, v88, v79
  v_mfma_f32_16x16x32_bf16 v[110:113], a[184:187], v[60:63], v[110:113]
  v_cvt_pk_bf16_f32 v108, v56, v57
  v_cvt_pk_bf16_f32 v109, v58, v59
  v_mfma_f32_16x16x32_bf16 v[110:113], a[200:203], v[94:97], v[110:113]
  buffer_store_dwordx4 v[106:109], v7, s[24:27], s33 offen nt
  v_mul_f32 v80, v88, v80
  v_mul_f32 v81, v88, v81
  v_mfma_f32_16x16x32_bf16 v[110:113], a[216:219], v[98:101], v[110:113]
  v_cvt_pk_bf16_f32 v78, v78, v79
  v_cvt_pk_bf16_f32 v79, v80, v81
  v_mfma_f32_16x16x32_bf16 v[110:113], a[232:235], v[102:105], v[110:113]
  ds_read_b128 a[248:251], v4 offset:0
  ds_read_b128 v[56:59], v4 offset:4096
  v_mfma_f32_16x16x32_bf16 v[106:109], a[236:239], v[102:105], 0
  ds_read_b128 v[80:83], v4 offset:8192
  ds_read_b128 v[84:87], v4 offset:12288
  v_mfma_f32_16x16x32_bf16 v[106:109], a[220:223], v[98:101], v[106:109]
  ds_read_b128 v[88:91], v4 offset:16384
  ds_read_b128 v[102:105], v4 offset:20480
  v_mfma_f32_16x16x32_bf16 v[106:109], a[204:207], v[94:97], v[106:109]
  v_cvt_pk_bf16_f32 v110, v110, v111
  v_cvt_pk_bf16_f32 v111, v112, v113
  v_mfma_f32_16x16x32_bf16 v[106:109], a[188:191], v[60:63], v[106:109]
  ds_write_b32 v5, v78 offset:4608
  v_mfma_f32_16x16x32_bf16 v[106:109], a[172:175], a[252:255], v[106:109]
  ds_write_b32 v5, v79 offset:5632
  v_mfma_f32_16x16x32_bf16 v[106:109], a[156:159], a[244:247], v[106:109]
  s_waitcnt lgkmcnt(2)
  v_add_f32 v64, v64, v65
  v_mfma_f32_16x16x32_bf16 v[60:63], a[144:147], a[248:251], 0
  v_rcp_f32 v66, v64
  v_mfma_f32_16x16x32_bf16 v[60:63], a[160:163], v[56:59], v[60:63]
  v_max3_f32 v9, v64, v66, v9
  v_mul_f32 v72, v66, v72
  v_mfma_f32_16x16x32_bf16 v[60:63], a[176:179], v[80:83], v[60:63]
  v_cvt_pk_bf16_f32 v112, v106, v107
  v_cvt_pk_bf16_f32 v113, v108, v109
  v_mfma_f32_16x16x32_bf16 v[60:63], a[192:195], v[84:87], v[60:63]
  buffer_store_dwordx4 v[110:113], v8, s[24:27], s33 offen nt
  v_mul_f32 v73, v66, v73
  v_mul_f32 v74, v66, v74
  v_mul_f32 v75, v66, v75
  v_cvt_pk_bf16_f32 v72, v72, v73
  v_cvt_pk_bf16_f32 v73, v74, v75
  ds_write_b32 v5, v72 offset:768
  ds_write_b32 v5, v73 offset:1792
  v_mul_f32 v68, v66, v68
  v_mul_f32 v69, v66, v69
  v_mul_f32 v70, v66, v70
  v_mul_f32 v71, v66, v71
  v_cvt_pk_bf16_f32 v68, v68, v69
  v_cvt_pk_bf16_f32 v69, v70, v71
  ds_write_b32 v5, v68 offset:2816
  ds_write_b32 v5, v69 offset:3840
  v_mul_f32 v52, v66, v52
  v_mul_f32 v53, v66, v53
  v_mul_f32 v54, v66, v54
  v_mul_f32 v55, v66, v55
  v_cvt_pk_bf16_f32 v52, v52, v53
  v_cvt_pk_bf16_f32 v53, v54, v55
  ds_write_b32 v5, v52 offset:4864
  ds_write_b32 v5, v53 offset:5888
  v_cmp_nge_f32 vcc, 0x53800000, v9
  s_lshl_b32 s5, s3, 2
  s_add_u32 s5, s5, 155648
  v_mov_b32 v11, s5
  s_nop 0
  s_cmp_lg_u64 vcc, 0
  s_cselect_b32 s5, 1, 0
  v_mov_b32 v52, s5
  ds_write_b32 v11, v52
  v_mov_b32 v11, 155648
  v_mfma_f32_16x16x32_bf16 v[60:63], a[208:211], v[88:91], v[60:63]
  s_waitcnt lgkmcnt(0)
  s_barrier
  v_mfma_f32_16x16x32_bf16 v[60:63], a[224:227], v[102:105], v[60:63]
  ds_read_b128 a[244:247], v3 offset:512
  ds_read_b128 a[252:255], v3 offset:4608
  v_mfma_f32_16x16x32_bf16 v[92:95], a[228:231], v[102:105], 0
  ds_read_b128 v[52:55], v3 offset:8704
  ds_read_b128 v[68:71], v3 offset:12800
  v_mfma_f32_16x16x32_bf16 v[92:95], a[212:215], v[88:91], v[92:95]
  ds_read_b128 v[72:75], v3 offset:16896
  ds_read_b128 v[76:79], v3 offset:20992
  v_mfma_f32_16x16x32_bf16 v[92:95], a[196:199], v[84:87], v[92:95]
  v_cvt_pk_bf16_f32 v60, v60, v61
  v_cvt_pk_bf16_f32 v61, v62, v63
  v_mfma_f32_16x16x32_bf16 v[92:95], a[180:183], v[80:83], v[92:95]
  ds_read_b128 v[64:67], v11
  s_waitcnt lgkmcnt(0)
  v_mfma_f32_16x16x32_bf16 v[92:95], a[164:167], v[56:59], v[92:95]
  v_mfma_f32_16x16x32_bf16 v[92:95], a[148:151], a[248:251], v[92:95]
  v_mfma_f32_16x16x32_bf16 v[80:83], a[144:147], a[244:247], 0
  v_mfma_f32_16x16x32_bf16 v[80:83], a[160:163], a[252:255], v[80:83]
  v_mfma_f32_16x16x32_bf16 v[80:83], a[176:179], v[52:55], v[80:83]
  v_cvt_pk_bf16_f32 v62, v92, v93
  v_cvt_pk_bf16_f32 v63, v94, v95
  v_mfma_f32_16x16x32_bf16 v[80:83], a[192:195], v[68:71], v[80:83]
  buffer_store_dwordx4 v[60:63], v7, s[24:27], s34 offen nt
  v_mfma_f32_16x16x32_bf16 v[80:83], a[208:211], v[72:75], v[80:83]
  v_mfma_f32_16x16x32_bf16 v[80:83], a[224:227], v[76:79], v[80:83]
  v_mfma_f32_16x16x32_bf16 v[84:87], a[228:231], v[76:79], 0
  v_mfma_f32_16x16x32_bf16 v[84:87], a[212:215], v[72:75], v[84:87]
  v_mfma_f32_16x16x32_bf16 v[84:87], a[196:199], v[68:71], v[84:87]
  v_cvt_pk_bf16_f32 v80, v80, v81
  v_cvt_pk_bf16_f32 v81, v82, v83
  v_mfma_f32_16x16x32_bf16 v[84:87], a[180:183], v[52:55], v[84:87]
  v_mfma_f32_16x16x32_bf16 v[84:87], a[164:167], a[252:255], v[84:87]
  v_mfma_f32_16x16x32_bf16 v[84:87], a[148:151], a[244:247], v[84:87]
  v_mfma_f32_16x16x32_bf16 v[56:59], a[152:155], a[244:247], 0
  v_mfma_f32_16x16x32_bf16 v[56:59], a[168:171], a[252:255], v[56:59]
  v_mfma_f32_16x16x32_bf16 v[56:59], a[184:187], v[52:55], v[56:59]
  v_cvt_pk_bf16_f32 v82, v84, v85
  v_cvt_pk_bf16_f32 v83, v86, v87
  v_mfma_f32_16x16x32_bf16 v[56:59], a[200:203], v[68:71], v[56:59]
  buffer_store_dwordx4 v[80:83], v7, s[24:27], s35 offen nt
  v_mfma_f32_16x16x32_bf16 v[56:59], a[216:219], v[72:75], v[56:59]
  v_mfma_f32_16x16x32_bf16 v[56:59], a[232:235], v[76:79], v[56:59]
  ds_read_b128 a[248:251], v4 offset:512
  ds_read_b128 v[60:63], v4 offset:4608
  v_mfma_f32_16x16x32_bf16 v[92:95], a[236:239], v[76:79], 0
  ds_read_b128 v[80:83], v4 offset:8704
  ds_read_b128 v[84:87], v4 offset:12800
  v_mfma_f32_16x16x32_bf16 v[92:95], a[220:223], v[72:75], v[92:95]
  ds_read_b128 v[76:79], v4 offset:16896
  ds_read_b128 v[88:91], v4 offset:20992
  v_mfma_f32_16x16x32_bf16 v[92:95], a[204:207], v[68:71], v[92:95]
  v_cvt_pk_bf16_f32 v56, v56, v57
  v_cvt_pk_bf16_f32 v57, v58, v59
  v_mfma_f32_16x16x32_bf16 v[92:95], a[188:191], v[52:55], v[92:95]
  v_mfma_f32_16x16x32_bf16 v[92:95], a[172:175], a[252:255], v[92:95]
  v_mfma_f32_16x16x32_bf16 v[92:95], a[156:159], a[244:247], v[92:95]
  s_waitcnt lgkmcnt(0)
  v_mfma_f32_16x16x32_bf16 v[52:55], a[144:147], a[248:251], 0
  v_or3_b32 v64, v64, v65, v66
  v_or_b32 v64, v64, v67
  v_mfma_f32_16x16x32_bf16 v[52:55], a[160:163], v[60:63], v[52:55]
  v_readfirstlane_b32 s49, v64
  v_mfma_f32_16x16x32_bf16 v[52:55], a[176:179], v[80:83], v[52:55]
  v_cvt_pk_bf16_f32 v58, v92, v93
  v_cvt_pk_bf16_f32 v59, v94, v95
  v_mfma_f32_16x16x32_bf16 v[52:55], a[192:195], v[84:87], v[52:55]
  buffer_store_dwordx4 v[56:59], v8, s[24:27], s35 offen nt
  v_mfma_f32_16x16x32_bf16 v[52:55], a[208:211], v[76:79], v[52:55]
  v_mfma_f32_16x16x32_bf16 v[52:55], a[224:227], v[88:91], v[52:55]
  v_mfma_f32_16x16x32_bf16 v[64:67], a[228:231], v[88:91], 0
  v_mfma_f32_16x16x32_bf16 v[64:67], a[212:215], v[76:79], v[64:67]
  v_mfma_f32_16x16x32_bf16 v[64:67], a[196:199], v[84:87], v[64:67]
  v_cvt_pk_bf16_f32 v52, v52, v53
  v_cvt_pk_bf16_f32 v53, v54, v55
  v_mfma_f32_16x16x32_bf16 v[64:67], a[180:183], v[80:83], v[64:67]
  v_mfma_f32_16x16x32_bf16 v[64:67], a[164:167], v[60:63], v[64:67]
  v_mfma_f32_16x16x32_bf16 v[64:67], a[148:151], a[248:251], v[64:67]
  s_nop 7
  v_cvt_pk_bf16_f32 v54, v64, v65
  v_cvt_pk_bf16_f32 v55, v66, v67
  buffer_store_dwordx4 v[52:55], v7, s[24:27], s36 offen nt
  s_cmp_lg_u32 s49, 0
  s_cbranch_scc1 L_safe
L_fin:
L_end:
  s_endpgm
L_safe:
  s_nop 15
  s_waitcnt vmcnt(0) lgkmcnt(0)
  s_mov_b32 s10, 100663296
  v_mbcnt_lo_u32_b32 v52, -1, 0
  v_mbcnt_hi_u32_b32 v52, -1, v52
  v_lshrrev_b32 v54, 2, v52
  v_and_b32 v54, 4, v54
  v_xor_b32 v53, v54, v52
  s_cmp_eq_u32 s47, 63
  s_cselect_b32 s5, 4, 0
  v_and_b32 v53, s5, v53
  v_cmp_eq_u32 vcc, 0, v53
  s_cmp_eq_u32 s48, 3
  s_cselect_b32 s5, 0xc31044fe, 0
  v_mov_b32 v11, s5
  v_mov_b32 v52, 0xc31044fe
  v_cndmask_b32 v11, 0, v11, vcc
  v_cndmask_b32 v52, v52, 0, vcc
  v_add_u32 v0, s46, v2
  v_xor_b32 v1, 64, v0
  s_add_u32 s56, s56, 480
  s_nop 7
L_sloop:
  s_barrier
  s_add_u32 s5, s56, 4
  s_and_b32 s5, s5, 511
  s_mul_i32 s31, s5, s57
  s_add_u32 s5, s56, 8
  s_and_b32 s5, s5, 511
  s_mul_i32 s32, s5, s57
  s_xor_b32 s5, s4, 0
  s_lshl_b32 s5, s5, 1
  s_add_u32 s5, s5, s56
  s_sub_u32 s5, s5, s3
  s_add_u32 s5, s5, 4
  s_and_b32 s5, s5, 511
  s_mul_i32 s33, s5, s57
  s_xor_b32 s5, s4, 1
  s_lshl_b32 s5, s5, 1
  s_add_u32 s5, s5, s56
  s_sub_u32 s5, s5, s3
  s_add_u32 s5, s5, 4
  s_and_b32 s5, s5, 511
  s_mul_i32 s34, s5, s57
  s_xor_b32 s5, s4, 2
  s_lshl_b32 s5, s5, 1
  s_add_u32 s5, s5, s56
  s_sub_u32 s5, s5, s3
  s_add_u32 s5, s5, 4
  s_and_b32 s5, s5, 511
  s_mul_i32 s35, s5, s57
  s_xor_b32 s5, s4, 3
  s_lshl_b32 s5, s5, 1
  s_add_u32 s5, s5, s56
  s_sub_u32 s5, s5, s3
  s_add_u32 s5, s5, 4
  s_and_b32 s5, s5, 511
  s_mul_i32 s36, s5, s57
  s_add_u32 m0, s46, 0
  s_nop 0
  buffer_load_dwordx4 v6, s[8:11], s31 offen offset:0 nt lds
  s_add_u32 m0, s46, 8064
  s_nop 0
  buffer_load_dwordx4 v6, s[8:11], s31 offen offset:128 nt lds
  s_add_u32 m0, s46, 16128
  s_nop 0
  buffer_load_dwordx4 v6, s[8:11], s31 offen offset:256 nt lds
  s_add_u32 m0, s46, 4096
  s_nop 0
  buffer_load_dwordx4 v6, s[8:11], s32 offen offset:0 nt lds
  s_add_u32 m0, s46, 12160
  s_nop 0
  buffer_load_dwordx4 v6, s[8:11], s32 offen offset:128 nt lds
  s_add_u32 m0, s46, 20224
  s_nop 0
  buffer_load_dwordx4 v6, s[8:11], s32 offen offset:256 nt lds
  s_waitcnt vmcnt(0)
  s_barrier
  ds_read_b128 a[244:247], v0 offset:0
  ds_read_b128 a[248:251], v1 offset:0
  ds_read_b128 a[252:255], v0 offset:8192
  ds_read_b128 v[60:63], v1 offset:8192
  ds_read_b128 v[68:71], v0 offset:16384
  ds_read_b128 v[72:75], v1 offset:16384
  s_waitcnt lgkmcnt(5)
  v_mfma_f32_16x16x32_bf16 v[64:67], v[184:187], a[244:247], 0
  s_waitcnt lgkmcnt(4)
  v_mfma_f32_16x16x32_bf16 v[64:67], v[196:199], a[248:251], v[64:67]
  s_waitcnt lgkmcnt(3)
  v_mfma_f32_16x16x32_bf16 v[64:67], v[208:211], a[252:255], v[64:67]
  s_waitcnt lgkmcnt(2)
  v_mfma_f32_16x16x32_bf16 v[64:67], v[220:223], v[60:63], v[64:67]
  s_waitcnt lgkmcnt(1)
  v_mfma_f32_16x16x32_bf16 v[64:67], v[232:235], v[68:71], v[64:67]
  s_waitcnt lgkmcnt(0)
  v_mfma_f32_16x16x32_bf16 v[64:67], v[244:247], v[72:75], v[64:67]
  v_mfma_f32_16x16x32_bf16 v[52:55], v[188:191], a[244:247], 0
  v_mfma_f32_16x16x32_bf16 v[52:55], v[200:203], a[248:251], v[52:55]
  v_mfma_f32_16x16x32_bf16 v[52:55], v[212:215], a[252:255], v[52:55]
  v_mfma_f32_16x16x32_bf16 v[52:55], v[224:227], v[60:63], v[52:55]
  v_mfma_f32_16x16x32_bf16 v[52:55], v[236:239], v[68:71], v[52:55]
  v_mfma_f32_16x16x32_bf16 v[52:55], v[248:251], v[72:75], v[52:55]
  v_mul_f32 v64, s42, v64
  v_mul_f32 v65, s42, v65
  v_mul_f32 v66, s42, v66
  v_mul_f32 v67, s42, v67
  v_cvt_pk_bf16_f32 v12, v64, v65
  v_cvt_pk_bf16_f32 v13, v66, v67
  v_mfma_f32_16x16x32_bf16 v[56:59], v[192:195], a[244:247], 0
  v_mfma_f32_16x16x32_bf16 v[56:59], v[204:207], a[248:251], v[56:59]
  v_mfma_f32_16x16x32_bf16 v[56:59], v[216:219], a[252:255], v[56:59]
  v_mfma_f32_16x16x32_bf16 v[56:59], v[228:231], v[60:63], v[56:59]
  v_mfma_f32_16x16x32_bf16 v[56:59], v[240:243], v[68:71], v[56:59]
  v_mfma_f32_16x16x32_bf16 v[56:59], v[252:255], v[72:75], v[56:59]
  v_mul_f32 v52, s42, v52
  v_mul_f32 v53, s42, v53
  v_mul_f32 v54, s42, v54
  v_mul_f32 v55, s42, v55
  v_cvt_pk_bf16_f32 v112, v52, v53
  v_cvt_pk_bf16_f32 v113, v54, v55
  v_mfma_f32_16x16x32_bf16 v[64:67], a[0:3], a[244:247], 0
  v_mfma_f32_16x16x32_bf16 v[64:67], a[12:15], a[248:251], v[64:67]
  v_mfma_f32_16x16x32_bf16 v[64:67], a[24:27], a[252:255], v[64:67]
  v_mfma_f32_16x16x32_bf16 v[64:67], a[36:39], v[60:63], v[64:67]
  v_mfma_f32_16x16x32_bf16 v[64:67], a[48:51], v[68:71], v[64:67]
  v_mfma_f32_16x16x32_bf16 v[64:67], a[60:63], v[72:75], v[64:67]
  v_mul_f32 v56, s42, v56
  v_mul_f32 v57, s42, v57
  v_mul_f32 v58, s42, v58
  v_mul_f32 v59, s42, v59
  v_cvt_pk_bf16_f32 v114, v56, v57
  v_cvt_pk_bf16_f32 v115, v58, v59
  v_mfma_f32_16x16x32_bf16 v[76:79], a[4:7], a[244:247], 0
  v_mfma_f32_16x16x32_bf16 v[76:79], a[16:19], a[248:251], v[76:79]
  v_mfma_f32_16x16x32_bf16 v[76:79], a[28:31], a[252:255], v[76:79]
  v_mfma_f32_16x16x32_bf16 v[76:79], a[40:43], v[60:63], v[76:79]
  v_mfma_f32_16x16x32_bf16 v[76:79], a[52:55], v[68:71], v[76:79]
  v_mfma_f32_16x16x32_bf16 v[76:79], a[64:67], v[72:75], v[76:79]
  v_cvt_pk_bf16_f32 v52, v64, v65
  v_cvt_pk_bf16_f32 v53, v66, v67
  v_mfma_f32_16x16x32_bf16 v[80:83], a[8:11], a[244:247], 0
  v_mfma_f32_16x16x32_bf16 v[80:83], a[20:23], a[248:251], v[80:83]
  v_mfma_f32_16x16x32_bf16 v[80:83], a[32:35], a[252:255], v[80:83]
  v_mfma_f32_16x16x32_bf16 v[80:83], a[44:47], v[60:63], v[80:83]
  v_mfma_f32_16x16x32_bf16 v[80:83], a[56:59], v[68:71], v[80:83]
  v_mfma_f32_16x16x32_bf16 v[80:83], a[68:71], v[72:75], v[80:83]
  v_cvt_pk_bf16_f32 v54, v76, v77
  v_cvt_pk_bf16_f32 v55, v78, v79
  v_mfma_f32_16x16x32_bf16 v[64:67], a[244:247], a[72:75], 0
  v_mfma_f32_16x16x32_bf16 v[64:67], a[248:251], a[84:87], v[64:67]
  v_mfma_f32_16x16x32_bf16 v[64:67], a[252:255], a[96:99], v[64:67]
  v_mfma_f32_16x16x32_bf16 v[64:67], v[60:63], a[108:111], v[64:67]
  v_mfma_f32_16x16x32_bf16 v[64:67], v[68:71], a[120:123], v[64:67]
  v_mfma_f32_16x16x32_bf16 v[64:67], v[72:75], a[132:135], v[64:67]
  v_cvt_pk_bf16_f32 v56, v80, v81
  v_cvt_pk_bf16_f32 v57, v82, v83
  v_mfma_f32_16x16x32_bf16 v[76:79], a[244:247], a[76:79], 0
  v_mfma_f32_16x16x32_bf16 v[76:79], a[248:251], a[88:91], v[76:79]
  v_mfma_f32_16x16x32_bf16 v[76:79], a[252:255], a[100:103], v[76:79]
  v_mfma_f32_16x16x32_bf16 v[76:79], v[60:63], a[112:115], v[76:79]
  v_mfma_f32_16x16x32_bf16 v[76:79], v[68:71], a[124:127], v[76:79]
  v_mfma_f32_16x16x32_bf16 v[76:79], v[72:75], a[136:139], v[76:79]
  v_cvt_pk_bf16_f32 v58, v64, v65
  v_cvt_pk_bf16_f32 v59, v66, v67
  v_mfma_f32_16x16x32_bf16 v[92:95], a[244:247], a[80:83], 0
  v_mfma_f32_16x16x32_bf16 v[92:95], a[248:251], a[92:95], v[92:95]
  v_mfma_f32_16x16x32_bf16 v[92:95], a[252:255], a[104:107], v[92:95]
  v_mfma_f32_16x16x32_bf16 v[92:95], v[60:63], a[116:119], v[92:95]
  v_mfma_f32_16x16x32_bf16 v[92:95], v[68:71], a[128:131], v[92:95]
  v_mfma_f32_16x16x32_bf16 v[92:95], v[72:75], a[140:143], v[92:95]
  v_cvt_pk_bf16_f32 v66, v76, v77
  v_cvt_pk_bf16_f32 v67, v78, v79
  s_nop 5
  v_cvt_pk_bf16_f32 v62, v92, v93
  v_cvt_pk_bf16_f32 v63, v94, v95
  ds_read_b128 a[244:247], v0 offset:2048
  ds_read_b128 a[248:251], v1 offset:2048
  ds_read_b128 a[252:255], v0 offset:10240
  ds_read_b128 v[76:79], v1 offset:10240
  ds_read_b128 v[80:83], v0 offset:18432
  ds_read_b128 v[84:87], v1 offset:18432
  s_waitcnt lgkmcnt(5)
  v_mfma_f32_16x16x32_bf16 v[88:91], v[184:187], a[244:247], 0
  s_waitcnt lgkmcnt(4)
  v_mfma_f32_16x16x32_bf16 v[88:91], v[196:199], a[248:251], v[88:91]
  s_waitcnt lgkmcnt(3)
  v_mfma_f32_16x16x32_bf16 v[88:91], v[208:211], a[252:255], v[88:91]
  s_waitcnt lgkmcnt(2)
  v_mfma_f32_16x16x32_bf16 v[88:91], v[220:223], v[76:79], v[88:91]
  s_waitcnt lgkmcnt(1)
  v_mfma_f32_16x16x32_bf16 v[88:91], v[232:235], v[80:83], v[88:91]
  s_waitcnt lgkmcnt(0)
  v_mfma_f32_16x16x32_bf16 v[88:91], v[244:247], v[84:87], v[88:91]
  v_mfma_f32_16x16x32_bf16 v[68:71], v[188:191], a[244:247], 0
  v_mfma_f32_16x16x32_bf16 v[68:71], v[200:203], a[248:251], v[68:71]
  v_mfma_f32_16x16x32_bf16 v[68:71], v[212:215], a[252:255], v[68:71]
  v_mfma_f32_16x16x32_bf16 v[68:71], v[224:227], v[76:79], v[68:71]
  v_mfma_f32_16x16x32_bf16 v[68:71], v[236:239], v[80:83], v[68:71]
  v_mfma_f32_16x16x32_bf16 v[68:71], v[248:251], v[84:87], v[68:71]
  v_mul_f32 v88, s42, v88
  v_mul_f32 v89, s42, v89
  v_mul_f32 v90, s42, v90
  v_mul_f32 v91, s42, v91
  v_cvt_pk_bf16_f32 v108, v88, v89
  v_cvt_pk_bf16_f32 v109, v90, v91
  v_mfma_f32_16x16x32_bf16 v[72:75], v[192:195], a[244:247], 0
  v_mfma_f32_16x16x32_bf16 v[72:75], v[204:207], a[248:251], v[72:75]
  v_mfma_f32_16x16x32_bf16 v[72:75], v[216:219], a[252:255], v[72:75]
  v_mfma_f32_16x16x32_bf16 v[72:75], v[228:231], v[76:79], v[72:75]
  v_mfma_f32_16x16x32_bf16 v[72:75], v[240:243], v[80:83], v[72:75]
  v_mfma_f32_16x16x32_bf16 v[72:75], v[252:255], v[84:87], v[72:75]
  v_mul_f32 v68, s42, v68
  v_mul_f32 v69, s42, v69
  v_mul_f32 v70, s42, v70
  v_mul_f32 v71, s42, v71
  v_cvt_pk_bf16_f32 v110, v68, v69
  v_cvt_pk_bf16_f32 v111, v70, v71
  v_mfma_f32_16x16x32_bf16 v[88:91], a[0:3], a[244:247], 0
  v_mfma_f32_16x16x32_bf16 v[88:91], a[12:15], a[248:251], v[88:91]
  v_mfma_f32_16x16x32_bf16 v[88:91], a[24:27], a[252:255], v[88:91]
  v_mfma_f32_16x16x32_bf16 v[88:91], a[36:39], v[76:79], v[88:91]
  v_mfma_f32_16x16x32_bf16 v[88:91], a[48:51], v[80:83], v[88:91]
  v_mfma_f32_16x16x32_bf16 v[88:91], a[60:63], v[84:87], v[88:91]
  v_mul_f32 v72, s42, v72
  v_mul_f32 v73, s42, v73
  v_mul_f32 v74, s42, v74
  v_mul_f32 v75, s42, v75
  v_cvt_pk_bf16_f32 v16, v72, v73
  v_cvt_pk_bf16_f32 v17, v74, v75
  v_mfma_f32_16x16x32_bf16 v[92:95], a[4:7], a[244:247], 0
  v_mfma_f32_16x16x32_bf16 v[92:95], a[16:19], a[248:251], v[92:95]
  v_mfma_f32_16x16x32_bf16 v[92:95], a[28:31], a[252:255], v[92:95]
  v_mfma_f32_16x16x32_bf16 v[92:95], a[40:43], v[76:79], v[92:95]
  v_mfma_f32_16x16x32_bf16 v[92:95], a[52:55], v[80:83], v[92:95]
  v_mfma_f32_16x16x32_bf16 v[92:95], a[64:67], v[84:87], v[92:95]
  v_cvt_pk_bf16_f32 v70, v88, v89
  v_cvt_pk_bf16_f32 v71, v90, v91
  v_mfma_f32_16x16x32_bf16 v[96:99], a[8:11], a[244:247], 0
  v_mfma_f32_16x16x32_bf16 v[96:99], a[20:23], a[248:251], v[96:99]
  v_mfma_f32_16x16x32_bf16 v[96:99], a[32:35], a[252:255], v[96:99]
  v_mfma_f32_16x16x32_bf16 v[96:99], a[44:47], v[76:79], v[96:99]
  v_mfma_f32_16x16x32_bf16 v[96:99], a[56:59], v[80:83], v[96:99]
  v_mfma_f32_16x16x32_bf16 v[96:99], a[68:71], v[84:87], v[96:99]
  v_cvt_pk_bf16_f32 v72, v92, v93
  v_cvt_pk_bf16_f32 v73, v94, v95
  v_mfma_f32_16x16x32_bf16 v[88:91], a[244:247], a[72:75], 0
  v_mfma_f32_16x16x32_bf16 v[88:91], a[248:251], a[84:87], v[88:91]
  v_mfma_f32_16x16x32_bf16 v[88:91], a[252:255], a[96:99], v[88:91]
  v_mfma_f32_16x16x32_bf16 v[88:91], v[76:79], a[108:111], v[88:91]
  v_mfma_f32_16x16x32_bf16 v[88:91], v[80:83], a[120:123], v[88:91]
  v_mfma_f32_16x16x32_bf16 v[88:91], v[84:87], a[132:135], v[88:91]
  v_cvt_pk_bf16_f32 v74, v96, v97
  v_cvt_pk_bf16_f32 v75, v98, v99
  v_mfma_f32_16x16x32_bf16 v[92:95], a[244:247], a[76:79], 0
  v_mfma_f32_16x16x32_bf16 v[92:95], a[248:251], a[88:91], v[92:95]
  v_mfma_f32_16x16x32_bf16 v[92:95], a[252:255], a[100:103], v[92:95]
  v_mfma_f32_16x16x32_bf16 v[92:95], v[76:79], a[112:115], v[92:95]
  v_mfma_f32_16x16x32_bf16 v[92:95], v[80:83], a[124:127], v[92:95]
  v_mfma_f32_16x16x32_bf16 v[92:95], v[84:87], a[136:139], v[92:95]
  v_cvt_pk_bf16_f32 v60, v88, v89
  v_cvt_pk_bf16_f32 v61, v90, v91
  v_mfma_f32_16x16x32_bf16 v[100:103], a[244:247], a[80:83], 0
  v_mfma_f32_16x16x32_bf16 v[100:103], a[248:251], a[92:95], v[100:103]
  v_mfma_f32_16x16x32_bf16 v[100:103], a[252:255], a[104:107], v[100:103]
  v_mfma_f32_16x16x32_bf16 v[100:103], v[76:79], a[116:119], v[100:103]
  v_mfma_f32_16x16x32_bf16 v[100:103], v[80:83], a[128:131], v[100:103]
  v_mfma_f32_16x16x32_bf16 v[100:103], v[84:87], a[140:143], v[100:103]
  v_cvt_pk_bf16_f32 v68, v92, v93
  v_cvt_pk_bf16_f32 v69, v94, v95
  s_nop 5
  v_cvt_pk_bf16_f32 v64, v100, v101
  v_cvt_pk_bf16_f32 v65, v102, v103
  ds_read_b128 a[244:247], v0 offset:4096
  ds_read_b128 a[248:251], v1 offset:4096
  ds_read_b128 a[252:255], v0 offset:12288
  ds_read_b128 v[88:91], v1 offset:12288
  ds_read_b128 v[92:95], v0 offset:20480
  ds_read_b128 v[96:99], v1 offset:20480
  s_waitcnt lgkmcnt(5)
  v_mfma_f32_16x16x32_bf16 v[84:87], v[184:187], a[244:247], 0
  s_waitcnt lgkmcnt(4)
  v_mfma_f32_16x16x32_bf16 v[84:87], v[196:199], a[248:251], v[84:87]
  s_waitcnt lgkmcnt(3)
  v_mfma_f32_16x16x32_bf16 v[84:87], v[208:211], a[252:255], v[84:87]
  s_waitcnt lgkmcnt(2)
  v_mfma_f32_16x16x32_bf16 v[84:87], v[220:223], v[88:91], v[84:87]
  s_waitcnt lgkmcnt(1)
  v_mfma_f32_16x16x32_bf16 v[84:87], v[232:235], v[92:95], v[84:87]
  s_waitcnt lgkmcnt(0)
  v_mfma_f32_16x16x32_bf16 v[84:87], v[244:247], v[96:99], v[84:87]
  v_mfma_f32_16x16x32_bf16 v[76:79], v[188:191], a[244:247], 0
  v_mfma_f32_16x16x32_bf16 v[76:79], v[200:203], a[248:251], v[76:79]
  v_mfma_f32_16x16x32_bf16 v[76:79], v[212:215], a[252:255], v[76:79]
  v_mfma_f32_16x16x32_bf16 v[76:79], v[224:227], v[88:91], v[76:79]
  v_mfma_f32_16x16x32_bf16 v[76:79], v[236:239], v[92:95], v[76:79]
  v_mfma_f32_16x16x32_bf16 v[76:79], v[248:251], v[96:99], v[76:79]
  v_mul_f32 v84, s42, v84
  v_mul_f32 v85, s42, v85
  v_mul_f32 v86, s42, v86
  v_mul_f32 v87, s42, v87
  v_cvt_pk_bf16_f32 v18, v84, v85
  v_cvt_pk_bf16_f32 v19, v86, v87
  v_mfma_f32_16x16x32_bf16 v[80:83], v[192:195], a[244:247], 0
  v_mfma_f32_16x16x32_bf16 v[80:83], v[204:207], a[248:251], v[80:83]
  v_mfma_f32_16x16x32_bf16 v[80:83], v[216:219], a[252:255], v[80:83]
  v_mfma_f32_16x16x32_bf16 v[80:83], v[228:231], v[88:91], v[80:83]
  v_mfma_f32_16x16x32_bf16 v[80:83], v[240:243], v[92:95], v[80:83]
  v_mfma_f32_16x16x32_bf16 v[80:83], v[252:255], v[96:99], v[80:83]
  v_mul_f32 v76, s42, v76
  v_mul_f32 v77, s42, v77
  v_mul_f32 v78, s42, v78
  v_mul_f32 v79, s42, v79
  v_cvt_pk_bf16_f32 v104, v76, v77
  v_cvt_pk_bf16_f32 v105, v78, v79
  v_mfma_f32_16x16x32_bf16 v[84:87], a[0:3], a[244:247], 0
  v_mfma_f32_16x16x32_bf16 v[84:87], a[12:15], a[248:251], v[84:87]
  v_mfma_f32_16x16x32_bf16 v[84:87], a[24:27], a[252:255], v[84:87]
  v_mfma_f32_16x16x32_bf16 v[84:87], a[36:39], v[88:91], v[84:87]
  v_mfma_f32_16x16x32_bf16 v[84:87], a[48:51], v[92:95], v[84:87]
  v_mfma_f32_16x16x32_bf16 v[84:87], a[60:63], v[96:99], v[84:87]
  v_mul_f32 v80, s42, v80
  v_mul_f32 v81, s42, v81
  v_mul_f32 v82, s42, v82
  v_mul_f32 v83, s42, v83
  v_cvt_pk_bf16_f32 v106, v80, v81
  v_cvt_pk_bf16_f32 v107, v82, v83
  v_mfma_f32_16x16x32_bf16 v[100:103], a[4:7], a[244:247], 0
  v_mfma_f32_16x16x32_bf16 v[100:103], a[16:19], a[248:251], v[100:103]
  v_mfma_f32_16x16x32_bf16 v[100:103], a[28:31], a[252:255], v[100:103]
  v_mfma_f32_16x16x32_bf16 v[100:103], a[40:43], v[88:91], v[100:103]
  v_mfma_f32_16x16x32_bf16 v[100:103], a[52:55], v[92:95], v[100:103]
  v_mfma_f32_16x16x32_bf16 v[100:103], a[64:67], v[96:99], v[100:103]
  v_cvt_pk_bf16_f32 v76, v84, v85
  v_cvt_pk_bf16_f32 v77, v86, v87
  v_mfma_f32_16x16x32_bf16 v[116:119], a[8:11], a[244:247], 0
  v_mfma_f32_16x16x32_bf16 v[116:119], a[20:23], a[248:251], v[116:119]
  v_mfma_f32_16x16x32_bf16 v[116:119], a[32:35], a[252:255], v[116:119]
  v_mfma_f32_16x16x32_bf16 v[116:119], a[44:47], v[88:91], v[116:119]
  v_mfma_f32_16x16x32_bf16 v[116:119], a[56:59], v[92:95], v[116:119]
  v_mfma_f32_16x16x32_bf16 v[116:119], a[68:71], v[96:99], v[116:119]
  v_cvt_pk_bf16_f32 v78, v100, v101
  v_cvt_pk_bf16_f32 v79, v102, v103
  v_mfma_f32_16x16x32_bf16 v[84:87], a[244:247], a[72:75], 0
  v_mfma_f32_16x16x32_bf16 v[84:87], a[248:251], a[84:87], v[84:87]
  v_mfma_f32_16x16x32_bf16 v[84:87], a[252:255], a[96:99], v[84:87]
  v_mfma_f32_16x16x32_bf16 v[84:87], v[88:91], a[108:111], v[84:87]
  v_mfma_f32_16x16x32_bf16 v[84:87], v[92:95], a[120:123], v[84:87]
  v_mfma_f32_16x16x32_bf16 v[84:87], v[96:99], a[132:135], v[84:87]
  v_cvt_pk_bf16_f32 v80, v116, v117
  v_cvt_pk_bf16_f32 v81, v118, v119
  v_mfma_f32_16x16x32_bf16 v[100:103], a[244:247], a[76:79], 0
  v_mfma_f32_16x16x32_bf16 v[100:103], a[248:251], a[88:91], v[100:103]
  v_mfma_f32_16x16x32_bf16 v[100:103], a[252:255], a[100:103], v[100:103]
  v_mfma_f32_16x16x32_bf16 v[100:103], v[88:91], a[112:115], v[100:103]
  v_mfma_f32_16x16x32_bf16 v[100:103], v[92:95], a[124:127], v[100:103]
  v_mfma_f32_16x16x32_bf16 v[100:103], v[96:99], a[136:139], v[100:103]
  v_cvt_pk_bf16_f32 v82, v84, v85
  v_cvt_pk_bf16_f32 v83, v86, v87
  v_mfma_f32_16x16x32_bf16 v[132:135], a[244:247], a[80:83], 0
  v_mfma_f32_16x16x32_bf16 v[132:135], a[248:251], a[92:95], v[132:135]
  v_mfma_f32_16x16x32_bf16 v[132:135], a[252:255], a[104:107], v[132:135]
  v_mfma_f32_16x16x32_bf16 v[132:135], v[88:91], a[116:119], v[132:135]
  v_mfma_f32_16x16x32_bf16 v[132:135], v[92:95], a[128:131], v[132:135]
  v_mfma_f32_16x16x32_bf16 v[132:135], v[96:99], a[140:143], v[132:135]
  v_cvt_pk_bf16_f32 v86, v100, v101
  v_cvt_pk_bf16_f32 v87, v102, v103
  s_nop 5
  v_cvt_pk_bf16_f32 v90, v132, v133
  v_cvt_pk_bf16_f32 v91, v134, v135
  ds_read_b128 a[244:247], v0 offset:6144
  ds_read_b128 a[248:251], v1 offset:6144
  ds_read_b128 a[252:255], v0 offset:14336
  ds_read_b128 v[116:119], v1 offset:14336
  ds_read_b128 v[120:123], v0 offset:22528
  ds_read_b128 v[124:127], v1 offset:22528
  s_waitcnt lgkmcnt(5)
  v_mfma_f32_16x16x32_bf16 v[128:131], v[184:187], a[244:247], 0
  s_waitcnt lgkmcnt(4)
  v_mfma_f32_16x16x32_bf16 v[128:131], v[196:199], a[248:251], v[128:131]
  s_waitcnt lgkmcnt(3)
  v_mfma_f32_16x16x32_bf16 v[128:131], v[208:211], a[252:255], v[128:131]
  s_waitcnt lgkmcnt(2)
  v_mfma_f32_16x16x32_bf16 v[128:131], v[220:223], v[116:119], v[128:131]
  s_waitcnt lgkmcnt(1)
  v_mfma_f32_16x16x32_bf16 v[128:131], v[232:235], v[120:123], v[128:131]
  s_waitcnt lgkmcnt(0)
  v_mfma_f32_16x16x32_bf16 v[128:131], v[244:247], v[124:127], v[128:131]
  v_mfma_f32_16x16x32_bf16 v[92:95], v[188:191], a[244:247], 0
  v_mfma_f32_16x16x32_bf16 v[92:95], v[200:203], a[248:251], v[92:95]
  v_mfma_f32_16x16x32_bf16 v[92:95], v[212:215], a[252:255], v[92:95]
  v_mfma_f32_16x16x32_bf16 v[92:95], v[224:227], v[116:119], v[92:95]
  v_mfma_f32_16x16x32_bf16 v[92:95], v[236:239], v[120:123], v[92:95]
  v_mfma_f32_16x16x32_bf16 v[92:95], v[248:251], v[124:127], v[92:95]
  v_mul_f32 v128, s42, v128
  v_mul_f32 v129, s42, v129
  v_mul_f32 v130, s42, v130
  v_mul_f32 v131, s42, v131
  v_cvt_pk_bf16_f32 v100, v128, v129
  v_cvt_pk_bf16_f32 v101, v130, v131
  v_mfma_f32_16x16x32_bf16 v[96:99], v[192:195], a[244:247], 0
  v_mfma_f32_16x16x32_bf16 v[96:99], v[204:207], a[248:251], v[96:99]
  v_mfma_f32_16x16x32_bf16 v[96:99], v[216:219], a[252:255], v[96:99]
  v_mfma_f32_16x16x32_bf16 v[96:99], v[228:231], v[116:119], v[96:99]
  v_mfma_f32_16x16x32_bf16 v[96:99], v[240:243], v[120:123], v[96:99]
  v_mfma_f32_16x16x32_bf16 v[96:99], v[252:255], v[124:127], v[96:99]
  v_mul_f32 v92, s42, v92
  v_mul_f32 v93, s42, v93
  v_mul_f32 v94, s42, v94
  v_mul_f32 v95, s42, v95
  v_cvt_pk_bf16_f32 v102, v92, v93
  v_cvt_pk_bf16_f32 v103, v94, v95
  v_mfma_f32_16x16x32_bf16 v[128:131], a[0:3], a[244:247], 0
  v_mfma_f32_16x16x32_bf16 v[128:131], a[12:15], a[248:251], v[128:131]
  v_mfma_f32_16x16x32_bf16 v[128:131], a[24:27], a[252:255], v[128:131]
  v_mfma_f32_16x16x32_bf16 v[128:131], a[36:39], v[116:119], v[128:131]
  v_mfma_f32_16x16x32_bf16 v[128:131], a[48:51], v[120:123], v[128:131]
  v_mfma_f32_16x16x32_bf16 v[128:131], a[60:63], v[124:127], v[128:131]
  v_mul_f32 v96, s42, v96
  v_mul_f32 v97, s42, v97
  v_mul_f32 v98, s42, v98
  v_mul_f32 v99, s42, v99
  v_cvt_pk_bf16_f32 v22, v96, v97
  v_cvt_pk_bf16_f32 v23, v98, v99
  v_mfma_f32_16x16x32_bf16 v[132:135], a[4:7], a[244:247], 0
  v_mfma_f32_16x16x32_bf16 v[132:135], a[16:19], a[248:251], v[132:135]
  v_mfma_f32_16x16x32_bf16 v[132:135], a[28:31], a[252:255], v[132:135]
  v_mfma_f32_16x16x32_bf16 v[132:135], a[40:43], v[116:119], v[132:135]
  v_mfma_f32_16x16x32_bf16 v[132:135], a[52:55], v[120:123], v[132:135]
  v_mfma_f32_16x16x32_bf16 v[132:135], a[64:67], v[124:127], v[132:135]
  v_cvt_pk_bf16_f32 v94, v128, v129
  v_cvt_pk_bf16_f32 v95, v130, v131
  v_mfma_f32_16x16x32_bf16 v[136:139], a[8:11], a[244:247], 0
  v_mfma_f32_16x16x32_bf16 v[136:139], a[20:23], a[248:251], v[136:139]
  v_mfma_f32_16x16x32_bf16 v[136:139], a[32:35], a[252:255], v[136:139]
  v_mfma_f32_16x16x32_bf16 v[136:139], a[44:47], v[116:119], v[136:139]
  v_mfma_f32_16x16x32_bf16 v[136:139], a[56:59], v[120:123], v[136:139]
  v_mfma_f32_16x16x32_bf16 v[136:139], a[68:71], v[124:127], v[136:139]
  v_cvt_pk_bf16_f32 v96, v132, v133
  v_cvt_pk_bf16_f32 v97, v134, v135
  v_mfma_f32_16x16x32_bf16 v[128:131], a[244:247], a[72:75], 0
  v_mfma_f32_16x16x32_bf16 v[128:131], a[248:251], a[84:87], v[128:131]
  v_mfma_f32_16x16x32_bf16 v[128:131], a[252:255], a[96:99], v[128:131]
  v_mfma_f32_16x16x32_bf16 v[128:131], v[116:119], a[108:111], v[128:131]
  v_mfma_f32_16x16x32_bf16 v[128:131], v[120:123], a[120:123], v[128:131]
  v_mfma_f32_16x16x32_bf16 v[128:131], v[124:127], a[132:135], v[128:131]
  v_cvt_pk_bf16_f32 v98, v136, v137
  v_cvt_pk_bf16_f32 v99, v138, v139
  v_mfma_f32_16x16x32_bf16 v[132:135], a[244:247], a[76:79], 0
  v_mfma_f32_16x16x32_bf16 v[132:135], a[248:251], a[88:91], v[132:135]
  v_mfma_f32_16x16x32_bf16 v[132:135], a[252:255], a[100:103], v[132:135]
  v_mfma_f32_16x16x32_bf16 v[132:135], v[116:119], a[112:115], v[132:135]
  v_mfma_f32_16x16x32_bf16 v[132:135], v[120:123], a[124:127], v[132:135]
  v_mfma_f32_16x16x32_bf16 v[132:135], v[124:127], a[136:139], v[132:135]
  v_cvt_pk_bf16_f32 v84, v128, v129
  v_cvt_pk_bf16_f32 v85, v130, v131
  v_mfma_f32_16x16x32_bf16 v[136:139], a[244:247], a[80:83], 0
  v_mfma_f32_16x16x32_bf16 v[136:139], a[248:251], a[92:95], v[136:139]
  v_mfma_f32_16x16x32_bf16 v[136:139], a[252:255], a[104:107], v[136:139]
  v_mfma_f32_16x16x32_bf16 v[136:139], v[116:119], a[116:119], v[136:139]
  v_mfma_f32_16x16x32_bf16 v[136:139], v[120:123], a[128:131], v[136:139]
  v_mfma_f32_16x16x32_bf16 v[136:139], v[124:127], a[140:143], v[136:139]
  v_cvt_pk_bf16_f32 v88, v132, v133
  v_cvt_pk_bf16_f32 v89, v134, v135
  s_nop 5
  v_cvt_pk_bf16_f32 v92, v136, v137
  v_cvt_pk_bf16_f32 v93, v138, v139
  v_mfma_f32_16x16x32_bf16 v[116:119], v[54:57], v[112:115], v[36:39]
  v_mfma_f32_16x16x32_bf16 v[116:119], v[52:55], v[12:15], v[116:119]
  v_mfma_f32_16x16x32_bf16 v[120:123], v[72:75], v[112:115], v[32:35]
  v_mfma_f32_16x16x32_bf16 v[120:123], v[70:73], v[12:15], v[120:123]
  v_mfma_f32_16x16x32_bf16 v[124:127], v[78:81], v[112:115], v[28:31]
  v_mfma_f32_16x16x32_bf16 v[124:127], v[76:79], v[12:15], v[124:127]
  v_mfma_f32_16x16x32_bf16 v[128:131], v[96:99], v[112:115], v[24:27]
  v_mfma_f32_16x16x32_bf16 v[128:131], v[94:97], v[12:15], v[128:131]
  s_nop 1
  v_add_f32 v124, v11, v124
  v_add_f32 v125, v11, v125
  v_add_f32 v126, v11, v126
  v_add_f32 v127, v11, v127
  s_nop 1
  v_add_f32 v128, v11, v128
  v_add_f32 v129, v11, v129
  v_add_f32 v130, v11, v130
  v_add_f32 v131, v11, v131
  v_max_f32 v132, v116, v117
  v_max3_f32 v132, v118, v119, v132
  v_max3_f32 v132, v120, v121, v132
  v_max3_f32 v132, v122, v123, v132
  v_max3_f32 v132, v124, v125, v132
  v_max3_f32 v132, v126, v127, v132
  v_max3_f32 v132, v128, v129, v132
  v_max3_f32 v132, v130, v131, v132
  v_mov_b32 v133, v132
  s_nop 1
  v_permlane32_swap_b32 v132, v133
  v_max_f32 v132, v132, v133
  v_mov_b32 v133, v132
  s_nop 1
  v_permlane16_swap_b32 v132, v133
  v_max_f32 v132, v132, v133
  v_sub_f32 v116, v116, v132
  v_sub_f32 v117, v117, v132
  v_sub_f32 v118, v118, v132
  v_sub_f32 v119, v119, v132
  v_sub_f32 v120, v120, v132
  v_sub_f32 v121, v121, v132
  v_sub_f32 v122, v122, v132
  v_sub_f32 v123, v123, v132
  v_sub_f32 v124, v124, v132
  v_sub_f32 v125, v125, v132
  v_sub_f32 v126, v126, v132
  v_sub_f32 v127, v127, v132
  v_sub_f32 v128, v128, v132
  v_sub_f32 v129, v129, v132
  v_sub_f32 v130, v130, v132
  v_sub_f32 v131, v131, v132
  v_exp_f32 v116, v116
  v_exp_f32 v117, v117
  v_exp_f32 v118, v118
  v_exp_f32 v119, v119
  v_cvt_pk_bf16_f32 v116, v116, v117
  v_cvt_pk_bf16_f32 v117, v118, v119
  v_exp_f32 v120, v120
  v_exp_f32 v121, v121
  v_exp_f32 v122, v122
  v_exp_f32 v123, v123
  v_cvt_pk_bf16_f32 v118, v120, v121
  v_cvt_pk_bf16_f32 v119, v122, v123
  v_exp_f32 v124, v124
  v_exp_f32 v125, v125
  v_exp_f32 v126, v126
  v_exp_f32 v127, v127
  v_cvt_pk_bf16_f32 v120, v124, v125
  v_cvt_pk_bf16_f32 v121, v126, v127
  v_exp_f32 v128, v128
  v_exp_f32 v129, v129
  v_exp_f32 v130, v130
  v_exp_f32 v131, v131
  v_cvt_pk_bf16_f32 v122, v128, v129
  v_cvt_pk_bf16_f32 v123, v130, v131
  v_mov_b64 v[112:113], 0
  s_nop 1
  v_smfmac_f32_16x16x64_bf16 v[112:115], a[240:243], v[116:123], v10
  v_mfma_f32_16x16x32_bf16 v[132:135], v[82:85], v[120:123], 0
  v_mfma_f32_16x16x32_bf16 v[132:135], v[58:61], v[116:119], v[132:135]
  v_mfma_f32_16x16x32_bf16 v[124:127], v[66:69], v[116:119], 0
  v_mfma_f32_16x16x32_bf16 v[124:127], v[86:89], v[120:123], v[124:127]
  v_mfma_f32_16x16x32_bf16 v[128:131], v[90:93], v[120:123], 0
  v_mfma_f32_16x16x32_bf16 v[128:131], v[62:65], v[116:119], v[128:131]
  v_add_f32 v112, v112, v113
  v_rcp_f32 v114, v112
  s_nop 0
  v_mul_f32 v132, v114, v132
  v_mul_f32 v133, v114, v133
  v_mul_f32 v134, v114, v134
  v_mul_f32 v135, v114, v135
  v_cvt_pk_bf16_f32 v132, v132, v133
  v_cvt_pk_bf16_f32 v133, v134, v135
  ds_write_b32 v5, v132 offset:0
  ds_write_b32 v5, v133 offset:1024
  v_mul_f32 v124, v114, v124
  v_mul_f32 v125, v114, v125
  v_mul_f32 v126, v114, v126
  v_mul_f32 v127, v114, v127
  v_cvt_pk_bf16_f32 v124, v124, v125
  v_cvt_pk_bf16_f32 v125, v126, v127
  ds_write_b32 v5, v124 offset:2048
  ds_write_b32 v5, v125 offset:3072
  v_mul_f32 v128, v114, v128
  v_mul_f32 v129, v114, v129
  v_mul_f32 v130, v114, v130
  v_mul_f32 v131, v114, v131
  v_cvt_pk_bf16_f32 v128, v128, v129
  v_cvt_pk_bf16_f32 v129, v130, v131
  ds_write_b32 v5, v128 offset:4096
  ds_write_b32 v5, v129 offset:5120
  v_mfma_f32_16x16x32_bf16 v[112:115], v[52:55], v[108:111], v[40:43]
  v_mfma_f32_16x16x32_bf16 v[112:115], v[54:57], v[14:17], v[112:115]
  v_mfma_f32_16x16x32_bf16 v[116:119], v[70:73], v[108:111], v[36:39]
  v_mfma_f32_16x16x32_bf16 v[116:119], v[72:75], v[14:17], v[116:119]
  v_mfma_f32_16x16x32_bf16 v[120:123], v[76:79], v[108:111], v[32:35]
  v_mfma_f32_16x16x32_bf16 v[120:123], v[78:81], v[14:17], v[120:123]
  v_mfma_f32_16x16x32_bf16 v[124:127], v[94:97], v[108:111], v[28:31]
  v_mfma_f32_16x16x32_bf16 v[124:127], v[96:99], v[14:17], v[124:127]
  s_nop 1
  v_add_f32 v120, v11, v120
  v_add_f32 v121, v11, v121
  v_add_f32 v122, v11, v122
  v_add_f32 v123, v11, v123
  s_nop 1
  v_add_f32 v124, v11, v124
  v_add_f32 v125, v11, v125
  v_add_f32 v126, v11, v126
  v_add_f32 v127, v11, v127
  v_max_f32 v132, v112, v113
  v_max3_f32 v132, v114, v115, v132
  v_max3_f32 v132, v116, v117, v132
  v_max3_f32 v132, v118, v119, v132
  v_max3_f32 v132, v120, v121, v132
  v_max3_f32 v132, v122, v123, v132
  v_max3_f32 v132, v124, v125, v132
  v_max3_f32 v132, v126, v127, v132
  v_mov_b32 v133, v132
  s_nop 1
  v_permlane32_swap_b32 v132, v133
  v_max_f32 v132, v132, v133
  v_mov_b32 v133, v132
  s_nop 1
  v_permlane16_swap_b32 v132, v133
  v_max_f32 v132, v132, v133
  v_sub_f32 v112, v112, v132
  v_sub_f32 v113, v113, v132
  v_sub_f32 v114, v114, v132
  v_sub_f32 v115, v115, v132
  v_sub_f32 v116, v116, v132
  v_sub_f32 v117, v117, v132
  v_sub_f32 v118, v118, v132
  v_sub_f32 v119, v119, v132
  v_sub_f32 v120, v120, v132
  v_sub_f32 v121, v121, v132
  v_sub_f32 v122, v122, v132
  v_sub_f32 v123, v123, v132
  v_sub_f32 v124, v124, v132
  v_sub_f32 v125, v125, v132
  v_sub_f32 v126, v126, v132
  v_sub_f32 v127, v127, v132
  v_exp_f32 v112, v112
  v_exp_f32 v113, v113
  v_exp_f32 v114, v114
  v_exp_f32 v115, v115
  v_cvt_pk_bf16_f32 v112, v112, v113
  v_cvt_pk_bf16_f32 v113, v114, v115
  v_exp_f32 v116, v116
  v_exp_f32 v117, v117
  v_exp_f32 v118, v118
  v_exp_f32 v119, v119
  v_cvt_pk_bf16_f32 v114, v116, v117
  v_cvt_pk_bf16_f32 v115, v118, v119
  v_exp_f32 v120, v120
  v_exp_f32 v121, v121
  v_exp_f32 v122, v122
  v_exp_f32 v123, v123
  v_cvt_pk_bf16_f32 v116, v120, v121
  v_cvt_pk_bf16_f32 v117, v122, v123
  v_exp_f32 v124, v124
  v_exp_f32 v125, v125
  v_exp_f32 v126, v126
  v_exp_f32 v127, v127
  v_cvt_pk_bf16_f32 v118, v124, v125
  v_cvt_pk_bf16_f32 v119, v126, v127
  v_mov_b64 v[108:109], 0
  s_nop 1
  v_smfmac_f32_16x16x64_bf16 v[108:111], a[240:243], v[112:119], v10
  v_mfma_f32_16x16x32_bf16 v[128:131], v[82:85], v[116:119], 0
  v_mfma_f32_16x16x32_bf16 v[128:131], v[58:61], v[112:115], v[128:131]
  v_mfma_f32_16x16x32_bf16 v[120:123], v[66:69], v[112:115], 0
  v_mfma_f32_16x16x32_bf16 v[120:123], v[86:89], v[116:119], v[120:123]
  v_mfma_f32_16x16x32_bf16 v[124:127], v[90:93], v[116:119], 0
  v_mfma_f32_16x16x32_bf16 v[124:127], v[62:65], v[112:115], v[124:127]
  v_add_f32 v108, v108, v109
  v_rcp_f32 v110, v108
  s_nop 0
  v_mul_f32 v128, v110, v128
  v_mul_f32 v129, v110, v129
  v_mul_f32 v130, v110, v130
  v_mul_f32 v131, v110, v131
  v_cvt_pk_bf16_f32 v128, v128, v129
  v_cvt_pk_bf16_f32 v129, v130, v131
  ds_write_b32 v5, v128 offset:256
  ds_write_b32 v5, v129 offset:1280
  v_mul_f32 v120, v110, v120
  v_mul_f32 v121, v110, v121
  v_mul_f32 v122, v110, v122
  v_mul_f32 v123, v110, v123
  v_cvt_pk_bf16_f32 v120, v120, v121
  v_cvt_pk_bf16_f32 v121, v122, v123
  ds_write_b32 v5, v120 offset:2304
  ds_write_b32 v5, v121 offset:3328
  v_mul_f32 v124, v110, v124
  v_mul_f32 v125, v110, v125
  v_mul_f32 v126, v110, v126
  v_mul_f32 v127, v110, v127
  v_cvt_pk_bf16_f32 v124, v124, v125
  v_cvt_pk_bf16_f32 v125, v126, v127
  ds_write_b32 v5, v124 offset:4352
  ds_write_b32 v5, v125 offset:5376
  v_mfma_f32_16x16x32_bf16 v[108:111], v[54:57], v[104:107], v[44:47]
  v_mfma_f32_16x16x32_bf16 v[108:111], v[52:55], v[18:21], v[108:111]
  v_mfma_f32_16x16x32_bf16 v[112:115], v[72:75], v[104:107], v[40:43]
  v_mfma_f32_16x16x32_bf16 v[112:115], v[70:73], v[18:21], v[112:115]
  v_mfma_f32_16x16x32_bf16 v[116:119], v[78:81], v[104:107], v[36:39]
  v_mfma_f32_16x16x32_bf16 v[116:119], v[76:79], v[18:21], v[116:119]
  v_mfma_f32_16x16x32_bf16 v[120:123], v[96:99], v[104:107], v[32:35]
  v_mfma_f32_16x16x32_bf16 v[120:123], v[94:97], v[18:21], v[120:123]
  v_add_f32 v108, v11, v108
  v_add_f32 v109, v11, v109
  v_add_f32 v110, v11, v110
  v_add_f32 v111, v11, v111
  v_add_f32 v112, v11, v112
  v_add_f32 v113, v11, v113
  v_add_f32 v114, v11, v114
  v_add_f32 v115, v11, v115
  v_max_f32 v132, v108, v109
  v_max3_f32 v132, v110, v111, v132
  v_max3_f32 v132, v112, v113, v132
  v_max3_f32 v132, v114, v115, v132
  v_max3_f32 v132, v116, v117, v132
  v_max3_f32 v132, v118, v119, v132
  v_max3_f32 v132, v120, v121, v132
  v_max3_f32 v132, v122, v123, v132
  v_mov_b32 v133, v132
  s_nop 1
  v_permlane32_swap_b32 v132, v133
  v_max_f32 v132, v132, v133
  v_mov_b32 v133, v132
  s_nop 1
  v_permlane16_swap_b32 v132, v133
  v_max_f32 v132, v132, v133
  v_sub_f32 v108, v108, v132
  v_sub_f32 v109, v109, v132
  v_sub_f32 v110, v110, v132
  v_sub_f32 v111, v111, v132
  v_sub_f32 v112, v112, v132
  v_sub_f32 v113, v113, v132
  v_sub_f32 v114, v114, v132
  v_sub_f32 v115, v115, v132
  v_sub_f32 v116, v116, v132
  v_sub_f32 v117, v117, v132
  v_sub_f32 v118, v118, v132
  v_sub_f32 v119, v119, v132
  v_sub_f32 v120, v120, v132
  v_sub_f32 v121, v121, v132
  v_sub_f32 v122, v122, v132
  v_sub_f32 v123, v123, v132
  v_exp_f32 v108, v108
  v_exp_f32 v109, v109
  v_exp_f32 v110, v110
  v_exp_f32 v111, v111
  v_cvt_pk_bf16_f32 v108, v108, v109
  v_cvt_pk_bf16_f32 v109, v110, v111
  v_exp_f32 v112, v112
  v_exp_f32 v113, v113
  v_exp_f32 v114, v114
  v_exp_f32 v115, v115
  v_cvt_pk_bf16_f32 v110, v112, v113
  v_cvt_pk_bf16_f32 v111, v114, v115
  v_exp_f32 v116, v116
  v_exp_f32 v117, v117
  v_exp_f32 v118, v118
  v_exp_f32 v119, v119
  v_cvt_pk_bf16_f32 v112, v116, v117
  v_cvt_pk_bf16_f32 v113, v118, v119
  v_exp_f32 v120, v120
  v_exp_f32 v121, v121
  v_exp_f32 v122, v122
  v_exp_f32 v123, v123
  v_cvt_pk_bf16_f32 v114, v120, v121
  v_cvt_pk_bf16_f32 v115, v122, v123
  v_mov_b64 v[104:105], 0
  s_nop 1
  v_smfmac_f32_16x16x64_bf16 v[104:107], a[240:243], v[108:115], v10
  v_mfma_f32_16x16x32_bf16 v[124:127], v[82:85], v[112:115], 0
  v_mfma_f32_16x16x32_bf16 v[124:127], v[58:61], v[108:111], v[124:127]
  v_mfma_f32_16x16x32_bf16 v[116:119], v[66:69], v[108:111], 0
  v_mfma_f32_16x16x32_bf16 v[116:119], v[86:89], v[112:115], v[116:119]
  v_mfma_f32_16x16x32_bf16 v[120:123], v[90:93], v[112:115], 0
  v_mfma_f32_16x16x32_bf16 v[120:123], v[62:65], v[108:111], v[120:123]
  v_add_f32 v104, v104, v105
  v_rcp_f32 v106, v104
  s_nop 0
  v_mul_f32 v124, v106, v124
  v_mul_f32 v125, v106, v125
  v_mul_f32 v126, v106, v126
  v_mul_f32 v127, v106, v127
  v_cvt_pk_bf16_f32 v124, v124, v125
  v_cvt_pk_bf16_f32 v125, v126, v127
  ds_write_b32 v5, v124 offset:512
  ds_write_b32 v5, v125 offset:1536
  v_mul_f32 v116, v106, v116
  v_mul_f32 v117, v106, v117
  v_mul_f32 v118, v106, v118
  v_mul_f32 v119, v106, v119
  v_cvt_pk_bf16_f32 v116, v116, v117
  v_cvt_pk_bf16_f32 v117, v118, v119
  ds_write_b32 v5, v116 offset:2560
  s_waitcnt lgkmcnt(12)
  ds_write_b32 v5, v117 offset:3584
  v_mul_f32 v120, v106, v120
  v_mul_f32 v121, v106, v121
  v_mul_f32 v122, v106, v122
  v_mul_f32 v123, v106, v123
  v_cvt_pk_bf16_f32 v120, v120, v121
  v_cvt_pk_bf16_f32 v121, v122, v123
  ds_write_b32 v5, v120 offset:4608
  ds_write_b32 v5, v121 offset:5632
  v_mfma_f32_16x16x32_bf16 v[104:107], v[52:55], v[100:103], v[48:51]
  v_mfma_f32_16x16x32_bf16 v[104:107], v[54:57], v[20:23], v[104:107]
  v_mfma_f32_16x16x32_bf16 v[108:111], v[70:73], v[100:103], v[44:47]
  v_mfma_f32_16x16x32_bf16 v[108:111], v[72:75], v[20:23], v[108:111]
  v_mfma_f32_16x16x32_bf16 v[112:115], v[76:79], v[100:103], v[40:43]
  v_mfma_f32_16x16x32_bf16 v[112:115], v[78:81], v[20:23], v[112:115]
  v_mfma_f32_16x16x32_bf16 v[52:55], v[94:97], v[100:103], v[36:39]
  v_mfma_f32_16x16x32_bf16 v[52:55], v[96:99], v[20:23], v[52:55]
  v_add_f32 v104, v11, v104
  v_add_f32 v105, v11, v105
  v_add_f32 v106, v11, v106
  v_add_f32 v107, v11, v107
  v_add_f32 v108, v11, v108
  v_add_f32 v109, v11, v109
  v_add_f32 v110, v11, v110
  v_add_f32 v111, v11, v111
  v_max_f32 v132, v104, v105
  v_max3_f32 v132, v106, v107, v132
  v_max3_f32 v132, v108, v109, v132
  v_max3_f32 v132, v110, v111, v132
  v_max3_f32 v132, v112, v113, v132
  v_max3_f32 v132, v114, v115, v132
  v_max3_f32 v132, v52, v53, v132
  v_max3_f32 v132, v54, v55, v132
  v_mov_b32 v133, v132
  s_nop 1
  v_permlane32_swap_b32 v132, v133
  v_max_f32 v132, v132, v133
  v_mov_b32 v133, v132
  s_nop 1
  v_permlane16_swap_b32 v132, v133
  v_max_f32 v132, v132, v133
  v_sub_f32 v104, v104, v132
  v_sub_f32 v105, v105, v132
  v_sub_f32 v106, v106, v132
  v_sub_f32 v107, v107, v132
  v_sub_f32 v108, v108, v132
  v_sub_f32 v109, v109, v132
  v_sub_f32 v110, v110, v132
  v_sub_f32 v111, v111, v132
  v_sub_f32 v112, v112, v132
  v_sub_f32 v113, v113, v132
  v_sub_f32 v114, v114, v132
  v_sub_f32 v115, v115, v132
  v_sub_f32 v52, v52, v132
  v_sub_f32 v53, v53, v132
  v_sub_f32 v54, v54, v132
  v_sub_f32 v55, v55, v132
  v_exp_f32 v104, v104
  v_exp_f32 v105, v105
  v_exp_f32 v106, v106
  v_exp_f32 v107, v107
  v_cvt_pk_bf16_f32 v104, v104, v105
  v_cvt_pk_bf16_f32 v105, v106, v107
  v_exp_f32 v108, v108
  v_exp_f32 v109, v109
  v_exp_f32 v110, v110
  v_exp_f32 v111, v111
  v_cvt_pk_bf16_f32 v106, v108, v109
  v_cvt_pk_bf16_f32 v107, v110, v111
  v_exp_f32 v112, v112
  v_exp_f32 v113, v113
  v_exp_f32 v114, v114
  v_exp_f32 v115, v115
  v_cvt_pk_bf16_f32 v108, v112, v113
  v_cvt_pk_bf16_f32 v109, v114, v115
  v_exp_f32 v52, v52
  v_exp_f32 v53, v53
  v_exp_f32 v54, v54
  v_exp_f32 v55, v55
  v_cvt_pk_bf16_f32 v110, v52, v53
  v_cvt_pk_bf16_f32 v111, v54, v55
  v_mov_b64 v[74:75], 0
  s_nop 1
  v_smfmac_f32_16x16x64_bf16 v[74:77], a[240:243], v[104:111], v10
  v_mfma_f32_16x16x32_bf16 v[78:81], v[82:85], v[108:111], 0
  v_mfma_f32_16x16x32_bf16 v[78:81], v[58:61], v[104:107], v[78:81]
  v_mfma_f32_16x16x32_bf16 v[52:55], v[66:69], v[104:107], 0
  v_mfma_f32_16x16x32_bf16 v[52:55], v[86:89], v[108:111], v[52:55]
  v_mfma_f32_16x16x32_bf16 v[70:73], v[90:93], v[108:111], 0
  v_mfma_f32_16x16x32_bf16 v[70:73], v[62:65], v[104:107], v[70:73]
  v_add_f32 v74, v74, v75
  v_rcp_f32 v76, v74
  s_nop 0
  v_mul_f32 v78, v76, v78
  v_mul_f32 v79, v76, v79
  v_mul_f32 v80, v76, v80
  v_mul_f32 v81, v76, v81
  v_cvt_pk_bf16_f32 v78, v78, v79
  v_cvt_pk_bf16_f32 v79, v80, v81
  s_waitcnt lgkmcnt(12)
  ds_write_b32 v5, v78 offset:768
  ds_write_b32 v5, v79 offset:1792
  v_mul_f32 v52, v76, v52
  v_mul_f32 v53, v76, v53
  v_mul_f32 v54, v76, v54
  v_mul_f32 v55, v76, v55
  v_cvt_pk_bf16_f32 v52, v52, v53
  v_cvt_pk_bf16_f32 v53, v54, v55
  ds_write_b32 v5, v52 offset:2816
  s_waitcnt lgkmcnt(12)
  ds_write_b32 v5, v53 offset:3840
  v_mul_f32 v70, v76, v70
  v_mul_f32 v71, v76, v71
  v_mul_f32 v72, v76, v72
  v_mul_f32 v73, v76, v73
  v_cvt_pk_bf16_f32 v70, v70, v71
  v_cvt_pk_bf16_f32 v71, v72, v73
  ds_write_b32 v5, v70 offset:4864
  ds_write_b32 v5, v71 offset:5888
  s_waitcnt lgkmcnt(0)
  s_barrier
  ds_read_b128 a[244:247], v3 offset:0
  ds_read_b128 a[248:251], v3 offset:4096
  ds_read_b128 a[252:255], v3 offset:8192
  ds_read_b128 v[60:63], v3 offset:12288
  ds_read_b128 v[64:67], v3 offset:16384
  ds_read_b128 v[76:79], v3 offset:20480
  s_waitcnt lgkmcnt(5)
  v_mfma_f32_16x16x32_bf16 v[56:59], a[144:147], a[244:247], 0
  s_waitcnt lgkmcnt(4)
  v_mfma_f32_16x16x32_bf16 v[56:59], a[160:163], a[248:251], v[56:59]
  s_waitcnt lgkmcnt(3)
  v_mfma_f32_16x16x32_bf16 v[56:59], a[176:179], a[252:255], v[56:59]
  s_waitcnt lgkmcnt(2)
  v_mfma_f32_16x16x32_bf16 v[56:59], a[192:195], v[60:63], v[56:59]
  s_waitcnt lgkmcnt(1)
  v_mfma_f32_16x16x32_bf16 v[56:59], a[208:211], v[64:67], v[56:59]
  s_waitcnt lgkmcnt(0)
  v_mfma_f32_16x16x32_bf16 v[56:59], a[224:227], v[76:79], v[56:59]
  v_mfma_f32_16x16x32_bf16 v[52:55], a[228:231], v[76:79], 0
  v_mfma_f32_16x16x32_bf16 v[52:55], a[212:215], v[64:67], v[52:55]
  v_mfma_f32_16x16x32_bf16 v[52:55], a[196:199], v[60:63], v[52:55]
  v_mfma_f32_16x16x32_bf16 v[52:55], a[180:183], a[252:255], v[52:55]
  v_mfma_f32_16x16x32_bf16 v[52:55], a[164:167], a[248:251], v[52:55]
  v_mfma_f32_16x16x32_bf16 v[52:55], a[148:151], a[244:247], v[52:55]
  v_mfma_f32_16x16x32_bf16 v[68:71], a[152:155], a[244:247], 0
  v_mfma_f32_16x16x32_bf16 v[68:71], a[168:171], a[248:251], v[68:71]
  v_mfma_f32_16x16x32_bf16 v[68:71], a[184:187], a[252:255], v[68:71]
  v_mfma_f32_16x16x32_bf16 v[68:71], a[200:203], v[60:63], v[68:71]
  v_mfma_f32_16x16x32_bf16 v[68:71], a[216:219], v[64:67], v[68:71]
  v_mfma_f32_16x16x32_bf16 v[68:71], a[232:235], v[76:79], v[68:71]
  v_mfma_f32_16x16x32_bf16 v[72:75], a[236:239], v[76:79], 0
  v_mfma_f32_16x16x32_bf16 v[72:75], a[220:223], v[64:67], v[72:75]
  v_mfma_f32_16x16x32_bf16 v[72:75], a[204:207], v[60:63], v[72:75]
  v_mfma_f32_16x16x32_bf16 v[72:75], a[188:191], a[252:255], v[72:75]
  v_mfma_f32_16x16x32_bf16 v[72:75], a[172:175], a[248:251], v[72:75]
  v_mfma_f32_16x16x32_bf16 v[72:75], a[156:159], a[244:247], v[72:75]
  v_cvt_pk_bf16_f32 v56, v56, v57
  v_cvt_pk_bf16_f32 v57, v58, v59
  v_cvt_pk_bf16_f32 v58, v52, v53
  v_cvt_pk_bf16_f32 v59, v54, v55
  buffer_store_dwordx4 v[56:59], v7, s[24:27], s33 offen nt
  v_cvt_pk_bf16_f32 v68, v68, v69
  v_cvt_pk_bf16_f32 v69, v70, v71
  s_nop 0
  v_cvt_pk_bf16_f32 v70, v72, v73
  v_cvt_pk_bf16_f32 v71, v74, v75
  buffer_store_dwordx4 v[68:71], v8, s[24:27], s33 offen nt
  ds_read_b128 a[244:247], v4 offset:0
  ds_read_b128 a[248:251], v4 offset:4096
  ds_read_b128 a[252:255], v4 offset:8192
  ds_read_b128 v[56:59], v4 offset:12288
  ds_read_b128 v[60:63], v4 offset:16384
  ds_read_b128 v[68:71], v4 offset:20480
  s_waitcnt lgkmcnt(5)
  v_mfma_f32_16x16x32_bf16 v[52:55], a[144:147], a[244:247], 0
  s_waitcnt lgkmcnt(4)
  v_mfma_f32_16x16x32_bf16 v[52:55], a[160:163], a[248:251], v[52:55]
  s_waitcnt lgkmcnt(3)
  v_mfma_f32_16x16x32_bf16 v[52:55], a[176:179], a[252:255], v[52:55]
  s_waitcnt lgkmcnt(2)
  v_mfma_f32_16x16x32_bf16 v[52:55], a[192:195], v[56:59], v[52:55]
  s_waitcnt lgkmcnt(1)
  v_mfma_f32_16x16x32_bf16 v[52:55], a[208:211], v[60:63], v[52:55]
  s_waitcnt lgkmcnt(0)
  v_mfma_f32_16x16x32_bf16 v[52:55], a[224:227], v[68:71], v[52:55]
  v_mfma_f32_16x16x32_bf16 v[64:67], a[228:231], v[68:71], 0
  v_mfma_f32_16x16x32_bf16 v[64:67], a[212:215], v[60:63], v[64:67]
  v_mfma_f32_16x16x32_bf16 v[64:67], a[196:199], v[56:59], v[64:67]
  v_mfma_f32_16x16x32_bf16 v[64:67], a[180:183], a[252:255], v[64:67]
  v_mfma_f32_16x16x32_bf16 v[64:67], a[164:167], a[248:251], v[64:67]
  v_mfma_f32_16x16x32_bf16 v[64:67], a[148:151], a[244:247], v[64:67]
  v_cvt_pk_bf16_f32 v52, v52, v53
  v_cvt_pk_bf16_f32 v53, v54, v55
  s_nop 5
  v_cvt_pk_bf16_f32 v54, v64, v65
  v_cvt_pk_bf16_f32 v55, v66, v67
  buffer_store_dwordx4 v[52:55], v7, s[24:27], s34 offen nt
  ds_read_b128 a[244:247], v3 offset:512
  ds_read_b128 a[248:251], v3 offset:4608
  ds_read_b128 a[252:255], v3 offset:8704
  ds_read_b128 v[56:59], v3 offset:12800
  ds_read_b128 v[60:63], v3 offset:16896
  ds_read_b128 v[76:79], v3 offset:20992
  s_waitcnt lgkmcnt(5)
  v_mfma_f32_16x16x32_bf16 v[52:55], a[144:147], a[244:247], 0
  s_waitcnt lgkmcnt(4)
  v_mfma_f32_16x16x32_bf16 v[52:55], a[160:163], a[248:251], v[52:55]
  s_waitcnt lgkmcnt(3)
  v_mfma_f32_16x16x32_bf16 v[52:55], a[176:179], a[252:255], v[52:55]
  s_waitcnt lgkmcnt(2)
  v_mfma_f32_16x16x32_bf16 v[52:55], a[192:195], v[56:59], v[52:55]
  s_waitcnt lgkmcnt(1)
  v_mfma_f32_16x16x32_bf16 v[52:55], a[208:211], v[60:63], v[52:55]
  s_waitcnt lgkmcnt(0)
  v_mfma_f32_16x16x32_bf16 v[52:55], a[224:227], v[76:79], v[52:55]
  v_mfma_f32_16x16x32_bf16 v[64:67], a[228:231], v[76:79], 0
  v_mfma_f32_16x16x32_bf16 v[64:67], a[212:215], v[60:63], v[64:67]
  v_mfma_f32_16x16x32_bf16 v[64:67], a[196:199], v[56:59], v[64:67]
  v_mfma_f32_16x16x32_bf16 v[64:67], a[180:183], a[252:255], v[64:67]
  v_mfma_f32_16x16x32_bf16 v[64:67], a[164:167], a[248:251], v[64:67]
  v_mfma_f32_16x16x32_bf16 v[64:67], a[148:151], a[244:247], v[64:67]
  v_mfma_f32_16x16x32_bf16 v[68:71], a[152:155], a[244:247], 0
  v_mfma_f32_16x16x32_bf16 v[68:71], a[168:171], a[248:251], v[68:71]
  v_mfma_f32_16x16x32_bf16 v[68:71], a[184:187], a[252:255], v[68:71]
  v_mfma_f32_16x16x32_bf16 v[68:71], a[200:203], v[56:59], v[68:71]
  v_mfma_f32_16x16x32_bf16 v[68:71], a[216:219], v[60:63], v[68:71]
  v_mfma_f32_16x16x32_bf16 v[68:71], a[232:235], v[76:79], v[68:71]
  v_mfma_f32_16x16x32_bf16 v[72:75], a[236:239], v[76:79], 0
  v_mfma_f32_16x16x32_bf16 v[72:75], a[220:223], v[60:63], v[72:75]
  v_mfma_f32_16x16x32_bf16 v[72:75], a[204:207], v[56:59], v[72:75]
  v_mfma_f32_16x16x32_bf16 v[72:75], a[188:191], a[252:255], v[72:75]
  v_mfma_f32_16x16x32_bf16 v[72:75], a[172:175], a[248:251], v[72:75]
  v_mfma_f32_16x16x32_bf16 v[72:75], a[156:159], a[244:247], v[72:75]
  v_cvt_pk_bf16_f32 v52, v52, v53
  v_cvt_pk_bf16_f32 v53, v54, v55
  v_cvt_pk_bf16_f32 v54, v64, v65
  v_cvt_pk_bf16_f32 v55, v66, v67
  buffer_store_dwordx4 v[52:55], v7, s[24:27], s35 offen nt
  v_cvt_pk_bf16_f32 v68, v68, v69
  v_cvt_pk_bf16_f32 v69, v70, v71
  s_nop 0
  v_cvt_pk_bf16_f32 v70, v72, v73
  v_cvt_pk_bf16_f32 v71, v74, v75
  buffer_store_dwordx4 v[68:71], v8, s[24:27], s35 offen nt
  ds_read_b128 a[244:247], v4 offset:512
  ds_read_b128 a[248:251], v4 offset:4608
  ds_read_b128 a[252:255], v4 offset:8704
  ds_read_b128 v[56:59], v4 offset:12800
  ds_read_b128 v[64:67], v4 offset:16896
  ds_read_b128 v[68:71], v4 offset:20992
  s_waitcnt lgkmcnt(5)
  v_mfma_f32_16x16x32_bf16 v[52:55], a[144:147], a[244:247], 0
  s_waitcnt lgkmcnt(4)
  v_mfma_f32_16x16x32_bf16 v[52:55], a[160:163], a[248:251], v[52:55]
  s_waitcnt lgkmcnt(3)
  v_mfma_f32_16x16x32_bf16 v[52:55], a[176:179], a[252:255], v[52:55]
  s_waitcnt lgkmcnt(2)
  v_mfma_f32_16x16x32_bf16 v[52:55], a[192:195], v[56:59], v[52:55]
  s_waitcnt lgkmcnt(1)
  v_mfma_f32_16x16x32_bf16 v[52:55], a[208:211], v[64:67], v[52:55]
  s_waitcnt lgkmcnt(0)
  v_mfma_f32_16x16x32_bf16 v[52:55], a[224:227], v[68:71], v[52:55]
  v_mfma_f32_16x16x32_bf16 v[60:63], a[228:231], v[68:71], 0
  v_mfma_f32_16x16x32_bf16 v[60:63], a[212:215], v[64:67], v[60:63]
  v_mfma_f32_16x16x32_bf16 v[60:63], a[196:199], v[56:59], v[60:63]
  v_mfma_f32_16x16x32_bf16 v[60:63], a[180:183], a[252:255], v[60:63]
  v_mfma_f32_16x16x32_bf16 v[60:63], a[164:167], a[248:251], v[60:63]
  v_mfma_f32_16x16x32_bf16 v[60:63], a[148:151], a[244:247], v[60:63]
  v_cvt_pk_bf16_f32 v52, v52, v53
  v_cvt_pk_bf16_f32 v53, v54, v55
  s_nop 5
  v_cvt_pk_bf16_f32 v54, v60, v61
  v_cvt_pk_bf16_f32 v55, v62, v63
  buffer_store_dwordx4 v[52:55], v7, s[24:27], s36 offen nt
  v_mov_b32 v11, 0
  s_add_u32 s56, s56, 32
  s_cmp_lt_u32 s56, 992
  s_nop 7
  s_cbranch_scc1 L_sloop
  s_branch L_fin

.section .rodata,"a"
.p2align 6
.amdhsa_kernel standalone__window_attn_swin__vision_kernel
  .amdhsa_next_free_vgpr 512
  .amdhsa_next_free_sgpr 100
  .amdhsa_accum_offset 256
  .amdhsa_group_segment_fixed_size 0
  .amdhsa_kernarg_size 72
  .amdhsa_user_sgpr_count 2
  .amdhsa_user_sgpr_kernarg_segment_ptr 1
  .amdhsa_system_sgpr_workgroup_id_x 1
.end_amdhsa_kernel
```

```asm
; @launch grid=(256,1,1) block=(256,1,1) lds=163840
.amdgcn_target "amdgcn-amd-amdhsa--gfx950"
.text
.globl standalone__window_attn_swin__vision_kernel
.p2align 12
.p2align 8
.type standalone__window_attn_swin__vision_kernel,@function
standalone__window_attn_swin__vision_kernel:
  s_cmpk_ge_u32 s2, 256
  s_cbranch_scc1 L_end
  s_load_dwordx2 s[8:9], s[0:1], 0
  s_load_dwordx2 s[20:21], s[0:1], 24
  s_load_dwordx2 s[12:13], s[0:1], 8
  s_load_dwordx2 s[16:17], s[0:1], 16
  s_load_dwordx2 s[24:25], s[0:1], 48
  v_lshrrev_b32 v63, 6, v0
  s_lshr_b32 s49, s2, 3
  v_readfirstlane_b32 s3, v63
  s_getpc_b64 s[50:51]
  v_and_b32 v63, 7, v0
  v_lshl_add_u32 v63, s49, 3, v63
  v_lshlrev_b32 v63, 7, v63
  v_min_u32 v63, L_safe-standalone__window_attn_swin__vision_kernel-256, v63
  v_mov_b32 v57, s51
  v_add_co_u32 v56, vcc, s50, v63
  s_and_b32 s47, s2, 63
  s_lshr_b32 s48, s2, 6
  v_addc_co_u32 v57, vcc, 0, v57, vcc
  global_load_dword v83, v[56:57], off
  v_bfe_u32 v54, v0, 3, 4
  v_and_b32 v52, 7, v0
  v_lshrrev_b32 v62, 1, v54
  v_lshlrev_b32 v66, 2, v54
  v_and_b32 v66, 4, v66
  v_xor_b32 v62, v62, v66
  v_xor_b32 v62, v52, v62
  v_and_b32 v11, 7, v54
  s_lshl_b32 s5, s47, 3
  s_add_u32 s5, s5, 4
  v_add_u32 v66, s5, v11
  v_and_b32 v66, 511, v66
  v_mul_u32_u24 v66, 0x180, v66
  v_lshl_add_u32 v6, v62, 4, v66
  v_and_b32 v53, 63, v0
  v_lshlrev_b32 v55, 4, v53
  s_mov_b32 s57, 196608
  s_lshl_b32 s56, s48, 3
  s_add_u32 s56, s56, s3
  s_add_u32 s5, s56, 484
  s_mul_i32 s31, s5, s57
  s_add_u32 s5, s5, 4
  s_and_b32 s5, s5, 511
  s_mul_i32 s32, s5, s57
  s_lshl_b32 s46, s3, 10
  s_lshl_b32 s5, s3, 11
  s_add_u32 m0, s5, 147456
  s_mov_b32 s11, 0x20000
  s_mov_b32 s10, 100663296
  s_mov_b32 s23, s11
  s_movk_i32 s22, 1800
  s_mov_b32 s15, s11
  s_mov_b32 s14, 221184
  s_waitcnt lgkmcnt(0)
  buffer_load_dwordx4 v55, s[20:23], 0 offen lds
  buffer_load_dwordx4 v55, s[20:23], 0 offen offset:1024 lds
  s_add_u32 m0, s46, 0
  v_and_b32 v62, 2, v54
  buffer_load_dwordx4 v6, s[8:11], s31 offen offset:0 nt lds
  s_add_u32 m0, s46, 8064
  v_lshrrev_b32 v66, 1, v54
  buffer_load_dwordx4 v6, s[8:11], s31 offen offset:128 nt lds
  s_add_u32 m0, s46, 16128
  v_and_b32 v66, 4, v66
  buffer_load_dwordx4 v6, s[8:11], s31 offen offset:256 nt lds
  s_add_u32 m0, s46, 4096
  v_or_b32 v66, v62, v66
  buffer_load_dwordx4 v6, s[8:11], s32 offen offset:0 nt lds
  s_add_u32 m0, s46, 12160
  v_xor_b32 v66, v52, v66
  buffer_load_dwordx4 v6, s[8:11], s32 offen offset:128 nt lds
  s_add_u32 m0, s46, 20224
  v_lshlrev_b32 v66, 4, v66
  buffer_load_dwordx4 v6, s[8:11], s32 offen offset:256 nt lds
  v_mul_u32_u24 v54, 1152, v11
  v_add_u32 v73, v66, v54
  s_mul_i32 s44, s3, 9216
  s_mov_b32 s19, s11
  s_mov_b32 s18, 73728
  s_lshl_b32 s49, s49, 2
  s_add_u32 s49, s49, s3
  s_mul_i32 s50, s49, 2304
  v_min_u32 v88, 17, v53
  v_lshlrev_b32 v88, 7, v88
  v_lshlrev_b32 v62, 1, v62
  v_xor_b32 v62, v52, v62
  v_mul_u32_u24 v66, 0x180, v11
  v_lshl_add_u32 v55, v62, 4, v66
  s_mul_i32 s45, s3, 3072
  s_mov_b32 s10, 95158272
  s_mov_b32 s27, s11
  s_mov_b32 s26, 100663296
  v_and_b32 v11, 15, v53
  v_lshrrev_b32 v52, 4, v53
  v_lshrrev_b32 v63, 1, v11
  v_lshlrev_b32 v62, 2, v11
  v_and_b32 v62, 4, v62
  v_xor_b32 v63, v63, v62
  v_xor_b32 v63, v52, v63
  v_lshlrev_b32 v63, 4, v63
  v_lshl_add_u32 v0, v11, 7, v63
  v_xor_b32 v1, 64, v0
  v_subrev_u32 v2, s46, v0
  s_add_u32 s28, s46, 24576
  s_add_u32 s29, s46, 49152
  s_mov_b32 s30, s46
  s_and_b32 s4, s3, 1
  v_lshlrev_b32 v63, 4, v11
  v_lshl_add_u32 v62, v52, 10, v63
  s_lshl_b32 s5, s4, 8
  s_add_u32 s5, s5, 73728
  v_add_u32 v3, s5, v62
  v_xor_b32 v4, 0x100, v3
  s_mul_i32 s5, s3, 6144
  s_add_u32 s6, s5, 98304
  s_add_u32 s5, s5, 73728
  s_xor_b32 s41, s5, s6
  v_lshl_add_u32 v62, v52, 2, v63
  v_add_u32 v5, s5, v62
  s_lshl_b32 s5, s47, 3
  s_add_u32 s5, s5, 4
  v_and_b32 v60, 7, v11
  v_lshrrev_b32 v64, 3, v11
  v_and_b32 v61, 1, v52
  v_lshrrev_b32 v65, 1, v52
  v_lshl_add_u32 v63, v61, 2, s5
  v_and_b32 v63, 511, v63
  v_mul_u32_u24 v63, 0x180, v63
  v_mul_u32_u24 v62, s57, v65
  v_add_u32 v63, v63, v62
  v_lshl_add_u32 v63, v11, 2, v63
  s_lshr_b32 s49, s3, 1
  s_lshl_b32 s5, s49, 6
  s_add_u32 s6, s5, 256
  v_add_u32 v8, s6, v63
  s_lshl_b32 s6, s4, 7
  s_add_u32 s5, s5, s6
  v_add_u32 v7, s5, v63
  s_lshl_b32 s5, s48, 3
  s_xor_b32 s6, s4, 0
  s_lshl_b32 s6, s6, 1
  s_sub_u32 s7, s6, s3
  s_sub_u32 s7, s7, 96
  s_mul_i32 s37, s7, s57
  s_add_u32 s6, s6, s5
  s_add_u32 s6, s6, 484
  s_and_b32 s6, s6, 511
  s_mul_i32 s33, s6, s57
  s_xor_b32 s6, s4, 1
  s_lshl_b32 s6, s6, 1
  s_sub_u32 s7, s6, s3
  s_sub_u32 s7, s7, 96
  s_mul_i32 s38, s7, s57
  s_add_u32 s6, s6, s5
  s_add_u32 s6, s6, 484
  s_and_b32 s6, s6, 511
  s_mul_i32 s34, s6, s57
  s_xor_b32 s6, s4, 2
  s_lshl_b32 s6, s6, 1
  s_sub_u32 s7, s6, s3
  s_sub_u32 s7, s7, 96
  s_mul_i32 s39, s7, s57
  s_add_u32 s6, s6, s5
  s_add_u32 s6, s6, 484
  s_and_b32 s6, s6, 511
  s_mul_i32 s35, s6, s57
  s_xor_b32 s6, s4, 3
  s_lshl_b32 s6, s6, 1
  s_sub_u32 s7, s6, s3
  s_sub_u32 s7, s7, 96
  s_mul_i32 s40, s7, s57
  s_add_u32 s6, s6, s5
  s_add_u32 s6, s6, 484
  s_and_b32 s6, s6, 511
  s_mul_i32 s36, s6, s57
  s_add_u32 s5, s56, 4
  s_mul_i32 s31, s5, s57
  s_add_u32 s5, s56, 8
  s_mul_i32 s32, s5, s57
  s_lshl_b32 s43, s57, 5
  s_mov_b32 s42, 0x3e553b95
  v_lshrrev_b32 v63, 2, v11
  v_lshl_add_u32 v62, v61, 1, v64
  v_lshl_add_u32 v63, v52, 3, v63
  v_lshlrev_b32 v63, 7, v63
  v_lshl_add_u32 v63, v62, 5, v63
  v_and_b32 v67, 3, v11
  v_lshl_add_u32 v63, v67, 3, v63
  s_mul_i32 s5, s3, 3
  s_and_b32 s6, s5, 3
  s_lshl_b32 s6, s6, 5
  s_lshr_b32 s7, s5, 2
  s_lshl_b32 s7, s7, 13
  s_add_u32 s7, s7, 24576
  v_xor_b32 v62, s6, v63
  v_add_u32 v72, s7, v62
  v_add_u32 v59, 73728, v72
  s_add_u32 s5, s5, 1
  s_and_b32 s6, s5, 3
  s_lshl_b32 s6, s6, 5
  s_lshr_b32 s7, s5, 2
  s_lshl_b32 s7, s7, 13
  s_add_u32 s7, s7, 24576
  v_xor_b32 v62, s6, v63
  v_add_u32 v58, s7, v62
  v_add_u32 v57, 73728, v58
  s_add_u32 s5, s5, 1
  s_and_b32 s6, s5, 3
  s_lshl_b32 s6, s6, 5
  s_lshr_b32 s7, s5, 2
  s_lshl_b32 s7, s7, 13
  s_add_u32 s7, s7, 24576
  v_xor_b32 v62, s6, v63
  v_add_u32 v82, s7, v62
  v_add_u32 v56, 73728, v82
  v_xor_b32 v62, s49, v61
  s_lshl_b32 s5, s4, 13
  v_lshl_add_u32 v63, v65, 3, v61
  v_lshl_add_u32 v63, v63, 2, v62
  v_lshl_add_u32 v63, v63, 4, v11
  v_lshlrev_b32 v63, 2, v63
  s_add_u32 s5, s5, 122880
  v_add_u32 v54, s5, v63
  v_add_u32 v53, 128, v54
  v_add_u32 v11, 139264, v63
  v_add_u32 v52, 128, v11
  s_mov_b32 s58, 0x05040100
  s_mov_b32 s59, 0x07060302
  v_cmp_gt_u32 vcc, 2, v67
  v_mov_b32 v63, 0x3f803f80
  v_mov_b32 v62, 0x44444444
  v_cndmask_b32 v63, 0, v63, vcc
  v_cmp_eq_u32 vcc, 1, v67
  v_mov_b32 v66, 0xeeeeeeee
  v_accvgpr_write_b32 a240, v63
  v_accvgpr_write_b32 a241, v63
  v_accvgpr_write_b32 a242, v63
  v_accvgpr_write_b32 a243, v63
  v_cndmask_b32 v10, v62, v66, vcc
  v_mov_b32 v9, 1.0
  v_mov_b64 v[14:15], 0
  v_mov_b64 v[20:21], 0
  v_sub_u32 v63, v64, v65
  v_mul_i32_i24 v63, 15, v63
  v_lshlrev_b32 v62, 2, v61
  v_sub_u32 v66, v60, v62
  v_add3_u32 v63, v63, v66, 19
  s_mul_i32 s5, s3, 2050
  s_add_u32 s5, s5, 147456
  v_lshl_add_u32 v61, v63, 3, s5
  v_mov_b64 v[24:25], 0
  v_mov_b64 v[26:27], 0
  v_mov_b64 v[28:29], 0
  v_mov_b64 v[30:31], 0
  v_mov_b64 v[32:33], 0
  v_mov_b64 v[34:35], 0
  v_mov_b64 v[36:37], 0
  v_mov_b64 v[38:39], 0
  v_mov_b64 v[40:41], 0
  v_mov_b64 v[42:43], 0
  v_mov_b64 v[44:45], 0
  v_mov_b64 v[46:47], 0
  v_mov_b64 v[48:49], 0
  v_mov_b64 v[50:51], 0
  v_xor_b32 v63, v62, v60
  s_cmp_eq_u32 s47, 63
  s_cselect_b32 s5, 4, 0
  v_and_b32 v63, s5, v63
  v_cmp_eq_u32 vcc, 0, v63
  s_cmp_eq_u32 s48, 3
  s_cselect_b32 s5, 0xc31044fe, 0
  v_mov_b32 v89, s5
  v_mov_b32 v63, 0xc31044fe
  v_cndmask_b32 v89, 0, v89, vcc
  v_cndmask_b32 v63, v63, 0, vcc
  s_add_u32 s5, s44, 0
  s_add_u32 m0, s46, 24576
  s_nop 0
  buffer_load_dwordx4 v73, s[12:15], s5 offen offset:0 lds
  s_add_u32 m0, s46, 32640
  s_nop 0
  buffer_load_dwordx4 v73, s[12:15], s5 offen offset:128 lds
  s_add_u32 m0, s46, 40704
  s_nop 0
  buffer_load_dwordx4 v73, s[12:15], s5 offen offset:256 lds
  s_add_u32 s5, s44, 36864
  s_add_u32 m0, s46, 28672
  s_nop 0
  buffer_load_dwordx4 v73, s[12:15], s5 offen offset:0 lds
  s_add_u32 m0, s46, 36736
  s_nop 0
  buffer_load_dwordx4 v73, s[12:15], s5 offen offset:128 lds
  s_add_u32 m0, s46, 44800
  s_nop 0
  buffer_load_dwordx4 v73, s[12:15], s5 offen offset:256 lds
  s_waitcnt vmcnt(12)
  ds_read_u16_d16_hi v24, v61 offset:24
  ds_read_u16_d16_hi v25, v61 offset:16
  ds_read_u16_d16_hi v26, v61 offset:8
  ds_read_u16_d16_hi v27, v61 offset:0
  ds_read_u16_d16_hi v28, v61 offset:264
  ds_read_u16_d16_hi v29, v61 offset:256
  ds_read_u16_d16_hi v30, v61 offset:248
  ds_read_u16_d16_hi v31, v61 offset:240
  ds_read_u16_d16_hi v32, v61 offset:504
  ds_read_u16_d16_hi v33, v61 offset:496
  ds_read_u16_d16_hi v34, v61 offset:488
  ds_read_u16_d16_hi v35, v61 offset:480
  ds_read_u16_d16_hi v36, v61 offset:744
  ds_read_u16_d16_hi v37, v61 offset:736
  ds_read_u16_d16_hi v38, v61 offset:728
  ds_read_u16_d16_hi v39, v61 offset:720
  ds_read_u16_d16_hi v40, v61 offset:984
  ds_read_u16_d16_hi v41, v61 offset:976
  ds_read_u16_d16_hi v42, v61 offset:968
  ds_read_u16_d16_hi v43, v61 offset:960
  ds_read_u16_d16_hi v44, v61 offset:1224
  ds_read_u16_d16_hi v45, v61 offset:1216
  ds_read_u16_d16_hi v46, v61 offset:1208
  ds_read_u16_d16_hi v47, v61 offset:1200
  ds_read_u16_d16_hi v48, v61 offset:1464
  ds_read_u16_d16_hi v49, v61 offset:1456
  ds_read_u16_d16_hi v50, v61 offset:1448
  ds_read_u16_d16_hi v51, v61 offset:1440
  s_mov_b32 s5, 0x3fb8aa3b
  s_waitcnt lgkmcnt(15)
  v_fma_f32 v24, v24, s5, v63
  v_fma_f32 v25, v25, s5, v63
  v_fma_f32 v26, v26, s5, v63
  v_fma_f32 v27, v27, s5, v63
  v_fma_f32 v28, v28, s5, v63
  v_fma_f32 v29, v29, s5, v63
  v_fma_f32 v30, v30, s5, v63
  v_fma_f32 v31, v31, s5, v63
  v_fma_f32 v32, v32, s5, v63
  v_fma_f32 v33, v33, s5, v63
  v_fma_f32 v34, v34, s5, v63
  v_fma_f32 v35, v35, s5, v63
  v_fma_f32 v36, v36, s5, v63
  s_waitcnt lgkmcnt(14)
  v_fma_f32 v37, v37, s5, v63
  s_waitcnt lgkmcnt(13)
  v_fma_f32 v38, v38, s5, v63
  s_waitcnt lgkmcnt(12)
  v_fma_f32 v39, v39, s5, v63
  s_waitcnt lgkmcnt(11)
  v_fma_f32 v40, v40, s5, v63
  s_waitcnt lgkmcnt(10)
  v_fma_f32 v41, v41, s5, v63
  s_waitcnt lgkmcnt(9)
  v_fma_f32 v42, v42, s5, v63
  s_waitcnt lgkmcnt(8)
  v_fma_f32 v43, v43, s5, v63
  s_waitcnt lgkmcnt(7)
  v_fma_f32 v44, v44, s5, v63
  s_waitcnt lgkmcnt(6)
  v_fma_f32 v45, v45, s5, v63
  s_waitcnt lgkmcnt(5)
  v_fma_f32 v46, v46, s5, v63
  s_waitcnt lgkmcnt(4)
  v_fma_f32 v47, v47, s5, v63
  s_waitcnt lgkmcnt(3)
  v_fma_f32 v48, v48, s5, v63
  s_waitcnt lgkmcnt(2)
  v_fma_f32 v49, v49, s5, v63
  s_waitcnt lgkmcnt(1)
  v_fma_f32 v50, v50, s5, v63
  s_waitcnt lgkmcnt(0)
  v_fma_f32 v51, v51, s5, v63
  v_add_f32 v60, v89, v48
  v_add_f32 v61, v89, v49
  v_add_f32 v62, v89, v50
  v_add_f32 v63, v89, v51
  v_add_f32 v74, v89, v44
  v_add_f32 v75, v89, v45
  v_add_f32 v76, v89, v46
  v_add_f32 v77, v89, v47
  v_add_f32 v64, v89, v40
  v_add_f32 v65, v89, v41
  v_add_f32 v66, v89, v42
  v_add_f32 v67, v89, v43
  v_add_f32 v78, v89, v32
  v_add_f32 v79, v89, v33
  v_add_f32 v80, v89, v34
  v_add_f32 v81, v89, v35
  v_add_f32 v84, v89, v28
  v_add_f32 v85, v89, v29
  v_add_f32 v86, v89, v30
  v_add_f32 v87, v89, v31
  v_add_f32 v68, v89, v24
  v_add_f32 v69, v89, v25
  v_add_f32 v70, v89, v26
  v_add_f32 v71, v89, v27
  s_add_u32 s5, s44, 73728
  s_add_u32 m0, s46, 49152
  s_nop 0
  buffer_load_dwordx4 v73, s[12:15], s5 offen offset:0 lds
  s_add_u32 m0, s46, 57216
  s_nop 0
  buffer_load_dwordx4 v73, s[12:15], s5 offen offset:128 lds
  s_add_u32 m0, s46, 65280
  s_nop 0
  buffer_load_dwordx4 v73, s[12:15], s5 offen offset:256 lds
  s_add_u32 s5, s44, 110592
  s_add_u32 m0, s46, 53248
  s_nop 0
  buffer_load_dwordx4 v73, s[12:15], s5 offen offset:0 lds
  s_add_u32 m0, s46, 61312
  s_nop 0
  buffer_load_dwordx4 v73, s[12:15], s5 offen offset:128 lds
  s_add_u32 m0, s46, 69376
  s_nop 0
  buffer_load_dwordx4 v73, s[12:15], s5 offen offset:256 lds
  s_cmp_ge_u32 s50, s14
  s_cselect_b64 s[52:53], s[16:17], s[12:13]
  s_cselect_b64 s[54:55], s[18:19], s[14:15]
  s_cselect_b32 s5, s14, 0
  s_sub_u32 s50, s50, s5
  buffer_load_dword v124, v88, s[52:55], s50 offen
  s_mov_b64 exec, 0
  s_cmp_eq_u32 s3, 0
  s_cbranch_scc1 L_hop_0_0
  s_cmp_eq_u32 s3, 1
  s_cbranch_scc1 L_hop_1_0
  s_cmp_eq_u32 s3, 2
  s_cbranch_scc1 L_hop_2_0
  s_branch L_hop_3_0
  s_nop 0
  s_nop 0
  s_nop 0
  s_nop 0
  s_nop 0
  s_nop 0
  s_nop 0
  s_nop 0
L_walk:
  s_mov_b64 exec, -1
L_walked:
  s_waitcnt vmcnt(13)
  s_barrier
  ds_read_b128 v[184:187], v0 offset:0
  ds_read_b128 v[188:191], v1 offset:0
  ds_read_b128 v[208:211], v0 offset:2048
  ds_read_b128 v[212:215], v1 offset:2048
  ds_read_b128 v[232:235], v0 offset:4096
  ds_read_b128 v[236:239], v1 offset:4096
  ds_read_b128 a[216:219], v0 offset:6144
  ds_read_b128 a[220:223], v1 offset:6144
  s_add_u32 s5, s44, 147456
  s_add_u32 m0, s46, 73728
  s_nop 0
  buffer_load_dwordx4 v73, s[12:15], s5 offen offset:0 lds
  s_add_u32 m0, s46, 81792
  s_nop 0
  buffer_load_dwordx4 v73, s[12:15], s5 offen offset:128 lds
  s_add_u32 m0, s46, 89856
  s_nop 0
  buffer_load_dwordx4 v73, s[12:15], s5 offen offset:256 lds
  s_waitcnt vmcnt(10)
  s_barrier
  ds_read_b64_tr_b16 a[0:1], v72 offset:0
  ds_read_b64_tr_b16 a[2:3], v72 offset:512
  ds_read_b64_tr_b16 a[12:13], v72 offset:4096
  ds_read_b64_tr_b16 a[14:15], v72 offset:4608
  s_waitcnt lgkmcnt(2)
  v_mfma_f32_16x16x32_bf16 v[108:111], a[0:3], v[184:187], 0
  s_add_u32 s5, s44, 184320
  s_add_u32 m0, s46, 77824
  ds_read_b64_tr_b16 a[4:5], v58 offset:0
  s_waitcnt lgkmcnt(1)
  v_mfma_f32_16x16x32_bf16 v[108:111], a[12:15], v[188:191], v[108:111]
  buffer_load_dwordx4 v73, s[12:15], s5 offen offset:0 lds
  v_mfma_f32_16x16x32_bf16 v[126:129], a[0:3], v[208:211], 0
  s_add_u32 m0, s46, 85888
  ds_read_b64_tr_b16 a[6:7], v58 offset:512
  ds_read_b64_tr_b16 a[16:17], v58 offset:4096
  v_mfma_f32_16x16x32_bf16 v[126:129], a[12:15], v[212:215], v[126:129]
  buffer_load_dwordx4 v73, s[12:15], s5 offen offset:128 lds
  v_mfma_f32_16x16x32_bf16 v[92:95], a[0:3], v[232:235], 0
  s_add_u32 m0, s46, 93952
  ds_read_b64_tr_b16 a[18:19], v58 offset:4608
  ds_read_b64_tr_b16 a[8:9], v82 offset:0
  v_mfma_f32_16x16x32_bf16 v[92:95], a[12:15], v[236:239], v[92:95]
  buffer_load_dwordx4 v73, s[12:15], s5 offen offset:256 lds
  v_mfma_f32_16x16x32_bf16 v[96:99], a[0:3], a[216:219], 0
  s_add_u32 s5, s44, 384
  s_add_u32 m0, s46, 98304
  ds_read_b64_tr_b16 a[10:11], v82 offset:512
  v_mfma_f32_16x16x32_bf16 v[96:99], a[12:15], a[220:223], v[96:99]
  s_waitcnt lgkmcnt(3)
  ds_read_b64_tr_b16 a[20:21], v82 offset:4096
  ds_read_b64_tr_b16 a[22:23], v82 offset:4608
  v_mfma_f32_16x16x32_bf16 v[138:141], a[4:7], v[184:187], 0
  buffer_load_dwordx4 v73, s[12:15], s5 offen offset:0 lds
  s_waitcnt lgkmcnt(4)
  v_mfma_f32_16x16x32_bf16 v[138:141], a[16:19], v[188:191], v[138:141]
  s_add_u32 m0, s46, 106368
  ds_read_b128 v[192:195], v0 offset:8192
  ds_read_b128 v[196:199], v1 offset:8192
  v_mfma_f32_16x16x32_bf16 v[116:119], a[4:7], v[208:211], 0
  buffer_load_dwordx4 v73, s[12:15], s5 offen offset:128 lds
  v_mfma_f32_16x16x32_bf16 v[116:119], a[16:19], v[212:215], v[116:119]
  s_add_u32 m0, s46, 114432
  ds_read_b128 v[216:219], v0 offset:10240
  ds_read_b128 v[220:223], v1 offset:10240
  v_mfma_f32_16x16x32_bf16 v[104:107], a[4:7], v[232:235], 0
  buffer_load_dwordx4 v73, s[12:15], s5 offen offset:256 lds
  v_mfma_f32_16x16x32_bf16 v[104:107], a[16:19], v[236:239], v[104:107]
  s_add_u32 s5, s44, 37248
  s_add_u32 m0, s46, 102400
  ds_read_b128 v[240:243], v0 offset:12288
  v_mfma_f32_16x16x32_bf16 v[88:91], a[4:7], a[216:219], 0
  s_waitcnt lgkmcnt(3)
  ds_read_b128 v[244:247], v1 offset:12288
  ds_read_b128 a[224:227], v0 offset:14336
  v_mfma_f32_16x16x32_bf16 v[88:91], a[16:19], a[220:223], v[88:91]
  s_waitcnt vmcnt(10)
  s_barrier
  v_mfma_f32_16x16x32_bf16 v[120:123], a[8:11], v[184:187], 0
  buffer_load_dwordx4 v73, s[12:15], s5 offen offset:0 lds
  v_mfma_f32_16x16x32_bf16 v[120:123], a[20:23], v[188:191], v[120:123]
  s_add_u32 m0, s46, 110464
  ds_read_b64_tr_b16 a[24:25], v72 offset:24576
  ds_read_b64_tr_b16 a[26:27], v72 offset:25088
  v_mfma_f32_16x16x32_bf16 v[134:137], a[8:11], v[208:211], 0
  buffer_load_dwordx4 v73, s[12:15], s5 offen offset:128 lds
  v_mfma_f32_16x16x32_bf16 v[134:137], a[20:23], v[212:215], v[134:137]
  s_add_u32 m0, s46, 118528
  ds_read_b64_tr_b16 a[36:37], v72 offset:28672
  ds_read_b64_tr_b16 a[38:39], v72 offset:29184
  v_mfma_f32_16x16x32_bf16 v[112:115], a[8:11], v[232:235], 0
  buffer_load_dwordx4 v73, s[12:15], s5 offen offset:256 lds
  v_mfma_f32_16x16x32_bf16 v[112:115], a[20:23], v[236:239], v[112:115]
  ds_read_b128 a[228:231], v1 offset:14336
  ds_read_b64_tr_b16 a[28:29], v58 offset:24576
  v_mfma_f32_16x16x32_bf16 v[100:103], a[8:11], a[216:219], 0
  ds_read_b64_tr_b16 a[30:31], v58 offset:25088
  ds_read_b64_tr_b16 a[40:41], v58 offset:28672
  v_mfma_f32_16x16x32_bf16 v[100:103], a[20:23], a[220:223], v[100:103]
  s_waitcnt lgkmcnt(6)
  ds_read_b64_tr_b16 a[42:43], v58 offset:29184
  ds_read_b64_tr_b16 a[32:33], v82 offset:24576
  v_mfma_f32_16x16x32_bf16 v[108:111], a[24:27], v[192:195], v[108:111]
  s_waitcnt lgkmcnt(6)
  ds_read_b64_tr_b16 a[34:35], v82 offset:25088
  ds_read_b64_tr_b16 a[44:45], v82 offset:28672
  v_mfma_f32_16x16x32_bf16 v[108:111], a[36:39], v[196:199], v[108:111]
  ds_read_b64_tr_b16 a[46:47], v82 offset:29184
  ds_read_b128 v[200:203], v0 offset:16384
  v_mfma_f32_16x16x32_bf16 v[126:129], a[24:27], v[216:219], v[126:129]
  ds_read_b128 v[204:207], v1 offset:16384
  ds_read_b128 v[224:227], v0 offset:18432
  v_mfma_f32_16x16x32_bf16 v[126:129], a[36:39], v[220:223], v[126:129]
  ds_read_b128 v[228:231], v1 offset:18432
  ds_read_b128 v[248:251], v0 offset:20480
  v_mfma_f32_16x16x32_bf16 v[92:95], a[24:27], v[240:243], v[92:95]
L_hop_0_0:
  s_cbranch_execz L_hop_0_1
  ds_read_b128 v[252:255], v1 offset:20480
  ds_read_b128 a[232:235], v0 offset:22528
  v_mfma_f32_16x16x32_bf16 v[92:95], a[36:39], v[244:247], v[92:95]
  s_add_u32 s5, s44, 74112
  s_add_u32 m0, s46, 122880
  ds_read_b128 a[236:239], v1 offset:22528
  v_mfma_f32_16x16x32_bf16 v[96:99], a[24:27], a[224:227], v[96:99]
  s_waitcnt lgkmcnt(7)
  v_mfma_f32_16x16x32_bf16 v[96:99], a[36:39], a[228:231], v[96:99]
  v_mfma_f32_16x16x32_bf16 v[138:141], a[28:31], v[192:195], v[138:141]
  buffer_load_dwordx4 v73, s[12:15], s5 offen offset:0 lds
  v_mfma_f32_16x16x32_bf16 v[138:141], a[40:43], v[196:199], v[138:141]
  s_add_u32 m0, s46, 130944
  v_mfma_f32_16x16x32_bf16 v[116:119], a[28:31], v[216:219], v[116:119]
  buffer_load_dwordx4 v73, s[12:15], s5 offen offset:128 lds
  v_mfma_f32_16x16x32_bf16 v[116:119], a[40:43], v[220:223], v[116:119]
  s_add_u32 m0, s46, 139008
  v_mfma_f32_16x16x32_bf16 v[104:107], a[28:31], v[240:243], v[104:107]
  buffer_load_dwordx4 v73, s[12:15], s5 offen offset:256 lds
  v_mfma_f32_16x16x32_bf16 v[104:107], a[40:43], v[244:247], v[104:107]
  s_add_u32 s5, s44, 110976
  s_add_u32 m0, s46, 126976
  v_mfma_f32_16x16x32_bf16 v[88:91], a[28:31], a[224:227], v[88:91]
  v_mfma_f32_16x16x32_bf16 v[88:91], a[40:43], a[228:231], v[88:91]
  s_waitcnt vmcnt(9)
  s_barrier
  v_mfma_f32_16x16x32_bf16 v[120:123], a[32:35], v[192:195], v[120:123]
  buffer_load_dwordx4 v73, s[12:15], s5 offen offset:0 lds
  v_mfma_f32_16x16x32_bf16 v[120:123], a[44:47], v[196:199], v[120:123]
  s_add_u32 m0, s46, 135040
  ds_read_b64_tr_b16 a[48:49], v72 offset:49152
  ds_read_b64_tr_b16 a[50:51], v72 offset:49664
  v_mfma_f32_16x16x32_bf16 v[134:137], a[32:35], v[216:219], v[134:137]
  buffer_load_dwordx4 v73, s[12:15], s5 offen offset:128 lds
  v_mfma_f32_16x16x32_bf16 v[134:137], a[44:47], v[220:223], v[134:137]
  s_add_u32 m0, s46, 143104
  ds_read_b64_tr_b16 a[60:61], v72 offset:53248
  ds_read_b64_tr_b16 a[62:63], v72 offset:53760
  v_mfma_f32_16x16x32_bf16 v[112:115], a[32:35], v[240:243], v[112:115]
  buffer_load_dwordx4 v73, s[12:15], s5 offen offset:256 lds
  v_mfma_f32_16x16x32_bf16 v[112:115], a[44:47], v[244:247], v[112:115]
  ds_read_b64_tr_b16 a[52:53], v58 offset:49152
  ds_read_b64_tr_b16 a[54:55], v58 offset:49664
  v_mfma_f32_16x16x32_bf16 v[100:103], a[32:35], a[224:227], v[100:103]
  ds_read_b64_tr_b16 a[64:65], v58 offset:53248
  ds_read_b64_tr_b16 a[66:67], v58 offset:53760
  v_mfma_f32_16x16x32_bf16 v[100:103], a[44:47], a[228:231], v[100:103]
  s_waitcnt lgkmcnt(6)
  ds_read_b64_tr_b16 a[56:57], v82 offset:49152
  ds_read_b64_tr_b16 a[58:59], v82 offset:49664
  v_mfma_f32_16x16x32_bf16 v[108:111], a[48:51], v[200:203], v[108:111]
  s_waitcnt lgkmcnt(6)
  ds_read_b64_tr_b16 a[68:69], v82 offset:53248
  ds_read_b64_tr_b16 a[70:71], v82 offset:53760
  v_mfma_f32_16x16x32_bf16 v[108:111], a[60:63], v[204:207], v[108:111]
  v_mfma_f32_16x16x32_bf16 v[126:129], a[48:51], v[224:227], v[126:129]
  v_mfma_f32_16x16x32_bf16 v[126:129], a[60:63], v[228:231], v[126:129]
  v_mfma_f32_16x16x32_bf16 v[92:95], a[48:51], v[248:251], v[92:95]
  v_mul_f32 v108, s42, v108
  v_mul_f32 v109, s42, v109
  v_mfma_f32_16x16x32_bf16 v[92:95], a[60:63], v[252:255], v[92:95]
  s_add_u32 s5, s44, 147840
  s_add_u32 m0, s46, 24576
  v_mul_f32 v110, s42, v110
  v_mfma_f32_16x16x32_bf16 v[96:99], a[48:51], a[232:235], v[96:99]
  v_mul_f32 v111, s42, v111
  v_cvt_pk_bf16_f32 v12, v108, v109
  v_mfma_f32_16x16x32_bf16 v[96:99], a[60:63], a[236:239], v[96:99]
  s_waitcnt lgkmcnt(0)
  v_cvt_pk_bf16_f32 v13, v110, v111
  v_mul_f32 v126, s42, v126
  v_mfma_f32_16x16x32_bf16 v[138:141], a[52:55], v[200:203], v[138:141]
  buffer_load_dwordx4 v73, s[12:15], s5 offen offset:0 lds
  v_mfma_f32_16x16x32_bf16 v[138:141], a[64:67], v[204:207], v[138:141]
  s_add_u32 m0, s46, 32640
  v_mul_f32 v127, s42, v127
  v_mul_f32 v128, s42, v128
  v_mfma_f32_16x16x32_bf16 v[116:119], a[52:55], v[224:227], v[116:119]
  buffer_load_dwordx4 v73, s[12:15], s5 offen offset:128 lds
  v_mfma_f32_16x16x32_bf16 v[116:119], a[64:67], v[228:231], v[116:119]
  s_add_u32 m0, s46, 40704
  v_mul_f32 v129, s42, v129
  v_cvt_pk_bf16_f32 v108, v126, v127
  v_mfma_f32_16x16x32_bf16 v[104:107], a[52:55], v[248:251], v[104:107]
  buffer_load_dwordx4 v73, s[12:15], s5 offen offset:256 lds
  v_mfma_f32_16x16x32_bf16 v[104:107], a[64:67], v[252:255], v[104:107]
  s_add_u32 s5, s44, 184704
  s_add_u32 m0, s46, 28672
  v_mul_f32 v138, s42, v138
  v_mfma_f32_16x16x32_bf16 v[88:91], a[52:55], a[232:235], v[88:91]
  v_mul_f32 v139, s42, v139
  v_mul_f32 v140, s42, v140
  v_mfma_f32_16x16x32_bf16 v[88:91], a[64:67], a[236:239], v[88:91]
  s_waitcnt vmcnt(9)
  s_barrier
  v_mfma_f32_16x16x32_bf16 v[120:123], a[56:59], v[200:203], v[120:123]
  buffer_load_dwordx4 v73, s[12:15], s5 offen offset:0 lds
  v_mfma_f32_16x16x32_bf16 v[120:123], a[68:71], v[204:207], v[120:123]
  s_add_u32 m0, s46, 36736
  ds_read_b64_tr_b16 a[72:73], v59 offset:0
  ds_read_b64_tr_b16 a[74:75], v59 offset:512
  v_mfma_f32_16x16x32_bf16 v[134:137], a[56:59], v[224:227], v[134:137]
  buffer_load_dwordx4 v73, s[12:15], s5 offen offset:128 lds
  v_mfma_f32_16x16x32_bf16 v[134:137], a[68:71], v[228:231], v[134:137]
  s_add_u32 m0, s46, 44800
  ds_read_b64_tr_b16 a[84:85], v59 offset:4096
  ds_read_b64_tr_b16 a[86:87], v59 offset:4608
  v_mfma_f32_16x16x32_bf16 v[112:115], a[56:59], v[248:251], v[112:115]
  buffer_load_dwordx4 v73, s[12:15], s5 offen offset:256 lds
  v_mfma_f32_16x16x32_bf16 v[112:115], a[68:71], v[252:255], v[112:115]
  ds_read_b64_tr_b16 a[76:77], v57 offset:0
  ds_read_b64_tr_b16 a[78:79], v57 offset:512
  v_mfma_f32_16x16x32_bf16 v[100:103], a[56:59], a[232:235], v[100:103]
  ds_read_b64_tr_b16 a[88:89], v57 offset:4096
  ds_read_b64_tr_b16 a[90:91], v57 offset:4608
  v_mfma_f32_16x16x32_bf16 v[100:103], a[68:71], a[236:239], v[100:103]
  s_waitcnt lgkmcnt(6)
  ds_read_b64_tr_b16 a[80:81], v56 offset:0
  ds_read_b64_tr_b16 a[82:83], v56 offset:512
  v_mfma_f32_16x16x32_bf16 v[130:133], a[72:75], v[184:187], 0
  s_waitcnt lgkmcnt(6)
  ds_read_b64_tr_b16 a[92:93], v56 offset:4096
  ds_read_b64_tr_b16 a[94:95], v56 offset:4608
  v_mfma_f32_16x16x32_bf16 v[130:133], a[84:87], v[188:191], v[130:133]
  v_mul_f32 v141, s42, v141
  v_cvt_pk_bf16_f32 v124, v138, v139
  v_mfma_f32_16x16x32_bf16 v[142:145], a[72:75], v[208:211], 0
  v_cvt_pk_bf16_f32 v125, v140, v141
  v_mul_f32 v120, s42, v120
  v_mfma_f32_16x16x32_bf16 v[142:145], a[84:87], v[212:215], v[142:145]
  v_mul_f32 v121, s42, v121
  v_mul_f32 v122, s42, v122
  v_mfma_f32_16x16x32_bf16 v[162:165], a[72:75], v[232:235], 0
  v_mul_f32 v123, s42, v123
  v_cvt_pk_bf16_f32 v126, v120, v121
  v_mfma_f32_16x16x32_bf16 v[162:165], a[84:87], v[236:239], v[162:165]
  s_add_u32 s5, s44, 768
  s_add_u32 m0, s46, 49152
  v_cvt_pk_bf16_f32 v127, v122, v123
  v_mfma_f32_16x16x32_bf16 v[158:161], a[72:75], a[216:219], 0
  v_cvt_pk_bf16_f32 v109, v128, v129
  v_mul_f32 v116, s42, v116
  v_mfma_f32_16x16x32_bf16 v[158:161], a[84:87], a[220:223], v[158:161]
  s_waitcnt lgkmcnt(0)
  v_mul_f32 v117, s42, v117
  v_mul_f32 v118, s42, v118
  v_mfma_f32_16x16x32_bf16 v[154:157], a[76:79], v[184:187], 0
  buffer_load_dwordx4 v73, s[12:15], s5 offen offset:0 lds
  v_mfma_f32_16x16x32_bf16 v[154:157], a[88:91], v[188:191], v[154:157]
  s_add_u32 m0, s46, 57216
  v_mul_f32 v119, s42, v119
  v_cvt_pk_bf16_f32 v110, v116, v117
  v_mfma_f32_16x16x32_bf16 v[174:177], a[76:79], v[208:211], 0
  buffer_load_dwordx4 v73, s[12:15], s5 offen offset:128 lds
  v_mfma_f32_16x16x32_bf16 v[174:177], a[88:91], v[212:215], v[174:177]
  s_add_u32 m0, s46, 65280
  v_cvt_pk_bf16_f32 v111, v118, v119
  v_mul_f32 v134, s42, v134
  v_mfma_f32_16x16x32_bf16 v[180:183], a[76:79], v[232:235], 0
  buffer_load_dwordx4 v73, s[12:15], s5 offen offset:256 lds
  v_mfma_f32_16x16x32_bf16 v[180:183], a[88:91], v[236:239], v[180:183]
  s_add_u32 s5, s44, 37632
  s_add_u32 m0, s46, 53248
  v_mul_f32 v135, s42, v135
  v_mfma_f32_16x16x32_bf16 v[166:169], a[76:79], a[216:219], 0
  v_mul_f32 v136, s42, v136
  v_mul_f32 v137, s42, v137
  v_mfma_f32_16x16x32_bf16 v[166:169], a[88:91], a[220:223], v[166:169]
  s_waitcnt vmcnt(9)
  s_barrier
  v_mfma_f32_16x16x32_bf16 v[170:173], a[80:83], v[184:187], 0
  buffer_load_dwordx4 v73, s[12:15], s5 offen offset:0 lds
  v_mfma_f32_16x16x32_bf16 v[170:173], a[92:95], v[188:191], v[170:173]
  s_add_u32 m0, s46, 61312
  ds_read_b64_tr_b16 a[96:97], v59 offset:24576
  ds_read_b64_tr_b16 a[98:99], v59 offset:25088
  v_mfma_f32_16x16x32_bf16 v[120:123], a[80:83], v[208:211], 0
  buffer_load_dwordx4 v73, s[12:15], s5 offen offset:128 lds
  v_mfma_f32_16x16x32_bf16 v[120:123], a[92:95], v[212:215], v[120:123]
  s_add_u32 m0, s46, 69376
  ds_read_b64_tr_b16 a[108:109], v59 offset:28672
  ds_read_b64_tr_b16 a[110:111], v59 offset:29184
  v_mfma_f32_16x16x32_bf16 v[146:149], a[80:83], v[232:235], 0
  buffer_load_dwordx4 v73, s[12:15], s5 offen offset:256 lds
  v_mfma_f32_16x16x32_bf16 v[146:149], a[92:95], v[236:239], v[146:149]
  ds_read_b64_tr_b16 a[100:101], v57 offset:24576
  ds_read_b64_tr_b16 a[102:103], v57 offset:25088
  v_mfma_f32_16x16x32_bf16 v[138:141], a[80:83], a[216:219], 0
  ds_read_b64_tr_b16 a[112:113], v57 offset:28672
  ds_read_b64_tr_b16 a[114:115], v57 offset:29184
  v_mfma_f32_16x16x32_bf16 v[138:141], a[92:95], a[220:223], v[138:141]
  s_waitcnt lgkmcnt(6)
  ds_read_b64_tr_b16 a[104:105], v56 offset:24576
  ds_read_b64_tr_b16 a[106:107], v56 offset:25088
  v_mfma_f32_16x16x32_bf16 v[130:133], a[96:99], v[192:195], v[130:133]
  s_waitcnt lgkmcnt(6)
  ds_read_b64_tr_b16 a[116:117], v56 offset:28672
  ds_read_b64_tr_b16 a[118:119], v56 offset:29184
  v_mfma_f32_16x16x32_bf16 v[130:133], a[108:111], v[196:199], v[130:133]
  v_cvt_pk_bf16_f32 v16, v134, v135
  v_cvt_pk_bf16_f32 v17, v136, v137
  v_mfma_f32_16x16x32_bf16 v[142:145], a[96:99], v[216:219], v[142:145]
  v_mul_f32 v92, s42, v92
  v_mul_f32 v93, s42, v93
  v_mfma_f32_16x16x32_bf16 v[142:145], a[108:111], v[220:223], v[142:145]
  v_mul_f32 v94, s42, v94
  v_mul_f32 v95, s42, v95
  v_mfma_f32_16x16x32_bf16 v[162:165], a[96:99], v[240:243], v[162:165]
  v_cvt_pk_bf16_f32 v18, v92, v93
  v_cvt_pk_bf16_f32 v19, v94, v95
  v_mfma_f32_16x16x32_bf16 v[162:165], a[108:111], v[244:247], v[162:165]
  s_add_u32 s5, s44, 74496
  s_add_u32 m0, s46, 73728
  v_mul_f32 v104, s42, v104
  v_mfma_f32_16x16x32_bf16 v[158:161], a[96:99], a[224:227], v[158:161]
  v_mul_f32 v105, s42, v105
  v_mul_f32 v106, s42, v106
  v_mfma_f32_16x16x32_bf16 v[158:161], a[108:111], a[228:231], v[158:161]
  s_waitcnt lgkmcnt(0)
  v_mul_f32 v107, s42, v107
  v_cvt_pk_bf16_f32 v134, v104, v105
  v_mfma_f32_16x16x32_bf16 v[154:157], a[100:103], v[192:195], v[154:157]
  buffer_load_dwordx4 v73, s[12:15], s5 offen offset:0 lds
  v_mfma_f32_16x16x32_bf16 v[154:157], a[112:115], v[196:199], v[154:157]
  s_add_u32 m0, s46, 81792
  v_cvt_pk_bf16_f32 v135, v106, v107
  v_mul_f32 v112, s42, v112
  v_mfma_f32_16x16x32_bf16 v[174:177], a[100:103], v[216:219], v[174:177]
  buffer_load_dwordx4 v73, s[12:15], s5 offen offset:128 lds
  v_mfma_f32_16x16x32_bf16 v[174:177], a[112:115], v[220:223], v[174:177]
  s_add_u32 m0, s46, 89856
  v_mul_f32 v113, s42, v113
  v_mul_f32 v114, s42, v114
  v_mfma_f32_16x16x32_bf16 v[180:183], a[100:103], v[240:243], v[180:183]
  buffer_load_dwordx4 v73, s[12:15], s5 offen offset:256 lds
  v_mfma_f32_16x16x32_bf16 v[180:183], a[112:115], v[244:247], v[180:183]
  s_add_u32 s5, s44, 111360
  s_add_u32 m0, s46, 77824
  v_mul_f32 v115, s42, v115
  v_mfma_f32_16x16x32_bf16 v[166:169], a[100:103], a[224:227], v[166:169]
  v_cvt_pk_bf16_f32 v136, v112, v113
  v_cvt_pk_bf16_f32 v137, v114, v115
  v_mfma_f32_16x16x32_bf16 v[166:169], a[112:115], a[228:231], v[166:169]
  s_waitcnt vmcnt(9)
  s_barrier
  v_mfma_f32_16x16x32_bf16 v[170:173], a[104:107], v[192:195], v[170:173]
  buffer_load_dwordx4 v73, s[12:15], s5 offen offset:0 lds
  v_mfma_f32_16x16x32_bf16 v[170:173], a[116:119], v[196:199], v[170:173]
  s_add_u32 m0, s46, 85888
  ds_read_b64_tr_b16 a[120:121], v72 offset:0
  ds_read_b64_tr_b16 a[122:123], v72 offset:512
  v_mfma_f32_16x16x32_bf16 v[120:123], a[104:107], v[216:219], v[120:123]
  buffer_load_dwordx4 v73, s[12:15], s5 offen offset:128 lds
  v_mfma_f32_16x16x32_bf16 v[120:123], a[116:119], v[220:223], v[120:123]
  s_add_u32 m0, s46, 93952
  ds_read_b64_tr_b16 a[132:133], v72 offset:4096
  ds_read_b64_tr_b16 a[134:135], v72 offset:4608
  v_mfma_f32_16x16x32_bf16 v[146:149], a[104:107], v[240:243], v[146:149]
  buffer_load_dwordx4 v73, s[12:15], s5 offen offset:256 lds
  v_mfma_f32_16x16x32_bf16 v[146:149], a[116:119], v[244:247], v[146:149]
  ds_read_b64_tr_b16 a[124:125], v58 offset:0
  ds_read_b64_tr_b16 a[126:127], v58 offset:512
  v_mfma_f32_16x16x32_bf16 v[138:141], a[104:107], a[224:227], v[138:141]
  ds_read_b64_tr_b16 a[136:137], v58 offset:4096
  ds_read_b64_tr_b16 a[138:139], v58 offset:4608
  v_mfma_f32_16x16x32_bf16 v[138:141], a[116:119], a[228:231], v[138:141]
  s_waitcnt lgkmcnt(6)
  ds_read_b64_tr_b16 a[128:129], v82 offset:0
  ds_read_b64_tr_b16 a[130:131], v82 offset:512
  v_mfma_f32_16x16x32_bf16 v[130:133], a[120:123], v[200:203], v[130:133]
  s_waitcnt lgkmcnt(6)
  ds_read_b64_tr_b16 a[140:141], v82 offset:4096
  ds_read_b64_tr_b16 a[142:143], v82 offset:4608
  v_mfma_f32_16x16x32_bf16 v[130:133], a[132:135], v[204:207], v[130:133]
  v_mul_f32 v96, s42, v96
  v_mul_f32 v97, s42, v97
  v_mfma_f32_16x16x32_bf16 v[142:145], a[120:123], v[224:227], v[142:145]
  v_mul_f32 v98, s42, v98
  v_mul_f32 v99, s42, v99
  v_mfma_f32_16x16x32_bf16 v[142:145], a[132:135], v[228:231], v[142:145]
  v_cvt_pk_bf16_f32 v178, v96, v97
  v_cvt_pk_bf16_f32 v179, v98, v99
  v_mfma_f32_16x16x32_bf16 v[162:165], a[120:123], v[248:251], v[162:165]
  v_cvt_pk_bf16_f32 v150, v130, v131
  v_cvt_pk_bf16_f32 v151, v132, v133
  v_mfma_f32_16x16x32_bf16 v[162:165], a[132:135], v[252:255], v[162:165]
  s_add_u32 s5, s44, 148224
  s_add_u32 m0, s46, 98304
  v_mul_f32 v88, s42, v88
  v_mfma_f32_16x16x32_bf16 v[158:161], a[120:123], a[232:235], v[158:161]
  v_cvt_pk_bf16_f32 v128, v142, v143
  v_cvt_pk_bf16_f32 v129, v144, v145
  v_mfma_f32_16x16x32_bf16 v[158:161], a[132:135], a[236:239], v[158:161]
  s_waitcnt lgkmcnt(0)
  v_mul_f32 v89, s42, v89
  v_mul_f32 v90, s42, v90
  v_mfma_f32_16x16x32_bf16 v[154:157], a[124:127], v[200:203], v[154:157]
  buffer_load_dwordx4 v73, s[12:15], s5 offen offset:0 lds
  v_mfma_f32_16x16x32_bf16 v[154:157], a[136:139], v[204:207], v[154:157]
  s_add_u32 m0, s46, 106368
  v_cvt_pk_bf16_f32 v116, v162, v163
  v_cvt_pk_bf16_f32 v117, v164, v165
  v_mfma_f32_16x16x32_bf16 v[174:177], a[124:127], v[224:227], v[174:177]
  buffer_load_dwordx4 v73, s[12:15], s5 offen offset:128 lds
  v_mfma_f32_16x16x32_bf16 v[174:177], a[136:139], v[228:231], v[174:177]
  s_add_u32 m0, s46, 114432
  v_cvt_pk_bf16_f32 v142, v158, v159
  v_cvt_pk_bf16_f32 v143, v160, v161
  v_mfma_f32_16x16x32_bf16 v[180:183], a[124:127], v[248:251], v[180:183]
  buffer_load_dwordx4 v73, s[12:15], s5 offen offset:256 lds
  v_mfma_f32_16x16x32_bf16 v[180:183], a[136:139], v[252:255], v[180:183]
  s_add_u32 s5, s44, 185088
  s_add_u32 m0, s46, 102400
  v_cvt_pk_bf16_f32 v152, v154, v155
  v_mfma_f32_16x16x32_bf16 v[166:169], a[124:127], a[232:235], v[166:169]
  v_cvt_pk_bf16_f32 v153, v156, v157
  v_cvt_pk_bf16_f32 v130, v174, v175
  v_mfma_f32_16x16x32_bf16 v[166:169], a[136:139], a[236:239], v[166:169]
  v_cvt_pk_bf16_f32 v131, v176, v177
  v_mul_f32 v91, s42, v91
  v_mfma_f32_16x16x32_bf16 v[170:173], a[128:131], v[200:203], v[170:173]
  buffer_load_dwordx4 v73, s[12:15], s5 offen offset:0 lds
  v_mfma_f32_16x16x32_bf16 v[170:173], a[140:143], v[204:207], v[170:173]
  s_add_u32 m0, s46, 110464
  v_cvt_pk_bf16_f32 v118, v180, v181
  v_cvt_pk_bf16_f32 v119, v182, v183
  v_mfma_f32_16x16x32_bf16 v[120:123], a[128:131], v[224:227], v[120:123]
  buffer_load_dwordx4 v73, s[12:15], s5 offen offset:128 lds
  v_mfma_f32_16x16x32_bf16 v[120:123], a[140:143], v[228:231], v[120:123]
  s_add_u32 m0, s46, 118528
  v_cvt_pk_bf16_f32 v144, v166, v167
  v_cvt_pk_bf16_f32 v145, v168, v169
  v_mfma_f32_16x16x32_bf16 v[146:149], a[128:131], v[248:251], v[146:149]
  buffer_load_dwordx4 v73, s[12:15], s5 offen offset:256 lds
  v_mfma_f32_16x16x32_bf16 v[146:149], a[140:143], v[252:255], v[146:149]
  v_cvt_pk_bf16_f32 v154, v170, v171
  v_cvt_pk_bf16_f32 v155, v172, v173
  v_mfma_f32_16x16x32_bf16 v[138:141], a[128:131], a[232:235], v[138:141]
  v_cvt_pk_bf16_f32 v132, v120, v121
  v_cvt_pk_bf16_f32 v133, v122, v123
  v_mfma_f32_16x16x32_bf16 v[138:141], a[140:143], a[236:239], v[138:141]
  v_cvt_pk_bf16_f32 v180, v88, v89
  v_cvt_pk_bf16_f32 v181, v90, v91
  v_mfma_f32_16x16x32_bf16 v[92:95], v[152:155], v[124:127], v[36:39]
  v_cvt_pk_bf16_f32 v120, v146, v147
  v_cvt_pk_bf16_f32 v121, v148, v149
  v_mfma_f32_16x16x32_bf16 v[92:95], v[150:153], v[12:15], v[92:95]
  v_mul_f32 v100, s42, v100
  v_mul_f32 v101, s42, v101
  v_mfma_f32_16x16x32_bf16 v[96:99], v[130:133], v[124:127], v[32:35]
  v_cvt_pk_bf16_f32 v146, v138, v139
  v_cvt_pk_bf16_f32 v147, v140, v141
  v_mfma_f32_16x16x32_bf16 v[96:99], v[128:131], v[12:15], v[96:99]
  v_mul_f32 v102, s42, v102
  v_mul_f32 v103, s42, v103
  v_mfma_f32_16x16x32_bf16 v[160:163], v[118:121], v[124:127], v[84:87]
  v_cvt_pk_bf16_f32 v22, v100, v101
  v_cvt_pk_bf16_f32 v23, v102, v103
  v_mfma_f32_16x16x32_bf16 v[160:163], v[116:119], v[12:15], v[160:163]
  v_exp_f32 v92, v92
  v_mfma_f32_16x16x32_bf16 v[156:159], v[144:147], v[124:127], v[68:71]
  v_exp_f32 v93, v93
  v_mfma_f32_16x16x32_bf16 v[156:159], v[142:145], v[12:15], v[156:159]
  v_exp_f32 v94, v94
  v_mfma_f32_16x16x32_bf16 v[100:103], v[150:153], v[108:111], v[40:43]
  v_exp_f32 v95, v95
  v_mfma_f32_16x16x32_bf16 v[100:103], v[152:155], v[14:17], v[100:103]
  v_exp_f32 v96, v96
  v_mfma_f32_16x16x32_bf16 v[104:107], v[128:131], v[108:111], v[36:39]
  v_exp_f32 v97, v97
  v_mfma_f32_16x16x32_bf16 v[104:107], v[130:133], v[14:17], v[104:107]
  v_exp_f32 v98, v98
  v_mfma_f32_16x16x32_bf16 v[122:125], v[116:119], v[108:111], v[78:81]
  s_add_u32 m0, s28, 0
  v_exp_f32 v99, v99
  v_mfma_f32_16x16x32_bf16 v[122:125], v[118:121], v[14:17], v[122:125]
  v_exp_f32 v160, v160
  v_mfma_f32_16x16x32_bf16 v[138:141], v[142:145], v[108:111], v[84:87]
  s_waitcnt vmcnt(6)
  s_barrier
  v_mfma_f32_16x16x32_bf16 v[138:141], v[144:147], v[14:17], v[138:141]
  buffer_load_dwordx4 v6, s[8:11], s31 offen offset:0 nt lds
  v_mfma_f32_16x16x32_bf16 v[108:111], v[152:155], v[134:137], v[74:77]
  s_add_u32 m0, s28, 8064
  ds_read_b64_tr_b16 a[144:145], v72 offset:24576
  ds_read_b64_tr_b16 a[146:147], v72 offset:25088
  v_mfma_f32_16x16x32_bf16 v[108:111], v[150:153], v[18:21], v[108:111]
  ds_read_b64_tr_b16 a[156:157], v72 offset:28672
  ds_read_b64_tr_b16 a[158:159], v72 offset:29184
  v_mfma_f32_16x16x32_bf16 v[112:115], v[130:133], v[134:137], v[64:67]
  buffer_load_dwordx4 v6, s[8:11], s31 offen offset:128 nt lds
  v_mfma_f32_16x16x32_bf16 v[112:115], v[128:131], v[18:21], v[112:115]
  s_add_u32 m0, s28, 16128
  ds_read_b64_tr_b16 a[148:149], v58 offset:24576
  ds_read_b64_tr_b16 a[150:151], v58 offset:25088
  v_mfma_f32_16x16x32_bf16 v[68:71], v[118:121], v[134:137], v[36:39]
  ds_read_b64_tr_b16 a[160:161], v58 offset:28672
  ds_read_b64_tr_b16 a[162:163], v58 offset:29184
  v_mfma_f32_16x16x32_bf16 v[68:71], v[116:119], v[18:21], v[68:71]
  buffer_load_dwordx4 v6, s[8:11], s31 offen offset:256 nt lds
  v_mfma_f32_16x16x32_bf16 v[64:67], v[144:147], v[134:137], v[32:35]
  s_add_u32 s31, s31, s43
  ds_read_b64_tr_b16 a[152:153], v82 offset:24576
  ds_read_b64_tr_b16 a[154:155], v82 offset:25088
  v_mfma_f32_16x16x32_bf16 v[64:67], v[142:145], v[18:21], v[64:67]
  ds_read_b64_tr_b16 a[164:165], v82 offset:28672
  ds_read_b64_tr_b16 a[166:167], v82 offset:29184
  v_mfma_f32_16x16x32_bf16 v[84:87], v[150:153], v[178:181], v[60:63]
  ds_read_b64_tr_b16 a[168:169], v72 offset:49152
  ds_read_b64_tr_b16 a[170:171], v72 offset:49664
  v_mfma_f32_16x16x32_bf16 v[84:87], v[152:155], v[20:23], v[84:87]
  ds_read_b64_tr_b16 a[180:181], v72 offset:53248
  ds_read_b64_tr_b16 a[182:183], v72 offset:53760
  v_mfma_f32_16x16x32_bf16 v[88:91], v[128:131], v[178:181], v[74:77]
  ds_read_b64_tr_b16 a[172:173], v58 offset:49152
  ds_read_b64_tr_b16 a[174:175], v58 offset:49664
  v_mfma_f32_16x16x32_bf16 v[88:91], v[130:133], v[20:23], v[88:91]
  ds_read_b64_tr_b16 a[184:185], v58 offset:53248
  ds_read_b64_tr_b16 a[186:187], v58 offset:53760
  v_mfma_f32_16x16x32_bf16 v[72:75], v[116:119], v[178:181], v[40:43]
  ds_read_b64_tr_b16 a[176:177], v82 offset:49152
  ds_read_b64_tr_b16 a[178:179], v82 offset:49664
  v_mfma_f32_16x16x32_bf16 v[72:75], v[118:121], v[20:23], v[72:75]
  ds_read_b64_tr_b16 a[188:189], v82 offset:53248
  ds_read_b64_tr_b16 a[190:191], v82 offset:53760
  v_mfma_f32_16x16x32_bf16 v[60:63], v[142:145], v[178:181], v[36:39]
  v_exp_f32 v161, v161
  v_mfma_f32_16x16x32_bf16 v[60:63], v[144:147], v[20:23], v[60:63]
  s_waitcnt lgkmcnt(6)
  v_exp_f32 v162, v162
  v_mfma_f32_16x16x32_bf16 v[134:137], v[184:187], a[144:147], 0
  v_exp_f32 v163, v163
  v_mfma_f32_16x16x32_bf16 v[134:137], v[188:191], a[156:159], v[134:137]
  v_exp_f32 v156, v156
  v_mfma_f32_16x16x32_bf16 v[130:133], v[184:187], a[148:151], 0
  v_exp_f32 v157, v157
  v_mfma_f32_16x16x32_bf16 v[130:133], v[188:191], a[160:163], v[130:133]
  v_exp_f32 v158, v158
  v_mfma_f32_16x16x32_bf16 v[78:81], v[184:187], a[152:155], 0
  v_exp_f32 v159, v159
  v_mfma_f32_16x16x32_bf16 v[78:81], v[188:191], a[164:167], v[78:81]
  v_cvt_pk_bf16_f32 v92, v92, v93
  v_cvt_pk_bf16_f32 v93, v94, v95
  v_mfma_f32_16x16x32_bf16 v[116:119], v[208:211], a[144:147], 0
  v_cvt_pk_bf16_f32 v94, v96, v97
  v_cvt_pk_bf16_f32 v95, v98, v99
  v_mfma_f32_16x16x32_bf16 v[116:119], v[212:215], a[156:159], v[116:119]
  v_cvt_pk_bf16_f32 v96, v160, v161
  v_cvt_pk_bf16_f32 v97, v162, v163
  v_mfma_f32_16x16x32_bf16 v[126:129], v[208:211], a[148:151], 0
  v_cvt_pk_bf16_f32 v98, v156, v157
  v_cvt_pk_bf16_f32 v99, v158, v159
  v_mfma_f32_16x16x32_bf16 v[126:129], v[212:215], a[160:163], v[126:129]
  v_exp_f32 v100, v100
  v_mfma_f32_16x16x32_bf16 v[142:145], v[208:211], a[152:155], 0
  v_exp_f32 v101, v101
  v_mfma_f32_16x16x32_bf16 v[142:145], v[212:215], a[164:167], v[142:145]
  v_exp_f32 v102, v102
  v_mfma_f32_16x16x32_bf16 v[134:137], v[192:195], a[168:171], v[134:137]
  v_exp_f32 v103, v103
  v_mfma_f32_16x16x32_bf16 v[134:137], v[196:199], a[180:183], v[134:137]
  v_exp_f32 v104, v104
  v_mfma_f32_16x16x32_bf16 v[130:133], v[192:195], a[172:175], v[130:133]
  s_waitcnt lgkmcnt(0)
  v_exp_f32 v105, v105
  v_mfma_f32_16x16x32_bf16 v[130:133], v[196:199], a[184:187], v[130:133]
  s_waitcnt vmcnt(3)
  s_barrier
  v_mfma_f32_16x16x32_bf16 v[78:81], v[192:195], a[176:179], v[78:81]
  ds_read_b64_tr_b16 a[192:193], v59 offset:0
  ds_read_b64_tr_b16 a[194:195], v59 offset:512
  v_mfma_f32_16x16x32_bf16 v[78:81], v[196:199], a[188:191], v[78:81]
  ds_read_b64_tr_b16 a[204:205], v59 offset:4096
  ds_read_b64_tr_b16 a[206:207], v59 offset:4608
  v_mfma_f32_16x16x32_bf16 v[116:119], v[216:219], a[168:171], v[116:119]
  ds_read_b64_tr_b16 a[196:197], v57 offset:0
  ds_read_b64_tr_b16 a[198:199], v57 offset:512
  v_mfma_f32_16x16x32_bf16 v[116:119], v[220:223], a[180:183], v[116:119]
  ds_read_b64_tr_b16 a[208:209], v57 offset:4096
  ds_read_b64_tr_b16 a[210:211], v57 offset:4608
  v_mfma_f32_16x16x32_bf16 v[126:129], v[216:219], a[172:175], v[126:129]
  s_add_u32 s5, s45, 0
  s_add_u32 m0, s46, 122880
  ds_read_b64_tr_b16 a[200:201], v56 offset:0
  v_mfma_f32_16x16x32_bf16 v[126:129], v[220:223], a[184:187], v[126:129]
  ds_read_b64_tr_b16 a[202:203], v56 offset:512
  ds_read_b64_tr_b16 a[212:213], v56 offset:4096
  v_mfma_f32_16x16x32_bf16 v[142:145], v[216:219], a[176:179], v[142:145]
  s_waitcnt lgkmcnt(5)
  ds_read_b64_tr_b16 a[214:215], v56 offset:4608
  v_cvt_pk_bf16_f32 v100, v100, v101
  v_mfma_f32_16x16x32_bf16 v[142:145], v[220:223], a[188:191], v[142:145]
  buffer_load_dwordx4 v55, s[16:19], s5 offen offset:0 lds
  v_mfma_f32_16x16x32_bf16 v[134:137], v[200:203], a[192:195], v[134:137]
  s_add_u32 m0, s46, 130944
  v_exp_f32 v106, v106
  v_mfma_f32_16x16x32_bf16 v[134:137], v[204:207], a[204:207], v[134:137]
  s_waitcnt lgkmcnt(1)
  v_exp_f32 v107, v107
  v_mfma_f32_16x16x32_bf16 v[130:133], v[200:203], a[196:199], v[130:133]
  buffer_load_dwordx4 v55, s[16:19], s5 offen offset:128 lds
  v_mfma_f32_16x16x32_bf16 v[130:133], v[204:207], a[208:211], v[130:133]
  s_add_u32 m0, s46, 139008
  v_exp_f32 v122, v122
  v_mfma_f32_16x16x32_bf16 v[78:81], v[200:203], a[200:203], v[78:81]
  s_waitcnt lgkmcnt(0)
  v_cvt_pk_bf16_f32 v56, v134, v135
  v_cvt_pk_bf16_f32 v57, v136, v137
  v_mfma_f32_16x16x32_bf16 v[78:81], v[204:207], a[212:215], v[78:81]
  buffer_load_dwordx4 v55, s[16:19], s5 offen offset:256 lds
  v_mfma_f32_16x16x32_bf16 v[116:119], v[224:227], a[192:195], v[116:119]
  s_add_u32 s5, s45, 12288
  v_cvt_pk_bf16_f32 v76, v130, v131
  v_cvt_pk_bf16_f32 v77, v132, v133
  v_mfma_f32_16x16x32_bf16 v[116:119], v[228:231], a[204:207], v[116:119]
  s_add_u32 m0, s46, 126976
  v_exp_f32 v123, v123
  v_mfma_f32_16x16x32_bf16 v[126:129], v[224:227], a[196:199], v[126:129]
  buffer_load_dwordx4 v55, s[16:19], s5 offen offset:0 lds
  v_mfma_f32_16x16x32_bf16 v[126:129], v[228:231], a[208:211], v[126:129]
  s_add_u32 m0, s46, 135040
  v_cvt_pk_bf16_f32 v164, v78, v79
  v_cvt_pk_bf16_f32 v165, v80, v81
  v_mfma_f32_16x16x32_bf16 v[142:145], v[224:227], a[200:203], v[142:145]
  v_cvt_pk_bf16_f32 v58, v116, v117
  v_cvt_pk_bf16_f32 v59, v118, v119
  v_mfma_f32_16x16x32_bf16 v[142:145], v[228:231], a[212:215], v[142:145]
  buffer_load_dwordx4 v55, s[16:19], s5 offen offset:128 lds
  v_mfma_f32_16x16x32_bf16 v[130:133], v[232:235], a[144:147], 0
  s_add_u32 m0, s46, 143104
  v_cvt_pk_bf16_f32 v78, v126, v127
  v_cvt_pk_bf16_f32 v79, v128, v129
  v_mfma_f32_16x16x32_bf16 v[130:133], v[236:239], a[156:159], v[130:133]
  v_exp_f32 v124, v124
  v_mfma_f32_16x16x32_bf16 v[130:133], v[240:243], a[168:171], v[130:133]
  buffer_load_dwordx4 v55, s[16:19], s5 offen offset:256 lds
  v_mfma_f32_16x16x32_bf16 v[130:133], v[244:247], a[180:183], v[130:133]
  v_cvt_pk_bf16_f32 v166, v142, v143
  v_cvt_pk_bf16_f32 v167, v144, v145
  v_mfma_f32_16x16x32_bf16 v[130:133], v[248:251], a[192:195], v[130:133]
  v_exp_f32 v125, v125
  v_mfma_f32_16x16x32_bf16 v[130:133], v[252:255], a[204:207], v[130:133]
  v_exp_f32 v138, v138
  v_mfma_f32_16x16x32_bf16 v[116:119], v[232:235], a[148:151], 0
  v_exp_f32 v139, v139
  v_mfma_f32_16x16x32_bf16 v[116:119], v[236:239], a[160:163], v[116:119]
  v_exp_f32 v140, v140
  v_mfma_f32_16x16x32_bf16 v[116:119], v[240:243], a[172:175], v[116:119]
  v_cvt_pk_bf16_f32 v80, v130, v131
  v_cvt_pk_bf16_f32 v81, v132, v133
  v_mfma_f32_16x16x32_bf16 v[116:119], v[244:247], a[184:187], v[116:119]
  v_exp_f32 v141, v141
  v_mfma_f32_16x16x32_bf16 v[116:119], v[248:251], a[196:199], v[116:119]
  v_cvt_pk_bf16_f32 v101, v102, v103
  v_cvt_pk_bf16_f32 v102, v104, v105
  v_mfma_f32_16x16x32_bf16 v[116:119], v[252:255], a[208:211], v[116:119]
  v_cvt_pk_bf16_f32 v103, v106, v107
  v_cvt_pk_bf16_f32 v104, v122, v123
  v_mfma_f32_16x16x32_bf16 v[126:129], v[232:235], a[152:155], 0
  v_cvt_pk_bf16_f32 v105, v124, v125
  v_cvt_pk_bf16_f32 v106, v138, v139
  v_mfma_f32_16x16x32_bf16 v[126:129], v[236:239], a[164:167], v[126:129]
  v_cvt_pk_bf16_f32 v107, v140, v141
  v_add_u32 v0, s28, v2
  v_mfma_f32_16x16x32_bf16 v[126:129], v[240:243], a[176:179], v[126:129]
  v_cvt_pk_bf16_f32 v172, v116, v117
  v_cvt_pk_bf16_f32 v173, v118, v119
  v_xor_b32 v1, 64, v0
  v_mfma_f32_16x16x32_bf16 v[126:129], v[244:247], a[188:191], v[126:129]
L_hop_1_0:
  s_cbranch_execz L_hop_1_1
  v_exp_f32 v108, v108
  v_mfma_f32_16x16x32_bf16 v[126:129], v[248:251], a[200:203], v[126:129]
  v_exp_f32 v109, v109
  v_mfma_f32_16x16x32_bf16 v[126:129], v[252:255], a[212:215], v[126:129]
  v_exp_f32 v110, v110
  v_cvt_pk_bf16_f32 v108, v108, v109
  v_mfma_f32_16x16x32_bf16 v[116:119], a[216:219], a[144:147], 0
  v_exp_f32 v111, v111
  v_mfma_f32_16x16x32_bf16 v[116:119], a[220:223], a[156:159], v[116:119]
  s_add_u32 s5, s45, 24576
  s_add_u32 m0, s46, 0
  v_exp_f32 v112, v112
  v_mfma_f32_16x16x32_bf16 v[116:119], a[224:227], a[168:171], v[116:119]
  v_cvt_pk_bf16_f32 v168, v126, v127
  v_cvt_pk_bf16_f32 v169, v128, v129
  v_cvt_pk_bf16_f32 v109, v110, v111
  v_mfma_f32_16x16x32_bf16 v[116:119], a[228:231], a[180:183], v[116:119]
  v_exp_f32 v113, v113
  v_mfma_f32_16x16x32_bf16 v[116:119], a[232:235], a[192:195], v[116:119]
  buffer_load_dwordx4 v55, s[16:19], s5 offen offset:0 lds
  v_cvt_pk_bf16_f32 v110, v112, v113
  v_mfma_f32_16x16x32_bf16 v[116:119], a[236:239], a[204:207], v[116:119]
  s_add_u32 m0, s46, 8064
  v_exp_f32 v114, v114
  v_mfma_f32_16x16x32_bf16 v[120:123], a[216:219], a[148:151], 0
  v_exp_f32 v115, v115
  v_mfma_f32_16x16x32_bf16 v[120:123], a[220:223], a[160:163], v[120:123]
  buffer_load_dwordx4 v55, s[16:19], s5 offen offset:128 lds
  v_cvt_pk_bf16_f32 v111, v114, v115
  v_mfma_f32_16x16x32_bf16 v[120:123], a[224:227], a[172:175], v[120:123]
  s_add_u32 m0, s46, 16128
  v_cvt_pk_bf16_f32 v82, v116, v117
  v_cvt_pk_bf16_f32 v83, v118, v119
  v_mfma_f32_16x16x32_bf16 v[120:123], a[228:231], a[184:187], v[120:123]
  v_exp_f32 v68, v68
  v_mfma_f32_16x16x32_bf16 v[120:123], a[232:235], a[196:199], v[120:123]
  buffer_load_dwordx4 v55, s[16:19], s5 offen offset:256 lds
  v_mov_b64 v[142:143], 0
  v_mfma_f32_16x16x32_bf16 v[120:123], a[236:239], a[208:211], v[120:123]
  s_add_u32 s5, s45, 36864
  s_add_u32 m0, s46, 4096
  v_exp_f32 v69, v69
  v_mfma_f32_16x16x32_bf16 v[116:119], a[216:219], a[152:155], 0
  v_exp_f32 v70, v70
  v_cvt_pk_bf16_f32 v112, v68, v69
  v_mfma_f32_16x16x32_bf16 v[116:119], a[220:223], a[164:167], v[116:119]
  buffer_load_dwordx4 v55, s[16:19], s5 offen offset:0 lds
  v_mfma_f32_16x16x32_bf16 v[116:119], a[224:227], a[176:179], v[116:119]
  s_add_u32 m0, s46, 12160
  v_cvt_pk_bf16_f32 v174, v120, v121
  v_cvt_pk_bf16_f32 v175, v122, v123
  v_mfma_f32_16x16x32_bf16 v[116:119], a[228:231], a[188:191], v[116:119]
  v_exp_f32 v71, v71
  v_mfma_f32_16x16x32_bf16 v[116:119], a[232:235], a[200:203], v[116:119]
  buffer_load_dwordx4 v55, s[16:19], s5 offen offset:128 lds
  v_cvt_pk_bf16_f32 v113, v70, v71
  v_mfma_f32_16x16x32_bf16 v[116:119], a[236:239], a[212:215], v[116:119]
  s_add_u32 m0, s46, 20224
  v_mov_b64 v[128:129], 0
  v_exp_f32 v64, v64
  v_smfmac_f32_16x16x64_bf16 v[142:145], a[240:243], v[92:99], v10
  v_exp_f32 v65, v65
  v_mfma_f32_16x16x32_bf16 v[160:163], v[80:83], v[96:99], 0
  buffer_load_dwordx4 v55, s[16:19], s5 offen offset:256 lds
  v_cvt_pk_bf16_f32 v114, v64, v65
  v_mfma_f32_16x16x32_bf16 v[160:163], v[56:59], v[92:95], v[160:163]
  v_cvt_pk_bf16_f32 v170, v116, v117
  v_cvt_pk_bf16_f32 v171, v118, v119
  v_mfma_f32_16x16x32_bf16 v[150:153], v[76:79], v[92:95], 0
  v_exp_f32 v66, v66
  v_mfma_f32_16x16x32_bf16 v[150:153], v[172:175], v[96:99], v[150:153]
  v_exp_f32 v67, v67
  v_mfma_f32_16x16x32_bf16 v[146:149], v[168:171], v[96:99], 0
  v_cvt_pk_bf16_f32 v115, v66, v67
  v_exp_f32 v84, v84
  v_mfma_f32_16x16x32_bf16 v[146:149], v[164:167], v[92:95], v[146:149]
  v_mov_b64 v[64:65], 0
  v_exp_f32 v85, v85
  v_smfmac_f32_16x16x64_bf16 v[128:131], a[240:243], v[100:107], v10
  v_exp_f32 v86, v86
  v_cvt_pk_bf16_f32 v84, v84, v85
  v_mfma_f32_16x16x32_bf16 v[138:141], v[80:83], v[104:107], 0
  v_exp_f32 v87, v87
  v_add_f32 v142, v142, v143
  v_mfma_f32_16x16x32_bf16 v[138:141], v[56:59], v[100:103], v[138:141]
  v_exp_f32 v88, v88
  v_cvt_pk_bf16_f32 v85, v86, v87
  v_mfma_f32_16x16x32_bf16 v[92:95], v[76:79], v[100:103], 0
  v_exp_f32 v89, v89
  v_mfma_f32_16x16x32_bf16 v[92:95], v[172:175], v[104:107], v[92:95]
  v_exp_f32 v90, v90
  v_cvt_pk_bf16_f32 v86, v88, v89
  v_mfma_f32_16x16x32_bf16 v[124:127], v[168:171], v[104:107], 0
  v_exp_f32 v91, v91
  v_add_f32 v128, v128, v129
  v_mfma_f32_16x16x32_bf16 v[124:127], v[164:167], v[100:103], v[124:127]
  v_exp_f32 v72, v72
  v_cvt_pk_bf16_f32 v87, v90, v91
  v_smfmac_f32_16x16x64_bf16 v[64:67], a[240:243], v[108:115], v10
  v_exp_f32 v73, v73
  v_exp_f32 v74, v74
  v_exp_f32 v75, v75
  v_exp_f32 v60, v60
  v_exp_f32 v61, v61
  v_exp_f32 v62, v62
  v_exp_f32 v63, v63
  v_mfma_f32_16x16x32_bf16 v[120:123], v[80:83], v[112:115], 0
  s_add_u32 s5, s45, 49152
  v_cvt_pk_bf16_f32 v88, v72, v73
  v_cvt_pk_bf16_f32 v89, v74, v75
  v_cvt_pk_bf16_f32 v90, v60, v61
  v_cvt_pk_bf16_f32 v91, v62, v63
  v_mfma_f32_16x16x32_bf16 v[120:123], v[56:59], v[108:111], v[120:123]
  s_waitcnt vmcnt(6) lgkmcnt(0)
  s_barrier
  v_mfma_f32_16x16x32_bf16 v[116:119], v[76:79], v[108:111], 0
  s_add_u32 m0, s46, 98304
  ds_read_b128 v[130:133], v0 offset:0
  v_mov_b64 v[100:101], 0
  v_mfma_f32_16x16x32_bf16 v[116:119], v[172:175], v[112:115], v[116:119]
  buffer_load_dwordx4 v55, s[16:19], s5 offen offset:0 lds
  v_mfma_f32_16x16x32_bf16 v[134:137], v[168:171], v[112:115], 0
  s_add_u32 m0, s46, 106368
  ds_read_b128 v[156:159], v1 offset:0
  ds_read_b128 a[252:255], v0 offset:8192
  v_mfma_f32_16x16x32_bf16 v[134:137], v[164:167], v[108:111], v[134:137]
  ds_read_b128 v[112:115], v1 offset:8192
  ds_read_b128 a[248:251], v0 offset:16384
  v_smfmac_f32_16x16x64_bf16 v[100:103], a[240:243], v[84:91], v10
  buffer_load_dwordx4 v55, s[16:19], s5 offen offset:128 lds
  v_mfma_f32_16x16x32_bf16 v[96:99], v[80:83], v[88:91], 0
  s_add_u32 m0, s46, 114432
  ds_read_b128 v[108:111], v1 offset:16384
  ds_read2st64_b32 v[60:61], v54 offset0:0 offset1:2
  v_mfma_f32_16x16x32_bf16 v[96:99], v[56:59], v[84:87], v[96:99]
  ds_read2st64_b32 v[104:105], v53 offset0:0 offset1:2
  ds_read2st64_b32 v[62:63], v54 offset0:4 offset1:6
  v_mfma_f32_16x16x32_bf16 v[80:83], v[76:79], v[84:87], 0
  buffer_load_dwordx4 v55, s[16:19], s5 offen offset:256 lds
  v_mfma_f32_16x16x32_bf16 v[80:83], v[172:175], v[88:91], v[80:83]
  s_add_u32 s5, s45, 61440
  s_add_u32 m0, s46, 102400
  ds_read2st64_b32 v[106:107], v53 offset0:4 offset1:6
  v_mfma_f32_16x16x32_bf16 v[76:79], v[168:171], v[88:91], 0
  s_waitcnt lgkmcnt(3)
  ds_read2st64_b32 v[68:69], v11 offset0:0 offset1:2
  ds_read2st64_b32 v[72:73], v52 offset0:0 offset1:2
  v_mfma_f32_16x16x32_bf16 v[76:79], v[164:167], v[84:87], v[76:79]
  buffer_load_dwordx4 v55, s[16:19], s5 offen offset:0 lds
  v_mfma_f32_16x16x32_bf16 v[56:59], a[0:3], v[130:133], 0
  s_add_u32 m0, s46, 110464
  ds_read2st64_b32 v[70:71], v11 offset0:4 offset1:6
  ds_read2st64_b32 v[74:75], v52 offset0:4 offset1:6
  v_mfma_f32_16x16x32_bf16 v[56:59], a[12:15], v[156:159], v[56:59]
  v_rcp_f32 v144, v142
  v_mfma_f32_16x16x32_bf16 v[56:59], a[24:27], a[252:255], v[56:59]
  buffer_load_dwordx4 v55, s[16:19], s5 offen offset:128 lds
  v_mfma_f32_16x16x32_bf16 v[56:59], a[36:39], v[112:115], v[56:59]
  s_add_u32 m0, s46, 118528
  v_mul_f32 v160, v144, v160
  v_mul_f32 v161, v144, v161
  v_mfma_f32_16x16x32_bf16 v[56:59], a[48:51], a[248:251], v[56:59]
  s_waitcnt lgkmcnt(4)
  v_perm_b32 v184, v104, v60, s58
  v_perm_b32 v188, v104, v60, s59
  v_mfma_f32_16x16x32_bf16 v[56:59], a[60:63], v[108:111], v[56:59]
  buffer_load_dwordx4 v55, s[16:19], s5 offen offset:256 lds
  v_mfma_f32_16x16x32_bf16 v[88:91], a[64:67], v[108:111], 0
  s_waitcnt lgkmcnt(0)
  v_perm_b32 v185, v105, v61, s58
  v_perm_b32 v189, v105, v61, s59
  v_mfma_f32_16x16x32_bf16 v[88:91], a[52:55], a[248:251], v[88:91]
  s_add_u32 m0, s28, 4096
  v_perm_b32 v186, v106, v62, s58
  v_perm_b32 v190, v106, v62, s59
  v_mfma_f32_16x16x32_bf16 v[88:91], a[40:43], v[112:115], v[88:91]
  s_mov_b32 s5, s28
  v_mul_f32 v56, s42, v56
  v_mul_f32 v57, s42, v57
  v_mfma_f32_16x16x32_bf16 v[88:91], a[28:31], a[252:255], v[88:91]
  v_mul_f32 v58, s42, v58
  v_mul_f32 v59, s42, v59
  v_mfma_f32_16x16x32_bf16 v[88:91], a[16:19], v[156:159], v[88:91]
  buffer_load_dwordx4 v6, s[8:11], s32 offen offset:0 nt lds
  v_mfma_f32_16x16x32_bf16 v[88:91], a[4:7], v[130:133], v[88:91]
  s_add_u32 m0, s28, 12160
  v_cvt_pk_bf16_f32 v12, v56, v57
  v_cvt_pk_bf16_f32 v13, v58, v59
  v_mfma_f32_16x16x32_bf16 v[84:87], a[8:11], v[130:133], 0
  v_perm_b32 v187, v107, v63, s58
  v_perm_b32 v191, v107, v63, s59
  v_perm_b32 v192, v72, v68, s58
  v_mfma_f32_16x16x32_bf16 v[84:87], a[20:23], v[156:159], v[84:87]
  buffer_load_dwordx4 v6, s[8:11], s32 offen offset:128 nt lds
  v_perm_b32 v196, v72, v68, s59
  v_mfma_f32_16x16x32_bf16 v[84:87], a[32:35], a[252:255], v[84:87]
  s_add_u32 m0, s28, 20224
  v_mul_f32 v88, s42, v88
  v_mul_f32 v89, s42, v89
  v_mul_f32 v90, s42, v90
  v_mfma_f32_16x16x32_bf16 v[84:87], a[44:47], v[112:115], v[84:87]
  s_mov_b32 s28, s29
  v_mul_f32 v91, s42, v91
  v_cvt_pk_bf16_f32 v56, v88, v89
  v_cvt_pk_bf16_f32 v57, v90, v91
  v_mfma_f32_16x16x32_bf16 v[84:87], a[56:59], a[248:251], v[84:87]
  buffer_load_dwordx4 v6, s[8:11], s32 offen offset:256 nt lds
  v_perm_b32 v193, v73, v69, s58
  v_mfma_f32_16x16x32_bf16 v[84:87], a[68:71], v[108:111], v[84:87]
  s_add_u32 s32, s32, s43
  v_perm_b32 v197, v73, v69, s59
  v_perm_b32 v194, v74, v70, s58
  v_perm_b32 v198, v74, v70, s59
  v_mfma_f32_16x16x32_bf16 v[88:91], a[132:135], v[108:111], 0
  ds_read2st64_b32 v[60:61], v54 offset0:16 offset1:18
  v_perm_b32 v195, v75, v71, s58
  v_perm_b32 v199, v75, v71, s59
  v_mfma_f32_16x16x32_bf16 v[88:91], a[120:123], a[248:251], v[88:91]
  ds_read2st64_b32 v[104:105], v53 offset0:16 offset1:18
  ds_read2st64_b32 v[62:63], v54 offset0:20 offset1:22
  v_mul_f32 v162, v144, v162
  v_mfma_f32_16x16x32_bf16 v[88:91], a[108:111], v[112:115], v[88:91]
  v_mul_f32 v84, s42, v84
  v_mul_f32 v85, s42, v85
  v_mul_f32 v86, s42, v86
  v_mfma_f32_16x16x32_bf16 v[88:91], a[96:99], a[252:255], v[88:91]
  v_mul_f32 v87, s42, v87
  v_cvt_pk_bf16_f32 v58, v84, v85
  v_cvt_pk_bf16_f32 v59, v86, v87
  v_mfma_f32_16x16x32_bf16 v[88:91], a[84:87], v[156:159], v[88:91]
  ds_read2st64_b32 v[106:107], v53 offset0:20 offset1:22
  ds_read2st64_b32 v[68:69], v11 offset0:16 offset1:18
  v_mul_f32 v163, v144, v163
  v_mfma_f32_16x16x32_bf16 v[88:91], a[72:75], v[130:133], v[88:91]
  ds_read2st64_b32 v[72:73], v52 offset0:16 offset1:18
  ds_read2st64_b32 v[70:71], v11 offset0:20 offset1:22
  v_cvt_pk_bf16_f32 v160, v160, v161
  v_mfma_f32_16x16x32_bf16 v[164:167], a[76:79], v[130:133], 0
  ds_read2st64_b32 v[74:75], v52 offset0:20 offset1:22
  v_cvt_pk_bf16_f32 v161, v162, v163
  v_mul_f32 v150, v144, v150
  v_mfma_f32_16x16x32_bf16 v[164:167], a[88:91], v[156:159], v[164:167]
  v_mul_f32 v151, v144, v151
  v_mul_f32 v152, v144, v152
  v_mul_f32 v153, v144, v153
  v_mfma_f32_16x16x32_bf16 v[164:167], a[100:103], a[252:255], v[164:167]
  v_cvt_pk_bf16_f32 v84, v88, v89
  v_cvt_pk_bf16_f32 v85, v90, v91
  v_cvt_pk_bf16_f32 v150, v150, v151
  v_mfma_f32_16x16x32_bf16 v[164:167], a[112:115], v[112:115], v[164:167]
  s_waitcnt lgkmcnt(4)
  v_cvt_pk_bf16_f32 v151, v152, v153
  v_mul_f32 v146, v144, v146
  v_mul_f32 v147, v144, v147
  v_mfma_f32_16x16x32_bf16 v[164:167], a[124:127], a[248:251], v[164:167]
  v_mul_f32 v148, v144, v148
  v_mul_f32 v149, v144, v149
  v_cvt_pk_bf16_f32 v146, v146, v147
  v_mfma_f32_16x16x32_bf16 v[164:167], a[136:139], v[108:111], v[164:167]
  s_waitcnt lgkmcnt(0)
  v_cvt_pk_bf16_f32 v147, v148, v149
  v_max3_f32 v9, v142, v144, v9
  v_perm_b32 v200, v104, v60, s58
  v_mfma_f32_16x16x32_bf16 v[168:171], a[140:143], v[108:111], 0
  ds_write2st64_b32 v5, v160, v161 offset0:0 offset1:4
  v_mfma_f32_16x16x32_bf16 v[168:171], a[128:131], a[248:251], v[168:171]
  ds_write2st64_b32 v5, v150, v151 offset0:8 offset1:12
  v_mfma_f32_16x16x32_bf16 v[168:171], a[116:119], v[112:115], v[168:171]
  v_cvt_pk_bf16_f32 v86, v164, v165
  v_cvt_pk_bf16_f32 v87, v166, v167
  v_perm_b32 v204, v104, v60, s59
  v_mfma_f32_16x16x32_bf16 v[168:171], a[104:107], a[252:255], v[168:171]
  ds_write2st64_b32 v5, v146, v147 offset0:16 offset1:20
  v_mfma_f32_16x16x32_bf16 v[168:171], a[92:95], v[156:159], v[168:171]
  v_perm_b32 v201, v105, v61, s58
  v_perm_b32 v205, v105, v61, s59
  v_perm_b32 v202, v106, v62, s58
  v_mfma_f32_16x16x32_bf16 v[168:171], a[80:83], v[130:133], v[168:171]
  v_perm_b32 v206, v106, v62, s59
  v_perm_b32 v203, v107, v63, s58
  v_perm_b32 v207, v107, v63, s59
  v_mfma_f32_16x16x32_bf16 v[102:105], v[130:133], a[144:147], 0
  v_perm_b32 v208, v72, v68, s58
  v_perm_b32 v212, v72, v68, s59
  v_perm_b32 v209, v73, v69, s58
  v_mfma_f32_16x16x32_bf16 v[102:105], v[156:159], a[156:159], v[102:105]
  v_perm_b32 v213, v73, v69, s59
  v_perm_b32 v210, v74, v70, s58
  v_perm_b32 v214, v74, v70, s59
  v_mfma_f32_16x16x32_bf16 v[102:105], a[252:255], a[168:171], v[102:105]
  ds_read_b128 v[148:151], v0 offset:2048
  v_cvt_pk_bf16_f32 v88, v168, v169
  v_cvt_pk_bf16_f32 v89, v170, v171
  v_mfma_f32_16x16x32_bf16 v[102:105], v[112:115], a[180:183], v[102:105]
  ds_read_b128 a[244:247], v1 offset:2048
  ds_read_b128 v[152:155], v0 offset:10240
  v_perm_b32 v211, v75, v71, s58
  v_mfma_f32_16x16x32_bf16 v[102:105], a[248:251], a[192:195], v[102:105]
  s_add_u32 m0, s29, 0
  ds_read_b128 v[168:171], v1 offset:10240
  ds_read_b128 v[164:167], v0 offset:18432
  v_perm_b32 v215, v75, v71, s59
  v_mfma_f32_16x16x32_bf16 v[102:105], v[108:111], a[204:207], v[102:105]
  ds_read_b128 v[160:163], v1 offset:18432
  v_add_u32 v54, 4294844416, v54
  v_add_u32 v53, 4294844416, v53
  v_mfma_f32_16x16x32_bf16 v[176:179], v[108:111], a[208:211], 0
  s_waitcnt vmcnt(3)
  s_barrier
  v_mfma_f32_16x16x32_bf16 v[176:179], a[248:251], a[196:199], v[176:179]
  buffer_load_dwordx4 v6, s[8:11], s31 offen offset:0 nt lds
  v_add_u32 v11, 4294844416, v11
  v_mfma_f32_16x16x32_bf16 v[176:179], v[112:115], a[184:187], v[176:179]
  s_add_u32 m0, s29, 8064
  v_cvt_pk_bf16_f32 v144, v102, v103
  v_cvt_pk_bf16_f32 v145, v104, v105
  v_add_u32 v52, 4294844416, v52
  v_mfma_f32_16x16x32_bf16 v[176:179], a[252:255], a[172:175], v[176:179]
  ds_read2st64_b32 v[60:61], v54 offset0:0 offset1:2
  ds_read2st64_b32 v[104:105], v53 offset0:0 offset1:2
  v_add_f32 v64, v64, v65
  v_mfma_f32_16x16x32_bf16 v[176:179], v[156:159], a[160:163], v[176:179]
  ds_read2st64_b32 v[62:63], v54 offset0:4 offset1:6
  ds_read2st64_b32 v[106:107], v53 offset0:4 offset1:6
  v_add_f32 v100, v100, v101
  v_mfma_f32_16x16x32_bf16 v[176:179], v[130:133], a[148:151], v[176:179]
  buffer_load_dwordx4 v6, s[8:11], s31 offen offset:128 nt lds
  v_mfma_f32_16x16x32_bf16 v[172:175], v[130:133], a[152:155], 0
  s_add_u32 m0, s29, 16128
  ds_read2st64_b32 v[68:69], v11 offset0:0 offset1:2
  ds_read2st64_b32 v[72:73], v52 offset0:0 offset1:2
  v_mfma_f32_16x16x32_bf16 v[172:175], v[156:159], a[164:167], v[172:175]
  ds_read2st64_b32 v[70:71], v11 offset0:4 offset1:6
  ds_read2st64_b32 v[74:75], v52 offset0:4 offset1:6
  v_mfma_f32_16x16x32_bf16 v[172:175], a[252:255], a[176:179], v[172:175]
  v_cvt_pk_bf16_f32 v132, v176, v177
  v_cvt_pk_bf16_f32 v133, v178, v179
  v_mfma_f32_16x16x32_bf16 v[172:175], v[112:115], a[188:191], v[172:175]
  buffer_load_dwordx4 v6, s[8:11], s31 offen offset:256 nt lds
  v_mfma_f32_16x16x32_bf16 v[172:175], a[248:251], a[200:203], v[172:175]
  s_add_u32 m0, s29, 4096
  v_rcp_f32 v130, v128
  v_mfma_f32_16x16x32_bf16 v[172:175], v[108:111], a[212:215], v[172:175]
  s_waitcnt lgkmcnt(4)
  v_perm_b32 v216, v104, v60, s58
  v_perm_b32 v220, v104, v60, s59
  v_perm_b32 v217, v105, v61, s58
  v_mfma_f32_16x16x32_bf16 v[156:159], a[0:3], v[148:151], 0
  s_waitcnt lgkmcnt(0)
  v_perm_b32 v221, v105, v61, s59
  v_perm_b32 v218, v106, v62, s58
  v_perm_b32 v222, v106, v62, s59
  v_mfma_f32_16x16x32_bf16 v[156:159], a[12:15], a[244:247], v[156:159]
  buffer_load_dwordx4 v6, s[8:11], s32 offen offset:0 nt lds
  v_perm_b32 v219, v107, v63, s58
  v_mfma_f32_16x16x32_bf16 v[156:159], a[24:27], v[152:155], v[156:159]
  s_add_u32 m0, s29, 12160
  v_cvt_pk_bf16_f32 v108, v172, v173
  v_cvt_pk_bf16_f32 v109, v174, v175
  v_perm_b32 v223, v107, v63, s59
  v_mfma_f32_16x16x32_bf16 v[156:159], a[36:39], v[168:171], v[156:159]
  s_add_u32 s31, s31, s43
  v_perm_b32 v224, v72, v68, s58
  v_perm_b32 v228, v72, v68, s59
  v_perm_b32 v225, v73, v69, s58
  v_mfma_f32_16x16x32_bf16 v[156:159], a[48:51], v[164:167], v[156:159]
  v_perm_b32 v229, v73, v69, s59
  v_perm_b32 v226, v74, v70, s58
  v_perm_b32 v230, v74, v70, s59
  v_mfma_f32_16x16x32_bf16 v[156:159], a[60:63], v[160:163], v[156:159]
  buffer_load_dwordx4 v6, s[8:11], s32 offen offset:128 nt lds
  v_perm_b32 v227, v75, v71, s58
  v_mfma_f32_16x16x32_bf16 v[172:175], a[64:67], v[160:163], 0
  s_add_u32 m0, s29, 20224
  ds_read2st64_b32 v[60:61], v54 offset0:16 offset1:18
  ds_read2st64_b32 v[104:105], v53 offset0:16 offset1:18
  v_perm_b32 v231, v75, v71, s59
  v_mfma_f32_16x16x32_bf16 v[172:175], a[52:55], v[164:167], v[172:175]
  s_mov_b32 s29, s30
  ds_read2st64_b32 v[62:63], v54 offset0:20 offset1:22
  ds_read2st64_b32 v[106:107], v53 offset0:20 offset1:22
  v_mul_f32 v138, v130, v138
  v_mfma_f32_16x16x32_bf16 v[172:175], a[40:43], v[168:171], v[172:175]
  v_mul_f32 v156, s42, v156
  v_mul_f32 v157, s42, v157
  v_mul_f32 v158, s42, v158
  v_mfma_f32_16x16x32_bf16 v[172:175], a[28:31], v[152:155], v[172:175]
  buffer_load_dwordx4 v6, s[8:11], s32 offen offset:256 nt lds
  v_mul_f32 v159, s42, v159
  v_mfma_f32_16x16x32_bf16 v[172:175], a[16:19], a[244:247], v[172:175]
  s_add_u32 s32, s32, s43
  ds_read2st64_b32 v[68:69], v11 offset0:16 offset1:18
  v_cvt_pk_bf16_f32 v112, v156, v157
  v_cvt_pk_bf16_f32 v113, v158, v159
  v_mfma_f32_16x16x32_bf16 v[172:175], a[4:7], v[148:151], v[172:175]
  ds_read2st64_b32 v[72:73], v52 offset0:16 offset1:18
  ds_read2st64_b32 v[70:71], v11 offset0:20 offset1:22
  v_mul_f32 v139, v130, v139
  v_mfma_f32_16x16x32_bf16 v[156:159], a[8:11], v[148:151], 0
  s_waitcnt lgkmcnt(3)
  ds_read2st64_b32 v[74:75], v52 offset0:20 offset1:22
  v_mul_f32 v140, v130, v140
  v_mul_f32 v141, v130, v141
  v_mfma_f32_16x16x32_bf16 v[156:159], a[20:23], a[244:247], v[156:159]
  v_cvt_pk_bf16_f32 v138, v138, v139
  v_cvt_pk_bf16_f32 v139, v140, v141
  v_mul_f32 v92, v130, v92
  v_mfma_f32_16x16x32_bf16 v[156:159], a[32:35], v[152:155], v[156:159]
  v_mul_f32 v172, s42, v172
  v_mul_f32 v173, s42, v173
  v_mul_f32 v174, s42, v174
  v_mfma_f32_16x16x32_bf16 v[156:159], a[44:47], v[168:171], v[156:159]
  v_mul_f32 v175, s42, v175
  v_cvt_pk_bf16_f32 v114, v172, v173
  v_cvt_pk_bf16_f32 v115, v174, v175
  v_mfma_f32_16x16x32_bf16 v[156:159], a[56:59], v[164:167], v[156:159]
  v_mul_f32 v93, v130, v93
  v_mul_f32 v94, v130, v94
  v_mul_f32 v95, v130, v95
  v_mfma_f32_16x16x32_bf16 v[156:159], a[68:71], v[160:163], v[156:159]
  s_waitcnt lgkmcnt(0)
  v_cvt_pk_bf16_f32 v92, v92, v93
  v_cvt_pk_bf16_f32 v93, v94, v95
  v_mul_f32 v124, v130, v124
  v_mfma_f32_16x16x32_bf16 v[140:143], a[132:135], v[160:163], 0
  v_mul_f32 v125, v130, v125
  v_mul_f32 v126, v130, v126
  v_mul_f32 v127, v130, v127
  v_mfma_f32_16x16x32_bf16 v[140:143], a[120:123], v[164:167], v[140:143]
  v_cvt_pk_bf16_f32 v124, v124, v125
  v_cvt_pk_bf16_f32 v125, v126, v127
  v_max3_f32 v9, v128, v130, v9
  v_mfma_f32_16x16x32_bf16 v[140:143], a[108:111], v[168:171], v[140:143]
  v_mul_f32 v156, s42, v156
  v_mul_f32 v157, s42, v157
  v_mul_f32 v158, s42, v158
  v_mfma_f32_16x16x32_bf16 v[140:143], a[96:99], v[152:155], v[140:143]
  v_mul_f32 v159, s42, v159
  v_cvt_pk_bf16_f32 v16, v156, v157
  v_cvt_pk_bf16_f32 v17, v158, v159
  v_mfma_f32_16x16x32_bf16 v[140:143], a[84:87], a[244:247], v[140:143]
  ds_write2st64_b32 v5, v138, v139 offset0:1 offset1:5
  v_mfma_f32_16x16x32_bf16 v[140:143], a[72:75], v[148:151], v[140:143]
  ds_write2st64_b32 v5, v92, v93 offset0:9 offset1:13
  v_mfma_f32_16x16x32_bf16 v[126:129], a[76:79], v[148:151], 0
  ds_write2st64_b32 v5, v124, v125 offset0:17 offset1:21
  v_mfma_f32_16x16x32_bf16 v[126:129], a[88:91], a[244:247], v[126:129]
  v_rcp_f32 v66, v64
  v_perm_b32 v232, v104, v60, s58
  v_mfma_f32_16x16x32_bf16 v[126:129], a[100:103], v[152:155], v[126:129]
  v_cvt_pk_bf16_f32 v90, v140, v141
  v_cvt_pk_bf16_f32 v91, v142, v143
  v_mul_f32 v120, v66, v120
  v_mfma_f32_16x16x32_bf16 v[126:129], a[112:115], v[168:171], v[126:129]
  v_mul_f32 v121, v66, v121
  v_mul_f32 v122, v66, v122
  v_mul_f32 v123, v66, v123
  v_mfma_f32_16x16x32_bf16 v[126:129], a[124:127], v[164:167], v[126:129]
  v_cvt_pk_bf16_f32 v120, v120, v121
  v_cvt_pk_bf16_f32 v121, v122, v123
  v_mul_f32 v116, v66, v116
  v_mfma_f32_16x16x32_bf16 v[126:129], a[136:139], v[160:163], v[126:129]
  v_mul_f32 v117, v66, v117
  v_mul_f32 v118, v66, v118
  v_mul_f32 v119, v66, v119
  v_mfma_f32_16x16x32_bf16 v[122:125], a[140:143], v[160:163], 0
  v_cvt_pk_bf16_f32 v116, v116, v117
  v_cvt_pk_bf16_f32 v117, v118, v119
  v_mul_f32 v134, v66, v134
  v_mfma_f32_16x16x32_bf16 v[122:125], a[128:131], v[164:167], v[122:125]
  v_mul_f32 v135, v66, v135
  v_mul_f32 v136, v66, v136
  v_mul_f32 v137, v66, v137
  v_mfma_f32_16x16x32_bf16 v[122:125], a[116:119], v[168:171], v[122:125]
  v_cvt_pk_bf16_f32 v92, v126, v127
  v_cvt_pk_bf16_f32 v93, v128, v129
  v_cvt_pk_bf16_f32 v134, v134, v135
  v_mfma_f32_16x16x32_bf16 v[122:125], a[104:107], v[152:155], v[122:125]
  v_cvt_pk_bf16_f32 v135, v136, v137
  v_max3_f32 v9, v64, v66, v9
  v_perm_b32 v236, v104, v60, s59
  v_mfma_f32_16x16x32_bf16 v[122:125], a[92:95], a[244:247], v[122:125]
  ds_write2st64_b32 v5, v120, v121 offset0:2 offset1:6
  v_mfma_f32_16x16x32_bf16 v[122:125], a[80:83], v[148:151], v[122:125]
  ds_write2st64_b32 v5, v116, v117 offset0:10 offset1:14
  v_mfma_f32_16x16x32_bf16 v[140:143], v[148:151], a[144:147], 0
  ds_write2st64_b32 v5, v134, v135 offset0:18 offset1:22
  v_mfma_f32_16x16x32_bf16 v[140:143], a[244:247], a[156:159], v[140:143]
  v_rcp_f32 v102, v100
  v_perm_b32 v233, v105, v61, s58
  v_mfma_f32_16x16x32_bf16 v[140:143], v[152:155], a[168:171], v[140:143]
  v_cvt_pk_bf16_f32 v94, v122, v123
  v_cvt_pk_bf16_f32 v95, v124, v125
  v_mfma_f32_16x16x32_bf16 v[140:143], v[168:171], a[180:183], v[140:143]
  v_mul_f32 v96, v102, v96
  v_mul_f32 v97, v102, v97
  v_mfma_f32_16x16x32_bf16 v[140:143], v[164:167], a[192:195], v[140:143]
  s_waitcnt vmcnt(6) lgkmcnt(0)
  s_barrier
  v_mfma_f32_16x16x32_bf16 v[140:143], v[160:163], a[204:207], v[140:143]
  ds_read_b128 v[64:67], v0 offset:4096
  ds_read_b128 v[118:121], v1 offset:4096
  v_mfma_f32_16x16x32_bf16 v[136:139], v[160:163], a[208:211], 0
  ds_read_b128 v[126:129], v0 offset:12288
  ds_read_b128 a[248:251], v1 offset:12288
  v_mfma_f32_16x16x32_bf16 v[136:139], v[164:167], a[196:199], v[136:139]
  ds_read_b128 a[252:255], v0 offset:20480
  ds_read_b128 v[172:175], v1 offset:20480
  v_mfma_f32_16x16x32_bf16 v[136:139], v[168:171], a[184:187], v[136:139]
  v_cvt_pk_bf16_f32 v146, v140, v141
  v_cvt_pk_bf16_f32 v147, v142, v143
  v_mfma_f32_16x16x32_bf16 v[136:139], v[152:155], a[172:175], v[136:139]
  v_mul_f32 v98, v102, v98
  v_mul_f32 v99, v102, v99
  v_mfma_f32_16x16x32_bf16 v[136:139], a[244:247], a[160:163], v[136:139]
  v_cvt_pk_bf16_f32 v96, v96, v97
  v_cvt_pk_bf16_f32 v97, v98, v99
  v_mfma_f32_16x16x32_bf16 v[136:139], v[148:151], a[148:151], v[136:139]
  v_mul_f32 v80, v102, v80
  v_mul_f32 v81, v102, v81
  v_mfma_f32_16x16x32_bf16 v[122:125], v[148:151], a[152:155], 0
  v_mul_f32 v82, v102, v82
  v_mul_f32 v83, v102, v83
  v_mfma_f32_16x16x32_bf16 v[122:125], a[244:247], a[164:167], v[122:125]
  v_cvt_pk_bf16_f32 v80, v80, v81
  v_cvt_pk_bf16_f32 v81, v82, v83
  v_mfma_f32_16x16x32_bf16 v[122:125], v[152:155], a[176:179], v[122:125]
  v_cvt_pk_bf16_f32 v134, v136, v137
  v_cvt_pk_bf16_f32 v135, v138, v139
  v_mfma_f32_16x16x32_bf16 v[122:125], v[168:171], a[188:191], v[122:125]
  v_mul_f32 v76, v102, v76
  v_mul_f32 v77, v102, v77
  v_mfma_f32_16x16x32_bf16 v[122:125], v[164:167], a[200:203], v[122:125]
  v_mul_f32 v78, v102, v78
  v_mul_f32 v79, v102, v79
  v_mfma_f32_16x16x32_bf16 v[122:125], v[160:163], a[212:215], v[122:125]
  s_waitcnt lgkmcnt(0)
  v_cvt_pk_bf16_f32 v76, v76, v77
  v_cvt_pk_bf16_f32 v77, v78, v79
  v_mfma_f32_16x16x32_bf16 v[136:139], a[0:3], v[64:67], 0
  v_max3_f32 v9, v100, v102, v9
  v_perm_b32 v237, v105, v61, s59
  v_mfma_f32_16x16x32_bf16 v[136:139], a[12:15], v[118:121], v[136:139]
  ds_write2st64_b32 v5, v96, v97 offset0:3 offset1:7
  v_mfma_f32_16x16x32_bf16 v[136:139], a[24:27], v[126:129], v[136:139]
  v_cvt_pk_bf16_f32 v110, v122, v123
  v_cvt_pk_bf16_f32 v111, v124, v125
  v_mfma_f32_16x16x32_bf16 v[136:139], a[36:39], a[248:251], v[136:139]
  ds_write2st64_b32 v5, v80, v81 offset0:11 offset1:15
  v_mfma_f32_16x16x32_bf16 v[136:139], a[48:51], a[252:255], v[136:139]
  ds_write2st64_b32 v5, v76, v77 offset0:19 offset1:23
  v_mfma_f32_16x16x32_bf16 v[136:139], a[60:63], v[172:175], v[136:139]
  v_perm_b32 v234, v106, v62, s58
  v_perm_b32 v238, v106, v62, s59
  v_mfma_f32_16x16x32_bf16 v[76:79], a[64:67], v[172:175], 0
  v_perm_b32 v235, v107, v63, s58
  v_perm_b32 v239, v107, v63, s59
  v_mfma_f32_16x16x32_bf16 v[76:79], a[52:55], a[252:255], v[76:79]
  v_perm_b32 v240, v72, v68, s58
  v_perm_b32 v244, v72, v68, s59
  v_mfma_f32_16x16x32_bf16 v[76:79], a[40:43], a[248:251], v[76:79]
  v_mul_f32 v136, s42, v136
  v_mul_f32 v137, s42, v137
  v_mfma_f32_16x16x32_bf16 v[76:79], a[28:31], v[126:129], v[76:79]
  v_mul_f32 v138, s42, v138
  v_mul_f32 v139, s42, v139
  v_mfma_f32_16x16x32_bf16 v[76:79], a[16:19], v[118:121], v[76:79]
  v_cvt_pk_bf16_f32 v18, v136, v137
  v_cvt_pk_bf16_f32 v19, v138, v139
  v_mfma_f32_16x16x32_bf16 v[76:79], a[4:7], v[64:67], v[76:79]
  v_perm_b32 v241, v73, v69, s58
  v_perm_b32 v245, v73, v69, s59
  v_mfma_f32_16x16x32_bf16 v[80:83], a[8:11], v[64:67], 0
  v_perm_b32 v242, v74, v70, s58
  v_perm_b32 v246, v74, v70, s59
  v_mfma_f32_16x16x32_bf16 v[80:83], a[20:23], v[118:121], v[80:83]
  v_perm_b32 v243, v75, v71, s58
  v_perm_b32 v247, v75, v71, s59
  v_mfma_f32_16x16x32_bf16 v[80:83], a[32:35], v[126:129], v[80:83]
  v_mul_f32 v76, s42, v76
  v_mul_f32 v77, s42, v77
  v_mfma_f32_16x16x32_bf16 v[80:83], a[44:47], a[248:251], v[80:83]
  v_mul_f32 v78, s42, v78
  v_mul_f32 v79, s42, v79
  v_mfma_f32_16x16x32_bf16 v[80:83], a[56:59], a[252:255], v[80:83]
L_hop_2_0:
  s_cbranch_execz L_hop_2_1
  v_cvt_pk_bf16_f32 v140, v76, v77
  v_cvt_pk_bf16_f32 v141, v78, v79
  v_mfma_f32_16x16x32_bf16 v[80:83], a[68:71], v[172:175], v[80:83]
  v_add_u32 v54, 98304, v54
  v_add_u32 v53, 98304, v53
  v_mfma_f32_16x16x32_bf16 v[76:79], a[132:135], v[172:175], 0
  v_add_u32 v11, 98304, v11
  v_add_u32 v52, 98304, v52
  v_mfma_f32_16x16x32_bf16 v[76:79], a[120:123], a[252:255], v[76:79]
  ds_read2st64_b32 v[60:61], v54 offset0:0 offset1:2
  ds_read2st64_b32 v[104:105], v53 offset0:0 offset1:2
  v_mfma_f32_16x16x32_bf16 v[76:79], a[108:111], a[248:251], v[76:79]
  v_mul_f32 v80, s42, v80
  v_mul_f32 v81, s42, v81
  v_mfma_f32_16x16x32_bf16 v[76:79], a[96:99], v[126:129], v[76:79]
  v_mul_f32 v82, s42, v82
  v_mul_f32 v83, s42, v83
  v_mfma_f32_16x16x32_bf16 v[76:79], a[84:87], v[118:121], v[76:79]
  v_cvt_pk_bf16_f32 v142, v80, v81
  v_cvt_pk_bf16_f32 v143, v82, v83
  v_mfma_f32_16x16x32_bf16 v[76:79], a[72:75], v[64:67], v[76:79]
  ds_read2st64_b32 v[62:63], v54 offset0:4 offset1:6
  ds_read2st64_b32 v[106:107], v53 offset0:4 offset1:6
  v_mfma_f32_16x16x32_bf16 v[80:83], a[76:79], v[64:67], 0
  ds_read2st64_b32 v[68:69], v11 offset0:0 offset1:2
  ds_read2st64_b32 v[72:73], v52 offset0:0 offset1:2
  v_mfma_f32_16x16x32_bf16 v[80:83], a[88:91], v[118:121], v[80:83]
  ds_read2st64_b32 v[70:71], v11 offset0:4 offset1:6
  ds_read2st64_b32 v[74:75], v52 offset0:4 offset1:6
  v_mfma_f32_16x16x32_bf16 v[80:83], a[100:103], v[126:129], v[80:83]
  v_cvt_pk_bf16_f32 v96, v76, v77
  v_cvt_pk_bf16_f32 v97, v78, v79
  v_mfma_f32_16x16x32_bf16 v[80:83], a[112:115], a[248:251], v[80:83]
  v_xor_b32 v5, s41, v5
  v_mfma_f32_16x16x32_bf16 v[80:83], a[124:127], a[252:255], v[80:83]
  s_waitcnt lgkmcnt(4)
  v_perm_b32 v248, v104, v60, s58
  v_perm_b32 v252, v104, v60, s59
  v_mfma_f32_16x16x32_bf16 v[80:83], a[136:139], v[172:175], v[80:83]
  v_perm_b32 v249, v105, v61, s58
  v_perm_b32 v253, v105, v61, s59
  v_mfma_f32_16x16x32_bf16 v[76:79], a[140:143], v[172:175], 0
  s_waitcnt lgkmcnt(0)
  v_perm_b32 v250, v106, v62, s58
  v_perm_b32 v254, v106, v62, s59
  v_mfma_f32_16x16x32_bf16 v[76:79], a[128:131], a[252:255], v[76:79]
  v_perm_b32 v251, v107, v63, s58
  v_perm_b32 v255, v107, v63, s59
  v_mfma_f32_16x16x32_bf16 v[76:79], a[116:119], a[248:251], v[76:79]
  v_cvt_pk_bf16_f32 v98, v80, v81
  v_cvt_pk_bf16_f32 v99, v82, v83
  v_mfma_f32_16x16x32_bf16 v[76:79], a[104:107], v[126:129], v[76:79]
  s_add_u32 m0, s30, 0
  v_perm_b32 v55, v72, v68, s58
  v_perm_b32 v68, v72, v68, s59
  v_mfma_f32_16x16x32_bf16 v[76:79], a[92:95], v[118:121], v[76:79]
  v_accvgpr_write_b32 a220, v68
  v_perm_b32 v102, v73, v69, s58
  v_mfma_f32_16x16x32_bf16 v[76:79], a[80:83], v[64:67], v[76:79]
  v_perm_b32 v69, v73, v69, s59
  v_accvgpr_write_b32 a221, v69
  v_mfma_f32_16x16x32_bf16 v[60:63], v[64:67], a[144:147], 0
  buffer_load_dwordx4 v6, s[8:11], s31 offen offset:0 nt lds
  v_mfma_f32_16x16x32_bf16 v[60:63], v[118:121], a[156:159], v[60:63]
  s_add_u32 m0, s30, 8064
  v_perm_b32 v103, v74, v70, s58
  v_perm_b32 v70, v74, v70, s59
  v_mfma_f32_16x16x32_bf16 v[60:63], v[126:129], a[168:171], v[60:63]
  v_cvt_pk_bf16_f32 v100, v76, v77
  v_cvt_pk_bf16_f32 v101, v78, v79
  v_mfma_f32_16x16x32_bf16 v[60:63], a[248:251], a[180:183], v[60:63]
  ds_read_b128 v[136:139], v0 offset:6144
  ds_read_b128 v[164:167], v1 offset:6144
  v_mfma_f32_16x16x32_bf16 v[60:63], a[252:255], a[192:195], v[60:63]
  buffer_load_dwordx4 v6, s[8:11], s31 offen offset:128 nt lds
  v_mfma_f32_16x16x32_bf16 v[60:63], v[172:175], a[204:207], v[60:63]
  s_add_u32 m0, s30, 16128
  ds_read_b128 v[160:163], v0 offset:14336
  ds_read_b128 v[148:151], v1 offset:14336
  v_mfma_f32_16x16x32_bf16 v[80:83], v[172:175], a[208:211], 0
  ds_read_b128 v[152:155], v0 offset:22528
  ds_read_b128 v[156:159], v1 offset:22528
  v_mfma_f32_16x16x32_bf16 v[80:83], a[252:255], a[196:199], v[80:83]
  v_accvgpr_write_b32 a222, v70
  v_perm_b32 v122, v75, v71, s58
  v_mfma_f32_16x16x32_bf16 v[80:83], a[248:251], a[184:187], v[80:83]
  buffer_load_dwordx4 v6, s[8:11], s31 offen offset:256 nt lds
  v_mfma_f32_16x16x32_bf16 v[80:83], v[126:129], a[172:175], v[80:83]
  s_add_u32 m0, s30, 4096
  v_cvt_pk_bf16_f32 v116, v60, v61
  v_cvt_pk_bf16_f32 v117, v62, v63
  v_mfma_f32_16x16x32_bf16 v[80:83], v[118:121], a[160:163], v[80:83]
  s_add_u32 s31, s31, s43
  v_perm_b32 v71, v75, v71, s59
  v_accvgpr_write_b32 a223, v71
  v_mfma_f32_16x16x32_bf16 v[80:83], v[64:67], a[148:151], v[80:83]
  ds_read2st64_b32 v[60:61], v54 offset0:16 offset1:18
  ds_read2st64_b32 v[104:105], v53 offset0:16 offset1:18
  v_mfma_f32_16x16x32_bf16 v[76:79], v[64:67], a[152:155], 0
  buffer_load_dwordx4 v6, s[8:11], s32 offen offset:0 nt lds
  v_mfma_f32_16x16x32_bf16 v[76:79], v[118:121], a[164:167], v[76:79]
  s_add_u32 m0, s30, 12160
  ds_read2st64_b32 v[62:63], v54 offset0:20 offset1:22
  ds_read2st64_b32 v[106:107], v53 offset0:20 offset1:22
  v_mfma_f32_16x16x32_bf16 v[76:79], v[126:129], a[176:179], v[76:79]
  v_cvt_pk_bf16_f32 v124, v80, v81
  v_cvt_pk_bf16_f32 v125, v82, v83
  v_mfma_f32_16x16x32_bf16 v[76:79], a[248:251], a[188:191], v[76:79]
  s_waitcnt lgkmcnt(2)
  ds_read2st64_b32 v[68:69], v11 offset0:16 offset1:18
  ds_read2st64_b32 v[72:73], v52 offset0:16 offset1:18
  v_mfma_f32_16x16x32_bf16 v[76:79], a[252:255], a[200:203], v[76:79]
  buffer_load_dwordx4 v6, s[8:11], s32 offen offset:128 nt lds
  v_mfma_f32_16x16x32_bf16 v[76:79], v[172:175], a[212:215], v[76:79]
  s_add_u32 m0, s30, 20224
  ds_read2st64_b32 v[70:71], v11 offset0:20 offset1:22
  ds_read2st64_b32 v[74:75], v52 offset0:20 offset1:22
  v_mfma_f32_16x16x32_bf16 v[64:67], a[72:75], v[136:139], 0
  s_waitcnt lgkmcnt(4)
  v_accvgpr_write_b32 a216, v55
  v_accvgpr_write_b32 a217, v102
  v_mfma_f32_16x16x32_bf16 v[64:67], a[84:87], v[164:167], v[64:67]
  s_mov_b32 s30, s5
  v_accvgpr_write_b32 a218, v103
  v_accvgpr_write_b32 a219, v122
  v_mfma_f32_16x16x32_bf16 v[64:67], a[96:99], v[160:163], v[64:67]
  buffer_load_dwordx4 v6, s[8:11], s32 offen offset:256 nt lds
  v_mfma_f32_16x16x32_bf16 v[64:67], a[108:111], v[148:151], v[64:67]
  s_add_u32 s32, s32, s43
  v_cvt_pk_bf16_f32 v128, v76, v77
  v_cvt_pk_bf16_f32 v129, v78, v79
  v_mfma_f32_16x16x32_bf16 v[64:67], a[120:123], v[152:155], v[64:67]
  s_waitcnt lgkmcnt(0)
  v_perm_b32 v11, v104, v60, s58
  v_perm_b32 v60, v104, v60, s59
  v_mfma_f32_16x16x32_bf16 v[64:67], a[132:135], v[156:159], v[64:67]
  v_accvgpr_write_b32 a224, v11
  v_accvgpr_write_b32 a228, v60
  v_mfma_f32_16x16x32_bf16 v[76:79], a[136:139], v[156:159], 0
  v_perm_b32 v52, v105, v61, s58
  v_perm_b32 v61, v105, v61, s59
  v_mfma_f32_16x16x32_bf16 v[76:79], a[124:127], v[152:155], v[76:79]
  v_accvgpr_write_b32 a225, v52
  v_accvgpr_write_b32 a229, v61
  v_mfma_f32_16x16x32_bf16 v[76:79], a[112:115], v[148:151], v[76:79]
  v_cvt_pk_bf16_f32 v102, v64, v65
  v_cvt_pk_bf16_f32 v103, v66, v67
  v_mfma_f32_16x16x32_bf16 v[76:79], a[100:103], v[160:163], v[76:79]
  v_perm_b32 v11, v106, v62, s58
  v_perm_b32 v62, v106, v62, s59
  v_mfma_f32_16x16x32_bf16 v[76:79], a[88:91], v[164:167], v[76:79]
  v_accvgpr_write_b32 a226, v11
  v_accvgpr_write_b32 a230, v62
  v_mfma_f32_16x16x32_bf16 v[76:79], a[76:79], v[136:139], v[76:79]
  v_perm_b32 v60, v107, v63, s58
  v_perm_b32 v63, v107, v63, s59
  v_mfma_f32_16x16x32_bf16 v[52:55], a[80:83], v[136:139], 0
  v_accvgpr_write_b32 a227, v60
  v_accvgpr_write_b32 a231, v63
  v_mfma_f32_16x16x32_bf16 v[52:55], a[92:95], v[164:167], v[52:55]
  v_perm_b32 v11, v72, v68, s58
  v_perm_b32 v68, v72, v68, s59
  v_mfma_f32_16x16x32_bf16 v[52:55], a[104:107], v[160:163], v[52:55]
  v_cvt_pk_bf16_f32 v104, v76, v77
  v_cvt_pk_bf16_f32 v105, v78, v79
  v_mfma_f32_16x16x32_bf16 v[52:55], a[116:119], v[148:151], v[52:55]
  v_accvgpr_write_b32 a232, v11
  v_accvgpr_write_b32 a236, v68
  v_mfma_f32_16x16x32_bf16 v[52:55], a[128:131], v[152:155], v[52:55]
  v_perm_b32 v64, v73, v69, s58
  v_perm_b32 v69, v73, v69, s59
  v_mfma_f32_16x16x32_bf16 v[52:55], a[140:143], v[156:159], v[52:55]
  v_accvgpr_write_b32 a233, v64
  v_accvgpr_write_b32 a237, v69
  v_mfma_f32_16x16x32_bf16 v[60:63], v[86:89], v[56:59], v[36:39]
  v_perm_b32 v11, v74, v70, s58
  v_perm_b32 v70, v74, v70, s59
  v_mfma_f32_16x16x32_bf16 v[60:63], v[84:87], v[12:15], v[60:63]
  v_accvgpr_write_b32 a234, v11
  v_accvgpr_write_b32 a238, v70
  v_mfma_f32_16x16x32_bf16 v[64:67], v[92:95], v[56:59], v[32:35]
  v_perm_b32 v68, v75, v71, s58
  v_perm_b32 v71, v75, v71, s59
  v_mfma_f32_16x16x32_bf16 v[64:67], v[90:93], v[12:15], v[64:67]
  v_accvgpr_write_b32 a235, v68
  v_accvgpr_write_b32 a239, v71
  v_mfma_f32_16x16x32_bf16 v[180:183], v[98:101], v[56:59], v[28:31]
  v_cvt_pk_bf16_f32 v106, v52, v53
  v_cvt_pk_bf16_f32 v107, v54, v55
  v_mfma_f32_16x16x32_bf16 v[180:183], v[96:99], v[12:15], v[180:183]
  v_exp_f32 v60, v60
  v_mfma_f32_16x16x32_bf16 v[168:171], v[104:107], v[56:59], v[24:27]
  v_exp_f32 v61, v61
  v_mfma_f32_16x16x32_bf16 v[168:171], v[102:105], v[12:15], v[168:171]
  v_exp_f32 v62, v62
  v_mfma_f32_16x16x32_bf16 v[76:79], v[84:87], v[112:115], v[40:43]
  v_exp_f32 v63, v63
  v_mfma_f32_16x16x32_bf16 v[76:79], v[86:89], v[14:17], v[76:79]
  v_exp_f32 v64, v64
  v_mfma_f32_16x16x32_bf16 v[80:83], v[90:93], v[112:115], v[36:39]
  v_exp_f32 v65, v65
  v_mfma_f32_16x16x32_bf16 v[80:83], v[92:95], v[14:17], v[80:83]
  v_exp_f32 v66, v66
  v_mfma_f32_16x16x32_bf16 v[176:179], v[96:99], v[112:115], v[32:35]
  v_exp_f32 v67, v67
  v_mfma_f32_16x16x32_bf16 v[176:179], v[98:101], v[14:17], v[176:179]
  v_exp_f32 v180, v180
  v_mfma_f32_16x16x32_bf16 v[172:175], v[102:105], v[112:115], v[28:31]
  v_exp_f32 v181, v181
  v_mfma_f32_16x16x32_bf16 v[172:175], v[104:107], v[14:17], v[172:175]
  v_exp_f32 v182, v182
  v_mfma_f32_16x16x32_bf16 v[68:71], v[86:89], v[140:143], v[44:47]
  v_exp_f32 v183, v183
  v_mfma_f32_16x16x32_bf16 v[68:71], v[84:87], v[18:21], v[68:71]
  v_exp_f32 v168, v168
  v_mfma_f32_16x16x32_bf16 v[72:75], v[92:95], v[140:143], v[40:43]
  v_exp_f32 v169, v169
  v_mfma_f32_16x16x32_bf16 v[72:75], v[90:93], v[18:21], v[72:75]
  v_exp_f32 v170, v170
  v_mfma_f32_16x16x32_bf16 v[112:115], v[98:101], v[140:143], v[36:39]
  v_exp_f32 v171, v171
  v_mfma_f32_16x16x32_bf16 v[112:115], v[96:99], v[18:21], v[112:115]
  v_cvt_pk_bf16_f32 v60, v60, v61
  v_cvt_pk_bf16_f32 v61, v62, v63
  v_mfma_f32_16x16x32_bf16 v[120:123], v[104:107], v[140:143], v[32:35]
  v_cvt_pk_bf16_f32 v62, v64, v65
  v_cvt_pk_bf16_f32 v63, v66, v67
  v_mfma_f32_16x16x32_bf16 v[120:123], v[102:105], v[18:21], v[120:123]
  v_cvt_pk_bf16_f32 v64, v180, v181
  v_cvt_pk_bf16_f32 v65, v182, v183
  v_mfma_f32_16x16x32_bf16 v[140:143], a[60:63], v[156:159], 0
  v_cvt_pk_bf16_f32 v66, v168, v169
  v_cvt_pk_bf16_f32 v67, v170, v171
  v_mfma_f32_16x16x32_bf16 v[140:143], a[48:51], v[152:155], v[140:143]
  v_exp_f32 v76, v76
  v_mfma_f32_16x16x32_bf16 v[140:143], a[36:39], v[148:151], v[140:143]
  v_exp_f32 v77, v77
  v_mfma_f32_16x16x32_bf16 v[140:143], a[24:27], v[160:163], v[140:143]
  v_exp_f32 v78, v78
  v_mfma_f32_16x16x32_bf16 v[140:143], a[12:15], v[164:167], v[140:143]
  v_exp_f32 v79, v79
  v_mfma_f32_16x16x32_bf16 v[140:143], a[0:3], v[136:139], v[140:143]
  v_exp_f32 v80, v80
  v_mfma_f32_16x16x32_bf16 v[56:59], a[4:7], v[136:139], 0
  v_exp_f32 v81, v81
  v_mfma_f32_16x16x32_bf16 v[56:59], a[16:19], v[164:167], v[56:59]
  v_exp_f32 v82, v82
  v_mfma_f32_16x16x32_bf16 v[56:59], a[28:31], v[160:163], v[56:59]
  v_exp_f32 v83, v83
  v_mfma_f32_16x16x32_bf16 v[56:59], a[40:43], v[148:151], v[56:59]
  v_mul_f32 v140, s42, v140
  v_mul_f32 v141, s42, v141
  v_mfma_f32_16x16x32_bf16 v[56:59], a[52:55], v[152:155], v[56:59]
  v_mul_f32 v142, s42, v142
  v_mul_f32 v143, s42, v143
  v_mfma_f32_16x16x32_bf16 v[56:59], a[64:67], v[156:159], v[56:59]
  v_cvt_pk_bf16_f32 v168, v140, v141
  v_cvt_pk_bf16_f32 v169, v142, v143
  v_mfma_f32_16x16x32_bf16 v[52:55], a[68:71], v[156:159], 0
  v_exp_f32 v176, v176
  v_mfma_f32_16x16x32_bf16 v[52:55], a[56:59], v[152:155], v[52:55]
  v_exp_f32 v177, v177
  v_mfma_f32_16x16x32_bf16 v[52:55], a[44:47], v[148:151], v[52:55]
  v_exp_f32 v178, v178
  v_mfma_f32_16x16x32_bf16 v[52:55], a[32:35], v[160:163], v[52:55]
  v_mul_f32 v56, s42, v56
  v_mul_f32 v57, s42, v57
  v_mfma_f32_16x16x32_bf16 v[52:55], a[20:23], v[164:167], v[52:55]
  v_mul_f32 v58, s42, v58
  v_mul_f32 v59, s42, v59
  v_mfma_f32_16x16x32_bf16 v[52:55], a[8:11], v[136:139], v[52:55]
  v_cvt_pk_bf16_f32 v170, v56, v57
  v_cvt_pk_bf16_f32 v171, v58, v59
  v_mfma_f32_16x16x32_bf16 v[180:183], v[136:139], a[144:147], 0
  v_exp_f32 v179, v179
  v_mfma_f32_16x16x32_bf16 v[180:183], v[164:167], a[156:159], v[180:183]
  v_exp_f32 v172, v172
  v_mfma_f32_16x16x32_bf16 v[180:183], v[160:163], a[168:171], v[180:183]
  v_mul_f32 v52, s42, v52
  v_mul_f32 v53, s42, v53
  v_mfma_f32_16x16x32_bf16 v[180:183], v[148:151], a[180:183], v[180:183]
  v_mul_f32 v54, s42, v54
  v_mul_f32 v55, s42, v55
  v_cvt_pk_bf16_f32 v22, v52, v53
  v_cvt_pk_bf16_f32 v23, v54, v55
  v_mfma_f32_16x16x32_bf16 v[180:183], v[152:155], a[192:195], v[180:183]
  s_waitcnt vmcnt(6) lgkmcnt(0)
  s_barrier
  v_mfma_f32_16x16x32_bf16 v[180:183], v[156:159], a[204:207], v[180:183]
  v_exp_f32 v173, v173
  v_mfma_f32_16x16x32_bf16 v[52:55], v[84:87], v[168:171], v[48:51]
  v_exp_f32 v174, v174
  v_mfma_f32_16x16x32_bf16 v[52:55], v[86:89], v[20:23], v[52:55]
  v_exp_f32 v175, v175
  v_mfma_f32_16x16x32_bf16 v[56:59], v[90:93], v[168:171], v[44:47]
  v_cvt_pk_bf16_f32 v76, v76, v77
  v_cvt_pk_bf16_f32 v77, v78, v79
  v_mfma_f32_16x16x32_bf16 v[56:59], v[92:95], v[20:23], v[56:59]
  v_cvt_pk_bf16_f32 v118, v180, v181
  v_cvt_pk_bf16_f32 v119, v182, v183
  v_mfma_f32_16x16x32_bf16 v[140:143], v[96:99], v[168:171], v[40:43]
  v_cvt_pk_bf16_f32 v78, v80, v81
  v_cvt_pk_bf16_f32 v79, v82, v83
  v_mfma_f32_16x16x32_bf16 v[140:143], v[98:101], v[20:23], v[140:143]
  v_cvt_pk_bf16_f32 v80, v176, v177
  v_cvt_pk_bf16_f32 v81, v178, v179
  v_mfma_f32_16x16x32_bf16 v[88:91], v[102:105], v[168:171], v[36:39]
  v_cvt_pk_bf16_f32 v82, v172, v173
  v_cvt_pk_bf16_f32 v83, v174, v175
  v_mfma_f32_16x16x32_bf16 v[88:91], v[104:107], v[20:23], v[88:91]
  ds_read_b128 v[84:87], v3 offset:0
  ds_read_b128 a[252:255], v3 offset:4096
  v_mfma_f32_16x16x32_bf16 v[96:99], v[156:159], a[208:211], 0
  ds_read_b128 a[248:251], v3 offset:8192
  ds_read_b128 v[100:103], v3 offset:12288
  v_mfma_f32_16x16x32_bf16 v[96:99], v[152:155], a[196:199], v[96:99]
  ds_read_b128 v[104:107], v3 offset:16384
  ds_read_b128 a[244:247], v3 offset:20480
  v_mfma_f32_16x16x32_bf16 v[96:99], v[148:151], a[184:187], v[96:99]
  v_exp_f32 v68, v68
  v_mfma_f32_16x16x32_bf16 v[96:99], v[160:163], a[172:175], v[96:99]
  v_exp_f32 v69, v69
  v_mfma_f32_16x16x32_bf16 v[96:99], v[164:167], a[160:163], v[96:99]
  v_exp_f32 v70, v70
  v_mfma_f32_16x16x32_bf16 v[96:99], v[136:139], a[148:151], v[96:99]
  v_exp_f32 v71, v71
  v_mfma_f32_16x16x32_bf16 v[92:95], v[136:139], a[152:155], 0
  v_exp_f32 v72, v72
  v_mfma_f32_16x16x32_bf16 v[92:95], v[164:167], a[164:167], v[92:95]
  v_exp_f32 v73, v73
  v_mfma_f32_16x16x32_bf16 v[92:95], v[160:163], a[176:179], v[92:95]
  v_exp_f32 v74, v74
  v_mfma_f32_16x16x32_bf16 v[92:95], v[148:151], a[188:191], v[92:95]
  v_exp_f32 v75, v75
  v_mfma_f32_16x16x32_bf16 v[92:95], v[152:155], a[200:203], v[92:95]
  v_cvt_pk_bf16_f32 v126, v96, v97
  v_cvt_pk_bf16_f32 v127, v98, v99
  v_mfma_f32_16x16x32_bf16 v[92:95], v[156:159], a[212:215], v[92:95]
  v_add_u32 v0, s28, v2
  v_xor_b32 v1, 64, v0
  s_waitcnt lgkmcnt(0)
  s_nop 1
L_loop:
  v_mfma_f32_16x16x32_bf16 v[96:99], v[84:87], v[184:187], 0
  v_exp_f32 v112, v112
  v_mfma_f32_16x16x32_bf16 v[96:99], a[252:255], v[200:203], v[96:99]
  v_exp_f32 v113, v113
  v_mfma_f32_16x16x32_bf16 v[96:99], a[248:251], v[216:219], v[96:99]
  v_cvt_pk_bf16_f32 v130, v92, v93
  v_cvt_pk_bf16_f32 v131, v94, v95
  v_mfma_f32_16x16x32_bf16 v[96:99], v[100:103], v[232:235], v[96:99]
  v_exp_f32 v114, v114
  v_mfma_f32_16x16x32_bf16 v[96:99], v[104:107], v[248:251], v[96:99]
  v_exp_f32 v115, v115
  v_mfma_f32_16x16x32_bf16 v[96:99], a[244:247], a[224:227], v[96:99]
  v_exp_f32 v120, v120
  v_mfma_f32_16x16x32_bf16 v[92:95], a[244:247], a[228:231], 0
  v_exp_f32 v121, v121
  v_mfma_f32_16x16x32_bf16 v[92:95], v[104:107], v[252:255], v[92:95]
  v_exp_f32 v122, v122
  v_mfma_f32_16x16x32_bf16 v[92:95], v[100:103], v[236:239], v[92:95]
  ds_read_b128 v[136:139], v4 offset:0
  v_cvt_pk_bf16_f32 v68, v68, v69
  v_mfma_f32_16x16x32_bf16 v[92:95], a[248:251], v[220:223], v[92:95]
  ds_read_b128 v[148:151], v4 offset:4096
  v_cvt_pk_bf16_f32 v69, v70, v71
  v_mfma_f32_16x16x32_bf16 v[92:95], a[252:255], v[204:207], v[92:95]
  ds_read_b128 v[164:167], v4 offset:8192
  v_cvt_pk_bf16_f32 v70, v72, v73
  v_mfma_f32_16x16x32_bf16 v[92:95], v[84:87], v[188:191], v[92:95]
  ds_read_b128 v[152:155], v4 offset:12288
  v_cvt_pk_bf16_f32 v71, v74, v75
  v_mfma_f32_16x16x32_bf16 v[160:163], v[84:87], v[192:195], 0
  ds_read_b128 v[156:159], v4 offset:16384
  v_cvt_pk_bf16_f32 v72, v112, v113
  v_mfma_f32_16x16x32_bf16 v[160:163], a[252:255], v[208:211], v[160:163]
  ds_read_b128 v[168:171], v4 offset:20480
  v_cvt_pk_bf16_f32 v73, v114, v115
  v_mfma_f32_16x16x32_bf16 v[160:163], a[248:251], v[224:227], v[160:163]
  v_cvt_pk_bf16_f32 v96, v96, v92
  v_cvt_pk_bf16_f32 v97, v97, v93
  v_mfma_f32_16x16x32_bf16 v[160:163], v[100:103], v[240:243], v[160:163]
  v_cvt_pk_bf16_f32 v98, v98, v94
  v_cvt_pk_bf16_f32 v99, v99, v95
  v_mfma_f32_16x16x32_bf16 v[160:163], v[104:107], a[216:219], v[160:163]
  buffer_store_dword v96, v7, s[24:27], s33 offen offset:0 nt
  v_mfma_f32_16x16x32_bf16 v[160:163], a[244:247], a[232:235], v[160:163]
  v_exp_f32 v123, v123
  v_mfma_f32_16x16x32_bf16 v[92:95], a[244:247], a[236:239], 0
  v_cvt_pk_bf16_f32 v74, v120, v121
  v_cvt_pk_bf16_f32 v75, v122, v123
  v_mfma_f32_16x16x32_bf16 v[92:95], v[104:107], a[220:223], v[92:95]
  buffer_store_dword v97, v7, s[24:27], s33 offen offset:384 nt
  v_mfma_f32_16x16x32_bf16 v[92:95], v[100:103], v[244:247], v[92:95]
  ds_read_b128 a[244:247], v3 offset:512
  v_mfma_f32_16x16x32_bf16 v[92:95], a[248:251], v[228:231], v[92:95]
  ds_read_b128 v[104:107], v3 offset:4608
  v_mfma_f32_16x16x32_bf16 v[92:95], a[252:255], v[212:215], v[92:95]
  buffer_store_dword v98, v7, s[24:27], s33 offen offset:768 nt
  v_mfma_f32_16x16x32_bf16 v[92:95], v[84:87], v[196:199], v[92:95]
  s_waitcnt lgkmcnt(2)
  ds_read_b128 a[248:251], v3 offset:8704
  v_mfma_f32_16x16x32_bf16 v[100:103], v[136:139], v[184:187], 0
  ds_read_b128 a[252:255], v3 offset:12800
  v_mfma_f32_16x16x32_bf16 v[100:103], v[148:151], v[200:203], v[100:103]
  buffer_store_dword v99, v7, s[24:27], s33 offen offset:1152 nt
  v_mfma_f32_16x16x32_bf16 v[100:103], v[164:167], v[216:219], v[100:103]
  v_cvt_pk_bf16_f32 v160, v160, v92
  v_cvt_pk_bf16_f32 v161, v161, v93
  v_mfma_f32_16x16x32_bf16 v[100:103], v[152:155], v[232:235], v[100:103]
  v_cvt_pk_bf16_f32 v162, v162, v94
  v_cvt_pk_bf16_f32 v163, v163, v95
  v_mfma_f32_16x16x32_bf16 v[100:103], v[156:159], v[248:251], v[100:103]
  buffer_store_dword v160, v8, s[24:27], s33 offen offset:0 nt
  v_mfma_f32_16x16x32_bf16 v[100:103], v[168:171], a[224:227], v[100:103]
  ds_read_b128 v[84:87], v3 offset:16896
  v_mfma_f32_16x16x32_bf16 v[96:99], v[168:171], a[228:231], 0
  ds_read_b128 v[92:95], v3 offset:20992
  v_xor_b32 v3, 40960, v3
  v_mfma_f32_16x16x32_bf16 v[96:99], v[156:159], v[252:255], v[96:99]
  buffer_store_dword v161, v8, s[24:27], s33 offen offset:384 nt
  v_mfma_f32_16x16x32_bf16 v[96:99], v[152:155], v[236:239], v[96:99]
  v_exp_f32 v52, v52
  v_mfma_f32_16x16x32_bf16 v[96:99], v[164:167], v[220:223], v[96:99]
  v_exp_f32 v53, v53
  v_mfma_f32_16x16x32_bf16 v[96:99], v[148:151], v[204:207], v[96:99]
  buffer_store_dword v162, v8, s[24:27], s33 offen offset:768 nt
  v_mfma_f32_16x16x32_bf16 v[96:99], v[136:139], v[188:191], v[96:99]
  s_waitcnt lgkmcnt(0)
  v_exp_f32 v54, v54
  v_mfma_f32_16x16x32_bf16 v[112:115], a[244:247], v[184:187], 0
  v_exp_f32 v55, v55
  v_mfma_f32_16x16x32_bf16 v[112:115], v[104:107], v[200:203], v[112:115]
  buffer_store_dword v163, v8, s[24:27], s33 offen offset:1152 nt
  v_mfma_f32_16x16x32_bf16 v[112:115], a[248:251], v[216:219], v[112:115]
  v_cvt_pk_bf16_f32 v100, v100, v96
  v_cvt_pk_bf16_f32 v101, v101, v97
  v_mfma_f32_16x16x32_bf16 v[112:115], a[252:255], v[232:235], v[112:115]
  v_cvt_pk_bf16_f32 v102, v102, v98
  v_cvt_pk_bf16_f32 v103, v103, v99
  v_mfma_f32_16x16x32_bf16 v[112:115], v[84:87], v[248:251], v[112:115]
  buffer_store_dword v100, v7, s[24:27], s34 offen offset:0 nt
  v_mfma_f32_16x16x32_bf16 v[112:115], v[92:95], a[224:227], v[112:115]
  v_exp_f32 v56, v56
  v_mfma_f32_16x16x32_bf16 v[136:139], v[92:95], a[228:231], 0
  v_exp_f32 v57, v57
  v_mfma_f32_16x16x32_bf16 v[136:139], v[84:87], v[252:255], v[136:139]
  buffer_store_dword v101, v7, s[24:27], s34 offen offset:384 nt
  v_mfma_f32_16x16x32_bf16 v[136:139], a[252:255], v[236:239], v[136:139]
  ds_read_b128 v[96:99], v4 offset:512
  v_cvt_pk_bf16_f32 v52, v52, v53
  v_mfma_f32_16x16x32_bf16 v[136:139], a[248:251], v[220:223], v[136:139]
  ds_read_b128 v[120:123], v4 offset:4608
  v_cvt_pk_bf16_f32 v53, v54, v55
  v_mfma_f32_16x16x32_bf16 v[136:139], v[104:107], v[204:207], v[136:139]
  buffer_store_dword v102, v7, s[24:27], s34 offen offset:768 nt
  v_mfma_f32_16x16x32_bf16 v[136:139], a[244:247], v[188:191], v[136:139]
  ds_read_b128 v[148:151], v4 offset:8704
  v_cvt_pk_bf16_f32 v54, v56, v57
  v_mfma_f32_16x16x32_bf16 v[152:155], a[244:247], v[192:195], 0
  ds_read_b128 v[156:159], v4 offset:12800
  v_mfma_f32_16x16x32_bf16 v[152:155], v[104:107], v[208:211], v[152:155]
  buffer_store_dword v103, v7, s[24:27], s34 offen offset:1152 nt
  v_mfma_f32_16x16x32_bf16 v[152:155], a[248:251], v[224:227], v[152:155]
  v_cvt_pk_bf16_f32 v112, v112, v136
  v_cvt_pk_bf16_f32 v113, v113, v137
  v_mfma_f32_16x16x32_bf16 v[152:155], a[252:255], v[240:243], v[152:155]
  v_cvt_pk_bf16_f32 v114, v114, v138
  v_cvt_pk_bf16_f32 v115, v115, v139
  v_mfma_f32_16x16x32_bf16 v[152:155], v[84:87], a[216:219], v[152:155]
  buffer_store_dword v112, v7, s[24:27], s35 offen offset:0 nt
  v_mfma_f32_16x16x32_bf16 v[152:155], v[92:95], a[232:235], v[152:155]
  ds_read_b128 v[100:103], v4 offset:16896
  v_mfma_f32_16x16x32_bf16 v[136:139], v[92:95], a[236:239], 0
  ds_read_b128 v[160:163], v4 offset:20992
  v_xor_b32 v4, 40960, v4
  v_mfma_f32_16x16x32_bf16 v[136:139], v[84:87], a[220:223], v[136:139]
  buffer_store_dword v113, v7, s[24:27], s35 offen offset:384 nt
  v_mfma_f32_16x16x32_bf16 v[136:139], a[252:255], v[244:247], v[136:139]
  v_exp_f32 v58, v58
  v_mfma_f32_16x16x32_bf16 v[136:139], a[248:251], v[228:231], v[136:139]
  v_exp_f32 v59, v59
  v_mfma_f32_16x16x32_bf16 v[136:139], v[104:107], v[212:215], v[136:139]
  buffer_store_dword v114, v7, s[24:27], s35 offen offset:768 nt
  v_mfma_f32_16x16x32_bf16 v[136:139], a[244:247], v[196:199], v[136:139]
  s_waitcnt lgkmcnt(0)
  v_exp_f32 v140, v140
  v_mfma_f32_16x16x32_bf16 v[84:87], v[96:99], v[184:187], 0
  v_exp_f32 v141, v141
  v_mfma_f32_16x16x32_bf16 v[84:87], v[120:123], v[200:203], v[84:87]
  buffer_store_dword v115, v7, s[24:27], s35 offen offset:1152 nt
  v_mfma_f32_16x16x32_bf16 v[84:87], v[148:151], v[216:219], v[84:87]
  v_cvt_pk_bf16_f32 v152, v152, v136
  v_cvt_pk_bf16_f32 v153, v153, v137
  v_mfma_f32_16x16x32_bf16 v[84:87], v[156:159], v[232:235], v[84:87]
  v_cvt_pk_bf16_f32 v154, v154, v138
  v_cvt_pk_bf16_f32 v155, v155, v139
  v_mfma_f32_16x16x32_bf16 v[84:87], v[100:103], v[248:251], v[84:87]
  buffer_store_dword v152, v8, s[24:27], s35 offen offset:0 nt
  v_mfma_f32_16x16x32_bf16 v[84:87], v[160:163], a[224:227], v[84:87]
  v_mov_b64 v[92:93], 0
  v_cvt_pk_bf16_f32 v55, v58, v59
  v_mfma_f32_16x16x32_bf16 v[104:107], v[160:163], a[228:231], 0
  v_exp_f32 v142, v142
  v_mfma_f32_16x16x32_bf16 v[104:107], v[100:103], v[252:255], v[104:107]
  buffer_store_dword v153, v8, s[24:27], s35 offen offset:384 nt
  v_mfma_f32_16x16x32_bf16 v[104:107], v[156:159], v[236:239], v[104:107]
  v_exp_f32 v143, v143
  v_mfma_f32_16x16x32_bf16 v[104:107], v[148:151], v[220:223], v[104:107]
  v_mov_b64 v[100:101], 0
  v_cvt_pk_bf16_f32 v56, v140, v141
  v_mfma_f32_16x16x32_bf16 v[104:107], v[120:123], v[204:207], v[104:107]
  buffer_store_dword v154, v8, s[24:27], s35 offen offset:768 nt
  v_mfma_f32_16x16x32_bf16 v[104:107], v[96:99], v[188:191], v[104:107]
  v_exp_f32 v88, v88
  v_smfmac_f32_16x16x64_bf16 v[92:95], a[240:243], v[60:67], v10
  v_exp_f32 v89, v89
  v_mfma_f32_16x16x32_bf16 v[96:99], v[116:119], v[64:67], 0
  buffer_store_dword v155, v8, s[24:27], s35 offen offset:1152 nt
  v_mfma_f32_16x16x32_bf16 v[96:99], v[144:147], v[60:63], v[96:99]
  v_cvt_pk_bf16_f32 v84, v84, v104
  v_cvt_pk_bf16_f32 v85, v85, v105
  v_mfma_f32_16x16x32_bf16 v[112:115], v[132:135], v[60:63], 0
  v_cvt_pk_bf16_f32 v86, v86, v106
  v_cvt_pk_bf16_f32 v87, v87, v107
  v_mfma_f32_16x16x32_bf16 v[112:115], v[124:127], v[64:67], v[112:115]
  buffer_store_dword v84, v7, s[24:27], s36 offen offset:0 nt
  v_mfma_f32_16x16x32_bf16 v[120:123], v[128:131], v[64:67], 0
  v_mov_b64 v[104:105], 0
  v_cvt_pk_bf16_f32 v57, v142, v143
  v_mfma_f32_16x16x32_bf16 v[120:123], v[108:111], v[60:63], v[120:123]
  v_exp_f32 v90, v90
  v_smfmac_f32_16x16x64_bf16 v[100:103], a[240:243], v[76:83], v10
  buffer_store_dword v85, v7, s[24:27], s36 offen offset:384 nt
  v_mfma_f32_16x16x32_bf16 v[64:67], v[116:119], v[80:83], 0
  v_exp_f32 v91, v91
  v_mfma_f32_16x16x32_bf16 v[64:67], v[144:147], v[76:79], v[64:67]
  v_cvt_pk_bf16_f32 v58, v88, v89
  v_cvt_pk_bf16_f32 v59, v90, v91
  v_mfma_f32_16x16x32_bf16 v[136:139], v[132:135], v[76:79], 0
  buffer_store_dword v86, v7, s[24:27], s36 offen offset:768 nt
  v_mfma_f32_16x16x32_bf16 v[136:139], v[124:127], v[80:83], v[136:139]
  v_mov_b64 v[60:61], 0
  v_add_f32 v92, v92, v93
  v_mfma_f32_16x16x32_bf16 v[140:143], v[128:131], v[80:83], 0
  ds_read_b128 a[248:251], v0 offset:0
  v_add_f32 v100, v100, v101
  v_mfma_f32_16x16x32_bf16 v[140:143], v[108:111], v[76:79], v[140:143]
  buffer_store_dword v87, v7, s[24:27], s36 offen offset:1152 nt
  v_smfmac_f32_16x16x64_bf16 v[104:107], a[240:243], v[68:75], v10
  ds_read_b128 a[244:247], v1 offset:0
  v_mfma_f32_16x16x32_bf16 v[80:83], v[116:119], v[72:75], 0
  ds_read_b128 a[252:255], v0 offset:8192
  v_mfma_f32_16x16x32_bf16 v[80:83], v[144:147], v[68:71], v[80:83]
  ds_read_b128 v[76:79], v1 offset:8192
  v_mfma_f32_16x16x32_bf16 v[156:159], v[132:135], v[68:71], 0
  ds_read_b128 v[160:163], v0 offset:16384
  v_mfma_f32_16x16x32_bf16 v[156:159], v[124:127], v[72:75], v[156:159]
  ds_read_b128 v[148:151], v1 offset:16384
  v_mfma_f32_16x16x32_bf16 v[152:155], v[128:131], v[72:75], 0
  v_rcp_f32 v94, v92
  v_mfma_f32_16x16x32_bf16 v[152:155], v[108:111], v[68:71], v[152:155]
  v_mul_f32 v96, v94, v96
  v_mul_f32 v97, v94, v97
  v_smfmac_f32_16x16x64_bf16 v[60:63], a[240:243], v[52:59], v10
  v_mul_f32 v98, v94, v98
  v_mul_f32 v99, v94, v99
  v_mfma_f32_16x16x32_bf16 v[68:71], v[116:119], v[56:59], 0
L_hop_3_0:
  s_cbranch_execz L_hop_3_1
  v_cvt_pk_bf16_f32 v96, v96, v97
  v_cvt_pk_bf16_f32 v97, v98, v99
  v_mfma_f32_16x16x32_bf16 v[68:71], v[144:147], v[52:55], v[68:71]
  v_mul_f32 v112, v94, v112
  v_mul_f32 v113, v94, v113
  v_mfma_f32_16x16x32_bf16 v[72:75], v[132:135], v[52:55], 0
  v_mul_f32 v114, v94, v114
  v_mul_f32 v115, v94, v115
  v_mfma_f32_16x16x32_bf16 v[72:75], v[124:127], v[56:59], v[72:75]
  v_cvt_pk_bf16_f32 v112, v112, v113
  v_cvt_pk_bf16_f32 v113, v114, v115
  v_mfma_f32_16x16x32_bf16 v[116:119], v[128:131], v[56:59], 0
  v_mul_f32 v120, v94, v120
  v_mul_f32 v121, v94, v121
  v_mfma_f32_16x16x32_bf16 v[116:119], v[108:111], v[52:55], v[116:119]
  s_waitcnt lgkmcnt(0)
  v_mul_f32 v122, v94, v122
  v_mul_f32 v123, v94, v123
  v_mfma_f32_16x16x32_bf16 v[52:55], a[0:3], a[248:251], 0
  v_cvt_pk_bf16_f32 v120, v120, v121
  v_cvt_pk_bf16_f32 v121, v122, v123
  v_mfma_f32_16x16x32_bf16 v[52:55], a[12:15], a[244:247], v[52:55]
  v_max3_f32 v9, v92, v94, v9
  v_add_f32 v104, v104, v105
  v_mfma_f32_16x16x32_bf16 v[52:55], a[24:27], a[252:255], v[52:55]
  ds_write_b32 v5, v96 offset:0
  v_mfma_f32_16x16x32_bf16 v[52:55], a[36:39], v[76:79], v[52:55]
  ds_write_b32 v5, v97 offset:1024
  v_mfma_f32_16x16x32_bf16 v[52:55], a[48:51], v[160:163], v[52:55]
  s_add_u32 m0, s30, 0
  v_rcp_f32 v102, v100
  v_mfma_f32_16x16x32_bf16 v[52:55], a[60:63], v[148:151], v[52:55]
  buffer_load_dwordx4 v6, s[8:11], s31 offen offset:0 nt lds
  v_mfma_f32_16x16x32_bf16 v[56:59], a[64:67], v[148:151], 0
  v_mul_f32 v64, v102, v64
  v_mul_f32 v65, v102, v65
  v_mfma_f32_16x16x32_bf16 v[56:59], a[52:55], v[160:163], v[56:59]
  ds_write_b32 v5, v112 offset:2048
  v_mfma_f32_16x16x32_bf16 v[56:59], a[40:43], v[76:79], v[56:59]
  v_mul_f32 v52, s42, v52
  v_mul_f32 v53, s42, v53
  v_mfma_f32_16x16x32_bf16 v[56:59], a[28:31], a[252:255], v[56:59]
  v_mul_f32 v54, s42, v54
  v_mul_f32 v55, s42, v55
  v_mfma_f32_16x16x32_bf16 v[56:59], a[16:19], a[244:247], v[56:59]
  v_cvt_pk_bf16_f32 v12, v52, v53
  v_cvt_pk_bf16_f32 v13, v54, v55
  v_mfma_f32_16x16x32_bf16 v[56:59], a[4:7], a[248:251], v[56:59]
  ds_write_b32 v5, v113 offset:3072
  v_mfma_f32_16x16x32_bf16 v[84:87], a[8:11], a[248:251], 0
  ds_write_b32 v5, v120 offset:4096
  v_mfma_f32_16x16x32_bf16 v[84:87], a[20:23], a[244:247], v[84:87]
  ds_write_b32 v5, v121 offset:5120
  v_mfma_f32_16x16x32_bf16 v[84:87], a[32:35], a[252:255], v[84:87]
  v_mul_f32 v56, s42, v56
  v_mul_f32 v57, s42, v57
  v_mfma_f32_16x16x32_bf16 v[84:87], a[44:47], v[76:79], v[84:87]
  v_mul_f32 v58, s42, v58
  v_mul_f32 v59, s42, v59
  v_mfma_f32_16x16x32_bf16 v[84:87], a[56:59], v[160:163], v[84:87]
  s_add_u32 m0, s30, 8064
  v_cvt_pk_bf16_f32 v52, v56, v57
  v_cvt_pk_bf16_f32 v53, v58, v59
  v_mfma_f32_16x16x32_bf16 v[84:87], a[68:71], v[148:151], v[84:87]
  buffer_load_dwordx4 v6, s[8:11], s31 offen offset:128 nt lds
  v_mfma_f32_16x16x32_bf16 v[88:91], a[132:135], v[148:151], 0
  v_mul_f32 v66, v102, v66
  v_mul_f32 v67, v102, v67
  v_mfma_f32_16x16x32_bf16 v[88:91], a[120:123], v[160:163], v[88:91]
  v_cvt_pk_bf16_f32 v64, v64, v65
  v_cvt_pk_bf16_f32 v65, v66, v67
  v_mfma_f32_16x16x32_bf16 v[88:91], a[108:111], v[76:79], v[88:91]
  v_mul_f32 v84, s42, v84
  v_mul_f32 v85, s42, v85
  v_mfma_f32_16x16x32_bf16 v[88:91], a[96:99], a[252:255], v[88:91]
  v_mul_f32 v86, s42, v86
  v_mul_f32 v87, s42, v87
  v_mfma_f32_16x16x32_bf16 v[88:91], a[84:87], a[244:247], v[88:91]
  v_cvt_pk_bf16_f32 v54, v84, v85
  v_cvt_pk_bf16_f32 v55, v86, v87
  v_mfma_f32_16x16x32_bf16 v[88:91], a[72:75], a[248:251], v[88:91]
  v_mul_f32 v136, v102, v136
  v_mul_f32 v137, v102, v137
  v_mfma_f32_16x16x32_bf16 v[56:59], a[76:79], a[248:251], 0
  v_mul_f32 v138, v102, v138
  v_mul_f32 v139, v102, v139
  v_mfma_f32_16x16x32_bf16 v[56:59], a[88:91], a[244:247], v[56:59]
  v_cvt_pk_bf16_f32 v136, v136, v137
  v_cvt_pk_bf16_f32 v137, v138, v139
  v_mfma_f32_16x16x32_bf16 v[56:59], a[100:103], a[252:255], v[56:59]
  v_cvt_pk_bf16_f32 v84, v88, v89
  v_cvt_pk_bf16_f32 v85, v90, v91
  v_mfma_f32_16x16x32_bf16 v[56:59], a[112:115], v[76:79], v[56:59]
  v_mul_f32 v140, v102, v140
  v_mul_f32 v141, v102, v141
  v_mfma_f32_16x16x32_bf16 v[56:59], a[124:127], v[160:163], v[56:59]
  s_add_u32 m0, s30, 16128
  v_mul_f32 v142, v102, v142
  v_mul_f32 v143, v102, v143
  v_mfma_f32_16x16x32_bf16 v[56:59], a[136:139], v[148:151], v[56:59]
  buffer_load_dwordx4 v6, s[8:11], s31 offen offset:256 nt lds
  v_mfma_f32_16x16x32_bf16 v[90:93], a[140:143], v[148:151], 0
  v_cvt_pk_bf16_f32 v140, v140, v141
  v_cvt_pk_bf16_f32 v141, v142, v143
  v_mfma_f32_16x16x32_bf16 v[90:93], a[128:131], v[160:163], v[90:93]
  v_max3_f32 v9, v100, v102, v9
  v_add_f32 v60, v60, v61
  v_mfma_f32_16x16x32_bf16 v[90:93], a[116:119], v[76:79], v[90:93]
  v_cvt_pk_bf16_f32 v86, v56, v57
  v_cvt_pk_bf16_f32 v87, v58, v59
  v_mfma_f32_16x16x32_bf16 v[90:93], a[104:107], a[252:255], v[90:93]
  ds_write_b32 v5, v64 offset:256
  v_mfma_f32_16x16x32_bf16 v[90:93], a[92:95], a[244:247], v[90:93]
  ds_write_b32 v5, v65 offset:1280
  v_mfma_f32_16x16x32_bf16 v[90:93], a[80:83], a[248:251], v[90:93]
  ds_write_b32 v5, v136 offset:2304
  v_mfma_f32_16x16x32_bf16 v[94:97], a[248:251], a[144:147], 0
  ds_write_b32 v5, v137 offset:3328
  v_mfma_f32_16x16x32_bf16 v[94:97], a[244:247], a[156:159], v[94:97]
  ds_write_b32 v5, v140 offset:4352
  v_mfma_f32_16x16x32_bf16 v[94:97], a[252:255], a[168:171], v[94:97]
  v_cvt_pk_bf16_f32 v88, v90, v91
  v_cvt_pk_bf16_f32 v89, v92, v93
  v_mfma_f32_16x16x32_bf16 v[94:97], v[76:79], a[180:183], v[94:97]
  ds_read_b128 v[56:59], v0 offset:2048
  v_mfma_f32_16x16x32_bf16 v[94:97], v[160:163], a[192:195], v[94:97]
  s_add_u32 m0, s30, 4096
  ds_read_b128 v[98:101], v1 offset:2048
  v_mfma_f32_16x16x32_bf16 v[94:97], v[148:151], a[204:207], v[94:97]
  buffer_load_dwordx4 v6, s[8:11], s32 offen offset:0 nt lds
  v_mfma_f32_16x16x32_bf16 v[62:65], v[148:151], a[208:211], 0
  ds_read_b128 v[120:123], v0 offset:10240
  v_mfma_f32_16x16x32_bf16 v[62:65], v[160:163], a[196:199], v[62:65]
  ds_read_b128 v[124:127], v1 offset:10240
  v_mfma_f32_16x16x32_bf16 v[62:65], v[76:79], a[184:187], v[62:65]
  v_cvt_pk_bf16_f32 v144, v94, v95
  v_cvt_pk_bf16_f32 v145, v96, v97
  v_mfma_f32_16x16x32_bf16 v[62:65], a[252:255], a[172:175], v[62:65]
  ds_read_b128 v[110:113], v0 offset:18432
  v_mfma_f32_16x16x32_bf16 v[62:65], a[244:247], a[160:163], v[62:65]
  ds_read_b128 v[128:131], v1 offset:18432
  v_mfma_f32_16x16x32_bf16 v[62:65], a[248:251], a[148:151], v[62:65]
  ds_write_b32 v5, v141 offset:5376
  v_mfma_f32_16x16x32_bf16 v[90:93], a[248:251], a[152:155], 0
  v_rcp_f32 v106, v104
  v_mfma_f32_16x16x32_bf16 v[90:93], a[244:247], a[164:167], v[90:93]
  v_mul_f32 v80, v106, v80
  v_mul_f32 v81, v106, v81
  v_mfma_f32_16x16x32_bf16 v[90:93], a[252:255], a[176:179], v[90:93]
  v_cvt_pk_bf16_f32 v132, v62, v63
  v_cvt_pk_bf16_f32 v133, v64, v65
  v_mfma_f32_16x16x32_bf16 v[90:93], v[76:79], a[188:191], v[90:93]
  s_waitcnt lgkmcnt(1)
  v_mul_f32 v82, v106, v82
  v_mul_f32 v83, v106, v83
  v_mfma_f32_16x16x32_bf16 v[90:93], v[160:163], a[200:203], v[90:93]
  s_add_u32 m0, s30, 12160
  v_cvt_pk_bf16_f32 v80, v80, v81
  v_cvt_pk_bf16_f32 v81, v82, v83
  v_mfma_f32_16x16x32_bf16 v[90:93], v[148:151], a[212:215], v[90:93]
  buffer_load_dwordx4 v6, s[8:11], s32 offen offset:128 nt lds
  v_mfma_f32_16x16x32_bf16 v[62:65], a[0:3], v[56:59], 0
  v_mul_f32 v156, v106, v156
  v_mul_f32 v157, v106, v157
  v_mfma_f32_16x16x32_bf16 v[62:65], a[12:15], v[98:101], v[62:65]
  v_mul_f32 v158, v106, v158
  v_mul_f32 v159, v106, v159
  v_mfma_f32_16x16x32_bf16 v[62:65], a[24:27], v[120:123], v[62:65]
  v_cvt_pk_bf16_f32 v108, v90, v91
  v_cvt_pk_bf16_f32 v109, v92, v93
  v_mfma_f32_16x16x32_bf16 v[62:65], a[36:39], v[124:127], v[62:65]
  v_cvt_pk_bf16_f32 v156, v156, v157
  v_cvt_pk_bf16_f32 v157, v158, v159
  v_mfma_f32_16x16x32_bf16 v[62:65], a[48:51], v[110:113], v[62:65]
  v_mul_f32 v152, v106, v152
  v_mul_f32 v153, v106, v153
  v_mfma_f32_16x16x32_bf16 v[62:65], a[60:63], v[128:131], v[62:65]
  v_mul_f32 v154, v106, v154
  v_mul_f32 v155, v106, v155
  v_mfma_f32_16x16x32_bf16 v[76:79], a[64:67], v[128:131], 0
  v_cvt_pk_bf16_f32 v152, v152, v153
  v_cvt_pk_bf16_f32 v153, v154, v155
  v_mfma_f32_16x16x32_bf16 v[76:79], a[52:55], v[110:113], v[76:79]
  v_max3_f32 v9, v104, v106, v9
  v_mfma_f32_16x16x32_bf16 v[76:79], a[40:43], v[124:127], v[76:79]
  v_mul_f32 v62, s42, v62
  v_mul_f32 v63, s42, v63
  v_mfma_f32_16x16x32_bf16 v[76:79], a[28:31], v[120:123], v[76:79]
  v_mul_f32 v64, s42, v64
  v_mul_f32 v65, s42, v65
  v_mfma_f32_16x16x32_bf16 v[76:79], a[16:19], v[98:101], v[76:79]
  s_add_u32 m0, s30, 20224
  v_cvt_pk_bf16_f32 v140, v62, v63
  v_cvt_pk_bf16_f32 v141, v64, v65
  v_mfma_f32_16x16x32_bf16 v[76:79], a[4:7], v[56:59], v[76:79]
  buffer_load_dwordx4 v6, s[8:11], s32 offen offset:256 nt lds
  v_mfma_f32_16x16x32_bf16 v[90:93], a[8:11], v[56:59], 0
  s_add_u32 s33, s31, s37
  v_rcp_f32 v62, v60
  v_mfma_f32_16x16x32_bf16 v[90:93], a[20:23], v[98:101], v[90:93]
  s_add_u32 s34, s31, s38
  ds_write_b32 v5, v80 offset:512
  v_mfma_f32_16x16x32_bf16 v[90:93], a[32:35], v[120:123], v[90:93]
  s_add_u32 s35, s31, s39
  v_mul_f32 v76, s42, v76
  v_mul_f32 v77, s42, v77
  v_mfma_f32_16x16x32_bf16 v[90:93], a[44:47], v[124:127], v[90:93]
  s_add_u32 s36, s31, s40
  v_mul_f32 v78, s42, v78
  v_mul_f32 v79, s42, v79
  v_mfma_f32_16x16x32_bf16 v[90:93], a[56:59], v[110:113], v[90:93]
  s_add_u32 s31, s31, s43
  v_cvt_pk_bf16_f32 v142, v76, v77
  v_cvt_pk_bf16_f32 v143, v78, v79
  v_mfma_f32_16x16x32_bf16 v[90:93], a[68:71], v[128:131], v[90:93]
  s_add_u32 s32, s32, s43
  ds_write_b32 v5, v81 offset:1536
  v_mfma_f32_16x16x32_bf16 v[64:67], a[132:135], v[128:131], 0
  s_mov_b32 s5, s28
  ds_write_b32 v5, v156 offset:2560
  v_mfma_f32_16x16x32_bf16 v[64:67], a[120:123], v[110:113], v[64:67]
  s_mov_b32 s28, s29
  ds_write_b32 v5, v157 offset:3584
  v_mfma_f32_16x16x32_bf16 v[64:67], a[108:111], v[124:127], v[64:67]
  s_mov_b32 s29, s30
  v_mul_f32 v90, s42, v90
  v_mul_f32 v91, s42, v91
  v_mfma_f32_16x16x32_bf16 v[64:67], a[96:99], v[120:123], v[64:67]
  s_mov_b32 s30, s5
  v_mul_f32 v92, s42, v92
  v_mul_f32 v93, s42, v93
  v_mfma_f32_16x16x32_bf16 v[64:67], a[84:87], v[98:101], v[64:67]
  v_cvt_pk_bf16_f32 v16, v90, v91
  v_cvt_pk_bf16_f32 v17, v92, v93
  v_mfma_f32_16x16x32_bf16 v[64:67], a[72:75], v[56:59], v[64:67]
  ds_write_b32 v5, v152 offset:4608
  v_mfma_f32_16x16x32_bf16 v[76:79], a[76:79], v[56:59], 0
  ds_write_b32 v5, v153 offset:5632
  v_mfma_f32_16x16x32_bf16 v[76:79], a[88:91], v[98:101], v[76:79]
  v_mul_f32 v68, v62, v68
  v_mul_f32 v69, v62, v69
  v_mfma_f32_16x16x32_bf16 v[76:79], a[100:103], v[120:123], v[76:79]
  v_cvt_pk_bf16_f32 v90, v64, v65
  v_cvt_pk_bf16_f32 v91, v66, v67
  v_mfma_f32_16x16x32_bf16 v[76:79], a[112:115], v[124:127], v[76:79]
  v_mul_f32 v70, v62, v70
  v_mul_f32 v71, v62, v71
  v_mfma_f32_16x16x32_bf16 v[76:79], a[124:127], v[110:113], v[76:79]
  v_cvt_pk_bf16_f32 v68, v68, v69
  v_cvt_pk_bf16_f32 v69, v70, v71
  v_mfma_f32_16x16x32_bf16 v[76:79], a[136:139], v[128:131], v[76:79]
  v_mul_f32 v72, v62, v72
  v_mul_f32 v73, v62, v73
  v_mfma_f32_16x16x32_bf16 v[64:67], a[140:143], v[128:131], 0
  v_mul_f32 v74, v62, v74
  v_mul_f32 v75, v62, v75
  v_mfma_f32_16x16x32_bf16 v[64:67], a[128:131], v[110:113], v[64:67]
  v_cvt_pk_bf16_f32 v72, v72, v73
  v_cvt_pk_bf16_f32 v73, v74, v75
  v_mfma_f32_16x16x32_bf16 v[64:67], a[116:119], v[124:127], v[64:67]
  v_cvt_pk_bf16_f32 v92, v76, v77
  v_cvt_pk_bf16_f32 v93, v78, v79
  v_mfma_f32_16x16x32_bf16 v[64:67], a[104:107], v[120:123], v[64:67]
  v_mul_f32 v116, v62, v116
  v_mul_f32 v117, v62, v117
  v_mfma_f32_16x16x32_bf16 v[64:67], a[92:95], v[98:101], v[64:67]
  v_mul_f32 v118, v62, v118
  v_mul_f32 v119, v62, v119
  v_mfma_f32_16x16x32_bf16 v[64:67], a[80:83], v[56:59], v[64:67]
  v_cvt_pk_bf16_f32 v116, v116, v117
  v_cvt_pk_bf16_f32 v117, v118, v119
  v_mfma_f32_16x16x32_bf16 v[74:77], v[56:59], a[144:147], 0
  v_max3_f32 v9, v60, v62, v9
  v_mfma_f32_16x16x32_bf16 v[74:77], v[98:101], a[156:159], v[74:77]
  ds_write_b32 v5, v68 offset:768
  v_mfma_f32_16x16x32_bf16 v[74:77], v[120:123], a[168:171], v[74:77]
  v_cvt_pk_bf16_f32 v94, v64, v65
  v_cvt_pk_bf16_f32 v95, v66, v67
  v_mfma_f32_16x16x32_bf16 v[74:77], v[124:127], a[180:183], v[74:77]
  ds_read_b128 a[244:247], v0 offset:4096
  v_mfma_f32_16x16x32_bf16 v[74:77], v[110:113], a[192:195], v[74:77]
  ds_read_b128 a[252:255], v1 offset:4096
  v_mfma_f32_16x16x32_bf16 v[74:77], v[128:131], a[204:207], v[74:77]
  ds_read_b128 a[248:251], v0 offset:12288
  v_mfma_f32_16x16x32_bf16 v[60:63], v[128:131], a[208:211], 0
  ds_read_b128 v[102:105], v1 offset:12288
  v_mfma_f32_16x16x32_bf16 v[60:63], v[110:113], a[196:199], v[60:63]
  ds_read_b128 v[64:67], v0 offset:20480
  v_mfma_f32_16x16x32_bf16 v[60:63], v[124:127], a[184:187], v[60:63]
  v_cvt_pk_bf16_f32 v146, v74, v75
  v_cvt_pk_bf16_f32 v147, v76, v77
  v_mfma_f32_16x16x32_bf16 v[60:63], v[120:123], a[172:175], v[60:63]
  ds_read_b128 v[78:81], v1 offset:20480
  v_mfma_f32_16x16x32_bf16 v[60:63], v[98:101], a[160:163], v[60:63]
  ds_write_b32 v5, v69 offset:1792
  v_mfma_f32_16x16x32_bf16 v[60:63], v[56:59], a[148:151], v[60:63]
  ds_write_b32 v5, v72 offset:2816
  v_mfma_f32_16x16x32_bf16 v[74:77], v[56:59], a[152:155], 0
  ds_write_b32 v5, v73 offset:3840
  v_mfma_f32_16x16x32_bf16 v[74:77], v[98:101], a[164:167], v[74:77]
  ds_write_b32 v5, v116 offset:4864
  v_mfma_f32_16x16x32_bf16 v[74:77], v[120:123], a[176:179], v[74:77]
  v_cvt_pk_bf16_f32 v134, v60, v61
  v_cvt_pk_bf16_f32 v135, v62, v63
  v_mfma_f32_16x16x32_bf16 v[74:77], v[124:127], a[188:191], v[74:77]
  ds_write_b32 v5, v117 offset:5888
  v_mfma_f32_16x16x32_bf16 v[74:77], v[110:113], a[200:203], v[74:77]
  v_xor_b32 v5, s41, v5
  v_mfma_f32_16x16x32_bf16 v[74:77], v[128:131], a[212:215], v[74:77]
  s_waitcnt lgkmcnt(5)
  v_mfma_f32_16x16x32_bf16 v[56:59], a[0:3], a[244:247], 0
  v_mfma_f32_16x16x32_bf16 v[56:59], a[12:15], a[252:255], v[56:59]
  v_mfma_f32_16x16x32_bf16 v[56:59], a[24:27], a[248:251], v[56:59]
  v_cvt_pk_bf16_f32 v110, v74, v75
  v_cvt_pk_bf16_f32 v111, v76, v77
  v_mfma_f32_16x16x32_bf16 v[56:59], a[36:39], v[102:105], v[56:59]
  v_mfma_f32_16x16x32_bf16 v[56:59], a[48:51], v[64:67], v[56:59]
  v_mfma_f32_16x16x32_bf16 v[56:59], a[60:63], v[78:81], v[56:59]
  v_mfma_f32_16x16x32_bf16 v[60:63], a[64:67], v[78:81], 0
  v_mfma_f32_16x16x32_bf16 v[60:63], a[52:55], v[64:67], v[60:63]
  v_mfma_f32_16x16x32_bf16 v[60:63], a[40:43], v[102:105], v[60:63]
  v_mul_f32 v56, s42, v56
  v_mul_f32 v57, s42, v57
  v_mfma_f32_16x16x32_bf16 v[60:63], a[28:31], a[248:251], v[60:63]
  v_mul_f32 v58, s42, v58
  v_mul_f32 v59, s42, v59
  v_mfma_f32_16x16x32_bf16 v[60:63], a[16:19], a[252:255], v[60:63]
  v_cvt_pk_bf16_f32 v18, v56, v57
  v_cvt_pk_bf16_f32 v19, v58, v59
  v_mfma_f32_16x16x32_bf16 v[60:63], a[4:7], a[244:247], v[60:63]
  v_mfma_f32_16x16x32_bf16 v[68:71], a[8:11], a[244:247], 0
  v_mfma_f32_16x16x32_bf16 v[68:71], a[20:23], a[252:255], v[68:71]
  v_mfma_f32_16x16x32_bf16 v[68:71], a[32:35], a[248:251], v[68:71]
  v_mul_f32 v60, s42, v60
  v_mul_f32 v61, s42, v61
  v_mfma_f32_16x16x32_bf16 v[68:71], a[44:47], v[102:105], v[68:71]
  v_mul_f32 v62, s42, v62
  v_mul_f32 v63, s42, v63
  v_mfma_f32_16x16x32_bf16 v[68:71], a[56:59], v[64:67], v[68:71]
  v_cvt_pk_bf16_f32 v56, v60, v61
  v_cvt_pk_bf16_f32 v57, v62, v63
  v_mfma_f32_16x16x32_bf16 v[68:71], a[68:71], v[78:81], v[68:71]
  v_mfma_f32_16x16x32_bf16 v[72:75], a[132:135], v[78:81], 0
  v_mfma_f32_16x16x32_bf16 v[72:75], a[120:123], v[64:67], v[72:75]
  v_mfma_f32_16x16x32_bf16 v[72:75], a[108:111], v[102:105], v[72:75]
  v_mul_f32 v68, s42, v68
  v_mul_f32 v69, s42, v69
  v_mfma_f32_16x16x32_bf16 v[72:75], a[96:99], a[248:251], v[72:75]
  v_mul_f32 v70, s42, v70
  v_mul_f32 v71, s42, v71
  v_mfma_f32_16x16x32_bf16 v[72:75], a[84:87], a[252:255], v[72:75]
  v_cvt_pk_bf16_f32 v58, v68, v69
  v_cvt_pk_bf16_f32 v59, v70, v71
  v_mfma_f32_16x16x32_bf16 v[72:75], a[72:75], a[244:247], v[72:75]
  v_mfma_f32_16x16x32_bf16 v[60:63], a[76:79], a[244:247], 0
  v_mfma_f32_16x16x32_bf16 v[60:63], a[88:91], a[252:255], v[60:63]
  v_mfma_f32_16x16x32_bf16 v[60:63], a[100:103], a[248:251], v[60:63]
  v_cvt_pk_bf16_f32 v96, v72, v73
  v_cvt_pk_bf16_f32 v97, v74, v75
  v_mfma_f32_16x16x32_bf16 v[60:63], a[112:115], v[102:105], v[60:63]
  v_mfma_f32_16x16x32_bf16 v[60:63], a[124:127], v[64:67], v[60:63]
  v_mfma_f32_16x16x32_bf16 v[60:63], a[136:139], v[78:81], v[60:63]
  v_mfma_f32_16x16x32_bf16 v[68:71], a[140:143], v[78:81], 0
  v_mfma_f32_16x16x32_bf16 v[68:71], a[128:131], v[64:67], v[68:71]
  v_mfma_f32_16x16x32_bf16 v[68:71], a[116:119], v[102:105], v[68:71]
  v_cvt_pk_bf16_f32 v98, v60, v61
  v_cvt_pk_bf16_f32 v99, v62, v63
  v_mfma_f32_16x16x32_bf16 v[68:71], a[104:107], a[248:251], v[68:71]
  v_mfma_f32_16x16x32_bf16 v[68:71], a[92:95], a[252:255], v[68:71]
  v_mfma_f32_16x16x32_bf16 v[68:71], a[80:83], a[244:247], v[68:71]
  v_mfma_f32_16x16x32_bf16 v[60:63], a[244:247], a[144:147], 0
  v_mfma_f32_16x16x32_bf16 v[60:63], a[252:255], a[156:159], v[60:63]
  v_mfma_f32_16x16x32_bf16 v[60:63], a[248:251], a[168:171], v[60:63]
  v_cvt_pk_bf16_f32 v100, v68, v69
  v_cvt_pk_bf16_f32 v101, v70, v71
  v_mfma_f32_16x16x32_bf16 v[60:63], v[102:105], a[180:183], v[60:63]
  ds_read_b128 v[148:151], v0 offset:6144
  v_mfma_f32_16x16x32_bf16 v[60:63], v[64:67], a[192:195], v[60:63]
  ds_read_b128 v[156:159], v1 offset:6144
  v_mfma_f32_16x16x32_bf16 v[60:63], v[78:81], a[204:207], v[60:63]
  ds_read_b128 v[164:167], v0 offset:14336
  v_mfma_f32_16x16x32_bf16 v[68:71], v[78:81], a[208:211], 0
  ds_read_b128 v[152:155], v1 offset:14336
  v_mfma_f32_16x16x32_bf16 v[68:71], v[64:67], a[196:199], v[68:71]
  ds_read_b128 v[160:163], v0 offset:22528
  v_mfma_f32_16x16x32_bf16 v[68:71], v[102:105], a[184:187], v[68:71]
  v_cvt_pk_bf16_f32 v116, v60, v61
  v_cvt_pk_bf16_f32 v117, v62, v63
  v_mfma_f32_16x16x32_bf16 v[68:71], a[248:251], a[172:175], v[68:71]
  ds_read_b128 v[136:139], v1 offset:22528
  v_mfma_f32_16x16x32_bf16 v[68:71], a[252:255], a[160:163], v[68:71]
  v_mfma_f32_16x16x32_bf16 v[68:71], a[244:247], a[148:151], v[68:71]
  v_mfma_f32_16x16x32_bf16 v[60:63], a[244:247], a[152:155], 0
  v_mfma_f32_16x16x32_bf16 v[60:63], a[252:255], a[164:167], v[60:63]
  v_mfma_f32_16x16x32_bf16 v[60:63], a[248:251], a[176:179], v[60:63]
  v_cvt_pk_bf16_f32 v124, v68, v69
  v_cvt_pk_bf16_f32 v125, v70, v71
  v_mfma_f32_16x16x32_bf16 v[60:63], v[102:105], a[188:191], v[60:63]
  v_mfma_f32_16x16x32_bf16 v[60:63], v[64:67], a[200:203], v[60:63]
  v_mfma_f32_16x16x32_bf16 v[60:63], v[78:81], a[212:215], v[60:63]
  s_waitcnt lgkmcnt(0)
  v_mfma_f32_16x16x32_bf16 v[68:71], a[72:75], v[148:151], 0
  v_mfma_f32_16x16x32_bf16 v[68:71], a[84:87], v[156:159], v[68:71]
  v_mfma_f32_16x16x32_bf16 v[68:71], a[96:99], v[164:167], v[68:71]
  v_cvt_pk_bf16_f32 v128, v60, v61
  v_cvt_pk_bf16_f32 v129, v62, v63
  v_mfma_f32_16x16x32_bf16 v[68:71], a[108:111], v[152:155], v[68:71]
  v_mfma_f32_16x16x32_bf16 v[68:71], a[120:123], v[160:163], v[68:71]
  s_waitcnt vmcnt(30)
  s_barrier
  v_mfma_f32_16x16x32_bf16 v[68:71], a[132:135], v[136:139], v[68:71]
  v_add_u32 v0, s28, v2
  v_xor_b32 v1, 64, v0
  v_mfma_f32_16x16x32_bf16 v[60:63], a[136:139], v[136:139], 0
  v_mfma_f32_16x16x32_bf16 v[60:63], a[124:127], v[160:163], v[60:63]
  v_mfma_f32_16x16x32_bf16 v[60:63], a[112:115], v[152:155], v[60:63]
  v_cvt_pk_bf16_f32 v102, v68, v69
  v_cvt_pk_bf16_f32 v103, v70, v71
  v_mfma_f32_16x16x32_bf16 v[60:63], a[100:103], v[164:167], v[60:63]
  v_mfma_f32_16x16x32_bf16 v[60:63], a[88:91], v[156:159], v[60:63]
  v_mfma_f32_16x16x32_bf16 v[60:63], a[76:79], v[148:151], v[60:63]
  v_mfma_f32_16x16x32_bf16 v[68:71], a[80:83], v[148:151], 0
  v_mfma_f32_16x16x32_bf16 v[68:71], a[92:95], v[156:159], v[68:71]
  v_mfma_f32_16x16x32_bf16 v[68:71], a[104:107], v[164:167], v[68:71]
  v_cvt_pk_bf16_f32 v104, v60, v61
  v_cvt_pk_bf16_f32 v105, v62, v63
  v_mfma_f32_16x16x32_bf16 v[68:71], a[116:119], v[152:155], v[68:71]
  v_mfma_f32_16x16x32_bf16 v[68:71], a[128:131], v[160:163], v[68:71]
  v_mfma_f32_16x16x32_bf16 v[68:71], a[140:143], v[136:139], v[68:71]
  v_mfma_f32_16x16x32_bf16 v[60:63], v[86:89], v[52:55], v[36:39]
  v_mfma_f32_16x16x32_bf16 v[60:63], v[84:87], v[12:15], v[60:63]
  v_mfma_f32_16x16x32_bf16 v[64:67], v[92:95], v[52:55], v[32:35]
  v_cvt_pk_bf16_f32 v106, v68, v69
  v_cvt_pk_bf16_f32 v107, v70, v71
  v_mfma_f32_16x16x32_bf16 v[64:67], v[90:93], v[12:15], v[64:67]
  v_mfma_f32_16x16x32_bf16 v[172:175], v[98:101], v[52:55], v[28:31]
  v_exp_f32 v60, v60
  v_mfma_f32_16x16x32_bf16 v[172:175], v[96:99], v[12:15], v[172:175]
  v_exp_f32 v61, v61
  v_mfma_f32_16x16x32_bf16 v[168:171], v[104:107], v[52:55], v[24:27]
  v_exp_f32 v62, v62
  v_mfma_f32_16x16x32_bf16 v[168:171], v[102:105], v[12:15], v[168:171]
  v_exp_f32 v63, v63
  v_mfma_f32_16x16x32_bf16 v[76:79], v[84:87], v[140:143], v[40:43]
  v_exp_f32 v64, v64
  v_mfma_f32_16x16x32_bf16 v[76:79], v[86:89], v[14:17], v[76:79]
  v_exp_f32 v65, v65
  v_mfma_f32_16x16x32_bf16 v[80:83], v[90:93], v[140:143], v[36:39]
  v_exp_f32 v66, v66
  v_mfma_f32_16x16x32_bf16 v[80:83], v[92:95], v[14:17], v[80:83]
  v_exp_f32 v67, v67
  v_mfma_f32_16x16x32_bf16 v[176:179], v[96:99], v[140:143], v[32:35]
  v_exp_f32 v172, v172
  v_mfma_f32_16x16x32_bf16 v[176:179], v[98:101], v[14:17], v[176:179]
  v_exp_f32 v173, v173
  v_mfma_f32_16x16x32_bf16 v[180:183], v[102:105], v[140:143], v[28:31]
  v_exp_f32 v174, v174
  v_mfma_f32_16x16x32_bf16 v[180:183], v[104:107], v[14:17], v[180:183]
  v_exp_f32 v175, v175
  v_mfma_f32_16x16x32_bf16 v[68:71], v[86:89], v[56:59], v[44:47]
  v_exp_f32 v168, v168
  v_mfma_f32_16x16x32_bf16 v[68:71], v[84:87], v[18:21], v[68:71]
  v_exp_f32 v169, v169
  v_mfma_f32_16x16x32_bf16 v[72:75], v[92:95], v[56:59], v[40:43]
  v_exp_f32 v170, v170
  v_mfma_f32_16x16x32_bf16 v[72:75], v[90:93], v[18:21], v[72:75]
  v_exp_f32 v171, v171
  v_mfma_f32_16x16x32_bf16 v[112:115], v[98:101], v[56:59], v[36:39]
  v_cvt_pk_bf16_f32 v60, v60, v61
  v_cvt_pk_bf16_f32 v61, v62, v63
  v_mfma_f32_16x16x32_bf16 v[112:115], v[96:99], v[18:21], v[112:115]
  v_cvt_pk_bf16_f32 v62, v64, v65
  v_cvt_pk_bf16_f32 v63, v66, v67
  v_mfma_f32_16x16x32_bf16 v[120:123], v[104:107], v[56:59], v[32:35]
  v_cvt_pk_bf16_f32 v64, v172, v173
  v_cvt_pk_bf16_f32 v65, v174, v175
  v_mfma_f32_16x16x32_bf16 v[120:123], v[102:105], v[18:21], v[120:123]
  v_cvt_pk_bf16_f32 v66, v168, v169
  v_cvt_pk_bf16_f32 v67, v170, v171
  v_mfma_f32_16x16x32_bf16 v[52:55], a[60:63], v[136:139], 0
  v_exp_f32 v76, v76
  v_mfma_f32_16x16x32_bf16 v[52:55], a[48:51], v[160:163], v[52:55]
  v_exp_f32 v77, v77
  v_mfma_f32_16x16x32_bf16 v[52:55], a[36:39], v[152:155], v[52:55]
  v_exp_f32 v78, v78
  v_mfma_f32_16x16x32_bf16 v[52:55], a[24:27], v[164:167], v[52:55]
  v_exp_f32 v79, v79
  v_mfma_f32_16x16x32_bf16 v[52:55], a[12:15], v[156:159], v[52:55]
  v_exp_f32 v80, v80
  v_mfma_f32_16x16x32_bf16 v[52:55], a[0:3], v[148:151], v[52:55]
  v_exp_f32 v81, v81
  v_mfma_f32_16x16x32_bf16 v[56:59], a[4:7], v[148:151], 0
  v_exp_f32 v82, v82
  v_mfma_f32_16x16x32_bf16 v[56:59], a[16:19], v[156:159], v[56:59]
  v_exp_f32 v83, v83
  v_mfma_f32_16x16x32_bf16 v[56:59], a[28:31], v[164:167], v[56:59]
  v_mul_f32 v52, s42, v52
  v_mul_f32 v53, s42, v53
  v_mfma_f32_16x16x32_bf16 v[56:59], a[40:43], v[152:155], v[56:59]
  v_mul_f32 v54, s42, v54
  v_mul_f32 v55, s42, v55
  v_mfma_f32_16x16x32_bf16 v[56:59], a[52:55], v[160:163], v[56:59]
  v_cvt_pk_bf16_f32 v168, v52, v53
  v_cvt_pk_bf16_f32 v169, v54, v55
  v_mfma_f32_16x16x32_bf16 v[56:59], a[64:67], v[136:139], v[56:59]
  v_exp_f32 v176, v176
  v_mfma_f32_16x16x32_bf16 v[140:143], a[68:71], v[136:139], 0
  v_exp_f32 v177, v177
  v_mfma_f32_16x16x32_bf16 v[140:143], a[56:59], v[160:163], v[140:143]
  v_exp_f32 v178, v178
  v_mfma_f32_16x16x32_bf16 v[140:143], a[44:47], v[152:155], v[140:143]
  v_mul_f32 v56, s42, v56
  v_mul_f32 v57, s42, v57
  v_mfma_f32_16x16x32_bf16 v[140:143], a[32:35], v[164:167], v[140:143]
  v_mul_f32 v58, s42, v58
  v_mul_f32 v59, s42, v59
  v_mfma_f32_16x16x32_bf16 v[140:143], a[20:23], v[156:159], v[140:143]
  v_cvt_pk_bf16_f32 v170, v56, v57
  v_cvt_pk_bf16_f32 v171, v58, v59
  v_mfma_f32_16x16x32_bf16 v[140:143], a[8:11], v[148:151], v[140:143]
  v_exp_f32 v179, v179
  v_mfma_f32_16x16x32_bf16 v[172:175], v[148:151], a[144:147], 0
  v_exp_f32 v180, v180
  v_mfma_f32_16x16x32_bf16 v[172:175], v[156:159], a[156:159], v[172:175]
  v_exp_f32 v181, v181
  v_mfma_f32_16x16x32_bf16 v[172:175], v[164:167], a[168:171], v[172:175]
  v_mul_f32 v140, s42, v140
  v_mul_f32 v141, s42, v141
  v_mfma_f32_16x16x32_bf16 v[172:175], v[152:155], a[180:183], v[172:175]
  v_mul_f32 v142, s42, v142
  v_mul_f32 v143, s42, v143
  v_mfma_f32_16x16x32_bf16 v[172:175], v[160:163], a[192:195], v[172:175]
  v_cvt_pk_bf16_f32 v22, v140, v141
  v_cvt_pk_bf16_f32 v23, v142, v143
  v_mfma_f32_16x16x32_bf16 v[172:175], v[136:139], a[204:207], v[172:175]
  v_exp_f32 v182, v182
  v_mfma_f32_16x16x32_bf16 v[52:55], v[84:87], v[168:171], v[48:51]
  v_exp_f32 v183, v183
  v_mfma_f32_16x16x32_bf16 v[52:55], v[86:89], v[20:23], v[52:55]
  v_cvt_pk_bf16_f32 v76, v76, v77
  v_cvt_pk_bf16_f32 v77, v78, v79
  v_mfma_f32_16x16x32_bf16 v[56:59], v[90:93], v[168:171], v[44:47]
  v_cvt_pk_bf16_f32 v118, v172, v173
  v_cvt_pk_bf16_f32 v119, v174, v175
  v_mfma_f32_16x16x32_bf16 v[56:59], v[92:95], v[20:23], v[56:59]
  v_cvt_pk_bf16_f32 v78, v80, v81
  v_cvt_pk_bf16_f32 v79, v82, v83
  v_mfma_f32_16x16x32_bf16 v[140:143], v[96:99], v[168:171], v[40:43]
  ds_read_b128 v[84:87], v3 offset:0
  v_cvt_pk_bf16_f32 v80, v176, v177
  v_mfma_f32_16x16x32_bf16 v[140:143], v[98:101], v[20:23], v[140:143]
  ds_read_b128 a[252:255], v3 offset:4096
  v_cvt_pk_bf16_f32 v81, v178, v179
  v_mfma_f32_16x16x32_bf16 v[88:91], v[102:105], v[168:171], v[36:39]
  ds_read_b128 a[248:251], v3 offset:8192
  v_cvt_pk_bf16_f32 v82, v180, v181
  v_mfma_f32_16x16x32_bf16 v[88:91], v[104:107], v[20:23], v[88:91]
  ds_read_b128 v[100:103], v3 offset:12288
  v_cvt_pk_bf16_f32 v83, v182, v183
  v_mfma_f32_16x16x32_bf16 v[96:99], v[136:139], a[208:211], 0
  ds_read_b128 v[104:107], v3 offset:16384
  v_mfma_f32_16x16x32_bf16 v[96:99], v[160:163], a[196:199], v[96:99]
  ds_read_b128 a[244:247], v3 offset:20480
  v_mfma_f32_16x16x32_bf16 v[96:99], v[152:155], a[184:187], v[96:99]
  v_exp_f32 v68, v68
  v_mfma_f32_16x16x32_bf16 v[96:99], v[164:167], a[172:175], v[96:99]
  v_exp_f32 v69, v69
  v_mfma_f32_16x16x32_bf16 v[96:99], v[156:159], a[160:163], v[96:99]
  v_exp_f32 v70, v70
  v_mfma_f32_16x16x32_bf16 v[96:99], v[148:151], a[148:151], v[96:99]
  v_exp_f32 v71, v71
  v_mfma_f32_16x16x32_bf16 v[92:95], v[148:151], a[152:155], 0
  v_exp_f32 v72, v72
  v_mfma_f32_16x16x32_bf16 v[92:95], v[156:159], a[164:167], v[92:95]
  v_exp_f32 v73, v73
  v_mfma_f32_16x16x32_bf16 v[92:95], v[164:167], a[176:179], v[92:95]
  v_cvt_pk_bf16_f32 v126, v96, v97
  v_cvt_pk_bf16_f32 v127, v98, v99
  v_mfma_f32_16x16x32_bf16 v[92:95], v[152:155], a[188:191], v[92:95]
  s_cmp_lt_u32 s31, 106954752
  v_exp_f32 v74, v74
  v_mfma_f32_16x16x32_bf16 v[92:95], v[160:163], a[200:203], v[92:95]
  s_waitcnt lgkmcnt(0)
  v_exp_f32 v75, v75
  v_mfma_f32_16x16x32_bf16 v[92:95], v[136:139], a[212:215], v[92:95]
  s_cbranch_scc1 L_loop
L_epi:
  v_mfma_f32_16x16x32_bf16 v[160:163], v[84:87], v[184:187], 0
  s_lshl_b32 s5, s3, 3
  v_mov_b64 v[96:97], 0
  v_cvt_pk_bf16_f32 v68, v68, v69
  v_mfma_f32_16x16x32_bf16 v[160:163], a[252:255], v[200:203], v[160:163]
L_hop_0_1:
  s_cbranch_execz L_walk
  s_add_u32 s5, s5, 155648
  v_exp_f32 v112, v112
  v_mfma_f32_16x16x32_bf16 v[160:163], a[248:251], v[216:219], v[160:163]
  v_cvt_pk_bf16_f32 v130, v92, v93
  v_cvt_pk_bf16_f32 v131, v94, v95
  v_mfma_f32_16x16x32_bf16 v[160:163], v[100:103], v[232:235], v[160:163]
  v_mov_b64 v[136:137], 0
  v_cvt_pk_bf16_f32 v69, v70, v71
  v_mfma_f32_16x16x32_bf16 v[160:163], v[104:107], v[248:251], v[160:163]
  v_exp_f32 v113, v113
  v_mfma_f32_16x16x32_bf16 v[160:163], a[244:247], a[224:227], v[160:163]
  v_exp_f32 v114, v114
  v_smfmac_f32_16x16x64_bf16 v[96:99], a[240:243], v[60:67], v10
  v_exp_f32 v115, v115
  v_mfma_f32_16x16x32_bf16 v[92:95], v[116:119], v[64:67], 0
  v_exp_f32 v120, v120
  v_mfma_f32_16x16x32_bf16 v[92:95], v[144:147], v[60:63], v[92:95]
  v_exp_f32 v121, v121
  v_mfma_f32_16x16x32_bf16 v[148:151], v[132:135], v[60:63], 0
  v_exp_f32 v122, v122
  v_mfma_f32_16x16x32_bf16 v[148:151], v[124:127], v[64:67], v[148:151]
  v_exp_f32 v123, v123
  v_mfma_f32_16x16x32_bf16 v[152:155], v[128:131], v[64:67], 0
  v_cvt_pk_bf16_f32 v70, v72, v73
  v_cvt_pk_bf16_f32 v71, v74, v75
  v_mfma_f32_16x16x32_bf16 v[152:155], v[108:111], v[60:63], v[152:155]
  v_cvt_pk_bf16_f32 v72, v112, v113
  v_cvt_pk_bf16_f32 v73, v114, v115
  v_smfmac_f32_16x16x64_bf16 v[136:139], a[240:243], v[76:83], v10
  v_cvt_pk_bf16_f32 v74, v120, v121
  v_cvt_pk_bf16_f32 v75, v122, v123
  v_mfma_f32_16x16x32_bf16 v[112:115], v[116:119], v[80:83], 0
  v_exp_f32 v52, v52
  v_mfma_f32_16x16x32_bf16 v[112:115], v[144:147], v[76:79], v[112:115]
  v_exp_f32 v53, v53
  v_mfma_f32_16x16x32_bf16 v[120:123], v[132:135], v[76:79], 0
  v_exp_f32 v54, v54
  v_mfma_f32_16x16x32_bf16 v[120:123], v[124:127], v[80:83], v[120:123]
  v_exp_f32 v55, v55
  v_mfma_f32_16x16x32_bf16 v[156:159], v[128:131], v[80:83], 0
  v_exp_f32 v56, v56
  v_mfma_f32_16x16x32_bf16 v[156:159], v[108:111], v[76:79], v[156:159]
  v_exp_f32 v57, v57
  v_mfma_f32_16x16x32_bf16 v[80:83], a[244:247], a[228:231], 0
  v_exp_f32 v58, v58
  v_mfma_f32_16x16x32_bf16 v[80:83], v[104:107], v[252:255], v[80:83]
  v_exp_f32 v59, v59
  v_mfma_f32_16x16x32_bf16 v[80:83], v[100:103], v[236:239], v[80:83]
  ds_read_b128 v[60:63], v4 offset:0
  ds_read_b128 v[64:67], v4 offset:4096
  v_mfma_f32_16x16x32_bf16 v[80:83], a[248:251], v[220:223], v[80:83]
  ds_read_b128 v[76:79], v4 offset:8192
  ds_read_b128 v[168:171], v4 offset:12288
  v_mfma_f32_16x16x32_bf16 v[80:83], a[252:255], v[204:207], v[80:83]
  ds_read_b128 v[176:179], v4 offset:16384
  ds_read_b128 v[180:183], v4 offset:20480
  v_mfma_f32_16x16x32_bf16 v[80:83], v[84:87], v[188:191], v[80:83]
  v_exp_f32 v140, v140
  v_mfma_f32_16x16x32_bf16 v[172:175], v[84:87], v[192:195], 0
  v_exp_f32 v141, v141
  v_mfma_f32_16x16x32_bf16 v[172:175], a[252:255], v[208:211], v[172:175]
  v_exp_f32 v142, v142
  v_mfma_f32_16x16x32_bf16 v[172:175], a[248:251], v[224:227], v[172:175]
  v_cvt_pk_bf16_f32 v160, v160, v80
  v_cvt_pk_bf16_f32 v161, v161, v81
  v_mfma_f32_16x16x32_bf16 v[172:175], v[100:103], v[240:243], v[172:175]
  v_cvt_pk_bf16_f32 v162, v162, v82
  v_cvt_pk_bf16_f32 v163, v163, v83
  v_mfma_f32_16x16x32_bf16 v[172:175], v[104:107], a[216:219], v[172:175]
  buffer_store_dword v160, v7, s[24:27], s33 offen offset:0 nt
  v_mfma_f32_16x16x32_bf16 v[172:175], a[244:247], a[232:235], v[172:175]
  v_exp_f32 v143, v143
  v_mfma_f32_16x16x32_bf16 v[80:83], a[244:247], a[236:239], 0
  buffer_store_dword v161, v7, s[24:27], s33 offen offset:384 nt
  v_mfma_f32_16x16x32_bf16 v[80:83], v[104:107], a[220:223], v[80:83]
  v_exp_f32 v88, v88
  v_mfma_f32_16x16x32_bf16 v[80:83], v[100:103], v[244:247], v[80:83]
  buffer_store_dword v162, v7, s[24:27], s33 offen offset:768 nt
  v_mfma_f32_16x16x32_bf16 v[80:83], a[248:251], v[228:231], v[80:83]
  v_exp_f32 v89, v89
  v_mfma_f32_16x16x32_bf16 v[80:83], a[252:255], v[212:215], v[80:83]
  buffer_store_dword v163, v7, s[24:27], s33 offen offset:1152 nt
  v_mfma_f32_16x16x32_bf16 v[80:83], v[84:87], v[196:199], v[80:83]
  s_waitcnt lgkmcnt(0)
  v_exp_f32 v90, v90
  v_mfma_f32_16x16x32_bf16 v[164:167], v[60:63], v[184:187], 0
  v_exp_f32 v91, v91
  v_mfma_f32_16x16x32_bf16 v[164:167], v[64:67], v[200:203], v[164:167]
  v_cvt_pk_bf16_f32 v52, v52, v53
  v_cvt_pk_bf16_f32 v53, v54, v55
  v_mfma_f32_16x16x32_bf16 v[164:167], v[76:79], v[216:219], v[164:167]
  v_cvt_pk_bf16_f32 v172, v172, v80
  v_cvt_pk_bf16_f32 v173, v173, v81
  v_mfma_f32_16x16x32_bf16 v[164:167], v[168:171], v[232:235], v[164:167]
  v_cvt_pk_bf16_f32 v174, v174, v82
  v_cvt_pk_bf16_f32 v175, v175, v83
  v_mfma_f32_16x16x32_bf16 v[164:167], v[176:179], v[248:251], v[164:167]
  buffer_store_dword v172, v8, s[24:27], s33 offen offset:0 nt
  v_mfma_f32_16x16x32_bf16 v[164:167], v[180:183], a[224:227], v[164:167]
  ds_read_b128 a[244:247], v3 offset:512
  v_mov_b64 v[80:81], 0
  v_mfma_f32_16x16x32_bf16 v[84:87], v[180:183], a[228:231], 0
  buffer_store_dword v173, v8, s[24:27], s33 offen offset:384 nt
  v_mfma_f32_16x16x32_bf16 v[84:87], v[176:179], v[252:255], v[84:87]
  ds_read_b128 a[248:251], v3 offset:4608
  ds_read_b128 a[252:255], v3 offset:8704
  v_mfma_f32_16x16x32_bf16 v[84:87], v[168:171], v[236:239], v[84:87]
  buffer_store_dword v174, v8, s[24:27], s33 offen offset:768 nt
  v_mfma_f32_16x16x32_bf16 v[84:87], v[76:79], v[220:223], v[84:87]
  ds_read_b128 v[100:103], v3 offset:12800
  ds_read_b128 v[104:107], v3 offset:16896
  v_mfma_f32_16x16x32_bf16 v[84:87], v[64:67], v[204:207], v[84:87]
  buffer_store_dword v175, v8, s[24:27], s33 offen offset:1152 nt
  v_mfma_f32_16x16x32_bf16 v[84:87], v[60:63], v[188:191], v[84:87]
  s_add_u32 s33, s33, s43
  ds_read_b128 v[160:163], v3 offset:20992
  v_cvt_pk_bf16_f32 v54, v56, v57
  v_smfmac_f32_16x16x64_bf16 v[80:83], a[240:243], v[68:75], v10
  v_cvt_pk_bf16_f32 v55, v58, v59
  v_cvt_pk_bf16_f32 v56, v140, v141
  v_mfma_f32_16x16x32_bf16 v[60:63], v[116:119], v[72:75], 0
  v_cvt_pk_bf16_f32 v57, v142, v143
  v_cvt_pk_bf16_f32 v58, v88, v89
  v_mfma_f32_16x16x32_bf16 v[60:63], v[144:147], v[68:71], v[60:63]
  v_cvt_pk_bf16_f32 v164, v164, v84
  v_cvt_pk_bf16_f32 v165, v165, v85
  v_mfma_f32_16x16x32_bf16 v[64:67], v[132:135], v[68:71], 0
  v_cvt_pk_bf16_f32 v166, v166, v86
  v_cvt_pk_bf16_f32 v167, v167, v87
  v_mfma_f32_16x16x32_bf16 v[64:67], v[124:127], v[72:75], v[64:67]
  buffer_store_dword v164, v7, s[24:27], s34 offen offset:0 nt
  v_mfma_f32_16x16x32_bf16 v[76:79], v[128:131], v[72:75], 0
  s_waitcnt lgkmcnt(0)
  v_cvt_pk_bf16_f32 v59, v90, v91
  v_add_f32 v96, v96, v97
  v_mfma_f32_16x16x32_bf16 v[76:79], v[108:111], v[68:71], v[76:79]
  buffer_store_dword v165, v7, s[24:27], s34 offen offset:384 nt
  v_mfma_f32_16x16x32_bf16 v[140:143], a[244:247], v[184:187], 0
  v_rcp_f32 v98, v96
  v_mfma_f32_16x16x32_bf16 v[140:143], a[248:251], v[200:203], v[140:143]
  buffer_store_dword v166, v7, s[24:27], s34 offen offset:768 nt
  v_mfma_f32_16x16x32_bf16 v[140:143], a[252:255], v[216:219], v[140:143]
  v_mov_b64 v[68:69], 0
  v_add_f32 v136, v136, v137
  v_mfma_f32_16x16x32_bf16 v[140:143], v[100:103], v[232:235], v[140:143]
L_hop_1_1:
  s_cbranch_execz L_walk
  buffer_store_dword v167, v7, s[24:27], s34 offen offset:1152 nt
  v_mul_f32 v92, v98, v92
  v_mfma_f32_16x16x32_bf16 v[140:143], v[104:107], v[248:251], v[140:143]
  s_add_u32 s34, s34, s43
  v_rcp_f32 v138, v136
  v_mul_f32 v93, v98, v93
  v_mfma_f32_16x16x32_bf16 v[140:143], v[160:163], a[224:227], v[140:143]
  v_mul_f32 v94, v98, v94
  v_mul_f32 v95, v98, v95
  v_cvt_pk_bf16_f32 v92, v92, v93
  v_mfma_f32_16x16x32_bf16 v[88:91], v[160:163], a[228:231], 0
  v_cvt_pk_bf16_f32 v93, v94, v95
  v_mul_f32 v148, v98, v148
  v_mul_f32 v149, v98, v149
  v_mfma_f32_16x16x32_bf16 v[88:91], v[104:107], v[252:255], v[88:91]
  v_mul_f32 v150, v98, v150
  v_mul_f32 v151, v98, v151
  v_cvt_pk_bf16_f32 v148, v148, v149
  v_mfma_f32_16x16x32_bf16 v[88:91], v[100:103], v[236:239], v[88:91]
  v_cvt_pk_bf16_f32 v149, v150, v151
  v_mul_f32 v152, v98, v152
  v_mul_f32 v153, v98, v153
  v_mfma_f32_16x16x32_bf16 v[88:91], a[252:255], v[220:223], v[88:91]
  v_mul_f32 v154, v98, v154
  v_mul_f32 v155, v98, v155
  v_cvt_pk_bf16_f32 v152, v152, v153
  v_mfma_f32_16x16x32_bf16 v[88:91], a[248:251], v[204:207], v[88:91]
  v_cvt_pk_bf16_f32 v153, v154, v155
  v_mul_f32 v112, v138, v112
  v_mul_f32 v113, v138, v113
  v_mfma_f32_16x16x32_bf16 v[88:91], a[244:247], v[188:191], v[88:91]
  v_mul_f32 v114, v138, v114
  v_mul_f32 v115, v138, v115
  v_cvt_pk_bf16_f32 v112, v112, v113
  v_smfmac_f32_16x16x64_bf16 v[68:71], a[240:243], v[52:59], v10
  v_cvt_pk_bf16_f32 v113, v114, v115
  v_mul_f32 v120, v138, v120
  v_mul_f32 v121, v138, v121
  v_mfma_f32_16x16x32_bf16 v[72:75], v[116:119], v[56:59], 0
  v_mul_f32 v122, v138, v122
  v_mul_f32 v123, v138, v123
  v_cvt_pk_bf16_f32 v120, v120, v121
  v_mfma_f32_16x16x32_bf16 v[72:75], v[144:147], v[52:55], v[72:75]
  v_cvt_pk_bf16_f32 v140, v140, v88
  v_cvt_pk_bf16_f32 v141, v141, v89
  v_cvt_pk_bf16_f32 v121, v122, v123
  v_mfma_f32_16x16x32_bf16 v[84:87], v[132:135], v[52:55], 0
  ds_read_b128 v[114:117], v4 offset:512
  v_cvt_pk_bf16_f32 v142, v142, v90
  v_cvt_pk_bf16_f32 v143, v143, v91
  v_mfma_f32_16x16x32_bf16 v[84:87], v[124:127], v[56:59], v[84:87]
  buffer_store_dword v140, v7, s[24:27], s35 offen offset:0 nt
  v_mul_f32 v156, v138, v156
  v_mfma_f32_16x16x32_bf16 v[88:91], v[128:131], v[56:59], 0
  ds_read_b128 v[122:125], v4 offset:4608
  ds_read_b128 v[132:135], v4 offset:8704
  v_mul_f32 v157, v138, v157
  v_mfma_f32_16x16x32_bf16 v[88:91], v[108:111], v[52:55], v[88:91]
  buffer_store_dword v141, v7, s[24:27], s35 offen offset:384 nt
  v_mul_f32 v158, v138, v158
  v_mfma_f32_16x16x32_bf16 v[126:129], a[244:247], v[192:195], 0
  ds_read_b128 v[108:111], v4 offset:12800
  ds_read_b128 v[52:55], v4 offset:16896
  v_mul_f32 v159, v138, v159
  v_mfma_f32_16x16x32_bf16 v[126:129], a[248:251], v[208:211], v[126:129]
  buffer_store_dword v142, v7, s[24:27], s35 offen offset:768 nt
  v_cvt_pk_bf16_f32 v156, v156, v157
  v_mfma_f32_16x16x32_bf16 v[126:129], a[252:255], v[224:227], v[126:129]
  ds_read_b128 v[144:147], v4 offset:20992
  v_cvt_pk_bf16_f32 v157, v158, v159
  v_max3_f32 v9, v96, v98, v9
  v_mfma_f32_16x16x32_bf16 v[126:129], v[100:103], v[240:243], v[126:129]
  buffer_store_dword v143, v7, s[24:27], s35 offen offset:1152 nt
  v_max3_f32 v9, v136, v138, v9
  v_mfma_f32_16x16x32_bf16 v[126:129], v[104:107], a[216:219], v[126:129]
  ds_write2st64_b32 v5, v92, v93 offset0:0 offset1:4
  v_mfma_f32_16x16x32_bf16 v[126:129], v[160:163], a[232:235], v[126:129]
  ds_write2st64_b32 v5, v148, v149 offset0:8 offset1:12
  v_mfma_f32_16x16x32_bf16 v[94:97], v[160:163], a[236:239], 0
  ds_write2st64_b32 v5, v152, v153 offset0:16 offset1:20
  v_mfma_f32_16x16x32_bf16 v[94:97], v[104:107], a[220:223], v[94:97]
  ds_write2st64_b32 v5, v112, v113 offset0:1 offset1:5
  v_mfma_f32_16x16x32_bf16 v[94:97], v[100:103], v[244:247], v[94:97]
  ds_write2st64_b32 v5, v120, v121 offset0:9 offset1:13
  v_mfma_f32_16x16x32_bf16 v[94:97], a[252:255], v[228:231], v[94:97]
  ds_write2st64_b32 v5, v156, v157 offset0:17 offset1:21
  v_mfma_f32_16x16x32_bf16 v[94:97], a[248:251], v[212:215], v[94:97]
  v_xor_b32 v3, 40960, v3
  v_xor_b32 v4, 40960, v4
  v_add_f32 v80, v80, v81
  v_mfma_f32_16x16x32_bf16 v[94:97], a[244:247], v[196:199], v[94:97]
  s_waitcnt lgkmcnt(6)
  v_rcp_f32 v82, v80
  v_add_f32 v68, v68, v69
  v_mfma_f32_16x16x32_bf16 v[56:59], v[114:117], v[184:187], 0
  v_rcp_f32 v70, v68
  v_max3_f32 v9, v80, v82, v9
  v_mfma_f32_16x16x32_bf16 v[56:59], v[122:125], v[200:203], v[56:59]
  v_max3_f32 v9, v68, v70, v9
  v_cmp_nge_f32 vcc, 0x53800000, v9
  v_mul_f32 v60, v82, v60
  v_mfma_f32_16x16x32_bf16 v[56:59], v[132:135], v[216:219], v[56:59]
  v_cvt_pk_bf16_f32 v126, v126, v94
  v_cvt_pk_bf16_f32 v127, v127, v95
  v_mul_f32 v61, v82, v61
  v_mfma_f32_16x16x32_bf16 v[56:59], v[108:111], v[232:235], v[56:59]
  s_waitcnt lgkmcnt(0)
  s_barrier
  v_mfma_f32_16x16x32_bf16 v[56:59], v[52:55], v[248:251], v[56:59]
  s_or_b32 s6, vcc_lo, vcc_hi
  ds_read_b128 a[244:247], v3 offset:0
  v_cvt_pk_bf16_f32 v128, v128, v96
  v_cvt_pk_bf16_f32 v129, v129, v97
  v_mfma_f32_16x16x32_bf16 v[56:59], v[144:147], a[224:227], v[56:59]
  buffer_store_dword v126, v8, s[24:27], s35 offen offset:0 nt
  v_mul_f32 v62, v82, v62
  v_mfma_f32_16x16x32_bf16 v[104:107], v[144:147], a[228:231], 0
  ds_read_b128 a[248:251], v3 offset:4096
  ds_read_b128 a[252:255], v3 offset:8192
  v_mul_f32 v63, v82, v63
  v_mfma_f32_16x16x32_bf16 v[104:107], v[52:55], v[252:255], v[104:107]
  buffer_store_dword v127, v8, s[24:27], s35 offen offset:384 nt
  v_cvt_pk_bf16_f32 v60, v60, v61
  v_mfma_f32_16x16x32_bf16 v[104:107], v[108:111], v[236:239], v[104:107]
  ds_read_b128 v[52:55], v3 offset:12288
  ds_read_b128 v[92:95], v3 offset:16384
  v_cvt_pk_bf16_f32 v61, v62, v63
  v_mfma_f32_16x16x32_bf16 v[104:107], v[132:135], v[220:223], v[104:107]
  buffer_store_dword v128, v8, s[24:27], s35 offen offset:768 nt
  v_mul_f32 v64, v82, v64
  v_mfma_f32_16x16x32_bf16 v[104:107], v[122:125], v[204:207], v[104:107]
  s_waitcnt lgkmcnt(2)
  ds_read_b128 v[100:103], v3 offset:20480
  v_mul_f32 v65, v82, v65
  v_mul_f32 v66, v82, v66
  v_mfma_f32_16x16x32_bf16 v[104:107], v[114:117], v[188:191], v[104:107]
  buffer_store_dword v129, v8, s[24:27], s35 offen offset:1152 nt
  v_mul_f32 v67, v82, v67
  v_mfma_f32_16x16x32_bf16 v[96:99], a[244:247], v[184:187], 0
  s_add_u32 s35, s35, s43
  v_cvt_pk_bf16_f32 v64, v64, v65
  v_cvt_pk_bf16_f32 v65, v66, v67
  v_mul_f32 v76, v82, v76
  v_mfma_f32_16x16x32_bf16 v[96:99], a[248:251], v[200:203], v[96:99]
  v_mul_f32 v77, v82, v77
  v_mul_f32 v78, v82, v78
  v_mul_f32 v79, v82, v79
  v_mfma_f32_16x16x32_bf16 v[96:99], a[252:255], v[216:219], v[96:99]
  s_waitcnt lgkmcnt(1)
  v_cvt_pk_bf16_f32 v56, v56, v104
  v_cvt_pk_bf16_f32 v57, v57, v105
  v_cvt_pk_bf16_f32 v76, v76, v77
  v_mfma_f32_16x16x32_bf16 v[96:99], v[52:55], v[232:235], v[96:99]
L_hop_2_1:
  s_cbranch_execz L_walk
  s_waitcnt lgkmcnt(0)
  v_cvt_pk_bf16_f32 v58, v58, v106
  v_cvt_pk_bf16_f32 v59, v59, v107
  v_cvt_pk_bf16_f32 v77, v78, v79
  v_mfma_f32_16x16x32_bf16 v[96:99], v[92:95], v[248:251], v[96:99]
  buffer_store_dword v56, v7, s[24:27], s36 offen offset:0 nt
  v_mul_f32 v72, v70, v72
  v_mfma_f32_16x16x32_bf16 v[96:99], v[100:103], a[224:227], v[96:99]
  v_mul_f32 v73, v70, v73
  v_mul_f32 v74, v70, v74
  v_mul_f32 v75, v70, v75
  v_mfma_f32_16x16x32_bf16 v[120:123], v[100:103], a[228:231], 0
  buffer_store_dword v57, v7, s[24:27], s36 offen offset:384 nt
  v_cvt_pk_bf16_f32 v72, v72, v73
  v_mfma_f32_16x16x32_bf16 v[120:123], v[92:95], v[252:255], v[120:123]
  v_cvt_pk_bf16_f32 v73, v74, v75
  v_mul_f32 v84, v70, v84
  v_mul_f32 v85, v70, v85
  v_mfma_f32_16x16x32_bf16 v[120:123], v[52:55], v[236:239], v[120:123]
  buffer_store_dword v58, v7, s[24:27], s36 offen offset:768 nt
  v_mul_f32 v86, v70, v86
  v_mfma_f32_16x16x32_bf16 v[120:123], a[252:255], v[220:223], v[120:123]
  ds_read_b128 v[66:69], v4 offset:0
  ds_read_b128 v[78:81], v4 offset:4096
  v_mul_f32 v87, v70, v87
  v_mfma_f32_16x16x32_bf16 v[120:123], a[248:251], v[204:207], v[120:123]
  buffer_store_dword v59, v7, s[24:27], s36 offen offset:1152 nt
  v_cvt_pk_bf16_f32 v84, v84, v85
  v_mfma_f32_16x16x32_bf16 v[120:123], a[244:247], v[188:191], v[120:123]
  s_add_u32 s36, s36, s43
  ds_read_b128 v[104:107], v4 offset:8192
  ds_read_b128 v[108:111], v4 offset:12288
  v_cvt_pk_bf16_f32 v85, v86, v87
  v_mfma_f32_16x16x32_bf16 v[56:59], a[244:247], v[192:195], 0
  ds_read_b128 v[112:115], v4 offset:16384
  ds_read_b128 v[116:119], v4 offset:20480
  v_mul_f32 v88, v70, v88
  v_mfma_f32_16x16x32_bf16 v[56:59], a[248:251], v[208:211], v[56:59]
  v_mul_f32 v89, v70, v89
  v_mul_f32 v90, v70, v90
  v_mul_f32 v91, v70, v91
  v_mfma_f32_16x16x32_bf16 v[56:59], a[252:255], v[224:227], v[56:59]
  v_cvt_pk_bf16_f32 v96, v96, v120
  v_cvt_pk_bf16_f32 v97, v97, v121
  v_cvt_pk_bf16_f32 v88, v88, v89
  v_mfma_f32_16x16x32_bf16 v[56:59], v[52:55], v[240:243], v[56:59]
  v_cvt_pk_bf16_f32 v98, v98, v122
  v_cvt_pk_bf16_f32 v99, v99, v123
  v_cvt_pk_bf16_f32 v89, v90, v91
  v_mfma_f32_16x16x32_bf16 v[56:59], v[92:95], a[216:219], v[56:59]
  buffer_store_dword v96, v7, s[24:27], s33 offen offset:0 nt
  v_mov_b32 v11, s5
  v_mfma_f32_16x16x32_bf16 v[56:59], v[100:103], a[232:235], v[56:59]
  v_mov_b32 v62, s6
  v_mfma_f32_16x16x32_bf16 v[120:123], v[100:103], a[236:239], 0
  buffer_store_dword v97, v7, s[24:27], s33 offen offset:384 nt
  v_mfma_f32_16x16x32_bf16 v[120:123], v[92:95], a[220:223], v[120:123]
  ds_write2st64_b32 v5, v60, v61 offset0:2 offset1:6
  v_mfma_f32_16x16x32_bf16 v[120:123], v[52:55], v[244:247], v[120:123]
  buffer_store_dword v98, v7, s[24:27], s33 offen offset:768 nt
  v_mfma_f32_16x16x32_bf16 v[120:123], a[252:255], v[228:231], v[120:123]
  ds_write2st64_b32 v5, v64, v65 offset0:10 offset1:14
  v_mfma_f32_16x16x32_bf16 v[120:123], a[248:251], v[212:215], v[120:123]
  buffer_store_dword v99, v7, s[24:27], s33 offen offset:1152 nt
  v_mfma_f32_16x16x32_bf16 v[120:123], a[244:247], v[196:199], v[120:123]
  s_waitcnt lgkmcnt(2)
  ds_write2st64_b32 v5, v76, v77 offset0:18 offset1:22
  v_mfma_f32_16x16x32_bf16 v[52:55], v[66:69], v[184:187], 0
  ds_write2st64_b32 v5, v72, v73 offset0:3 offset1:7
  v_mfma_f32_16x16x32_bf16 v[52:55], v[78:81], v[200:203], v[52:55]
  ds_write2st64_b32 v5, v84, v85 offset0:11 offset1:15
  ds_write2st64_b32 v5, v88, v89 offset0:19 offset1:23
  ds_write_b32 v11, v62
  v_mfma_f32_16x16x32_bf16 v[52:55], v[104:107], v[216:219], v[52:55]
  v_cvt_pk_bf16_f32 v56, v56, v120
  v_cvt_pk_bf16_f32 v57, v57, v121
  v_mfma_f32_16x16x32_bf16 v[52:55], v[108:111], v[232:235], v[52:55]
  s_waitcnt lgkmcnt(0)
  s_barrier
  v_mfma_f32_16x16x32_bf16 v[52:55], v[112:115], v[248:251], v[52:55]
  v_cvt_pk_bf16_f32 v58, v58, v122
  v_cvt_pk_bf16_f32 v59, v59, v123
  v_mfma_f32_16x16x32_bf16 v[52:55], v[116:119], a[224:227], v[52:55]
  buffer_store_dword v56, v8, s[24:27], s33 offen offset:0 nt
  v_mfma_f32_16x16x32_bf16 v[86:89], v[116:119], a[228:231], 0
  ds_read_b128 a[244:247], v3 offset:512
  ds_read_b128 a[248:251], v3 offset:4608
  v_mfma_f32_16x16x32_bf16 v[86:89], v[112:115], v[252:255], v[86:89]
  buffer_store_dword v57, v8, s[24:27], s33 offen offset:384 nt
  v_mfma_f32_16x16x32_bf16 v[86:89], v[108:111], v[236:239], v[86:89]
  ds_read_b128 a[252:255], v3 offset:8704
  ds_read_b128 v[60:63], v3 offset:12800
  v_mfma_f32_16x16x32_bf16 v[86:89], v[104:107], v[220:223], v[86:89]
  buffer_store_dword v58, v8, s[24:27], s33 offen offset:768 nt
  v_mfma_f32_16x16x32_bf16 v[86:89], v[78:81], v[204:207], v[86:89]
  s_waitcnt lgkmcnt(2)
  ds_read_b128 v[74:77], v3 offset:16896
  ds_read_b128 v[82:85], v3 offset:20992
  v_mfma_f32_16x16x32_bf16 v[86:89], v[66:69], v[188:191], v[86:89]
  buffer_store_dword v59, v8, s[24:27], s33 offen offset:1152 nt
  v_mfma_f32_16x16x32_bf16 v[70:73], a[244:247], v[184:187], 0
  v_mov_b32 v11, 155648
  v_mfma_f32_16x16x32_bf16 v[70:73], a[248:251], v[200:203], v[70:73]
  s_waitcnt lgkmcnt(2)
  ds_read2_b32 v[98:99], v11 offset0:0 offset1:2
  ds_read2_b32 v[100:101], v11 offset0:4 offset1:6
  v_mfma_f32_16x16x32_bf16 v[70:73], a[252:255], v[216:219], v[70:73]
  v_cvt_pk_bf16_f32 v52, v52, v86
  v_cvt_pk_bf16_f32 v53, v53, v87
  v_mfma_f32_16x16x32_bf16 v[70:73], v[60:63], v[232:235], v[70:73]
  s_waitcnt lgkmcnt(2)
  v_cvt_pk_bf16_f32 v54, v54, v88
  v_cvt_pk_bf16_f32 v55, v55, v89
  v_mfma_f32_16x16x32_bf16 v[70:73], v[74:77], v[248:251], v[70:73]
  buffer_store_dword v52, v7, s[24:27], s34 offen offset:0 nt
  v_mfma_f32_16x16x32_bf16 v[70:73], v[82:85], a[224:227], v[70:73]
  v_mfma_f32_16x16x32_bf16 v[102:105], v[82:85], a[228:231], 0
  buffer_store_dword v53, v7, s[24:27], s34 offen offset:384 nt
  v_mfma_f32_16x16x32_bf16 v[102:105], v[74:77], v[252:255], v[102:105]
  s_waitcnt lgkmcnt(0)
  v_or3_b32 v98, v98, v99, v100
  v_or_b32 v98, v98, v101
  v_mfma_f32_16x16x32_bf16 v[102:105], v[60:63], v[236:239], v[102:105]
  buffer_store_dword v54, v7, s[24:27], s34 offen offset:768 nt
  v_mfma_f32_16x16x32_bf16 v[102:105], a[252:255], v[220:223], v[102:105]
  ds_read_b128 v[56:59], v4 offset:512
  ds_read_b128 v[64:67], v4 offset:4608
  v_mfma_f32_16x16x32_bf16 v[102:105], a[248:251], v[204:207], v[102:105]
  buffer_store_dword v55, v7, s[24:27], s34 offen offset:1152 nt
  v_mfma_f32_16x16x32_bf16 v[102:105], a[244:247], v[188:191], v[102:105]
  ds_read_b128 v[78:81], v4 offset:8704
  ds_read_b128 v[86:89], v4 offset:12800
  v_mfma_f32_16x16x32_bf16 v[52:55], a[244:247], v[192:195], 0
  ds_read_b128 v[90:93], v4 offset:16896
  ds_read_b128 v[94:97], v4 offset:20992
  v_mfma_f32_16x16x32_bf16 v[52:55], a[248:251], v[208:211], v[52:55]
  v_readfirstlane_b32 s49, v98
  v_mfma_f32_16x16x32_bf16 v[52:55], a[252:255], v[224:227], v[52:55]
  v_cvt_pk_bf16_f32 v70, v70, v102
  v_cvt_pk_bf16_f32 v71, v71, v103
  v_mfma_f32_16x16x32_bf16 v[52:55], v[60:63], v[240:243], v[52:55]
L_hop_3_1:
  s_cbranch_execz L_walk
  v_cvt_pk_bf16_f32 v72, v72, v104
  v_cvt_pk_bf16_f32 v73, v73, v105
  v_mfma_f32_16x16x32_bf16 v[52:55], v[74:77], a[216:219], v[52:55]
  buffer_store_dword v70, v7, s[24:27], s35 offen offset:0 nt
  v_mfma_f32_16x16x32_bf16 v[52:55], v[82:85], a[232:235], v[52:55]
  v_mfma_f32_16x16x32_bf16 v[98:101], v[82:85], a[236:239], 0
  buffer_store_dword v71, v7, s[24:27], s35 offen offset:384 nt
  v_mfma_f32_16x16x32_bf16 v[98:101], v[74:77], a[220:223], v[98:101]
  v_mfma_f32_16x16x32_bf16 v[98:101], v[60:63], v[244:247], v[98:101]
  buffer_store_dword v72, v7, s[24:27], s35 offen offset:768 nt
  v_mfma_f32_16x16x32_bf16 v[98:101], a[252:255], v[228:231], v[98:101]
  v_mfma_f32_16x16x32_bf16 v[98:101], a[248:251], v[212:215], v[98:101]
  buffer_store_dword v73, v7, s[24:27], s35 offen offset:1152 nt
  v_mfma_f32_16x16x32_bf16 v[98:101], a[244:247], v[196:199], v[98:101]
  s_waitcnt lgkmcnt(0)
  v_mfma_f32_16x16x32_bf16 v[60:63], v[56:59], v[184:187], 0
  v_mfma_f32_16x16x32_bf16 v[60:63], v[64:67], v[200:203], v[60:63]
  v_mfma_f32_16x16x32_bf16 v[60:63], v[78:81], v[216:219], v[60:63]
  v_cvt_pk_bf16_f32 v52, v52, v98
  v_cvt_pk_bf16_f32 v53, v53, v99
  v_mfma_f32_16x16x32_bf16 v[60:63], v[86:89], v[232:235], v[60:63]
  v_cvt_pk_bf16_f32 v54, v54, v100
  v_cvt_pk_bf16_f32 v55, v55, v101
  v_mfma_f32_16x16x32_bf16 v[60:63], v[90:93], v[248:251], v[60:63]
  buffer_store_dword v52, v8, s[24:27], s35 offen offset:0 nt
  v_mfma_f32_16x16x32_bf16 v[60:63], v[94:97], a[224:227], v[60:63]
  v_mfma_f32_16x16x32_bf16 v[68:71], v[94:97], a[228:231], 0
  buffer_store_dword v53, v8, s[24:27], s35 offen offset:384 nt
  v_mfma_f32_16x16x32_bf16 v[68:71], v[90:93], v[252:255], v[68:71]
  v_mfma_f32_16x16x32_bf16 v[68:71], v[86:89], v[236:239], v[68:71]
  buffer_store_dword v54, v8, s[24:27], s35 offen offset:768 nt
  v_mfma_f32_16x16x32_bf16 v[68:71], v[78:81], v[220:223], v[68:71]
  v_mfma_f32_16x16x32_bf16 v[68:71], v[64:67], v[204:207], v[68:71]
  buffer_store_dword v55, v8, s[24:27], s35 offen offset:1152 nt
  v_mfma_f32_16x16x32_bf16 v[68:71], v[56:59], v[188:191], v[68:71]
  s_nop 7
  v_cvt_pk_bf16_f32 v60, v60, v68
  v_cvt_pk_bf16_f32 v61, v61, v69
  v_cvt_pk_bf16_f32 v62, v62, v70
  v_cvt_pk_bf16_f32 v63, v63, v71
  buffer_store_dword v60, v7, s[24:27], s36 offen offset:0 nt
  buffer_store_dword v61, v7, s[24:27], s36 offen offset:384 nt
  buffer_store_dword v62, v7, s[24:27], s36 offen offset:768 nt
  buffer_store_dword v63, v7, s[24:27], s36 offen offset:1152 nt
  s_cmp_lg_u32 s49, 0
  s_cbranch_scc1 L_safe
L_fin:
L_end:
  s_endpgm
L_safe:
  s_nop 15
  s_waitcnt vmcnt(0) lgkmcnt(0)
  s_mov_b32 s10, 100663296
  v_mbcnt_lo_u32_b32 v52, -1, 0
  v_mbcnt_hi_u32_b32 v52, -1, v52
  v_lshrrev_b32 v54, 2, v52
  v_and_b32 v54, 4, v54
  v_xor_b32 v53, v54, v52
  s_cmp_eq_u32 s47, 63
  s_cselect_b32 s5, 4, 0
  v_and_b32 v53, s5, v53
  v_cmp_eq_u32 vcc, 0, v53
  s_cmp_eq_u32 s48, 3
  s_cselect_b32 s5, 0xc31044fe, 0
  v_mov_b32 v11, s5
  v_mov_b32 v52, 0xc31044fe
  v_cndmask_b32 v11, 0, v11, vcc
  v_cndmask_b32 v52, v52, 0, vcc
  v_add_u32 v0, s46, v2
  v_xor_b32 v1, 64, v0
  s_add_u32 s56, s56, 480
  s_nop 7
L_sloop:
  s_barrier
  s_add_u32 s5, s56, 4
  s_and_b32 s5, s5, 511
  s_mul_i32 s31, s5, s57
  s_add_u32 s5, s56, 8
  s_and_b32 s5, s5, 511
  s_mul_i32 s32, s5, s57
  s_xor_b32 s5, s4, 0
  s_lshl_b32 s5, s5, 1
  s_add_u32 s5, s5, s56
  s_sub_u32 s5, s5, s3
  s_add_u32 s5, s5, 4
  s_and_b32 s5, s5, 511
  s_mul_i32 s33, s5, s57
  s_xor_b32 s5, s4, 1
  s_lshl_b32 s5, s5, 1
  s_add_u32 s5, s5, s56
  s_sub_u32 s5, s5, s3
  s_add_u32 s5, s5, 4
  s_and_b32 s5, s5, 511
  s_mul_i32 s34, s5, s57
  s_xor_b32 s5, s4, 2
  s_lshl_b32 s5, s5, 1
  s_add_u32 s5, s5, s56
  s_sub_u32 s5, s5, s3
  s_add_u32 s5, s5, 4
  s_and_b32 s5, s5, 511
  s_mul_i32 s35, s5, s57
  s_xor_b32 s5, s4, 3
  s_lshl_b32 s5, s5, 1
  s_add_u32 s5, s5, s56
  s_sub_u32 s5, s5, s3
  s_add_u32 s5, s5, 4
  s_and_b32 s5, s5, 511
  s_mul_i32 s36, s5, s57
  s_add_u32 m0, s46, 0
  s_nop 0
  buffer_load_dwordx4 v6, s[8:11], s31 offen offset:0 nt lds
  s_add_u32 m0, s46, 8064
  s_nop 0
  buffer_load_dwordx4 v6, s[8:11], s31 offen offset:128 nt lds
  s_add_u32 m0, s46, 16128
  s_nop 0
  buffer_load_dwordx4 v6, s[8:11], s31 offen offset:256 nt lds
  s_add_u32 m0, s46, 4096
  s_nop 0
  buffer_load_dwordx4 v6, s[8:11], s32 offen offset:0 nt lds
  s_add_u32 m0, s46, 12160
  s_nop 0
  buffer_load_dwordx4 v6, s[8:11], s32 offen offset:128 nt lds
  s_add_u32 m0, s46, 20224
  s_nop 0
  buffer_load_dwordx4 v6, s[8:11], s32 offen offset:256 nt lds
  s_waitcnt vmcnt(0)
  s_barrier
  ds_read_b128 a[244:247], v0 offset:0
  ds_read_b128 a[248:251], v1 offset:0
  ds_read_b128 a[252:255], v0 offset:8192
  ds_read_b128 v[60:63], v1 offset:8192
  ds_read_b128 v[68:71], v0 offset:16384
  ds_read_b128 v[72:75], v1 offset:16384
  s_waitcnt lgkmcnt(5)
  v_mfma_f32_16x16x32_bf16 v[64:67], a[0:3], a[244:247], 0
  s_waitcnt lgkmcnt(4)
  v_mfma_f32_16x16x32_bf16 v[64:67], a[12:15], a[248:251], v[64:67]
  s_waitcnt lgkmcnt(3)
  v_mfma_f32_16x16x32_bf16 v[64:67], a[24:27], a[252:255], v[64:67]
  s_waitcnt lgkmcnt(2)
  v_mfma_f32_16x16x32_bf16 v[64:67], a[36:39], v[60:63], v[64:67]
  s_waitcnt lgkmcnt(1)
  v_mfma_f32_16x16x32_bf16 v[64:67], a[48:51], v[68:71], v[64:67]
  s_waitcnt lgkmcnt(0)
  v_mfma_f32_16x16x32_bf16 v[64:67], a[60:63], v[72:75], v[64:67]
  v_mfma_f32_16x16x32_bf16 v[52:55], a[4:7], a[244:247], 0
  v_mfma_f32_16x16x32_bf16 v[52:55], a[16:19], a[248:251], v[52:55]
  v_mfma_f32_16x16x32_bf16 v[52:55], a[28:31], a[252:255], v[52:55]
  v_mfma_f32_16x16x32_bf16 v[52:55], a[40:43], v[60:63], v[52:55]
  v_mfma_f32_16x16x32_bf16 v[52:55], a[52:55], v[68:71], v[52:55]
  v_mfma_f32_16x16x32_bf16 v[52:55], a[64:67], v[72:75], v[52:55]
  v_mul_f32 v64, s42, v64
  v_mul_f32 v65, s42, v65
  v_mul_f32 v66, s42, v66
  v_mul_f32 v67, s42, v67
  v_cvt_pk_bf16_f32 v12, v64, v65
  v_cvt_pk_bf16_f32 v13, v66, v67
  v_mfma_f32_16x16x32_bf16 v[56:59], a[8:11], a[244:247], 0
  v_mfma_f32_16x16x32_bf16 v[56:59], a[20:23], a[248:251], v[56:59]
  v_mfma_f32_16x16x32_bf16 v[56:59], a[32:35], a[252:255], v[56:59]
  v_mfma_f32_16x16x32_bf16 v[56:59], a[44:47], v[60:63], v[56:59]
  v_mfma_f32_16x16x32_bf16 v[56:59], a[56:59], v[68:71], v[56:59]
  v_mfma_f32_16x16x32_bf16 v[56:59], a[68:71], v[72:75], v[56:59]
  v_mul_f32 v52, s42, v52
  v_mul_f32 v53, s42, v53
  v_mul_f32 v54, s42, v54
  v_mul_f32 v55, s42, v55
  v_cvt_pk_bf16_f32 v112, v52, v53
  v_cvt_pk_bf16_f32 v113, v54, v55
  v_mfma_f32_16x16x32_bf16 v[64:67], a[72:75], a[244:247], 0
  v_mfma_f32_16x16x32_bf16 v[64:67], a[84:87], a[248:251], v[64:67]
  v_mfma_f32_16x16x32_bf16 v[64:67], a[96:99], a[252:255], v[64:67]
  v_mfma_f32_16x16x32_bf16 v[64:67], a[108:111], v[60:63], v[64:67]
  v_mfma_f32_16x16x32_bf16 v[64:67], a[120:123], v[68:71], v[64:67]
  v_mfma_f32_16x16x32_bf16 v[64:67], a[132:135], v[72:75], v[64:67]
  v_mul_f32 v56, s42, v56
  v_mul_f32 v57, s42, v57
  v_mul_f32 v58, s42, v58
  v_mul_f32 v59, s42, v59
  v_cvt_pk_bf16_f32 v114, v56, v57
  v_cvt_pk_bf16_f32 v115, v58, v59
  v_mfma_f32_16x16x32_bf16 v[76:79], a[76:79], a[244:247], 0
  v_mfma_f32_16x16x32_bf16 v[76:79], a[88:91], a[248:251], v[76:79]
  v_mfma_f32_16x16x32_bf16 v[76:79], a[100:103], a[252:255], v[76:79]
  v_mfma_f32_16x16x32_bf16 v[76:79], a[112:115], v[60:63], v[76:79]
  v_mfma_f32_16x16x32_bf16 v[76:79], a[124:127], v[68:71], v[76:79]
  v_mfma_f32_16x16x32_bf16 v[76:79], a[136:139], v[72:75], v[76:79]
  v_cvt_pk_bf16_f32 v52, v64, v65
  v_cvt_pk_bf16_f32 v53, v66, v67
  v_mfma_f32_16x16x32_bf16 v[80:83], a[80:83], a[244:247], 0
  v_mfma_f32_16x16x32_bf16 v[80:83], a[92:95], a[248:251], v[80:83]
  v_mfma_f32_16x16x32_bf16 v[80:83], a[104:107], a[252:255], v[80:83]
  v_mfma_f32_16x16x32_bf16 v[80:83], a[116:119], v[60:63], v[80:83]
  v_mfma_f32_16x16x32_bf16 v[80:83], a[128:131], v[68:71], v[80:83]
  v_mfma_f32_16x16x32_bf16 v[80:83], a[140:143], v[72:75], v[80:83]
  v_cvt_pk_bf16_f32 v54, v76, v77
  v_cvt_pk_bf16_f32 v55, v78, v79
  v_mfma_f32_16x16x32_bf16 v[64:67], a[244:247], a[144:147], 0
  v_mfma_f32_16x16x32_bf16 v[64:67], a[248:251], a[156:159], v[64:67]
  v_mfma_f32_16x16x32_bf16 v[64:67], a[252:255], a[168:171], v[64:67]
  v_mfma_f32_16x16x32_bf16 v[64:67], v[60:63], a[180:183], v[64:67]
  v_mfma_f32_16x16x32_bf16 v[64:67], v[68:71], a[192:195], v[64:67]
  v_mfma_f32_16x16x32_bf16 v[64:67], v[72:75], a[204:207], v[64:67]
  v_cvt_pk_bf16_f32 v56, v80, v81
  v_cvt_pk_bf16_f32 v57, v82, v83
  v_mfma_f32_16x16x32_bf16 v[76:79], a[244:247], a[148:151], 0
  v_mfma_f32_16x16x32_bf16 v[76:79], a[248:251], a[160:163], v[76:79]
  v_mfma_f32_16x16x32_bf16 v[76:79], a[252:255], a[172:175], v[76:79]
  v_mfma_f32_16x16x32_bf16 v[76:79], v[60:63], a[184:187], v[76:79]
  v_mfma_f32_16x16x32_bf16 v[76:79], v[68:71], a[196:199], v[76:79]
  v_mfma_f32_16x16x32_bf16 v[76:79], v[72:75], a[208:211], v[76:79]
  v_cvt_pk_bf16_f32 v58, v64, v65
  v_cvt_pk_bf16_f32 v59, v66, v67
  v_mfma_f32_16x16x32_bf16 v[92:95], a[244:247], a[152:155], 0
  v_mfma_f32_16x16x32_bf16 v[92:95], a[248:251], a[164:167], v[92:95]
  v_mfma_f32_16x16x32_bf16 v[92:95], a[252:255], a[176:179], v[92:95]
  v_mfma_f32_16x16x32_bf16 v[92:95], v[60:63], a[188:191], v[92:95]
  v_mfma_f32_16x16x32_bf16 v[92:95], v[68:71], a[200:203], v[92:95]
  v_mfma_f32_16x16x32_bf16 v[92:95], v[72:75], a[212:215], v[92:95]
  v_cvt_pk_bf16_f32 v66, v76, v77
  v_cvt_pk_bf16_f32 v67, v78, v79
  s_nop 5
  v_cvt_pk_bf16_f32 v62, v92, v93
  v_cvt_pk_bf16_f32 v63, v94, v95
  ds_read_b128 a[244:247], v0 offset:2048
  ds_read_b128 a[248:251], v1 offset:2048
  ds_read_b128 a[252:255], v0 offset:10240
  ds_read_b128 v[76:79], v1 offset:10240
  ds_read_b128 v[80:83], v0 offset:18432
  ds_read_b128 v[84:87], v1 offset:18432
  s_waitcnt lgkmcnt(5)
  v_mfma_f32_16x16x32_bf16 v[88:91], a[0:3], a[244:247], 0
  s_waitcnt lgkmcnt(4)
  v_mfma_f32_16x16x32_bf16 v[88:91], a[12:15], a[248:251], v[88:91]
  s_waitcnt lgkmcnt(3)
  v_mfma_f32_16x16x32_bf16 v[88:91], a[24:27], a[252:255], v[88:91]
  s_waitcnt lgkmcnt(2)
  v_mfma_f32_16x16x32_bf16 v[88:91], a[36:39], v[76:79], v[88:91]
  s_waitcnt lgkmcnt(1)
  v_mfma_f32_16x16x32_bf16 v[88:91], a[48:51], v[80:83], v[88:91]
  s_waitcnt lgkmcnt(0)
  v_mfma_f32_16x16x32_bf16 v[88:91], a[60:63], v[84:87], v[88:91]
  v_mfma_f32_16x16x32_bf16 v[68:71], a[4:7], a[244:247], 0
  v_mfma_f32_16x16x32_bf16 v[68:71], a[16:19], a[248:251], v[68:71]
  v_mfma_f32_16x16x32_bf16 v[68:71], a[28:31], a[252:255], v[68:71]
  v_mfma_f32_16x16x32_bf16 v[68:71], a[40:43], v[76:79], v[68:71]
  v_mfma_f32_16x16x32_bf16 v[68:71], a[52:55], v[80:83], v[68:71]
  v_mfma_f32_16x16x32_bf16 v[68:71], a[64:67], v[84:87], v[68:71]
  v_mul_f32 v88, s42, v88
  v_mul_f32 v89, s42, v89
  v_mul_f32 v90, s42, v90
  v_mul_f32 v91, s42, v91
  v_cvt_pk_bf16_f32 v108, v88, v89
  v_cvt_pk_bf16_f32 v109, v90, v91
  v_mfma_f32_16x16x32_bf16 v[72:75], a[8:11], a[244:247], 0
  v_mfma_f32_16x16x32_bf16 v[72:75], a[20:23], a[248:251], v[72:75]
  v_mfma_f32_16x16x32_bf16 v[72:75], a[32:35], a[252:255], v[72:75]
  v_mfma_f32_16x16x32_bf16 v[72:75], a[44:47], v[76:79], v[72:75]
  v_mfma_f32_16x16x32_bf16 v[72:75], a[56:59], v[80:83], v[72:75]
  v_mfma_f32_16x16x32_bf16 v[72:75], a[68:71], v[84:87], v[72:75]
  v_mul_f32 v68, s42, v68
  v_mul_f32 v69, s42, v69
  v_mul_f32 v70, s42, v70
  v_mul_f32 v71, s42, v71
  v_cvt_pk_bf16_f32 v110, v68, v69
  v_cvt_pk_bf16_f32 v111, v70, v71
  v_mfma_f32_16x16x32_bf16 v[88:91], a[72:75], a[244:247], 0
  v_mfma_f32_16x16x32_bf16 v[88:91], a[84:87], a[248:251], v[88:91]
  v_mfma_f32_16x16x32_bf16 v[88:91], a[96:99], a[252:255], v[88:91]
  v_mfma_f32_16x16x32_bf16 v[88:91], a[108:111], v[76:79], v[88:91]
  v_mfma_f32_16x16x32_bf16 v[88:91], a[120:123], v[80:83], v[88:91]
  v_mfma_f32_16x16x32_bf16 v[88:91], a[132:135], v[84:87], v[88:91]
  v_mul_f32 v72, s42, v72
  v_mul_f32 v73, s42, v73
  v_mul_f32 v74, s42, v74
  v_mul_f32 v75, s42, v75
  v_cvt_pk_bf16_f32 v16, v72, v73
  v_cvt_pk_bf16_f32 v17, v74, v75
  v_mfma_f32_16x16x32_bf16 v[92:95], a[76:79], a[244:247], 0
  v_mfma_f32_16x16x32_bf16 v[92:95], a[88:91], a[248:251], v[92:95]
  v_mfma_f32_16x16x32_bf16 v[92:95], a[100:103], a[252:255], v[92:95]
  v_mfma_f32_16x16x32_bf16 v[92:95], a[112:115], v[76:79], v[92:95]
  v_mfma_f32_16x16x32_bf16 v[92:95], a[124:127], v[80:83], v[92:95]
  v_mfma_f32_16x16x32_bf16 v[92:95], a[136:139], v[84:87], v[92:95]
  v_cvt_pk_bf16_f32 v70, v88, v89
  v_cvt_pk_bf16_f32 v71, v90, v91
  v_mfma_f32_16x16x32_bf16 v[96:99], a[80:83], a[244:247], 0
  v_mfma_f32_16x16x32_bf16 v[96:99], a[92:95], a[248:251], v[96:99]
  v_mfma_f32_16x16x32_bf16 v[96:99], a[104:107], a[252:255], v[96:99]
  v_mfma_f32_16x16x32_bf16 v[96:99], a[116:119], v[76:79], v[96:99]
  v_mfma_f32_16x16x32_bf16 v[96:99], a[128:131], v[80:83], v[96:99]
  v_mfma_f32_16x16x32_bf16 v[96:99], a[140:143], v[84:87], v[96:99]
  v_cvt_pk_bf16_f32 v72, v92, v93
  v_cvt_pk_bf16_f32 v73, v94, v95
  v_mfma_f32_16x16x32_bf16 v[88:91], a[244:247], a[144:147], 0
  v_mfma_f32_16x16x32_bf16 v[88:91], a[248:251], a[156:159], v[88:91]
  v_mfma_f32_16x16x32_bf16 v[88:91], a[252:255], a[168:171], v[88:91]
  v_mfma_f32_16x16x32_bf16 v[88:91], v[76:79], a[180:183], v[88:91]
  v_mfma_f32_16x16x32_bf16 v[88:91], v[80:83], a[192:195], v[88:91]
  v_mfma_f32_16x16x32_bf16 v[88:91], v[84:87], a[204:207], v[88:91]
  v_cvt_pk_bf16_f32 v74, v96, v97
  v_cvt_pk_bf16_f32 v75, v98, v99
  v_mfma_f32_16x16x32_bf16 v[92:95], a[244:247], a[148:151], 0
  v_mfma_f32_16x16x32_bf16 v[92:95], a[248:251], a[160:163], v[92:95]
  v_mfma_f32_16x16x32_bf16 v[92:95], a[252:255], a[172:175], v[92:95]
  v_mfma_f32_16x16x32_bf16 v[92:95], v[76:79], a[184:187], v[92:95]
  v_mfma_f32_16x16x32_bf16 v[92:95], v[80:83], a[196:199], v[92:95]
  v_mfma_f32_16x16x32_bf16 v[92:95], v[84:87], a[208:211], v[92:95]
  v_cvt_pk_bf16_f32 v60, v88, v89
  v_cvt_pk_bf16_f32 v61, v90, v91
  v_mfma_f32_16x16x32_bf16 v[100:103], a[244:247], a[152:155], 0
  v_mfma_f32_16x16x32_bf16 v[100:103], a[248:251], a[164:167], v[100:103]
  v_mfma_f32_16x16x32_bf16 v[100:103], a[252:255], a[176:179], v[100:103]
  v_mfma_f32_16x16x32_bf16 v[100:103], v[76:79], a[188:191], v[100:103]
  v_mfma_f32_16x16x32_bf16 v[100:103], v[80:83], a[200:203], v[100:103]
  v_mfma_f32_16x16x32_bf16 v[100:103], v[84:87], a[212:215], v[100:103]
  v_cvt_pk_bf16_f32 v68, v92, v93
  v_cvt_pk_bf16_f32 v69, v94, v95
  s_nop 5
  v_cvt_pk_bf16_f32 v64, v100, v101
  v_cvt_pk_bf16_f32 v65, v102, v103
  ds_read_b128 a[244:247], v0 offset:4096
  ds_read_b128 a[248:251], v1 offset:4096
  ds_read_b128 a[252:255], v0 offset:12288
  ds_read_b128 v[88:91], v1 offset:12288
  ds_read_b128 v[92:95], v0 offset:20480
  ds_read_b128 v[96:99], v1 offset:20480
  s_waitcnt lgkmcnt(5)
  v_mfma_f32_16x16x32_bf16 v[84:87], a[0:3], a[244:247], 0
  s_waitcnt lgkmcnt(4)
  v_mfma_f32_16x16x32_bf16 v[84:87], a[12:15], a[248:251], v[84:87]
  s_waitcnt lgkmcnt(3)
  v_mfma_f32_16x16x32_bf16 v[84:87], a[24:27], a[252:255], v[84:87]
  s_waitcnt lgkmcnt(2)
  v_mfma_f32_16x16x32_bf16 v[84:87], a[36:39], v[88:91], v[84:87]
  s_waitcnt lgkmcnt(1)
  v_mfma_f32_16x16x32_bf16 v[84:87], a[48:51], v[92:95], v[84:87]
  s_waitcnt lgkmcnt(0)
  v_mfma_f32_16x16x32_bf16 v[84:87], a[60:63], v[96:99], v[84:87]
  v_mfma_f32_16x16x32_bf16 v[76:79], a[4:7], a[244:247], 0
  v_mfma_f32_16x16x32_bf16 v[76:79], a[16:19], a[248:251], v[76:79]
  v_mfma_f32_16x16x32_bf16 v[76:79], a[28:31], a[252:255], v[76:79]
  v_mfma_f32_16x16x32_bf16 v[76:79], a[40:43], v[88:91], v[76:79]
  v_mfma_f32_16x16x32_bf16 v[76:79], a[52:55], v[92:95], v[76:79]
  v_mfma_f32_16x16x32_bf16 v[76:79], a[64:67], v[96:99], v[76:79]
  v_mul_f32 v84, s42, v84
  v_mul_f32 v85, s42, v85
  v_mul_f32 v86, s42, v86
  v_mul_f32 v87, s42, v87
  v_cvt_pk_bf16_f32 v18, v84, v85
  v_cvt_pk_bf16_f32 v19, v86, v87
  v_mfma_f32_16x16x32_bf16 v[80:83], a[8:11], a[244:247], 0
  v_mfma_f32_16x16x32_bf16 v[80:83], a[20:23], a[248:251], v[80:83]
  v_mfma_f32_16x16x32_bf16 v[80:83], a[32:35], a[252:255], v[80:83]
  v_mfma_f32_16x16x32_bf16 v[80:83], a[44:47], v[88:91], v[80:83]
  v_mfma_f32_16x16x32_bf16 v[80:83], a[56:59], v[92:95], v[80:83]
  v_mfma_f32_16x16x32_bf16 v[80:83], a[68:71], v[96:99], v[80:83]
  v_mul_f32 v76, s42, v76
  v_mul_f32 v77, s42, v77
  v_mul_f32 v78, s42, v78
  v_mul_f32 v79, s42, v79
  v_cvt_pk_bf16_f32 v104, v76, v77
  v_cvt_pk_bf16_f32 v105, v78, v79
  v_mfma_f32_16x16x32_bf16 v[84:87], a[72:75], a[244:247], 0
  v_mfma_f32_16x16x32_bf16 v[84:87], a[84:87], a[248:251], v[84:87]
  v_mfma_f32_16x16x32_bf16 v[84:87], a[96:99], a[252:255], v[84:87]
  v_mfma_f32_16x16x32_bf16 v[84:87], a[108:111], v[88:91], v[84:87]
  v_mfma_f32_16x16x32_bf16 v[84:87], a[120:123], v[92:95], v[84:87]
  v_mfma_f32_16x16x32_bf16 v[84:87], a[132:135], v[96:99], v[84:87]
  v_mul_f32 v80, s42, v80
  v_mul_f32 v81, s42, v81
  v_mul_f32 v82, s42, v82
  v_mul_f32 v83, s42, v83
  v_cvt_pk_bf16_f32 v106, v80, v81
  v_cvt_pk_bf16_f32 v107, v82, v83
  v_mfma_f32_16x16x32_bf16 v[100:103], a[76:79], a[244:247], 0
  v_mfma_f32_16x16x32_bf16 v[100:103], a[88:91], a[248:251], v[100:103]
  v_mfma_f32_16x16x32_bf16 v[100:103], a[100:103], a[252:255], v[100:103]
  v_mfma_f32_16x16x32_bf16 v[100:103], a[112:115], v[88:91], v[100:103]
  v_mfma_f32_16x16x32_bf16 v[100:103], a[124:127], v[92:95], v[100:103]
  v_mfma_f32_16x16x32_bf16 v[100:103], a[136:139], v[96:99], v[100:103]
  v_cvt_pk_bf16_f32 v76, v84, v85
  v_cvt_pk_bf16_f32 v77, v86, v87
  v_mfma_f32_16x16x32_bf16 v[116:119], a[80:83], a[244:247], 0
  v_mfma_f32_16x16x32_bf16 v[116:119], a[92:95], a[248:251], v[116:119]
  v_mfma_f32_16x16x32_bf16 v[116:119], a[104:107], a[252:255], v[116:119]
  v_mfma_f32_16x16x32_bf16 v[116:119], a[116:119], v[88:91], v[116:119]
  v_mfma_f32_16x16x32_bf16 v[116:119], a[128:131], v[92:95], v[116:119]
  v_mfma_f32_16x16x32_bf16 v[116:119], a[140:143], v[96:99], v[116:119]
  v_cvt_pk_bf16_f32 v78, v100, v101
  v_cvt_pk_bf16_f32 v79, v102, v103
  v_mfma_f32_16x16x32_bf16 v[84:87], a[244:247], a[144:147], 0
  v_mfma_f32_16x16x32_bf16 v[84:87], a[248:251], a[156:159], v[84:87]
  v_mfma_f32_16x16x32_bf16 v[84:87], a[252:255], a[168:171], v[84:87]
  v_mfma_f32_16x16x32_bf16 v[84:87], v[88:91], a[180:183], v[84:87]
  v_mfma_f32_16x16x32_bf16 v[84:87], v[92:95], a[192:195], v[84:87]
  v_mfma_f32_16x16x32_bf16 v[84:87], v[96:99], a[204:207], v[84:87]
  v_cvt_pk_bf16_f32 v80, v116, v117
  v_cvt_pk_bf16_f32 v81, v118, v119
  v_mfma_f32_16x16x32_bf16 v[100:103], a[244:247], a[148:151], 0
  v_mfma_f32_16x16x32_bf16 v[100:103], a[248:251], a[160:163], v[100:103]
  v_mfma_f32_16x16x32_bf16 v[100:103], a[252:255], a[172:175], v[100:103]
  v_mfma_f32_16x16x32_bf16 v[100:103], v[88:91], a[184:187], v[100:103]
  v_mfma_f32_16x16x32_bf16 v[100:103], v[92:95], a[196:199], v[100:103]
  v_mfma_f32_16x16x32_bf16 v[100:103], v[96:99], a[208:211], v[100:103]
  v_cvt_pk_bf16_f32 v82, v84, v85
  v_cvt_pk_bf16_f32 v83, v86, v87
  v_mfma_f32_16x16x32_bf16 v[132:135], a[244:247], a[152:155], 0
  v_mfma_f32_16x16x32_bf16 v[132:135], a[248:251], a[164:167], v[132:135]
  v_mfma_f32_16x16x32_bf16 v[132:135], a[252:255], a[176:179], v[132:135]
  v_mfma_f32_16x16x32_bf16 v[132:135], v[88:91], a[188:191], v[132:135]
  v_mfma_f32_16x16x32_bf16 v[132:135], v[92:95], a[200:203], v[132:135]
  v_mfma_f32_16x16x32_bf16 v[132:135], v[96:99], a[212:215], v[132:135]
  v_cvt_pk_bf16_f32 v86, v100, v101
  v_cvt_pk_bf16_f32 v87, v102, v103
  s_nop 5
  v_cvt_pk_bf16_f32 v90, v132, v133
  v_cvt_pk_bf16_f32 v91, v134, v135
  ds_read_b128 a[244:247], v0 offset:6144
  ds_read_b128 a[248:251], v1 offset:6144
  ds_read_b128 a[252:255], v0 offset:14336
  ds_read_b128 v[116:119], v1 offset:14336
  ds_read_b128 v[120:123], v0 offset:22528
  ds_read_b128 v[124:127], v1 offset:22528
  s_waitcnt lgkmcnt(5)
  v_mfma_f32_16x16x32_bf16 v[128:131], a[0:3], a[244:247], 0
  s_waitcnt lgkmcnt(4)
  v_mfma_f32_16x16x32_bf16 v[128:131], a[12:15], a[248:251], v[128:131]
  s_waitcnt lgkmcnt(3)
  v_mfma_f32_16x16x32_bf16 v[128:131], a[24:27], a[252:255], v[128:131]
  s_waitcnt lgkmcnt(2)
  v_mfma_f32_16x16x32_bf16 v[128:131], a[36:39], v[116:119], v[128:131]
  s_waitcnt lgkmcnt(1)
  v_mfma_f32_16x16x32_bf16 v[128:131], a[48:51], v[120:123], v[128:131]
  s_waitcnt lgkmcnt(0)
  v_mfma_f32_16x16x32_bf16 v[128:131], a[60:63], v[124:127], v[128:131]
  v_mfma_f32_16x16x32_bf16 v[92:95], a[4:7], a[244:247], 0
  v_mfma_f32_16x16x32_bf16 v[92:95], a[16:19], a[248:251], v[92:95]
  v_mfma_f32_16x16x32_bf16 v[92:95], a[28:31], a[252:255], v[92:95]
  v_mfma_f32_16x16x32_bf16 v[92:95], a[40:43], v[116:119], v[92:95]
  v_mfma_f32_16x16x32_bf16 v[92:95], a[52:55], v[120:123], v[92:95]
  v_mfma_f32_16x16x32_bf16 v[92:95], a[64:67], v[124:127], v[92:95]
  v_mul_f32 v128, s42, v128
  v_mul_f32 v129, s42, v129
  v_mul_f32 v130, s42, v130
  v_mul_f32 v131, s42, v131
  v_cvt_pk_bf16_f32 v100, v128, v129
  v_cvt_pk_bf16_f32 v101, v130, v131
  v_mfma_f32_16x16x32_bf16 v[96:99], a[8:11], a[244:247], 0
  v_mfma_f32_16x16x32_bf16 v[96:99], a[20:23], a[248:251], v[96:99]
  v_mfma_f32_16x16x32_bf16 v[96:99], a[32:35], a[252:255], v[96:99]
  v_mfma_f32_16x16x32_bf16 v[96:99], a[44:47], v[116:119], v[96:99]
  v_mfma_f32_16x16x32_bf16 v[96:99], a[56:59], v[120:123], v[96:99]
  v_mfma_f32_16x16x32_bf16 v[96:99], a[68:71], v[124:127], v[96:99]
  v_mul_f32 v92, s42, v92
  v_mul_f32 v93, s42, v93
  v_mul_f32 v94, s42, v94
  v_mul_f32 v95, s42, v95
  v_cvt_pk_bf16_f32 v102, v92, v93
  v_cvt_pk_bf16_f32 v103, v94, v95
  v_mfma_f32_16x16x32_bf16 v[128:131], a[72:75], a[244:247], 0
  v_mfma_f32_16x16x32_bf16 v[128:131], a[84:87], a[248:251], v[128:131]
  v_mfma_f32_16x16x32_bf16 v[128:131], a[96:99], a[252:255], v[128:131]
  v_mfma_f32_16x16x32_bf16 v[128:131], a[108:111], v[116:119], v[128:131]
  v_mfma_f32_16x16x32_bf16 v[128:131], a[120:123], v[120:123], v[128:131]
  v_mfma_f32_16x16x32_bf16 v[128:131], a[132:135], v[124:127], v[128:131]
  v_mul_f32 v96, s42, v96
  v_mul_f32 v97, s42, v97
  v_mul_f32 v98, s42, v98
  v_mul_f32 v99, s42, v99
  v_cvt_pk_bf16_f32 v22, v96, v97
  v_cvt_pk_bf16_f32 v23, v98, v99
  v_mfma_f32_16x16x32_bf16 v[132:135], a[76:79], a[244:247], 0
  v_mfma_f32_16x16x32_bf16 v[132:135], a[88:91], a[248:251], v[132:135]
  v_mfma_f32_16x16x32_bf16 v[132:135], a[100:103], a[252:255], v[132:135]
  v_mfma_f32_16x16x32_bf16 v[132:135], a[112:115], v[116:119], v[132:135]
  v_mfma_f32_16x16x32_bf16 v[132:135], a[124:127], v[120:123], v[132:135]
  v_mfma_f32_16x16x32_bf16 v[132:135], a[136:139], v[124:127], v[132:135]
  v_cvt_pk_bf16_f32 v94, v128, v129
  v_cvt_pk_bf16_f32 v95, v130, v131
  v_mfma_f32_16x16x32_bf16 v[136:139], a[80:83], a[244:247], 0
  v_mfma_f32_16x16x32_bf16 v[136:139], a[92:95], a[248:251], v[136:139]
  v_mfma_f32_16x16x32_bf16 v[136:139], a[104:107], a[252:255], v[136:139]
  v_mfma_f32_16x16x32_bf16 v[136:139], a[116:119], v[116:119], v[136:139]
  v_mfma_f32_16x16x32_bf16 v[136:139], a[128:131], v[120:123], v[136:139]
  v_mfma_f32_16x16x32_bf16 v[136:139], a[140:143], v[124:127], v[136:139]
  v_cvt_pk_bf16_f32 v96, v132, v133
  v_cvt_pk_bf16_f32 v97, v134, v135
  v_mfma_f32_16x16x32_bf16 v[128:131], a[244:247], a[144:147], 0
  v_mfma_f32_16x16x32_bf16 v[128:131], a[248:251], a[156:159], v[128:131]
  v_mfma_f32_16x16x32_bf16 v[128:131], a[252:255], a[168:171], v[128:131]
  v_mfma_f32_16x16x32_bf16 v[128:131], v[116:119], a[180:183], v[128:131]
  v_mfma_f32_16x16x32_bf16 v[128:131], v[120:123], a[192:195], v[128:131]
  v_mfma_f32_16x16x32_bf16 v[128:131], v[124:127], a[204:207], v[128:131]
  v_cvt_pk_bf16_f32 v98, v136, v137
  v_cvt_pk_bf16_f32 v99, v138, v139
  v_mfma_f32_16x16x32_bf16 v[132:135], a[244:247], a[148:151], 0
  v_mfma_f32_16x16x32_bf16 v[132:135], a[248:251], a[160:163], v[132:135]
  v_mfma_f32_16x16x32_bf16 v[132:135], a[252:255], a[172:175], v[132:135]
  v_mfma_f32_16x16x32_bf16 v[132:135], v[116:119], a[184:187], v[132:135]
  v_mfma_f32_16x16x32_bf16 v[132:135], v[120:123], a[196:199], v[132:135]
  v_mfma_f32_16x16x32_bf16 v[132:135], v[124:127], a[208:211], v[132:135]
  v_cvt_pk_bf16_f32 v84, v128, v129
  v_cvt_pk_bf16_f32 v85, v130, v131
  v_mfma_f32_16x16x32_bf16 v[136:139], a[244:247], a[152:155], 0
  v_mfma_f32_16x16x32_bf16 v[136:139], a[248:251], a[164:167], v[136:139]
  v_mfma_f32_16x16x32_bf16 v[136:139], a[252:255], a[176:179], v[136:139]
  v_mfma_f32_16x16x32_bf16 v[136:139], v[116:119], a[188:191], v[136:139]
  v_mfma_f32_16x16x32_bf16 v[136:139], v[120:123], a[200:203], v[136:139]
  v_mfma_f32_16x16x32_bf16 v[136:139], v[124:127], a[212:215], v[136:139]
  v_cvt_pk_bf16_f32 v88, v132, v133
  v_cvt_pk_bf16_f32 v89, v134, v135
  s_nop 5
  v_cvt_pk_bf16_f32 v92, v136, v137
  v_cvt_pk_bf16_f32 v93, v138, v139
  v_mfma_f32_16x16x32_bf16 v[116:119], v[54:57], v[112:115], v[36:39]
  v_mfma_f32_16x16x32_bf16 v[116:119], v[52:55], v[12:15], v[116:119]
  v_mfma_f32_16x16x32_bf16 v[120:123], v[72:75], v[112:115], v[32:35]
  v_mfma_f32_16x16x32_bf16 v[120:123], v[70:73], v[12:15], v[120:123]
  v_mfma_f32_16x16x32_bf16 v[124:127], v[78:81], v[112:115], v[28:31]
  v_mfma_f32_16x16x32_bf16 v[124:127], v[76:79], v[12:15], v[124:127]
  v_mfma_f32_16x16x32_bf16 v[128:131], v[96:99], v[112:115], v[24:27]
  v_mfma_f32_16x16x32_bf16 v[128:131], v[94:97], v[12:15], v[128:131]
  s_nop 1
  v_add_f32 v124, v11, v124
  v_add_f32 v125, v11, v125
  v_add_f32 v126, v11, v126
  v_add_f32 v127, v11, v127
  s_nop 1
  v_add_f32 v128, v11, v128
  v_add_f32 v129, v11, v129
  v_add_f32 v130, v11, v130
  v_add_f32 v131, v11, v131
  v_max_f32 v132, v116, v117
  v_max3_f32 v132, v118, v119, v132
  v_max3_f32 v132, v120, v121, v132
  v_max3_f32 v132, v122, v123, v132
  v_max3_f32 v132, v124, v125, v132
  v_max3_f32 v132, v126, v127, v132
  v_max3_f32 v132, v128, v129, v132
  v_max3_f32 v132, v130, v131, v132
  v_mov_b32 v133, v132
  s_nop 1
  v_permlane32_swap_b32 v132, v133
  v_max_f32 v132, v132, v133
  v_mov_b32 v133, v132
  s_nop 1
  v_permlane16_swap_b32 v132, v133
  v_max_f32 v132, v132, v133
  v_sub_f32 v116, v116, v132
  v_sub_f32 v117, v117, v132
  v_sub_f32 v118, v118, v132
  v_sub_f32 v119, v119, v132
  v_sub_f32 v120, v120, v132
  v_sub_f32 v121, v121, v132
  v_sub_f32 v122, v122, v132
  v_sub_f32 v123, v123, v132
  v_sub_f32 v124, v124, v132
  v_sub_f32 v125, v125, v132
  v_sub_f32 v126, v126, v132
  v_sub_f32 v127, v127, v132
  v_sub_f32 v128, v128, v132
  v_sub_f32 v129, v129, v132
  v_sub_f32 v130, v130, v132
  v_sub_f32 v131, v131, v132
  v_exp_f32 v116, v116
  v_exp_f32 v117, v117
  v_exp_f32 v118, v118
  v_exp_f32 v119, v119
  v_cvt_pk_bf16_f32 v116, v116, v117
  v_cvt_pk_bf16_f32 v117, v118, v119
  v_exp_f32 v120, v120
  v_exp_f32 v121, v121
  v_exp_f32 v122, v122
  v_exp_f32 v123, v123
  v_cvt_pk_bf16_f32 v118, v120, v121
  v_cvt_pk_bf16_f32 v119, v122, v123
  v_exp_f32 v124, v124
  v_exp_f32 v125, v125
  v_exp_f32 v126, v126
  v_exp_f32 v127, v127
  v_cvt_pk_bf16_f32 v120, v124, v125
  v_cvt_pk_bf16_f32 v121, v126, v127
  v_exp_f32 v128, v128
  v_exp_f32 v129, v129
  v_exp_f32 v130, v130
  v_exp_f32 v131, v131
  v_cvt_pk_bf16_f32 v122, v128, v129
  v_cvt_pk_bf16_f32 v123, v130, v131
  v_mov_b64 v[112:113], 0
  s_nop 1
  v_smfmac_f32_16x16x64_bf16 v[112:115], a[240:243], v[116:123], v10
  v_mfma_f32_16x16x32_bf16 v[132:135], v[82:85], v[120:123], 0
  v_mfma_f32_16x16x32_bf16 v[132:135], v[58:61], v[116:119], v[132:135]
  v_mfma_f32_16x16x32_bf16 v[124:127], v[66:69], v[116:119], 0
  v_mfma_f32_16x16x32_bf16 v[124:127], v[86:89], v[120:123], v[124:127]
  v_mfma_f32_16x16x32_bf16 v[128:131], v[90:93], v[120:123], 0
  v_mfma_f32_16x16x32_bf16 v[128:131], v[62:65], v[116:119], v[128:131]
  v_add_f32 v112, v112, v113
  v_rcp_f32 v114, v112
  s_nop 0
  v_mul_f32 v132, v114, v132
  v_mul_f32 v133, v114, v133
  v_mul_f32 v134, v114, v134
  v_mul_f32 v135, v114, v135
  v_cvt_pk_bf16_f32 v132, v132, v133
  v_cvt_pk_bf16_f32 v133, v134, v135
  ds_write_b32 v5, v132 offset:0
  ds_write_b32 v5, v133 offset:1024
  v_mul_f32 v124, v114, v124
  v_mul_f32 v125, v114, v125
  v_mul_f32 v126, v114, v126
  v_mul_f32 v127, v114, v127
  v_cvt_pk_bf16_f32 v124, v124, v125
  v_cvt_pk_bf16_f32 v125, v126, v127
  ds_write_b32 v5, v124 offset:2048
  ds_write_b32 v5, v125 offset:3072
  v_mul_f32 v128, v114, v128
  v_mul_f32 v129, v114, v129
  v_mul_f32 v130, v114, v130
  v_mul_f32 v131, v114, v131
  v_cvt_pk_bf16_f32 v128, v128, v129
  v_cvt_pk_bf16_f32 v129, v130, v131
  ds_write_b32 v5, v128 offset:4096
  ds_write_b32 v5, v129 offset:5120
  v_mfma_f32_16x16x32_bf16 v[112:115], v[52:55], v[108:111], v[40:43]
  v_mfma_f32_16x16x32_bf16 v[112:115], v[54:57], v[14:17], v[112:115]
  v_mfma_f32_16x16x32_bf16 v[116:119], v[70:73], v[108:111], v[36:39]
  v_mfma_f32_16x16x32_bf16 v[116:119], v[72:75], v[14:17], v[116:119]
  v_mfma_f32_16x16x32_bf16 v[120:123], v[76:79], v[108:111], v[32:35]
  v_mfma_f32_16x16x32_bf16 v[120:123], v[78:81], v[14:17], v[120:123]
  v_mfma_f32_16x16x32_bf16 v[124:127], v[94:97], v[108:111], v[28:31]
  v_mfma_f32_16x16x32_bf16 v[124:127], v[96:99], v[14:17], v[124:127]
  s_nop 1
  v_add_f32 v120, v11, v120
  v_add_f32 v121, v11, v121
  v_add_f32 v122, v11, v122
  v_add_f32 v123, v11, v123
  s_nop 1
  v_add_f32 v124, v11, v124
  v_add_f32 v125, v11, v125
  v_add_f32 v126, v11, v126
  v_add_f32 v127, v11, v127
  v_max_f32 v132, v112, v113
  v_max3_f32 v132, v114, v115, v132
  v_max3_f32 v132, v116, v117, v132
  v_max3_f32 v132, v118, v119, v132
  v_max3_f32 v132, v120, v121, v132
  v_max3_f32 v132, v122, v123, v132
  v_max3_f32 v132, v124, v125, v132
  v_max3_f32 v132, v126, v127, v132
  v_mov_b32 v133, v132
  s_nop 1
  v_permlane32_swap_b32 v132, v133
  v_max_f32 v132, v132, v133
  v_mov_b32 v133, v132
  s_nop 1
  v_permlane16_swap_b32 v132, v133
  v_max_f32 v132, v132, v133
  v_sub_f32 v112, v112, v132
  v_sub_f32 v113, v113, v132
  v_sub_f32 v114, v114, v132
  v_sub_f32 v115, v115, v132
  v_sub_f32 v116, v116, v132
  v_sub_f32 v117, v117, v132
  v_sub_f32 v118, v118, v132
  v_sub_f32 v119, v119, v132
  v_sub_f32 v120, v120, v132
  v_sub_f32 v121, v121, v132
  v_sub_f32 v122, v122, v132
  v_sub_f32 v123, v123, v132
  v_sub_f32 v124, v124, v132
  v_sub_f32 v125, v125, v132
  v_sub_f32 v126, v126, v132
  v_sub_f32 v127, v127, v132
  v_exp_f32 v112, v112
  v_exp_f32 v113, v113
  v_exp_f32 v114, v114
  v_exp_f32 v115, v115
  v_cvt_pk_bf16_f32 v112, v112, v113
  v_cvt_pk_bf16_f32 v113, v114, v115
  v_exp_f32 v116, v116
  v_exp_f32 v117, v117
  v_exp_f32 v118, v118
  v_exp_f32 v119, v119
  v_cvt_pk_bf16_f32 v114, v116, v117
  v_cvt_pk_bf16_f32 v115, v118, v119
  v_exp_f32 v120, v120
  v_exp_f32 v121, v121
  v_exp_f32 v122, v122
  v_exp_f32 v123, v123
  v_cvt_pk_bf16_f32 v116, v120, v121
  v_cvt_pk_bf16_f32 v117, v122, v123
  v_exp_f32 v124, v124
  v_exp_f32 v125, v125
  v_exp_f32 v126, v126
  v_exp_f32 v127, v127
  v_cvt_pk_bf16_f32 v118, v124, v125
  v_cvt_pk_bf16_f32 v119, v126, v127
  v_mov_b64 v[108:109], 0
  s_nop 1
  v_smfmac_f32_16x16x64_bf16 v[108:111], a[240:243], v[112:119], v10
  v_mfma_f32_16x16x32_bf16 v[128:131], v[82:85], v[116:119], 0
  v_mfma_f32_16x16x32_bf16 v[128:131], v[58:61], v[112:115], v[128:131]
  v_mfma_f32_16x16x32_bf16 v[120:123], v[66:69], v[112:115], 0
  v_mfma_f32_16x16x32_bf16 v[120:123], v[86:89], v[116:119], v[120:123]
  v_mfma_f32_16x16x32_bf16 v[124:127], v[90:93], v[116:119], 0
  v_mfma_f32_16x16x32_bf16 v[124:127], v[62:65], v[112:115], v[124:127]
  v_add_f32 v108, v108, v109
  v_rcp_f32 v110, v108
  s_nop 0
  v_mul_f32 v128, v110, v128
  v_mul_f32 v129, v110, v129
  v_mul_f32 v130, v110, v130
  v_mul_f32 v131, v110, v131
  v_cvt_pk_bf16_f32 v128, v128, v129
  v_cvt_pk_bf16_f32 v129, v130, v131
  ds_write_b32 v5, v128 offset:256
  ds_write_b32 v5, v129 offset:1280
  v_mul_f32 v120, v110, v120
  v_mul_f32 v121, v110, v121
  v_mul_f32 v122, v110, v122
  v_mul_f32 v123, v110, v123
  v_cvt_pk_bf16_f32 v120, v120, v121
  v_cvt_pk_bf16_f32 v121, v122, v123
  ds_write_b32 v5, v120 offset:2304
  ds_write_b32 v5, v121 offset:3328
  v_mul_f32 v124, v110, v124
  v_mul_f32 v125, v110, v125
  v_mul_f32 v126, v110, v126
  v_mul_f32 v127, v110, v127
  v_cvt_pk_bf16_f32 v124, v124, v125
  v_cvt_pk_bf16_f32 v125, v126, v127
  ds_write_b32 v5, v124 offset:4352
  ds_write_b32 v5, v125 offset:5376
  v_mfma_f32_16x16x32_bf16 v[108:111], v[54:57], v[104:107], v[44:47]
  v_mfma_f32_16x16x32_bf16 v[108:111], v[52:55], v[18:21], v[108:111]
  v_mfma_f32_16x16x32_bf16 v[112:115], v[72:75], v[104:107], v[40:43]
  v_mfma_f32_16x16x32_bf16 v[112:115], v[70:73], v[18:21], v[112:115]
  v_mfma_f32_16x16x32_bf16 v[116:119], v[78:81], v[104:107], v[36:39]
  v_mfma_f32_16x16x32_bf16 v[116:119], v[76:79], v[18:21], v[116:119]
  v_mfma_f32_16x16x32_bf16 v[120:123], v[96:99], v[104:107], v[32:35]
  v_mfma_f32_16x16x32_bf16 v[120:123], v[94:97], v[18:21], v[120:123]
  v_add_f32 v108, v11, v108
  v_add_f32 v109, v11, v109
  v_add_f32 v110, v11, v110
  v_add_f32 v111, v11, v111
  v_add_f32 v112, v11, v112
  v_add_f32 v113, v11, v113
  v_add_f32 v114, v11, v114
  v_add_f32 v115, v11, v115
  v_max_f32 v132, v108, v109
  v_max3_f32 v132, v110, v111, v132
  v_max3_f32 v132, v112, v113, v132
  v_max3_f32 v132, v114, v115, v132
  v_max3_f32 v132, v116, v117, v132
  v_max3_f32 v132, v118, v119, v132
  v_max3_f32 v132, v120, v121, v132
  v_max3_f32 v132, v122, v123, v132
  v_mov_b32 v133, v132
  s_nop 1
  v_permlane32_swap_b32 v132, v133
  v_max_f32 v132, v132, v133
  v_mov_b32 v133, v132
  s_nop 1
  v_permlane16_swap_b32 v132, v133
  v_max_f32 v132, v132, v133
  v_sub_f32 v108, v108, v132
  v_sub_f32 v109, v109, v132
  v_sub_f32 v110, v110, v132
  v_sub_f32 v111, v111, v132
  v_sub_f32 v112, v112, v132
  v_sub_f32 v113, v113, v132
  v_sub_f32 v114, v114, v132
  v_sub_f32 v115, v115, v132
  v_sub_f32 v116, v116, v132
  v_sub_f32 v117, v117, v132
  v_sub_f32 v118, v118, v132
  v_sub_f32 v119, v119, v132
  v_sub_f32 v120, v120, v132
  v_sub_f32 v121, v121, v132
  v_sub_f32 v122, v122, v132
  v_sub_f32 v123, v123, v132
  v_exp_f32 v108, v108
  v_exp_f32 v109, v109
  v_exp_f32 v110, v110
  v_exp_f32 v111, v111
  v_cvt_pk_bf16_f32 v108, v108, v109
  v_cvt_pk_bf16_f32 v109, v110, v111
  v_exp_f32 v112, v112
  v_exp_f32 v113, v113
  v_exp_f32 v114, v114
  v_exp_f32 v115, v115
  v_cvt_pk_bf16_f32 v110, v112, v113
  v_cvt_pk_bf16_f32 v111, v114, v115
  v_exp_f32 v116, v116
  v_exp_f32 v117, v117
  v_exp_f32 v118, v118
  v_exp_f32 v119, v119
  v_cvt_pk_bf16_f32 v112, v116, v117
  v_cvt_pk_bf16_f32 v113, v118, v119
  v_exp_f32 v120, v120
  v_exp_f32 v121, v121
  v_exp_f32 v122, v122
  v_exp_f32 v123, v123
  v_cvt_pk_bf16_f32 v114, v120, v121
  v_cvt_pk_bf16_f32 v115, v122, v123
  v_mov_b64 v[104:105], 0
  s_nop 1
  v_smfmac_f32_16x16x64_bf16 v[104:107], a[240:243], v[108:115], v10
  v_mfma_f32_16x16x32_bf16 v[124:127], v[82:85], v[112:115], 0
  v_mfma_f32_16x16x32_bf16 v[124:127], v[58:61], v[108:111], v[124:127]
  v_mfma_f32_16x16x32_bf16 v[116:119], v[66:69], v[108:111], 0
  v_mfma_f32_16x16x32_bf16 v[116:119], v[86:89], v[112:115], v[116:119]
  v_mfma_f32_16x16x32_bf16 v[120:123], v[90:93], v[112:115], 0
  v_mfma_f32_16x16x32_bf16 v[120:123], v[62:65], v[108:111], v[120:123]
  v_add_f32 v104, v104, v105
  v_rcp_f32 v106, v104
  s_nop 0
  v_mul_f32 v124, v106, v124
  v_mul_f32 v125, v106, v125
  v_mul_f32 v126, v106, v126
  v_mul_f32 v127, v106, v127
  v_cvt_pk_bf16_f32 v124, v124, v125
  v_cvt_pk_bf16_f32 v125, v126, v127
  ds_write_b32 v5, v124 offset:512
  ds_write_b32 v5, v125 offset:1536
  v_mul_f32 v116, v106, v116
  v_mul_f32 v117, v106, v117
  v_mul_f32 v118, v106, v118
  v_mul_f32 v119, v106, v119
  v_cvt_pk_bf16_f32 v116, v116, v117
  v_cvt_pk_bf16_f32 v117, v118, v119
  ds_write_b32 v5, v116 offset:2560
  s_waitcnt lgkmcnt(12)
  ds_write_b32 v5, v117 offset:3584
  v_mul_f32 v120, v106, v120
  v_mul_f32 v121, v106, v121
  v_mul_f32 v122, v106, v122
  v_mul_f32 v123, v106, v123
  v_cvt_pk_bf16_f32 v120, v120, v121
  v_cvt_pk_bf16_f32 v121, v122, v123
  ds_write_b32 v5, v120 offset:4608
  ds_write_b32 v5, v121 offset:5632
  v_mfma_f32_16x16x32_bf16 v[104:107], v[52:55], v[100:103], v[48:51]
  v_mfma_f32_16x16x32_bf16 v[104:107], v[54:57], v[20:23], v[104:107]
  v_mfma_f32_16x16x32_bf16 v[108:111], v[70:73], v[100:103], v[44:47]
  v_mfma_f32_16x16x32_bf16 v[108:111], v[72:75], v[20:23], v[108:111]
  v_mfma_f32_16x16x32_bf16 v[112:115], v[76:79], v[100:103], v[40:43]
  v_mfma_f32_16x16x32_bf16 v[112:115], v[78:81], v[20:23], v[112:115]
  v_mfma_f32_16x16x32_bf16 v[52:55], v[94:97], v[100:103], v[36:39]
  v_mfma_f32_16x16x32_bf16 v[52:55], v[96:99], v[20:23], v[52:55]
  v_add_f32 v104, v11, v104
  v_add_f32 v105, v11, v105
  v_add_f32 v106, v11, v106
  v_add_f32 v107, v11, v107
  v_add_f32 v108, v11, v108
  v_add_f32 v109, v11, v109
  v_add_f32 v110, v11, v110
  v_add_f32 v111, v11, v111
  v_max_f32 v132, v104, v105
  v_max3_f32 v132, v106, v107, v132
  v_max3_f32 v132, v108, v109, v132
  v_max3_f32 v132, v110, v111, v132
  v_max3_f32 v132, v112, v113, v132
  v_max3_f32 v132, v114, v115, v132
  v_max3_f32 v132, v52, v53, v132
  v_max3_f32 v132, v54, v55, v132
  v_mov_b32 v133, v132
  s_nop 1
  v_permlane32_swap_b32 v132, v133
  v_max_f32 v132, v132, v133
  v_mov_b32 v133, v132
  s_nop 1
  v_permlane16_swap_b32 v132, v133
  v_max_f32 v132, v132, v133
  v_sub_f32 v104, v104, v132
  v_sub_f32 v105, v105, v132
  v_sub_f32 v106, v106, v132
  v_sub_f32 v107, v107, v132
  v_sub_f32 v108, v108, v132
  v_sub_f32 v109, v109, v132
  v_sub_f32 v110, v110, v132
  v_sub_f32 v111, v111, v132
  v_sub_f32 v112, v112, v132
  v_sub_f32 v113, v113, v132
  v_sub_f32 v114, v114, v132
  v_sub_f32 v115, v115, v132
  v_sub_f32 v52, v52, v132
  v_sub_f32 v53, v53, v132
  v_sub_f32 v54, v54, v132
  v_sub_f32 v55, v55, v132
  v_exp_f32 v104, v104
  v_exp_f32 v105, v105
  v_exp_f32 v106, v106
  v_exp_f32 v107, v107
  v_cvt_pk_bf16_f32 v104, v104, v105
  v_cvt_pk_bf16_f32 v105, v106, v107
  v_exp_f32 v108, v108
  v_exp_f32 v109, v109
  v_exp_f32 v110, v110
  v_exp_f32 v111, v111
  v_cvt_pk_bf16_f32 v106, v108, v109
  v_cvt_pk_bf16_f32 v107, v110, v111
  v_exp_f32 v112, v112
  v_exp_f32 v113, v113
  v_exp_f32 v114, v114
  v_exp_f32 v115, v115
  v_cvt_pk_bf16_f32 v108, v112, v113
  v_cvt_pk_bf16_f32 v109, v114, v115
  v_exp_f32 v52, v52
  v_exp_f32 v53, v53
  v_exp_f32 v54, v54
  v_exp_f32 v55, v55
  v_cvt_pk_bf16_f32 v110, v52, v53
  v_cvt_pk_bf16_f32 v111, v54, v55
  v_mov_b64 v[74:75], 0
  s_nop 1
  v_smfmac_f32_16x16x64_bf16 v[74:77], a[240:243], v[104:111], v10
  v_mfma_f32_16x16x32_bf16 v[78:81], v[82:85], v[108:111], 0
  v_mfma_f32_16x16x32_bf16 v[78:81], v[58:61], v[104:107], v[78:81]
  v_mfma_f32_16x16x32_bf16 v[52:55], v[66:69], v[104:107], 0
  v_mfma_f32_16x16x32_bf16 v[52:55], v[86:89], v[108:111], v[52:55]
  v_mfma_f32_16x16x32_bf16 v[70:73], v[90:93], v[108:111], 0
  v_mfma_f32_16x16x32_bf16 v[70:73], v[62:65], v[104:107], v[70:73]
  v_add_f32 v74, v74, v75
  v_rcp_f32 v76, v74
  s_nop 0
  v_mul_f32 v78, v76, v78
  v_mul_f32 v79, v76, v79
  v_mul_f32 v80, v76, v80
  v_mul_f32 v81, v76, v81
  v_cvt_pk_bf16_f32 v78, v78, v79
  v_cvt_pk_bf16_f32 v79, v80, v81
  s_waitcnt lgkmcnt(12)
  ds_write_b32 v5, v78 offset:768
  ds_write_b32 v5, v79 offset:1792
  v_mul_f32 v52, v76, v52
  v_mul_f32 v53, v76, v53
  v_mul_f32 v54, v76, v54
  v_mul_f32 v55, v76, v55
  v_cvt_pk_bf16_f32 v52, v52, v53
  v_cvt_pk_bf16_f32 v53, v54, v55
  ds_write_b32 v5, v52 offset:2816
  s_waitcnt lgkmcnt(12)
  ds_write_b32 v5, v53 offset:3840
  v_mul_f32 v70, v76, v70
  v_mul_f32 v71, v76, v71
  v_mul_f32 v72, v76, v72
  v_mul_f32 v73, v76, v73
  v_cvt_pk_bf16_f32 v70, v70, v71
  v_cvt_pk_bf16_f32 v71, v72, v73
  ds_write_b32 v5, v70 offset:4864
  ds_write_b32 v5, v71 offset:5888
  s_waitcnt lgkmcnt(0)
  s_barrier
  ds_read_b128 a[244:247], v3 offset:0
  ds_read_b128 a[248:251], v3 offset:4096
  ds_read_b128 a[252:255], v3 offset:8192
  ds_read_b128 v[64:67], v3 offset:12288
  ds_read_b128 v[74:77], v3 offset:16384
  ds_read_b128 v[78:81], v3 offset:20480
  s_waitcnt lgkmcnt(5)
  v_mfma_f32_16x16x32_bf16 v[56:59], a[244:247], v[184:187], 0
  s_waitcnt lgkmcnt(4)
  v_mfma_f32_16x16x32_bf16 v[56:59], a[248:251], v[200:203], v[56:59]
  s_waitcnt lgkmcnt(3)
  v_mfma_f32_16x16x32_bf16 v[56:59], a[252:255], v[216:219], v[56:59]
  s_waitcnt lgkmcnt(2)
  v_mfma_f32_16x16x32_bf16 v[56:59], v[64:67], v[232:235], v[56:59]
  s_waitcnt lgkmcnt(1)
  v_mfma_f32_16x16x32_bf16 v[56:59], v[74:77], v[248:251], v[56:59]
  s_waitcnt lgkmcnt(0)
  v_mfma_f32_16x16x32_bf16 v[56:59], v[78:81], a[224:227], v[56:59]
  v_mfma_f32_16x16x32_bf16 v[68:71], v[78:81], a[228:231], 0
  v_mfma_f32_16x16x32_bf16 v[68:71], v[74:77], v[252:255], v[68:71]
  v_mfma_f32_16x16x32_bf16 v[68:71], v[64:67], v[236:239], v[68:71]
  v_mfma_f32_16x16x32_bf16 v[68:71], a[252:255], v[220:223], v[68:71]
  v_mfma_f32_16x16x32_bf16 v[68:71], a[248:251], v[204:207], v[68:71]
  v_mfma_f32_16x16x32_bf16 v[68:71], a[244:247], v[188:191], v[68:71]
  v_mfma_f32_16x16x32_bf16 v[52:55], a[244:247], v[192:195], 0
  v_mfma_f32_16x16x32_bf16 v[52:55], a[248:251], v[208:211], v[52:55]
  v_mfma_f32_16x16x32_bf16 v[52:55], a[252:255], v[224:227], v[52:55]
  v_mfma_f32_16x16x32_bf16 v[52:55], v[64:67], v[240:243], v[52:55]
  v_mfma_f32_16x16x32_bf16 v[52:55], v[74:77], a[216:219], v[52:55]
  v_mfma_f32_16x16x32_bf16 v[52:55], v[78:81], a[232:235], v[52:55]
  v_mfma_f32_16x16x32_bf16 v[60:63], v[78:81], a[236:239], 0
  v_mfma_f32_16x16x32_bf16 v[60:63], v[74:77], a[220:223], v[60:63]
  v_mfma_f32_16x16x32_bf16 v[60:63], v[64:67], v[244:247], v[60:63]
  v_mfma_f32_16x16x32_bf16 v[60:63], a[252:255], v[228:231], v[60:63]
  v_mfma_f32_16x16x32_bf16 v[60:63], a[248:251], v[212:215], v[60:63]
  v_mfma_f32_16x16x32_bf16 v[60:63], a[244:247], v[196:199], v[60:63]
  v_cvt_pk_bf16_f32 v56, v56, v68
  v_cvt_pk_bf16_f32 v57, v57, v69
  v_cvt_pk_bf16_f32 v58, v58, v70
  v_cvt_pk_bf16_f32 v59, v59, v71
  buffer_store_dword v56, v7, s[24:27], s33 offen offset:0 nt
  buffer_store_dword v57, v7, s[24:27], s33 offen offset:384 nt
  buffer_store_dword v58, v7, s[24:27], s33 offen offset:768 nt
  buffer_store_dword v59, v7, s[24:27], s33 offen offset:1152 nt
  v_cvt_pk_bf16_f32 v52, v52, v60
  v_cvt_pk_bf16_f32 v53, v53, v61
  v_cvt_pk_bf16_f32 v54, v54, v62
  v_cvt_pk_bf16_f32 v55, v55, v63
  buffer_store_dword v52, v8, s[24:27], s33 offen offset:0 nt
  buffer_store_dword v53, v8, s[24:27], s33 offen offset:384 nt
  buffer_store_dword v54, v8, s[24:27], s33 offen offset:768 nt
  buffer_store_dword v55, v8, s[24:27], s33 offen offset:1152 nt
  ds_read_b128 a[244:247], v4 offset:0
  ds_read_b128 a[248:251], v4 offset:4096
  ds_read_b128 a[252:255], v4 offset:8192
  ds_read_b128 v[64:67], v4 offset:12288
  ds_read_b128 v[68:71], v4 offset:16384
  ds_read_b128 v[72:75], v4 offset:20480
  s_waitcnt lgkmcnt(5)
  v_mfma_f32_16x16x32_bf16 v[52:55], a[244:247], v[184:187], 0
  s_waitcnt lgkmcnt(4)
  v_mfma_f32_16x16x32_bf16 v[52:55], a[248:251], v[200:203], v[52:55]
  s_waitcnt lgkmcnt(3)
  v_mfma_f32_16x16x32_bf16 v[52:55], a[252:255], v[216:219], v[52:55]
  s_waitcnt lgkmcnt(2)
  v_mfma_f32_16x16x32_bf16 v[52:55], v[64:67], v[232:235], v[52:55]
  s_waitcnt lgkmcnt(1)
  v_mfma_f32_16x16x32_bf16 v[52:55], v[68:71], v[248:251], v[52:55]
  s_waitcnt lgkmcnt(0)
  v_mfma_f32_16x16x32_bf16 v[52:55], v[72:75], a[224:227], v[52:55]
  v_mfma_f32_16x16x32_bf16 v[56:59], v[72:75], a[228:231], 0
  v_mfma_f32_16x16x32_bf16 v[56:59], v[68:71], v[252:255], v[56:59]
  v_mfma_f32_16x16x32_bf16 v[56:59], v[64:67], v[236:239], v[56:59]
  v_mfma_f32_16x16x32_bf16 v[56:59], a[252:255], v[220:223], v[56:59]
  v_mfma_f32_16x16x32_bf16 v[56:59], a[248:251], v[204:207], v[56:59]
  v_mfma_f32_16x16x32_bf16 v[56:59], a[244:247], v[188:191], v[56:59]
  s_nop 7
  v_cvt_pk_bf16_f32 v52, v52, v56
  v_cvt_pk_bf16_f32 v53, v53, v57
  v_cvt_pk_bf16_f32 v54, v54, v58
  v_cvt_pk_bf16_f32 v55, v55, v59
  buffer_store_dword v52, v7, s[24:27], s34 offen offset:0 nt
  buffer_store_dword v53, v7, s[24:27], s34 offen offset:384 nt
  buffer_store_dword v54, v7, s[24:27], s34 offen offset:768 nt
  buffer_store_dword v55, v7, s[24:27], s34 offen offset:1152 nt
  ds_read_b128 a[244:247], v3 offset:512
  ds_read_b128 a[248:251], v3 offset:4608
  ds_read_b128 a[252:255], v3 offset:8704
  ds_read_b128 v[64:67], v3 offset:12800
  ds_read_b128 v[68:71], v3 offset:16896
  ds_read_b128 v[76:79], v3 offset:20992
  s_waitcnt lgkmcnt(5)
  v_mfma_f32_16x16x32_bf16 v[52:55], a[244:247], v[184:187], 0
  s_waitcnt lgkmcnt(4)
  v_mfma_f32_16x16x32_bf16 v[52:55], a[248:251], v[200:203], v[52:55]
  s_waitcnt lgkmcnt(3)
  v_mfma_f32_16x16x32_bf16 v[52:55], a[252:255], v[216:219], v[52:55]
  s_waitcnt lgkmcnt(2)
  v_mfma_f32_16x16x32_bf16 v[52:55], v[64:67], v[232:235], v[52:55]
  s_waitcnt lgkmcnt(1)
  v_mfma_f32_16x16x32_bf16 v[52:55], v[68:71], v[248:251], v[52:55]
  s_waitcnt lgkmcnt(0)
  v_mfma_f32_16x16x32_bf16 v[52:55], v[76:79], a[224:227], v[52:55]
  v_mfma_f32_16x16x32_bf16 v[72:75], v[76:79], a[228:231], 0
  v_mfma_f32_16x16x32_bf16 v[72:75], v[68:71], v[252:255], v[72:75]
  v_mfma_f32_16x16x32_bf16 v[72:75], v[64:67], v[236:239], v[72:75]
  v_mfma_f32_16x16x32_bf16 v[72:75], a[252:255], v[220:223], v[72:75]
  v_mfma_f32_16x16x32_bf16 v[72:75], a[248:251], v[204:207], v[72:75]
  v_mfma_f32_16x16x32_bf16 v[72:75], a[244:247], v[188:191], v[72:75]
  v_mfma_f32_16x16x32_bf16 v[56:59], a[244:247], v[192:195], 0
  v_mfma_f32_16x16x32_bf16 v[56:59], a[248:251], v[208:211], v[56:59]
  v_mfma_f32_16x16x32_bf16 v[56:59], a[252:255], v[224:227], v[56:59]
  v_mfma_f32_16x16x32_bf16 v[56:59], v[64:67], v[240:243], v[56:59]
  v_mfma_f32_16x16x32_bf16 v[56:59], v[68:71], a[216:219], v[56:59]
  v_mfma_f32_16x16x32_bf16 v[56:59], v[76:79], a[232:235], v[56:59]
  v_mfma_f32_16x16x32_bf16 v[60:63], v[76:79], a[236:239], 0
  v_mfma_f32_16x16x32_bf16 v[60:63], v[68:71], a[220:223], v[60:63]
  v_mfma_f32_16x16x32_bf16 v[60:63], v[64:67], v[244:247], v[60:63]
  v_mfma_f32_16x16x32_bf16 v[60:63], a[252:255], v[228:231], v[60:63]
  v_mfma_f32_16x16x32_bf16 v[60:63], a[248:251], v[212:215], v[60:63]
  v_mfma_f32_16x16x32_bf16 v[60:63], a[244:247], v[196:199], v[60:63]
  v_cvt_pk_bf16_f32 v52, v52, v72
  v_cvt_pk_bf16_f32 v53, v53, v73
  v_cvt_pk_bf16_f32 v54, v54, v74
  v_cvt_pk_bf16_f32 v55, v55, v75
  buffer_store_dword v52, v7, s[24:27], s35 offen offset:0 nt
  buffer_store_dword v53, v7, s[24:27], s35 offen offset:384 nt
  buffer_store_dword v54, v7, s[24:27], s35 offen offset:768 nt
  buffer_store_dword v55, v7, s[24:27], s35 offen offset:1152 nt
  v_cvt_pk_bf16_f32 v56, v56, v60
  v_cvt_pk_bf16_f32 v57, v57, v61
  v_cvt_pk_bf16_f32 v58, v58, v62
  v_cvt_pk_bf16_f32 v59, v59, v63
  buffer_store_dword v56, v8, s[24:27], s35 offen offset:0 nt
  buffer_store_dword v57, v8, s[24:27], s35 offen offset:384 nt
  buffer_store_dword v58, v8, s[24:27], s35 offen offset:768 nt
  buffer_store_dword v59, v8, s[24:27], s35 offen offset:1152 nt
  ds_read_b128 a[244:247], v4 offset:512
  ds_read_b128 a[248:251], v4 offset:4608
  ds_read_b128 a[252:255], v4 offset:8704
  ds_read_b128 v[64:67], v4 offset:12800
  ds_read_b128 v[68:71], v4 offset:16896
  ds_read_b128 v[72:75], v4 offset:20992
  s_waitcnt lgkmcnt(5)
  v_mfma_f32_16x16x32_bf16 v[52:55], a[244:247], v[184:187], 0
  s_waitcnt lgkmcnt(4)
  v_mfma_f32_16x16x32_bf16 v[52:55], a[248:251], v[200:203], v[52:55]
  s_waitcnt lgkmcnt(3)
  v_mfma_f32_16x16x32_bf16 v[52:55], a[252:255], v[216:219], v[52:55]
  s_waitcnt lgkmcnt(2)
  v_mfma_f32_16x16x32_bf16 v[52:55], v[64:67], v[232:235], v[52:55]
  s_waitcnt lgkmcnt(1)
  v_mfma_f32_16x16x32_bf16 v[52:55], v[68:71], v[248:251], v[52:55]
  s_waitcnt lgkmcnt(0)
  v_mfma_f32_16x16x32_bf16 v[52:55], v[72:75], a[224:227], v[52:55]
  v_mfma_f32_16x16x32_bf16 v[56:59], v[72:75], a[228:231], 0
  v_mfma_f32_16x16x32_bf16 v[56:59], v[68:71], v[252:255], v[56:59]
  v_mfma_f32_16x16x32_bf16 v[56:59], v[64:67], v[236:239], v[56:59]
  v_mfma_f32_16x16x32_bf16 v[56:59], a[252:255], v[220:223], v[56:59]
  v_mfma_f32_16x16x32_bf16 v[56:59], a[248:251], v[204:207], v[56:59]
  v_mfma_f32_16x16x32_bf16 v[56:59], a[244:247], v[188:191], v[56:59]
  s_nop 7
  v_cvt_pk_bf16_f32 v52, v52, v56
  v_cvt_pk_bf16_f32 v53, v53, v57
  v_cvt_pk_bf16_f32 v54, v54, v58
  v_cvt_pk_bf16_f32 v55, v55, v59
  buffer_store_dword v52, v7, s[24:27], s36 offen offset:0 nt
  buffer_store_dword v53, v7, s[24:27], s36 offen offset:384 nt
  buffer_store_dword v54, v7, s[24:27], s36 offen offset:768 nt
  buffer_store_dword v55, v7, s[24:27], s36 offen offset:1152 nt
  v_mov_b32 v11, 0
  s_add_u32 s56, s56, 32
  s_cmp_lt_u32 s56, 992
  s_nop 7
  s_cbranch_scc1 L_sloop
  s_branch L_fin
.section .rodata,"a"
.p2align 6
.amdhsa_kernel standalone__window_attn_swin__vision_kernel
  .amdhsa_next_free_vgpr 512
  .amdhsa_next_free_sgpr 100
  .amdhsa_accum_offset 256
  .amdhsa_group_segment_fixed_size 0
  .amdhsa_kernarg_size 72
  .amdhsa_user_sgpr_count 2
  .amdhsa_user_sgpr_kernarg_segment_ptr 1
  .amdhsa_system_sgpr_workgroup_id_x 1
.end_amdhsa_kernel
```

```asm
; @launch grid=(256,1,1) block=(256,1,1) lds=163840
.amdgcn_target "amdgcn-amd-amdhsa--gfx950"
.text
.globl standalone__window_attn_swin__vision_kernel
.p2align 12
.p2align 8
.type standalone__window_attn_swin__vision_kernel,@function
standalone__window_attn_swin__vision_kernel:
  s_cmpk_ge_u32 s2, 256
  s_cbranch_scc1 L_end
  s_load_dwordx2 s[8:9], s[0:1], 0
  s_load_dwordx2 s[20:21], s[0:1], 24
  s_load_dwordx2 s[12:13], s[0:1], 8
  s_load_dwordx2 s[16:17], s[0:1], 16
  s_load_dwordx2 s[24:25], s[0:1], 48
  s_load_dwordx2 s[62:63], s[0:1], 64
  v_lshrrev_b32 v72, 6, v0
  s_lshr_b32 s49, s2, 3
  v_readfirstlane_b32 s3, v72
  s_getpc_b64 s[50:51]
  v_and_b32 v72, 7, v0
  v_lshl_add_u32 v72, s49, 3, v72
  v_lshlrev_b32 v72, 7, v72
  v_min_u32 v72, L_safe-standalone__window_attn_swin__vision_kernel-256, v72
  v_mov_b32 v55, s51
  v_add_co_u32 v54, vcc, s50, v72
  s_and_b32 s47, s2, 63
  s_lshr_b32 s48, s2, 6
  v_addc_co_u32 v55, vcc, 0, v55, vcc
  global_load_dword v70, v[54:55], off
  v_bfe_u32 v56, v0, 3, 4
  v_and_b32 v11, 7, v0
  v_lshrrev_b32 v65, 1, v56
  v_lshlrev_b32 v73, 2, v56
  v_and_b32 v73, 4, v73
  v_xor_b32 v65, v65, v73
  v_xor_b32 v65, v11, v65
  v_and_b32 v54, 7, v56
  s_add_u32 s48, s48, 60
  s_cmp_lt_u32 s2, 60
  s_cselect_b32 s48, s2, s48
  s_cselect_b32 s47, 63, s47
  s_lshl_b32 s5, s47, 3
  s_add_u32 s5, s5, 4
  v_add_u32 v73, s5, v54
  v_and_b32 v73, 511, v73
  v_mul_u32_u24 v73, 0x180, v73
  v_lshlrev_b32 v57, 4, v65
  v_add_u32 v6, v57, v73
  v_and_b32 v55, 63, v0
  v_lshlrev_b32 v58, 4, v55
  s_mov_b32 s57, 196608
  s_lshl_b32 s5, s48, 3
  s_add_u32 s5, s5, s3
  s_add_u32 s5, s5, 4
  s_mul_i32 s31, s5, s57
  s_add_u32 s5, s5, 4
  s_and_b32 s5, s5, 511
  s_mul_i32 s32, s5, s57
  s_lshl_b32 s46, s3, 10
  s_lshl_b32 s5, s3, 11
  s_add_u32 m0, s5, 147456
  s_mov_b32 s11, 0x20000
  s_mov_b32 s10, 100663296
  s_mov_b32 s23, s11
  s_movk_i32 s22, 1800
  s_mov_b32 s15, s11
  s_mov_b32 s14, 221184
  s_waitcnt lgkmcnt(0)
  buffer_load_dwordx4 v58, s[20:23], 0 offen lds
  buffer_load_dwordx4 v58, s[20:23], 0 offen offset:1024 lds
  s_add_u32 m0, s46, 0
  v_and_b32 v65, 2, v56
  buffer_load_dwordx4 v6, s[8:11], s31 offen offset:0 nt lds
  s_add_u32 m0, s46, 8064
  v_lshrrev_b32 v73, 1, v56
  buffer_load_dwordx4 v6, s[8:11], s31 offen offset:128 nt lds
  s_add_u32 m0, s46, 16128
  v_and_b32 v73, 4, v73
  buffer_load_dwordx4 v6, s[8:11], s31 offen offset:256 nt lds
  s_add_u32 m0, s46, 4096
  v_or_b32 v73, v65, v73
  buffer_load_dwordx4 v6, s[8:11], s32 offen offset:0 nt lds
  s_add_u32 m0, s46, 12160
  v_xor_b32 v73, v11, v73
  buffer_load_dwordx4 v6, s[8:11], s32 offen offset:128 nt lds
  s_add_u32 m0, s46, 20224
  v_lshlrev_b32 v73, 4, v73
  buffer_load_dwordx4 v6, s[8:11], s32 offen offset:256 nt lds
  v_mul_u32_u24 v56, 1152, v54
  v_add_u32 v58, v73, v56
  s_mul_i32 s44, s3, 9216
  s_mov_b32 s19, s11
  s_mov_b32 s18, 73728
  s_lshl_b32 s49, s49, 2
  s_add_u32 s49, s49, s3
  s_mul_i32 s50, s49, 2304
  v_min_u32 v71, 17, v55
  v_lshlrev_b32 v71, 7, v71
  v_lshlrev_b32 v65, 1, v65
  v_xor_b32 v65, v11, v65
  v_mul_u32_u24 v73, 0x180, v54
  v_lshl_add_u32 v69, v65, 4, v73
  s_mul_i32 s45, s3, 3072
  v_add_u32 v6, v57, v73
  s_mov_b32 s27, s11
  s_mov_b32 s26, 100663296
  v_and_b32 v11, 15, v55
  v_lshrrev_b32 v54, 4, v55
  v_lshrrev_b32 v72, 1, v11
  v_lshlrev_b32 v65, 2, v11
  v_and_b32 v65, 4, v65
  v_xor_b32 v72, v72, v65
  v_xor_b32 v72, v54, v72
  v_lshlrev_b32 v72, 4, v72
  v_lshl_add_u32 v0, v11, 7, v72
  v_xor_b32 v1, 64, v0
  v_subrev_u32 v2, s46, v0
  s_add_u32 s28, s46, 24576
  s_add_u32 s29, s46, 49152
  s_mov_b32 s30, s46
  s_and_b32 s4, s3, 1
  v_lshlrev_b32 v72, 4, v11
  v_lshl_add_u32 v65, v54, 10, v72
  s_lshl_b32 s5, s4, 8
  s_add_u32 s5, s5, 73728
  v_add_u32 v3, s5, v65
  v_xor_b32 v4, 0x100, v3
  s_mul_i32 s5, s3, 6144
  s_add_u32 s6, s5, 98304
  s_add_u32 s5, s5, 73728
  s_xor_b32 s41, s5, s6
  v_lshl_add_u32 v65, v54, 2, v72
  v_add_u32 v5, s5, v65
  v_and_b32 v64, 7, v11
  v_lshrrev_b32 v67, 3, v11
  v_and_b32 v66, 1, v54
  v_lshrrev_b32 v56, 1, v54
  v_mul_u32_u24 v72, 0x600, v66
  v_mul_u32_u24 v65, s57, v56
  v_add_u32 v72, v72, v65
  v_lshl_add_u32 v72, v11, 2, v72
  s_lshr_b32 s49, s3, 1
  s_lshl_b32 s5, s49, 6
  s_add_u32 s6, s5, 256
  v_add_u32 v53, s6, v72
  s_lshl_b32 s6, s4, 7
  s_add_u32 s5, s5, s6
  v_add_u32 v52, s5, v72
  s_lshl_b32 s5, s47, 3
  s_add_u32 s5, s5, 4
  s_mul_i32 s5, s5, 384
  s_cmp_eq_u32 s47, 63
  s_cselect_b32 s37, 0, s5
  s_cselect_b32 s5, s5, 0
  s_cselect_b32 s6, s57, 0
  v_mul_u32_u24 v65, s6, v66
  v_sub_u32 v65, s5, v65
  s_lshl_b32 s38, s48, 3
  s_add_u32 s38, s38, 4
  s_xor_b32 s6, s4, 0
  s_lshl_b32 s6, s6, 1
  s_add_u32 s6, s6, s38
  s_and_b32 s6, s6, 511
  s_mul_i32 s6, s6, s57
  s_add_u32 s33, s6, s37
  s_xor_b32 s6, s4, 1
  s_lshl_b32 s6, s6, 1
  s_add_u32 s6, s6, s38
  s_and_b32 s6, s6, 511
  s_mul_i32 s6, s6, s57
  s_add_u32 s34, s6, s37
  s_xor_b32 s6, s4, 2
  s_lshl_b32 s6, s6, 1
  s_add_u32 s6, s6, s38
  s_and_b32 s6, s6, 511
  s_mul_i32 s6, s6, s57
  s_add_u32 s35, s6, s37
  s_xor_b32 s6, s4, 3
  s_lshl_b32 s6, s6, 1
  s_add_u32 s6, s6, s38
  s_and_b32 s6, s6, 511
  s_mul_i32 s6, s6, s57
  s_add_u32 s36, s6, s37
  v_add_u32 v7, v52, v65
  v_add_u32 v8, v53, v65
  s_lshr_b32 s5, s2, 6
  s_and_b32 s6, s2, 63
  s_mul_i32 s56, s5, 15
  s_lshl_b32 s43, s57, 5
  s_cmp_eq_u32 s6, 63
  s_cselect_b32 s6, s56, s6
  s_cselect_b32 s5, 60, s5
  s_cselect_b32 s43, 3072, s43
  s_mul_i32 s5, s5, 1572864
  s_mul_i32 s6, s6, 3072
  s_add_u32 s5, s5, s6
  s_add_u32 s56, s5, 787968
  s_cmp_eq_u32 s43, 3072
  s_cselect_b32 s10, s10, 95158272
  s_mul_i32 s5, s3, s57
  s_add_u32 s31, s56, s5
  s_add_u32 s32, s31, 786432
  s_mul_i32 s6, s43, 3
  s_add_u32 s5, s5, s6
  s_xor_b32 s6, s4, 0
  s_mul_i32 s6, s6, 393216
  s_sub_u32 s37, s6, s5
  s_xor_b32 s6, s4, 1
  s_mul_i32 s6, s6, 393216
  s_sub_u32 s38, s6, s5
  s_xor_b32 s6, s4, 2
  s_mul_i32 s6, s6, 393216
  s_sub_u32 s39, s6, s5
  s_xor_b32 s6, s4, 3
  s_mul_i32 s6, s6, 393216
  s_sub_u32 s40, s6, s5
  s_mul_i32 s97, s43, 17
  s_add_u32 s97, s97, s31
  s_mov_b32 s42, 0x3e553b95
  v_lshrrev_b32 v72, 2, v11
  v_lshl_add_u32 v65, v66, 1, v67
  v_lshl_add_u32 v72, v54, 3, v72
  v_lshlrev_b32 v72, 7, v72
  v_lshl_add_u32 v72, v65, 5, v72
  v_and_b32 v74, 3, v11
  v_lshl_add_u32 v72, v74, 3, v72
  s_mul_i32 s5, s3, 3
  s_and_b32 s6, s5, 3
  s_lshl_b32 s6, s6, 5
  s_lshr_b32 s7, s5, 2
  s_lshl_b32 s7, s7, 13
  s_add_u32 s7, s7, 24576
  v_xor_b32 v65, s6, v72
  v_add_u32 v61, s7, v65
  v_add_u32 v57, 73728, v61
  s_add_u32 s5, s5, 1
  s_and_b32 s6, s5, 3
  s_lshl_b32 s6, s6, 5
  s_lshr_b32 s7, s5, 2
  s_lshl_b32 s7, s7, 13
  s_add_u32 s7, s7, 24576
  v_xor_b32 v65, s6, v72
  v_add_u32 v62, s7, v65
  v_add_u32 v60, 73728, v62
  s_add_u32 s5, s5, 1
  s_and_b32 s6, s5, 3
  s_lshl_b32 s6, s6, 5
  s_lshr_b32 s7, s5, 2
  s_lshl_b32 s7, s7, 13
  s_add_u32 s7, s7, 24576
  v_xor_b32 v65, s6, v72
  v_add_u32 v63, s7, v65
  v_add_u32 v59, 73728, v63
  v_xor_b32 v65, s49, v66
  s_lshl_b32 s5, s4, 13
  v_lshl_add_u32 v72, v56, 3, v66
  v_lshl_add_u32 v72, v72, 2, v65
  v_lshl_add_u32 v72, v72, 4, v11
  v_lshlrev_b32 v72, 2, v72
  s_add_u32 s5, s5, 122880
  v_add_u32 v68, s5, v72
  v_add_u32 v11, 128, v68
  v_add_u32 v54, 139264, v72
  v_add_u32 v55, 128, v54
  s_mov_b32 s58, 0x05040100
  s_mov_b32 s59, 0x07060302
  v_cmp_gt_u32 vcc, 2, v74
  v_mov_b32 v72, 0x3f803f80
  v_mov_b32 v65, 0x44444444
  v_cndmask_b32 v72, 0, v72, vcc
  v_cmp_eq_u32 vcc, 1, v74
  v_mov_b32 v73, 0xeeeeeeee
  v_accvgpr_write_b32 a240, v72
  v_accvgpr_write_b32 a241, v72
  v_accvgpr_write_b32 a242, v72
  v_accvgpr_write_b32 a243, v72
  v_cndmask_b32 v10, v65, v73, vcc
  v_mov_b32 v9, 1.0
  s_mov_b32 s98, s43
  s_mov_b64 s[20:21], s[62:63]
  s_mov_b32 s22, 402653184
  s_min_u32 s96, s3, 1
  s_lshl_b32 s96, s96, 7
  s_xor_b32 s96, s96, 1664
  s_cmp_eq_u32 s47, 63
  s_cselect_b32 s5, 2, 0
  s_or_b32 s96, s96, s5
  v_lshlrev_b32 v72, 2, v64
  v_add_u32 v72, 155712, v72
  v_mov_b32 v65, 0
  ds_write_b32 v72, v65
  v_mov_b64 v[14:15], 0
  v_mov_b64 v[20:21], 0
  v_sub_u32 v72, v67, v56
  v_mul_i32_i24 v72, 15, v72
  v_lshlrev_b32 v65, 2, v66
  v_sub_u32 v73, v64, v65
  v_add3_u32 v72, v72, v73, 19
  s_mul_i32 s5, s3, 2050
  s_add_u32 s5, s5, 147456
  v_lshl_add_u32 v66, v72, 3, s5
  v_mov_b64 v[24:25], 0
  v_mov_b64 v[26:27], 0
  v_mov_b64 v[28:29], 0
  v_mov_b64 v[30:31], 0
  v_mov_b64 v[32:33], 0
  v_mov_b64 v[34:35], 0
  v_mov_b64 v[36:37], 0
  v_mov_b64 v[38:39], 0
  v_mov_b64 v[40:41], 0
  v_mov_b64 v[42:43], 0
  v_mov_b64 v[44:45], 0
  v_mov_b64 v[46:47], 0
  v_mov_b64 v[48:49], 0
  v_mov_b64 v[50:51], 0
  v_xor_b32 v72, v65, v64
  s_cmp_eq_u32 s47, 63
  s_cselect_b32 s5, 4, 0
  v_and_b32 v72, s5, v72
  v_cmp_eq_u32 vcc, 0, v72
  s_cmp_eq_u32 s48, 63
  s_cselect_b32 s5, 0xc31044fe, 0
  v_mov_b32 v92, s5
  v_mov_b32 v56, 0xc31044fe
  v_cndmask_b32 v92, 0, v92, vcc
  v_cndmask_b32 v56, v56, 0, vcc
  s_add_u32 s5, s44, 0
  s_add_u32 m0, s46, 24576
  s_nop 0
  buffer_load_dwordx4 v58, s[12:15], s5 offen offset:0 lds
  s_add_u32 m0, s46, 32640
  s_nop 0
  buffer_load_dwordx4 v58, s[12:15], s5 offen offset:128 lds
  s_add_u32 m0, s46, 40704
  s_nop 0
  buffer_load_dwordx4 v58, s[12:15], s5 offen offset:256 lds
  s_add_u32 s5, s44, 36864
  s_add_u32 m0, s46, 28672
  s_nop 0
  buffer_load_dwordx4 v58, s[12:15], s5 offen offset:0 lds
  s_add_u32 m0, s46, 36736
  s_nop 0
  buffer_load_dwordx4 v58, s[12:15], s5 offen offset:128 lds
  s_add_u32 m0, s46, 44800
  s_nop 0
  buffer_load_dwordx4 v58, s[12:15], s5 offen offset:256 lds
  s_waitcnt vmcnt(12)
  ds_read_u16_d16_hi v24, v66 offset:24
  ds_read_u16_d16_hi v25, v66 offset:16
  ds_read_u16_d16_hi v26, v66 offset:8
  ds_read_u16_d16_hi v27, v66 offset:0
  ds_read_u16_d16_hi v28, v66 offset:264
  ds_read_u16_d16_hi v29, v66 offset:256
  ds_read_u16_d16_hi v30, v66 offset:248
  ds_read_u16_d16_hi v31, v66 offset:240
  ds_read_u16_d16_hi v32, v66 offset:504
  ds_read_u16_d16_hi v33, v66 offset:496
  ds_read_u16_d16_hi v34, v66 offset:488
  ds_read_u16_d16_hi v35, v66 offset:480
  ds_read_u16_d16_hi v36, v66 offset:744
  ds_read_u16_d16_hi v37, v66 offset:736
  ds_read_u16_d16_hi v38, v66 offset:728
  ds_read_u16_d16_hi v39, v66 offset:720
  ds_read_u16_d16_hi v40, v66 offset:984
  ds_read_u16_d16_hi v41, v66 offset:976
  ds_read_u16_d16_hi v42, v66 offset:968
  ds_read_u16_d16_hi v43, v66 offset:960
  ds_read_u16_d16_hi v44, v66 offset:1224
  ds_read_u16_d16_hi v45, v66 offset:1216
  ds_read_u16_d16_hi v46, v66 offset:1208
  ds_read_u16_d16_hi v47, v66 offset:1200
  ds_read_u16_d16_hi v48, v66 offset:1464
  ds_read_u16_d16_hi v49, v66 offset:1456
  ds_read_u16_d16_hi v50, v66 offset:1448
  ds_read_u16_d16_hi v51, v66 offset:1440
  s_mov_b32 s5, 0x3fb8aa3b
  v_add_f32 v92, v56, v92
  s_waitcnt lgkmcnt(15)
  v_mul_f32 v24, s5, v24
  v_mul_f32 v25, s5, v25
  v_mul_f32 v26, s5, v26
  v_mul_f32 v27, s5, v27
  v_mul_f32 v28, s5, v28
  v_mul_f32 v29, s5, v29
  v_mul_f32 v30, s5, v30
  v_mul_f32 v31, s5, v31
  v_mul_f32 v32, s5, v32
  v_mul_f32 v33, s5, v33
  v_mul_f32 v34, s5, v34
  v_mul_f32 v35, s5, v35
  v_mul_f32 v36, s5, v36
  s_waitcnt lgkmcnt(14)
  v_mul_f32 v37, s5, v37
  s_waitcnt lgkmcnt(13)
  v_mul_f32 v38, s5, v38
  s_waitcnt lgkmcnt(12)
  v_mul_f32 v39, s5, v39
  s_waitcnt lgkmcnt(11)
  v_mul_f32 v40, s5, v40
  s_waitcnt lgkmcnt(10)
  v_mul_f32 v41, s5, v41
  s_waitcnt lgkmcnt(9)
  v_mul_f32 v42, s5, v42
  s_waitcnt lgkmcnt(8)
  v_mul_f32 v43, s5, v43
  s_waitcnt lgkmcnt(7)
  v_mul_f32 v44, s5, v44
  s_waitcnt lgkmcnt(6)
  v_mul_f32 v45, s5, v45
  s_waitcnt lgkmcnt(5)
  v_mul_f32 v46, s5, v46
  s_waitcnt lgkmcnt(4)
  v_mul_f32 v47, s5, v47
  s_waitcnt lgkmcnt(3)
  v_mul_f32 v48, s5, v48
  s_waitcnt lgkmcnt(2)
  v_mul_f32 v49, s5, v49
  s_waitcnt lgkmcnt(1)
  v_mul_f32 v50, s5, v50
  s_waitcnt lgkmcnt(0)
  v_mul_f32 v51, s5, v51
  v_add_f32 v72, v92, v48
  v_add_f32 v73, v92, v49
  v_add_f32 v74, v92, v50
  v_add_f32 v75, v92, v51
  v_add_f32 v64, v92, v44
  v_add_f32 v65, v92, v45
  v_add_f32 v66, v92, v46
  v_add_f32 v67, v92, v47
  v_add_f32 v76, v92, v40
  v_add_f32 v77, v92, v41
  v_add_f32 v78, v92, v42
  v_add_f32 v79, v92, v43
  v_add_f32 v84, v92, v32
  v_add_f32 v85, v92, v33
  v_add_f32 v86, v92, v34
  v_add_f32 v87, v92, v35
  v_add_f32 v80, v92, v28
  v_add_f32 v81, v92, v29
  v_add_f32 v82, v92, v30
  v_add_f32 v83, v92, v31
  v_add_f32 v88, v92, v24
  v_add_f32 v89, v92, v25
  v_add_f32 v90, v92, v26
  v_add_f32 v91, v92, v27
  s_add_u32 s5, s44, 73728
  s_add_u32 m0, s46, 49152
  s_nop 0
  buffer_load_dwordx4 v58, s[12:15], s5 offen offset:0 lds
  s_add_u32 m0, s46, 57216
  s_nop 0
  buffer_load_dwordx4 v58, s[12:15], s5 offen offset:128 lds
  s_add_u32 m0, s46, 65280
  s_nop 0
  buffer_load_dwordx4 v58, s[12:15], s5 offen offset:256 lds
  s_add_u32 s5, s44, 110592
  s_add_u32 m0, s46, 53248
  s_nop 0
  buffer_load_dwordx4 v58, s[12:15], s5 offen offset:0 lds
  s_add_u32 m0, s46, 61312
  s_nop 0
  buffer_load_dwordx4 v58, s[12:15], s5 offen offset:128 lds
  s_add_u32 m0, s46, 69376
  s_nop 0
  buffer_load_dwordx4 v58, s[12:15], s5 offen offset:256 lds
  s_cmp_ge_u32 s50, s14
  s_cselect_b64 s[52:53], s[16:17], s[12:13]
  s_cselect_b64 s[54:55], s[18:19], s[14:15]
  s_cselect_b32 s5, s14, 0
  s_sub_u32 s50, s50, s5
  buffer_load_dword v120, v71, s[52:55], s50 offen
  s_mov_b64 exec, 0
  s_cmp_eq_u32 s3, 0
  s_cbranch_scc1 L_hop_0_0
  s_cmp_eq_u32 s3, 1
  s_cbranch_scc1 L_hop_1_0
  s_cmp_eq_u32 s3, 2
  s_cbranch_scc1 L_hop_2_0
  s_branch L_hop_3_0
  s_nop 0
  s_nop 0
  s_nop 0
  s_nop 0
  s_nop 0
  s_nop 0
  s_nop 0
  s_nop 0
  s_nop 0
  s_nop 0
  s_nop 0
  s_nop 0
  s_nop 0
  s_nop 0
  s_nop 0
  s_nop 0
  s_nop 0
  s_nop 0
  s_nop 0
  s_nop 0
  s_nop 0
  s_nop 0
  s_nop 0
  s_nop 0
  s_nop 0
  s_nop 0
  s_nop 0
  s_nop 0
  s_nop 0
  s_nop 0
  s_nop 0
  s_nop 0
  s_nop 0
  s_nop 0
  s_nop 0
  s_nop 0
  s_nop 0
  s_nop 0
  s_nop 0
  s_nop 0
  s_nop 0
  s_nop 0
  s_nop 0
  s_nop 0
  s_nop 0
  s_nop 0
  s_nop 0
  s_nop 0
  s_nop 0
  s_nop 0
  s_nop 0
  s_nop 0
  s_nop 0
  s_nop 0
  s_nop 0
  s_nop 0
  s_nop 0
  s_nop 0
  s_nop 0
  s_nop 0
  s_nop 0
  s_nop 0
  s_nop 0
  s_nop 0
  s_nop 0
  s_nop 0
  s_nop 0
  s_nop 0
  s_nop 0
  s_nop 0
  s_nop 0
  s_nop 0
  s_nop 0
  s_nop 0
  s_nop 0
  s_nop 0
  s_nop 0
  s_nop 0
  s_nop 0
  s_nop 0
  s_nop 0
  s_nop 0
  s_nop 0
  s_nop 0
  s_nop 0
  s_nop 0
  s_nop 0
  s_nop 0
  s_nop 0
  s_nop 0
  s_nop 0
  s_nop 0
  s_nop 0
  s_nop 0
  s_nop 0
  s_nop 0
  s_nop 0
  s_nop 0
  s_nop 0
  s_nop 0
  s_nop 0
  s_nop 0
  s_nop 0
  s_nop 0
  s_nop 0
  s_nop 0
  s_nop 0
  s_nop 0
  s_nop 0
  s_nop 0
  s_nop 0
  s_nop 0
  s_nop 0
  s_nop 0
  s_nop 0
  s_nop 0
  s_nop 0
  s_nop 0
  s_nop 0
  s_nop 0
  s_nop 0
  s_nop 0
  s_nop 0
  s_nop 0
  s_nop 0
  s_nop 0
  s_nop 0
  s_nop 0
  s_nop 0
  s_nop 0
  s_nop 0
  s_nop 0
  s_nop 0
  s_nop 0
  s_nop 0
  s_nop 0
  s_nop 0
  s_nop 0
  s_nop 0
  s_nop 0
  s_nop 0
  s_nop 0
  s_nop 0
  s_nop 0
  s_nop 0
  s_nop 0
  s_nop 0
  s_nop 0
  s_nop 0
  s_nop 0
  s_nop 0
  s_nop 0
  s_nop 0
  s_nop 0
  s_nop 0
  s_nop 0
  s_nop 0
  s_nop 0
  s_nop 0
  s_nop 0
  s_nop 0
  s_nop 0
  s_nop 0
  s_nop 0
  s_nop 0
  s_nop 0
  s_nop 0
  s_nop 0
  s_nop 0
  s_nop 0
  s_nop 0
  s_nop 0
  s_nop 0
  s_nop 0
  s_nop 0
  s_nop 0
  s_nop 0
  s_nop 0
  s_nop 0
  s_nop 0
  s_nop 0
  s_nop 0
  s_nop 0
  s_nop 0
  s_nop 0
  s_nop 0
  s_nop 0
  s_nop 0
  s_nop 0
  s_nop 0
  s_nop 0
  s_nop 0
  s_nop 0
  s_nop 0
  s_nop 0
  s_nop 0
  s_nop 0
  s_nop 0
  s_nop 0
  s_nop 0
  s_nop 0
  s_nop 0
  s_nop 0
  s_nop 0
  s_nop 0
  s_nop 0
  s_nop 0
  s_nop 0
  s_nop 0
  s_nop 0
  s_nop 0
  s_nop 0
  s_nop 0
  s_nop 0
  s_nop 0
  s_nop 0
  s_nop 0
  s_nop 0
  s_nop 0
  s_nop 0
  s_nop 0
  s_nop 0
  s_nop 0
  s_nop 0
  s_nop 0
  s_nop 0
  s_nop 0
  s_nop 0
  s_nop 0
  s_nop 0
  s_nop 0
  s_nop 0
  s_nop 0
  s_nop 0
  s_nop 0
  s_nop 0
  s_nop 0
  s_nop 0
  s_nop 0
  s_nop 0
  s_nop 0
  s_nop 0
  s_nop 0
  s_nop 0
  s_nop 0
  s_nop 0
  s_nop 0
  s_nop 0
  s_nop 0
  s_nop 0
  s_nop 0
  s_nop 0
  s_nop 0
  s_nop 0
  s_nop 0
  s_nop 0
  s_nop 0
  s_nop 0
  s_nop 0
  s_nop 0
  s_nop 0
  s_nop 0
  s_nop 0
  s_nop 0
  s_nop 0
  s_nop 0
  s_nop 0
  s_nop 0
  s_nop 0
  s_nop 0
  s_nop 0
  s_nop 0
  s_nop 0
  s_nop 0
  s_nop 0
  s_nop 0
  s_nop 0
  s_nop 0
  s_nop 0
  s_nop 0
  s_nop 0
  s_nop 0
  s_nop 0
  s_nop 0
  s_nop 0
  s_nop 0
  s_nop 0
  s_nop 0
  s_nop 0
  s_nop 0
  s_nop 0
  s_nop 0
  s_nop 0
  s_nop 0
  s_nop 0
  s_nop 0
  s_nop 0
  s_nop 0
  s_nop 0
  s_nop 0
  s_nop 0
  s_nop 0
  s_nop 0
  s_nop 0
  s_nop 0
  s_nop 0
  s_nop 0
  s_nop 0
  s_nop 0
  s_nop 0
  s_nop 0
  s_nop 0
  s_nop 0
  s_nop 0
  s_nop 0
  s_nop 0
  s_nop 0
  s_nop 0
  s_nop 0
  s_nop 0
  s_nop 0
  s_nop 0
  s_nop 0
  s_nop 0
  s_nop 0
  s_nop 0
  s_nop 0
  s_nop 0
  s_nop 0
  s_nop 0
  s_nop 0
  s_nop 0
  s_nop 0
  s_nop 0
  s_nop 0
  s_nop 0
  s_nop 0
  s_nop 0
  s_nop 0
  s_nop 0
  s_nop 0
  s_nop 0
  s_nop 0
  s_nop 0
  s_nop 0
  s_nop 0
  s_nop 0
  s_nop 0
  s_nop 0
  s_nop 0
  s_nop 0
  s_nop 0
  s_nop 0
  s_nop 0
  s_nop 0
  s_nop 0
  s_nop 0
  s_nop 0
  s_nop 0
  s_nop 0
  s_nop 0
  s_nop 0
  s_nop 0
  s_nop 0
  s_nop 0
  s_nop 0
  s_nop 0
  s_nop 0
  s_nop 0
  s_nop 0
  s_nop 0
  s_nop 0
  s_nop 0
  s_nop 0
  s_nop 0
  s_nop 0
  s_nop 0
  s_nop 0
  s_nop 0
  s_nop 0
  s_nop 0
  s_nop 0
L_walk:
  s_mov_b64 exec, -1
L_walked:
  s_waitcnt vmcnt(13)
  s_barrier
  ds_read_b128 v[184:187], v0 offset:0
  ds_read_b128 v[188:191], v1 offset:0
  ds_read_b128 v[208:211], v0 offset:2048
  ds_read_b128 v[212:215], v1 offset:2048
  ds_read_b128 v[232:235], v0 offset:4096
  ds_read_b128 v[236:239], v1 offset:4096
  ds_read_b128 a[216:219], v0 offset:6144
  ds_read_b128 a[220:223], v1 offset:6144
  s_add_u32 s5, s44, 147456
  s_add_u32 m0, s46, 73728
  s_nop 0
  buffer_load_dwordx4 v58, s[12:15], s5 offen offset:0 lds
  s_add_u32 m0, s46, 81792
  s_nop 0
  buffer_load_dwordx4 v58, s[12:15], s5 offen offset:128 lds
  s_add_u32 m0, s46, 89856
  s_nop 0
  buffer_load_dwordx4 v58, s[12:15], s5 offen offset:256 lds
  s_waitcnt vmcnt(10)
  s_barrier
  ds_read_b64_tr_b16 a[0:1], v61 offset:0
  ds_read_b64_tr_b16 a[2:3], v61 offset:512
  ds_read_b64_tr_b16 a[12:13], v61 offset:4096
  ds_read_b64_tr_b16 a[14:15], v61 offset:4608
  s_waitcnt lgkmcnt(2)
  v_mfma_f32_16x16x32_bf16 v[116:119], a[0:3], v[184:187], 0
  s_add_u32 s5, s44, 184320
  s_add_u32 m0, s46, 77824
  ds_read_b64_tr_b16 a[4:5], v62 offset:0
  s_waitcnt lgkmcnt(1)
  v_mfma_f32_16x16x32_bf16 v[116:119], a[12:15], v[188:191], v[116:119]
  buffer_load_dwordx4 v58, s[12:15], s5 offen offset:0 lds
  v_mfma_f32_16x16x32_bf16 v[128:131], a[0:3], v[208:211], 0
  s_add_u32 m0, s46, 85888
  ds_read_b64_tr_b16 a[6:7], v62 offset:512
  ds_read_b64_tr_b16 a[16:17], v62 offset:4096
  v_mfma_f32_16x16x32_bf16 v[128:131], a[12:15], v[212:215], v[128:131]
  buffer_load_dwordx4 v58, s[12:15], s5 offen offset:128 lds
  v_mfma_f32_16x16x32_bf16 v[168:171], a[0:3], v[232:235], 0
  s_add_u32 m0, s46, 93952
  ds_read_b64_tr_b16 a[18:19], v62 offset:4608
  ds_read_b64_tr_b16 a[8:9], v63 offset:0
  v_mfma_f32_16x16x32_bf16 v[168:171], a[12:15], v[236:239], v[168:171]
  buffer_load_dwordx4 v58, s[12:15], s5 offen offset:256 lds
  v_mfma_f32_16x16x32_bf16 v[92:95], a[0:3], a[216:219], 0
  s_add_u32 s5, s44, 384
  s_add_u32 m0, s46, 98304
  ds_read_b64_tr_b16 a[10:11], v63 offset:512
  v_mfma_f32_16x16x32_bf16 v[92:95], a[12:15], a[220:223], v[92:95]
  s_waitcnt lgkmcnt(3)
  ds_read_b64_tr_b16 a[20:21], v63 offset:4096
  ds_read_b64_tr_b16 a[22:23], v63 offset:4608
  v_mfma_f32_16x16x32_bf16 v[136:139], a[4:7], v[184:187], 0
  buffer_load_dwordx4 v58, s[12:15], s5 offen offset:0 lds
  s_waitcnt lgkmcnt(4)
  v_mfma_f32_16x16x32_bf16 v[136:139], a[16:19], v[188:191], v[136:139]
  s_add_u32 m0, s46, 106368
  ds_read_b128 v[192:195], v0 offset:8192
  ds_read_b128 v[196:199], v1 offset:8192
  v_mfma_f32_16x16x32_bf16 v[132:135], a[4:7], v[208:211], 0
  buffer_load_dwordx4 v58, s[12:15], s5 offen offset:128 lds
  v_mfma_f32_16x16x32_bf16 v[132:135], a[16:19], v[212:215], v[132:135]
  s_add_u32 m0, s46, 114432
  ds_read_b128 v[216:219], v0 offset:10240
  ds_read_b128 v[220:223], v1 offset:10240
  v_mfma_f32_16x16x32_bf16 v[164:167], a[4:7], v[232:235], 0
  buffer_load_dwordx4 v58, s[12:15], s5 offen offset:256 lds
  v_mfma_f32_16x16x32_bf16 v[164:167], a[16:19], v[236:239], v[164:167]
  s_add_u32 s5, s44, 37248
  s_add_u32 m0, s46, 102400
  ds_read_b128 v[240:243], v0 offset:12288
  v_mfma_f32_16x16x32_bf16 v[108:111], a[4:7], a[216:219], 0
  s_waitcnt lgkmcnt(3)
  ds_read_b128 v[244:247], v1 offset:12288
  ds_read_b128 a[224:227], v0 offset:14336
  v_mfma_f32_16x16x32_bf16 v[108:111], a[16:19], a[220:223], v[108:111]
  s_waitcnt vmcnt(10)
  s_barrier
  v_mfma_f32_16x16x32_bf16 v[124:127], a[8:11], v[184:187], 0
  buffer_load_dwordx4 v58, s[12:15], s5 offen offset:0 lds
  v_mfma_f32_16x16x32_bf16 v[124:127], a[20:23], v[188:191], v[124:127]
  s_add_u32 m0, s46, 110464
  ds_read_b64_tr_b16 a[24:25], v61 offset:24576
  ds_read_b64_tr_b16 a[26:27], v61 offset:25088
  v_mfma_f32_16x16x32_bf16 v[152:155], a[8:11], v[208:211], 0
  buffer_load_dwordx4 v58, s[12:15], s5 offen offset:128 lds
  v_mfma_f32_16x16x32_bf16 v[152:155], a[20:23], v[212:215], v[152:155]
  s_add_u32 m0, s46, 118528
  ds_read_b64_tr_b16 a[36:37], v61 offset:28672
  ds_read_b64_tr_b16 a[38:39], v61 offset:29184
  v_mfma_f32_16x16x32_bf16 v[100:103], a[8:11], v[232:235], 0
  buffer_load_dwordx4 v58, s[12:15], s5 offen offset:256 lds
  v_mfma_f32_16x16x32_bf16 v[100:103], a[20:23], v[236:239], v[100:103]
  ds_read_b128 a[228:231], v1 offset:14336
  ds_read_b64_tr_b16 a[28:29], v62 offset:24576
  v_mfma_f32_16x16x32_bf16 v[112:115], a[8:11], a[216:219], 0
  ds_read_b64_tr_b16 a[30:31], v62 offset:25088
  ds_read_b64_tr_b16 a[40:41], v62 offset:28672
  v_mfma_f32_16x16x32_bf16 v[112:115], a[20:23], a[220:223], v[112:115]
  s_waitcnt lgkmcnt(6)
  ds_read_b64_tr_b16 a[42:43], v62 offset:29184
  ds_read_b64_tr_b16 a[32:33], v63 offset:24576
  v_mfma_f32_16x16x32_bf16 v[116:119], a[24:27], v[192:195], v[116:119]
  s_waitcnt lgkmcnt(6)
  ds_read_b64_tr_b16 a[34:35], v63 offset:25088
  ds_read_b64_tr_b16 a[44:45], v63 offset:28672
  v_mfma_f32_16x16x32_bf16 v[116:119], a[36:39], v[196:199], v[116:119]
  ds_read_b64_tr_b16 a[46:47], v63 offset:29184
  ds_read_b128 v[200:203], v0 offset:16384
  v_mfma_f32_16x16x32_bf16 v[128:131], a[24:27], v[216:219], v[128:131]
  ds_read_b128 v[204:207], v1 offset:16384
  ds_read_b128 v[224:227], v0 offset:18432
  v_mfma_f32_16x16x32_bf16 v[128:131], a[36:39], v[220:223], v[128:131]
  ds_read_b128 v[228:231], v1 offset:18432
  ds_read_b128 v[248:251], v0 offset:20480
  v_mfma_f32_16x16x32_bf16 v[168:171], a[24:27], v[240:243], v[168:171]
  ds_read_b128 v[252:255], v1 offset:20480
  ds_read_b128 a[232:235], v0 offset:22528
  v_mfma_f32_16x16x32_bf16 v[168:171], a[36:39], v[244:247], v[168:171]
  s_add_u32 s5, s44, 74112
  s_add_u32 m0, s46, 122880
  ds_read_b128 a[236:239], v1 offset:22528
  v_mfma_f32_16x16x32_bf16 v[92:95], a[24:27], a[224:227], v[92:95]
  s_waitcnt lgkmcnt(7)
  v_mfma_f32_16x16x32_bf16 v[92:95], a[36:39], a[228:231], v[92:95]
  v_mfma_f32_16x16x32_bf16 v[136:139], a[28:31], v[192:195], v[136:139]
  buffer_load_dwordx4 v58, s[12:15], s5 offen offset:0 lds
  v_mfma_f32_16x16x32_bf16 v[136:139], a[40:43], v[196:199], v[136:139]
  s_add_u32 m0, s46, 130944
  v_mfma_f32_16x16x32_bf16 v[132:135], a[28:31], v[216:219], v[132:135]
  buffer_load_dwordx4 v58, s[12:15], s5 offen offset:128 lds
  v_mfma_f32_16x16x32_bf16 v[132:135], a[40:43], v[220:223], v[132:135]
  s_add_u32 m0, s46, 139008
  v_mfma_f32_16x16x32_bf16 v[164:167], a[28:31], v[240:243], v[164:167]
  buffer_load_dwordx4 v58, s[12:15], s5 offen offset:256 lds
  v_mfma_f32_16x16x32_bf16 v[164:167], a[40:43], v[244:247], v[164:167]
  s_add_u32 s5, s44, 110976
  s_add_u32 m0, s46, 126976
  v_mfma_f32_16x16x32_bf16 v[108:111], a[28:31], a[224:227], v[108:111]
  v_mfma_f32_16x16x32_bf16 v[108:111], a[40:43], a[228:231], v[108:111]
  s_waitcnt vmcnt(9)
  s_barrier
  v_mfma_f32_16x16x32_bf16 v[124:127], a[32:35], v[192:195], v[124:127]
  buffer_load_dwordx4 v58, s[12:15], s5 offen offset:0 lds
  v_mfma_f32_16x16x32_bf16 v[124:127], a[44:47], v[196:199], v[124:127]
  s_add_u32 m0, s46, 135040
  ds_read_b64_tr_b16 a[48:49], v61 offset:49152
  ds_read_b64_tr_b16 a[50:51], v61 offset:49664
  v_mfma_f32_16x16x32_bf16 v[152:155], a[32:35], v[216:219], v[152:155]
  buffer_load_dwordx4 v58, s[12:15], s5 offen offset:128 lds
  v_mfma_f32_16x16x32_bf16 v[152:155], a[44:47], v[220:223], v[152:155]
  s_add_u32 m0, s46, 143104
  ds_read_b64_tr_b16 a[60:61], v61 offset:53248
  ds_read_b64_tr_b16 a[62:63], v61 offset:53760
  v_mfma_f32_16x16x32_bf16 v[100:103], a[32:35], v[240:243], v[100:103]
  buffer_load_dwordx4 v58, s[12:15], s5 offen offset:256 lds
  v_mfma_f32_16x16x32_bf16 v[100:103], a[44:47], v[244:247], v[100:103]
  ds_read_b64_tr_b16 a[52:53], v62 offset:49152
  ds_read_b64_tr_b16 a[54:55], v62 offset:49664
  v_mfma_f32_16x16x32_bf16 v[112:115], a[32:35], a[224:227], v[112:115]
  ds_read_b64_tr_b16 a[64:65], v62 offset:53248
  ds_read_b64_tr_b16 a[66:67], v62 offset:53760
  v_mfma_f32_16x16x32_bf16 v[112:115], a[44:47], a[228:231], v[112:115]
  s_waitcnt lgkmcnt(6)
  ds_read_b64_tr_b16 a[56:57], v63 offset:49152
  ds_read_b64_tr_b16 a[58:59], v63 offset:49664
  v_mfma_f32_16x16x32_bf16 v[116:119], a[48:51], v[200:203], v[116:119]
  s_waitcnt lgkmcnt(6)
  ds_read_b64_tr_b16 a[68:69], v63 offset:53248
  ds_read_b64_tr_b16 a[70:71], v63 offset:53760
  v_mfma_f32_16x16x32_bf16 v[116:119], a[60:63], v[204:207], v[116:119]
  v_mfma_f32_16x16x32_bf16 v[128:131], a[48:51], v[224:227], v[128:131]
  v_mfma_f32_16x16x32_bf16 v[128:131], a[60:63], v[228:231], v[128:131]
  v_mfma_f32_16x16x32_bf16 v[168:171], a[48:51], v[248:251], v[168:171]
  v_mul_f32 v116, s42, v116
  v_mul_f32 v117, s42, v117
  v_mfma_f32_16x16x32_bf16 v[168:171], a[60:63], v[252:255], v[168:171]
  s_add_u32 s5, s44, 147840
  s_add_u32 m0, s46, 24576
  v_mul_f32 v118, s42, v118
  v_mfma_f32_16x16x32_bf16 v[92:95], a[48:51], a[232:235], v[92:95]
  v_mul_f32 v119, s42, v119
  v_cvt_pk_bf16_f32 v12, v116, v117
  v_mfma_f32_16x16x32_bf16 v[92:95], a[60:63], a[236:239], v[92:95]
  s_waitcnt lgkmcnt(0)
  v_cvt_pk_bf16_f32 v13, v118, v119
  v_mul_f32 v128, s42, v128
  v_mfma_f32_16x16x32_bf16 v[136:139], a[52:55], v[200:203], v[136:139]
  buffer_load_dwordx4 v58, s[12:15], s5 offen offset:0 lds
  v_mfma_f32_16x16x32_bf16 v[136:139], a[64:67], v[204:207], v[136:139]
  s_add_u32 m0, s46, 32640
  v_mul_f32 v129, s42, v129
  v_mul_f32 v130, s42, v130
  v_mfma_f32_16x16x32_bf16 v[132:135], a[52:55], v[224:227], v[132:135]
  buffer_load_dwordx4 v58, s[12:15], s5 offen offset:128 lds
  v_mfma_f32_16x16x32_bf16 v[132:135], a[64:67], v[228:231], v[132:135]
  s_add_u32 m0, s46, 40704
  v_mul_f32 v131, s42, v131
  v_cvt_pk_bf16_f32 v116, v128, v129
  v_mfma_f32_16x16x32_bf16 v[164:167], a[52:55], v[248:251], v[164:167]
  buffer_load_dwordx4 v58, s[12:15], s5 offen offset:256 lds
  v_mfma_f32_16x16x32_bf16 v[164:167], a[64:67], v[252:255], v[164:167]
  s_add_u32 s5, s44, 184704
  s_add_u32 m0, s46, 28672
  v_mul_f32 v136, s42, v136
  v_mfma_f32_16x16x32_bf16 v[108:111], a[52:55], a[232:235], v[108:111]
  v_mul_f32 v137, s42, v137
  v_mul_f32 v138, s42, v138
  v_mfma_f32_16x16x32_bf16 v[108:111], a[64:67], a[236:239], v[108:111]
  s_waitcnt vmcnt(9)
  s_barrier
  v_mfma_f32_16x16x32_bf16 v[124:127], a[56:59], v[200:203], v[124:127]
  buffer_load_dwordx4 v58, s[12:15], s5 offen offset:0 lds
  v_mfma_f32_16x16x32_bf16 v[124:127], a[68:71], v[204:207], v[124:127]
  s_add_u32 m0, s46, 36736
  ds_read_b64_tr_b16 a[72:73], v57 offset:0
  ds_read_b64_tr_b16 a[74:75], v57 offset:512
  v_mfma_f32_16x16x32_bf16 v[152:155], a[56:59], v[224:227], v[152:155]
  buffer_load_dwordx4 v58, s[12:15], s5 offen offset:128 lds
  v_mfma_f32_16x16x32_bf16 v[152:155], a[68:71], v[228:231], v[152:155]
  s_add_u32 m0, s46, 44800
  ds_read_b64_tr_b16 a[84:85], v57 offset:4096
  ds_read_b64_tr_b16 a[86:87], v57 offset:4608
  v_mfma_f32_16x16x32_bf16 v[100:103], a[56:59], v[248:251], v[100:103]
  buffer_load_dwordx4 v58, s[12:15], s5 offen offset:256 lds
  v_mfma_f32_16x16x32_bf16 v[100:103], a[68:71], v[252:255], v[100:103]
  ds_read_b64_tr_b16 a[76:77], v60 offset:0
  ds_read_b64_tr_b16 a[78:79], v60 offset:512
  v_mfma_f32_16x16x32_bf16 v[112:115], a[56:59], a[232:235], v[112:115]
  ds_read_b64_tr_b16 a[88:89], v60 offset:4096
  ds_read_b64_tr_b16 a[90:91], v60 offset:4608
  v_mfma_f32_16x16x32_bf16 v[112:115], a[68:71], a[236:239], v[112:115]
  s_waitcnt lgkmcnt(6)
  ds_read_b64_tr_b16 a[80:81], v59 offset:0
  ds_read_b64_tr_b16 a[82:83], v59 offset:512
  v_mfma_f32_16x16x32_bf16 v[140:143], a[72:75], v[184:187], 0
  s_waitcnt lgkmcnt(6)
  ds_read_b64_tr_b16 a[92:93], v59 offset:4096
  ds_read_b64_tr_b16 a[94:95], v59 offset:4608
  v_mfma_f32_16x16x32_bf16 v[140:143], a[84:87], v[188:191], v[140:143]
  v_mul_f32 v139, s42, v139
  v_cvt_pk_bf16_f32 v104, v136, v137
  v_mfma_f32_16x16x32_bf16 v[144:147], a[72:75], v[208:211], 0
  v_cvt_pk_bf16_f32 v105, v138, v139
  v_mul_f32 v124, s42, v124
  v_mfma_f32_16x16x32_bf16 v[144:147], a[84:87], v[212:215], v[144:147]
  v_mul_f32 v125, s42, v125
  v_mul_f32 v126, s42, v126
  v_mfma_f32_16x16x32_bf16 v[160:163], a[72:75], v[232:235], 0
  v_mul_f32 v127, s42, v127
  v_cvt_pk_bf16_f32 v106, v124, v125
  v_mfma_f32_16x16x32_bf16 v[160:163], a[84:87], v[236:239], v[160:163]
  s_add_u32 s5, s44, 768
  s_add_u32 m0, s46, 49152
  v_cvt_pk_bf16_f32 v107, v126, v127
  v_mfma_f32_16x16x32_bf16 v[122:125], a[72:75], a[216:219], 0
  v_cvt_pk_bf16_f32 v117, v130, v131
  v_mul_f32 v132, s42, v132
  v_mfma_f32_16x16x32_bf16 v[122:125], a[84:87], a[220:223], v[122:125]
  s_waitcnt lgkmcnt(0)
  v_mul_f32 v133, s42, v133
  v_mul_f32 v134, s42, v134
  v_mfma_f32_16x16x32_bf16 v[148:151], a[76:79], v[184:187], 0
  buffer_load_dwordx4 v58, s[12:15], s5 offen offset:0 lds
  v_mfma_f32_16x16x32_bf16 v[148:151], a[88:91], v[188:191], v[148:151]
  s_add_u32 m0, s46, 57216
  v_mul_f32 v135, s42, v135
  v_cvt_pk_bf16_f32 v118, v132, v133
  v_mfma_f32_16x16x32_bf16 v[128:131], a[76:79], v[208:211], 0
  buffer_load_dwordx4 v58, s[12:15], s5 offen offset:128 lds
  v_mfma_f32_16x16x32_bf16 v[128:131], a[88:91], v[212:215], v[128:131]
  s_add_u32 m0, s46, 65280
  v_cvt_pk_bf16_f32 v119, v134, v135
  v_mul_f32 v152, s42, v152
  v_mfma_f32_16x16x32_bf16 v[180:183], a[76:79], v[232:235], 0
  buffer_load_dwordx4 v58, s[12:15], s5 offen offset:256 lds
  v_mfma_f32_16x16x32_bf16 v[180:183], a[88:91], v[236:239], v[180:183]
  s_add_u32 s5, s44, 37632
  s_add_u32 m0, s46, 53248
  v_mul_f32 v153, s42, v153
  v_mfma_f32_16x16x32_bf16 v[156:159], a[76:79], a[216:219], 0
  v_mul_f32 v154, s42, v154
  v_mul_f32 v155, s42, v155
  v_mfma_f32_16x16x32_bf16 v[156:159], a[88:91], a[220:223], v[156:159]
  s_waitcnt vmcnt(9)
  s_barrier
  v_mfma_f32_16x16x32_bf16 v[96:99], a[80:83], v[184:187], 0
  buffer_load_dwordx4 v58, s[12:15], s5 offen offset:0 lds
  v_mfma_f32_16x16x32_bf16 v[96:99], a[92:95], v[188:191], v[96:99]
  s_add_u32 m0, s46, 61312
  ds_read_b64_tr_b16 a[96:97], v57 offset:24576
  ds_read_b64_tr_b16 a[98:99], v57 offset:25088
  v_mfma_f32_16x16x32_bf16 v[176:179], a[80:83], v[208:211], 0
  buffer_load_dwordx4 v58, s[12:15], s5 offen offset:128 lds
  v_mfma_f32_16x16x32_bf16 v[176:179], a[92:95], v[212:215], v[176:179]
  s_add_u32 m0, s46, 69376
  ds_read_b64_tr_b16 a[108:109], v57 offset:28672
  ds_read_b64_tr_b16 a[110:111], v57 offset:29184
  v_mfma_f32_16x16x32_bf16 v[172:175], a[80:83], v[232:235], 0
  buffer_load_dwordx4 v58, s[12:15], s5 offen offset:256 lds
  v_mfma_f32_16x16x32_bf16 v[172:175], a[92:95], v[236:239], v[172:175]
  ds_read_b64_tr_b16 a[100:101], v60 offset:24576
  ds_read_b64_tr_b16 a[102:103], v60 offset:25088
  v_mfma_f32_16x16x32_bf16 v[136:139], a[80:83], a[216:219], 0
  ds_read_b64_tr_b16 a[112:113], v60 offset:28672
  ds_read_b64_tr_b16 a[114:115], v60 offset:29184
  v_mfma_f32_16x16x32_bf16 v[136:139], a[92:95], a[220:223], v[136:139]
  s_waitcnt lgkmcnt(6)
  ds_read_b64_tr_b16 a[104:105], v59 offset:24576
  ds_read_b64_tr_b16 a[106:107], v59 offset:25088
  v_mfma_f32_16x16x32_bf16 v[140:143], a[96:99], v[192:195], v[140:143]
  s_waitcnt lgkmcnt(6)
  ds_read_b64_tr_b16 a[116:117], v59 offset:28672
  ds_read_b64_tr_b16 a[118:119], v59 offset:29184
  v_mfma_f32_16x16x32_bf16 v[140:143], a[108:111], v[196:199], v[140:143]
  v_cvt_pk_bf16_f32 v16, v152, v153
  v_cvt_pk_bf16_f32 v17, v154, v155
  v_mfma_f32_16x16x32_bf16 v[144:147], a[96:99], v[216:219], v[144:147]
  v_mul_f32 v168, s42, v168
  v_mul_f32 v169, s42, v169
  v_mfma_f32_16x16x32_bf16 v[144:147], a[108:111], v[220:223], v[144:147]
  v_mul_f32 v170, s42, v170
  v_mul_f32 v171, s42, v171
  v_mfma_f32_16x16x32_bf16 v[160:163], a[96:99], v[240:243], v[160:163]
  v_cvt_pk_bf16_f32 v18, v168, v169
  v_cvt_pk_bf16_f32 v19, v170, v171
  v_mfma_f32_16x16x32_bf16 v[160:163], a[108:111], v[244:247], v[160:163]
  s_add_u32 s5, s44, 74496
  s_add_u32 m0, s46, 73728
  v_mul_f32 v164, s42, v164
  v_mfma_f32_16x16x32_bf16 v[122:125], a[96:99], a[224:227], v[122:125]
  v_mul_f32 v165, s42, v165
  v_mul_f32 v166, s42, v166
  v_mfma_f32_16x16x32_bf16 v[122:125], a[108:111], a[228:231], v[122:125]
  s_waitcnt lgkmcnt(0)
  v_mul_f32 v167, s42, v167
  v_cvt_pk_bf16_f32 v152, v164, v165
  v_mfma_f32_16x16x32_bf16 v[148:151], a[100:103], v[192:195], v[148:151]
  buffer_load_dwordx4 v58, s[12:15], s5 offen offset:0 lds
  v_mfma_f32_16x16x32_bf16 v[148:151], a[112:115], v[196:199], v[148:151]
  s_add_u32 m0, s46, 81792
  v_cvt_pk_bf16_f32 v153, v166, v167
  v_mul_f32 v100, s42, v100
  v_mfma_f32_16x16x32_bf16 v[128:131], a[100:103], v[216:219], v[128:131]
  buffer_load_dwordx4 v58, s[12:15], s5 offen offset:128 lds
  v_mfma_f32_16x16x32_bf16 v[128:131], a[112:115], v[220:223], v[128:131]
  s_add_u32 m0, s46, 89856
  v_mul_f32 v101, s42, v101
  v_mul_f32 v102, s42, v102
  v_mfma_f32_16x16x32_bf16 v[180:183], a[100:103], v[240:243], v[180:183]
  buffer_load_dwordx4 v58, s[12:15], s5 offen offset:256 lds
  v_mfma_f32_16x16x32_bf16 v[180:183], a[112:115], v[244:247], v[180:183]
  s_add_u32 s5, s44, 111360
  s_add_u32 m0, s46, 77824
  v_mul_f32 v103, s42, v103
  v_mfma_f32_16x16x32_bf16 v[156:159], a[100:103], a[224:227], v[156:159]
  v_add_f32 v168, v56, v36
  v_add_f32 v169, v56, v37
  v_mfma_f32_16x16x32_bf16 v[156:159], a[112:115], a[228:231], v[156:159]
  s_waitcnt vmcnt(9)
  s_barrier
  v_mfma_f32_16x16x32_bf16 v[96:99], a[104:107], v[192:195], v[96:99]
  buffer_load_dwordx4 v58, s[12:15], s5 offen offset:0 lds
  v_mfma_f32_16x16x32_bf16 v[96:99], a[116:119], v[196:199], v[96:99]
  s_add_u32 m0, s46, 85888
  ds_read_b64_tr_b16 a[120:121], v61 offset:0
  ds_read_b64_tr_b16 a[122:123], v61 offset:512
  v_mfma_f32_16x16x32_bf16 v[176:179], a[104:107], v[216:219], v[176:179]
  buffer_load_dwordx4 v58, s[12:15], s5 offen offset:128 lds
  v_mfma_f32_16x16x32_bf16 v[176:179], a[116:119], v[220:223], v[176:179]
  s_add_u32 m0, s46, 93952
  ds_read_b64_tr_b16 a[132:133], v61 offset:4096
  ds_read_b64_tr_b16 a[134:135], v61 offset:4608
  v_mfma_f32_16x16x32_bf16 v[172:175], a[104:107], v[240:243], v[172:175]
  buffer_load_dwordx4 v58, s[12:15], s5 offen offset:256 lds
  v_mfma_f32_16x16x32_bf16 v[172:175], a[116:119], v[244:247], v[172:175]
  ds_read_b64_tr_b16 a[124:125], v62 offset:0
  ds_read_b64_tr_b16 a[126:127], v62 offset:512
  v_mfma_f32_16x16x32_bf16 v[136:139], a[104:107], a[224:227], v[136:139]
  ds_read_b64_tr_b16 a[136:137], v62 offset:4096
  ds_read_b64_tr_b16 a[138:139], v62 offset:4608
  v_mfma_f32_16x16x32_bf16 v[136:139], a[116:119], a[228:231], v[136:139]
  s_waitcnt lgkmcnt(6)
  ds_read_b64_tr_b16 a[128:129], v63 offset:0
  ds_read_b64_tr_b16 a[130:131], v63 offset:512
  v_mfma_f32_16x16x32_bf16 v[140:143], a[120:123], v[200:203], v[140:143]
  s_waitcnt lgkmcnt(6)
  ds_read_b64_tr_b16 a[140:141], v63 offset:4096
  ds_read_b64_tr_b16 a[142:143], v63 offset:4608
  v_mfma_f32_16x16x32_bf16 v[140:143], a[132:135], v[204:207], v[140:143]
  v_add_f32 v170, v56, v38
  v_add_f32 v171, v56, v39
  v_mfma_f32_16x16x32_bf16 v[144:147], a[120:123], v[224:227], v[144:147]
  v_add_f32 v132, v56, v32
  v_add_f32 v133, v56, v33
  v_mfma_f32_16x16x32_bf16 v[144:147], a[132:135], v[228:231], v[144:147]
  v_add_f32 v134, v56, v34
  v_add_f32 v135, v56, v35
  v_mfma_f32_16x16x32_bf16 v[160:163], a[120:123], v[248:251], v[160:163]
  v_cvt_pk_bf16_f32 v120, v140, v141
  v_cvt_pk_bf16_f32 v121, v142, v143
  v_mfma_f32_16x16x32_bf16 v[160:163], a[132:135], v[252:255], v[160:163]
  s_add_u32 s5, s44, 148224
  s_add_u32 m0, s46, 98304
  v_add_f32 v164, v56, v40
  v_mfma_f32_16x16x32_bf16 v[122:125], a[120:123], a[232:235], v[122:125]
  v_cvt_pk_bf16_f32 v140, v144, v145
  v_cvt_pk_bf16_f32 v141, v146, v147
  v_mfma_f32_16x16x32_bf16 v[122:125], a[132:135], a[236:239], v[122:125]
  s_waitcnt lgkmcnt(0)
  v_add_f32 v165, v56, v41
  v_add_f32 v166, v56, v42
  v_mfma_f32_16x16x32_bf16 v[148:151], a[124:127], v[200:203], v[148:151]
  buffer_load_dwordx4 v58, s[12:15], s5 offen offset:0 lds
  v_mfma_f32_16x16x32_bf16 v[148:151], a[136:139], v[204:207], v[148:151]
  s_add_u32 m0, s46, 106368
  v_cvt_pk_bf16_f32 v146, v160, v161
  v_cvt_pk_bf16_f32 v147, v162, v163
  v_mfma_f32_16x16x32_bf16 v[128:131], a[124:127], v[224:227], v[128:131]
  buffer_load_dwordx4 v58, s[12:15], s5 offen offset:128 lds
  v_mfma_f32_16x16x32_bf16 v[128:131], a[136:139], v[228:231], v[128:131]
  s_add_u32 m0, s46, 114432
  v_cvt_pk_bf16_f32 v126, v122, v123
  v_cvt_pk_bf16_f32 v127, v124, v125
  v_mfma_f32_16x16x32_bf16 v[180:183], a[124:127], v[248:251], v[180:183]
  buffer_load_dwordx4 v58, s[12:15], s5 offen offset:256 lds
  v_mfma_f32_16x16x32_bf16 v[180:183], a[136:139], v[252:255], v[180:183]
  s_add_u32 s5, s44, 185088
  s_add_u32 m0, s46, 102400
  v_cvt_pk_bf16_f32 v122, v148, v149
  v_mfma_f32_16x16x32_bf16 v[156:159], a[124:127], a[232:235], v[156:159]
  v_cvt_pk_bf16_f32 v123, v150, v151
  v_cvt_pk_bf16_f32 v142, v128, v129
  v_mfma_f32_16x16x32_bf16 v[156:159], a[136:139], a[236:239], v[156:159]
  v_cvt_pk_bf16_f32 v143, v130, v131
  v_add_f32 v167, v56, v43
  v_mfma_f32_16x16x32_bf16 v[96:99], a[128:131], v[200:203], v[96:99]
  buffer_load_dwordx4 v58, s[12:15], s5 offen offset:0 lds
  v_mfma_f32_16x16x32_bf16 v[96:99], a[140:143], v[204:207], v[96:99]
  s_add_u32 m0, s46, 110464
  v_cvt_pk_bf16_f32 v148, v180, v181
  v_cvt_pk_bf16_f32 v149, v182, v183
  v_mfma_f32_16x16x32_bf16 v[176:179], a[128:131], v[224:227], v[176:179]
  buffer_load_dwordx4 v58, s[12:15], s5 offen offset:128 lds
  v_mfma_f32_16x16x32_bf16 v[176:179], a[140:143], v[228:231], v[176:179]
  s_add_u32 m0, s46, 118528
  v_cvt_pk_bf16_f32 v128, v156, v157
  v_cvt_pk_bf16_f32 v129, v158, v159
  v_mfma_f32_16x16x32_bf16 v[172:175], a[128:131], v[248:251], v[172:175]
  buffer_load_dwordx4 v58, s[12:15], s5 offen offset:256 lds
  v_mfma_f32_16x16x32_bf16 v[172:175], a[140:143], v[252:255], v[172:175]
  v_cvt_pk_bf16_f32 v124, v96, v97
  v_cvt_pk_bf16_f32 v125, v98, v99
  v_mfma_f32_16x16x32_bf16 v[136:139], a[128:131], a[232:235], v[136:139]
  v_cvt_pk_bf16_f32 v144, v176, v177
  v_cvt_pk_bf16_f32 v145, v178, v179
  v_mfma_f32_16x16x32_bf16 v[136:139], a[140:143], a[236:239], v[136:139]
  v_cvt_pk_bf16_f32 v154, v100, v101
  v_cvt_pk_bf16_f32 v155, v102, v103
  v_mfma_f32_16x16x32_bf16 v[96:99], v[122:125], v[104:107], v[168:171]
  v_cvt_pk_bf16_f32 v150, v172, v173
  v_cvt_pk_bf16_f32 v151, v174, v175
  v_mfma_f32_16x16x32_bf16 v[96:99], v[120:123], v[12:15], v[96:99]
  v_mul_f32 v92, s42, v92
  v_mul_f32 v93, s42, v93
  v_mfma_f32_16x16x32_bf16 v[100:103], v[142:145], v[104:107], v[132:135]
L_hop_0_0:
  s_cbranch_execz L_hop_0_1
  v_cvt_pk_bf16_f32 v130, v136, v137
  v_cvt_pk_bf16_f32 v131, v138, v139
  v_mfma_f32_16x16x32_bf16 v[100:103], v[140:143], v[12:15], v[100:103]
  v_mul_f32 v94, s42, v94
  v_mul_f32 v95, s42, v95
  v_mfma_f32_16x16x32_bf16 v[172:175], v[148:151], v[104:107], v[80:83]
  v_cvt_pk_bf16_f32 v176, v92, v93
  v_cvt_pk_bf16_f32 v177, v94, v95
  v_mfma_f32_16x16x32_bf16 v[172:175], v[146:149], v[12:15], v[172:175]
  v_mul_f32 v108, s42, v108
  v_mul_f32 v109, s42, v109
  v_mfma_f32_16x16x32_bf16 v[180:183], v[128:131], v[104:107], v[88:91]
  v_mul_f32 v110, s42, v110
  v_mul_f32 v111, s42, v111
  v_mfma_f32_16x16x32_bf16 v[180:183], v[126:129], v[12:15], v[180:183]
  v_cvt_pk_bf16_f32 v178, v108, v109
  v_cvt_pk_bf16_f32 v179, v110, v111
  v_mfma_f32_16x16x32_bf16 v[104:107], v[120:123], v[116:119], v[164:167]
  v_mul_f32 v112, s42, v112
  v_mul_f32 v113, s42, v113
  v_mfma_f32_16x16x32_bf16 v[104:107], v[122:125], v[14:17], v[104:107]
  v_mul_f32 v114, s42, v114
  v_mul_f32 v115, s42, v115
  v_mfma_f32_16x16x32_bf16 v[108:111], v[140:143], v[116:119], v[168:171]
  v_cvt_pk_bf16_f32 v22, v112, v113
  v_cvt_pk_bf16_f32 v23, v114, v115
  v_mfma_f32_16x16x32_bf16 v[108:111], v[142:145], v[14:17], v[108:111]
  v_exp_f32 v96, v96
  v_mfma_f32_16x16x32_bf16 v[156:159], v[146:149], v[116:119], v[84:87]
  s_add_u32 m0, s28, 0
  v_exp_f32 v97, v97
  v_mfma_f32_16x16x32_bf16 v[156:159], v[148:151], v[14:17], v[156:159]
  v_exp_f32 v98, v98
  v_mfma_f32_16x16x32_bf16 v[160:163], v[126:129], v[116:119], v[80:83]
  s_waitcnt vmcnt(6)
  s_barrier
  v_mfma_f32_16x16x32_bf16 v[160:163], v[128:131], v[14:17], v[160:163]
  buffer_load_dwordx4 v6, s[8:11], s31 offen offset:0 nt lds
  v_mfma_f32_16x16x32_bf16 v[80:83], v[122:125], v[152:155], v[64:67]
  s_add_u32 m0, s28, 8064
  ds_read_b64_tr_b16 a[144:145], v61 offset:24576
  ds_read_b64_tr_b16 a[146:147], v61 offset:25088
  v_mfma_f32_16x16x32_bf16 v[80:83], v[120:123], v[18:21], v[80:83]
  ds_read_b64_tr_b16 a[156:157], v61 offset:28672
  ds_read_b64_tr_b16 a[158:159], v61 offset:29184
  v_mfma_f32_16x16x32_bf16 v[84:87], v[142:145], v[152:155], v[76:79]
  buffer_load_dwordx4 v6, s[8:11], s31 offen offset:128 nt lds
  v_mfma_f32_16x16x32_bf16 v[84:87], v[140:143], v[18:21], v[84:87]
  s_add_u32 m0, s28, 16128
  ds_read_b64_tr_b16 a[148:149], v62 offset:24576
  ds_read_b64_tr_b16 a[150:151], v62 offset:25088
  v_mfma_f32_16x16x32_bf16 v[112:115], v[148:151], v[152:155], v[168:171]
  ds_read_b64_tr_b16 a[160:161], v62 offset:28672
  ds_read_b64_tr_b16 a[162:163], v62 offset:29184
  v_mfma_f32_16x16x32_bf16 v[112:115], v[146:149], v[18:21], v[112:115]
  buffer_load_dwordx4 v6, s[8:11], s31 offen offset:256 nt lds
  v_mfma_f32_16x16x32_bf16 v[136:139], v[128:131], v[152:155], v[132:135]
  s_add_u32 s31, s31, s43
  ds_read_b64_tr_b16 a[152:153], v63 offset:24576
  ds_read_b64_tr_b16 a[154:155], v63 offset:25088
  v_mfma_f32_16x16x32_bf16 v[136:139], v[126:129], v[18:21], v[136:139]
  ds_read_b64_tr_b16 a[164:165], v63 offset:28672
  ds_read_b64_tr_b16 a[166:167], v63 offset:29184
  v_mfma_f32_16x16x32_bf16 v[88:91], v[120:123], v[176:179], v[72:75]
  ds_read_b64_tr_b16 a[168:169], v61 offset:49152
  ds_read_b64_tr_b16 a[170:171], v61 offset:49664
  v_mfma_f32_16x16x32_bf16 v[88:91], v[122:125], v[20:23], v[88:91]
  ds_read_b64_tr_b16 a[180:181], v61 offset:53248
  ds_read_b64_tr_b16 a[182:183], v61 offset:53760
  v_mfma_f32_16x16x32_bf16 v[92:95], v[140:143], v[176:179], v[64:67]
  ds_read_b64_tr_b16 a[172:173], v62 offset:49152
  ds_read_b64_tr_b16 a[174:175], v62 offset:49664
  v_mfma_f32_16x16x32_bf16 v[92:95], v[142:145], v[20:23], v[92:95]
  ds_read_b64_tr_b16 a[184:185], v62 offset:53248
  ds_read_b64_tr_b16 a[186:187], v62 offset:53760
  v_mfma_f32_16x16x32_bf16 v[152:155], v[146:149], v[176:179], v[164:167]
  ds_read_b64_tr_b16 a[176:177], v63 offset:49152
  ds_read_b64_tr_b16 a[178:179], v63 offset:49664
  v_mfma_f32_16x16x32_bf16 v[152:155], v[148:151], v[20:23], v[152:155]
  ds_read_b64_tr_b16 a[188:189], v63 offset:53248
  ds_read_b64_tr_b16 a[190:191], v63 offset:53760
  v_mfma_f32_16x16x32_bf16 v[164:167], v[126:129], v[176:179], v[168:171]
  v_exp_f32 v99, v99
  v_mfma_f32_16x16x32_bf16 v[164:167], v[128:131], v[20:23], v[164:167]
  s_waitcnt lgkmcnt(6)
  v_exp_f32 v100, v100
  v_mfma_f32_16x16x32_bf16 v[116:119], v[184:187], a[144:147], 0
  v_exp_f32 v101, v101
  v_mfma_f32_16x16x32_bf16 v[116:119], v[188:191], a[156:159], v[116:119]
  v_exp_f32 v102, v102
  v_mfma_f32_16x16x32_bf16 v[72:75], v[184:187], a[148:151], 0
  v_exp_f32 v103, v103
  v_mfma_f32_16x16x32_bf16 v[72:75], v[188:191], a[160:163], v[72:75]
  v_exp_f32 v172, v172
  v_mfma_f32_16x16x32_bf16 v[128:131], v[184:187], a[152:155], 0
  v_exp_f32 v173, v173
  v_mfma_f32_16x16x32_bf16 v[128:131], v[188:191], a[164:167], v[128:131]
  v_exp_f32 v174, v174
  v_mfma_f32_16x16x32_bf16 v[132:135], v[208:211], a[144:147], 0
  v_exp_f32 v175, v175
  v_mfma_f32_16x16x32_bf16 v[132:135], v[212:215], a[156:159], v[132:135]
  v_exp_f32 v180, v180
  v_mfma_f32_16x16x32_bf16 v[124:127], v[208:211], a[148:151], 0
  v_exp_f32 v181, v181
  v_mfma_f32_16x16x32_bf16 v[124:127], v[212:215], a[160:163], v[124:127]
  v_exp_f32 v182, v182
  v_mfma_f32_16x16x32_bf16 v[120:123], v[208:211], a[152:155], 0
  v_exp_f32 v183, v183
  v_mfma_f32_16x16x32_bf16 v[120:123], v[212:215], a[164:167], v[120:123]
  v_cvt_pk_bf16_f32 v96, v96, v97
  v_cvt_pk_bf16_f32 v97, v98, v99
  v_mfma_f32_16x16x32_bf16 v[116:119], v[192:195], a[168:171], v[116:119]
  v_cvt_pk_bf16_f32 v98, v100, v101
  v_cvt_pk_bf16_f32 v99, v102, v103
  v_mfma_f32_16x16x32_bf16 v[116:119], v[196:199], a[180:183], v[116:119]
  v_cvt_pk_bf16_f32 v100, v172, v173
  v_cvt_pk_bf16_f32 v101, v174, v175
  v_mfma_f32_16x16x32_bf16 v[72:75], v[192:195], a[172:175], v[72:75]
  s_waitcnt lgkmcnt(0)
  v_cvt_pk_bf16_f32 v102, v180, v181
  v_cvt_pk_bf16_f32 v103, v182, v183
  v_mfma_f32_16x16x32_bf16 v[72:75], v[196:199], a[184:187], v[72:75]
  s_waitcnt vmcnt(3)
  s_barrier
  v_mfma_f32_16x16x32_bf16 v[128:131], v[192:195], a[176:179], v[128:131]
  ds_read_b64_tr_b16 a[192:193], v57 offset:0
  ds_read_b64_tr_b16 a[194:195], v57 offset:512
  v_mfma_f32_16x16x32_bf16 v[128:131], v[196:199], a[188:191], v[128:131]
  ds_read_b64_tr_b16 a[204:205], v57 offset:4096
  ds_read_b64_tr_b16 a[206:207], v57 offset:4608
  v_mfma_f32_16x16x32_bf16 v[132:135], v[216:219], a[168:171], v[132:135]
  ds_read_b64_tr_b16 a[196:197], v60 offset:0
  ds_read_b64_tr_b16 a[198:199], v60 offset:512
  v_mfma_f32_16x16x32_bf16 v[132:135], v[220:223], a[180:183], v[132:135]
  ds_read_b64_tr_b16 a[208:209], v60 offset:4096
  ds_read_b64_tr_b16 a[210:211], v60 offset:4608
  v_mfma_f32_16x16x32_bf16 v[124:127], v[216:219], a[172:175], v[124:127]
  s_add_u32 s5, s45, 0
  s_add_u32 m0, s46, 122880
  ds_read_b64_tr_b16 a[200:201], v59 offset:0
  v_mfma_f32_16x16x32_bf16 v[124:127], v[220:223], a[184:187], v[124:127]
  ds_read_b64_tr_b16 a[202:203], v59 offset:512
  ds_read_b64_tr_b16 a[212:213], v59 offset:4096
  v_mfma_f32_16x16x32_bf16 v[120:123], v[216:219], a[176:179], v[120:123]
  s_waitcnt lgkmcnt(5)
  ds_read_b64_tr_b16 a[214:215], v59 offset:4608
  v_add_u32 v0, s28, v2
  v_mfma_f32_16x16x32_bf16 v[120:123], v[220:223], a[188:191], v[120:123]
  buffer_load_dwordx4 v69, s[16:19], s5 offen offset:0 lds
  v_mfma_f32_16x16x32_bf16 v[116:119], v[200:203], a[192:195], v[116:119]
  s_add_u32 m0, s46, 130944
  v_exp_f32 v104, v104
  v_mfma_f32_16x16x32_bf16 v[116:119], v[204:207], a[204:207], v[116:119]
  s_waitcnt lgkmcnt(1)
  v_exp_f32 v105, v105
  v_mfma_f32_16x16x32_bf16 v[72:75], v[200:203], a[196:199], v[72:75]
  buffer_load_dwordx4 v69, s[16:19], s5 offen offset:128 lds
  v_mfma_f32_16x16x32_bf16 v[72:75], v[204:207], a[208:211], v[72:75]
  s_add_u32 m0, s46, 139008
  v_exp_f32 v106, v106
  v_mfma_f32_16x16x32_bf16 v[128:131], v[200:203], a[200:203], v[128:131]
  s_waitcnt lgkmcnt(0)
  v_cvt_pk_bf16_f32 v172, v116, v117
  v_cvt_pk_bf16_f32 v173, v118, v119
  v_mfma_f32_16x16x32_bf16 v[128:131], v[204:207], a[212:215], v[128:131]
  buffer_load_dwordx4 v69, s[16:19], s5 offen offset:256 lds
  v_mfma_f32_16x16x32_bf16 v[132:135], v[224:227], a[192:195], v[132:135]
  s_add_u32 s5, s45, 12288
  v_cvt_pk_bf16_f32 v76, v72, v73
  v_cvt_pk_bf16_f32 v77, v74, v75
  v_mfma_f32_16x16x32_bf16 v[132:135], v[228:231], a[204:207], v[132:135]
  s_add_u32 m0, s46, 126976
  v_exp_f32 v107, v107
  v_mfma_f32_16x16x32_bf16 v[124:127], v[224:227], a[196:199], v[124:127]
  buffer_load_dwordx4 v69, s[16:19], s5 offen offset:0 lds
  v_mfma_f32_16x16x32_bf16 v[124:127], v[228:231], a[208:211], v[124:127]
  s_add_u32 m0, s46, 135040
  v_cvt_pk_bf16_f32 v56, v128, v129
  v_cvt_pk_bf16_f32 v57, v130, v131
  v_mfma_f32_16x16x32_bf16 v[120:123], v[224:227], a[200:203], v[120:123]
  v_cvt_pk_bf16_f32 v174, v132, v133
  v_cvt_pk_bf16_f32 v175, v134, v135
  v_mfma_f32_16x16x32_bf16 v[120:123], v[228:231], a[212:215], v[120:123]
  buffer_load_dwordx4 v69, s[16:19], s5 offen offset:128 lds
  v_mfma_f32_16x16x32_bf16 v[60:63], v[232:235], a[144:147], 0
  s_add_u32 m0, s46, 143104
  v_cvt_pk_bf16_f32 v78, v124, v125
  v_cvt_pk_bf16_f32 v79, v126, v127
  v_mfma_f32_16x16x32_bf16 v[60:63], v[236:239], a[156:159], v[60:63]
  v_exp_f32 v108, v108
  v_mfma_f32_16x16x32_bf16 v[60:63], v[240:243], a[168:171], v[60:63]
  buffer_load_dwordx4 v69, s[16:19], s5 offen offset:256 lds
  v_mfma_f32_16x16x32_bf16 v[60:63], v[244:247], a[180:183], v[60:63]
  v_cvt_pk_bf16_f32 v58, v120, v121
  v_cvt_pk_bf16_f32 v59, v122, v123
  v_mfma_f32_16x16x32_bf16 v[60:63], v[248:251], a[192:195], v[60:63]
  v_exp_f32 v109, v109
  v_mfma_f32_16x16x32_bf16 v[60:63], v[252:255], a[204:207], v[60:63]
  v_exp_f32 v110, v110
  v_mfma_f32_16x16x32_bf16 v[124:127], v[232:235], a[148:151], 0
  v_exp_f32 v111, v111
  v_mfma_f32_16x16x32_bf16 v[124:127], v[236:239], a[160:163], v[124:127]
  v_exp_f32 v156, v156
  v_mfma_f32_16x16x32_bf16 v[124:127], v[240:243], a[172:175], v[124:127]
  v_cvt_pk_bf16_f32 v116, v60, v61
  v_cvt_pk_bf16_f32 v117, v62, v63
  v_mfma_f32_16x16x32_bf16 v[124:127], v[244:247], a[184:187], v[124:127]
  v_exp_f32 v157, v157
  v_mfma_f32_16x16x32_bf16 v[124:127], v[248:251], a[196:199], v[124:127]
  v_exp_f32 v158, v158
  v_mfma_f32_16x16x32_bf16 v[124:127], v[252:255], a[208:211], v[124:127]
  v_exp_f32 v159, v159
  v_mfma_f32_16x16x32_bf16 v[60:63], v[232:235], a[152:155], 0
  v_exp_f32 v160, v160
  v_mfma_f32_16x16x32_bf16 v[60:63], v[236:239], a[164:167], v[60:63]
  v_exp_f32 v161, v161
  v_mfma_f32_16x16x32_bf16 v[60:63], v[240:243], a[176:179], v[60:63]
  v_cvt_pk_bf16_f32 v70, v124, v125
  v_cvt_pk_bf16_f32 v71, v126, v127
  v_cvt_pk_bf16_f32 v104, v104, v105
  v_mfma_f32_16x16x32_bf16 v[60:63], v[244:247], a[188:191], v[60:63]
  v_exp_f32 v162, v162
  v_cvt_pk_bf16_f32 v105, v106, v107
  v_mfma_f32_16x16x32_bf16 v[60:63], v[248:251], a[200:203], v[60:63]
  v_exp_f32 v163, v163
  v_cvt_pk_bf16_f32 v106, v108, v109
  v_mfma_f32_16x16x32_bf16 v[60:63], v[252:255], a[212:215], v[60:63]
  v_cvt_pk_bf16_f32 v107, v110, v111
  v_cvt_pk_bf16_f32 v108, v156, v157
  v_cvt_pk_bf16_f32 v109, v158, v159
  v_mfma_f32_16x16x32_bf16 v[124:127], a[216:219], a[144:147], 0
  v_cvt_pk_bf16_f32 v110, v160, v161
  v_cvt_pk_bf16_f32 v111, v162, v163
  v_xor_b32 v1, 64, v0
  v_mfma_f32_16x16x32_bf16 v[124:127], a[220:223], a[156:159], v[124:127]
  s_add_u32 s5, s45, 24576
  s_add_u32 m0, s46, 0
  v_exp_f32 v80, v80
  v_mfma_f32_16x16x32_bf16 v[124:127], a[224:227], a[168:171], v[124:127]
  v_cvt_pk_bf16_f32 v120, v60, v61
  v_cvt_pk_bf16_f32 v121, v62, v63
  v_mfma_f32_16x16x32_bf16 v[124:127], a[228:231], a[180:183], v[124:127]
  v_exp_f32 v81, v81
  v_mfma_f32_16x16x32_bf16 v[124:127], a[232:235], a[192:195], v[124:127]
  buffer_load_dwordx4 v69, s[16:19], s5 offen offset:0 lds
  v_cvt_pk_bf16_f32 v80, v80, v81
  v_mfma_f32_16x16x32_bf16 v[124:127], a[236:239], a[204:207], v[124:127]
  s_add_u32 m0, s46, 8064
  v_exp_f32 v82, v82
  v_mfma_f32_16x16x32_bf16 v[128:131], a[216:219], a[148:151], 0
  v_exp_f32 v83, v83
  v_mfma_f32_16x16x32_bf16 v[128:131], a[220:223], a[160:163], v[128:131]
  buffer_load_dwordx4 v69, s[16:19], s5 offen offset:128 lds
  v_cvt_pk_bf16_f32 v81, v82, v83
  v_mfma_f32_16x16x32_bf16 v[128:131], a[224:227], a[172:175], v[128:131]
  s_add_u32 m0, s46, 16128
  v_cvt_pk_bf16_f32 v118, v124, v125
  v_cvt_pk_bf16_f32 v119, v126, v127
  v_mfma_f32_16x16x32_bf16 v[128:131], a[228:231], a[184:187], v[128:131]
  v_exp_f32 v84, v84
  v_mfma_f32_16x16x32_bf16 v[128:131], a[232:235], a[196:199], v[128:131]
  buffer_load_dwordx4 v69, s[16:19], s5 offen offset:256 lds
  v_mov_b64 v[124:125], 0
  v_mfma_f32_16x16x32_bf16 v[128:131], a[236:239], a[208:211], v[128:131]
  s_add_u32 s5, s45, 36864
  s_add_u32 m0, s46, 4096
  v_exp_f32 v85, v85
  v_mfma_f32_16x16x32_bf16 v[132:135], a[216:219], a[152:155], 0
  v_exp_f32 v86, v86
  v_cvt_pk_bf16_f32 v82, v84, v85
  v_mfma_f32_16x16x32_bf16 v[132:135], a[220:223], a[164:167], v[132:135]
  buffer_load_dwordx4 v69, s[16:19], s5 offen offset:0 lds
  v_mfma_f32_16x16x32_bf16 v[132:135], a[224:227], a[176:179], v[132:135]
  s_add_u32 m0, s46, 12160
  v_cvt_pk_bf16_f32 v72, v128, v129
  v_cvt_pk_bf16_f32 v73, v130, v131
  v_mfma_f32_16x16x32_bf16 v[132:135], a[228:231], a[188:191], v[132:135]
  v_exp_f32 v87, v87
  v_mfma_f32_16x16x32_bf16 v[132:135], a[232:235], a[200:203], v[132:135]
  buffer_load_dwordx4 v69, s[16:19], s5 offen offset:128 lds
  v_cvt_pk_bf16_f32 v83, v86, v87
  v_mfma_f32_16x16x32_bf16 v[132:135], a[236:239], a[212:215], v[132:135]
  s_add_u32 m0, s46, 20224
  v_mov_b64 v[128:129], 0
  v_exp_f32 v112, v112
  v_smfmac_f32_16x16x64_bf16 v[124:127], a[240:243], v[96:103], v10
  v_exp_f32 v113, v113
  v_mfma_f32_16x16x32_bf16 v[160:163], v[116:119], v[100:103], 0
  buffer_load_dwordx4 v69, s[16:19], s5 offen offset:256 lds
  v_cvt_pk_bf16_f32 v84, v112, v113
  v_mfma_f32_16x16x32_bf16 v[160:163], v[172:175], v[96:99], v[160:163]
  v_cvt_pk_bf16_f32 v122, v132, v133
  v_cvt_pk_bf16_f32 v123, v134, v135
  v_mfma_f32_16x16x32_bf16 v[156:159], v[76:79], v[96:99], 0
  v_exp_f32 v114, v114
  v_mfma_f32_16x16x32_bf16 v[156:159], v[70:73], v[100:103], v[156:159]
  v_exp_f32 v115, v115
  v_mfma_f32_16x16x32_bf16 v[64:67], v[120:123], v[100:103], 0
  v_exp_f32 v136, v136
  v_cvt_pk_bf16_f32 v85, v114, v115
  v_mfma_f32_16x16x32_bf16 v[64:67], v[56:59], v[96:99], v[64:67]
  v_exp_f32 v137, v137
  v_mov_b64 v[148:149], 0
  v_smfmac_f32_16x16x64_bf16 v[128:131], a[240:243], v[104:111], v10
  v_exp_f32 v138, v138
  v_cvt_pk_bf16_f32 v86, v136, v137
  v_mfma_f32_16x16x32_bf16 v[180:183], v[116:119], v[108:111], 0
  v_exp_f32 v139, v139
  v_add_f32 v124, v124, v125
  v_mfma_f32_16x16x32_bf16 v[180:183], v[172:175], v[104:107], v[180:183]
  v_cvt_pk_bf16_f32 v87, v138, v139
  v_exp_f32 v88, v88
  v_mfma_f32_16x16x32_bf16 v[176:179], v[76:79], v[104:107], 0
  v_exp_f32 v89, v89
  v_mfma_f32_16x16x32_bf16 v[176:179], v[70:73], v[108:111], v[176:179]
  v_exp_f32 v90, v90
  v_cvt_pk_bf16_f32 v88, v88, v89
  v_mfma_f32_16x16x32_bf16 v[140:143], v[120:123], v[108:111], 0
  v_exp_f32 v91, v91
  v_add_f32 v128, v128, v129
  v_mfma_f32_16x16x32_bf16 v[140:143], v[56:59], v[104:107], v[140:143]
  v_exp_f32 v92, v92
  v_cvt_pk_bf16_f32 v89, v90, v91
  v_smfmac_f32_16x16x64_bf16 v[148:151], a[240:243], v[80:87], v10
  v_exp_f32 v93, v93
  v_exp_f32 v94, v94
  v_exp_f32 v95, v95
  v_exp_f32 v152, v152
  v_exp_f32 v153, v153
  v_exp_f32 v154, v154
  v_exp_f32 v155, v155
  v_exp_f32 v164, v164
  v_exp_f32 v165, v165
  v_exp_f32 v166, v166
  v_exp_f32 v167, v167
  v_mfma_f32_16x16x32_bf16 v[132:135], v[116:119], v[84:87], 0
  s_add_u32 s5, s45, 49152
  v_cvt_pk_bf16_f32 v90, v92, v93
  v_cvt_pk_bf16_f32 v91, v94, v95
  v_cvt_pk_bf16_f32 v92, v152, v153
  v_cvt_pk_bf16_f32 v93, v154, v155
  v_cvt_pk_bf16_f32 v94, v164, v165
  v_cvt_pk_bf16_f32 v95, v166, v167
  v_mfma_f32_16x16x32_bf16 v[132:135], v[172:175], v[80:83], v[132:135]
  s_waitcnt vmcnt(6) lgkmcnt(0)
  s_barrier
  v_mfma_f32_16x16x32_bf16 v[112:115], v[76:79], v[80:83], 0
  s_add_u32 m0, s46, 98304
  ds_read_b128 v[168:171], v0 offset:0
  v_mov_b64 v[104:105], 0
  v_mfma_f32_16x16x32_bf16 v[112:115], v[70:73], v[84:87], v[112:115]
  buffer_load_dwordx4 v69, s[16:19], s5 offen offset:0 lds
  v_mfma_f32_16x16x32_bf16 v[108:111], v[120:123], v[84:87], 0
  s_add_u32 m0, s46, 106368
  ds_read_b128 v[60:63], v1 offset:0
  ds_read_b128 v[150:153], v0 offset:8192
  v_mfma_f32_16x16x32_bf16 v[108:111], v[56:59], v[80:83], v[108:111]
  ds_read_b128 v[136:139], v1 offset:8192
  ds_read_b128 a[248:251], v0 offset:16384
  v_smfmac_f32_16x16x64_bf16 v[104:107], a[240:243], v[88:95], v10
  buffer_load_dwordx4 v69, s[16:19], s5 offen offset:128 lds
  v_mfma_f32_16x16x32_bf16 v[144:147], v[116:119], v[92:95], 0
  s_add_u32 m0, s46, 114432
  ds_read_b128 v[164:167], v1 offset:16384
  ds_read2st64_b32 v[96:97], v68 offset0:0 offset1:2
  v_mfma_f32_16x16x32_bf16 v[144:147], v[172:175], v[88:91], v[144:147]
  ds_read2st64_b32 v[84:85], v11 offset0:0 offset1:2
  ds_read2st64_b32 v[98:99], v68 offset0:4 offset1:6
  v_mfma_f32_16x16x32_bf16 v[116:119], v[76:79], v[88:91], 0
  buffer_load_dwordx4 v69, s[16:19], s5 offen offset:256 lds
  v_mfma_f32_16x16x32_bf16 v[116:119], v[70:73], v[92:95], v[116:119]
  s_add_u32 s5, s45, 61440
  s_add_u32 m0, s46, 102400
  ds_read2st64_b32 v[86:87], v11 offset0:4 offset1:6
  v_mfma_f32_16x16x32_bf16 v[100:103], v[120:123], v[92:95], 0
  s_waitcnt lgkmcnt(3)
  ds_read2st64_b32 v[76:77], v54 offset0:0 offset1:2
  ds_read2st64_b32 v[80:81], v55 offset0:0 offset1:2
  v_mfma_f32_16x16x32_bf16 v[100:103], v[56:59], v[88:91], v[100:103]
  buffer_load_dwordx4 v69, s[16:19], s5 offen offset:0 lds
  v_mfma_f32_16x16x32_bf16 v[72:75], a[0:3], v[168:171], 0
  s_add_u32 m0, s46, 110464
  ds_read2st64_b32 v[78:79], v54 offset0:4 offset1:6
  ds_read2st64_b32 v[82:83], v55 offset0:4 offset1:6
  v_mfma_f32_16x16x32_bf16 v[72:75], a[12:15], v[60:63], v[72:75]
  v_rcp_f32 v126, v124
  v_mfma_f32_16x16x32_bf16 v[72:75], a[24:27], v[150:153], v[72:75]
  buffer_load_dwordx4 v69, s[16:19], s5 offen offset:128 lds
  v_mfma_f32_16x16x32_bf16 v[72:75], a[36:39], v[136:139], v[72:75]
  s_add_u32 m0, s46, 118528
  v_mul_f32 v160, v126, v160
  v_mul_f32 v161, v126, v161
  v_mfma_f32_16x16x32_bf16 v[72:75], a[48:51], a[248:251], v[72:75]
  s_waitcnt lgkmcnt(4)
  v_perm_b32 v184, v84, v96, s58
  v_perm_b32 v188, v84, v96, s59
  v_mfma_f32_16x16x32_bf16 v[72:75], a[60:63], v[164:167], v[72:75]
  buffer_load_dwordx4 v69, s[16:19], s5 offen offset:256 lds
  v_mfma_f32_16x16x32_bf16 v[88:91], a[64:67], v[164:167], 0
  s_waitcnt lgkmcnt(0)
  v_perm_b32 v185, v85, v97, s58
  v_perm_b32 v189, v85, v97, s59
  v_mfma_f32_16x16x32_bf16 v[88:91], a[52:55], a[248:251], v[88:91]
  s_add_u32 m0, s28, 4096
  v_perm_b32 v186, v86, v98, s58
  v_perm_b32 v190, v86, v98, s59
  v_mfma_f32_16x16x32_bf16 v[88:91], a[40:43], v[136:139], v[88:91]
  s_mov_b32 s5, s28
  v_mul_f32 v72, s42, v72
  v_mul_f32 v73, s42, v73
  v_mfma_f32_16x16x32_bf16 v[88:91], a[28:31], v[150:153], v[88:91]
  v_mul_f32 v74, s42, v74
  v_mul_f32 v75, s42, v75
  v_mfma_f32_16x16x32_bf16 v[88:91], a[16:19], v[60:63], v[88:91]
  buffer_load_dwordx4 v6, s[8:11], s32 offen offset:0 nt lds
  v_mfma_f32_16x16x32_bf16 v[88:91], a[4:7], v[168:171], v[88:91]
  s_add_u32 m0, s28, 12160
  v_cvt_pk_bf16_f32 v12, v72, v73
  v_cvt_pk_bf16_f32 v13, v74, v75
  v_mfma_f32_16x16x32_bf16 v[56:59], a[8:11], v[168:171], 0
  v_perm_b32 v187, v87, v99, s58
  v_perm_b32 v191, v87, v99, s59
  v_perm_b32 v192, v80, v76, s58
  v_mfma_f32_16x16x32_bf16 v[56:59], a[20:23], v[60:63], v[56:59]
  buffer_load_dwordx4 v6, s[8:11], s32 offen offset:128 nt lds
  v_perm_b32 v196, v80, v76, s59
  v_mfma_f32_16x16x32_bf16 v[56:59], a[32:35], v[150:153], v[56:59]
  s_add_u32 m0, s28, 20224
  v_mul_f32 v88, s42, v88
  v_mul_f32 v89, s42, v89
  v_mul_f32 v90, s42, v90
  v_mfma_f32_16x16x32_bf16 v[56:59], a[44:47], v[136:139], v[56:59]
  s_mov_b32 s28, s29
  v_mul_f32 v91, s42, v91
  v_cvt_pk_bf16_f32 v72, v88, v89
  v_cvt_pk_bf16_f32 v73, v90, v91
  v_mfma_f32_16x16x32_bf16 v[56:59], a[56:59], a[248:251], v[56:59]
  buffer_load_dwordx4 v6, s[8:11], s32 offen offset:256 nt lds
  v_perm_b32 v193, v81, v77, s58
  v_mfma_f32_16x16x32_bf16 v[56:59], a[68:71], v[164:167], v[56:59]
  s_add_u32 s32, s32, s43
  v_perm_b32 v197, v81, v77, s59
  v_perm_b32 v194, v82, v78, s58
  v_perm_b32 v198, v82, v78, s59
  v_mfma_f32_16x16x32_bf16 v[88:91], a[132:135], v[164:167], 0
  ds_read2st64_b32 v[96:97], v68 offset0:16 offset1:18
  v_perm_b32 v195, v83, v79, s58
  v_perm_b32 v199, v83, v79, s59
  v_mfma_f32_16x16x32_bf16 v[88:91], a[120:123], a[248:251], v[88:91]
  ds_read2st64_b32 v[84:85], v11 offset0:16 offset1:18
  ds_read2st64_b32 v[98:99], v68 offset0:20 offset1:22
  v_mul_f32 v162, v126, v162
  v_mfma_f32_16x16x32_bf16 v[88:91], a[108:111], v[136:139], v[88:91]
  v_mul_f32 v56, s42, v56
  v_mul_f32 v57, s42, v57
  v_mul_f32 v58, s42, v58
  v_mfma_f32_16x16x32_bf16 v[88:91], a[96:99], v[150:153], v[88:91]
  v_mul_f32 v59, s42, v59
  v_cvt_pk_bf16_f32 v74, v56, v57
  v_cvt_pk_bf16_f32 v75, v58, v59
  v_mfma_f32_16x16x32_bf16 v[88:91], a[84:87], v[60:63], v[88:91]
  ds_read2st64_b32 v[86:87], v11 offset0:20 offset1:22
  ds_read2st64_b32 v[76:77], v54 offset0:16 offset1:18
  v_mul_f32 v163, v126, v163
  v_mfma_f32_16x16x32_bf16 v[88:91], a[72:75], v[168:171], v[88:91]
  ds_read2st64_b32 v[80:81], v55 offset0:16 offset1:18
  ds_read2st64_b32 v[78:79], v54 offset0:20 offset1:22
  v_cvt_pk_bf16_f32 v160, v160, v161
  v_mfma_f32_16x16x32_bf16 v[56:59], a[76:79], v[168:171], 0
  ds_read2st64_b32 v[82:83], v55 offset0:20 offset1:22
  v_cvt_pk_bf16_f32 v161, v162, v163
  v_mul_f32 v156, v126, v156
  v_mfma_f32_16x16x32_bf16 v[56:59], a[88:91], v[60:63], v[56:59]
  v_mul_f32 v157, v126, v157
  v_mul_f32 v158, v126, v158
  v_mul_f32 v159, v126, v159
  v_mfma_f32_16x16x32_bf16 v[56:59], a[100:103], v[150:153], v[56:59]
  v_cvt_pk_bf16_f32 v120, v88, v89
  v_cvt_pk_bf16_f32 v121, v90, v91
  v_cvt_pk_bf16_f32 v156, v156, v157
  v_mfma_f32_16x16x32_bf16 v[56:59], a[112:115], v[136:139], v[56:59]
  s_waitcnt lgkmcnt(4)
  v_cvt_pk_bf16_f32 v157, v158, v159
  v_mul_f32 v64, v126, v64
  v_mul_f32 v65, v126, v65
  v_mfma_f32_16x16x32_bf16 v[56:59], a[124:127], a[248:251], v[56:59]
  v_mul_f32 v66, v126, v66
  v_mul_f32 v67, v126, v67
  v_cvt_pk_bf16_f32 v64, v64, v65
  v_mfma_f32_16x16x32_bf16 v[56:59], a[136:139], v[164:167], v[56:59]
  s_waitcnt lgkmcnt(0)
  v_cvt_pk_bf16_f32 v65, v66, v67
  v_max3_f32 v9, v124, v126, v9
  v_perm_b32 v200, v84, v96, s58
  v_mfma_f32_16x16x32_bf16 v[92:95], a[140:143], v[164:167], 0
  ds_write2st64_b32 v5, v160, v161 offset0:0 offset1:4
  v_mfma_f32_16x16x32_bf16 v[92:95], a[128:131], a[248:251], v[92:95]
  ds_write2st64_b32 v5, v156, v157 offset0:8 offset1:12
  v_mfma_f32_16x16x32_bf16 v[92:95], a[116:119], v[136:139], v[92:95]
  v_cvt_pk_bf16_f32 v122, v56, v57
  v_cvt_pk_bf16_f32 v123, v58, v59
  v_perm_b32 v204, v84, v96, s59
  v_mfma_f32_16x16x32_bf16 v[92:95], a[104:107], v[150:153], v[92:95]
  ds_write2st64_b32 v5, v64, v65 offset0:16 offset1:20
  v_mfma_f32_16x16x32_bf16 v[92:95], a[92:95], v[60:63], v[92:95]
  v_perm_b32 v201, v85, v97, s58
  v_perm_b32 v205, v85, v97, s59
  v_perm_b32 v202, v86, v98, s58
  v_mfma_f32_16x16x32_bf16 v[92:95], a[80:83], v[168:171], v[92:95]
  v_perm_b32 v206, v86, v98, s59
  v_perm_b32 v203, v87, v99, s58
  v_perm_b32 v207, v87, v99, s59
  v_mfma_f32_16x16x32_bf16 v[88:91], v[168:171], a[144:147], 0
  v_perm_b32 v208, v80, v76, s58
  v_perm_b32 v212, v80, v76, s59
  v_perm_b32 v209, v81, v77, s58
  v_mfma_f32_16x16x32_bf16 v[88:91], v[60:63], a[156:159], v[88:91]
  v_perm_b32 v213, v81, v77, s59
  v_perm_b32 v210, v82, v78, s58
  v_perm_b32 v214, v82, v78, s59
  v_mfma_f32_16x16x32_bf16 v[88:91], v[150:153], a[168:171], v[88:91]
  ds_read_b128 a[252:255], v0 offset:2048
  v_cvt_pk_bf16_f32 v124, v92, v93
  v_cvt_pk_bf16_f32 v125, v94, v95
  v_mfma_f32_16x16x32_bf16 v[88:91], v[136:139], a[180:183], v[88:91]
  ds_read_b128 v[172:175], v1 offset:2048
  ds_read_b128 v[156:159], v0 offset:10240
  v_perm_b32 v211, v83, v79, s58
  v_mfma_f32_16x16x32_bf16 v[88:91], a[248:251], a[192:195], v[88:91]
  s_add_u32 m0, s29, 0
  ds_read_b128 a[244:247], v1 offset:10240
  ds_read_b128 v[92:95], v0 offset:18432
  v_perm_b32 v215, v83, v79, s59
  v_mfma_f32_16x16x32_bf16 v[88:91], v[164:167], a[204:207], v[88:91]
  ds_read_b128 v[160:163], v1 offset:18432
  v_add_u32 v68, 4294844416, v68
  v_add_u32 v11, 4294844416, v11
  v_mfma_f32_16x16x32_bf16 v[64:67], v[164:167], a[208:211], 0
  s_waitcnt vmcnt(3)
  s_barrier
  v_mfma_f32_16x16x32_bf16 v[64:67], a[248:251], a[196:199], v[64:67]
  buffer_load_dwordx4 v6, s[8:11], s31 offen offset:0 nt lds
  v_add_u32 v54, 4294844416, v54
  v_mfma_f32_16x16x32_bf16 v[64:67], v[136:139], a[184:187], v[64:67]
  s_add_u32 m0, s29, 8064
  v_cvt_pk_bf16_f32 v56, v88, v89
  v_cvt_pk_bf16_f32 v57, v90, v91
  v_add_u32 v55, 4294844416, v55
  v_mfma_f32_16x16x32_bf16 v[64:67], v[150:153], a[172:175], v[64:67]
  ds_read2st64_b32 v[96:97], v68 offset0:0 offset1:2
  ds_read2st64_b32 v[84:85], v11 offset0:0 offset1:2
  v_add_f32 v148, v148, v149
  v_mfma_f32_16x16x32_bf16 v[64:67], v[60:63], a[160:163], v[64:67]
  ds_read2st64_b32 v[98:99], v68 offset0:4 offset1:6
  ds_read2st64_b32 v[86:87], v11 offset0:4 offset1:6
  v_add_f32 v104, v104, v105
  v_mfma_f32_16x16x32_bf16 v[64:67], v[168:171], a[148:151], v[64:67]
  buffer_load_dwordx4 v6, s[8:11], s31 offen offset:128 nt lds
  v_mfma_f32_16x16x32_bf16 v[88:91], v[168:171], a[152:155], 0
  s_add_u32 m0, s29, 16128
  ds_read2st64_b32 v[76:77], v54 offset0:0 offset1:2
  ds_read2st64_b32 v[80:81], v55 offset0:0 offset1:2
  v_mfma_f32_16x16x32_bf16 v[88:91], v[60:63], a[164:167], v[88:91]
  ds_read2st64_b32 v[78:79], v54 offset0:4 offset1:6
  ds_read2st64_b32 v[82:83], v55 offset0:4 offset1:6
  v_mfma_f32_16x16x32_bf16 v[88:91], v[150:153], a[176:179], v[88:91]
  v_cvt_pk_bf16_f32 v60, v64, v65
  v_cvt_pk_bf16_f32 v61, v66, v67
  v_mfma_f32_16x16x32_bf16 v[88:91], v[136:139], a[188:191], v[88:91]
  buffer_load_dwordx4 v6, s[8:11], s31 offen offset:256 nt lds
  v_mfma_f32_16x16x32_bf16 v[88:91], a[248:251], a[200:203], v[88:91]
  s_add_u32 m0, s29, 4096
  v_rcp_f32 v130, v128
  v_mfma_f32_16x16x32_bf16 v[88:91], v[164:167], a[212:215], v[88:91]
  s_waitcnt lgkmcnt(4)
  v_perm_b32 v216, v84, v96, s58
  v_perm_b32 v220, v84, v96, s59
  v_perm_b32 v217, v85, v97, s58
  v_mfma_f32_16x16x32_bf16 v[164:167], a[0:3], a[252:255], 0
L_hop_1_0:
  s_cbranch_execz L_hop_1_1
  s_waitcnt lgkmcnt(0)
  v_perm_b32 v221, v85, v97, s59
  v_perm_b32 v218, v86, v98, s58
  v_perm_b32 v222, v86, v98, s59
  v_mfma_f32_16x16x32_bf16 v[164:167], a[12:15], v[172:175], v[164:167]
  buffer_load_dwordx4 v6, s[8:11], s32 offen offset:0 nt lds
  v_perm_b32 v219, v87, v99, s58
  v_mfma_f32_16x16x32_bf16 v[164:167], a[24:27], v[156:159], v[164:167]
  s_add_u32 m0, s29, 12160
  v_cvt_pk_bf16_f32 v64, v88, v89
  v_cvt_pk_bf16_f32 v65, v90, v91
  v_perm_b32 v223, v87, v99, s59
  v_mfma_f32_16x16x32_bf16 v[164:167], a[36:39], a[244:247], v[164:167]
  s_add_u32 s31, s31, s43
  v_perm_b32 v224, v80, v76, s58
  v_perm_b32 v228, v80, v76, s59
  v_perm_b32 v225, v81, v77, s58
  v_mfma_f32_16x16x32_bf16 v[164:167], a[48:51], v[92:95], v[164:167]
  v_perm_b32 v229, v81, v77, s59
  v_perm_b32 v226, v82, v78, s58
  v_perm_b32 v230, v82, v78, s59
  v_mfma_f32_16x16x32_bf16 v[164:167], a[60:63], v[160:163], v[164:167]
  buffer_load_dwordx4 v6, s[8:11], s32 offen offset:128 nt lds
  v_perm_b32 v227, v83, v79, s58
  v_mfma_f32_16x16x32_bf16 v[168:171], a[64:67], v[160:163], 0
  s_add_u32 m0, s29, 20224
  ds_read2st64_b32 v[96:97], v68 offset0:16 offset1:18
  ds_read2st64_b32 v[84:85], v11 offset0:16 offset1:18
  v_perm_b32 v231, v83, v79, s59
  v_mfma_f32_16x16x32_bf16 v[168:171], a[52:55], v[92:95], v[168:171]
  s_mov_b32 s29, s30
  ds_read2st64_b32 v[98:99], v68 offset0:20 offset1:22
  ds_read2st64_b32 v[86:87], v11 offset0:20 offset1:22
  v_mul_f32 v180, v130, v180
  v_mfma_f32_16x16x32_bf16 v[168:171], a[40:43], a[244:247], v[168:171]
  v_mul_f32 v164, s42, v164
  v_mul_f32 v165, s42, v165
  v_mul_f32 v166, s42, v166
  v_mfma_f32_16x16x32_bf16 v[168:171], a[28:31], v[156:159], v[168:171]
  buffer_load_dwordx4 v6, s[8:11], s32 offen offset:256 nt lds
  v_mul_f32 v167, s42, v167
  v_mfma_f32_16x16x32_bf16 v[168:171], a[16:19], v[172:175], v[168:171]
  s_add_u32 s32, s32, s43
  ds_read2st64_b32 v[76:77], v54 offset0:16 offset1:18
  v_cvt_pk_bf16_f32 v88, v164, v165
  v_cvt_pk_bf16_f32 v89, v166, v167
  v_mfma_f32_16x16x32_bf16 v[168:171], a[4:7], a[252:255], v[168:171]
  ds_read2st64_b32 v[80:81], v55 offset0:16 offset1:18
  ds_read2st64_b32 v[78:79], v54 offset0:20 offset1:22
  v_mul_f32 v181, v130, v181
  v_mfma_f32_16x16x32_bf16 v[164:167], a[8:11], a[252:255], 0
  s_waitcnt lgkmcnt(3)
  ds_read2st64_b32 v[82:83], v55 offset0:20 offset1:22
  v_mul_f32 v182, v130, v182
  v_mul_f32 v183, v130, v183
  v_mfma_f32_16x16x32_bf16 v[164:167], a[20:23], v[172:175], v[164:167]
  v_cvt_pk_bf16_f32 v180, v180, v181
  v_cvt_pk_bf16_f32 v181, v182, v183
  v_mul_f32 v176, v130, v176
  v_mfma_f32_16x16x32_bf16 v[164:167], a[32:35], v[156:159], v[164:167]
  v_mul_f32 v168, s42, v168
  v_mul_f32 v169, s42, v169
  v_mul_f32 v170, s42, v170
  v_mfma_f32_16x16x32_bf16 v[164:167], a[44:47], a[244:247], v[164:167]
  v_mul_f32 v171, s42, v171
  v_cvt_pk_bf16_f32 v90, v168, v169
  v_cvt_pk_bf16_f32 v91, v170, v171
  v_mfma_f32_16x16x32_bf16 v[164:167], a[56:59], v[92:95], v[164:167]
  v_mul_f32 v177, v130, v177
  v_mul_f32 v178, v130, v178
  v_mul_f32 v179, v130, v179
  v_mfma_f32_16x16x32_bf16 v[164:167], a[68:71], v[160:163], v[164:167]
  s_waitcnt lgkmcnt(0)
  v_cvt_pk_bf16_f32 v176, v176, v177
  v_cvt_pk_bf16_f32 v177, v178, v179
  v_mul_f32 v140, v130, v140
  v_mfma_f32_16x16x32_bf16 v[168:171], a[132:135], v[160:163], 0
  v_mul_f32 v141, v130, v141
  v_mul_f32 v142, v130, v142
  v_mul_f32 v143, v130, v143
  v_mfma_f32_16x16x32_bf16 v[168:171], a[120:123], v[92:95], v[168:171]
  v_cvt_pk_bf16_f32 v140, v140, v141
  v_cvt_pk_bf16_f32 v141, v142, v143
  v_max3_f32 v9, v128, v130, v9
  v_mfma_f32_16x16x32_bf16 v[168:171], a[108:111], a[244:247], v[168:171]
  v_mul_f32 v164, s42, v164
  v_mul_f32 v165, s42, v165
  v_mul_f32 v166, s42, v166
  v_mfma_f32_16x16x32_bf16 v[168:171], a[96:99], v[156:159], v[168:171]
  v_mul_f32 v167, s42, v167
  v_cvt_pk_bf16_f32 v16, v164, v165
  v_cvt_pk_bf16_f32 v17, v166, v167
  v_mfma_f32_16x16x32_bf16 v[168:171], a[84:87], v[172:175], v[168:171]
  ds_write2st64_b32 v5, v180, v181 offset0:1 offset1:5
  v_mfma_f32_16x16x32_bf16 v[168:171], a[72:75], a[252:255], v[168:171]
  ds_write2st64_b32 v5, v176, v177 offset0:9 offset1:13
  v_mfma_f32_16x16x32_bf16 v[164:167], a[76:79], a[252:255], 0
  ds_write2st64_b32 v5, v140, v141 offset0:17 offset1:21
  v_mfma_f32_16x16x32_bf16 v[164:167], a[88:91], v[172:175], v[164:167]
  v_rcp_f32 v150, v148
  v_perm_b32 v232, v84, v96, s58
  v_mfma_f32_16x16x32_bf16 v[164:167], a[100:103], v[156:159], v[164:167]
  v_cvt_pk_bf16_f32 v128, v168, v169
  v_cvt_pk_bf16_f32 v129, v170, v171
  v_mul_f32 v132, v150, v132
  v_mfma_f32_16x16x32_bf16 v[164:167], a[112:115], a[244:247], v[164:167]
  v_mul_f32 v133, v150, v133
  v_mul_f32 v134, v150, v134
  v_mul_f32 v135, v150, v135
  v_mfma_f32_16x16x32_bf16 v[164:167], a[124:127], v[92:95], v[164:167]
  v_cvt_pk_bf16_f32 v132, v132, v133
  v_cvt_pk_bf16_f32 v133, v134, v135
  v_mul_f32 v112, v150, v112
  v_mfma_f32_16x16x32_bf16 v[164:167], a[136:139], v[160:163], v[164:167]
  v_mul_f32 v113, v150, v113
  v_mul_f32 v114, v150, v114
  v_mul_f32 v115, v150, v115
  v_mfma_f32_16x16x32_bf16 v[140:143], a[140:143], v[160:163], 0
  v_cvt_pk_bf16_f32 v112, v112, v113
  v_cvt_pk_bf16_f32 v113, v114, v115
  v_mul_f32 v108, v150, v108
  v_mfma_f32_16x16x32_bf16 v[140:143], a[128:131], v[92:95], v[140:143]
  v_mul_f32 v109, v150, v109
  v_mul_f32 v110, v150, v110
  v_mul_f32 v111, v150, v111
  v_mfma_f32_16x16x32_bf16 v[140:143], a[116:119], a[244:247], v[140:143]
  v_cvt_pk_bf16_f32 v130, v164, v165
  v_cvt_pk_bf16_f32 v131, v166, v167
  v_cvt_pk_bf16_f32 v108, v108, v109
  v_mfma_f32_16x16x32_bf16 v[140:143], a[104:107], v[156:159], v[140:143]
  v_cvt_pk_bf16_f32 v109, v110, v111
  v_max3_f32 v9, v148, v150, v9
  v_perm_b32 v236, v84, v96, s59
  v_mfma_f32_16x16x32_bf16 v[140:143], a[92:95], v[172:175], v[140:143]
  ds_write2st64_b32 v5, v132, v133 offset0:2 offset1:6
  v_mfma_f32_16x16x32_bf16 v[140:143], a[80:83], a[252:255], v[140:143]
  ds_write2st64_b32 v5, v112, v113 offset0:10 offset1:14
  v_mfma_f32_16x16x32_bf16 v[148:151], a[252:255], a[144:147], 0
  ds_write2st64_b32 v5, v108, v109 offset0:18 offset1:22
  v_mfma_f32_16x16x32_bf16 v[148:151], v[172:175], a[156:159], v[148:151]
  v_rcp_f32 v106, v104
  v_perm_b32 v233, v85, v97, s58
  v_mfma_f32_16x16x32_bf16 v[148:151], v[156:159], a[168:171], v[148:151]
  v_cvt_pk_bf16_f32 v132, v140, v141
  v_cvt_pk_bf16_f32 v133, v142, v143
  v_mfma_f32_16x16x32_bf16 v[148:151], a[244:247], a[180:183], v[148:151]
  v_mul_f32 v144, v106, v144
  v_mul_f32 v145, v106, v145
  v_mfma_f32_16x16x32_bf16 v[148:151], v[92:95], a[192:195], v[148:151]
  s_waitcnt vmcnt(6) lgkmcnt(0)
  s_barrier
  v_mfma_f32_16x16x32_bf16 v[148:151], v[160:163], a[204:207], v[148:151]
  ds_read_b128 v[112:115], v0 offset:4096
  ds_read_b128 v[152:155], v1 offset:4096
  v_mfma_f32_16x16x32_bf16 v[136:139], v[160:163], a[208:211], 0
  ds_read_b128 v[164:167], v0 offset:12288
  ds_read_b128 v[168:171], v1 offset:12288
  v_mfma_f32_16x16x32_bf16 v[136:139], v[92:95], a[196:199], v[136:139]
  ds_read_b128 v[176:179], v0 offset:20480
  ds_read_b128 v[180:183], v1 offset:20480
  v_mfma_f32_16x16x32_bf16 v[136:139], a[244:247], a[184:187], v[136:139]
  v_cvt_pk_bf16_f32 v58, v148, v149
  v_cvt_pk_bf16_f32 v59, v150, v151
  v_mfma_f32_16x16x32_bf16 v[136:139], v[156:159], a[172:175], v[136:139]
  v_mul_f32 v146, v106, v146
  v_mul_f32 v147, v106, v147
  v_mfma_f32_16x16x32_bf16 v[136:139], v[172:175], a[160:163], v[136:139]
  v_cvt_pk_bf16_f32 v144, v144, v145
  v_cvt_pk_bf16_f32 v145, v146, v147
  v_mfma_f32_16x16x32_bf16 v[136:139], a[252:255], a[148:151], v[136:139]
  v_mul_f32 v116, v106, v116
  v_mul_f32 v117, v106, v117
  v_mfma_f32_16x16x32_bf16 v[140:143], a[252:255], a[152:155], 0
  v_mul_f32 v118, v106, v118
  v_mul_f32 v119, v106, v119
  v_mfma_f32_16x16x32_bf16 v[140:143], v[172:175], a[164:167], v[140:143]
  v_cvt_pk_bf16_f32 v116, v116, v117
  v_cvt_pk_bf16_f32 v117, v118, v119
  v_mfma_f32_16x16x32_bf16 v[140:143], v[156:159], a[176:179], v[140:143]
  v_cvt_pk_bf16_f32 v62, v136, v137
  v_cvt_pk_bf16_f32 v63, v138, v139
  v_mfma_f32_16x16x32_bf16 v[140:143], a[244:247], a[188:191], v[140:143]
  v_mul_f32 v100, v106, v100
  v_mul_f32 v101, v106, v101
  v_mfma_f32_16x16x32_bf16 v[140:143], v[92:95], a[200:203], v[140:143]
  v_mul_f32 v102, v106, v102
  v_mul_f32 v103, v106, v103
  v_mfma_f32_16x16x32_bf16 v[140:143], v[160:163], a[212:215], v[140:143]
  s_waitcnt lgkmcnt(0)
  v_cvt_pk_bf16_f32 v100, v100, v101
  v_cvt_pk_bf16_f32 v101, v102, v103
  v_mfma_f32_16x16x32_bf16 v[136:139], a[0:3], v[112:115], 0
  v_max3_f32 v9, v104, v106, v9
  v_perm_b32 v237, v85, v97, s59
  v_mfma_f32_16x16x32_bf16 v[136:139], a[12:15], v[152:155], v[136:139]
  ds_write2st64_b32 v5, v144, v145 offset0:3 offset1:7
  v_mfma_f32_16x16x32_bf16 v[136:139], a[24:27], v[164:167], v[136:139]
  v_cvt_pk_bf16_f32 v66, v140, v141
  v_cvt_pk_bf16_f32 v67, v142, v143
  v_mfma_f32_16x16x32_bf16 v[136:139], a[36:39], v[168:171], v[136:139]
  ds_write2st64_b32 v5, v116, v117 offset0:11 offset1:15
  v_mfma_f32_16x16x32_bf16 v[136:139], a[48:51], v[176:179], v[136:139]
  ds_write2st64_b32 v5, v100, v101 offset0:19 offset1:23
  v_mfma_f32_16x16x32_bf16 v[136:139], a[60:63], v[180:183], v[136:139]
  v_perm_b32 v234, v86, v98, s58
  v_perm_b32 v238, v86, v98, s59
  v_mfma_f32_16x16x32_bf16 v[92:95], a[64:67], v[180:183], 0
  v_perm_b32 v235, v87, v99, s58
  v_perm_b32 v239, v87, v99, s59
  v_mfma_f32_16x16x32_bf16 v[92:95], a[52:55], v[176:179], v[92:95]
  v_perm_b32 v240, v80, v76, s58
  v_perm_b32 v244, v80, v76, s59
  v_mfma_f32_16x16x32_bf16 v[92:95], a[40:43], v[168:171], v[92:95]
  v_mul_f32 v136, s42, v136
  v_mul_f32 v137, s42, v137
  v_mfma_f32_16x16x32_bf16 v[92:95], a[28:31], v[164:167], v[92:95]
  v_mul_f32 v138, s42, v138
  v_mul_f32 v139, s42, v139
  v_mfma_f32_16x16x32_bf16 v[92:95], a[16:19], v[152:155], v[92:95]
  v_cvt_pk_bf16_f32 v18, v136, v137
  v_cvt_pk_bf16_f32 v19, v138, v139
  v_mfma_f32_16x16x32_bf16 v[92:95], a[4:7], v[112:115], v[92:95]
  v_perm_b32 v241, v81, v77, s58
  v_perm_b32 v245, v81, v77, s59
  v_mfma_f32_16x16x32_bf16 v[104:107], a[8:11], v[112:115], 0
  v_perm_b32 v242, v82, v78, s58
  v_perm_b32 v246, v82, v78, s59
  v_mfma_f32_16x16x32_bf16 v[104:107], a[20:23], v[152:155], v[104:107]
  v_perm_b32 v243, v83, v79, s58
  v_perm_b32 v247, v83, v79, s59
  v_mfma_f32_16x16x32_bf16 v[104:107], a[32:35], v[164:167], v[104:107]
  v_mul_f32 v92, s42, v92
  v_mul_f32 v93, s42, v93
  v_mfma_f32_16x16x32_bf16 v[104:107], a[44:47], v[168:171], v[104:107]
  v_mul_f32 v94, s42, v94
  v_mul_f32 v95, s42, v95
  v_mfma_f32_16x16x32_bf16 v[104:107], a[56:59], v[176:179], v[104:107]
  v_cvt_pk_bf16_f32 v100, v92, v93
  v_cvt_pk_bf16_f32 v101, v94, v95
  v_mfma_f32_16x16x32_bf16 v[104:107], a[68:71], v[180:183], v[104:107]
  v_add_u32 v68, 98304, v68
  v_add_u32 v11, 98304, v11
  v_mfma_f32_16x16x32_bf16 v[92:95], a[132:135], v[180:183], 0
  v_add_u32 v54, 98304, v54
  v_add_u32 v55, 98304, v55
  v_mfma_f32_16x16x32_bf16 v[92:95], a[120:123], v[176:179], v[92:95]
  ds_read2st64_b32 v[96:97], v68 offset0:0 offset1:2
  ds_read2st64_b32 v[84:85], v11 offset0:0 offset1:2
  v_mfma_f32_16x16x32_bf16 v[92:95], a[108:111], v[168:171], v[92:95]
  v_mul_f32 v104, s42, v104
  v_mul_f32 v105, s42, v105
  v_mfma_f32_16x16x32_bf16 v[92:95], a[96:99], v[164:167], v[92:95]
  v_mul_f32 v106, s42, v106
  v_mul_f32 v107, s42, v107
  v_mfma_f32_16x16x32_bf16 v[92:95], a[84:87], v[152:155], v[92:95]
  v_cvt_pk_bf16_f32 v102, v104, v105
  v_cvt_pk_bf16_f32 v103, v106, v107
  v_mfma_f32_16x16x32_bf16 v[92:95], a[72:75], v[112:115], v[92:95]
  ds_read2st64_b32 v[98:99], v68 offset0:4 offset1:6
  ds_read2st64_b32 v[86:87], v11 offset0:4 offset1:6
  v_mfma_f32_16x16x32_bf16 v[104:107], a[76:79], v[112:115], 0
  ds_read2st64_b32 v[76:77], v54 offset0:0 offset1:2
  ds_read2st64_b32 v[80:81], v55 offset0:0 offset1:2
  v_mfma_f32_16x16x32_bf16 v[104:107], a[88:91], v[152:155], v[104:107]
  ds_read2st64_b32 v[78:79], v54 offset0:4 offset1:6
  ds_read2st64_b32 v[82:83], v55 offset0:4 offset1:6
  v_mfma_f32_16x16x32_bf16 v[104:107], a[100:103], v[164:167], v[104:107]
  v_cvt_pk_bf16_f32 v136, v92, v93
  v_cvt_pk_bf16_f32 v137, v94, v95
  v_mfma_f32_16x16x32_bf16 v[104:107], a[112:115], v[168:171], v[104:107]
  v_xor_b32 v5, s41, v5
  v_mfma_f32_16x16x32_bf16 v[104:107], a[124:127], v[176:179], v[104:107]
  s_waitcnt lgkmcnt(4)
  v_perm_b32 v248, v84, v96, s58
  v_perm_b32 v252, v84, v96, s59
  v_mfma_f32_16x16x32_bf16 v[104:107], a[136:139], v[180:183], v[104:107]
  v_perm_b32 v249, v85, v97, s58
  v_perm_b32 v253, v85, v97, s59
  v_mfma_f32_16x16x32_bf16 v[92:95], a[140:143], v[180:183], 0
  s_waitcnt lgkmcnt(0)
  v_perm_b32 v250, v86, v98, s58
  v_perm_b32 v254, v86, v98, s59
  v_mfma_f32_16x16x32_bf16 v[92:95], a[128:131], v[176:179], v[92:95]
  v_perm_b32 v251, v87, v99, s58
  v_perm_b32 v255, v87, v99, s59
  v_mfma_f32_16x16x32_bf16 v[92:95], a[116:119], v[168:171], v[92:95]
  v_cvt_pk_bf16_f32 v138, v104, v105
  v_cvt_pk_bf16_f32 v139, v106, v107
  v_mfma_f32_16x16x32_bf16 v[92:95], a[104:107], v[164:167], v[92:95]
  s_add_u32 m0, s30, 0
  v_perm_b32 v110, v80, v76, s58
  v_perm_b32 v76, v80, v76, s59
  v_mfma_f32_16x16x32_bf16 v[92:95], a[92:95], v[152:155], v[92:95]
  v_accvgpr_write_b32 a220, v76
  v_perm_b32 v111, v81, v77, s58
  v_mfma_f32_16x16x32_bf16 v[92:95], a[80:83], v[112:115], v[92:95]
  v_perm_b32 v77, v81, v77, s59
  v_accvgpr_write_b32 a221, v77
  v_mfma_f32_16x16x32_bf16 v[84:87], v[112:115], a[144:147], 0
  buffer_load_dwordx4 v6, s[8:11], s31 offen offset:0 nt lds
  v_mfma_f32_16x16x32_bf16 v[84:87], v[152:155], a[156:159], v[84:87]
  s_add_u32 m0, s30, 8064
  v_perm_b32 v116, v82, v78, s58
  v_perm_b32 v78, v82, v78, s59
  v_mfma_f32_16x16x32_bf16 v[84:87], v[164:167], a[168:171], v[84:87]
  v_cvt_pk_bf16_f32 v140, v92, v93
  v_cvt_pk_bf16_f32 v141, v94, v95
  v_mfma_f32_16x16x32_bf16 v[84:87], v[168:171], a[180:183], v[84:87]
  ds_read_b128 a[248:251], v0 offset:6144
  ds_read_b128 a[244:247], v1 offset:6144
  v_mfma_f32_16x16x32_bf16 v[84:87], v[176:179], a[192:195], v[84:87]
  buffer_load_dwordx4 v6, s[8:11], s31 offen offset:128 nt lds
  v_mfma_f32_16x16x32_bf16 v[84:87], v[180:183], a[204:207], v[84:87]
  s_add_u32 m0, s30, 16128
  ds_read_b128 a[252:255], v0 offset:14336
  ds_read_b128 v[144:147], v1 offset:14336
  v_mfma_f32_16x16x32_bf16 v[104:107], v[180:183], a[208:211], 0
  ds_read_b128 v[148:151], v0 offset:22528
  ds_read_b128 v[172:175], v1 offset:22528
  v_mfma_f32_16x16x32_bf16 v[104:107], v[176:179], a[196:199], v[104:107]
  v_accvgpr_write_b32 a222, v78
  v_perm_b32 v117, v83, v79, s58
  v_mfma_f32_16x16x32_bf16 v[104:107], v[168:171], a[184:187], v[104:107]
  buffer_load_dwordx4 v6, s[8:11], s31 offen offset:256 nt lds
  v_mfma_f32_16x16x32_bf16 v[104:107], v[164:167], a[172:175], v[104:107]
  s_add_u32 m0, s30, 4096
  v_cvt_pk_bf16_f32 v108, v84, v85
  v_cvt_pk_bf16_f32 v109, v86, v87
  v_mfma_f32_16x16x32_bf16 v[104:107], v[152:155], a[160:163], v[104:107]
  s_add_u32 s31, s31, s43
  v_perm_b32 v79, v83, v79, s59
  v_accvgpr_write_b32 a223, v79
  v_mfma_f32_16x16x32_bf16 v[104:107], v[112:115], a[148:151], v[104:107]
  ds_read2st64_b32 v[96:97], v68 offset0:16 offset1:18
  ds_read2st64_b32 v[84:85], v11 offset0:16 offset1:18
  v_mfma_f32_16x16x32_bf16 v[92:95], v[112:115], a[152:155], 0
  buffer_load_dwordx4 v6, s[8:11], s32 offen offset:0 nt lds
  v_mfma_f32_16x16x32_bf16 v[92:95], v[152:155], a[164:167], v[92:95]
  s_add_u32 m0, s30, 12160
  ds_read2st64_b32 v[98:99], v68 offset0:20 offset1:22
  ds_read2st64_b32 v[86:87], v11 offset0:20 offset1:22
  v_mfma_f32_16x16x32_bf16 v[92:95], v[164:167], a[176:179], v[92:95]
  v_cvt_pk_bf16_f32 v112, v104, v105
  v_cvt_pk_bf16_f32 v113, v106, v107
  v_mfma_f32_16x16x32_bf16 v[92:95], v[168:171], a[188:191], v[92:95]
  s_waitcnt lgkmcnt(2)
  ds_read2st64_b32 v[76:77], v54 offset0:16 offset1:18
  ds_read2st64_b32 v[80:81], v55 offset0:16 offset1:18
  v_mfma_f32_16x16x32_bf16 v[92:95], v[176:179], a[200:203], v[92:95]
  buffer_load_dwordx4 v6, s[8:11], s32 offen offset:128 nt lds
  v_mfma_f32_16x16x32_bf16 v[92:95], v[180:183], a[212:215], v[92:95]
  s_add_u32 m0, s30, 20224
  ds_read2st64_b32 v[78:79], v54 offset0:20 offset1:22
  ds_read2st64_b32 v[82:83], v55 offset0:20 offset1:22
  v_mfma_f32_16x16x32_bf16 v[68:71], a[72:75], a[248:251], 0
  s_waitcnt lgkmcnt(4)
  v_accvgpr_write_b32 a216, v110
  v_accvgpr_write_b32 a217, v111
  v_mfma_f32_16x16x32_bf16 v[68:71], a[84:87], a[244:247], v[68:71]
  s_mov_b32 s30, s5
  v_accvgpr_write_b32 a218, v116
  v_accvgpr_write_b32 a219, v117
  v_mfma_f32_16x16x32_bf16 v[68:71], a[96:99], a[252:255], v[68:71]
  buffer_load_dwordx4 v6, s[8:11], s32 offen offset:256 nt lds
  v_mfma_f32_16x16x32_bf16 v[68:71], a[108:111], v[144:147], v[68:71]
  s_add_u32 s32, s32, s43
  v_cvt_pk_bf16_f32 v116, v92, v93
  v_cvt_pk_bf16_f32 v117, v94, v95
  v_mfma_f32_16x16x32_bf16 v[68:71], a[120:123], v[148:151], v[68:71]
  s_waitcnt lgkmcnt(0)
  v_perm_b32 v11, v84, v96, s58
  v_perm_b32 v96, v84, v96, s59
  v_mfma_f32_16x16x32_bf16 v[68:71], a[132:135], v[172:175], v[68:71]
  v_accvgpr_write_b32 a224, v11
  v_accvgpr_write_b32 a228, v96
  v_mfma_f32_16x16x32_bf16 v[92:95], a[136:139], v[172:175], 0
  v_perm_b32 v54, v85, v97, s58
  v_perm_b32 v97, v85, v97, s59
  v_mfma_f32_16x16x32_bf16 v[92:95], a[124:127], v[148:151], v[92:95]
  v_accvgpr_write_b32 a225, v54
  v_accvgpr_write_b32 a229, v97
  v_mfma_f32_16x16x32_bf16 v[92:95], a[112:115], v[144:147], v[92:95]
  v_cvt_pk_bf16_f32 v164, v68, v69
  v_cvt_pk_bf16_f32 v165, v70, v71
  v_mfma_f32_16x16x32_bf16 v[92:95], a[100:103], a[252:255], v[92:95]
  v_perm_b32 v11, v86, v98, s58
  v_perm_b32 v98, v86, v98, s59
  v_mfma_f32_16x16x32_bf16 v[92:95], a[88:91], a[244:247], v[92:95]
  v_accvgpr_write_b32 a226, v11
  v_accvgpr_write_b32 a230, v98
  v_mfma_f32_16x16x32_bf16 v[92:95], a[76:79], a[248:251], v[92:95]
  v_perm_b32 v54, v87, v99, s58
  v_perm_b32 v99, v87, v99, s59
  v_mfma_f32_16x16x32_bf16 v[156:159], a[80:83], a[248:251], 0
  v_accvgpr_write_b32 a227, v54
  v_accvgpr_write_b32 a231, v99
  v_mfma_f32_16x16x32_bf16 v[156:159], a[92:95], a[244:247], v[156:159]
  v_perm_b32 v11, v80, v76, s58
  v_perm_b32 v76, v80, v76, s59
  v_mfma_f32_16x16x32_bf16 v[156:159], a[104:107], a[252:255], v[156:159]
  v_cvt_pk_bf16_f32 v166, v92, v93
  v_cvt_pk_bf16_f32 v167, v94, v95
  v_mfma_f32_16x16x32_bf16 v[156:159], a[116:119], v[144:147], v[156:159]
  v_accvgpr_write_b32 a232, v11
  v_accvgpr_write_b32 a236, v76
  v_mfma_f32_16x16x32_bf16 v[156:159], a[128:131], v[148:151], v[156:159]
  v_perm_b32 v54, v81, v77, s58
  v_perm_b32 v77, v81, v77, s59
  v_mfma_f32_16x16x32_bf16 v[156:159], a[140:143], v[172:175], v[156:159]
  v_accvgpr_write_b32 a233, v54
  v_accvgpr_write_b32 a237, v77
  v_mfma_f32_16x16x32_bf16 v[92:95], v[122:125], v[72:75], v[36:39]
  v_perm_b32 v11, v82, v78, s58
  v_perm_b32 v78, v82, v78, s59
  v_mfma_f32_16x16x32_bf16 v[92:95], v[120:123], v[12:15], v[92:95]
  v_accvgpr_write_b32 a234, v11
  v_accvgpr_write_b32 a238, v78
  v_mfma_f32_16x16x32_bf16 v[96:99], v[130:133], v[72:75], v[32:35]
  v_perm_b32 v54, v83, v79, s58
  v_perm_b32 v79, v83, v79, s59
  v_mfma_f32_16x16x32_bf16 v[96:99], v[128:131], v[12:15], v[96:99]
  v_accvgpr_write_b32 a235, v54
  v_accvgpr_write_b32 a239, v79
  v_mfma_f32_16x16x32_bf16 v[68:71], v[138:141], v[72:75], v[28:31]
  v_cvt_pk_bf16_f32 v168, v156, v157
  v_cvt_pk_bf16_f32 v169, v158, v159
  v_mfma_f32_16x16x32_bf16 v[68:71], v[136:139], v[12:15], v[68:71]
  v_exp_f32 v92, v92
  v_mfma_f32_16x16x32_bf16 v[104:107], v[166:169], v[72:75], v[24:27]
  s_mov_b32 s44, 0
  v_exp_f32 v93, v93
  v_mfma_f32_16x16x32_bf16 v[104:107], v[164:167], v[12:15], v[104:107]
  s_mov_b32 s45, 0
  v_exp_f32 v94, v94
  v_mfma_f32_16x16x32_bf16 v[76:79], v[120:123], v[88:91], v[40:43]
  s_mov_b32 s59, 0
  v_exp_f32 v95, v95
  v_mfma_f32_16x16x32_bf16 v[76:79], v[122:125], v[14:17], v[76:79]
  s_mov_b32 s58, 0
  v_exp_f32 v96, v96
  v_mfma_f32_16x16x32_bf16 v[80:83], v[128:131], v[88:91], v[36:39]
  s_mov_b64 s[12:13], 0
  v_exp_f32 v97, v97
  v_mfma_f32_16x16x32_bf16 v[80:83], v[130:133], v[14:17], v[80:83]
  s_mov_b64 s[16:17], 0
  v_exp_f32 v98, v98
  v_mfma_f32_16x16x32_bf16 v[180:183], v[136:139], v[88:91], v[32:35]
  s_mov_b64 s[18:19], 0
  v_exp_f32 v99, v99
  v_mfma_f32_16x16x32_bf16 v[180:183], v[138:141], v[14:17], v[180:183]
  s_mov_b64 s[60:61], 0
  v_exp_f32 v68, v68
  v_mfma_f32_16x16x32_bf16 v[176:179], v[164:167], v[88:91], v[28:31]
  s_mov_b32 s15, 0
  v_exp_f32 v69, v69
  v_mfma_f32_16x16x32_bf16 v[176:179], v[166:169], v[14:17], v[176:179]
  s_mov_b32 s99, 0
  v_exp_f32 v70, v70
  v_mfma_f32_16x16x32_bf16 v[84:87], v[122:125], v[100:103], v[44:47]
  v_exp_f32 v71, v71
  v_mfma_f32_16x16x32_bf16 v[84:87], v[120:123], v[18:21], v[84:87]
  v_exp_f32 v104, v104
  v_mfma_f32_16x16x32_bf16 v[88:91], v[130:133], v[100:103], v[40:43]
  v_exp_f32 v105, v105
  v_mfma_f32_16x16x32_bf16 v[88:91], v[128:131], v[18:21], v[88:91]
  v_exp_f32 v106, v106
  v_mfma_f32_16x16x32_bf16 v[160:163], v[138:141], v[100:103], v[36:39]
  v_exp_f32 v107, v107
  v_mfma_f32_16x16x32_bf16 v[160:163], v[136:139], v[18:21], v[160:163]
  v_cvt_pk_bf16_f32 v92, v92, v93
  v_cvt_pk_bf16_f32 v93, v94, v95
  v_mfma_f32_16x16x32_bf16 v[156:159], v[166:169], v[100:103], v[32:35]
  v_cvt_pk_bf16_f32 v94, v96, v97
  v_cvt_pk_bf16_f32 v95, v98, v99
  v_mfma_f32_16x16x32_bf16 v[156:159], v[164:167], v[18:21], v[156:159]
  v_cvt_pk_bf16_f32 v96, v68, v69
  v_cvt_pk_bf16_f32 v97, v70, v71
  v_mfma_f32_16x16x32_bf16 v[72:75], a[60:63], v[172:175], 0
  v_cvt_pk_bf16_f32 v98, v104, v105
  v_cvt_pk_bf16_f32 v99, v106, v107
  v_mfma_f32_16x16x32_bf16 v[72:75], a[48:51], v[148:151], v[72:75]
  v_exp_f32 v76, v76
  v_mfma_f32_16x16x32_bf16 v[72:75], a[36:39], v[144:147], v[72:75]
  v_exp_f32 v77, v77
  v_mfma_f32_16x16x32_bf16 v[72:75], a[24:27], a[252:255], v[72:75]
  v_exp_f32 v78, v78
  v_mfma_f32_16x16x32_bf16 v[72:75], a[12:15], a[244:247], v[72:75]
  v_exp_f32 v79, v79
  v_mfma_f32_16x16x32_bf16 v[72:75], a[0:3], a[248:251], v[72:75]
  v_exp_f32 v80, v80
  v_mfma_f32_16x16x32_bf16 v[104:107], a[4:7], a[248:251], 0
  v_exp_f32 v81, v81
  v_mfma_f32_16x16x32_bf16 v[104:107], a[16:19], a[244:247], v[104:107]
  v_exp_f32 v82, v82
  v_mfma_f32_16x16x32_bf16 v[104:107], a[28:31], a[252:255], v[104:107]
  v_exp_f32 v83, v83
  v_mfma_f32_16x16x32_bf16 v[104:107], a[40:43], v[144:147], v[104:107]
  v_mul_f32 v72, s42, v72
  v_mul_f32 v73, s42, v73
  v_mfma_f32_16x16x32_bf16 v[104:107], a[52:55], v[148:151], v[104:107]
  v_mul_f32 v74, s42, v74
  v_mul_f32 v75, s42, v75
  v_mfma_f32_16x16x32_bf16 v[104:107], a[64:67], v[172:175], v[104:107]
  v_cvt_pk_bf16_f32 v152, v72, v73
  v_cvt_pk_bf16_f32 v153, v74, v75
  v_mfma_f32_16x16x32_bf16 v[100:103], a[68:71], v[172:175], 0
  v_exp_f32 v180, v180
  v_mfma_f32_16x16x32_bf16 v[100:103], a[56:59], v[148:151], v[100:103]
  v_exp_f32 v181, v181
  v_mfma_f32_16x16x32_bf16 v[100:103], a[44:47], v[144:147], v[100:103]
  v_exp_f32 v182, v182
  v_mfma_f32_16x16x32_bf16 v[100:103], a[32:35], a[252:255], v[100:103]
  v_mul_f32 v104, s42, v104
  v_mul_f32 v105, s42, v105
  v_mfma_f32_16x16x32_bf16 v[100:103], a[20:23], a[244:247], v[100:103]
  v_mul_f32 v106, s42, v106
  v_mul_f32 v107, s42, v107
  v_mfma_f32_16x16x32_bf16 v[100:103], a[8:11], a[248:251], v[100:103]
  v_cvt_pk_bf16_f32 v154, v104, v105
  v_cvt_pk_bf16_f32 v155, v106, v107
  v_mfma_f32_16x16x32_bf16 v[68:71], a[248:251], a[144:147], 0
  v_exp_f32 v183, v183
  v_mfma_f32_16x16x32_bf16 v[68:71], a[244:247], a[156:159], v[68:71]
  v_exp_f32 v176, v176
  v_mfma_f32_16x16x32_bf16 v[68:71], a[252:255], a[168:171], v[68:71]
  v_mul_f32 v100, s42, v100
  v_mul_f32 v101, s42, v101
  v_mfma_f32_16x16x32_bf16 v[68:71], v[144:147], a[180:183], v[68:71]
  v_mul_f32 v102, s42, v102
  v_mul_f32 v103, s42, v103
  v_cvt_pk_bf16_f32 v22, v100, v101
  v_cvt_pk_bf16_f32 v23, v102, v103
  v_mfma_f32_16x16x32_bf16 v[68:71], v[148:151], a[192:195], v[68:71]
  s_waitcnt vmcnt(6) lgkmcnt(0)
  s_barrier
  v_mfma_f32_16x16x32_bf16 v[68:71], v[172:175], a[204:207], v[68:71]
  v_exp_f32 v177, v177
  v_mfma_f32_16x16x32_bf16 v[100:103], v[120:123], v[152:155], v[48:51]
  v_exp_f32 v178, v178
  v_mfma_f32_16x16x32_bf16 v[100:103], v[122:125], v[20:23], v[100:103]
  v_exp_f32 v179, v179
  v_mfma_f32_16x16x32_bf16 v[104:107], v[128:131], v[152:155], v[44:47]
  v_cvt_pk_bf16_f32 v76, v76, v77
  v_cvt_pk_bf16_f32 v77, v78, v79
  v_mfma_f32_16x16x32_bf16 v[104:107], v[130:133], v[20:23], v[104:107]
  v_cvt_pk_bf16_f32 v110, v68, v69
  v_cvt_pk_bf16_f32 v111, v70, v71
  v_mfma_f32_16x16x32_bf16 v[72:75], v[136:139], v[152:155], v[40:43]
  v_cvt_pk_bf16_f32 v78, v80, v81
  v_cvt_pk_bf16_f32 v79, v82, v83
  v_mfma_f32_16x16x32_bf16 v[72:75], v[138:141], v[20:23], v[72:75]
  v_cvt_pk_bf16_f32 v80, v180, v181
  v_cvt_pk_bf16_f32 v81, v182, v183
  v_mfma_f32_16x16x32_bf16 v[68:71], v[164:167], v[152:155], v[36:39]
  v_cvt_pk_bf16_f32 v82, v176, v177
  v_cvt_pk_bf16_f32 v83, v178, v179
  v_mfma_f32_16x16x32_bf16 v[68:71], v[166:169], v[20:23], v[68:71]
  ds_read_b128 v[180:183], v3 offset:0
  ds_read_b128 v[120:123], v3 offset:4096
  v_mfma_f32_16x16x32_bf16 v[136:139], v[172:175], a[208:211], 0
  ds_read_b128 v[128:131], v3 offset:8192
  ds_read_b128 v[124:127], v3 offset:12288
  v_mfma_f32_16x16x32_bf16 v[136:139], v[148:151], a[196:199], v[136:139]
  ds_read_b128 v[132:135], v3 offset:16384
  ds_read_b128 v[176:179], v3 offset:20480
  v_mfma_f32_16x16x32_bf16 v[136:139], v[144:147], a[184:187], v[136:139]
  v_exp_f32 v84, v84
  v_mfma_f32_16x16x32_bf16 v[136:139], a[252:255], a[172:175], v[136:139]
  v_exp_f32 v85, v85
  v_mfma_f32_16x16x32_bf16 v[136:139], a[244:247], a[160:163], v[136:139]
  v_exp_f32 v86, v86
  v_mfma_f32_16x16x32_bf16 v[136:139], a[248:251], a[148:151], v[136:139]
  v_exp_f32 v87, v87
  v_mfma_f32_16x16x32_bf16 v[164:167], a[248:251], a[152:155], 0
  v_exp_f32 v88, v88
  v_mfma_f32_16x16x32_bf16 v[164:167], a[244:247], a[164:167], v[164:167]
  v_exp_f32 v89, v89
  v_mfma_f32_16x16x32_bf16 v[164:167], a[252:255], a[176:179], v[164:167]
  v_exp_f32 v90, v90
  v_mfma_f32_16x16x32_bf16 v[164:167], v[144:147], a[188:191], v[164:167]
  v_exp_f32 v91, v91
  v_mfma_f32_16x16x32_bf16 v[164:167], v[148:151], a[200:203], v[164:167]
  v_cvt_pk_bf16_f32 v114, v136, v137
  v_cvt_pk_bf16_f32 v115, v138, v139
  v_mfma_f32_16x16x32_bf16 v[164:167], v[172:175], a[212:215], v[164:167]
L_hop_2_0:
  s_cbranch_execz L_hop_2_1
  v_add_u32 v0, s28, v2
  v_xor_b32 v1, 64, v0
  s_waitcnt lgkmcnt(0)
  s_nop 1
L_loop:
  v_mfma_f32_16x16x32_bf16 v[148:151], v[180:183], v[184:187], 0
  v_exp_f32 v160, v160
  v_mfma_f32_16x16x32_bf16 v[148:151], v[120:123], v[200:203], v[148:151]
  v_exp_f32 v161, v161
  v_mfma_f32_16x16x32_bf16 v[148:151], v[128:131], v[216:219], v[148:151]
  v_cvt_pk_bf16_f32 v118, v164, v165
  v_cvt_pk_bf16_f32 v119, v166, v167
  v_mfma_f32_16x16x32_bf16 v[148:151], v[124:127], v[232:235], v[148:151]
  v_exp_f32 v162, v162
  v_mfma_f32_16x16x32_bf16 v[148:151], v[132:135], v[248:251], v[148:151]
  v_exp_f32 v163, v163
  v_mfma_f32_16x16x32_bf16 v[148:151], v[176:179], a[224:227], v[148:151]
  v_exp_f32 v156, v156
  v_mfma_f32_16x16x32_bf16 v[168:171], v[176:179], a[228:231], 0
  v_exp_f32 v157, v157
  v_mfma_f32_16x16x32_bf16 v[168:171], v[132:135], v[252:255], v[168:171]
  v_exp_f32 v158, v158
  v_mfma_f32_16x16x32_bf16 v[168:171], v[124:127], v[236:239], v[168:171]
  ds_read_b128 v[164:167], v4 offset:0
  v_cvt_pk_bf16_f32 v84, v84, v85
  v_mfma_f32_16x16x32_bf16 v[168:171], v[128:131], v[220:223], v[168:171]
  ds_read_b128 v[172:175], v4 offset:4096
  v_cvt_pk_bf16_f32 v85, v86, v87
  v_mfma_f32_16x16x32_bf16 v[168:171], v[120:123], v[204:207], v[168:171]
  ds_read_b128 v[144:147], v4 offset:8192
  v_cvt_pk_bf16_f32 v86, v88, v89
  v_mfma_f32_16x16x32_bf16 v[168:171], v[180:183], v[188:191], v[168:171]
  ds_read_b128 v[140:143], v4 offset:12288
  v_cvt_pk_bf16_f32 v87, v90, v91
  v_mfma_f32_16x16x32_bf16 v[152:155], v[180:183], v[192:195], 0
  ds_read_b128 a[252:255], v4 offset:16384
  v_cvt_pk_bf16_f32 v88, v160, v161
  v_mfma_f32_16x16x32_bf16 v[152:155], v[120:123], v[208:211], v[152:155]
  ds_read_b128 v[136:139], v4 offset:20480
  v_cvt_pk_bf16_f32 v89, v162, v163
  v_mfma_f32_16x16x32_bf16 v[152:155], v[128:131], v[224:227], v[152:155]
  v_cvt_pk_bf16_f32 v148, v148, v168
  v_cvt_pk_bf16_f32 v149, v149, v169
  v_mfma_f32_16x16x32_bf16 v[152:155], v[124:127], v[240:243], v[152:155]
  v_cvt_pk_bf16_f32 v150, v150, v170
  v_cvt_pk_bf16_f32 v151, v151, v171
  v_mfma_f32_16x16x32_bf16 v[152:155], v[132:135], a[216:219], v[152:155]
  buffer_store_dword v148, v7, s[24:27], s33 offen offset:0 nt
  v_mfma_f32_16x16x32_bf16 v[152:155], v[176:179], a[232:235], v[152:155]
  v_exp_f32 v159, v159
  v_mfma_f32_16x16x32_bf16 v[160:163], v[176:179], a[236:239], 0
  v_cvt_pk_bf16_f32 v90, v156, v157
  v_cvt_pk_bf16_f32 v91, v158, v159
  v_mfma_f32_16x16x32_bf16 v[160:163], v[132:135], a[220:223], v[160:163]
  buffer_store_dword v149, v7, s[24:27], s33 offen offset:384 nt
  v_mfma_f32_16x16x32_bf16 v[160:163], v[124:127], v[244:247], v[160:163]
  ds_read_b128 a[244:247], v3 offset:512
  v_mfma_f32_16x16x32_bf16 v[160:163], v[128:131], v[228:231], v[160:163]
  ds_read_b128 a[248:251], v3 offset:4608
  v_mfma_f32_16x16x32_bf16 v[160:163], v[120:123], v[212:215], v[160:163]
  buffer_store_dword v150, v7, s[24:27], s33 offen offset:768 nt
  v_mfma_f32_16x16x32_bf16 v[160:163], v[180:183], v[196:199], v[160:163]
  s_waitcnt lgkmcnt(2)
  ds_read_b128 v[168:171], v3 offset:8704
  v_mfma_f32_16x16x32_bf16 v[132:135], v[164:167], v[184:187], 0
  ds_read_b128 v[120:123], v3 offset:12800
  v_mfma_f32_16x16x32_bf16 v[132:135], v[172:175], v[200:203], v[132:135]
  buffer_store_dword v151, v7, s[24:27], s33 offen offset:1152 nt
  v_mfma_f32_16x16x32_bf16 v[132:135], v[144:147], v[216:219], v[132:135]
  v_cvt_pk_bf16_f32 v152, v152, v160
  v_cvt_pk_bf16_f32 v153, v153, v161
  v_mfma_f32_16x16x32_bf16 v[132:135], v[140:143], v[232:235], v[132:135]
  v_cvt_pk_bf16_f32 v154, v154, v162
  v_cvt_pk_bf16_f32 v155, v155, v163
  v_mfma_f32_16x16x32_bf16 v[132:135], a[252:255], v[248:251], v[132:135]
  buffer_store_dword v152, v8, s[24:27], s33 offen offset:0 nt
  v_mfma_f32_16x16x32_bf16 v[132:135], v[136:139], a[224:227], v[132:135]
  ds_read_b128 v[128:131], v3 offset:16896
  v_mfma_f32_16x16x32_bf16 v[124:127], v[136:139], a[228:231], 0
  ds_read_b128 v[148:151], v3 offset:20992
  v_xor_b32 v3, 40960, v3
  v_mfma_f32_16x16x32_bf16 v[124:127], a[252:255], v[252:255], v[124:127]
  buffer_store_dword v153, v8, s[24:27], s33 offen offset:384 nt
  v_mfma_f32_16x16x32_bf16 v[124:127], v[140:143], v[236:239], v[124:127]
  v_exp_f32 v100, v100
  v_mfma_f32_16x16x32_bf16 v[124:127], v[144:147], v[220:223], v[124:127]
  v_exp_f32 v101, v101
  v_mfma_f32_16x16x32_bf16 v[124:127], v[172:175], v[204:207], v[124:127]
  buffer_store_dword v154, v8, s[24:27], s33 offen offset:768 nt
  v_mfma_f32_16x16x32_bf16 v[124:127], v[164:167], v[188:191], v[124:127]
  s_waitcnt lgkmcnt(0)
  v_exp_f32 v102, v102
  v_mfma_f32_16x16x32_bf16 v[136:139], a[244:247], v[184:187], 0
  v_exp_f32 v103, v103
  v_mfma_f32_16x16x32_bf16 v[136:139], a[248:251], v[200:203], v[136:139]
  buffer_store_dword v155, v8, s[24:27], s33 offen offset:1152 nt
  v_mfma_f32_16x16x32_bf16 v[136:139], v[168:171], v[216:219], v[136:139]
  v_cvt_pk_bf16_f32 v132, v132, v124
  v_cvt_pk_bf16_f32 v133, v133, v125
  v_mfma_f32_16x16x32_bf16 v[136:139], v[120:123], v[232:235], v[136:139]
  v_cvt_pk_bf16_f32 v134, v134, v126
  v_cvt_pk_bf16_f32 v135, v135, v127
  v_mfma_f32_16x16x32_bf16 v[136:139], v[128:131], v[248:251], v[136:139]
  buffer_store_dword v132, v7, s[24:27], s34 offen offset:0 nt
  v_mfma_f32_16x16x32_bf16 v[136:139], v[148:151], a[224:227], v[136:139]
  v_exp_f32 v104, v104
  v_mfma_f32_16x16x32_bf16 v[152:155], v[148:151], a[228:231], 0
  v_exp_f32 v105, v105
  v_mfma_f32_16x16x32_bf16 v[152:155], v[128:131], v[252:255], v[152:155]
  buffer_store_dword v133, v7, s[24:27], s34 offen offset:384 nt
  v_mfma_f32_16x16x32_bf16 v[152:155], v[120:123], v[236:239], v[152:155]
  ds_read_b128 v[124:127], v4 offset:512
  v_cvt_pk_bf16_f32 v100, v100, v101
  v_mfma_f32_16x16x32_bf16 v[152:155], v[168:171], v[220:223], v[152:155]
  ds_read_b128 v[140:143], v4 offset:4608
  v_cvt_pk_bf16_f32 v101, v102, v103
  v_mfma_f32_16x16x32_bf16 v[152:155], a[248:251], v[204:207], v[152:155]
  buffer_store_dword v134, v7, s[24:27], s34 offen offset:768 nt
  v_mfma_f32_16x16x32_bf16 v[152:155], a[244:247], v[188:191], v[152:155]
  ds_read_b128 v[156:159], v4 offset:8704
  v_cvt_pk_bf16_f32 v102, v104, v105
  v_mfma_f32_16x16x32_bf16 v[144:147], a[244:247], v[192:195], 0
  ds_read_b128 v[160:163], v4 offset:12800
  v_mfma_f32_16x16x32_bf16 v[144:147], a[248:251], v[208:211], v[144:147]
  buffer_store_dword v135, v7, s[24:27], s34 offen offset:1152 nt
  v_mfma_f32_16x16x32_bf16 v[144:147], v[168:171], v[224:227], v[144:147]
  v_cvt_pk_bf16_f32 v136, v136, v152
  v_cvt_pk_bf16_f32 v137, v137, v153
  v_mfma_f32_16x16x32_bf16 v[144:147], v[120:123], v[240:243], v[144:147]
  v_cvt_pk_bf16_f32 v138, v138, v154
  v_cvt_pk_bf16_f32 v139, v139, v155
  v_mfma_f32_16x16x32_bf16 v[144:147], v[128:131], a[216:219], v[144:147]
  buffer_store_dword v136, v7, s[24:27], s35 offen offset:0 nt
  v_mfma_f32_16x16x32_bf16 v[144:147], v[148:151], a[232:235], v[144:147]
  ds_read_b128 v[132:135], v4 offset:16896
  v_mfma_f32_16x16x32_bf16 v[164:167], v[148:151], a[236:239], 0
  ds_read_b128 v[152:155], v4 offset:20992
  v_xor_b32 v4, 40960, v4
  v_mfma_f32_16x16x32_bf16 v[164:167], v[128:131], a[220:223], v[164:167]
  buffer_store_dword v137, v7, s[24:27], s35 offen offset:384 nt
  v_mfma_f32_16x16x32_bf16 v[164:167], v[120:123], v[244:247], v[164:167]
  v_exp_f32 v106, v106
  v_mfma_f32_16x16x32_bf16 v[164:167], v[168:171], v[228:231], v[164:167]
  v_exp_f32 v107, v107
  v_mfma_f32_16x16x32_bf16 v[164:167], a[248:251], v[212:215], v[164:167]
  buffer_store_dword v138, v7, s[24:27], s35 offen offset:768 nt
  v_mfma_f32_16x16x32_bf16 v[164:167], a[244:247], v[196:199], v[164:167]
  s_waitcnt lgkmcnt(0)
  v_exp_f32 v72, v72
  v_mfma_f32_16x16x32_bf16 v[120:123], v[124:127], v[184:187], 0
  v_exp_f32 v73, v73
  v_mfma_f32_16x16x32_bf16 v[120:123], v[140:143], v[200:203], v[120:123]
  buffer_store_dword v139, v7, s[24:27], s35 offen offset:1152 nt
  v_mfma_f32_16x16x32_bf16 v[120:123], v[156:159], v[216:219], v[120:123]
  v_cvt_pk_bf16_f32 v144, v144, v164
  v_cvt_pk_bf16_f32 v145, v145, v165
  v_mfma_f32_16x16x32_bf16 v[120:123], v[160:163], v[232:235], v[120:123]
  v_cvt_pk_bf16_f32 v146, v146, v166
  v_cvt_pk_bf16_f32 v147, v147, v167
  v_mfma_f32_16x16x32_bf16 v[120:123], v[132:135], v[248:251], v[120:123]
  buffer_store_dword v144, v8, s[24:27], s35 offen offset:0 nt
  v_mfma_f32_16x16x32_bf16 v[120:123], v[152:155], a[224:227], v[120:123]
  v_mov_b64 v[176:177], 0
  v_cvt_pk_bf16_f32 v103, v106, v107
  v_mfma_f32_16x16x32_bf16 v[128:131], v[152:155], a[228:231], 0
  v_exp_f32 v74, v74
  v_mfma_f32_16x16x32_bf16 v[128:131], v[132:135], v[252:255], v[128:131]
  buffer_store_dword v145, v8, s[24:27], s35 offen offset:384 nt
  v_mfma_f32_16x16x32_bf16 v[128:131], v[160:163], v[236:239], v[128:131]
  v_exp_f32 v75, v75
  v_mfma_f32_16x16x32_bf16 v[128:131], v[156:159], v[220:223], v[128:131]
  v_mov_b64 v[152:153], 0
  v_cvt_pk_bf16_f32 v104, v72, v73
  v_mfma_f32_16x16x32_bf16 v[128:131], v[140:143], v[204:207], v[128:131]
  buffer_store_dword v146, v8, s[24:27], s35 offen offset:768 nt
  v_mfma_f32_16x16x32_bf16 v[128:131], v[124:127], v[188:191], v[128:131]
  v_exp_f32 v68, v68
  v_smfmac_f32_16x16x64_bf16 v[176:179], a[240:243], v[92:99], v10
  v_exp_f32 v69, v69
  v_mfma_f32_16x16x32_bf16 v[180:183], v[108:111], v[96:99], 0
  buffer_store_dword v147, v8, s[24:27], s35 offen offset:1152 nt
  v_mfma_f32_16x16x32_bf16 v[180:183], v[56:59], v[92:95], v[180:183]
  v_cvt_pk_bf16_f32 v120, v120, v128
  v_cvt_pk_bf16_f32 v121, v121, v129
  v_mfma_f32_16x16x32_bf16 v[168:171], v[60:63], v[92:95], 0
  v_cvt_pk_bf16_f32 v122, v122, v130
  v_cvt_pk_bf16_f32 v123, v123, v131
  v_mfma_f32_16x16x32_bf16 v[168:171], v[112:115], v[96:99], v[168:171]
  buffer_store_dword v120, v7, s[24:27], s36 offen offset:0 nt
  v_mfma_f32_16x16x32_bf16 v[172:175], v[116:119], v[96:99], 0
  v_mov_b64 v[128:129], 0
  v_cvt_pk_bf16_f32 v105, v74, v75
  v_mfma_f32_16x16x32_bf16 v[172:175], v[64:67], v[92:95], v[172:175]
  v_exp_f32 v70, v70
  v_smfmac_f32_16x16x64_bf16 v[152:155], a[240:243], v[76:83], v10
  buffer_store_dword v121, v7, s[24:27], s36 offen offset:384 nt
  v_mfma_f32_16x16x32_bf16 v[72:75], v[108:111], v[80:83], 0
  v_exp_f32 v71, v71
  v_mfma_f32_16x16x32_bf16 v[72:75], v[56:59], v[76:79], v[72:75]
  v_cvt_pk_bf16_f32 v106, v68, v69
  v_cvt_pk_bf16_f32 v107, v70, v71
  v_mfma_f32_16x16x32_bf16 v[164:167], v[60:63], v[76:79], 0
  buffer_store_dword v122, v7, s[24:27], s36 offen offset:768 nt
  v_mfma_f32_16x16x32_bf16 v[164:167], v[112:115], v[80:83], v[164:167]
  v_mov_b64 v[92:93], 0
  v_add_f32 v176, v176, v177
  v_mfma_f32_16x16x32_bf16 v[160:163], v[116:119], v[80:83], 0
  ds_read_b128 v[140:143], v0 offset:0
  v_add_f32 v152, v152, v153
  v_mfma_f32_16x16x32_bf16 v[160:163], v[64:67], v[76:79], v[160:163]
  buffer_store_dword v123, v7, s[24:27], s36 offen offset:1152 nt
  v_smfmac_f32_16x16x64_bf16 v[128:131], a[240:243], v[84:91], v10
  ds_read_b128 v[156:159], v1 offset:0
  v_mfma_f32_16x16x32_bf16 v[124:127], v[108:111], v[88:91], 0
  ds_read_b128 v[148:151], v0 offset:8192
  v_mfma_f32_16x16x32_bf16 v[124:127], v[56:59], v[84:87], v[124:127]
  ds_read_b128 v[144:147], v1 offset:8192
  v_mfma_f32_16x16x32_bf16 v[120:123], v[60:63], v[84:87], 0
  ds_read_b128 v[136:139], v0 offset:16384
  v_mfma_f32_16x16x32_bf16 v[120:123], v[112:115], v[88:91], v[120:123]
  ds_read_b128 v[132:135], v1 offset:16384
  v_mfma_f32_16x16x32_bf16 v[96:99], v[116:119], v[88:91], 0
  v_rcp_f32 v178, v176
  v_mfma_f32_16x16x32_bf16 v[96:99], v[64:67], v[84:87], v[96:99]
  v_mul_f32 v180, v178, v180
  v_mul_f32 v181, v178, v181
  v_smfmac_f32_16x16x64_bf16 v[92:95], a[240:243], v[100:107], v10
  v_mul_f32 v182, v178, v182
  v_mul_f32 v183, v178, v183
  v_mfma_f32_16x16x32_bf16 v[84:87], v[108:111], v[104:107], 0
  v_cvt_pk_bf16_f32 v180, v180, v181
  v_cvt_pk_bf16_f32 v181, v182, v183
  v_mfma_f32_16x16x32_bf16 v[84:87], v[56:59], v[100:103], v[84:87]
  v_mul_f32 v168, v178, v168
  v_mul_f32 v169, v178, v169
  v_mfma_f32_16x16x32_bf16 v[80:83], v[60:63], v[100:103], 0
  v_mul_f32 v170, v178, v170
  v_mul_f32 v171, v178, v171
  v_mfma_f32_16x16x32_bf16 v[80:83], v[112:115], v[104:107], v[80:83]
  v_cvt_pk_bf16_f32 v168, v168, v169
  v_cvt_pk_bf16_f32 v169, v170, v171
  v_mfma_f32_16x16x32_bf16 v[88:91], v[116:119], v[104:107], 0
  v_mul_f32 v172, v178, v172
  v_mul_f32 v173, v178, v173
  v_mfma_f32_16x16x32_bf16 v[88:91], v[64:67], v[100:103], v[88:91]
  s_waitcnt lgkmcnt(0)
  v_mul_f32 v174, v178, v174
  v_mul_f32 v175, v178, v175
  v_mfma_f32_16x16x32_bf16 v[64:67], a[0:3], v[140:143], 0
  v_cvt_pk_bf16_f32 v172, v172, v173
  v_cvt_pk_bf16_f32 v173, v174, v175
  v_mfma_f32_16x16x32_bf16 v[64:67], a[12:15], v[156:159], v[64:67]
  v_max3_f32 v9, v176, v178, v9
  v_add_f32 v128, v128, v129
  v_mfma_f32_16x16x32_bf16 v[64:67], a[24:27], v[148:151], v[64:67]
  ds_write_b32 v5, v180 offset:0
  v_mfma_f32_16x16x32_bf16 v[64:67], a[36:39], v[144:147], v[64:67]
  ds_write_b32 v5, v181 offset:1024
  v_mfma_f32_16x16x32_bf16 v[64:67], a[48:51], v[136:139], v[64:67]
  s_add_u32 m0, s30, 0
  v_rcp_f32 v154, v152
  v_mfma_f32_16x16x32_bf16 v[64:67], a[60:63], v[132:135], v[64:67]
  buffer_load_dwordx4 v6, s[8:11], s31 offen offset:0 nt lds
  v_mfma_f32_16x16x32_bf16 v[60:63], a[64:67], v[132:135], 0
  v_mul_f32 v72, v154, v72
  v_mul_f32 v73, v154, v73
  v_mfma_f32_16x16x32_bf16 v[60:63], a[52:55], v[136:139], v[60:63]
  ds_write_b32 v5, v168 offset:2048
  v_mfma_f32_16x16x32_bf16 v[60:63], a[40:43], v[144:147], v[60:63]
  v_mul_f32 v64, s42, v64
  v_mul_f32 v65, s42, v65
  v_mfma_f32_16x16x32_bf16 v[60:63], a[28:31], v[148:151], v[60:63]
  v_mul_f32 v66, s42, v66
  v_mul_f32 v67, s42, v67
  v_mfma_f32_16x16x32_bf16 v[60:63], a[16:19], v[156:159], v[60:63]
  v_cvt_pk_bf16_f32 v12, v64, v65
  v_cvt_pk_bf16_f32 v13, v66, v67
  v_mfma_f32_16x16x32_bf16 v[60:63], a[4:7], v[140:143], v[60:63]
  ds_write_b32 v5, v169 offset:3072
  v_mfma_f32_16x16x32_bf16 v[56:59], a[8:11], v[140:143], 0
  ds_write_b32 v5, v172 offset:4096
  v_mfma_f32_16x16x32_bf16 v[56:59], a[20:23], v[156:159], v[56:59]
  ds_write_b32 v5, v173 offset:5120
  v_mfma_f32_16x16x32_bf16 v[56:59], a[32:35], v[148:151], v[56:59]
  v_mul_f32 v60, s42, v60
  v_mul_f32 v61, s42, v61
  v_mfma_f32_16x16x32_bf16 v[56:59], a[44:47], v[144:147], v[56:59]
  v_mul_f32 v62, s42, v62
  v_mul_f32 v63, s42, v63
  v_mfma_f32_16x16x32_bf16 v[56:59], a[56:59], v[136:139], v[56:59]
  s_add_u32 m0, s30, 8064
  v_cvt_pk_bf16_f32 v76, v60, v61
  v_cvt_pk_bf16_f32 v77, v62, v63
  v_mfma_f32_16x16x32_bf16 v[56:59], a[68:71], v[132:135], v[56:59]
  buffer_load_dwordx4 v6, s[8:11], s31 offen offset:128 nt lds
  v_mfma_f32_16x16x32_bf16 v[64:67], a[132:135], v[132:135], 0
  v_mul_f32 v74, v154, v74
  v_mul_f32 v75, v154, v75
  v_mfma_f32_16x16x32_bf16 v[64:67], a[120:123], v[136:139], v[64:67]
  v_cvt_pk_bf16_f32 v72, v72, v73
  v_cvt_pk_bf16_f32 v73, v74, v75
  v_mfma_f32_16x16x32_bf16 v[64:67], a[108:111], v[144:147], v[64:67]
  v_mul_f32 v56, s42, v56
  v_mul_f32 v57, s42, v57
  v_mfma_f32_16x16x32_bf16 v[64:67], a[96:99], v[148:151], v[64:67]
  v_mul_f32 v58, s42, v58
  v_mul_f32 v59, s42, v59
  v_mfma_f32_16x16x32_bf16 v[64:67], a[84:87], v[156:159], v[64:67]
  v_cvt_pk_bf16_f32 v78, v56, v57
  v_cvt_pk_bf16_f32 v79, v58, v59
  v_mfma_f32_16x16x32_bf16 v[64:67], a[72:75], v[140:143], v[64:67]
  v_mul_f32 v164, v154, v164
  v_mul_f32 v165, v154, v165
  v_mfma_f32_16x16x32_bf16 v[56:59], a[76:79], v[140:143], 0
  v_mul_f32 v166, v154, v166
  v_mul_f32 v167, v154, v167
  v_mfma_f32_16x16x32_bf16 v[56:59], a[88:91], v[156:159], v[56:59]
  v_cvt_pk_bf16_f32 v164, v164, v165
  v_cvt_pk_bf16_f32 v165, v166, v167
  v_mfma_f32_16x16x32_bf16 v[56:59], a[100:103], v[148:151], v[56:59]
  v_cvt_pk_bf16_f32 v68, v64, v65
  v_cvt_pk_bf16_f32 v69, v66, v67
  v_mfma_f32_16x16x32_bf16 v[56:59], a[112:115], v[144:147], v[56:59]
  v_mul_f32 v160, v154, v160
  v_mul_f32 v161, v154, v161
  v_mfma_f32_16x16x32_bf16 v[56:59], a[124:127], v[136:139], v[56:59]
  s_add_u32 m0, s30, 16128
  v_mul_f32 v162, v154, v162
  v_mul_f32 v163, v154, v163
  v_mfma_f32_16x16x32_bf16 v[56:59], a[136:139], v[132:135], v[56:59]
  buffer_load_dwordx4 v6, s[8:11], s31 offen offset:256 nt lds
  v_mfma_f32_16x16x32_bf16 v[60:63], a[140:143], v[132:135], 0
  v_cvt_pk_bf16_f32 v160, v160, v161
  v_cvt_pk_bf16_f32 v161, v162, v163
  v_mfma_f32_16x16x32_bf16 v[60:63], a[128:131], v[136:139], v[60:63]
  v_max3_f32 v9, v152, v154, v9
  v_add_f32 v92, v92, v93
  v_mfma_f32_16x16x32_bf16 v[60:63], a[116:119], v[144:147], v[60:63]
  v_cvt_pk_bf16_f32 v70, v56, v57
  v_cvt_pk_bf16_f32 v71, v58, v59
  v_mfma_f32_16x16x32_bf16 v[60:63], a[104:107], v[148:151], v[60:63]
  ds_write_b32 v5, v72 offset:256
  v_mfma_f32_16x16x32_bf16 v[60:63], a[92:95], v[156:159], v[60:63]
  ds_write_b32 v5, v73 offset:1280
  v_mfma_f32_16x16x32_bf16 v[60:63], a[80:83], v[140:143], v[60:63]
  ds_write_b32 v5, v164 offset:2304
  v_mfma_f32_16x16x32_bf16 v[64:67], v[140:143], a[144:147], 0
  ds_write_b32 v5, v165 offset:3328
  v_mfma_f32_16x16x32_bf16 v[64:67], v[156:159], a[156:159], v[64:67]
  ds_write_b32 v5, v160 offset:4352
  v_mfma_f32_16x16x32_bf16 v[64:67], v[148:151], a[168:171], v[64:67]
  v_cvt_pk_bf16_f32 v72, v60, v61
  v_cvt_pk_bf16_f32 v73, v62, v63
  v_mfma_f32_16x16x32_bf16 v[64:67], v[144:147], a[180:183], v[64:67]
  ds_read_b128 a[244:247], v0 offset:2048
  v_mfma_f32_16x16x32_bf16 v[64:67], v[136:139], a[192:195], v[64:67]
  s_add_u32 m0, s30, 4096
  ds_read_b128 a[248:251], v1 offset:2048
  v_mfma_f32_16x16x32_bf16 v[64:67], v[132:135], a[204:207], v[64:67]
  buffer_load_dwordx4 v6, s[8:11], s32 offen offset:0 nt lds
  v_mfma_f32_16x16x32_bf16 v[116:119], v[132:135], a[208:211], 0
  ds_read_b128 a[252:255], v0 offset:10240
  v_mfma_f32_16x16x32_bf16 v[116:119], v[136:139], a[196:199], v[116:119]
  ds_write_b32 v5, v161 offset:5376
  v_mfma_f32_16x16x32_bf16 v[116:119], v[144:147], a[184:187], v[116:119]
  v_cvt_pk_bf16_f32 v56, v64, v65
  v_cvt_pk_bf16_f32 v57, v66, v67
  v_mfma_f32_16x16x32_bf16 v[116:119], v[148:151], a[172:175], v[116:119]
  ds_read_b128 v[112:115], v1 offset:10240
  v_mfma_f32_16x16x32_bf16 v[116:119], v[156:159], a[160:163], v[116:119]
  ds_read_b128 v[104:107], v0 offset:18432
  v_mfma_f32_16x16x32_bf16 v[116:119], v[140:143], a[148:151], v[116:119]
  ds_read_b128 v[108:111], v1 offset:18432
  v_mfma_f32_16x16x32_bf16 v[100:103], v[140:143], a[152:155], 0
  v_rcp_f32 v130, v128
  v_mfma_f32_16x16x32_bf16 v[100:103], v[156:159], a[164:167], v[100:103]
  v_mul_f32 v124, v130, v124
  v_mul_f32 v125, v130, v125
  v_mfma_f32_16x16x32_bf16 v[100:103], v[148:151], a[176:179], v[100:103]
  v_cvt_pk_bf16_f32 v60, v116, v117
  v_cvt_pk_bf16_f32 v61, v118, v119
  v_mfma_f32_16x16x32_bf16 v[100:103], v[144:147], a[188:191], v[100:103]
  s_waitcnt lgkmcnt(0)
  v_mul_f32 v126, v130, v126
  v_mul_f32 v127, v130, v127
  v_mfma_f32_16x16x32_bf16 v[100:103], v[136:139], a[200:203], v[100:103]
  s_add_u32 m0, s30, 12160
  v_cvt_pk_bf16_f32 v124, v124, v125
  v_cvt_pk_bf16_f32 v125, v126, v127
  v_mfma_f32_16x16x32_bf16 v[100:103], v[132:135], a[212:215], v[100:103]
  buffer_load_dwordx4 v6, s[8:11], s32 offen offset:128 nt lds
  v_mfma_f32_16x16x32_bf16 v[136:139], a[0:3], a[244:247], 0
  v_mul_f32 v120, v130, v120
  v_mul_f32 v121, v130, v121
  v_mfma_f32_16x16x32_bf16 v[136:139], a[12:15], a[248:251], v[136:139]
  v_mul_f32 v122, v130, v122
  v_mul_f32 v123, v130, v123
  v_mfma_f32_16x16x32_bf16 v[136:139], a[24:27], a[252:255], v[136:139]
  v_cvt_pk_bf16_f32 v64, v100, v101
  v_cvt_pk_bf16_f32 v65, v102, v103
  v_mfma_f32_16x16x32_bf16 v[136:139], a[36:39], v[112:115], v[136:139]
  v_cvt_pk_bf16_f32 v120, v120, v121
  v_cvt_pk_bf16_f32 v121, v122, v123
  v_mfma_f32_16x16x32_bf16 v[136:139], a[48:51], v[104:107], v[136:139]
  v_mul_f32 v96, v130, v96
  v_mul_f32 v97, v130, v97
  v_mfma_f32_16x16x32_bf16 v[136:139], a[60:63], v[108:111], v[136:139]
  v_mul_f32 v98, v130, v98
  v_mul_f32 v99, v130, v99
  v_mfma_f32_16x16x32_bf16 v[132:135], a[64:67], v[108:111], 0
  v_cvt_pk_bf16_f32 v96, v96, v97
  v_cvt_pk_bf16_f32 v97, v98, v99
  v_mfma_f32_16x16x32_bf16 v[132:135], a[52:55], v[104:107], v[132:135]
  v_max3_f32 v9, v128, v130, v9
  v_mfma_f32_16x16x32_bf16 v[132:135], a[40:43], v[112:115], v[132:135]
  v_mul_f32 v136, s42, v136
  v_mul_f32 v137, s42, v137
  v_mfma_f32_16x16x32_bf16 v[132:135], a[28:31], a[252:255], v[132:135]
  v_mul_f32 v138, s42, v138
  v_mul_f32 v139, s42, v139
  v_mfma_f32_16x16x32_bf16 v[132:135], a[16:19], a[248:251], v[132:135]
  s_add_u32 m0, s30, 20224
  v_cvt_pk_bf16_f32 v100, v136, v137
  v_cvt_pk_bf16_f32 v101, v138, v139
  v_mfma_f32_16x16x32_bf16 v[132:135], a[4:7], a[244:247], v[132:135]
  buffer_load_dwordx4 v6, s[8:11], s32 offen offset:256 nt lds
  v_mfma_f32_16x16x32_bf16 v[116:119], a[8:11], a[244:247], 0
  s_add_u32 s33, s31, s37
  v_rcp_f32 v94, v92
  v_mfma_f32_16x16x32_bf16 v[116:119], a[20:23], a[248:251], v[116:119]
  s_add_u32 s34, s31, s38
  ds_write_b32 v5, v124 offset:512
  v_mfma_f32_16x16x32_bf16 v[116:119], a[32:35], a[252:255], v[116:119]
  s_add_u32 s35, s31, s39
  v_mul_f32 v132, s42, v132
  v_mul_f32 v133, s42, v133
  v_mfma_f32_16x16x32_bf16 v[116:119], a[44:47], v[112:115], v[116:119]
  s_add_u32 s36, s31, s40
  v_mul_f32 v134, s42, v134
  v_mul_f32 v135, s42, v135
  v_mfma_f32_16x16x32_bf16 v[116:119], a[56:59], v[104:107], v[116:119]
  s_add_u32 s31, s31, s43
  v_cvt_pk_bf16_f32 v102, v132, v133
  v_cvt_pk_bf16_f32 v103, v134, v135
  v_mfma_f32_16x16x32_bf16 v[116:119], a[68:71], v[108:111], v[116:119]
  s_add_u32 s32, s32, s43
  ds_write_b32 v5, v125 offset:1536
  v_mfma_f32_16x16x32_bf16 v[128:131], a[132:135], v[108:111], 0
  s_mov_b32 s5, s28
  ds_write_b32 v5, v120 offset:2560
  v_mfma_f32_16x16x32_bf16 v[128:131], a[120:123], v[104:107], v[128:131]
  s_mov_b32 s28, s29
  ds_write_b32 v5, v121 offset:3584
  v_mfma_f32_16x16x32_bf16 v[128:131], a[108:111], v[112:115], v[128:131]
  s_mov_b32 s29, s30
  ds_write_b32 v5, v96 offset:4608
  v_mfma_f32_16x16x32_bf16 v[128:131], a[96:99], a[252:255], v[128:131]
  s_mov_b32 s30, s5
  ds_write_b32 v5, v97 offset:5632
  v_mfma_f32_16x16x32_bf16 v[128:131], a[84:87], a[248:251], v[128:131]
  v_mul_f32 v116, s42, v116
  v_mul_f32 v117, s42, v117
  v_mfma_f32_16x16x32_bf16 v[128:131], a[72:75], a[244:247], v[128:131]
  v_mul_f32 v118, s42, v118
  v_mul_f32 v119, s42, v119
  v_mfma_f32_16x16x32_bf16 v[96:99], a[76:79], a[244:247], 0
  v_cvt_pk_bf16_f32 v16, v116, v117
  v_cvt_pk_bf16_f32 v17, v118, v119
  v_mfma_f32_16x16x32_bf16 v[96:99], a[88:91], a[248:251], v[96:99]
  v_mul_f32 v84, v94, v84
  v_mul_f32 v85, v94, v85
  v_mfma_f32_16x16x32_bf16 v[96:99], a[100:103], a[252:255], v[96:99]
  s_add_u32 s59, s59, 1
  v_cvt_pk_bf16_f32 v120, v128, v129
  v_cvt_pk_bf16_f32 v121, v130, v131
  v_mfma_f32_16x16x32_bf16 v[96:99], a[112:115], v[112:115], v[96:99]
  s_cmp_eq_u32 s59, 4
  v_mul_f32 v86, v94, v86
  v_mul_f32 v87, v94, v87
  v_mfma_f32_16x16x32_bf16 v[96:99], a[124:127], v[104:107], v[96:99]
  s_cselect_b32 s18, s16, s18
  v_cvt_pk_bf16_f32 v84, v84, v85
  v_cvt_pk_bf16_f32 v85, v86, v87
  v_mfma_f32_16x16x32_bf16 v[96:99], a[136:139], v[108:111], v[96:99]
  s_cselect_b32 s15, s60, s15
  v_mul_f32 v80, v94, v80
  v_mul_f32 v81, v94, v81
  v_mfma_f32_16x16x32_bf16 v[116:119], a[140:143], v[108:111], 0
  s_cmp_eq_u32 s59, 8
  v_mul_f32 v82, v94, v82
  v_mul_f32 v83, v94, v83
  v_mfma_f32_16x16x32_bf16 v[116:119], a[128:131], v[104:107], v[116:119]
  s_cselect_b32 s19, s16, s19
  v_cvt_pk_bf16_f32 v80, v80, v81
  v_cvt_pk_bf16_f32 v81, v82, v83
  v_mfma_f32_16x16x32_bf16 v[116:119], a[116:119], v[112:115], v[116:119]
  s_cselect_b32 s99, s60, s99
  v_cvt_pk_bf16_f32 v122, v96, v97
  v_cvt_pk_bf16_f32 v123, v98, v99
  v_mfma_f32_16x16x32_bf16 v[116:119], a[104:107], a[252:255], v[116:119]
  s_memrealtime s[16:17]
  v_mul_f32 v88, v94, v88
  v_mul_f32 v89, v94, v89
  v_mfma_f32_16x16x32_bf16 v[116:119], a[92:95], a[248:251], v[116:119]
  s_memtime s[60:61]
  v_mul_f32 v90, v94, v90
  v_mul_f32 v91, v94, v91
  v_mfma_f32_16x16x32_bf16 v[116:119], a[80:83], a[244:247], v[116:119]
  v_cvt_pk_bf16_f32 v88, v88, v89
  v_cvt_pk_bf16_f32 v89, v90, v91
  v_mfma_f32_16x16x32_bf16 v[132:135], a[244:247], a[144:147], 0
  v_max3_f32 v9, v92, v94, v9
  v_mfma_f32_16x16x32_bf16 v[132:135], a[248:251], a[156:159], v[132:135]
  ds_write_b32 v5, v84 offset:768
  v_mfma_f32_16x16x32_bf16 v[132:135], a[252:255], a[168:171], v[132:135]
  v_cvt_pk_bf16_f32 v124, v116, v117
  v_cvt_pk_bf16_f32 v125, v118, v119
  v_mfma_f32_16x16x32_bf16 v[132:135], v[112:115], a[180:183], v[132:135]
  ds_read_b128 v[92:95], v0 offset:4096
  v_mfma_f32_16x16x32_bf16 v[132:135], v[104:107], a[192:195], v[132:135]
  ds_read_b128 v[96:99], v1 offset:4096
  v_mfma_f32_16x16x32_bf16 v[132:135], v[108:111], a[204:207], v[132:135]
  ds_read_b128 v[136:139], v0 offset:12288
  v_mfma_f32_16x16x32_bf16 v[128:131], v[108:111], a[208:211], 0
  ds_read_b128 v[116:119], v1 offset:12288
  v_mfma_f32_16x16x32_bf16 v[128:131], v[104:107], a[196:199], v[128:131]
  ds_write_b32 v5, v85 offset:1792
  v_mfma_f32_16x16x32_bf16 v[128:131], v[112:115], a[184:187], v[128:131]
  v_cvt_pk_bf16_f32 v58, v132, v133
  v_cvt_pk_bf16_f32 v59, v134, v135
  v_mfma_f32_16x16x32_bf16 v[128:131], a[252:255], a[172:175], v[128:131]
  ds_write_b32 v5, v80 offset:2816
  v_mfma_f32_16x16x32_bf16 v[128:131], a[248:251], a[160:163], v[128:131]
  ds_write_b32 v5, v81 offset:3840
  v_mfma_f32_16x16x32_bf16 v[128:131], a[244:247], a[148:151], v[128:131]
  ds_write_b32 v5, v88 offset:4864
  v_mfma_f32_16x16x32_bf16 v[132:135], a[244:247], a[152:155], 0
  ds_write_b32 v5, v89 offset:5888
  v_mfma_f32_16x16x32_bf16 v[132:135], a[248:251], a[164:167], v[132:135]
  ds_read_b128 v[80:83], v0 offset:20480
  v_xor_b32 v5, s41, v5
  v_mfma_f32_16x16x32_bf16 v[132:135], a[252:255], a[176:179], v[132:135]
  ds_read_b128 v[84:87], v1 offset:20480
  v_cvt_pk_bf16_f32 v62, v128, v129
  v_mfma_f32_16x16x32_bf16 v[132:135], v[112:115], a[188:191], v[132:135]
  s_waitcnt lgkmcnt(7)
  v_cvt_pk_bf16_f32 v63, v130, v131
  v_mfma_f32_16x16x32_bf16 v[132:135], v[104:107], a[200:203], v[132:135]
  s_bitcmp1_b32 s96, s59
  v_mfma_f32_16x16x32_bf16 v[132:135], v[108:111], a[212:215], v[132:135]
  s_cbranch_scc1 L_k2
L_k2r:
  v_mfma_f32_16x16x32_bf16 v[104:107], a[0:3], v[92:95], 0
  v_mfma_f32_16x16x32_bf16 v[104:107], a[12:15], v[96:99], v[104:107]
  v_mfma_f32_16x16x32_bf16 v[104:107], a[24:27], v[136:139], v[104:107]
  v_cvt_pk_bf16_f32 v66, v132, v133
  v_cvt_pk_bf16_f32 v67, v134, v135
  v_mfma_f32_16x16x32_bf16 v[104:107], a[36:39], v[116:119], v[104:107]
  s_waitcnt lgkmcnt(0)
  v_mfma_f32_16x16x32_bf16 v[104:107], a[48:51], v[80:83], v[104:107]
  v_mfma_f32_16x16x32_bf16 v[104:107], a[60:63], v[84:87], v[104:107]
  v_mfma_f32_16x16x32_bf16 v[88:91], a[64:67], v[84:87], 0
  v_mfma_f32_16x16x32_bf16 v[88:91], a[52:55], v[80:83], v[88:91]
  v_mfma_f32_16x16x32_bf16 v[88:91], a[40:43], v[116:119], v[88:91]
  v_mul_f32 v104, s42, v104
  v_mul_f32 v105, s42, v105
  v_mfma_f32_16x16x32_bf16 v[88:91], a[28:31], v[136:139], v[88:91]
  v_mul_f32 v106, s42, v106
  v_mul_f32 v107, s42, v107
  v_mfma_f32_16x16x32_bf16 v[88:91], a[16:19], v[96:99], v[88:91]
  v_cvt_pk_bf16_f32 v18, v104, v105
  v_cvt_pk_bf16_f32 v19, v106, v107
  v_mfma_f32_16x16x32_bf16 v[88:91], a[4:7], v[92:95], v[88:91]
  v_mfma_f32_16x16x32_bf16 v[108:111], a[8:11], v[92:95], 0
  v_mfma_f32_16x16x32_bf16 v[108:111], a[20:23], v[96:99], v[108:111]
  v_mfma_f32_16x16x32_bf16 v[108:111], a[32:35], v[136:139], v[108:111]
  v_mul_f32 v88, s42, v88
  v_mul_f32 v89, s42, v89
  v_mfma_f32_16x16x32_bf16 v[108:111], a[44:47], v[116:119], v[108:111]
  v_mul_f32 v90, s42, v90
  v_mul_f32 v91, s42, v91
  v_mfma_f32_16x16x32_bf16 v[108:111], a[56:59], v[80:83], v[108:111]
  v_cvt_pk_bf16_f32 v104, v88, v89
  v_cvt_pk_bf16_f32 v105, v90, v91
  v_mfma_f32_16x16x32_bf16 v[108:111], a[68:71], v[84:87], v[108:111]
L_hop_3_0:
  s_cbranch_execz L_hop_3_1
  v_mfma_f32_16x16x32_bf16 v[112:115], a[132:135], v[84:87], 0
  v_mfma_f32_16x16x32_bf16 v[112:115], a[120:123], v[80:83], v[112:115]
  v_mfma_f32_16x16x32_bf16 v[112:115], a[108:111], v[116:119], v[112:115]
  v_mul_f32 v108, s42, v108
  v_mul_f32 v109, s42, v109
  v_mfma_f32_16x16x32_bf16 v[112:115], a[96:99], v[136:139], v[112:115]
  v_mul_f32 v110, s42, v110
  v_mul_f32 v111, s42, v111
  v_mfma_f32_16x16x32_bf16 v[112:115], a[84:87], v[96:99], v[112:115]
  v_cvt_pk_bf16_f32 v106, v108, v109
  v_cvt_pk_bf16_f32 v107, v110, v111
  v_mfma_f32_16x16x32_bf16 v[112:115], a[72:75], v[92:95], v[112:115]
  v_mfma_f32_16x16x32_bf16 v[88:91], a[76:79], v[92:95], 0
  v_mfma_f32_16x16x32_bf16 v[88:91], a[88:91], v[96:99], v[88:91]
  v_mfma_f32_16x16x32_bf16 v[88:91], a[100:103], v[136:139], v[88:91]
  v_cvt_pk_bf16_f32 v128, v112, v113
  v_cvt_pk_bf16_f32 v129, v114, v115
  v_mfma_f32_16x16x32_bf16 v[88:91], a[112:115], v[116:119], v[88:91]
  v_mfma_f32_16x16x32_bf16 v[88:91], a[124:127], v[80:83], v[88:91]
  v_mfma_f32_16x16x32_bf16 v[88:91], a[136:139], v[84:87], v[88:91]
  v_mfma_f32_16x16x32_bf16 v[108:111], a[140:143], v[84:87], 0
  v_mfma_f32_16x16x32_bf16 v[108:111], a[128:131], v[80:83], v[108:111]
  v_mfma_f32_16x16x32_bf16 v[108:111], a[116:119], v[116:119], v[108:111]
  v_cvt_pk_bf16_f32 v130, v88, v89
  v_cvt_pk_bf16_f32 v131, v90, v91
  v_mfma_f32_16x16x32_bf16 v[108:111], a[104:107], v[136:139], v[108:111]
  v_mfma_f32_16x16x32_bf16 v[108:111], a[92:95], v[96:99], v[108:111]
  v_mfma_f32_16x16x32_bf16 v[108:111], a[80:83], v[92:95], v[108:111]
  v_mfma_f32_16x16x32_bf16 v[88:91], v[92:95], a[144:147], 0
  v_mfma_f32_16x16x32_bf16 v[88:91], v[96:99], a[156:159], v[88:91]
  v_mfma_f32_16x16x32_bf16 v[88:91], v[136:139], a[168:171], v[88:91]
  v_cvt_pk_bf16_f32 v132, v108, v109
  v_cvt_pk_bf16_f32 v133, v110, v111
  v_mfma_f32_16x16x32_bf16 v[88:91], v[116:119], a[180:183], v[88:91]
  ds_read_b128 a[252:255], v0 offset:6144
  v_mfma_f32_16x16x32_bf16 v[88:91], v[80:83], a[192:195], v[88:91]
  ds_read_b128 v[144:147], v1 offset:6144
  v_mfma_f32_16x16x32_bf16 v[88:91], v[84:87], a[204:207], v[88:91]
  ds_read_b128 v[148:151], v0 offset:14336
  v_mfma_f32_16x16x32_bf16 v[140:143], v[84:87], a[208:211], 0
  ds_read_b128 a[248:251], v1 offset:14336
  v_mfma_f32_16x16x32_bf16 v[140:143], v[80:83], a[196:199], v[140:143]
  ds_read_b128 a[244:247], v0 offset:22528
  v_mfma_f32_16x16x32_bf16 v[140:143], v[116:119], a[184:187], v[140:143]
  v_cvt_pk_bf16_f32 v108, v88, v89
  v_cvt_pk_bf16_f32 v109, v90, v91
  v_mfma_f32_16x16x32_bf16 v[140:143], v[136:139], a[172:175], v[140:143]
  ds_read_b128 v[152:155], v1 offset:22528
  v_mfma_f32_16x16x32_bf16 v[140:143], v[96:99], a[160:163], v[140:143]
  v_mfma_f32_16x16x32_bf16 v[140:143], v[92:95], a[148:151], v[140:143]
  v_mfma_f32_16x16x32_bf16 v[156:159], v[92:95], a[152:155], 0
  v_mfma_f32_16x16x32_bf16 v[156:159], v[96:99], a[164:167], v[156:159]
  v_mfma_f32_16x16x32_bf16 v[156:159], v[136:139], a[176:179], v[156:159]
  v_cvt_pk_bf16_f32 v112, v140, v141
  v_cvt_pk_bf16_f32 v113, v142, v143
  v_mfma_f32_16x16x32_bf16 v[156:159], v[116:119], a[188:191], v[156:159]
L_k4:
  v_mfma_f32_16x16x32_bf16 v[156:159], v[80:83], a[200:203], v[156:159]
  v_mfma_f32_16x16x32_bf16 v[156:159], v[84:87], a[212:215], v[156:159]
  s_waitcnt lgkmcnt(0)
  v_mfma_f32_16x16x32_bf16 v[88:91], a[72:75], a[252:255], 0
  v_mfma_f32_16x16x32_bf16 v[88:91], a[84:87], v[144:147], v[88:91]
  v_mfma_f32_16x16x32_bf16 v[88:91], a[96:99], v[148:151], v[88:91]
  v_cvt_pk_bf16_f32 v116, v156, v157
  v_cvt_pk_bf16_f32 v117, v158, v159
  v_mfma_f32_16x16x32_bf16 v[88:91], a[108:111], a[248:251], v[88:91]
  v_mfma_f32_16x16x32_bf16 v[88:91], a[120:123], a[244:247], v[88:91]
  s_waitcnt vmcnt(30)
  s_barrier
  v_mfma_f32_16x16x32_bf16 v[88:91], a[132:135], v[152:155], v[88:91]
  v_add_u32 v0, s28, v2
  v_xor_b32 v1, 64, v0
  v_mfma_f32_16x16x32_bf16 v[80:83], a[136:139], v[152:155], 0
  v_mfma_f32_16x16x32_bf16 v[80:83], a[124:127], a[244:247], v[80:83]
  v_mfma_f32_16x16x32_bf16 v[80:83], a[112:115], a[248:251], v[80:83]
  v_cvt_pk_bf16_f32 v136, v88, v89
  v_cvt_pk_bf16_f32 v137, v90, v91
  v_mfma_f32_16x16x32_bf16 v[80:83], a[100:103], v[148:151], v[80:83]
  v_mfma_f32_16x16x32_bf16 v[80:83], a[88:91], v[144:147], v[80:83]
  v_mfma_f32_16x16x32_bf16 v[80:83], a[76:79], a[252:255], v[80:83]
  v_mfma_f32_16x16x32_bf16 v[84:87], a[80:83], a[252:255], 0
  v_mfma_f32_16x16x32_bf16 v[84:87], a[92:95], v[144:147], v[84:87]
  v_mfma_f32_16x16x32_bf16 v[84:87], a[104:107], v[148:151], v[84:87]
  v_cvt_pk_bf16_f32 v138, v80, v81
  v_cvt_pk_bf16_f32 v139, v82, v83
  v_mfma_f32_16x16x32_bf16 v[84:87], a[116:119], a[248:251], v[84:87]
  v_mfma_f32_16x16x32_bf16 v[84:87], a[128:131], a[244:247], v[84:87]
  v_mfma_f32_16x16x32_bf16 v[84:87], a[140:143], v[152:155], v[84:87]
  v_mfma_f32_16x16x32_bf16 v[92:95], v[70:73], v[76:79], v[36:39]
  v_mfma_f32_16x16x32_bf16 v[92:95], v[68:71], v[12:15], v[92:95]
  v_mfma_f32_16x16x32_bf16 v[96:99], v[122:125], v[76:79], v[32:35]
  v_cvt_pk_bf16_f32 v140, v84, v85
  v_cvt_pk_bf16_f32 v141, v86, v87
  v_mfma_f32_16x16x32_bf16 v[96:99], v[120:123], v[12:15], v[96:99]
  v_mfma_f32_16x16x32_bf16 v[172:175], v[130:133], v[76:79], v[28:31]
  v_exp_f32 v92, v92
  v_mfma_f32_16x16x32_bf16 v[172:175], v[128:131], v[12:15], v[172:175]
  v_exp_f32 v93, v93
  v_mfma_f32_16x16x32_bf16 v[176:179], v[138:141], v[76:79], v[24:27]
  v_exp_f32 v94, v94
  v_mfma_f32_16x16x32_bf16 v[176:179], v[136:139], v[12:15], v[176:179]
  v_exp_f32 v95, v95
  v_mfma_f32_16x16x32_bf16 v[76:79], v[68:71], v[100:103], v[40:43]
  v_exp_f32 v96, v96
  v_mfma_f32_16x16x32_bf16 v[76:79], v[70:73], v[14:17], v[76:79]
  v_exp_f32 v97, v97
  v_mfma_f32_16x16x32_bf16 v[80:83], v[120:123], v[100:103], v[36:39]
  v_exp_f32 v98, v98
  v_mfma_f32_16x16x32_bf16 v[80:83], v[122:125], v[14:17], v[80:83]
  v_exp_f32 v99, v99
  v_mfma_f32_16x16x32_bf16 v[168:171], v[128:131], v[100:103], v[32:35]
  v_exp_f32 v172, v172
  v_mfma_f32_16x16x32_bf16 v[168:171], v[130:133], v[14:17], v[168:171]
  v_exp_f32 v173, v173
  v_mfma_f32_16x16x32_bf16 v[164:167], v[136:139], v[100:103], v[28:31]
  v_exp_f32 v174, v174
  v_mfma_f32_16x16x32_bf16 v[164:167], v[138:141], v[14:17], v[164:167]
  v_exp_f32 v175, v175
  v_mfma_f32_16x16x32_bf16 v[84:87], v[70:73], v[104:107], v[44:47]
  v_exp_f32 v176, v176
  v_mfma_f32_16x16x32_bf16 v[84:87], v[68:71], v[18:21], v[84:87]
  v_exp_f32 v177, v177
  v_mfma_f32_16x16x32_bf16 v[88:91], v[122:125], v[104:107], v[40:43]
  v_exp_f32 v178, v178
  v_mfma_f32_16x16x32_bf16 v[88:91], v[120:123], v[18:21], v[88:91]
  v_exp_f32 v179, v179
  v_mfma_f32_16x16x32_bf16 v[160:163], v[130:133], v[104:107], v[36:39]
  v_cvt_pk_bf16_f32 v92, v92, v93
  v_cvt_pk_bf16_f32 v93, v94, v95
  v_mfma_f32_16x16x32_bf16 v[160:163], v[128:131], v[18:21], v[160:163]
  v_cvt_pk_bf16_f32 v94, v96, v97
  v_cvt_pk_bf16_f32 v95, v98, v99
  v_mfma_f32_16x16x32_bf16 v[156:159], v[138:141], v[104:107], v[32:35]
  v_cvt_pk_bf16_f32 v96, v172, v173
  v_cvt_pk_bf16_f32 v97, v174, v175
  v_mfma_f32_16x16x32_bf16 v[156:159], v[136:139], v[18:21], v[156:159]
  v_cvt_pk_bf16_f32 v98, v176, v177
  v_cvt_pk_bf16_f32 v99, v178, v179
  v_mfma_f32_16x16x32_bf16 v[180:183], a[60:63], v[152:155], 0
  v_exp_f32 v76, v76
  v_mfma_f32_16x16x32_bf16 v[180:183], a[48:51], a[244:247], v[180:183]
  v_exp_f32 v77, v77
  v_mfma_f32_16x16x32_bf16 v[180:183], a[36:39], a[248:251], v[180:183]
  v_exp_f32 v78, v78
  v_mfma_f32_16x16x32_bf16 v[180:183], a[24:27], v[148:151], v[180:183]
  v_exp_f32 v79, v79
  v_mfma_f32_16x16x32_bf16 v[180:183], a[12:15], v[144:147], v[180:183]
  v_exp_f32 v80, v80
  v_mfma_f32_16x16x32_bf16 v[180:183], a[0:3], a[252:255], v[180:183]
  v_exp_f32 v81, v81
  v_mfma_f32_16x16x32_bf16 v[100:103], a[4:7], a[252:255], 0
  v_exp_f32 v82, v82
  v_mfma_f32_16x16x32_bf16 v[100:103], a[16:19], v[144:147], v[100:103]
  v_exp_f32 v83, v83
  v_mfma_f32_16x16x32_bf16 v[100:103], a[28:31], v[148:151], v[100:103]
  v_mul_f32 v180, s42, v180
  v_mul_f32 v181, s42, v181
  v_mfma_f32_16x16x32_bf16 v[100:103], a[40:43], a[248:251], v[100:103]
  v_mul_f32 v182, s42, v182
  v_mul_f32 v183, s42, v183
  v_mfma_f32_16x16x32_bf16 v[100:103], a[52:55], a[244:247], v[100:103]
  v_cvt_pk_bf16_f32 v172, v180, v181
  v_cvt_pk_bf16_f32 v173, v182, v183
  v_mfma_f32_16x16x32_bf16 v[100:103], a[64:67], v[152:155], v[100:103]
  v_exp_f32 v168, v168
  v_mfma_f32_16x16x32_bf16 v[104:107], a[68:71], v[152:155], 0
  v_exp_f32 v169, v169
  v_mfma_f32_16x16x32_bf16 v[104:107], a[56:59], a[244:247], v[104:107]
  v_exp_f32 v170, v170
  v_mfma_f32_16x16x32_bf16 v[104:107], a[44:47], a[248:251], v[104:107]
  v_mul_f32 v100, s42, v100
  v_mul_f32 v101, s42, v101
  v_mfma_f32_16x16x32_bf16 v[104:107], a[32:35], v[148:151], v[104:107]
  v_mul_f32 v102, s42, v102
  v_mul_f32 v103, s42, v103
  v_mfma_f32_16x16x32_bf16 v[104:107], a[20:23], v[144:147], v[104:107]
  v_cvt_pk_bf16_f32 v174, v100, v101
  v_cvt_pk_bf16_f32 v175, v102, v103
  v_mfma_f32_16x16x32_bf16 v[104:107], a[8:11], a[252:255], v[104:107]
  v_exp_f32 v171, v171
  v_mfma_f32_16x16x32_bf16 v[176:179], a[252:255], a[144:147], 0
  v_exp_f32 v164, v164
  v_mfma_f32_16x16x32_bf16 v[176:179], v[144:147], a[156:159], v[176:179]
  v_exp_f32 v165, v165
  v_mfma_f32_16x16x32_bf16 v[176:179], v[148:151], a[168:171], v[176:179]
  v_mul_f32 v104, s42, v104
  v_mul_f32 v105, s42, v105
  v_mfma_f32_16x16x32_bf16 v[176:179], a[248:251], a[180:183], v[176:179]
  v_mul_f32 v106, s42, v106
  v_mul_f32 v107, s42, v107
  v_mfma_f32_16x16x32_bf16 v[176:179], a[244:247], a[192:195], v[176:179]
  v_cvt_pk_bf16_f32 v22, v104, v105
  v_cvt_pk_bf16_f32 v23, v106, v107
  v_mfma_f32_16x16x32_bf16 v[176:179], v[152:155], a[204:207], v[176:179]
  v_exp_f32 v166, v166
  v_mfma_f32_16x16x32_bf16 v[100:103], v[68:71], v[172:175], v[48:51]
  v_exp_f32 v167, v167
  v_mfma_f32_16x16x32_bf16 v[100:103], v[70:73], v[20:23], v[100:103]
  v_cvt_pk_bf16_f32 v76, v76, v77
  v_cvt_pk_bf16_f32 v77, v78, v79
  v_mfma_f32_16x16x32_bf16 v[104:107], v[120:123], v[172:175], v[44:47]
  v_cvt_pk_bf16_f32 v110, v176, v177
  v_cvt_pk_bf16_f32 v111, v178, v179
  v_mfma_f32_16x16x32_bf16 v[104:107], v[122:125], v[20:23], v[104:107]
  v_cvt_pk_bf16_f32 v78, v80, v81
  v_cvt_pk_bf16_f32 v79, v82, v83
  v_mfma_f32_16x16x32_bf16 v[72:75], v[128:131], v[172:175], v[40:43]
  ds_read_b128 v[180:183], v3 offset:0
  v_cvt_pk_bf16_f32 v80, v168, v169
  v_mfma_f32_16x16x32_bf16 v[72:75], v[130:133], v[20:23], v[72:75]
  ds_read_b128 v[120:123], v3 offset:4096
  v_cvt_pk_bf16_f32 v81, v170, v171
  v_mfma_f32_16x16x32_bf16 v[68:71], v[136:139], v[172:175], v[36:39]
  ds_read_b128 v[128:131], v3 offset:8192
  v_cvt_pk_bf16_f32 v82, v164, v165
  v_mfma_f32_16x16x32_bf16 v[68:71], v[138:141], v[20:23], v[68:71]
  ds_read_b128 v[124:127], v3 offset:12288
  v_cvt_pk_bf16_f32 v83, v166, v167
  v_mfma_f32_16x16x32_bf16 v[168:171], v[152:155], a[208:211], 0
  ds_read_b128 v[132:135], v3 offset:16384
  v_mfma_f32_16x16x32_bf16 v[168:171], a[244:247], a[196:199], v[168:171]
  ds_read_b128 v[176:179], v3 offset:20480
  v_mfma_f32_16x16x32_bf16 v[168:171], a[248:251], a[184:187], v[168:171]
  v_exp_f32 v84, v84
  v_mfma_f32_16x16x32_bf16 v[168:171], v[148:151], a[172:175], v[168:171]
  v_exp_f32 v85, v85
  v_mfma_f32_16x16x32_bf16 v[168:171], v[144:147], a[160:163], v[168:171]
  v_exp_f32 v86, v86
  v_mfma_f32_16x16x32_bf16 v[168:171], a[252:255], a[148:151], v[168:171]
  v_exp_f32 v87, v87
  v_mfma_f32_16x16x32_bf16 v[164:167], a[252:255], a[152:155], 0
  v_exp_f32 v88, v88
  v_mfma_f32_16x16x32_bf16 v[164:167], v[144:147], a[164:167], v[164:167]
  v_exp_f32 v89, v89
  v_mfma_f32_16x16x32_bf16 v[164:167], v[148:151], a[176:179], v[164:167]
  v_cvt_pk_bf16_f32 v114, v168, v169
  v_cvt_pk_bf16_f32 v115, v170, v171
  v_mfma_f32_16x16x32_bf16 v[164:167], a[248:251], a[188:191], v[164:167]
  s_cmp_lt_u32 s31, s97
  v_exp_f32 v90, v90
  v_mfma_f32_16x16x32_bf16 v[164:167], a[244:247], a[200:203], v[164:167]
  s_waitcnt lgkmcnt(0)
  v_exp_f32 v91, v91
  v_mfma_f32_16x16x32_bf16 v[164:167], v[152:155], a[212:215], v[164:167]
  s_cbranch_scc1 L_loop
L_epi:
  v_mfma_f32_16x16x32_bf16 v[16:19], v[180:183], v[184:187], 0
L_hop_0_1:
  s_cbranch_execz L_hop_0_2
  s_lshl_b32 s5, s3, 3
  v_mov_b64 v[136:137], 0
  v_cvt_pk_bf16_f32 v84, v84, v85
  v_mfma_f32_16x16x32_bf16 v[16:19], v[120:123], v[200:203], v[16:19]
  s_add_u32 s5, s5, 155648
  v_exp_f32 v160, v160
  v_mfma_f32_16x16x32_bf16 v[16:19], v[128:131], v[216:219], v[16:19]
  v_cvt_pk_bf16_f32 v118, v164, v165
  v_cvt_pk_bf16_f32 v119, v166, v167
  v_mfma_f32_16x16x32_bf16 v[16:19], v[124:127], v[232:235], v[16:19]
  v_mov_b64 v[140:141], 0
  v_cvt_pk_bf16_f32 v85, v86, v87
  v_mfma_f32_16x16x32_bf16 v[16:19], v[132:135], v[248:251], v[16:19]
  v_exp_f32 v161, v161
  v_mfma_f32_16x16x32_bf16 v[16:19], v[176:179], a[224:227], v[16:19]
  v_exp_f32 v162, v162
  v_smfmac_f32_16x16x64_bf16 v[136:139], a[240:243], v[92:99], v10
  v_exp_f32 v163, v163
  v_mfma_f32_16x16x32_bf16 v[144:147], v[108:111], v[96:99], 0
  v_exp_f32 v156, v156
  v_mfma_f32_16x16x32_bf16 v[144:147], v[56:59], v[92:95], v[144:147]
  v_exp_f32 v157, v157
  v_mfma_f32_16x16x32_bf16 v[148:151], v[60:63], v[92:95], 0
  v_exp_f32 v158, v158
  v_mfma_f32_16x16x32_bf16 v[148:151], v[112:115], v[96:99], v[148:151]
  v_exp_f32 v159, v159
  v_mfma_f32_16x16x32_bf16 v[152:155], v[116:119], v[96:99], 0
  v_cvt_pk_bf16_f32 v86, v88, v89
  v_cvt_pk_bf16_f32 v87, v90, v91
  v_mfma_f32_16x16x32_bf16 v[152:155], v[64:67], v[92:95], v[152:155]
  v_cvt_pk_bf16_f32 v88, v160, v161
  v_cvt_pk_bf16_f32 v89, v162, v163
  v_smfmac_f32_16x16x64_bf16 v[140:143], a[240:243], v[76:83], v10
  v_cvt_pk_bf16_f32 v90, v156, v157
  v_cvt_pk_bf16_f32 v91, v158, v159
  v_mfma_f32_16x16x32_bf16 v[92:95], v[108:111], v[80:83], 0
  v_exp_f32 v100, v100
  v_mfma_f32_16x16x32_bf16 v[92:95], v[56:59], v[76:79], v[92:95]
  v_exp_f32 v101, v101
  v_mfma_f32_16x16x32_bf16 v[96:99], v[60:63], v[76:79], 0
  v_exp_f32 v102, v102
  v_mfma_f32_16x16x32_bf16 v[96:99], v[112:115], v[80:83], v[96:99]
  v_exp_f32 v103, v103
  v_mfma_f32_16x16x32_bf16 v[156:159], v[116:119], v[80:83], 0
  v_exp_f32 v104, v104
  v_mfma_f32_16x16x32_bf16 v[156:159], v[64:67], v[76:79], v[156:159]
  v_exp_f32 v105, v105
  v_mfma_f32_16x16x32_bf16 v[160:163], v[176:179], a[228:231], 0
  v_exp_f32 v106, v106
  v_mfma_f32_16x16x32_bf16 v[160:163], v[132:135], v[252:255], v[160:163]
  v_exp_f32 v107, v107
  v_mfma_f32_16x16x32_bf16 v[160:163], v[124:127], v[236:239], v[160:163]
  ds_read_b128 a[248:251], v4 offset:0
  ds_read_b128 v[80:83], v4 offset:4096
  v_mfma_f32_16x16x32_bf16 v[160:163], v[128:131], v[220:223], v[160:163]
  ds_read_b128 v[168:171], v4 offset:8192
  ds_read_b128 v[52:55], v4 offset:12288
  v_mfma_f32_16x16x32_bf16 v[160:163], v[120:123], v[204:207], v[160:163]
  ds_read_b128 v[172:175], v4 offset:16384
  ds_read_b128 a[252:255], v4 offset:20480
  v_mfma_f32_16x16x32_bf16 v[160:163], v[180:183], v[188:191], v[160:163]
  v_exp_f32 v72, v72
  v_mfma_f32_16x16x32_bf16 v[164:167], v[180:183], v[192:195], 0
  v_exp_f32 v73, v73
  v_mfma_f32_16x16x32_bf16 v[164:167], v[120:123], v[208:211], v[164:167]
  v_exp_f32 v74, v74
  v_mfma_f32_16x16x32_bf16 v[164:167], v[128:131], v[224:227], v[164:167]
  v_cvt_pk_bf16_f32 v16, v16, v160
  v_cvt_pk_bf16_f32 v17, v17, v161
  v_mfma_f32_16x16x32_bf16 v[164:167], v[124:127], v[240:243], v[164:167]
  v_cvt_pk_bf16_f32 v18, v18, v162
  v_cvt_pk_bf16_f32 v19, v19, v163
  v_mfma_f32_16x16x32_bf16 v[164:167], v[132:135], a[216:219], v[164:167]
  buffer_store_dword v16, v7, s[24:27], s33 offen offset:0 nt
  v_mfma_f32_16x16x32_bf16 v[164:167], v[176:179], a[232:235], v[164:167]
  v_exp_f32 v75, v75
  v_mfma_f32_16x16x32_bf16 v[76:79], v[176:179], a[236:239], 0
  buffer_store_dword v17, v7, s[24:27], s33 offen offset:384 nt
  v_mfma_f32_16x16x32_bf16 v[76:79], v[132:135], a[220:223], v[76:79]
  v_exp_f32 v68, v68
  v_mfma_f32_16x16x32_bf16 v[76:79], v[124:127], v[244:247], v[76:79]
  buffer_store_dword v18, v7, s[24:27], s33 offen offset:768 nt
  v_mfma_f32_16x16x32_bf16 v[76:79], v[128:131], v[228:231], v[76:79]
  v_exp_f32 v69, v69
  v_mfma_f32_16x16x32_bf16 v[76:79], v[120:123], v[212:215], v[76:79]
  buffer_store_dword v19, v7, s[24:27], s33 offen offset:1152 nt
  v_mfma_f32_16x16x32_bf16 v[76:79], v[180:183], v[196:199], v[76:79]
  s_waitcnt lgkmcnt(0)
  v_exp_f32 v70, v70
  v_mfma_f32_16x16x32_bf16 v[132:135], a[248:251], v[184:187], 0
  v_exp_f32 v71, v71
  v_mfma_f32_16x16x32_bf16 v[132:135], v[80:83], v[200:203], v[132:135]
  v_cvt_pk_bf16_f32 v100, v100, v101
  v_cvt_pk_bf16_f32 v101, v102, v103
  v_mfma_f32_16x16x32_bf16 v[132:135], v[168:171], v[216:219], v[132:135]
  v_cvt_pk_bf16_f32 v164, v164, v76
  v_cvt_pk_bf16_f32 v165, v165, v77
  v_mfma_f32_16x16x32_bf16 v[132:135], v[52:55], v[232:235], v[132:135]
  v_cvt_pk_bf16_f32 v166, v166, v78
  v_cvt_pk_bf16_f32 v167, v167, v79
  v_mfma_f32_16x16x32_bf16 v[132:135], v[172:175], v[248:251], v[132:135]
  buffer_store_dword v164, v8, s[24:27], s33 offen offset:0 nt
  v_mfma_f32_16x16x32_bf16 v[132:135], a[252:255], a[224:227], v[132:135]
  ds_read_b128 a[244:247], v3 offset:512
  v_mov_b64 v[76:77], 0
  v_mfma_f32_16x16x32_bf16 v[176:179], a[252:255], a[228:231], 0
  buffer_store_dword v165, v8, s[24:27], s33 offen offset:384 nt
  v_mfma_f32_16x16x32_bf16 v[176:179], v[172:175], v[252:255], v[176:179]
  ds_read_b128 v[160:163], v3 offset:4608
  ds_read_b128 a[252:255], v3 offset:8704
  v_mfma_f32_16x16x32_bf16 v[176:179], v[52:55], v[236:239], v[176:179]
  buffer_store_dword v166, v8, s[24:27], s33 offen offset:768 nt
  v_mfma_f32_16x16x32_bf16 v[176:179], v[168:171], v[220:223], v[176:179]
  ds_read_b128 v[120:123], v3 offset:12800
  ds_read_b128 v[124:127], v3 offset:16896
  v_mfma_f32_16x16x32_bf16 v[176:179], v[80:83], v[204:207], v[176:179]
  buffer_store_dword v167, v8, s[24:27], s33 offen offset:1152 nt
  v_mfma_f32_16x16x32_bf16 v[176:179], a[248:251], v[188:191], v[176:179]
  s_add_u32 s33, s33, s98
  ds_read_b128 v[128:131], v3 offset:20992
  v_cvt_pk_bf16_f32 v102, v104, v105
  v_smfmac_f32_16x16x64_bf16 v[76:79], a[240:243], v[84:91], v10
  v_cvt_pk_bf16_f32 v103, v106, v107
  v_cvt_pk_bf16_f32 v104, v72, v73
  v_mfma_f32_16x16x32_bf16 v[16:19], v[108:111], v[88:91], 0
  v_cvt_pk_bf16_f32 v105, v74, v75
  v_cvt_pk_bf16_f32 v106, v68, v69
  v_mfma_f32_16x16x32_bf16 v[16:19], v[56:59], v[84:87], v[16:19]
  v_cvt_pk_bf16_f32 v132, v132, v176
  v_cvt_pk_bf16_f32 v133, v133, v177
  v_mfma_f32_16x16x32_bf16 v[52:55], v[60:63], v[84:87], 0
  v_cvt_pk_bf16_f32 v134, v134, v178
  v_cvt_pk_bf16_f32 v135, v135, v179
  v_mfma_f32_16x16x32_bf16 v[52:55], v[112:115], v[88:91], v[52:55]
  buffer_store_dword v132, v7, s[24:27], s34 offen offset:0 nt
  v_mfma_f32_16x16x32_bf16 v[72:75], v[116:119], v[88:91], 0
  s_waitcnt lgkmcnt(0)
  v_cvt_pk_bf16_f32 v107, v70, v71
  v_add_f32 v136, v136, v137
  v_mfma_f32_16x16x32_bf16 v[72:75], v[64:67], v[84:87], v[72:75]
  buffer_store_dword v133, v7, s[24:27], s34 offen offset:384 nt
  v_mfma_f32_16x16x32_bf16 v[88:91], a[244:247], v[184:187], 0
  v_rcp_f32 v138, v136
  v_mfma_f32_16x16x32_bf16 v[88:91], v[160:163], v[200:203], v[88:91]
  buffer_store_dword v134, v7, s[24:27], s34 offen offset:768 nt
  v_mfma_f32_16x16x32_bf16 v[88:91], a[252:255], v[216:219], v[88:91]
L_hop_1_1:
  s_cbranch_execz L_hop_1_2
  v_mov_b64 v[68:69], 0
  v_add_f32 v140, v140, v141
  v_mfma_f32_16x16x32_bf16 v[88:91], v[120:123], v[232:235], v[88:91]
  buffer_store_dword v135, v7, s[24:27], s34 offen offset:1152 nt
  v_mul_f32 v144, v138, v144
  v_mfma_f32_16x16x32_bf16 v[88:91], v[124:127], v[248:251], v[88:91]
  s_add_u32 s34, s34, s98
  v_rcp_f32 v142, v140
  v_mul_f32 v145, v138, v145
  v_mfma_f32_16x16x32_bf16 v[88:91], v[128:131], a[224:227], v[88:91]
  v_mul_f32 v146, v138, v146
  v_mul_f32 v147, v138, v147
  v_cvt_pk_bf16_f32 v144, v144, v145
  v_mfma_f32_16x16x32_bf16 v[132:135], v[128:131], a[228:231], 0
  v_cvt_pk_bf16_f32 v145, v146, v147
  v_mul_f32 v148, v138, v148
  v_mul_f32 v149, v138, v149
  v_mfma_f32_16x16x32_bf16 v[132:135], v[124:127], v[252:255], v[132:135]
  v_mul_f32 v150, v138, v150
  v_mul_f32 v151, v138, v151
  v_cvt_pk_bf16_f32 v148, v148, v149
  v_mfma_f32_16x16x32_bf16 v[132:135], v[120:123], v[236:239], v[132:135]
  v_cvt_pk_bf16_f32 v149, v150, v151
  v_mul_f32 v152, v138, v152
  v_mul_f32 v153, v138, v153
  v_mfma_f32_16x16x32_bf16 v[132:135], a[252:255], v[220:223], v[132:135]
  v_mul_f32 v154, v138, v154
  v_mul_f32 v155, v138, v155
  v_cvt_pk_bf16_f32 v152, v152, v153
  v_mfma_f32_16x16x32_bf16 v[132:135], v[160:163], v[204:207], v[132:135]
  v_cvt_pk_bf16_f32 v153, v154, v155
  v_mul_f32 v92, v142, v92
  v_mul_f32 v93, v142, v93
  v_mfma_f32_16x16x32_bf16 v[132:135], a[244:247], v[188:191], v[132:135]
  v_mul_f32 v94, v142, v94
  v_mul_f32 v95, v142, v95
  v_cvt_pk_bf16_f32 v92, v92, v93
  v_smfmac_f32_16x16x64_bf16 v[68:71], a[240:243], v[100:107], v10
  v_cvt_pk_bf16_f32 v93, v94, v95
  v_mul_f32 v96, v142, v96
  v_mul_f32 v97, v142, v97
  v_mfma_f32_16x16x32_bf16 v[80:83], v[108:111], v[104:107], 0
  v_mul_f32 v98, v142, v98
  v_mul_f32 v99, v142, v99
  v_cvt_pk_bf16_f32 v96, v96, v97
  v_mfma_f32_16x16x32_bf16 v[80:83], v[56:59], v[100:103], v[80:83]
  v_cvt_pk_bf16_f32 v88, v88, v132
  v_cvt_pk_bf16_f32 v89, v89, v133
  v_cvt_pk_bf16_f32 v97, v98, v99
  v_mfma_f32_16x16x32_bf16 v[56:59], v[60:63], v[100:103], 0
  ds_read_b128 v[84:87], v4 offset:512
  v_cvt_pk_bf16_f32 v90, v90, v134
  v_cvt_pk_bf16_f32 v91, v91, v135
  v_mfma_f32_16x16x32_bf16 v[56:59], v[112:115], v[104:107], v[56:59]
  buffer_store_dword v88, v7, s[24:27], s35 offen offset:0 nt
  v_mul_f32 v156, v142, v156
  v_mfma_f32_16x16x32_bf16 v[60:63], v[116:119], v[104:107], 0
  ds_read_b128 v[108:111], v4 offset:4608
  ds_read_b128 v[112:115], v4 offset:8704
  v_mul_f32 v157, v142, v157
  v_mfma_f32_16x16x32_bf16 v[60:63], v[64:67], v[100:103], v[60:63]
  buffer_store_dword v89, v7, s[24:27], s35 offen offset:384 nt
  v_mul_f32 v158, v142, v158
  v_mfma_f32_16x16x32_bf16 v[104:107], a[244:247], v[192:195], 0
  ds_read_b128 v[100:103], v4 offset:12800
  ds_read_b128 v[64:67], v4 offset:16896
  v_mul_f32 v159, v142, v159
  v_mfma_f32_16x16x32_bf16 v[104:107], v[160:163], v[208:211], v[104:107]
  buffer_store_dword v90, v7, s[24:27], s35 offen offset:768 nt
  v_cvt_pk_bf16_f32 v156, v156, v157
  v_mfma_f32_16x16x32_bf16 v[104:107], a[252:255], v[224:227], v[104:107]
  ds_read_b128 v[116:119], v4 offset:20992
  v_cvt_pk_bf16_f32 v157, v158, v159
  v_max3_f32 v9, v136, v138, v9
  v_mfma_f32_16x16x32_bf16 v[104:107], v[120:123], v[240:243], v[104:107]
  buffer_store_dword v91, v7, s[24:27], s35 offen offset:1152 nt
  v_max3_f32 v9, v140, v142, v9
  v_mfma_f32_16x16x32_bf16 v[104:107], v[124:127], a[216:219], v[104:107]
  ds_write2st64_b32 v5, v144, v145 offset0:0 offset1:4
  v_mfma_f32_16x16x32_bf16 v[104:107], v[128:131], a[232:235], v[104:107]
  ds_write2st64_b32 v5, v148, v149 offset0:8 offset1:12
  v_mfma_f32_16x16x32_bf16 v[132:135], v[128:131], a[236:239], 0
  ds_write2st64_b32 v5, v152, v153 offset0:16 offset1:20
  v_mfma_f32_16x16x32_bf16 v[132:135], v[124:127], a[220:223], v[132:135]
  ds_write2st64_b32 v5, v92, v93 offset0:1 offset1:5
  v_mfma_f32_16x16x32_bf16 v[132:135], v[120:123], v[244:247], v[132:135]
  ds_write2st64_b32 v5, v96, v97 offset0:9 offset1:13
  v_mfma_f32_16x16x32_bf16 v[132:135], a[252:255], v[228:231], v[132:135]
  ds_write2st64_b32 v5, v156, v157 offset0:17 offset1:21
  v_mfma_f32_16x16x32_bf16 v[132:135], v[160:163], v[212:215], v[132:135]
  v_xor_b32 v3, 40960, v3
  v_xor_b32 v4, 40960, v4
  v_add_f32 v76, v76, v77
  v_mfma_f32_16x16x32_bf16 v[132:135], a[244:247], v[196:199], v[132:135]
  s_waitcnt lgkmcnt(6)
  v_rcp_f32 v78, v76
  v_add_f32 v68, v68, v69
  v_mfma_f32_16x16x32_bf16 v[88:91], v[84:87], v[184:187], 0
  v_rcp_f32 v70, v68
  v_max3_f32 v9, v76, v78, v9
  v_mfma_f32_16x16x32_bf16 v[88:91], v[108:111], v[200:203], v[88:91]
  v_max3_f32 v9, v68, v70, v9
  v_cmp_nge_f32 vcc, 0x53800000, v9
  v_mul_f32 v16, v78, v16
  v_mfma_f32_16x16x32_bf16 v[88:91], v[112:115], v[216:219], v[88:91]
  v_cvt_pk_bf16_f32 v104, v104, v132
  v_cvt_pk_bf16_f32 v105, v105, v133
  v_mul_f32 v17, v78, v17
  v_mfma_f32_16x16x32_bf16 v[88:91], v[100:103], v[232:235], v[88:91]
  s_waitcnt lgkmcnt(0)
  s_barrier
  v_mfma_f32_16x16x32_bf16 v[88:91], v[64:67], v[248:251], v[88:91]
  s_or_b32 s6, vcc_lo, vcc_hi
  ds_read_b128 a[244:247], v3 offset:0
  v_cvt_pk_bf16_f32 v106, v106, v134
  v_cvt_pk_bf16_f32 v107, v107, v135
  v_mfma_f32_16x16x32_bf16 v[88:91], v[116:119], a[224:227], v[88:91]
  buffer_store_dword v104, v8, s[24:27], s35 offen offset:0 nt
  v_mul_f32 v18, v78, v18
  v_mfma_f32_16x16x32_bf16 v[120:123], v[116:119], a[228:231], 0
  ds_read_b128 a[248:251], v3 offset:4096
  ds_read_b128 a[252:255], v3 offset:8192
  v_mul_f32 v19, v78, v19
  v_mfma_f32_16x16x32_bf16 v[120:123], v[64:67], v[252:255], v[120:123]
  buffer_store_dword v105, v8, s[24:27], s35 offen offset:384 nt
  v_cvt_pk_bf16_f32 v16, v16, v17
  v_mfma_f32_16x16x32_bf16 v[120:123], v[100:103], v[236:239], v[120:123]
  ds_read_b128 v[64:67], v3 offset:12288
  ds_read_b128 v[92:95], v3 offset:16384
  v_cvt_pk_bf16_f32 v17, v18, v19
  v_mfma_f32_16x16x32_bf16 v[120:123], v[112:115], v[220:223], v[120:123]
  buffer_store_dword v106, v8, s[24:27], s35 offen offset:768 nt
  v_mul_f32 v52, v78, v52
  v_mfma_f32_16x16x32_bf16 v[120:123], v[108:111], v[204:207], v[120:123]
  s_waitcnt lgkmcnt(2)
  ds_read_b128 v[100:103], v3 offset:20480
  v_mul_f32 v53, v78, v53
  v_mul_f32 v54, v78, v54
  v_mfma_f32_16x16x32_bf16 v[120:123], v[84:87], v[188:191], v[120:123]
  buffer_store_dword v107, v8, s[24:27], s35 offen offset:1152 nt
  v_mul_f32 v55, v78, v55
  v_mfma_f32_16x16x32_bf16 v[96:99], a[244:247], v[184:187], 0
  s_add_u32 s35, s35, s98
  v_cvt_pk_bf16_f32 v52, v52, v53
  v_cvt_pk_bf16_f32 v53, v54, v55
  v_mul_f32 v72, v78, v72
  v_mfma_f32_16x16x32_bf16 v[96:99], a[248:251], v[200:203], v[96:99]
  v_mul_f32 v73, v78, v73
  v_mul_f32 v74, v78, v74
  v_mul_f32 v75, v78, v75
  v_mfma_f32_16x16x32_bf16 v[96:99], a[252:255], v[216:219], v[96:99]
  s_waitcnt lgkmcnt(1)
  v_cvt_pk_bf16_f32 v88, v88, v120
  v_cvt_pk_bf16_f32 v89, v89, v121
  v_cvt_pk_bf16_f32 v72, v72, v73
  v_mfma_f32_16x16x32_bf16 v[96:99], v[64:67], v[232:235], v[96:99]
L_hop_2_1:
  s_cbranch_execz L_walk
  s_waitcnt lgkmcnt(0)
  v_cvt_pk_bf16_f32 v90, v90, v122
  v_cvt_pk_bf16_f32 v91, v91, v123
  v_cvt_pk_bf16_f32 v73, v74, v75
  v_mfma_f32_16x16x32_bf16 v[96:99], v[92:95], v[248:251], v[96:99]
  buffer_store_dword v88, v7, s[24:27], s36 offen offset:0 nt
  v_mul_f32 v80, v70, v80
  v_mfma_f32_16x16x32_bf16 v[96:99], v[100:103], a[224:227], v[96:99]
  v_mul_f32 v81, v70, v81
  v_mul_f32 v82, v70, v82
  v_mul_f32 v83, v70, v83
  v_mfma_f32_16x16x32_bf16 v[120:123], v[100:103], a[228:231], 0
  buffer_store_dword v89, v7, s[24:27], s36 offen offset:384 nt
  v_cvt_pk_bf16_f32 v80, v80, v81
  v_mfma_f32_16x16x32_bf16 v[120:123], v[92:95], v[252:255], v[120:123]
  v_cvt_pk_bf16_f32 v81, v82, v83
  v_mul_f32 v56, v70, v56
  v_mul_f32 v57, v70, v57
  v_mfma_f32_16x16x32_bf16 v[120:123], v[64:67], v[236:239], v[120:123]
  buffer_store_dword v90, v7, s[24:27], s36 offen offset:768 nt
  v_mul_f32 v58, v70, v58
  v_mfma_f32_16x16x32_bf16 v[120:123], a[252:255], v[220:223], v[120:123]
  ds_read_b128 v[76:79], v4 offset:0
  ds_read_b128 v[84:87], v4 offset:4096
  v_mul_f32 v59, v70, v59
  v_mfma_f32_16x16x32_bf16 v[120:123], a[248:251], v[204:207], v[120:123]
  buffer_store_dword v91, v7, s[24:27], s36 offen offset:1152 nt
  v_cvt_pk_bf16_f32 v56, v56, v57
  v_mfma_f32_16x16x32_bf16 v[120:123], a[244:247], v[188:191], v[120:123]
  s_add_u32 s36, s36, s98
  ds_read_b128 v[104:107], v4 offset:8192
  ds_read_b128 v[108:111], v4 offset:12288
  v_cvt_pk_bf16_f32 v57, v58, v59
  v_mfma_f32_16x16x32_bf16 v[88:91], a[244:247], v[192:195], 0
  ds_read_b128 v[112:115], v4 offset:16384
  ds_read_b128 v[116:119], v4 offset:20480
  v_mul_f32 v60, v70, v60
  v_mfma_f32_16x16x32_bf16 v[88:91], a[248:251], v[208:211], v[88:91]
  v_mul_f32 v61, v70, v61
  v_mul_f32 v62, v70, v62
  v_mul_f32 v63, v70, v63
  v_mfma_f32_16x16x32_bf16 v[88:91], a[252:255], v[224:227], v[88:91]
  v_cvt_pk_bf16_f32 v96, v96, v120
  v_cvt_pk_bf16_f32 v97, v97, v121
  v_cvt_pk_bf16_f32 v60, v60, v61
  v_mfma_f32_16x16x32_bf16 v[88:91], v[64:67], v[240:243], v[88:91]
L_hop_3_1:
  s_cbranch_execz L_walk
  v_cvt_pk_bf16_f32 v98, v98, v122
  v_cvt_pk_bf16_f32 v99, v99, v123
  v_cvt_pk_bf16_f32 v61, v62, v63
  v_mfma_f32_16x16x32_bf16 v[88:91], v[92:95], a[216:219], v[88:91]
  buffer_store_dword v96, v7, s[24:27], s33 offen offset:0 nt
  v_mov_b32 v0, s5
  v_mfma_f32_16x16x32_bf16 v[88:91], v[100:103], a[232:235], v[88:91]
  v_mov_b32 v1, s6
  v_mfma_f32_16x16x32_bf16 v[68:71], v[100:103], a[236:239], 0
  buffer_store_dword v97, v7, s[24:27], s33 offen offset:384 nt
  v_mfma_f32_16x16x32_bf16 v[68:71], v[92:95], a[220:223], v[68:71]
  ds_write2st64_b32 v5, v16, v17 offset0:2 offset1:6
  v_mfma_f32_16x16x32_bf16 v[68:71], v[64:67], v[244:247], v[68:71]
  buffer_store_dword v98, v7, s[24:27], s33 offen offset:768 nt
  v_mfma_f32_16x16x32_bf16 v[68:71], a[252:255], v[228:231], v[68:71]
  ds_write2st64_b32 v5, v52, v53 offset0:10 offset1:14
  v_mfma_f32_16x16x32_bf16 v[68:71], a[248:251], v[212:215], v[68:71]
  buffer_store_dword v99, v7, s[24:27], s33 offen offset:1152 nt
  v_mfma_f32_16x16x32_bf16 v[68:71], a[244:247], v[196:199], v[68:71]
  s_waitcnt lgkmcnt(2)
  ds_write2st64_b32 v5, v72, v73 offset0:18 offset1:22
  v_mfma_f32_16x16x32_bf16 v[16:19], v[76:79], v[184:187], 0
  ds_write2st64_b32 v5, v80, v81 offset0:3 offset1:7
  v_mfma_f32_16x16x32_bf16 v[16:19], v[84:87], v[200:203], v[16:19]
  ds_write2st64_b32 v5, v56, v57 offset0:11 offset1:15
  ds_write2st64_b32 v5, v60, v61 offset0:19 offset1:23
  ds_write_b32 v0, v1
  v_mfma_f32_16x16x32_bf16 v[16:19], v[104:107], v[216:219], v[16:19]
  v_cvt_pk_bf16_f32 v88, v88, v68
  v_cvt_pk_bf16_f32 v89, v89, v69
  v_mfma_f32_16x16x32_bf16 v[16:19], v[108:111], v[232:235], v[16:19]
  s_waitcnt lgkmcnt(0)
  s_barrier
  v_mfma_f32_16x16x32_bf16 v[16:19], v[112:115], v[248:251], v[16:19]
  v_cvt_pk_bf16_f32 v90, v90, v70
  v_cvt_pk_bf16_f32 v91, v91, v71
  v_mfma_f32_16x16x32_bf16 v[16:19], v[116:119], a[224:227], v[16:19]
  buffer_store_dword v88, v8, s[24:27], s33 offen offset:0 nt
  v_mfma_f32_16x16x32_bf16 v[64:67], v[116:119], a[228:231], 0
  ds_read_b128 a[244:247], v3 offset:512
  ds_read_b128 a[248:251], v3 offset:4608
  v_mfma_f32_16x16x32_bf16 v[64:67], v[112:115], v[252:255], v[64:67]
  buffer_store_dword v89, v8, s[24:27], s33 offen offset:384 nt
  v_mfma_f32_16x16x32_bf16 v[64:67], v[108:111], v[236:239], v[64:67]
  ds_read_b128 a[252:255], v3 offset:8704
  ds_read_b128 v[52:55], v3 offset:12800
  v_mfma_f32_16x16x32_bf16 v[64:67], v[104:107], v[220:223], v[64:67]
  buffer_store_dword v90, v8, s[24:27], s33 offen offset:768 nt
  v_mfma_f32_16x16x32_bf16 v[64:67], v[84:87], v[204:207], v[64:67]
  s_waitcnt lgkmcnt(2)
  ds_read_b128 v[60:63], v3 offset:16896
  ds_read_b128 v[68:71], v3 offset:20992
  v_mfma_f32_16x16x32_bf16 v[64:67], v[76:79], v[188:191], v[64:67]
  buffer_store_dword v91, v8, s[24:27], s33 offen offset:1152 nt
  v_mfma_f32_16x16x32_bf16 v[56:59], a[244:247], v[184:187], 0
  v_mov_b32 v0, 155648
  v_mfma_f32_16x16x32_bf16 v[56:59], a[248:251], v[200:203], v[56:59]
  s_waitcnt lgkmcnt(2)
  ds_read2_b32 v[92:93], v0 offset0:0 offset1:2
  ds_read2_b32 v[94:95], v0 offset0:4 offset1:6
  v_mfma_f32_16x16x32_bf16 v[56:59], a[252:255], v[216:219], v[56:59]
  v_cvt_pk_bf16_f32 v16, v16, v64
  v_cvt_pk_bf16_f32 v17, v17, v65
  v_mfma_f32_16x16x32_bf16 v[56:59], v[52:55], v[232:235], v[56:59]
  s_waitcnt lgkmcnt(2)
  v_cvt_pk_bf16_f32 v18, v18, v66
  v_cvt_pk_bf16_f32 v19, v19, v67
  v_mfma_f32_16x16x32_bf16 v[56:59], v[60:63], v[248:251], v[56:59]
  buffer_store_dword v16, v7, s[24:27], s34 offen offset:0 nt
  v_mfma_f32_16x16x32_bf16 v[56:59], v[68:71], a[224:227], v[56:59]
  v_mfma_f32_16x16x32_bf16 v[96:99], v[68:71], a[228:231], 0
  buffer_store_dword v17, v7, s[24:27], s34 offen offset:384 nt
  v_mfma_f32_16x16x32_bf16 v[96:99], v[60:63], v[252:255], v[96:99]
  s_waitcnt lgkmcnt(0)
  v_or3_b32 v92, v92, v93, v94
  v_or_b32 v92, v92, v95
  v_mfma_f32_16x16x32_bf16 v[96:99], v[52:55], v[236:239], v[96:99]
  buffer_store_dword v18, v7, s[24:27], s34 offen offset:768 nt
  v_mfma_f32_16x16x32_bf16 v[96:99], a[252:255], v[220:223], v[96:99]
  ds_read_b128 v[64:67], v4 offset:512
  ds_read_b128 v[72:75], v4 offset:4608
  v_mfma_f32_16x16x32_bf16 v[96:99], a[248:251], v[204:207], v[96:99]
  buffer_store_dword v19, v7, s[24:27], s34 offen offset:1152 nt
  v_mfma_f32_16x16x32_bf16 v[96:99], a[244:247], v[188:191], v[96:99]
  ds_read_b128 v[76:79], v4 offset:8704
  ds_read_b128 v[80:83], v4 offset:12800
  v_mfma_f32_16x16x32_bf16 v[16:19], a[244:247], v[192:195], 0
  ds_read_b128 v[84:87], v4 offset:16896
  ds_read_b128 v[88:91], v4 offset:20992
  v_mfma_f32_16x16x32_bf16 v[16:19], a[248:251], v[208:211], v[16:19]
  v_readfirstlane_b32 s49, v92
  v_mfma_f32_16x16x32_bf16 v[16:19], a[252:255], v[224:227], v[16:19]
  v_cvt_pk_bf16_f32 v56, v56, v96
  v_cvt_pk_bf16_f32 v57, v57, v97
  v_mfma_f32_16x16x32_bf16 v[16:19], v[52:55], v[240:243], v[16:19]
  v_cvt_pk_bf16_f32 v58, v58, v98
  v_cvt_pk_bf16_f32 v59, v59, v99
  v_mfma_f32_16x16x32_bf16 v[16:19], v[60:63], a[216:219], v[16:19]
  buffer_store_dword v56, v7, s[24:27], s35 offen offset:0 nt
  v_mfma_f32_16x16x32_bf16 v[16:19], v[68:71], a[232:235], v[16:19]
  v_mfma_f32_16x16x32_bf16 v[92:95], v[68:71], a[236:239], 0
  buffer_store_dword v57, v7, s[24:27], s35 offen offset:384 nt
  v_mfma_f32_16x16x32_bf16 v[92:95], v[60:63], a[220:223], v[92:95]
  v_mfma_f32_16x16x32_bf16 v[92:95], v[52:55], v[244:247], v[92:95]
  buffer_store_dword v58, v7, s[24:27], s35 offen offset:768 nt
  v_mfma_f32_16x16x32_bf16 v[92:95], a[252:255], v[228:231], v[92:95]
  v_mfma_f32_16x16x32_bf16 v[92:95], a[248:251], v[212:215], v[92:95]
  buffer_store_dword v59, v7, s[24:27], s35 offen offset:1152 nt
  v_mfma_f32_16x16x32_bf16 v[92:95], a[244:247], v[196:199], v[92:95]
  s_waitcnt lgkmcnt(0)
  v_mfma_f32_16x16x32_bf16 v[52:55], v[64:67], v[184:187], 0
  v_mfma_f32_16x16x32_bf16 v[52:55], v[72:75], v[200:203], v[52:55]
  v_mfma_f32_16x16x32_bf16 v[52:55], v[76:79], v[216:219], v[52:55]
  v_cvt_pk_bf16_f32 v16, v16, v92
  v_cvt_pk_bf16_f32 v17, v17, v93
  v_mfma_f32_16x16x32_bf16 v[52:55], v[80:83], v[232:235], v[52:55]
  v_cvt_pk_bf16_f32 v18, v18, v94
  v_cvt_pk_bf16_f32 v19, v19, v95
  v_mfma_f32_16x16x32_bf16 v[52:55], v[84:87], v[248:251], v[52:55]
  buffer_store_dword v16, v8, s[24:27], s35 offen offset:0 nt
  v_mfma_f32_16x16x32_bf16 v[52:55], v[88:91], a[224:227], v[52:55]
  v_mfma_f32_16x16x32_bf16 v[56:59], v[88:91], a[228:231], 0
  buffer_store_dword v17, v8, s[24:27], s35 offen offset:384 nt
  v_mfma_f32_16x16x32_bf16 v[56:59], v[84:87], v[252:255], v[56:59]
  v_mfma_f32_16x16x32_bf16 v[56:59], v[80:83], v[236:239], v[56:59]
  buffer_store_dword v18, v8, s[24:27], s35 offen offset:768 nt
  v_mfma_f32_16x16x32_bf16 v[56:59], v[76:79], v[220:223], v[56:59]
  v_mfma_f32_16x16x32_bf16 v[56:59], v[72:75], v[204:207], v[56:59]
  buffer_store_dword v19, v8, s[24:27], s35 offen offset:1152 nt
  v_mfma_f32_16x16x32_bf16 v[56:59], v[64:67], v[188:191], v[56:59]
  s_nop 7
  v_cvt_pk_bf16_f32 v52, v52, v56
  v_cvt_pk_bf16_f32 v53, v53, v57
  v_cvt_pk_bf16_f32 v54, v54, v58
  v_cvt_pk_bf16_f32 v55, v55, v59
  buffer_store_dword v52, v7, s[24:27], s36 offen offset:0 nt
  buffer_store_dword v53, v7, s[24:27], s36 offen offset:384 nt
  buffer_store_dword v54, v7, s[24:27], s36 offen offset:768 nt
  buffer_store_dword v55, v7, s[24:27], s36 offen offset:1152 nt
  s_cmp_lg_u32 s49, 0
  s_cbranch_scc1 L_safe
L_fin:
L_end:
  s_endpgm
L_hop_0_2:
  s_cbranch_execz L_walk
L_pad3431:
L_k2:
  s_cmp_lg_u32 s59, 10
  s_cbranch_scc1 L_k7
  s_waitcnt vmcnt(30)
  v_mfma_f32_16x16x32_bf16 v[104:107], a[0:3], v[92:95], 0
  v_mbcnt_lo_u32_b32 v75, -1, 0
  v_mbcnt_hi_u32_b32 v75, -1, v75
  v_mfma_f32_16x16x32_bf16 v[104:107], a[12:15], v[96:99], v[104:107]
  s_sub_u32 s49, s19, s18
  s_sub_u32 s50, s15, s99
  s_add_u32 s50, s50, 45360
  v_mfma_f32_16x16x32_bf16 v[104:107], a[24:27], v[136:139], v[104:107]
  s_mul_i32 s49, s49, s50
  v_cvt_pk_bf16_f32 v66, v132, v133
  v_cvt_pk_bf16_f32 v67, v134, v135
  v_mfma_f32_16x16x32_bf16 v[104:107], a[36:39], v[116:119], v[104:107]
  s_waitcnt lgkmcnt(0)
  s_mul_hi_u32 s49, s49, 384088
  s_add_u32 s49, s49, s19
  v_mfma_f32_16x16x32_bf16 v[104:107], a[48:51], v[80:83], v[104:107]
  s_and_b32 s50, s2, 7
  v_readlane_b32 s12, v52, s50
  v_mfma_f32_16x16x32_bf16 v[104:107], a[60:63], v[84:87], v[104:107]
  s_sub_u32 s49, s49, 1024
  v_subrev_u32 v11, s49, v52
  v_subrev_u32 v74, s49, v53
  v_mfma_f32_16x16x32_bf16 v[88:91], a[64:67], v[84:87], 0
  v_max_u32 v126, v11, v74
  v_cmp_lt_u32 vcc, 2047, v126
  v_mfma_f32_16x16x32_bf16 v[88:91], a[52:55], v[80:83], v[88:91]
  v_and_b32 v54, 7, v75
  v_lshrrev_b32 v55, 3, v75
  v_mfma_f32_16x16x32_bf16 v[88:91], a[40:43], v[116:119], v[88:91]
  s_or_b32 s51, vcc_lo, vcc_hi
  v_mul_f32 v104, s42, v104
  v_mul_f32 v105, s42, v105
  v_mfma_f32_16x16x32_bf16 v[88:91], a[28:31], v[136:139], v[88:91]
  v_mul_f32 v106, s42, v106
  v_mul_f32 v107, s42, v107
  v_mfma_f32_16x16x32_bf16 v[88:91], a[16:19], v[96:99], v[88:91]
  v_cvt_pk_bf16_f32 v18, v104, v105
  v_cvt_pk_bf16_f32 v19, v106, v107
  v_mfma_f32_16x16x32_bf16 v[88:91], a[4:7], v[92:95], v[88:91]
  v_lshl_add_u32 v11, v11, 3, v54
  v_lshl_add_u32 v74, v74, 3, v55
  v_mfma_f32_16x16x32_bf16 v[108:111], a[8:11], v[92:95], 0
  v_lshlrev_b32 v126, 3, v54
  v_cmp_lt_u32 vcc, v11, v74
  v_mfma_f32_16x16x32_bf16 v[108:111], a[20:23], v[96:99], v[108:111]
  s_sub_u32 s52, s12, s49
  s_sub_u32 s52, s52, 960
  s_lshr_b32 s52, s52, 7
  v_mfma_f32_16x16x32_bf16 v[108:111], a[32:35], v[136:139], v[108:111]
  s_or_b32 s51, s51, s52
  v_mul_f32 v88, s42, v88
  v_mul_f32 v89, s42, v89
  v_mfma_f32_16x16x32_bf16 v[108:111], a[44:47], v[116:119], v[108:111]
  v_mul_f32 v90, s42, v90
  v_mul_f32 v91, s42, v91
  v_mfma_f32_16x16x32_bf16 v[108:111], a[56:59], v[80:83], v[108:111]
  v_cvt_pk_bf16_f32 v104, v88, v89
  v_cvt_pk_bf16_f32 v105, v90, v91
  v_mfma_f32_16x16x32_bf16 v[108:111], a[68:71], v[84:87], v[108:111]
  v_lshrrev_b64 v[54:55], v126, vcc
  v_and_b32 v55, 0xff, v54
  v_mfma_f32_16x16x32_bf16 v[112:115], a[132:135], v[84:87], 0
  v_bcnt_u32_b32 v55, v55, 0
  s_nop 0
  v_readlane_b32 s52, v55, s50
  v_mfma_f32_16x16x32_bf16 v[112:115], a[120:123], v[80:83], v[112:115]
  s_nop 2
  s_sub_u32 s52, 7, s52
  v_cmp_eq_u32 vcc, s52, v55
  v_mfma_f32_16x16x32_bf16 v[112:115], a[108:111], v[116:119], v[112:115]
  v_mul_f32 v108, s42, v108
  v_mul_f32 v109, s42, v109
  v_mfma_f32_16x16x32_bf16 v[112:115], a[96:99], v[136:139], v[112:115]
  s_ff1_i32_b32 s52, vcc_lo
  v_mul_f32 v110, s42, v110
  v_mul_f32 v111, s42, v111
  v_mfma_f32_16x16x32_bf16 v[112:115], a[84:87], v[96:99], v[112:115]
  s_and_b32 s52, s52, 7
  v_cvt_pk_bf16_f32 v106, v108, v109
  v_cvt_pk_bf16_f32 v107, v110, v111
  v_mfma_f32_16x16x32_bf16 v[112:115], a[72:75], v[92:95], v[112:115]
  v_readlane_b32 s53, v11, s52
  v_mfma_f32_16x16x32_bf16 v[88:91], a[76:79], v[92:95], 0
  s_nop 1
  s_lshr_b32 s53, s53, 3
  s_add_u32 s53, s53, s49
  s_mov_b32 s14, s12
  v_mfma_f32_16x16x32_bf16 v[88:91], a[88:91], v[96:99], v[88:91]
  s_sub_u32 s49, s53, s12
  v_mfma_f32_16x16x32_bf16 v[88:91], a[100:103], v[136:139], v[88:91]
  v_cvt_pk_bf16_f32 v128, v112, v113
  v_cvt_pk_bf16_f32 v129, v114, v115
  v_mfma_f32_16x16x32_bf16 v[88:91], a[112:115], v[116:119], v[88:91]
  s_cmp_gt_i32 s49, 0
  s_cselect_b32 s45, 2, 1
  s_cselect_b32 s12, s53, s12
  v_mfma_f32_16x16x32_bf16 v[88:91], a[124:127], v[80:83], v[88:91]
  v_mfma_f32_16x16x32_bf16 v[88:91], a[136:139], v[84:87], v[88:91]
  s_cmp_gt_i32 s49, 0
  s_cselect_b32 s53, s52, s50
  s_cselect_b32 s96, 1, 7
  v_mfma_f32_16x16x32_bf16 v[108:111], a[140:143], v[84:87], 0
  s_lshl_b32 s96, s96, 11
  s_not_b32 s13, s12
  s_abs_i32 s49, s49
  v_mfma_f32_16x16x32_bf16 v[108:111], a[128:131], v[80:83], v[108:111]
  s_cmp_lt_u32 s49, 330
  s_cselect_b32 s51, 1, s51
  v_mfma_f32_16x16x32_bf16 v[108:111], a[116:119], v[116:119], v[108:111]
  v_cvt_pk_bf16_f32 v130, v88, v89
  v_cvt_pk_bf16_f32 v131, v90, v91
  v_mfma_f32_16x16x32_bf16 v[108:111], a[104:107], v[136:139], v[108:111]
  s_cmp_eq_u32 s51, 0
  s_cselect_b32 s45, s45, 0
  s_cselect_b32 s96, s96, 0
  v_mfma_f32_16x16x32_bf16 v[108:111], a[92:95], v[96:99], v[108:111]
  s_andn2_b32 s51, s2, 7
  s_add_u32 s51, s51, s53
  s_lshl_b32 s51, s51, 7
  v_mfma_f32_16x16x32_bf16 v[108:111], a[80:83], v[92:95], v[108:111]
  s_add_u32 s44, s51, 2097152
  s_lshr_b32 s49, s45, 1
  s_lshl_b32 s49, s49, s52
  v_mfma_f32_16x16x32_bf16 v[88:91], v[92:95], a[144:147], 0
  s_lshl_b32 s54, s3, 2
  s_add_u32 s54, s54, 155712
  v_mov_b32 v11, s54
  v_mfma_f32_16x16x32_bf16 v[88:91], v[96:99], a[156:159], v[88:91]
  v_mov_b32 v74, s49
  v_mfma_f32_16x16x32_bf16 v[88:91], v[136:139], a[168:171], v[88:91]
  v_cvt_pk_bf16_f32 v132, v108, v109
  v_cvt_pk_bf16_f32 v133, v110, v111
  v_mfma_f32_16x16x32_bf16 v[88:91], v[116:119], a[180:183], v[88:91]
  ds_read_b128 a[252:255], v0 offset:6144
  v_mfma_f32_16x16x32_bf16 v[88:91], v[80:83], a[192:195], v[88:91]
  ds_read_b128 v[144:147], v1 offset:6144
  v_mfma_f32_16x16x32_bf16 v[88:91], v[84:87], a[204:207], v[88:91]
  ds_read_b128 v[148:151], v0 offset:14336
  v_mfma_f32_16x16x32_bf16 v[140:143], v[84:87], a[208:211], 0
  ds_read_b128 a[248:251], v1 offset:14336
  v_mfma_f32_16x16x32_bf16 v[140:143], v[80:83], a[196:199], v[140:143]
  ds_read_b128 a[244:247], v0 offset:22528
  v_mfma_f32_16x16x32_bf16 v[140:143], v[116:119], a[184:187], v[140:143]
  v_cvt_pk_bf16_f32 v108, v88, v89
  v_cvt_pk_bf16_f32 v109, v90, v91
  v_mfma_f32_16x16x32_bf16 v[140:143], v[136:139], a[172:175], v[140:143]
  ds_read_b128 v[152:155], v1 offset:22528
  v_mfma_f32_16x16x32_bf16 v[140:143], v[96:99], a[160:163], v[140:143]
  ds_write_b32 v11, v74
  v_mfma_f32_16x16x32_bf16 v[140:143], v[92:95], a[148:151], v[140:143]
  v_mfma_f32_16x16x32_bf16 v[156:159], v[92:95], a[152:155], 0
  v_mfma_f32_16x16x32_bf16 v[156:159], v[96:99], a[164:167], v[156:159]
  v_mfma_f32_16x16x32_bf16 v[156:159], v[136:139], a[176:179], v[156:159]
  v_cvt_pk_bf16_f32 v112, v140, v141
  v_cvt_pk_bf16_f32 v113, v142, v143
  v_mfma_f32_16x16x32_bf16 v[156:159], v[116:119], a[188:191], v[156:159]
  s_waitcnt lgkmcnt(0)
  s_branch L_k4
L_hop_1_2:
  s_cbranch_execz L_walk
L_pad3594:
L_k7:
  s_cmp_lg_u32 s59, 9
  s_cbranch_scc1 L_k5
  v_mbcnt_lo_u32_b32 v11, -1, 0
  v_mbcnt_hi_u32_b32 v11, -1, v11
  s_lshr_b32 s50, s2, 3
  s_lshl_b32 s50, s50, 9
  s_add_u32 s50, s50, 1048576
  v_lshlrev_b32 v11, 3, v11
  buffer_load_dwordx2 v[52:53], v11, s[20:23], s50 offen sc1
  s_branch L_k2r
L_k5:
  s_cmp_lg_u32 s59, 7
  s_cbranch_scc1 L_k1
  v_mbcnt_lo_u32_b32 v11, -1, 0
  v_mbcnt_hi_u32_b32 v11, -1, v11
  s_waitcnt lgkmcnt(0)
  s_sub_u32 s49, s16, s18
  s_sub_u32 s50, s15, s60
  s_add_u32 s50, s50, 45360
  s_mul_i32 s49, s49, s50
  s_mul_hi_u32 s49, s49, 384088
  s_add_u32 s49, s49, s16
  s_lshr_b32 s50, s2, 3
  s_lshl_b32 s50, s50, 9
  s_add_u32 s50, s50, 1048576
  s_and_b32 s51, s2, 7
  s_lshl_b32 s51, s51, 3
  v_lshl_add_u32 v54, v11, 6, s51
  s_lshl_b32 s51, s51, 3
  v_lshl_add_u32 v55, v11, 3, s51
  v_mov_b32 v66, s49
  s_mov_b64 exec, 0xff
  buffer_store_dword v66, v54, s[20:23], s50 offen sc1
  buffer_store_dword v66, v55, s[20:23], s50 offen offset:4 sc1
  s_mov_b64 exec, -1
  s_branch L_k2r
L_k1:
  s_cmp_lg_u32 s59, 1
  s_cbranch_scc1 L_k9
  v_mov_b32 v7, v52
  v_mov_b32 v8, v53
  s_branch L_k2r
L_k9:
  s_cmp_lg_u32 s59, 11
  s_cbranch_scc1 L_k12
  s_cmp_eq_u32 s45, 1
  s_cbranch_scc1 L_k11
  v_mov_b32 v11, 155712
  ds_read_b128 v[88:91], v11
  s_waitcnt lgkmcnt(0)
  v_and_b32 v88, v88, v89
  v_and_b32 v90, v90, v91
  v_and_b32 v88, v88, v90
  s_nop 0
  v_readfirstlane_b32 s49, v88
  s_nop 3
  s_cmp_eq_u32 s49, 0
  s_cbranch_scc1 L_k2r
  v_mov_b32 v54, s12
  v_mov_b32 v55, s13
  s_mov_b64 exec, 1
  buffer_store_dwordx2 v[54:55], off, s[20:23], s44 sc1
  s_mov_b64 exec, -1
  s_movk_i32 s96, 4096
  s_branch L_k2r
L_k11:
  buffer_load_dwordx2 v[52:53], off, s[20:23], s44 sc1
  s_branch L_k2r
L_k12:
  s_cmp_lg_u32 s59, 12
  s_cbranch_scc1 L_k13
  s_cmp_eq_u32 s45, 2
  s_cbranch_scc1 L_k12t
  s_waitcnt vmcnt(30)
  v_cmp_eq_u64 vcc, s[12:13], v[52:53]
  s_nop 3
  s_and_b32 s49, vcc_lo, 1
  s_lshl_b32 s54, s3, 2
  s_add_u32 s54, s54, 155728
  v_mov_b32 v11, s54
  v_mov_b32 v54, s49
  ds_write_b32 v11, v54
  s_waitcnt lgkmcnt(0)
  s_branch L_k2r
L_k12t:
  s_sub_u32 s49, s44, 2097152
  s_lshr_b32 s49, s49, 7
  s_lshr_b32 s52, s49, 6
  s_and_b32 s53, s49, 63
  s_mul_i32 s50, s52, 15
  s_lshl_b32 s51, s57, 5
  s_cmp_eq_u32 s53, 63
  s_cselect_b32 s53, s50, s53
  s_cselect_b32 s52, 60, s52
  s_cselect_b32 s51, 3072, s51
  s_mul_i32 s52, s52, 1572864
  s_mul_i32 s53, s53, 3072
  s_add_u32 s52, s52, s53
  s_add_u32 s50, s52, 787968
  s_cmp_eq_u32 s51, 3072
  s_cselect_b32 s10, 100663296, s10
  s_sub_u32 s51, s51, s43
  s_mul_i32 s51, s51, 14
  s_sub_u32 s50, s50, s56
  s_add_u32 s58, s50, s51
  s_sub_u32 s49, s58, s43
  s_add_u32 s31, s31, s49
  s_add_u32 s32, s32, s49
  s_sub_u32 s37, s37, s49
  s_sub_u32 s38, s38, s49
  s_sub_u32 s39, s39, s49
  s_sub_u32 s40, s40, s49
  s_add_u32 s97, s97, s58
  s_mov_b32 s98, s58
  s_mov_b32 s45, 4
  s_branch L_k2r
L_k13:
  v_mov_b32 v11, 155728
  ds_read_b128 v[88:91], v11
  s_waitcnt lgkmcnt(0)
  v_and_b32 v88, v88, v89
  v_and_b32 v90, v90, v91
  v_and_b32 v88, v88, v90
  s_nop 0
  v_readfirstlane_b32 s49, v88
  s_nop 3
  s_cmp_eq_u32 s49, 0
  s_cbranch_scc1 L_k2r
  s_sub_u32 s97, s97, s43
  s_mov_b32 s45, 3
  s_branch L_k2r
L_safe:
  s_nop 15
  s_waitcnt vmcnt(0) lgkmcnt(0)
  s_mov_b32 s10, 100663296
  v_mbcnt_lo_u32_b32 v57, -1, 0
  v_mbcnt_hi_u32_b32 v57, -1, v57
  v_lshrrev_b32 v58, 2, v57
  v_and_b32 v58, 4, v58
  v_xor_b32 v59, v58, v57
  s_cmp_eq_u32 s47, 63
  s_cselect_b32 s5, 4, 0
  v_and_b32 v59, s5, v59
  v_cmp_eq_u32 vcc, 0, v59
  s_cmp_eq_u32 s48, 63
  s_cselect_b32 s5, 0xc31044fe, 0
  v_mov_b32 v54, s5
  v_mov_b32 v11, 0xc31044fe
  v_cndmask_b32 v54, 0, v54, vcc
  v_cndmask_b32 v11, v11, 0, vcc
  v_add_u32 v0, s46, v2
  v_xor_b32 v1, 64, v0
  s_lshl_b32 s5, s48, 3
  s_add_u32 s5, s5, s3
  s_add_u32 s5, s5, 4
  s_mul_i32 s31, s5, s57
  s_add_u32 s5, s5, 4
  s_and_b32 s5, s5, 511
  s_mul_i32 s32, s5, s57
  v_lshrrev_b32 v58, 2, v58
  s_lshl_b32 s5, s47, 3
  s_add_u32 s5, s5, 4
  s_mul_i32 s5, s5, 384
  s_cmp_eq_u32 s47, 63
  s_cselect_b32 s49, 0, s5
  s_cselect_b32 s5, s5, 0
  s_cselect_b32 s6, s57, 0
  v_mul_u32_u24 v56, s6, v58
  v_sub_u32 v56, s5, v56
  s_lshl_b32 s50, s48, 3
  s_add_u32 s50, s50, 4
  s_xor_b32 s6, s4, 0
  s_lshl_b32 s6, s6, 1
  s_add_u32 s6, s6, s50
  s_and_b32 s6, s6, 511
  s_mul_i32 s6, s6, s57
  s_add_u32 s33, s6, s49
  s_xor_b32 s6, s4, 1
  s_lshl_b32 s6, s6, 1
  s_add_u32 s6, s6, s50
  s_and_b32 s6, s6, 511
  s_mul_i32 s6, s6, s57
  s_add_u32 s34, s6, s49
  s_xor_b32 s6, s4, 2
  s_lshl_b32 s6, s6, 1
  s_add_u32 s6, s6, s50
  s_and_b32 s6, s6, 511
  s_mul_i32 s6, s6, s57
  s_add_u32 s35, s6, s49
  s_xor_b32 s6, s4, 3
  s_lshl_b32 s6, s6, 1
  s_add_u32 s6, s6, s50
  s_and_b32 s6, s6, 511
  s_mul_i32 s6, s6, s57
  s_add_u32 s36, s6, s49
  s_lshl_b32 s5, s47, 3
  s_add_u32 s5, s5, 4
  v_lshrrev_b32 v58, 3, v57
  v_add_u32 v59, s5, v58
  v_and_b32 v59, 511, v59
  v_sub_u32 v59, v59, v58
  v_mul_i32_i24 v55, 0x180, v59
  v_add_u32 v6, v6, v55
  v_add_u32 v7, v7, v56
  v_add_u32 v8, v8, v56
  v_add_f32 v54, v11, v54
  s_cmp_eq_u32 s45, 3
  s_cselect_b32 s49, 15, 16
  s_cmp_eq_u32 s45, 4
  s_cselect_b32 s49, 17, s49
  s_mov_b32 s50, 0
  s_sub_u32 s56, s56, s43
  s_nop 7
L_sloop:
  s_barrier
  s_add_u32 m0, s46, 0
  s_nop 0
  buffer_load_dwordx4 v6, s[8:11], s31 offen offset:0 nt lds
  s_add_u32 m0, s46, 8064
  s_nop 0
  buffer_load_dwordx4 v6, s[8:11], s31 offen offset:128 nt lds
  s_add_u32 m0, s46, 16128
  s_nop 0
  buffer_load_dwordx4 v6, s[8:11], s31 offen offset:256 nt lds
  s_add_u32 m0, s46, 4096
  s_nop 0
  buffer_load_dwordx4 v6, s[8:11], s32 offen offset:0 nt lds
  s_add_u32 m0, s46, 12160
  s_nop 0
  buffer_load_dwordx4 v6, s[8:11], s32 offen offset:128 nt lds
  s_add_u32 m0, s46, 20224
  s_nop 0
  buffer_load_dwordx4 v6, s[8:11], s32 offen offset:256 nt lds
  s_waitcnt vmcnt(0)
  s_barrier
  ds_read_b128 a[244:247], v0 offset:0
  ds_read_b128 a[248:251], v1 offset:0
  ds_read_b128 a[252:255], v0 offset:8192
  ds_read_b128 v[72:75], v1 offset:8192
  ds_read_b128 v[80:83], v0 offset:16384
  ds_read_b128 v[84:87], v1 offset:16384
  s_waitcnt lgkmcnt(5)
  v_mfma_f32_16x16x32_bf16 v[68:71], a[0:3], a[244:247], 0
  s_waitcnt lgkmcnt(4)
  v_mfma_f32_16x16x32_bf16 v[68:71], a[12:15], a[248:251], v[68:71]
  s_waitcnt lgkmcnt(3)
  v_mfma_f32_16x16x32_bf16 v[68:71], a[24:27], a[252:255], v[68:71]
  s_waitcnt lgkmcnt(2)
  v_mfma_f32_16x16x32_bf16 v[68:71], a[36:39], v[72:75], v[68:71]
  s_waitcnt lgkmcnt(1)
  v_mfma_f32_16x16x32_bf16 v[68:71], a[48:51], v[80:83], v[68:71]
  s_waitcnt lgkmcnt(0)
  v_mfma_f32_16x16x32_bf16 v[68:71], a[60:63], v[84:87], v[68:71]
  v_mfma_f32_16x16x32_bf16 v[60:63], a[4:7], a[244:247], 0
  v_mfma_f32_16x16x32_bf16 v[60:63], a[16:19], a[248:251], v[60:63]
  v_mfma_f32_16x16x32_bf16 v[60:63], a[28:31], a[252:255], v[60:63]
  v_mfma_f32_16x16x32_bf16 v[60:63], a[40:43], v[72:75], v[60:63]
  v_mfma_f32_16x16x32_bf16 v[60:63], a[52:55], v[80:83], v[60:63]
  v_mfma_f32_16x16x32_bf16 v[60:63], a[64:67], v[84:87], v[60:63]
  v_mul_f32 v68, s42, v68
  v_mul_f32 v69, s42, v69
  v_mul_f32 v70, s42, v70
  v_mul_f32 v71, s42, v71
  v_cvt_pk_bf16_f32 v12, v68, v69
  v_cvt_pk_bf16_f32 v13, v70, v71
  v_mfma_f32_16x16x32_bf16 v[64:67], a[8:11], a[244:247], 0
  v_mfma_f32_16x16x32_bf16 v[64:67], a[20:23], a[248:251], v[64:67]
  v_mfma_f32_16x16x32_bf16 v[64:67], a[32:35], a[252:255], v[64:67]
  v_mfma_f32_16x16x32_bf16 v[64:67], a[44:47], v[72:75], v[64:67]
  v_mfma_f32_16x16x32_bf16 v[64:67], a[56:59], v[80:83], v[64:67]
  v_mfma_f32_16x16x32_bf16 v[64:67], a[68:71], v[84:87], v[64:67]
  v_mul_f32 v60, s42, v60
  v_mul_f32 v61, s42, v61
  v_mul_f32 v62, s42, v62
  v_mul_f32 v63, s42, v63
  v_cvt_pk_bf16_f32 v128, v60, v61
  v_cvt_pk_bf16_f32 v129, v62, v63
  v_mfma_f32_16x16x32_bf16 v[68:71], a[72:75], a[244:247], 0
  v_mfma_f32_16x16x32_bf16 v[68:71], a[84:87], a[248:251], v[68:71]
  v_mfma_f32_16x16x32_bf16 v[68:71], a[96:99], a[252:255], v[68:71]
  v_mfma_f32_16x16x32_bf16 v[68:71], a[108:111], v[72:75], v[68:71]
  v_mfma_f32_16x16x32_bf16 v[68:71], a[120:123], v[80:83], v[68:71]
  v_mfma_f32_16x16x32_bf16 v[68:71], a[132:135], v[84:87], v[68:71]
  v_mul_f32 v64, s42, v64
  v_mul_f32 v65, s42, v65
  v_mul_f32 v66, s42, v66
  v_mul_f32 v67, s42, v67
  v_cvt_pk_bf16_f32 v130, v64, v65
  v_cvt_pk_bf16_f32 v131, v66, v67
  v_mfma_f32_16x16x32_bf16 v[76:79], a[76:79], a[244:247], 0
  v_mfma_f32_16x16x32_bf16 v[76:79], a[88:91], a[248:251], v[76:79]
  v_mfma_f32_16x16x32_bf16 v[76:79], a[100:103], a[252:255], v[76:79]
  v_mfma_f32_16x16x32_bf16 v[76:79], a[112:115], v[72:75], v[76:79]
  v_mfma_f32_16x16x32_bf16 v[76:79], a[124:127], v[80:83], v[76:79]
  v_mfma_f32_16x16x32_bf16 v[76:79], a[136:139], v[84:87], v[76:79]
  v_cvt_pk_bf16_f32 v60, v68, v69
  v_cvt_pk_bf16_f32 v61, v70, v71
  v_mfma_f32_16x16x32_bf16 v[88:91], a[80:83], a[244:247], 0
  v_mfma_f32_16x16x32_bf16 v[88:91], a[92:95], a[248:251], v[88:91]
  v_mfma_f32_16x16x32_bf16 v[88:91], a[104:107], a[252:255], v[88:91]
  v_mfma_f32_16x16x32_bf16 v[88:91], a[116:119], v[72:75], v[88:91]
  v_mfma_f32_16x16x32_bf16 v[88:91], a[128:131], v[80:83], v[88:91]
  v_mfma_f32_16x16x32_bf16 v[88:91], a[140:143], v[84:87], v[88:91]
  v_cvt_pk_bf16_f32 v62, v76, v77
  v_cvt_pk_bf16_f32 v63, v78, v79
  v_mfma_f32_16x16x32_bf16 v[92:95], a[244:247], a[144:147], 0
  v_mfma_f32_16x16x32_bf16 v[92:95], a[248:251], a[156:159], v[92:95]
  v_mfma_f32_16x16x32_bf16 v[92:95], a[252:255], a[168:171], v[92:95]
  v_mfma_f32_16x16x32_bf16 v[92:95], v[72:75], a[180:183], v[92:95]
  v_mfma_f32_16x16x32_bf16 v[92:95], v[80:83], a[192:195], v[92:95]
  v_mfma_f32_16x16x32_bf16 v[92:95], v[84:87], a[204:207], v[92:95]
  v_cvt_pk_bf16_f32 v64, v88, v89
  v_cvt_pk_bf16_f32 v65, v90, v91
  v_mfma_f32_16x16x32_bf16 v[96:99], a[244:247], a[148:151], 0
  v_mfma_f32_16x16x32_bf16 v[96:99], a[248:251], a[160:163], v[96:99]
  v_mfma_f32_16x16x32_bf16 v[96:99], a[252:255], a[172:175], v[96:99]
  v_mfma_f32_16x16x32_bf16 v[96:99], v[72:75], a[184:187], v[96:99]
  v_mfma_f32_16x16x32_bf16 v[96:99], v[80:83], a[196:199], v[96:99]
  v_mfma_f32_16x16x32_bf16 v[96:99], v[84:87], a[208:211], v[96:99]
  v_cvt_pk_bf16_f32 v68, v92, v93
  v_cvt_pk_bf16_f32 v69, v94, v95
  v_mfma_f32_16x16x32_bf16 v[104:107], a[244:247], a[152:155], 0
  v_mfma_f32_16x16x32_bf16 v[104:107], a[248:251], a[164:167], v[104:107]
  v_mfma_f32_16x16x32_bf16 v[104:107], a[252:255], a[176:179], v[104:107]
  v_mfma_f32_16x16x32_bf16 v[104:107], v[72:75], a[188:191], v[104:107]
  v_mfma_f32_16x16x32_bf16 v[104:107], v[80:83], a[200:203], v[104:107]
  v_mfma_f32_16x16x32_bf16 v[104:107], v[84:87], a[212:215], v[104:107]
  v_cvt_pk_bf16_f32 v76, v96, v97
  v_cvt_pk_bf16_f32 v77, v98, v99
  s_nop 5
  v_cvt_pk_bf16_f32 v72, v104, v105
  v_cvt_pk_bf16_f32 v73, v106, v107
  ds_read_b128 a[244:247], v0 offset:2048
  ds_read_b128 a[248:251], v1 offset:2048
  ds_read_b128 a[252:255], v0 offset:10240
  ds_read_b128 v[88:91], v1 offset:10240
  ds_read_b128 v[92:95], v0 offset:18432
  ds_read_b128 v[96:99], v1 offset:18432
  s_waitcnt lgkmcnt(5)
  v_mfma_f32_16x16x32_bf16 v[100:103], a[0:3], a[244:247], 0
  s_waitcnt lgkmcnt(4)
  v_mfma_f32_16x16x32_bf16 v[100:103], a[12:15], a[248:251], v[100:103]
  s_waitcnt lgkmcnt(3)
  v_mfma_f32_16x16x32_bf16 v[100:103], a[24:27], a[252:255], v[100:103]
  s_waitcnt lgkmcnt(2)
  v_mfma_f32_16x16x32_bf16 v[100:103], a[36:39], v[88:91], v[100:103]
  s_waitcnt lgkmcnt(1)
  v_mfma_f32_16x16x32_bf16 v[100:103], a[48:51], v[92:95], v[100:103]
  s_waitcnt lgkmcnt(0)
  v_mfma_f32_16x16x32_bf16 v[100:103], a[60:63], v[96:99], v[100:103]
  v_mfma_f32_16x16x32_bf16 v[80:83], a[4:7], a[244:247], 0
  v_mfma_f32_16x16x32_bf16 v[80:83], a[16:19], a[248:251], v[80:83]
  v_mfma_f32_16x16x32_bf16 v[80:83], a[28:31], a[252:255], v[80:83]
  v_mfma_f32_16x16x32_bf16 v[80:83], a[40:43], v[88:91], v[80:83]
  v_mfma_f32_16x16x32_bf16 v[80:83], a[52:55], v[92:95], v[80:83]
  v_mfma_f32_16x16x32_bf16 v[80:83], a[64:67], v[96:99], v[80:83]
  v_mul_f32 v100, s42, v100
  v_mul_f32 v101, s42, v101
  v_mul_f32 v102, s42, v102
  v_mul_f32 v103, s42, v103
  v_cvt_pk_bf16_f32 v124, v100, v101
  v_cvt_pk_bf16_f32 v125, v102, v103
  v_mfma_f32_16x16x32_bf16 v[84:87], a[8:11], a[244:247], 0
  v_mfma_f32_16x16x32_bf16 v[84:87], a[20:23], a[248:251], v[84:87]
  v_mfma_f32_16x16x32_bf16 v[84:87], a[32:35], a[252:255], v[84:87]
  v_mfma_f32_16x16x32_bf16 v[84:87], a[44:47], v[88:91], v[84:87]
  v_mfma_f32_16x16x32_bf16 v[84:87], a[56:59], v[92:95], v[84:87]
  v_mfma_f32_16x16x32_bf16 v[84:87], a[68:71], v[96:99], v[84:87]
  v_mul_f32 v80, s42, v80
  v_mul_f32 v81, s42, v81
  v_mul_f32 v82, s42, v82
  v_mul_f32 v83, s42, v83
  v_cvt_pk_bf16_f32 v126, v80, v81
  v_cvt_pk_bf16_f32 v127, v82, v83
  v_mfma_f32_16x16x32_bf16 v[100:103], a[72:75], a[244:247], 0
  v_mfma_f32_16x16x32_bf16 v[100:103], a[84:87], a[248:251], v[100:103]
  v_mfma_f32_16x16x32_bf16 v[100:103], a[96:99], a[252:255], v[100:103]
  v_mfma_f32_16x16x32_bf16 v[100:103], a[108:111], v[88:91], v[100:103]
  v_mfma_f32_16x16x32_bf16 v[100:103], a[120:123], v[92:95], v[100:103]
  v_mfma_f32_16x16x32_bf16 v[100:103], a[132:135], v[96:99], v[100:103]
  v_mul_f32 v84, s42, v84
  v_mul_f32 v85, s42, v85
  v_mul_f32 v86, s42, v86
  v_mul_f32 v87, s42, v87
  v_cvt_pk_bf16_f32 v16, v84, v85
  v_cvt_pk_bf16_f32 v17, v86, v87
  v_mfma_f32_16x16x32_bf16 v[104:107], a[76:79], a[244:247], 0
  v_mfma_f32_16x16x32_bf16 v[104:107], a[88:91], a[248:251], v[104:107]
  v_mfma_f32_16x16x32_bf16 v[104:107], a[100:103], a[252:255], v[104:107]
  v_mfma_f32_16x16x32_bf16 v[104:107], a[112:115], v[88:91], v[104:107]
  v_mfma_f32_16x16x32_bf16 v[104:107], a[124:127], v[92:95], v[104:107]
  v_mfma_f32_16x16x32_bf16 v[104:107], a[136:139], v[96:99], v[104:107]
  v_cvt_pk_bf16_f32 v80, v100, v101
  v_cvt_pk_bf16_f32 v81, v102, v103
  v_mfma_f32_16x16x32_bf16 v[108:111], a[80:83], a[244:247], 0
  v_mfma_f32_16x16x32_bf16 v[108:111], a[92:95], a[248:251], v[108:111]
  v_mfma_f32_16x16x32_bf16 v[108:111], a[104:107], a[252:255], v[108:111]
  v_mfma_f32_16x16x32_bf16 v[108:111], a[116:119], v[88:91], v[108:111]
  v_mfma_f32_16x16x32_bf16 v[108:111], a[128:131], v[92:95], v[108:111]
  v_mfma_f32_16x16x32_bf16 v[108:111], a[140:143], v[96:99], v[108:111]
  v_cvt_pk_bf16_f32 v82, v104, v105
  v_cvt_pk_bf16_f32 v83, v106, v107
  v_mfma_f32_16x16x32_bf16 v[100:103], a[244:247], a[144:147], 0
  v_mfma_f32_16x16x32_bf16 v[100:103], a[248:251], a[156:159], v[100:103]
  v_mfma_f32_16x16x32_bf16 v[100:103], a[252:255], a[168:171], v[100:103]
  v_mfma_f32_16x16x32_bf16 v[100:103], v[88:91], a[180:183], v[100:103]
  v_mfma_f32_16x16x32_bf16 v[100:103], v[92:95], a[192:195], v[100:103]
  v_mfma_f32_16x16x32_bf16 v[100:103], v[96:99], a[204:207], v[100:103]
  v_cvt_pk_bf16_f32 v84, v108, v109
  v_cvt_pk_bf16_f32 v85, v110, v111
  v_mfma_f32_16x16x32_bf16 v[104:107], a[244:247], a[148:151], 0
  v_mfma_f32_16x16x32_bf16 v[104:107], a[248:251], a[160:163], v[104:107]
  v_mfma_f32_16x16x32_bf16 v[104:107], a[252:255], a[172:175], v[104:107]
  v_mfma_f32_16x16x32_bf16 v[104:107], v[88:91], a[184:187], v[104:107]
  v_mfma_f32_16x16x32_bf16 v[104:107], v[92:95], a[196:199], v[104:107]
  v_mfma_f32_16x16x32_bf16 v[104:107], v[96:99], a[208:211], v[104:107]
  v_cvt_pk_bf16_f32 v70, v100, v101
  v_cvt_pk_bf16_f32 v71, v102, v103
  v_mfma_f32_16x16x32_bf16 v[116:119], a[244:247], a[152:155], 0
  v_mfma_f32_16x16x32_bf16 v[116:119], a[248:251], a[164:167], v[116:119]
  v_mfma_f32_16x16x32_bf16 v[116:119], a[252:255], a[176:179], v[116:119]
  v_mfma_f32_16x16x32_bf16 v[116:119], v[88:91], a[188:191], v[116:119]
  v_mfma_f32_16x16x32_bf16 v[116:119], v[92:95], a[200:203], v[116:119]
  v_mfma_f32_16x16x32_bf16 v[116:119], v[96:99], a[212:215], v[116:119]
  v_cvt_pk_bf16_f32 v78, v104, v105
  v_cvt_pk_bf16_f32 v79, v106, v107
  s_nop 5
  v_cvt_pk_bf16_f32 v74, v116, v117
  v_cvt_pk_bf16_f32 v75, v118, v119
  ds_read_b128 a[244:247], v0 offset:4096
  ds_read_b128 a[248:251], v1 offset:4096
  ds_read_b128 a[252:255], v0 offset:12288
  ds_read_b128 v[104:107], v1 offset:12288
  ds_read_b128 v[108:111], v0 offset:20480
  ds_read_b128 v[112:115], v1 offset:20480
  s_waitcnt lgkmcnt(5)
  v_mfma_f32_16x16x32_bf16 v[96:99], a[0:3], a[244:247], 0
  s_waitcnt lgkmcnt(4)
  v_mfma_f32_16x16x32_bf16 v[96:99], a[12:15], a[248:251], v[96:99]
  s_waitcnt lgkmcnt(3)
  v_mfma_f32_16x16x32_bf16 v[96:99], a[24:27], a[252:255], v[96:99]
  s_waitcnt lgkmcnt(2)
  v_mfma_f32_16x16x32_bf16 v[96:99], a[36:39], v[104:107], v[96:99]
  s_waitcnt lgkmcnt(1)
  v_mfma_f32_16x16x32_bf16 v[96:99], a[48:51], v[108:111], v[96:99]
  s_waitcnt lgkmcnt(0)
  v_mfma_f32_16x16x32_bf16 v[96:99], a[60:63], v[112:115], v[96:99]
  v_mfma_f32_16x16x32_bf16 v[88:91], a[4:7], a[244:247], 0
  v_mfma_f32_16x16x32_bf16 v[88:91], a[16:19], a[248:251], v[88:91]
  v_mfma_f32_16x16x32_bf16 v[88:91], a[28:31], a[252:255], v[88:91]
  v_mfma_f32_16x16x32_bf16 v[88:91], a[40:43], v[104:107], v[88:91]
  v_mfma_f32_16x16x32_bf16 v[88:91], a[52:55], v[108:111], v[88:91]
  v_mfma_f32_16x16x32_bf16 v[88:91], a[64:67], v[112:115], v[88:91]
  v_mul_f32 v96, s42, v96
  v_mul_f32 v97, s42, v97
  v_mul_f32 v98, s42, v98
  v_mul_f32 v99, s42, v99
  v_cvt_pk_bf16_f32 v18, v96, v97
  v_cvt_pk_bf16_f32 v19, v98, v99
  v_mfma_f32_16x16x32_bf16 v[92:95], a[8:11], a[244:247], 0
  v_mfma_f32_16x16x32_bf16 v[92:95], a[20:23], a[248:251], v[92:95]
  v_mfma_f32_16x16x32_bf16 v[92:95], a[32:35], a[252:255], v[92:95]
  v_mfma_f32_16x16x32_bf16 v[92:95], a[44:47], v[104:107], v[92:95]
  v_mfma_f32_16x16x32_bf16 v[92:95], a[56:59], v[108:111], v[92:95]
  v_mfma_f32_16x16x32_bf16 v[92:95], a[68:71], v[112:115], v[92:95]
  v_mul_f32 v88, s42, v88
  v_mul_f32 v89, s42, v89
  v_mul_f32 v90, s42, v90
  v_mul_f32 v91, s42, v91
  v_cvt_pk_bf16_f32 v120, v88, v89
  v_cvt_pk_bf16_f32 v121, v90, v91
  v_mfma_f32_16x16x32_bf16 v[96:99], a[72:75], a[244:247], 0
  v_mfma_f32_16x16x32_bf16 v[96:99], a[84:87], a[248:251], v[96:99]
  v_mfma_f32_16x16x32_bf16 v[96:99], a[96:99], a[252:255], v[96:99]
  v_mfma_f32_16x16x32_bf16 v[96:99], a[108:111], v[104:107], v[96:99]
  v_mfma_f32_16x16x32_bf16 v[96:99], a[120:123], v[108:111], v[96:99]
  v_mfma_f32_16x16x32_bf16 v[96:99], a[132:135], v[112:115], v[96:99]
  v_mul_f32 v92, s42, v92
  v_mul_f32 v93, s42, v93
  v_mul_f32 v94, s42, v94
  v_mul_f32 v95, s42, v95
  v_cvt_pk_bf16_f32 v122, v92, v93
  v_cvt_pk_bf16_f32 v123, v94, v95
  v_mfma_f32_16x16x32_bf16 v[100:103], a[76:79], a[244:247], 0
  v_mfma_f32_16x16x32_bf16 v[100:103], a[88:91], a[248:251], v[100:103]
  v_mfma_f32_16x16x32_bf16 v[100:103], a[100:103], a[252:255], v[100:103]
  v_mfma_f32_16x16x32_bf16 v[100:103], a[112:115], v[104:107], v[100:103]
  v_mfma_f32_16x16x32_bf16 v[100:103], a[124:127], v[108:111], v[100:103]
  v_mfma_f32_16x16x32_bf16 v[100:103], a[136:139], v[112:115], v[100:103]
  v_cvt_pk_bf16_f32 v88, v96, v97
  v_cvt_pk_bf16_f32 v89, v98, v99
  v_mfma_f32_16x16x32_bf16 v[116:119], a[80:83], a[244:247], 0
  v_mfma_f32_16x16x32_bf16 v[116:119], a[92:95], a[248:251], v[116:119]
  v_mfma_f32_16x16x32_bf16 v[116:119], a[104:107], a[252:255], v[116:119]
  v_mfma_f32_16x16x32_bf16 v[116:119], a[116:119], v[104:107], v[116:119]
  v_mfma_f32_16x16x32_bf16 v[116:119], a[128:131], v[108:111], v[116:119]
  v_mfma_f32_16x16x32_bf16 v[116:119], a[140:143], v[112:115], v[116:119]
  v_cvt_pk_bf16_f32 v90, v100, v101
  v_cvt_pk_bf16_f32 v91, v102, v103
  v_mfma_f32_16x16x32_bf16 v[132:135], a[244:247], a[144:147], 0
  v_mfma_f32_16x16x32_bf16 v[132:135], a[248:251], a[156:159], v[132:135]
  v_mfma_f32_16x16x32_bf16 v[132:135], a[252:255], a[168:171], v[132:135]
  v_mfma_f32_16x16x32_bf16 v[132:135], v[104:107], a[180:183], v[132:135]
  v_mfma_f32_16x16x32_bf16 v[132:135], v[108:111], a[192:195], v[132:135]
  v_mfma_f32_16x16x32_bf16 v[132:135], v[112:115], a[204:207], v[132:135]
  v_cvt_pk_bf16_f32 v92, v116, v117
  v_cvt_pk_bf16_f32 v93, v118, v119
  v_mfma_f32_16x16x32_bf16 v[136:139], a[244:247], a[148:151], 0
  v_mfma_f32_16x16x32_bf16 v[136:139], a[248:251], a[160:163], v[136:139]
  v_mfma_f32_16x16x32_bf16 v[136:139], a[252:255], a[172:175], v[136:139]
  v_mfma_f32_16x16x32_bf16 v[136:139], v[104:107], a[184:187], v[136:139]
  v_mfma_f32_16x16x32_bf16 v[136:139], v[108:111], a[196:199], v[136:139]
  v_mfma_f32_16x16x32_bf16 v[136:139], v[112:115], a[208:211], v[136:139]
  v_cvt_pk_bf16_f32 v96, v132, v133
  v_cvt_pk_bf16_f32 v97, v134, v135
  v_mfma_f32_16x16x32_bf16 v[116:119], a[244:247], a[152:155], 0
  v_mfma_f32_16x16x32_bf16 v[116:119], a[248:251], a[164:167], v[116:119]
  v_mfma_f32_16x16x32_bf16 v[116:119], a[252:255], a[176:179], v[116:119]
  v_mfma_f32_16x16x32_bf16 v[116:119], v[104:107], a[188:191], v[116:119]
  v_mfma_f32_16x16x32_bf16 v[116:119], v[108:111], a[200:203], v[116:119]
  v_mfma_f32_16x16x32_bf16 v[116:119], v[112:115], a[212:215], v[116:119]
  v_cvt_pk_bf16_f32 v100, v136, v137
  v_cvt_pk_bf16_f32 v101, v138, v139
  s_nop 5
  v_cvt_pk_bf16_f32 v104, v116, v117
  v_cvt_pk_bf16_f32 v105, v118, v119
  ds_read_b128 a[244:247], v0 offset:6144
  ds_read_b128 a[248:251], v1 offset:6144
  ds_read_b128 a[252:255], v0 offset:14336
  ds_read_b128 v[132:135], v1 offset:14336
  ds_read_b128 v[136:139], v0 offset:22528
  ds_read_b128 v[140:143], v1 offset:22528
  s_waitcnt lgkmcnt(5)
  v_mfma_f32_16x16x32_bf16 v[144:147], a[0:3], a[244:247], 0
  s_waitcnt lgkmcnt(4)
  v_mfma_f32_16x16x32_bf16 v[144:147], a[12:15], a[248:251], v[144:147]
  s_waitcnt lgkmcnt(3)
  v_mfma_f32_16x16x32_bf16 v[144:147], a[24:27], a[252:255], v[144:147]
  s_waitcnt lgkmcnt(2)
  v_mfma_f32_16x16x32_bf16 v[144:147], a[36:39], v[132:135], v[144:147]
  s_waitcnt lgkmcnt(1)
  v_mfma_f32_16x16x32_bf16 v[144:147], a[48:51], v[136:139], v[144:147]
  s_waitcnt lgkmcnt(0)
  v_mfma_f32_16x16x32_bf16 v[144:147], a[60:63], v[140:143], v[144:147]
  v_mfma_f32_16x16x32_bf16 v[108:111], a[4:7], a[244:247], 0
  v_mfma_f32_16x16x32_bf16 v[108:111], a[16:19], a[248:251], v[108:111]
  v_mfma_f32_16x16x32_bf16 v[108:111], a[28:31], a[252:255], v[108:111]
  v_mfma_f32_16x16x32_bf16 v[108:111], a[40:43], v[132:135], v[108:111]
  v_mfma_f32_16x16x32_bf16 v[108:111], a[52:55], v[136:139], v[108:111]
  v_mfma_f32_16x16x32_bf16 v[108:111], a[64:67], v[140:143], v[108:111]
  v_mul_f32 v144, s42, v144
  v_mul_f32 v145, s42, v145
  v_mul_f32 v146, s42, v146
  v_mul_f32 v147, s42, v147
  v_cvt_pk_bf16_f32 v116, v144, v145
  v_cvt_pk_bf16_f32 v117, v146, v147
  v_mfma_f32_16x16x32_bf16 v[112:115], a[8:11], a[244:247], 0
  v_mfma_f32_16x16x32_bf16 v[112:115], a[20:23], a[248:251], v[112:115]
  v_mfma_f32_16x16x32_bf16 v[112:115], a[32:35], a[252:255], v[112:115]
  v_mfma_f32_16x16x32_bf16 v[112:115], a[44:47], v[132:135], v[112:115]
  v_mfma_f32_16x16x32_bf16 v[112:115], a[56:59], v[136:139], v[112:115]
  v_mfma_f32_16x16x32_bf16 v[112:115], a[68:71], v[140:143], v[112:115]
  v_mul_f32 v108, s42, v108
  v_mul_f32 v109, s42, v109
  v_mul_f32 v110, s42, v110
  v_mul_f32 v111, s42, v111
  v_cvt_pk_bf16_f32 v118, v108, v109
  v_cvt_pk_bf16_f32 v119, v110, v111
  v_mfma_f32_16x16x32_bf16 v[144:147], a[72:75], a[244:247], 0
  v_mfma_f32_16x16x32_bf16 v[144:147], a[84:87], a[248:251], v[144:147]
  v_mfma_f32_16x16x32_bf16 v[144:147], a[96:99], a[252:255], v[144:147]
  v_mfma_f32_16x16x32_bf16 v[144:147], a[108:111], v[132:135], v[144:147]
  v_mfma_f32_16x16x32_bf16 v[144:147], a[120:123], v[136:139], v[144:147]
  v_mfma_f32_16x16x32_bf16 v[144:147], a[132:135], v[140:143], v[144:147]
  v_mul_f32 v112, s42, v112
  v_mul_f32 v113, s42, v113
  v_mul_f32 v114, s42, v114
  v_mul_f32 v115, s42, v115
  v_cvt_pk_bf16_f32 v22, v112, v113
  v_cvt_pk_bf16_f32 v23, v114, v115
  v_mfma_f32_16x16x32_bf16 v[148:151], a[76:79], a[244:247], 0
  v_mfma_f32_16x16x32_bf16 v[148:151], a[88:91], a[248:251], v[148:151]
  v_mfma_f32_16x16x32_bf16 v[148:151], a[100:103], a[252:255], v[148:151]
  v_mfma_f32_16x16x32_bf16 v[148:151], a[112:115], v[132:135], v[148:151]
  v_mfma_f32_16x16x32_bf16 v[148:151], a[124:127], v[136:139], v[148:151]
  v_mfma_f32_16x16x32_bf16 v[148:151], a[136:139], v[140:143], v[148:151]
  v_cvt_pk_bf16_f32 v108, v144, v145
  v_cvt_pk_bf16_f32 v109, v146, v147
  v_mfma_f32_16x16x32_bf16 v[152:155], a[80:83], a[244:247], 0
  v_mfma_f32_16x16x32_bf16 v[152:155], a[92:95], a[248:251], v[152:155]
  v_mfma_f32_16x16x32_bf16 v[152:155], a[104:107], a[252:255], v[152:155]
  v_mfma_f32_16x16x32_bf16 v[152:155], a[116:119], v[132:135], v[152:155]
  v_mfma_f32_16x16x32_bf16 v[152:155], a[128:131], v[136:139], v[152:155]
  v_mfma_f32_16x16x32_bf16 v[152:155], a[140:143], v[140:143], v[152:155]
  v_cvt_pk_bf16_f32 v110, v148, v149
  v_cvt_pk_bf16_f32 v111, v150, v151
  v_mfma_f32_16x16x32_bf16 v[144:147], a[244:247], a[144:147], 0
  v_mfma_f32_16x16x32_bf16 v[144:147], a[248:251], a[156:159], v[144:147]
  v_mfma_f32_16x16x32_bf16 v[144:147], a[252:255], a[168:171], v[144:147]
  v_mfma_f32_16x16x32_bf16 v[144:147], v[132:135], a[180:183], v[144:147]
  v_mfma_f32_16x16x32_bf16 v[144:147], v[136:139], a[192:195], v[144:147]
  v_mfma_f32_16x16x32_bf16 v[144:147], v[140:143], a[204:207], v[144:147]
  v_cvt_pk_bf16_f32 v112, v152, v153
  v_cvt_pk_bf16_f32 v113, v154, v155
  v_mfma_f32_16x16x32_bf16 v[148:151], a[244:247], a[148:151], 0
  v_mfma_f32_16x16x32_bf16 v[148:151], a[248:251], a[160:163], v[148:151]
  v_mfma_f32_16x16x32_bf16 v[148:151], a[252:255], a[172:175], v[148:151]
  v_mfma_f32_16x16x32_bf16 v[148:151], v[132:135], a[184:187], v[148:151]
  v_mfma_f32_16x16x32_bf16 v[148:151], v[136:139], a[196:199], v[148:151]
  v_mfma_f32_16x16x32_bf16 v[148:151], v[140:143], a[208:211], v[148:151]
  v_cvt_pk_bf16_f32 v98, v144, v145
  v_cvt_pk_bf16_f32 v99, v146, v147
  v_mfma_f32_16x16x32_bf16 v[152:155], a[244:247], a[152:155], 0
  v_mfma_f32_16x16x32_bf16 v[152:155], a[248:251], a[164:167], v[152:155]
  v_mfma_f32_16x16x32_bf16 v[152:155], a[252:255], a[176:179], v[152:155]
  v_mfma_f32_16x16x32_bf16 v[152:155], v[132:135], a[188:191], v[152:155]
  v_mfma_f32_16x16x32_bf16 v[152:155], v[136:139], a[200:203], v[152:155]
  v_mfma_f32_16x16x32_bf16 v[152:155], v[140:143], a[212:215], v[152:155]
  v_cvt_pk_bf16_f32 v102, v148, v149
  v_cvt_pk_bf16_f32 v103, v150, v151
  s_nop 5
  v_cvt_pk_bf16_f32 v106, v152, v153
  v_cvt_pk_bf16_f32 v107, v154, v155
  v_mfma_f32_16x16x32_bf16 v[132:135], v[62:65], v[128:131], v[36:39]
  v_mfma_f32_16x16x32_bf16 v[132:135], v[60:63], v[12:15], v[132:135]
  v_mfma_f32_16x16x32_bf16 v[136:139], v[82:85], v[128:131], v[32:35]
  v_mfma_f32_16x16x32_bf16 v[136:139], v[80:83], v[12:15], v[136:139]
  v_mfma_f32_16x16x32_bf16 v[140:143], v[90:93], v[128:131], v[28:31]
  v_mfma_f32_16x16x32_bf16 v[140:143], v[88:91], v[12:15], v[140:143]
  v_mfma_f32_16x16x32_bf16 v[144:147], v[110:113], v[128:131], v[24:27]
  v_mfma_f32_16x16x32_bf16 v[144:147], v[108:111], v[12:15], v[144:147]
  v_add_f32 v132, v11, v132
  v_add_f32 v133, v11, v133
  v_add_f32 v134, v11, v134
  v_add_f32 v135, v11, v135
  v_add_f32 v136, v11, v136
  v_add_f32 v137, v11, v137
  v_add_f32 v138, v11, v138
  v_add_f32 v139, v11, v139
  v_add_f32 v140, v54, v140
  v_add_f32 v141, v54, v141
  v_add_f32 v142, v54, v142
  v_add_f32 v143, v54, v143
  v_add_f32 v144, v54, v144
  v_add_f32 v145, v54, v145
  v_add_f32 v146, v54, v146
  v_add_f32 v147, v54, v147
  v_max_f32 v57, v132, v133
  v_max3_f32 v57, v134, v135, v57
  v_max3_f32 v57, v136, v137, v57
  v_max3_f32 v57, v138, v139, v57
  v_max3_f32 v57, v140, v141, v57
  v_max3_f32 v57, v142, v143, v57
  v_max3_f32 v57, v144, v145, v57
  v_max3_f32 v57, v146, v147, v57
  v_mov_b32 v58, v57
  s_nop 1
  v_permlane32_swap_b32 v57, v58
  v_max_f32 v57, v57, v58
  v_mov_b32 v58, v57
  s_nop 1
  v_permlane16_swap_b32 v57, v58
  v_max_f32 v57, v57, v58
  v_sub_f32 v132, v132, v57
  v_sub_f32 v133, v133, v57
  v_sub_f32 v134, v134, v57
  v_sub_f32 v135, v135, v57
  v_sub_f32 v136, v136, v57
  v_sub_f32 v137, v137, v57
  v_sub_f32 v138, v138, v57
  v_sub_f32 v139, v139, v57
  v_sub_f32 v140, v140, v57
  v_sub_f32 v141, v141, v57
  v_sub_f32 v142, v142, v57
  v_sub_f32 v143, v143, v57
  v_sub_f32 v144, v144, v57
  v_sub_f32 v145, v145, v57
  v_sub_f32 v146, v146, v57
  v_sub_f32 v147, v147, v57
  v_exp_f32 v132, v132
  v_exp_f32 v133, v133
  v_exp_f32 v134, v134
  v_exp_f32 v135, v135
  v_cvt_pk_bf16_f32 v132, v132, v133
  v_cvt_pk_bf16_f32 v133, v134, v135
  v_exp_f32 v136, v136
  v_exp_f32 v137, v137
  v_exp_f32 v138, v138
  v_exp_f32 v139, v139
  v_cvt_pk_bf16_f32 v134, v136, v137
  v_cvt_pk_bf16_f32 v135, v138, v139
  v_exp_f32 v140, v140
  v_exp_f32 v141, v141
  v_exp_f32 v142, v142
  v_exp_f32 v143, v143
  v_cvt_pk_bf16_f32 v136, v140, v141
  v_cvt_pk_bf16_f32 v137, v142, v143
  v_exp_f32 v144, v144
  v_exp_f32 v145, v145
  v_exp_f32 v146, v146
  v_exp_f32 v147, v147
  v_cvt_pk_bf16_f32 v138, v144, v145
  v_cvt_pk_bf16_f32 v139, v146, v147
  v_mov_b64 v[128:129], 0
  s_nop 1
  v_smfmac_f32_16x16x64_bf16 v[128:131], a[240:243], v[132:139], v10
  v_mfma_f32_16x16x32_bf16 v[148:151], v[96:99], v[136:139], 0
  v_mfma_f32_16x16x32_bf16 v[148:151], v[68:71], v[132:135], v[148:151]
  v_mfma_f32_16x16x32_bf16 v[140:143], v[76:79], v[132:135], 0
  v_mfma_f32_16x16x32_bf16 v[140:143], v[100:103], v[136:139], v[140:143]
  v_mfma_f32_16x16x32_bf16 v[144:147], v[104:107], v[136:139], 0
  v_mfma_f32_16x16x32_bf16 v[144:147], v[72:75], v[132:135], v[144:147]
  v_add_f32 v128, v128, v129
  v_rcp_f32 v130, v128
  s_nop 0
  v_mul_f32 v148, v130, v148
  v_mul_f32 v149, v130, v149
  v_mul_f32 v150, v130, v150
  v_mul_f32 v151, v130, v151
  v_cvt_pk_bf16_f32 v148, v148, v149
  v_cvt_pk_bf16_f32 v149, v150, v151
  ds_write_b32 v5, v148 offset:0
  ds_write_b32 v5, v149 offset:1024
  v_mul_f32 v140, v130, v140
  v_mul_f32 v141, v130, v141
  v_mul_f32 v142, v130, v142
  v_mul_f32 v143, v130, v143
  v_cvt_pk_bf16_f32 v140, v140, v141
  v_cvt_pk_bf16_f32 v141, v142, v143
  ds_write_b32 v5, v140 offset:2048
  ds_write_b32 v5, v141 offset:3072
  v_mul_f32 v144, v130, v144
  v_mul_f32 v145, v130, v145
  v_mul_f32 v146, v130, v146
  v_mul_f32 v147, v130, v147
  v_cvt_pk_bf16_f32 v144, v144, v145
  v_cvt_pk_bf16_f32 v145, v146, v147
  ds_write_b32 v5, v144 offset:4096
  ds_write_b32 v5, v145 offset:5120
  v_mfma_f32_16x16x32_bf16 v[128:131], v[60:63], v[124:127], v[40:43]
  v_mfma_f32_16x16x32_bf16 v[128:131], v[62:65], v[14:17], v[128:131]
  v_mfma_f32_16x16x32_bf16 v[132:135], v[80:83], v[124:127], v[36:39]
  v_mfma_f32_16x16x32_bf16 v[132:135], v[82:85], v[14:17], v[132:135]
  v_mfma_f32_16x16x32_bf16 v[136:139], v[88:91], v[124:127], v[32:35]
  v_mfma_f32_16x16x32_bf16 v[136:139], v[90:93], v[14:17], v[136:139]
  v_mfma_f32_16x16x32_bf16 v[140:143], v[108:111], v[124:127], v[28:31]
  v_mfma_f32_16x16x32_bf16 v[140:143], v[110:113], v[14:17], v[140:143]
  v_add_f32 v128, v11, v128
  v_add_f32 v129, v11, v129
  v_add_f32 v130, v11, v130
  v_add_f32 v131, v11, v131
  v_add_f32 v132, v11, v132
  v_add_f32 v133, v11, v133
  v_add_f32 v134, v11, v134
  v_add_f32 v135, v11, v135
  v_add_f32 v136, v54, v136
  v_add_f32 v137, v54, v137
  v_add_f32 v138, v54, v138
  v_add_f32 v139, v54, v139
  v_add_f32 v140, v54, v140
  v_add_f32 v141, v54, v141
  v_add_f32 v142, v54, v142
  v_add_f32 v143, v54, v143
  v_max_f32 v57, v128, v129
  v_max3_f32 v57, v130, v131, v57
  v_max3_f32 v57, v132, v133, v57
  v_max3_f32 v57, v134, v135, v57
  v_max3_f32 v57, v136, v137, v57
  v_max3_f32 v57, v138, v139, v57
  v_max3_f32 v57, v140, v141, v57
  v_max3_f32 v57, v142, v143, v57
  v_mov_b32 v58, v57
  s_nop 1
  v_permlane32_swap_b32 v57, v58
  v_max_f32 v57, v57, v58
  v_mov_b32 v58, v57
  s_nop 1
  v_permlane16_swap_b32 v57, v58
  v_max_f32 v57, v57, v58
  v_sub_f32 v128, v128, v57
  v_sub_f32 v129, v129, v57
  v_sub_f32 v130, v130, v57
  v_sub_f32 v131, v131, v57
  v_sub_f32 v132, v132, v57
  v_sub_f32 v133, v133, v57
  v_sub_f32 v134, v134, v57
  v_sub_f32 v135, v135, v57
  v_sub_f32 v136, v136, v57
  v_sub_f32 v137, v137, v57
  v_sub_f32 v138, v138, v57
  v_sub_f32 v139, v139, v57
  v_sub_f32 v140, v140, v57
  v_sub_f32 v141, v141, v57
  v_sub_f32 v142, v142, v57
  v_sub_f32 v143, v143, v57
  v_exp_f32 v128, v128
  v_exp_f32 v129, v129
  v_exp_f32 v130, v130
  v_exp_f32 v131, v131
  v_cvt_pk_bf16_f32 v128, v128, v129
  v_cvt_pk_bf16_f32 v129, v130, v131
  v_exp_f32 v132, v132
  v_exp_f32 v133, v133
  v_exp_f32 v134, v134
  v_exp_f32 v135, v135
  v_cvt_pk_bf16_f32 v130, v132, v133
  v_cvt_pk_bf16_f32 v131, v134, v135
  v_exp_f32 v136, v136
  v_exp_f32 v137, v137
  v_exp_f32 v138, v138
  v_exp_f32 v139, v139
  v_cvt_pk_bf16_f32 v132, v136, v137
  v_cvt_pk_bf16_f32 v133, v138, v139
  v_exp_f32 v140, v140
  v_exp_f32 v141, v141
  v_exp_f32 v142, v142
  v_exp_f32 v143, v143
  v_cvt_pk_bf16_f32 v134, v140, v141
  v_cvt_pk_bf16_f32 v135, v142, v143
  v_mov_b64 v[124:125], 0
  s_nop 1
  v_smfmac_f32_16x16x64_bf16 v[124:127], a[240:243], v[128:135], v10
  v_mfma_f32_16x16x32_bf16 v[144:147], v[96:99], v[132:135], 0
  v_mfma_f32_16x16x32_bf16 v[144:147], v[68:71], v[128:131], v[144:147]
  v_mfma_f32_16x16x32_bf16 v[136:139], v[76:79], v[128:131], 0
  v_mfma_f32_16x16x32_bf16 v[136:139], v[100:103], v[132:135], v[136:139]
  v_mfma_f32_16x16x32_bf16 v[140:143], v[104:107], v[132:135], 0
  v_mfma_f32_16x16x32_bf16 v[140:143], v[72:75], v[128:131], v[140:143]
  v_add_f32 v124, v124, v125
  v_rcp_f32 v126, v124
  s_nop 0
  v_mul_f32 v144, v126, v144
  v_mul_f32 v145, v126, v145
  v_mul_f32 v146, v126, v146
  v_mul_f32 v147, v126, v147
  v_cvt_pk_bf16_f32 v144, v144, v145
  v_cvt_pk_bf16_f32 v145, v146, v147
  ds_write_b32 v5, v144 offset:256
  ds_write_b32 v5, v145 offset:1280
  v_mul_f32 v136, v126, v136
  v_mul_f32 v137, v126, v137
  v_mul_f32 v138, v126, v138
  v_mul_f32 v139, v126, v139
  v_cvt_pk_bf16_f32 v136, v136, v137
  v_cvt_pk_bf16_f32 v137, v138, v139
  ds_write_b32 v5, v136 offset:2304
  ds_write_b32 v5, v137 offset:3328
  v_mul_f32 v140, v126, v140
  v_mul_f32 v141, v126, v141
  v_mul_f32 v142, v126, v142
  v_mul_f32 v143, v126, v143
  v_cvt_pk_bf16_f32 v140, v140, v141
  v_cvt_pk_bf16_f32 v141, v142, v143
  ds_write_b32 v5, v140 offset:4352
  ds_write_b32 v5, v141 offset:5376
  v_mfma_f32_16x16x32_bf16 v[124:127], v[62:65], v[120:123], v[44:47]
  v_mfma_f32_16x16x32_bf16 v[124:127], v[60:63], v[18:21], v[124:127]
  v_mfma_f32_16x16x32_bf16 v[128:131], v[82:85], v[120:123], v[40:43]
  v_mfma_f32_16x16x32_bf16 v[128:131], v[80:83], v[18:21], v[128:131]
  v_mfma_f32_16x16x32_bf16 v[132:135], v[90:93], v[120:123], v[36:39]
  v_mfma_f32_16x16x32_bf16 v[132:135], v[88:91], v[18:21], v[132:135]
  v_mfma_f32_16x16x32_bf16 v[136:139], v[110:113], v[120:123], v[32:35]
  v_mfma_f32_16x16x32_bf16 v[136:139], v[108:111], v[18:21], v[136:139]
  v_add_f32 v124, v54, v124
  v_add_f32 v125, v54, v125
  v_add_f32 v126, v54, v126
  v_add_f32 v127, v54, v127
  v_add_f32 v128, v54, v128
  v_add_f32 v129, v54, v129
  v_add_f32 v130, v54, v130
  v_add_f32 v131, v54, v131
  v_add_f32 v132, v11, v132
  v_add_f32 v133, v11, v133
  v_add_f32 v134, v11, v134
  v_add_f32 v135, v11, v135
  v_add_f32 v136, v11, v136
  v_add_f32 v137, v11, v137
  v_add_f32 v138, v11, v138
  v_add_f32 v139, v11, v139
  v_max_f32 v57, v124, v125
  v_max3_f32 v57, v126, v127, v57
  v_max3_f32 v57, v128, v129, v57
  v_max3_f32 v57, v130, v131, v57
  v_max3_f32 v57, v132, v133, v57
  v_max3_f32 v57, v134, v135, v57
  v_max3_f32 v57, v136, v137, v57
  v_max3_f32 v57, v138, v139, v57
  v_mov_b32 v58, v57
  s_nop 1
  v_permlane32_swap_b32 v57, v58
  v_max_f32 v57, v57, v58
  v_mov_b32 v58, v57
  s_nop 1
  v_permlane16_swap_b32 v57, v58
  v_max_f32 v57, v57, v58
  v_sub_f32 v124, v124, v57
  v_sub_f32 v125, v125, v57
  v_sub_f32 v126, v126, v57
  v_sub_f32 v127, v127, v57
  v_sub_f32 v128, v128, v57
  v_sub_f32 v129, v129, v57
  v_sub_f32 v130, v130, v57
  v_sub_f32 v131, v131, v57
  v_sub_f32 v132, v132, v57
  v_sub_f32 v133, v133, v57
  v_sub_f32 v134, v134, v57
  v_sub_f32 v135, v135, v57
  v_sub_f32 v136, v136, v57
  v_sub_f32 v137, v137, v57
  v_sub_f32 v138, v138, v57
  v_sub_f32 v139, v139, v57
  v_exp_f32 v124, v124
  v_exp_f32 v125, v125
  v_exp_f32 v126, v126
  v_exp_f32 v127, v127
  v_cvt_pk_bf16_f32 v124, v124, v125
  v_cvt_pk_bf16_f32 v125, v126, v127
  v_exp_f32 v128, v128
  v_exp_f32 v129, v129
  v_exp_f32 v130, v130
  v_exp_f32 v131, v131
  v_cvt_pk_bf16_f32 v126, v128, v129
  v_cvt_pk_bf16_f32 v127, v130, v131
  v_exp_f32 v132, v132
  v_exp_f32 v133, v133
  v_exp_f32 v134, v134
  v_exp_f32 v135, v135
  v_cvt_pk_bf16_f32 v128, v132, v133
  v_cvt_pk_bf16_f32 v129, v134, v135
  v_exp_f32 v136, v136
  v_exp_f32 v137, v137
  v_exp_f32 v138, v138
  v_exp_f32 v139, v139
  v_cvt_pk_bf16_f32 v130, v136, v137
  v_cvt_pk_bf16_f32 v131, v138, v139
  v_mov_b64 v[120:121], 0
  s_nop 1
  v_smfmac_f32_16x16x64_bf16 v[120:123], a[240:243], v[124:131], v10
  v_mfma_f32_16x16x32_bf16 v[140:143], v[96:99], v[128:131], 0
  v_mfma_f32_16x16x32_bf16 v[140:143], v[68:71], v[124:127], v[140:143]
  v_mfma_f32_16x16x32_bf16 v[132:135], v[76:79], v[124:127], 0
  v_mfma_f32_16x16x32_bf16 v[132:135], v[100:103], v[128:131], v[132:135]
  v_mfma_f32_16x16x32_bf16 v[136:139], v[104:107], v[128:131], 0
  v_mfma_f32_16x16x32_bf16 v[136:139], v[72:75], v[124:127], v[136:139]
  v_add_f32 v120, v120, v121
  v_rcp_f32 v122, v120
  s_nop 0
  v_mul_f32 v140, v122, v140
  v_mul_f32 v141, v122, v141
  v_mul_f32 v142, v122, v142
  v_mul_f32 v143, v122, v143
  v_cvt_pk_bf16_f32 v140, v140, v141
  v_cvt_pk_bf16_f32 v141, v142, v143
  ds_write_b32 v5, v140 offset:512
  ds_write_b32 v5, v141 offset:1536
  v_mul_f32 v132, v122, v132
  v_mul_f32 v133, v122, v133
  v_mul_f32 v134, v122, v134
  v_mul_f32 v135, v122, v135
  v_cvt_pk_bf16_f32 v132, v132, v133
  v_cvt_pk_bf16_f32 v133, v134, v135
  ds_write_b32 v5, v132 offset:2560
  s_waitcnt lgkmcnt(12)
  ds_write_b32 v5, v133 offset:3584
  v_mul_f32 v136, v122, v136
  v_mul_f32 v137, v122, v137
  v_mul_f32 v138, v122, v138
  v_mul_f32 v139, v122, v139
  v_cvt_pk_bf16_f32 v136, v136, v137
  v_cvt_pk_bf16_f32 v137, v138, v139
  ds_write_b32 v5, v136 offset:4608
  ds_write_b32 v5, v137 offset:5632
  v_mfma_f32_16x16x32_bf16 v[120:123], v[60:63], v[116:119], v[48:51]
  v_mfma_f32_16x16x32_bf16 v[120:123], v[62:65], v[20:23], v[120:123]
  v_mfma_f32_16x16x32_bf16 v[124:127], v[80:83], v[116:119], v[44:47]
  v_mfma_f32_16x16x32_bf16 v[124:127], v[82:85], v[20:23], v[124:127]
  v_mfma_f32_16x16x32_bf16 v[128:131], v[88:91], v[116:119], v[40:43]
  v_mfma_f32_16x16x32_bf16 v[128:131], v[90:93], v[20:23], v[128:131]
  v_mfma_f32_16x16x32_bf16 v[60:63], v[108:111], v[116:119], v[36:39]
  v_mfma_f32_16x16x32_bf16 v[60:63], v[110:113], v[20:23], v[60:63]
  v_add_f32 v120, v54, v120
  v_add_f32 v121, v54, v121
  v_add_f32 v122, v54, v122
  v_add_f32 v123, v54, v123
  v_add_f32 v124, v54, v124
  v_add_f32 v125, v54, v125
  v_add_f32 v126, v54, v126
  v_add_f32 v127, v54, v127
  v_add_f32 v128, v11, v128
  v_add_f32 v129, v11, v129
  v_add_f32 v130, v11, v130
  v_add_f32 v131, v11, v131
  v_add_f32 v60, v11, v60
  v_add_f32 v61, v11, v61
  v_add_f32 v62, v11, v62
  v_add_f32 v63, v11, v63
  v_max_f32 v57, v120, v121
  v_max3_f32 v57, v122, v123, v57
  v_max3_f32 v57, v124, v125, v57
  v_max3_f32 v57, v126, v127, v57
  v_max3_f32 v57, v128, v129, v57
  v_max3_f32 v57, v130, v131, v57
  v_max3_f32 v57, v60, v61, v57
  v_max3_f32 v57, v62, v63, v57
  v_mov_b32 v58, v57
  s_nop 1
  v_permlane32_swap_b32 v57, v58
  v_max_f32 v57, v57, v58
  v_mov_b32 v58, v57
  s_nop 1
  v_permlane16_swap_b32 v57, v58
  v_max_f32 v57, v57, v58
  v_sub_f32 v120, v120, v57
  v_sub_f32 v121, v121, v57
  v_sub_f32 v122, v122, v57
  v_sub_f32 v123, v123, v57
  v_sub_f32 v124, v124, v57
  v_sub_f32 v125, v125, v57
  v_sub_f32 v126, v126, v57
  v_sub_f32 v127, v127, v57
  v_sub_f32 v128, v128, v57
  v_sub_f32 v129, v129, v57
  v_sub_f32 v130, v130, v57
  v_sub_f32 v131, v131, v57
  v_sub_f32 v60, v60, v57
  v_sub_f32 v61, v61, v57
  v_sub_f32 v62, v62, v57
  v_sub_f32 v63, v63, v57
  v_exp_f32 v120, v120
  v_exp_f32 v121, v121
  v_exp_f32 v122, v122
  v_exp_f32 v123, v123
  v_cvt_pk_bf16_f32 v120, v120, v121
  v_cvt_pk_bf16_f32 v121, v122, v123
  v_exp_f32 v124, v124
  v_exp_f32 v125, v125
  v_exp_f32 v126, v126
  v_exp_f32 v127, v127
  v_cvt_pk_bf16_f32 v122, v124, v125
  v_cvt_pk_bf16_f32 v123, v126, v127
  v_exp_f32 v128, v128
  v_exp_f32 v129, v129
  v_exp_f32 v130, v130
  v_exp_f32 v131, v131
  v_cvt_pk_bf16_f32 v124, v128, v129
  v_cvt_pk_bf16_f32 v125, v130, v131
  v_exp_f32 v60, v60
  v_exp_f32 v61, v61
  v_exp_f32 v62, v62
  v_exp_f32 v63, v63
  v_cvt_pk_bf16_f32 v126, v60, v61
  v_cvt_pk_bf16_f32 v127, v62, v63
  v_mov_b64 v[80:81], 0
  s_nop 1
  v_smfmac_f32_16x16x64_bf16 v[80:83], a[240:243], v[120:127], v10
  v_mfma_f32_16x16x32_bf16 v[84:87], v[96:99], v[124:127], 0
  v_mfma_f32_16x16x32_bf16 v[84:87], v[68:71], v[120:123], v[84:87]
  v_mfma_f32_16x16x32_bf16 v[60:63], v[76:79], v[120:123], 0
  v_mfma_f32_16x16x32_bf16 v[60:63], v[100:103], v[124:127], v[60:63]
  v_mfma_f32_16x16x32_bf16 v[64:67], v[104:107], v[124:127], 0
  v_mfma_f32_16x16x32_bf16 v[64:67], v[72:75], v[120:123], v[64:67]
  v_add_f32 v80, v80, v81
  v_rcp_f32 v82, v80
  s_nop 0
  v_mul_f32 v84, v82, v84
  v_mul_f32 v85, v82, v85
  v_mul_f32 v86, v82, v86
  v_mul_f32 v87, v82, v87
  v_cvt_pk_bf16_f32 v84, v84, v85
  v_cvt_pk_bf16_f32 v85, v86, v87
  s_waitcnt lgkmcnt(12)
  ds_write_b32 v5, v84 offset:768
  ds_write_b32 v5, v85 offset:1792
  v_mul_f32 v60, v82, v60
  v_mul_f32 v61, v82, v61
  v_mul_f32 v62, v82, v62
  v_mul_f32 v63, v82, v63
  v_cvt_pk_bf16_f32 v60, v60, v61
  v_cvt_pk_bf16_f32 v61, v62, v63
  ds_write_b32 v5, v60 offset:2816
  s_waitcnt lgkmcnt(12)
  ds_write_b32 v5, v61 offset:3840
  v_mul_f32 v64, v82, v64
  v_mul_f32 v65, v82, v65
  v_mul_f32 v66, v82, v66
  v_mul_f32 v67, v82, v67
  v_cvt_pk_bf16_f32 v64, v64, v65
  v_cvt_pk_bf16_f32 v65, v66, v67
  ds_write_b32 v5, v64 offset:4864
  ds_write_b32 v5, v65 offset:5888
  s_waitcnt lgkmcnt(0)
  s_barrier
  ds_read_b128 a[244:247], v3 offset:0
  ds_read_b128 a[248:251], v3 offset:4096
  ds_read_b128 a[252:255], v3 offset:8192
  ds_read_b128 v[72:75], v3 offset:12288
  ds_read_b128 v[76:79], v3 offset:16384
  ds_read_b128 v[84:87], v3 offset:20480
  s_waitcnt lgkmcnt(5)
  v_mfma_f32_16x16x32_bf16 v[68:71], a[244:247], v[184:187], 0
  s_waitcnt lgkmcnt(4)
  v_mfma_f32_16x16x32_bf16 v[68:71], a[248:251], v[200:203], v[68:71]
  s_waitcnt lgkmcnt(3)
  v_mfma_f32_16x16x32_bf16 v[68:71], a[252:255], v[216:219], v[68:71]
  s_waitcnt lgkmcnt(2)
  v_mfma_f32_16x16x32_bf16 v[68:71], v[72:75], v[232:235], v[68:71]
  s_waitcnt lgkmcnt(1)
  v_mfma_f32_16x16x32_bf16 v[68:71], v[76:79], v[248:251], v[68:71]
  s_waitcnt lgkmcnt(0)
  v_mfma_f32_16x16x32_bf16 v[68:71], v[84:87], a[224:227], v[68:71]
  v_mfma_f32_16x16x32_bf16 v[80:83], v[84:87], a[228:231], 0
  v_mfma_f32_16x16x32_bf16 v[80:83], v[76:79], v[252:255], v[80:83]
  v_mfma_f32_16x16x32_bf16 v[80:83], v[72:75], v[236:239], v[80:83]
  v_mfma_f32_16x16x32_bf16 v[80:83], a[252:255], v[220:223], v[80:83]
  v_mfma_f32_16x16x32_bf16 v[80:83], a[248:251], v[204:207], v[80:83]
  v_mfma_f32_16x16x32_bf16 v[80:83], a[244:247], v[188:191], v[80:83]
  v_mfma_f32_16x16x32_bf16 v[60:63], a[244:247], v[192:195], 0
  v_mfma_f32_16x16x32_bf16 v[60:63], a[248:251], v[208:211], v[60:63]
  v_mfma_f32_16x16x32_bf16 v[60:63], a[252:255], v[224:227], v[60:63]
  v_mfma_f32_16x16x32_bf16 v[60:63], v[72:75], v[240:243], v[60:63]
  v_mfma_f32_16x16x32_bf16 v[60:63], v[76:79], a[216:219], v[60:63]
  v_mfma_f32_16x16x32_bf16 v[60:63], v[84:87], a[232:235], v[60:63]
  v_mfma_f32_16x16x32_bf16 v[64:67], v[84:87], a[236:239], 0
  v_mfma_f32_16x16x32_bf16 v[64:67], v[76:79], a[220:223], v[64:67]
  v_mfma_f32_16x16x32_bf16 v[64:67], v[72:75], v[244:247], v[64:67]
  v_mfma_f32_16x16x32_bf16 v[64:67], a[252:255], v[228:231], v[64:67]
  v_mfma_f32_16x16x32_bf16 v[64:67], a[248:251], v[212:215], v[64:67]
  v_mfma_f32_16x16x32_bf16 v[64:67], a[244:247], v[196:199], v[64:67]
  v_cvt_pk_bf16_f32 v68, v68, v80
  v_cvt_pk_bf16_f32 v69, v69, v81
  v_cvt_pk_bf16_f32 v70, v70, v82
  v_cvt_pk_bf16_f32 v71, v71, v83
  buffer_store_dword v68, v7, s[24:27], s33 offen offset:0 nt
  buffer_store_dword v69, v7, s[24:27], s33 offen offset:384 nt
  buffer_store_dword v70, v7, s[24:27], s33 offen offset:768 nt
  buffer_store_dword v71, v7, s[24:27], s33 offen offset:1152 nt
  v_cvt_pk_bf16_f32 v60, v60, v64
  v_cvt_pk_bf16_f32 v61, v61, v65
  v_cvt_pk_bf16_f32 v62, v62, v66
  v_cvt_pk_bf16_f32 v63, v63, v67
  buffer_store_dword v60, v8, s[24:27], s33 offen offset:0 nt
  buffer_store_dword v61, v8, s[24:27], s33 offen offset:384 nt
  buffer_store_dword v62, v8, s[24:27], s33 offen offset:768 nt
  buffer_store_dword v63, v8, s[24:27], s33 offen offset:1152 nt
  ds_read_b128 a[244:247], v4 offset:0
  ds_read_b128 a[248:251], v4 offset:4096
  ds_read_b128 a[252:255], v4 offset:8192
  ds_read_b128 v[68:71], v4 offset:12288
  ds_read_b128 v[72:75], v4 offset:16384
  ds_read_b128 v[76:79], v4 offset:20480
  s_waitcnt lgkmcnt(5)
  v_mfma_f32_16x16x32_bf16 v[60:63], a[244:247], v[184:187], 0
  s_waitcnt lgkmcnt(4)
  v_mfma_f32_16x16x32_bf16 v[60:63], a[248:251], v[200:203], v[60:63]
  s_waitcnt lgkmcnt(3)
  v_mfma_f32_16x16x32_bf16 v[60:63], a[252:255], v[216:219], v[60:63]
  s_waitcnt lgkmcnt(2)
  v_mfma_f32_16x16x32_bf16 v[60:63], v[68:71], v[232:235], v[60:63]
  s_waitcnt lgkmcnt(1)
  v_mfma_f32_16x16x32_bf16 v[60:63], v[72:75], v[248:251], v[60:63]
  s_waitcnt lgkmcnt(0)
  v_mfma_f32_16x16x32_bf16 v[60:63], v[76:79], a[224:227], v[60:63]
  v_mfma_f32_16x16x32_bf16 v[64:67], v[76:79], a[228:231], 0
  v_mfma_f32_16x16x32_bf16 v[64:67], v[72:75], v[252:255], v[64:67]
  v_mfma_f32_16x16x32_bf16 v[64:67], v[68:71], v[236:239], v[64:67]
  v_mfma_f32_16x16x32_bf16 v[64:67], a[252:255], v[220:223], v[64:67]
  v_mfma_f32_16x16x32_bf16 v[64:67], a[248:251], v[204:207], v[64:67]
  v_mfma_f32_16x16x32_bf16 v[64:67], a[244:247], v[188:191], v[64:67]
  s_nop 7
  v_cvt_pk_bf16_f32 v60, v60, v64
  v_cvt_pk_bf16_f32 v61, v61, v65
  v_cvt_pk_bf16_f32 v62, v62, v66
  v_cvt_pk_bf16_f32 v63, v63, v67
  buffer_store_dword v60, v7, s[24:27], s34 offen offset:0 nt
  buffer_store_dword v61, v7, s[24:27], s34 offen offset:384 nt
  buffer_store_dword v62, v7, s[24:27], s34 offen offset:768 nt
  buffer_store_dword v63, v7, s[24:27], s34 offen offset:1152 nt
  ds_read_b128 a[244:247], v3 offset:512
  ds_read_b128 a[248:251], v3 offset:4608
  ds_read_b128 a[252:255], v3 offset:8704
  ds_read_b128 v[72:75], v3 offset:12800
  ds_read_b128 v[76:79], v3 offset:16896
  ds_read_b128 v[84:87], v3 offset:20992
  s_waitcnt lgkmcnt(5)
  v_mfma_f32_16x16x32_bf16 v[60:63], a[244:247], v[184:187], 0
  s_waitcnt lgkmcnt(4)
  v_mfma_f32_16x16x32_bf16 v[60:63], a[248:251], v[200:203], v[60:63]
  s_waitcnt lgkmcnt(3)
  v_mfma_f32_16x16x32_bf16 v[60:63], a[252:255], v[216:219], v[60:63]
  s_waitcnt lgkmcnt(2)
  v_mfma_f32_16x16x32_bf16 v[60:63], v[72:75], v[232:235], v[60:63]
  s_waitcnt lgkmcnt(1)
  v_mfma_f32_16x16x32_bf16 v[60:63], v[76:79], v[248:251], v[60:63]
  s_waitcnt lgkmcnt(0)
  v_mfma_f32_16x16x32_bf16 v[60:63], v[84:87], a[224:227], v[60:63]
  v_mfma_f32_16x16x32_bf16 v[80:83], v[84:87], a[228:231], 0
  v_mfma_f32_16x16x32_bf16 v[80:83], v[76:79], v[252:255], v[80:83]
  v_mfma_f32_16x16x32_bf16 v[80:83], v[72:75], v[236:239], v[80:83]
  v_mfma_f32_16x16x32_bf16 v[80:83], a[252:255], v[220:223], v[80:83]
  v_mfma_f32_16x16x32_bf16 v[80:83], a[248:251], v[204:207], v[80:83]
  v_mfma_f32_16x16x32_bf16 v[80:83], a[244:247], v[188:191], v[80:83]
  v_mfma_f32_16x16x32_bf16 v[64:67], a[244:247], v[192:195], 0
  v_mfma_f32_16x16x32_bf16 v[64:67], a[248:251], v[208:211], v[64:67]
  v_mfma_f32_16x16x32_bf16 v[64:67], a[252:255], v[224:227], v[64:67]
  v_mfma_f32_16x16x32_bf16 v[64:67], v[72:75], v[240:243], v[64:67]
  v_mfma_f32_16x16x32_bf16 v[64:67], v[76:79], a[216:219], v[64:67]
  v_mfma_f32_16x16x32_bf16 v[64:67], v[84:87], a[232:235], v[64:67]
  v_mfma_f32_16x16x32_bf16 v[68:71], v[84:87], a[236:239], 0
  v_mfma_f32_16x16x32_bf16 v[68:71], v[76:79], a[220:223], v[68:71]
  v_mfma_f32_16x16x32_bf16 v[68:71], v[72:75], v[244:247], v[68:71]
  v_mfma_f32_16x16x32_bf16 v[68:71], a[252:255], v[228:231], v[68:71]
  v_mfma_f32_16x16x32_bf16 v[68:71], a[248:251], v[212:215], v[68:71]
  v_mfma_f32_16x16x32_bf16 v[68:71], a[244:247], v[196:199], v[68:71]
  v_cvt_pk_bf16_f32 v60, v60, v80
  v_cvt_pk_bf16_f32 v61, v61, v81
  v_cvt_pk_bf16_f32 v62, v62, v82
  v_cvt_pk_bf16_f32 v63, v63, v83
  buffer_store_dword v60, v7, s[24:27], s35 offen offset:0 nt
  buffer_store_dword v61, v7, s[24:27], s35 offen offset:384 nt
  buffer_store_dword v62, v7, s[24:27], s35 offen offset:768 nt
  buffer_store_dword v63, v7, s[24:27], s35 offen offset:1152 nt
  v_cvt_pk_bf16_f32 v64, v64, v68
  v_cvt_pk_bf16_f32 v65, v65, v69
  v_cvt_pk_bf16_f32 v66, v66, v70
  v_cvt_pk_bf16_f32 v67, v67, v71
  buffer_store_dword v64, v8, s[24:27], s35 offen offset:0 nt
  buffer_store_dword v65, v8, s[24:27], s35 offen offset:384 nt
  buffer_store_dword v66, v8, s[24:27], s35 offen offset:768 nt
  buffer_store_dword v67, v8, s[24:27], s35 offen offset:1152 nt
  ds_read_b128 a[244:247], v4 offset:512
  ds_read_b128 a[248:251], v4 offset:4608
  ds_read_b128 a[252:255], v4 offset:8704
  ds_read_b128 v[72:75], v4 offset:12800
  ds_read_b128 v[76:79], v4 offset:16896
  ds_read_b128 v[80:83], v4 offset:20992
  s_waitcnt lgkmcnt(5)
  v_mfma_f32_16x16x32_bf16 v[60:63], a[244:247], v[184:187], 0
  s_waitcnt lgkmcnt(4)
  v_mfma_f32_16x16x32_bf16 v[60:63], a[248:251], v[200:203], v[60:63]
  s_waitcnt lgkmcnt(3)
  v_mfma_f32_16x16x32_bf16 v[60:63], a[252:255], v[216:219], v[60:63]
  s_waitcnt lgkmcnt(2)
  v_mfma_f32_16x16x32_bf16 v[60:63], v[72:75], v[232:235], v[60:63]
  s_waitcnt lgkmcnt(1)
  v_mfma_f32_16x16x32_bf16 v[60:63], v[76:79], v[248:251], v[60:63]
  s_waitcnt lgkmcnt(0)
  v_mfma_f32_16x16x32_bf16 v[60:63], v[80:83], a[224:227], v[60:63]
  v_mfma_f32_16x16x32_bf16 v[64:67], v[80:83], a[228:231], 0
  v_mfma_f32_16x16x32_bf16 v[64:67], v[76:79], v[252:255], v[64:67]
  v_mfma_f32_16x16x32_bf16 v[64:67], v[72:75], v[236:239], v[64:67]
  v_mfma_f32_16x16x32_bf16 v[64:67], a[252:255], v[220:223], v[64:67]
  v_mfma_f32_16x16x32_bf16 v[64:67], a[248:251], v[204:207], v[64:67]
  v_mfma_f32_16x16x32_bf16 v[64:67], a[244:247], v[188:191], v[64:67]
  s_nop 7
  v_cvt_pk_bf16_f32 v60, v60, v64
  v_cvt_pk_bf16_f32 v61, v61, v65
  v_cvt_pk_bf16_f32 v62, v62, v66
  v_cvt_pk_bf16_f32 v63, v63, v67
  buffer_store_dword v60, v7, s[24:27], s36 offen offset:0 nt
  buffer_store_dword v61, v7, s[24:27], s36 offen offset:384 nt
  buffer_store_dword v62, v7, s[24:27], s36 offen offset:768 nt
  buffer_store_dword v63, v7, s[24:27], s36 offen offset:1152 nt
  v_sub_u32 v6, v6, v55
  v_sub_u32 v7, v7, v56
  v_sub_u32 v8, v8, v56
  v_mov_b32 v11, 0
  v_mov_b32 v54, 0
  v_mov_b32 v55, 0
  v_mov_b32 v56, 0
  s_add_u32 s50, s50, 1
  s_cmp_eq_u32 s50, 16
  s_cselect_b32 s5, s58, s43
  s_add_u32 s56, s56, s5
  s_mul_i32 s5, s3, s57
  s_add_u32 s31, s56, s5
  s_add_u32 s32, s31, 786432
  s_xor_b32 s5, s4, 0
  s_mul_i32 s5, s5, 393216
  s_add_u32 s33, s5, s56
  s_xor_b32 s5, s4, 1
  s_mul_i32 s5, s5, 393216
  s_add_u32 s34, s5, s56
  s_xor_b32 s5, s4, 2
  s_mul_i32 s5, s5, 393216
  s_add_u32 s35, s5, s56
  s_xor_b32 s5, s4, 3
  s_mul_i32 s5, s5, 393216
  s_add_u32 s36, s5, s56
  s_cmp_lt_u32 s50, s49
  s_nop 7
  s_cbranch_scc1 L_sloop
  s_branch L_fin
.section .rodata,"a"
.p2align 6
.amdhsa_kernel standalone__window_attn_swin__vision_kernel
  .amdhsa_next_free_vgpr 512
  .amdhsa_next_free_sgpr 102
  .amdhsa_accum_offset 256
  .amdhsa_group_segment_fixed_size 0
  .amdhsa_kernarg_size 72
  .amdhsa_user_sgpr_count 2
  .amdhsa_user_sgpr_kernarg_segment_ptr 1
  .amdhsa_system_sgpr_workgroup_id_x 1
.end_amdhsa_kernel
```

```asm
; @launch grid=(256,1,1) block=(256,1,1) lds=163840
.amdgcn_target "amdgcn-amd-amdhsa--gfx950"
.text
.globl standalone__window_attn_swin__vision_kernel
.p2align 12
.p2align 8
.type standalone__window_attn_swin__vision_kernel,@function
standalone__window_attn_swin__vision_kernel:
  s_cmpk_ge_u32 s2, 256
  s_cbranch_scc1 L_end
  s_load_dwordx2 s[8:9], s[0:1], 0
  s_load_dwordx2 s[20:21], s[0:1], 24
  s_load_dwordx2 s[12:13], s[0:1], 8
  s_load_dwordx2 s[16:17], s[0:1], 16
  s_load_dwordx2 s[24:25], s[0:1], 48
  s_load_dwordx2 s[62:63], s[0:1], 64
  v_lshrrev_b32 v73, 6, v0
  s_lshr_b32 s49, s2, 3
  v_readfirstlane_b32 s3, v73
  s_getpc_b64 s[50:51]
  v_and_b32 v73, 15, v0
  v_mad_u32_u24 v73, s49, 9, v73
  v_lshlrev_b32 v73, 7, v73
  v_min_u32 v73, L_safe-standalone__window_attn_swin__vision_kernel-256, v73
  v_mov_b32 v59, s51
  v_add_co_u32 v58, vcc, s50, v73
  s_and_b32 s47, s2, 63
  s_lshr_b32 s48, s2, 6
  v_addc_co_u32 v59, vcc, 0, v59, vcc
  global_load_dword v94, v[58:59], off
  v_bfe_u32 v56, v0, 3, 4
  v_and_b32 v54, 7, v0
  v_lshrrev_b32 v66, 1, v56
  v_lshlrev_b32 v74, 2, v56
  v_and_b32 v74, 4, v74
  v_xor_b32 v66, v66, v74
  v_xor_b32 v66, v54, v66
  v_and_b32 v55, 7, v56
  s_add_u32 s48, s48, 60
  s_cmp_lt_u32 s2, 60
  s_cselect_b32 s48, s2, s48
  s_cselect_b32 s47, 63, s47
  s_lshl_b32 s5, s47, 3
  s_add_u32 s5, s5, 4
  v_add_u32 v74, s5, v55
  v_and_b32 v74, 511, v74
  v_mul_u32_u24 v74, 0x180, v74
  v_lshlrev_b32 v57, 4, v66
  v_add_u32 v6, v57, v74
  v_and_b32 v64, 63, v0
  v_lshlrev_b32 v58, 4, v64
  s_mov_b32 s57, 196608
  s_lshl_b32 s5, s48, 3
  s_add_u32 s5, s5, s3
  s_add_u32 s5, s5, 4
  s_mul_i32 s31, s5, s57
  s_add_u32 s5, s5, 4
  s_and_b32 s5, s5, 511
  s_mul_i32 s32, s5, s57
  s_lshl_b32 s46, s3, 10
  s_lshl_b32 s5, s3, 11
  s_add_u32 m0, s5, 147456
  s_mov_b32 s11, 0x20000
  s_mov_b32 s10, 100663296
  s_mov_b32 s23, s11
  s_movk_i32 s22, 1800
  s_mov_b32 s15, s11
  s_mov_b32 s14, 221184
  s_waitcnt lgkmcnt(0)
  buffer_load_dwordx4 v58, s[20:23], 0 offen lds
  buffer_load_dwordx4 v58, s[20:23], 0 offen offset:1024 lds
  s_add_u32 m0, s46, 0
  v_and_b32 v66, 2, v56
  buffer_load_dwordx4 v6, s[8:11], s31 offen offset:0 nt lds
  s_add_u32 m0, s46, 8064
  v_lshrrev_b32 v74, 1, v56
  buffer_load_dwordx4 v6, s[8:11], s31 offen offset:128 nt lds
  s_add_u32 m0, s46, 16128
  v_and_b32 v74, 4, v74
  buffer_load_dwordx4 v6, s[8:11], s31 offen offset:256 nt lds
  s_add_u32 m0, s46, 4096
  v_or_b32 v74, v66, v74
  buffer_load_dwordx4 v6, s[8:11], s32 offen offset:0 nt lds
  s_add_u32 m0, s46, 12160
  v_xor_b32 v74, v54, v74
  buffer_load_dwordx4 v6, s[8:11], s32 offen offset:128 nt lds
  s_add_u32 m0, s46, 20224
  v_lshlrev_b32 v74, 4, v74
  buffer_load_dwordx4 v6, s[8:11], s32 offen offset:256 nt lds
  v_mul_u32_u24 v56, 1152, v55
  v_add_u32 v58, v74, v56
  s_mul_i32 s44, s3, 9216
  s_mov_b32 s19, s11
  s_mov_b32 s18, 73728
  s_lshl_b32 s49, s49, 2
  s_add_u32 s49, s49, s3
  s_mul_i32 s50, s49, 2304
  v_min_u32 v92, 17, v64
  v_lshlrev_b32 v92, 7, v92
  v_lshlrev_b32 v66, 1, v66
  v_xor_b32 v66, v54, v66
  v_mul_u32_u24 v74, 0x180, v55
  v_lshl_add_u32 v71, v66, 4, v74
  s_mul_i32 s45, s3, 3072
  v_add_u32 v6, v57, v74
  s_mov_b32 s27, s11
  s_mov_b32 s26, 100663296
  v_and_b32 v54, 15, v64
  v_lshrrev_b32 v55, 4, v64
  v_lshrrev_b32 v73, 1, v54
  v_lshlrev_b32 v66, 2, v54
  v_and_b32 v66, 4, v66
  v_xor_b32 v73, v73, v66
  v_xor_b32 v73, v55, v73
  v_lshlrev_b32 v73, 4, v73
  v_lshl_add_u32 v0, v54, 7, v73
  v_xor_b32 v1, 64, v0
  v_subrev_u32 v2, s46, v0
  s_add_u32 s28, s46, 24576
  s_add_u32 s29, s46, 49152
  s_mov_b32 s30, s46
  s_and_b32 s4, s3, 1
  v_lshlrev_b32 v73, 4, v54
  v_lshl_add_u32 v66, v55, 10, v73
  s_lshl_b32 s5, s4, 8
  s_add_u32 s5, s5, 73728
  v_add_u32 v3, s5, v66
  v_xor_b32 v4, 0x100, v3
  s_mul_i32 s5, s3, 6144
  s_add_u32 s6, s5, 98304
  s_add_u32 s5, s5, 73728
  s_xor_b32 s41, s5, s6
  v_lshl_add_u32 v66, v55, 2, v73
  v_add_u32 v5, s5, v66
  v_and_b32 v65, 7, v54
  v_lshrrev_b32 v70, 3, v54
  v_and_b32 v67, 1, v55
  v_lshrrev_b32 v72, 1, v55
  v_mul_u32_u24 v73, 0x600, v67
  v_mul_u32_u24 v66, s57, v72
  v_add_u32 v73, v73, v66
  v_lshl_add_u32 v73, v54, 2, v73
  s_lshr_b32 s49, s3, 1
  s_lshl_b32 s5, s49, 6
  s_add_u32 s6, s5, 256
  v_add_u32 v53, s6, v73
  s_lshl_b32 s6, s4, 7
  s_add_u32 s5, s5, s6
  v_add_u32 v52, s5, v73
  s_lshl_b32 s5, s47, 3
  s_add_u32 s5, s5, 4
  s_mul_i32 s5, s5, 384
  s_cmp_eq_u32 s47, 63
  s_cselect_b32 s37, 0, s5
  s_cselect_b32 s5, s5, 0
  s_cselect_b32 s6, s57, 0
  v_mul_u32_u24 v66, s6, v67
  v_sub_u32 v66, s5, v66
  s_lshl_b32 s38, s48, 3
  s_add_u32 s38, s38, 4
  s_xor_b32 s6, s4, 0
  s_lshl_b32 s6, s6, 1
  s_add_u32 s6, s6, s38
  s_and_b32 s6, s6, 511
  s_mul_i32 s6, s6, s57
  s_add_u32 s33, s6, s37
  s_xor_b32 s6, s4, 1
  s_lshl_b32 s6, s6, 1
  s_add_u32 s6, s6, s38
  s_and_b32 s6, s6, 511
  s_mul_i32 s6, s6, s57
  s_add_u32 s34, s6, s37
  s_xor_b32 s6, s4, 2
  s_lshl_b32 s6, s6, 1
  s_add_u32 s6, s6, s38
  s_and_b32 s6, s6, 511
  s_mul_i32 s6, s6, s57
  s_add_u32 s35, s6, s37
  s_xor_b32 s6, s4, 3
  s_lshl_b32 s6, s6, 1
  s_add_u32 s6, s6, s38
  s_and_b32 s6, s6, 511
  s_mul_i32 s6, s6, s57
  s_add_u32 s36, s6, s37
  v_add_u32 v7, v52, v66
  v_add_u32 v8, v53, v66
  s_lshr_b32 s5, s2, 6
  s_and_b32 s6, s2, 63
  s_mul_i32 s56, s5, 15
  s_lshl_b32 s43, s57, 5
  s_cmp_eq_u32 s6, 63
  s_cselect_b32 s6, s56, s6
  s_cselect_b32 s5, 60, s5
  s_cselect_b32 s43, 3072, s43
  s_mul_i32 s5, s5, 1572864
  s_mul_i32 s6, s6, 3072
  s_add_u32 s5, s5, s6
  s_add_u32 s56, s5, 787968
  s_cmp_eq_u32 s43, 3072
  s_cselect_b32 s10, s10, 95158272
  s_mul_i32 s5, s3, s57
  s_add_u32 s31, s56, s5
  s_add_u32 s32, s31, 786432
  s_mul_i32 s6, s43, 3
  s_add_u32 s5, s5, s6
  s_xor_b32 s6, s4, 0
  s_mul_i32 s6, s6, 393216
  s_sub_u32 s37, s6, s5
  s_xor_b32 s6, s4, 1
  s_mul_i32 s6, s6, 393216
  s_sub_u32 s38, s6, s5
  s_xor_b32 s6, s4, 2
  s_mul_i32 s6, s6, 393216
  s_sub_u32 s39, s6, s5
  s_xor_b32 s6, s4, 3
  s_mul_i32 s6, s6, 393216
  s_sub_u32 s40, s6, s5
  s_mul_i32 s97, s43, 17
  s_add_u32 s97, s97, s31
  s_mov_b32 s42, 0x3e553b95
  v_lshrrev_b32 v73, 2, v54
  v_lshl_add_u32 v66, v67, 1, v70
  v_lshl_add_u32 v73, v55, 3, v73
  v_lshlrev_b32 v73, 7, v73
  v_lshl_add_u32 v73, v66, 5, v73
  v_and_b32 v75, 3, v54
  v_lshl_add_u32 v73, v75, 3, v73
  s_mul_i32 s5, s3, 3
  s_and_b32 s6, s5, 3
  s_lshl_b32 s6, s6, 5
  s_lshr_b32 s7, s5, 2
  s_lshl_b32 s7, s7, 13
  s_add_u32 s7, s7, 24576
  v_xor_b32 v66, s6, v73
  v_add_u32 v61, s7, v66
  v_add_u32 v57, 73728, v61
  s_add_u32 s5, s5, 1
  s_and_b32 s6, s5, 3
  s_lshl_b32 s6, s6, 5
  s_lshr_b32 s7, s5, 2
  s_lshl_b32 s7, s7, 13
  s_add_u32 s7, s7, 24576
  v_xor_b32 v66, s6, v73
  v_add_u32 v62, s7, v66
  v_add_u32 v60, 73728, v62
  s_add_u32 s5, s5, 1
  s_and_b32 s6, s5, 3
  s_lshl_b32 s6, s6, 5
  s_lshr_b32 s7, s5, 2
  s_lshl_b32 s7, s7, 13
  s_add_u32 s7, s7, 24576
  v_xor_b32 v66, s6, v73
  v_add_u32 v63, s7, v66
  v_add_u32 v59, 73728, v63
  v_xor_b32 v66, s49, v67
  s_lshl_b32 s5, s4, 13
  v_lshl_add_u32 v73, v72, 3, v67
  v_lshl_add_u32 v73, v73, 2, v66
  v_lshl_add_u32 v73, v73, 4, v54
  v_lshlrev_b32 v73, 2, v73
  s_add_u32 s5, s5, 122880
  v_add_u32 v68, s5, v73
  v_add_u32 v69, 128, v68
  v_add_u32 v54, 139264, v73
  v_add_u32 v55, 128, v54
  s_mov_b32 s58, 0x05040100
  s_mov_b32 s59, 0x07060302
  v_cmp_gt_u32 vcc, 2, v75
  v_mov_b32 v73, 0x3f803f80
  v_mov_b32 v66, 0x44444444
  v_cndmask_b32 v73, 0, v73, vcc
  v_cmp_eq_u32 vcc, 1, v75
  v_mov_b32 v74, 0xeeeeeeee
  v_accvgpr_write_b32 a240, v73
  v_accvgpr_write_b32 a241, v73
  v_accvgpr_write_b32 a242, v73
  v_accvgpr_write_b32 a243, v73
  v_cndmask_b32 v10, v66, v74, vcc
  v_mov_b32 v9, 1.0
  s_mov_b32 s98, s43
  s_mov_b64 s[20:21], s[62:63]
  s_mov_b32 s22, 402653184
  s_min_u32 s96, s3, 1
  s_lshl_b32 s96, s96, 7
  s_xor_b32 s96, s96, 1152
  s_mov_b64 s[62:63], -1
  v_lshlrev_b32 v11, 3, v64
  v_lshlrev_b32 v73, 2, v65
  v_add_u32 v73, 155712, v73
  v_mov_b32 v66, 0
  ds_write_b32 v73, v66
  v_mov_b64 v[14:15], 0
  v_mov_b64 v[20:21], 0
  v_sub_u32 v73, v70, v72
  v_mul_i32_i24 v73, 15, v73
  v_lshlrev_b32 v66, 2, v67
  v_sub_u32 v74, v65, v66
  v_add3_u32 v73, v73, v74, 19
  s_mul_i32 s5, s3, 2050
  s_add_u32 s5, s5, 147456
  v_lshl_add_u32 v64, v73, 3, s5
  v_mov_b64 v[24:25], 0
  v_mov_b64 v[26:27], 0
  v_mov_b64 v[28:29], 0
  v_mov_b64 v[30:31], 0
  v_mov_b64 v[32:33], 0
  v_mov_b64 v[34:35], 0
  v_mov_b64 v[36:37], 0
  v_mov_b64 v[38:39], 0
  v_mov_b64 v[40:41], 0
  v_mov_b64 v[42:43], 0
  v_mov_b64 v[44:45], 0
  v_mov_b64 v[46:47], 0
  v_mov_b64 v[48:49], 0
  v_mov_b64 v[50:51], 0
  v_xor_b32 v73, v66, v65
  s_cmp_eq_u32 s47, 63
  s_cselect_b32 s5, 4, 0
  v_and_b32 v73, s5, v73
  v_cmp_eq_u32 vcc, 0, v73
  s_cmp_eq_u32 s48, 63
  s_cselect_b32 s5, 0xc31044fe, 0
  v_mov_b32 v93, s5
  v_mov_b32 v70, 0xc31044fe
  v_cndmask_b32 v93, 0, v93, vcc
  v_cndmask_b32 v70, v70, 0, vcc
  s_add_u32 s5, s44, 0
  s_add_u32 m0, s46, 24576
  s_nop 0
  buffer_load_dwordx4 v58, s[12:15], s5 offen offset:0 lds
  s_add_u32 m0, s46, 32640
  s_nop 0
  buffer_load_dwordx4 v58, s[12:15], s5 offen offset:128 lds
  s_add_u32 m0, s46, 40704
  s_nop 0
  buffer_load_dwordx4 v58, s[12:15], s5 offen offset:256 lds
  s_add_u32 s5, s44, 36864
  s_add_u32 m0, s46, 28672
  s_nop 0
  buffer_load_dwordx4 v58, s[12:15], s5 offen offset:0 lds
  s_add_u32 m0, s46, 36736
  s_nop 0
  buffer_load_dwordx4 v58, s[12:15], s5 offen offset:128 lds
  s_add_u32 m0, s46, 44800
  s_nop 0
  buffer_load_dwordx4 v58, s[12:15], s5 offen offset:256 lds
  s_waitcnt vmcnt(12)
  ds_read_u16_d16_hi v24, v64 offset:24
  ds_read_u16_d16_hi v25, v64 offset:16
  ds_read_u16_d16_hi v26, v64 offset:8
  ds_read_u16_d16_hi v27, v64 offset:0
  ds_read_u16_d16_hi v28, v64 offset:264
  ds_read_u16_d16_hi v29, v64 offset:256
  ds_read_u16_d16_hi v30, v64 offset:248
  ds_read_u16_d16_hi v31, v64 offset:240
  ds_read_u16_d16_hi v32, v64 offset:504
  ds_read_u16_d16_hi v33, v64 offset:496
  ds_read_u16_d16_hi v34, v64 offset:488
  ds_read_u16_d16_hi v35, v64 offset:480
  ds_read_u16_d16_hi v36, v64 offset:744
  ds_read_u16_d16_hi v37, v64 offset:736
  ds_read_u16_d16_hi v38, v64 offset:728
  ds_read_u16_d16_hi v39, v64 offset:720
  ds_read_u16_d16_hi v40, v64 offset:984
  ds_read_u16_d16_hi v41, v64 offset:976
  ds_read_u16_d16_hi v42, v64 offset:968
  ds_read_u16_d16_hi v43, v64 offset:960
  ds_read_u16_d16_hi v44, v64 offset:1224
  ds_read_u16_d16_hi v45, v64 offset:1216
  ds_read_u16_d16_hi v46, v64 offset:1208
  ds_read_u16_d16_hi v47, v64 offset:1200
  ds_read_u16_d16_hi v48, v64 offset:1464
  ds_read_u16_d16_hi v49, v64 offset:1456
  ds_read_u16_d16_hi v50, v64 offset:1448
  ds_read_u16_d16_hi v51, v64 offset:1440
  s_mov_b32 s5, 0x3fb8aa3b
  v_add_f32 v93, v70, v93
  s_waitcnt lgkmcnt(15)
  v_mul_f32 v24, s5, v24
  v_mul_f32 v25, s5, v25
  v_mul_f32 v26, s5, v26
  v_mul_f32 v27, s5, v27
  v_mul_f32 v28, s5, v28
  v_mul_f32 v29, s5, v29
  v_mul_f32 v30, s5, v30
  v_mul_f32 v31, s5, v31
  v_mul_f32 v32, s5, v32
  v_mul_f32 v33, s5, v33
  v_mul_f32 v34, s5, v34
  v_mul_f32 v35, s5, v35
  v_mul_f32 v36, s5, v36
  s_waitcnt lgkmcnt(14)
  v_mul_f32 v37, s5, v37
  s_waitcnt lgkmcnt(13)
  v_mul_f32 v38, s5, v38
  s_waitcnt lgkmcnt(12)
  v_mul_f32 v39, s5, v39
  s_waitcnt lgkmcnt(11)
  v_mul_f32 v40, s5, v40
  s_waitcnt lgkmcnt(10)
  v_mul_f32 v41, s5, v41
  s_waitcnt lgkmcnt(9)
  v_mul_f32 v42, s5, v42
  s_waitcnt lgkmcnt(8)
  v_mul_f32 v43, s5, v43
  s_waitcnt lgkmcnt(7)
  v_mul_f32 v44, s5, v44
  s_waitcnt lgkmcnt(6)
  v_mul_f32 v45, s5, v45
  s_waitcnt lgkmcnt(5)
  v_mul_f32 v46, s5, v46
  s_waitcnt lgkmcnt(4)
  v_mul_f32 v47, s5, v47
  s_waitcnt lgkmcnt(3)
  v_mul_f32 v48, s5, v48
  s_waitcnt lgkmcnt(2)
  v_mul_f32 v49, s5, v49
  s_waitcnt lgkmcnt(1)
  v_mul_f32 v50, s5, v50
  s_waitcnt lgkmcnt(0)
  v_mul_f32 v51, s5, v51
  v_add_f32 v72, v93, v48
  v_add_f32 v73, v93, v49
  v_add_f32 v74, v93, v50
  v_add_f32 v75, v93, v51
  v_add_f32 v64, v93, v44
  v_add_f32 v65, v93, v45
  v_add_f32 v66, v93, v46
  v_add_f32 v67, v93, v47
  v_add_f32 v76, v93, v40
  v_add_f32 v77, v93, v41
  v_add_f32 v78, v93, v42
  v_add_f32 v79, v93, v43
  v_add_f32 v84, v93, v32
  v_add_f32 v85, v93, v33
  v_add_f32 v86, v93, v34
  v_add_f32 v87, v93, v35
  v_add_f32 v80, v93, v28
  v_add_f32 v81, v93, v29
  v_add_f32 v82, v93, v30
  v_add_f32 v83, v93, v31
  v_add_f32 v88, v93, v24
  v_add_f32 v89, v93, v25
  v_add_f32 v90, v93, v26
  v_add_f32 v91, v93, v27
  s_add_u32 s5, s44, 73728
  s_add_u32 m0, s46, 49152
  s_nop 0
  buffer_load_dwordx4 v58, s[12:15], s5 offen offset:0 lds
  s_add_u32 m0, s46, 57216
  s_nop 0
  buffer_load_dwordx4 v58, s[12:15], s5 offen offset:128 lds
  s_add_u32 m0, s46, 65280
  s_nop 0
  buffer_load_dwordx4 v58, s[12:15], s5 offen offset:256 lds
  s_add_u32 s5, s44, 110592
  s_add_u32 m0, s46, 53248
  s_nop 0
  buffer_load_dwordx4 v58, s[12:15], s5 offen offset:0 lds
  s_add_u32 m0, s46, 61312
  s_nop 0
  buffer_load_dwordx4 v58, s[12:15], s5 offen offset:128 lds
  s_add_u32 m0, s46, 69376
  s_nop 0
  buffer_load_dwordx4 v58, s[12:15], s5 offen offset:256 lds
  s_cmp_ge_u32 s50, s14
  s_cselect_b64 s[52:53], s[16:17], s[12:13]
  s_cselect_b64 s[54:55], s[18:19], s[14:15]
  s_cselect_b32 s5, s14, 0
  s_sub_u32 s50, s50, s5
  buffer_load_dword v96, v92, s[52:55], s50 offen
  s_mov_b64 exec, 0
  s_cmp_eq_u32 s3, 0
  s_cbranch_scc1 L_hop_0_0
  s_cmp_eq_u32 s3, 1
  s_cbranch_scc1 L_hop_1_0
  s_cmp_eq_u32 s3, 2
  s_cbranch_scc1 L_hop_2_0
  s_branch L_hop_3_0
  s_nop 0
  s_nop 0
  s_nop 0
  s_nop 0
  s_nop 0
  s_nop 0
  s_nop 0
  s_nop 0
  s_nop 0
  s_nop 0
  s_nop 0
  s_nop 0
  s_nop 0
  s_nop 0
  s_nop 0
  s_nop 0
  s_nop 0
  s_nop 0
  s_nop 0
  s_nop 0
  s_nop 0
  s_nop 0
  s_nop 0
  s_nop 0
  s_nop 0
  s_nop 0
  s_nop 0
  s_nop 0
  s_nop 0
  s_nop 0
  s_nop 0
  s_nop 0
  s_nop 0
  s_nop 0
  s_nop 0
  s_nop 0
  s_nop 0
  s_nop 0
  s_nop 0
  s_nop 0
  s_nop 0
  s_nop 0
  s_nop 0
  s_nop 0
  s_nop 0
  s_nop 0
  s_nop 0
  s_nop 0
  s_nop 0
  s_nop 0
  s_nop 0
  s_nop 0
  s_nop 0
  s_nop 0
  s_nop 0
  s_nop 0
  s_nop 0
  s_nop 0
  s_nop 0
  s_nop 0
  s_nop 0
  s_nop 0
  s_nop 0
  s_nop 0
  s_nop 0
  s_nop 0
  s_nop 0
  s_nop 0
  s_nop 0
  s_nop 0
  s_nop 0
  s_nop 0
  s_nop 0
  s_nop 0
  s_nop 0
  s_nop 0
  s_nop 0
  s_nop 0
  s_nop 0
  s_nop 0
  s_nop 0
  s_nop 0
  s_nop 0
  s_nop 0
  s_nop 0
  s_nop 0
  s_nop 0
  s_nop 0
  s_nop 0
  s_nop 0
  s_nop 0
  s_nop 0
  s_nop 0
  s_nop 0
  s_nop 0
  s_nop 0
  s_nop 0
  s_nop 0
  s_nop 0
  s_nop 0
  s_nop 0
  s_nop 0
  s_nop 0
  s_nop 0
  s_nop 0
  s_nop 0
  s_nop 0
  s_nop 0
  s_nop 0
  s_nop 0
  s_nop 0
  s_nop 0
  s_nop 0
  s_nop 0
  s_nop 0
  s_nop 0
  s_nop 0
  s_nop 0
  s_nop 0
  s_nop 0
  s_nop 0
  s_nop 0
  s_nop 0
  s_nop 0
  s_nop 0
  s_nop 0
  s_nop 0
  s_nop 0
  s_nop 0
  s_nop 0
  s_nop 0
  s_nop 0
  s_nop 0
  s_nop 0
  s_nop 0
  s_nop 0
  s_nop 0
  s_nop 0
  s_nop 0
  s_nop 0
  s_nop 0
  s_nop 0
  s_nop 0
  s_nop 0
  s_nop 0
  s_nop 0
  s_nop 0
  s_nop 0
  s_nop 0
  s_nop 0
  s_nop 0
  s_nop 0
  s_nop 0
  s_nop 0
  s_nop 0
  s_nop 0
  s_nop 0
  s_nop 0
  s_nop 0
  s_nop 0
  s_nop 0
  s_nop 0
  s_nop 0
  s_nop 0
  s_nop 0
  s_nop 0
  s_nop 0
  s_nop 0
  s_nop 0
  s_nop 0
  s_nop 0
  s_nop 0
  s_nop 0
  s_nop 0
  s_nop 0
  s_nop 0
  s_nop 0
  s_nop 0
  s_nop 0
  s_nop 0
  s_nop 0
  s_nop 0
  s_nop 0
  s_nop 0
  s_nop 0
  s_nop 0
  s_nop 0
  s_nop 0
  s_nop 0
  s_nop 0
  s_nop 0
  s_nop 0
  s_nop 0
  s_nop 0
  s_nop 0
  s_nop 0
  s_nop 0
  s_nop 0
  s_nop 0
  s_nop 0
  s_nop 0
  s_nop 0
  s_nop 0
  s_nop 0
  s_nop 0
  s_nop 0
  s_nop 0
  s_nop 0
  s_nop 0
  s_nop 0
  s_nop 0
  s_nop 0
  s_nop 0
  s_nop 0
  s_nop 0
  s_nop 0
  s_nop 0
  s_nop 0
  s_nop 0
  s_nop 0
  s_nop 0
  s_nop 0
  s_nop 0
  s_nop 0
  s_nop 0
  s_nop 0
  s_nop 0
  s_nop 0
  s_nop 0
  s_nop 0
  s_nop 0
  s_nop 0
  s_nop 0
  s_nop 0
  s_nop 0
  s_nop 0
  s_nop 0
  s_nop 0
  s_nop 0
  s_nop 0
  s_nop 0
  s_nop 0
  s_nop 0
  s_nop 0
  s_nop 0
  s_nop 0
  s_nop 0
  s_nop 0
  s_nop 0
  s_nop 0
  s_nop 0
  s_nop 0
  s_nop 0
  s_nop 0
  s_nop 0
  s_nop 0
  s_nop 0
  s_nop 0
  s_nop 0
  s_nop 0
  s_nop 0
  s_nop 0
  s_nop 0
  s_nop 0
  s_nop 0
  s_nop 0
  s_nop 0
  s_nop 0
  s_nop 0
  s_nop 0
  s_nop 0
  s_nop 0
  s_nop 0
  s_nop 0
  s_nop 0
  s_nop 0
  s_nop 0
  s_nop 0
  s_nop 0
  s_nop 0
  s_nop 0
  s_nop 0
  s_nop 0
  s_nop 0
  s_nop 0
  s_nop 0
  s_nop 0
  s_nop 0
  s_nop 0
  s_nop 0
  s_nop 0
  s_nop 0
  s_nop 0
  s_nop 0
  s_nop 0
  s_nop 0
  s_nop 0
  s_nop 0
  s_nop 0
  s_nop 0
  s_nop 0
  s_nop 0
  s_nop 0
  s_nop 0
  s_nop 0
  s_nop 0
  s_nop 0
  s_nop 0
  s_nop 0
  s_nop 0
  s_nop 0
  s_nop 0
  s_nop 0
  s_nop 0
  s_nop 0
  s_nop 0
  s_nop 0
  s_nop 0
  s_nop 0
  s_nop 0
  s_nop 0
  s_nop 0
  s_nop 0
  s_nop 0
  s_nop 0
  s_nop 0
  s_nop 0
  s_nop 0
  s_nop 0
  s_nop 0
  s_nop 0
  s_nop 0
  s_nop 0
  s_nop 0
  s_nop 0
  s_nop 0
  s_nop 0
  s_nop 0
  s_nop 0
  s_nop 0
  s_nop 0
  s_nop 0
  s_nop 0
  s_nop 0
  s_nop 0
  s_nop 0
  s_nop 0
  s_nop 0
  s_nop 0
  s_nop 0
  s_nop 0
  s_nop 0
  s_nop 0
  s_nop 0
  s_nop 0
  s_nop 0
  s_nop 0
  s_nop 0
  s_nop 0
  s_nop 0
  s_nop 0
  s_nop 0
  s_nop 0
  s_nop 0
  s_nop 0
  s_nop 0
  s_nop 0
  s_nop 0
  s_nop 0
  s_nop 0
  s_nop 0
  s_nop 0
  s_nop 0
  s_nop 0
  s_nop 0
  s_nop 0
  s_nop 0
  s_nop 0
  s_nop 0
  s_nop 0
  s_nop 0
  s_nop 0
  s_nop 0
  s_nop 0
  s_nop 0
  s_nop 0
  s_nop 0
  s_nop 0
  s_nop 0
  s_nop 0
  s_nop 0
  s_nop 0
  s_nop 0
  s_nop 0
  s_nop 0
  s_nop 0
  s_nop 0
  s_nop 0
  s_nop 0
  s_nop 0
  s_nop 0
  s_nop 0
  s_nop 0
  s_nop 0
  s_nop 0
  s_nop 0
  s_nop 0
  s_nop 0
  s_nop 0
  s_nop 0
  s_nop 0
  s_nop 0
  s_nop 0
  s_nop 0
  s_nop 0
  s_nop 0
  s_nop 0
  s_nop 0
  s_nop 0
  s_nop 0
  s_nop 0
  s_nop 0
  s_nop 0
  s_nop 0
  s_nop 0
  s_nop 0
L_walk:
  s_mov_b64 exec, -1
L_walked:
  s_waitcnt vmcnt(13)
  s_barrier
  ds_read_b128 v[184:187], v0 offset:0
  ds_read_b128 v[188:191], v1 offset:0
  ds_read_b128 v[208:211], v0 offset:2048
  ds_read_b128 v[212:215], v1 offset:2048
  ds_read_b128 v[232:235], v0 offset:4096
  ds_read_b128 v[236:239], v1 offset:4096
  ds_read_b128 a[216:219], v0 offset:6144
  ds_read_b128 a[220:223], v1 offset:6144
  s_add_u32 s5, s44, 147456
  s_add_u32 m0, s46, 73728
  s_nop 0
  buffer_load_dwordx4 v58, s[12:15], s5 offen offset:0 lds
  s_add_u32 m0, s46, 81792
  s_nop 0
  buffer_load_dwordx4 v58, s[12:15], s5 offen offset:128 lds
  s_add_u32 m0, s46, 89856
  s_nop 0
  buffer_load_dwordx4 v58, s[12:15], s5 offen offset:256 lds
  s_waitcnt vmcnt(10)
  s_barrier
  ds_read_b64_tr_b16 a[0:1], v61 offset:0
  ds_read_b64_tr_b16 a[2:3], v61 offset:512
  ds_read_b64_tr_b16 a[12:13], v61 offset:4096
  ds_read_b64_tr_b16 a[14:15], v61 offset:4608
  s_waitcnt lgkmcnt(2)
  v_mfma_f32_16x16x32_bf16 v[116:119], a[0:3], v[184:187], 0
  s_add_u32 s5, s44, 184320
  s_add_u32 m0, s46, 77824
  ds_read_b64_tr_b16 a[4:5], v62 offset:0
  s_waitcnt lgkmcnt(1)
  v_mfma_f32_16x16x32_bf16 v[116:119], a[12:15], v[188:191], v[116:119]
  buffer_load_dwordx4 v58, s[12:15], s5 offen offset:0 lds
  v_mfma_f32_16x16x32_bf16 v[128:131], a[0:3], v[208:211], 0
  s_add_u32 m0, s46, 85888
  ds_read_b64_tr_b16 a[6:7], v62 offset:512
  ds_read_b64_tr_b16 a[16:17], v62 offset:4096
  v_mfma_f32_16x16x32_bf16 v[128:131], a[12:15], v[212:215], v[128:131]
  buffer_load_dwordx4 v58, s[12:15], s5 offen offset:128 lds
  v_mfma_f32_16x16x32_bf16 v[120:123], a[0:3], v[232:235], 0
  s_add_u32 m0, s46, 93952
  ds_read_b64_tr_b16 a[18:19], v62 offset:4608
  ds_read_b64_tr_b16 a[8:9], v63 offset:0
  v_mfma_f32_16x16x32_bf16 v[120:123], a[12:15], v[236:239], v[120:123]
  buffer_load_dwordx4 v58, s[12:15], s5 offen offset:256 lds
  v_mfma_f32_16x16x32_bf16 v[92:95], a[0:3], a[216:219], 0
  s_add_u32 s5, s44, 384
  s_add_u32 m0, s46, 98304
  ds_read_b64_tr_b16 a[10:11], v63 offset:512
  v_mfma_f32_16x16x32_bf16 v[92:95], a[12:15], a[220:223], v[92:95]
  s_waitcnt lgkmcnt(3)
  ds_read_b64_tr_b16 a[20:21], v63 offset:4096
  ds_read_b64_tr_b16 a[22:23], v63 offset:4608
  v_mfma_f32_16x16x32_bf16 v[136:139], a[4:7], v[184:187], 0
  buffer_load_dwordx4 v58, s[12:15], s5 offen offset:0 lds
  s_waitcnt lgkmcnt(4)
  v_mfma_f32_16x16x32_bf16 v[136:139], a[16:19], v[188:191], v[136:139]
  s_add_u32 m0, s46, 106368
  ds_read_b128 v[192:195], v0 offset:8192
  ds_read_b128 v[196:199], v1 offset:8192
  v_mfma_f32_16x16x32_bf16 v[132:135], a[4:7], v[208:211], 0
  buffer_load_dwordx4 v58, s[12:15], s5 offen offset:128 lds
  v_mfma_f32_16x16x32_bf16 v[132:135], a[16:19], v[212:215], v[132:135]
  s_add_u32 m0, s46, 114432
  ds_read_b128 v[216:219], v0 offset:10240
  ds_read_b128 v[220:223], v1 offset:10240
  v_mfma_f32_16x16x32_bf16 v[148:151], a[4:7], v[232:235], 0
  buffer_load_dwordx4 v58, s[12:15], s5 offen offset:256 lds
  v_mfma_f32_16x16x32_bf16 v[148:151], a[16:19], v[236:239], v[148:151]
  s_add_u32 s5, s44, 37248
  s_add_u32 m0, s46, 102400
  ds_read_b128 v[240:243], v0 offset:12288
  v_mfma_f32_16x16x32_bf16 v[108:111], a[4:7], a[216:219], 0
  s_waitcnt lgkmcnt(3)
  ds_read_b128 v[244:247], v1 offset:12288
  ds_read_b128 a[224:227], v0 offset:14336
  v_mfma_f32_16x16x32_bf16 v[108:111], a[16:19], a[220:223], v[108:111]
  s_waitcnt vmcnt(10)
  s_barrier
  v_mfma_f32_16x16x32_bf16 v[140:143], a[8:11], v[184:187], 0
  buffer_load_dwordx4 v58, s[12:15], s5 offen offset:0 lds
  v_mfma_f32_16x16x32_bf16 v[140:143], a[20:23], v[188:191], v[140:143]
  s_add_u32 m0, s46, 110464
  ds_read_b64_tr_b16 a[24:25], v61 offset:24576
  ds_read_b64_tr_b16 a[26:27], v61 offset:25088
  v_mfma_f32_16x16x32_bf16 v[124:127], a[8:11], v[208:211], 0
  buffer_load_dwordx4 v58, s[12:15], s5 offen offset:128 lds
  v_mfma_f32_16x16x32_bf16 v[124:127], a[20:23], v[212:215], v[124:127]
  s_add_u32 m0, s46, 118528
  ds_read_b64_tr_b16 a[36:37], v61 offset:28672
  ds_read_b64_tr_b16 a[38:39], v61 offset:29184
  v_mfma_f32_16x16x32_bf16 v[100:103], a[8:11], v[232:235], 0
  buffer_load_dwordx4 v58, s[12:15], s5 offen offset:256 lds
  v_mfma_f32_16x16x32_bf16 v[100:103], a[20:23], v[236:239], v[100:103]
  ds_read_b128 a[228:231], v1 offset:14336
  ds_read_b64_tr_b16 a[28:29], v62 offset:24576
  v_mfma_f32_16x16x32_bf16 v[112:115], a[8:11], a[216:219], 0
  ds_read_b64_tr_b16 a[30:31], v62 offset:25088
  ds_read_b64_tr_b16 a[40:41], v62 offset:28672
  v_mfma_f32_16x16x32_bf16 v[112:115], a[20:23], a[220:223], v[112:115]
  s_waitcnt lgkmcnt(6)
  ds_read_b64_tr_b16 a[42:43], v62 offset:29184
  ds_read_b64_tr_b16 a[32:33], v63 offset:24576
  v_mfma_f32_16x16x32_bf16 v[116:119], a[24:27], v[192:195], v[116:119]
  s_waitcnt lgkmcnt(6)
  ds_read_b64_tr_b16 a[34:35], v63 offset:25088
  ds_read_b64_tr_b16 a[44:45], v63 offset:28672
  v_mfma_f32_16x16x32_bf16 v[116:119], a[36:39], v[196:199], v[116:119]
  ds_read_b64_tr_b16 a[46:47], v63 offset:29184
  ds_read_b128 v[200:203], v0 offset:16384
  v_mfma_f32_16x16x32_bf16 v[128:131], a[24:27], v[216:219], v[128:131]
  ds_read_b128 v[204:207], v1 offset:16384
  ds_read_b128 v[224:227], v0 offset:18432
  v_mfma_f32_16x16x32_bf16 v[128:131], a[36:39], v[220:223], v[128:131]
  ds_read_b128 v[228:231], v1 offset:18432
  ds_read_b128 v[248:251], v0 offset:20480
  v_mfma_f32_16x16x32_bf16 v[120:123], a[24:27], v[240:243], v[120:123]
  ds_read_b128 v[252:255], v1 offset:20480
  ds_read_b128 a[232:235], v0 offset:22528
  v_mfma_f32_16x16x32_bf16 v[120:123], a[36:39], v[244:247], v[120:123]
  s_add_u32 s5, s44, 74112
  s_add_u32 m0, s46, 122880
  ds_read_b128 a[236:239], v1 offset:22528
  v_mfma_f32_16x16x32_bf16 v[92:95], a[24:27], a[224:227], v[92:95]
  s_waitcnt lgkmcnt(7)
  v_mfma_f32_16x16x32_bf16 v[92:95], a[36:39], a[228:231], v[92:95]
  v_mfma_f32_16x16x32_bf16 v[136:139], a[28:31], v[192:195], v[136:139]
  buffer_load_dwordx4 v58, s[12:15], s5 offen offset:0 lds
  v_mfma_f32_16x16x32_bf16 v[136:139], a[40:43], v[196:199], v[136:139]
  s_add_u32 m0, s46, 130944
  v_mfma_f32_16x16x32_bf16 v[132:135], a[28:31], v[216:219], v[132:135]
  buffer_load_dwordx4 v58, s[12:15], s5 offen offset:128 lds
  v_mfma_f32_16x16x32_bf16 v[132:135], a[40:43], v[220:223], v[132:135]
  s_add_u32 m0, s46, 139008
  v_mfma_f32_16x16x32_bf16 v[148:151], a[28:31], v[240:243], v[148:151]
  buffer_load_dwordx4 v58, s[12:15], s5 offen offset:256 lds
  v_mfma_f32_16x16x32_bf16 v[148:151], a[40:43], v[244:247], v[148:151]
  s_add_u32 s5, s44, 110976
  s_add_u32 m0, s46, 126976
  v_mfma_f32_16x16x32_bf16 v[108:111], a[28:31], a[224:227], v[108:111]
  v_mfma_f32_16x16x32_bf16 v[108:111], a[40:43], a[228:231], v[108:111]
  s_waitcnt vmcnt(9)
  s_barrier
  v_mfma_f32_16x16x32_bf16 v[140:143], a[32:35], v[192:195], v[140:143]
  buffer_load_dwordx4 v58, s[12:15], s5 offen offset:0 lds
  v_mfma_f32_16x16x32_bf16 v[140:143], a[44:47], v[196:199], v[140:143]
  s_add_u32 m0, s46, 135040
  ds_read_b64_tr_b16 a[48:49], v61 offset:49152
  ds_read_b64_tr_b16 a[50:51], v61 offset:49664
  v_mfma_f32_16x16x32_bf16 v[124:127], a[32:35], v[216:219], v[124:127]
  buffer_load_dwordx4 v58, s[12:15], s5 offen offset:128 lds
  v_mfma_f32_16x16x32_bf16 v[124:127], a[44:47], v[220:223], v[124:127]
  s_add_u32 m0, s46, 143104
  ds_read_b64_tr_b16 a[60:61], v61 offset:53248
  ds_read_b64_tr_b16 a[62:63], v61 offset:53760
  v_mfma_f32_16x16x32_bf16 v[100:103], a[32:35], v[240:243], v[100:103]
  buffer_load_dwordx4 v58, s[12:15], s5 offen offset:256 lds
  v_mfma_f32_16x16x32_bf16 v[100:103], a[44:47], v[244:247], v[100:103]
  ds_read_b64_tr_b16 a[52:53], v62 offset:49152
  ds_read_b64_tr_b16 a[54:55], v62 offset:49664
  v_mfma_f32_16x16x32_bf16 v[112:115], a[32:35], a[224:227], v[112:115]
  ds_read_b64_tr_b16 a[64:65], v62 offset:53248
  ds_read_b64_tr_b16 a[66:67], v62 offset:53760
  v_mfma_f32_16x16x32_bf16 v[112:115], a[44:47], a[228:231], v[112:115]
  s_waitcnt lgkmcnt(6)
  ds_read_b64_tr_b16 a[56:57], v63 offset:49152
  ds_read_b64_tr_b16 a[58:59], v63 offset:49664
  v_mfma_f32_16x16x32_bf16 v[116:119], a[48:51], v[200:203], v[116:119]
  s_waitcnt lgkmcnt(6)
  ds_read_b64_tr_b16 a[68:69], v63 offset:53248
  ds_read_b64_tr_b16 a[70:71], v63 offset:53760
  v_mfma_f32_16x16x32_bf16 v[116:119], a[60:63], v[204:207], v[116:119]
  v_mfma_f32_16x16x32_bf16 v[128:131], a[48:51], v[224:227], v[128:131]
  v_mfma_f32_16x16x32_bf16 v[128:131], a[60:63], v[228:231], v[128:131]
  v_mfma_f32_16x16x32_bf16 v[120:123], a[48:51], v[248:251], v[120:123]
  v_mul_f32 v116, s42, v116
  v_mul_f32 v117, s42, v117
  v_mfma_f32_16x16x32_bf16 v[120:123], a[60:63], v[252:255], v[120:123]
  s_add_u32 s5, s44, 147840
  s_add_u32 m0, s46, 24576
  v_mul_f32 v118, s42, v118
  v_mfma_f32_16x16x32_bf16 v[92:95], a[48:51], a[232:235], v[92:95]
  v_mul_f32 v119, s42, v119
  v_cvt_pk_bf16_f32 v12, v116, v117
  v_mfma_f32_16x16x32_bf16 v[92:95], a[60:63], a[236:239], v[92:95]
  s_waitcnt lgkmcnt(0)
  v_cvt_pk_bf16_f32 v13, v118, v119
  v_mul_f32 v128, s42, v128
  v_mfma_f32_16x16x32_bf16 v[136:139], a[52:55], v[200:203], v[136:139]
  buffer_load_dwordx4 v58, s[12:15], s5 offen offset:0 lds
  v_mfma_f32_16x16x32_bf16 v[136:139], a[64:67], v[204:207], v[136:139]
  s_add_u32 m0, s46, 32640
  v_mul_f32 v129, s42, v129
  v_mul_f32 v130, s42, v130
  v_mfma_f32_16x16x32_bf16 v[132:135], a[52:55], v[224:227], v[132:135]
  buffer_load_dwordx4 v58, s[12:15], s5 offen offset:128 lds
  v_mfma_f32_16x16x32_bf16 v[132:135], a[64:67], v[228:231], v[132:135]
  s_add_u32 m0, s46, 40704
  v_mul_f32 v131, s42, v131
  v_cvt_pk_bf16_f32 v180, v128, v129
  v_mfma_f32_16x16x32_bf16 v[148:151], a[52:55], v[248:251], v[148:151]
  buffer_load_dwordx4 v58, s[12:15], s5 offen offset:256 lds
  v_mfma_f32_16x16x32_bf16 v[148:151], a[64:67], v[252:255], v[148:151]
  s_add_u32 s5, s44, 184704
  s_add_u32 m0, s46, 28672
  v_mul_f32 v136, s42, v136
  v_mfma_f32_16x16x32_bf16 v[108:111], a[52:55], a[232:235], v[108:111]
  v_mul_f32 v137, s42, v137
  v_mul_f32 v138, s42, v138
  v_mfma_f32_16x16x32_bf16 v[108:111], a[64:67], a[236:239], v[108:111]
  s_waitcnt vmcnt(9)
  s_barrier
  v_mfma_f32_16x16x32_bf16 v[140:143], a[56:59], v[200:203], v[140:143]
  buffer_load_dwordx4 v58, s[12:15], s5 offen offset:0 lds
  v_mfma_f32_16x16x32_bf16 v[140:143], a[68:71], v[204:207], v[140:143]
  s_add_u32 m0, s46, 36736
  ds_read_b64_tr_b16 a[72:73], v57 offset:0
  ds_read_b64_tr_b16 a[74:75], v57 offset:512
  v_mfma_f32_16x16x32_bf16 v[124:127], a[56:59], v[224:227], v[124:127]
  buffer_load_dwordx4 v58, s[12:15], s5 offen offset:128 lds
  v_mfma_f32_16x16x32_bf16 v[124:127], a[68:71], v[228:231], v[124:127]
  s_add_u32 m0, s46, 44800
  ds_read_b64_tr_b16 a[84:85], v57 offset:4096
  ds_read_b64_tr_b16 a[86:87], v57 offset:4608
  v_mfma_f32_16x16x32_bf16 v[100:103], a[56:59], v[248:251], v[100:103]
  buffer_load_dwordx4 v58, s[12:15], s5 offen offset:256 lds
  v_mfma_f32_16x16x32_bf16 v[100:103], a[68:71], v[252:255], v[100:103]
  ds_read_b64_tr_b16 a[76:77], v60 offset:0
  ds_read_b64_tr_b16 a[78:79], v60 offset:512
  v_mfma_f32_16x16x32_bf16 v[112:115], a[56:59], a[232:235], v[112:115]
  ds_read_b64_tr_b16 a[88:89], v60 offset:4096
  ds_read_b64_tr_b16 a[90:91], v60 offset:4608
  v_mfma_f32_16x16x32_bf16 v[112:115], a[68:71], a[236:239], v[112:115]
  s_waitcnt lgkmcnt(6)
  ds_read_b64_tr_b16 a[80:81], v59 offset:0
  ds_read_b64_tr_b16 a[82:83], v59 offset:512
  v_mfma_f32_16x16x32_bf16 v[116:119], a[72:75], v[184:187], 0
  s_waitcnt lgkmcnt(6)
  ds_read_b64_tr_b16 a[92:93], v59 offset:4096
  ds_read_b64_tr_b16 a[94:95], v59 offset:4608
  v_mfma_f32_16x16x32_bf16 v[116:119], a[84:87], v[188:191], v[116:119]
  v_mul_f32 v139, s42, v139
  v_cvt_pk_bf16_f32 v144, v136, v137
  v_mfma_f32_16x16x32_bf16 v[156:159], a[72:75], v[208:211], 0
  v_cvt_pk_bf16_f32 v145, v138, v139
  v_mul_f32 v140, s42, v140
  v_mfma_f32_16x16x32_bf16 v[156:159], a[84:87], v[212:215], v[156:159]
  v_mul_f32 v141, s42, v141
  v_mul_f32 v142, s42, v142
  v_mfma_f32_16x16x32_bf16 v[166:169], a[72:75], v[232:235], 0
  v_mul_f32 v143, s42, v143
  v_cvt_pk_bf16_f32 v146, v140, v141
  v_mfma_f32_16x16x32_bf16 v[166:169], a[84:87], v[236:239], v[166:169]
  s_add_u32 s5, s44, 768
  s_add_u32 m0, s46, 49152
  v_cvt_pk_bf16_f32 v147, v142, v143
  v_mfma_f32_16x16x32_bf16 v[172:175], a[72:75], a[216:219], 0
  v_cvt_pk_bf16_f32 v181, v130, v131
  v_mul_f32 v132, s42, v132
  v_mfma_f32_16x16x32_bf16 v[172:175], a[84:87], a[220:223], v[172:175]
  s_waitcnt lgkmcnt(0)
  v_mul_f32 v133, s42, v133
  v_mul_f32 v134, s42, v134
  v_mfma_f32_16x16x32_bf16 v[136:139], a[76:79], v[184:187], 0
  buffer_load_dwordx4 v58, s[12:15], s5 offen offset:0 lds
  v_mfma_f32_16x16x32_bf16 v[136:139], a[88:91], v[188:191], v[136:139]
  s_add_u32 m0, s46, 57216
  v_mul_f32 v135, s42, v135
  v_cvt_pk_bf16_f32 v182, v132, v133
  v_mfma_f32_16x16x32_bf16 v[140:143], a[76:79], v[208:211], 0
  buffer_load_dwordx4 v58, s[12:15], s5 offen offset:128 lds
  v_mfma_f32_16x16x32_bf16 v[140:143], a[88:91], v[212:215], v[140:143]
  s_add_u32 m0, s46, 65280
  v_cvt_pk_bf16_f32 v183, v134, v135
  v_mul_f32 v124, s42, v124
  v_mfma_f32_16x16x32_bf16 v[160:163], a[76:79], v[232:235], 0
  buffer_load_dwordx4 v58, s[12:15], s5 offen offset:256 lds
  v_mfma_f32_16x16x32_bf16 v[160:163], a[88:91], v[236:239], v[160:163]
  s_add_u32 s5, s44, 37632
  s_add_u32 m0, s46, 53248
  v_mul_f32 v125, s42, v125
  v_mfma_f32_16x16x32_bf16 v[96:99], a[76:79], a[216:219], 0
  v_mul_f32 v126, s42, v126
  v_mul_f32 v127, s42, v127
  v_mfma_f32_16x16x32_bf16 v[96:99], a[88:91], a[220:223], v[96:99]
  s_waitcnt vmcnt(9)
  s_barrier
  v_mfma_f32_16x16x32_bf16 v[152:155], a[80:83], v[184:187], 0
  buffer_load_dwordx4 v58, s[12:15], s5 offen offset:0 lds
  v_mfma_f32_16x16x32_bf16 v[152:155], a[92:95], v[188:191], v[152:155]
  s_add_u32 m0, s46, 61312
  ds_read_b64_tr_b16 a[96:97], v57 offset:24576
  ds_read_b64_tr_b16 a[98:99], v57 offset:25088
  v_mfma_f32_16x16x32_bf16 v[176:179], a[80:83], v[208:211], 0
  buffer_load_dwordx4 v58, s[12:15], s5 offen offset:128 lds
  v_mfma_f32_16x16x32_bf16 v[176:179], a[92:95], v[212:215], v[176:179]
  s_add_u32 m0, s46, 69376
  ds_read_b64_tr_b16 a[108:109], v57 offset:28672
  ds_read_b64_tr_b16 a[110:111], v57 offset:29184
  v_mfma_f32_16x16x32_bf16 v[128:131], a[80:83], v[232:235], 0
  buffer_load_dwordx4 v58, s[12:15], s5 offen offset:256 lds
  v_mfma_f32_16x16x32_bf16 v[128:131], a[92:95], v[236:239], v[128:131]
  ds_read_b64_tr_b16 a[100:101], v60 offset:24576
  ds_read_b64_tr_b16 a[102:103], v60 offset:25088
  v_mfma_f32_16x16x32_bf16 v[104:107], a[80:83], a[216:219], 0
  ds_read_b64_tr_b16 a[112:113], v60 offset:28672
  ds_read_b64_tr_b16 a[114:115], v60 offset:29184
  v_mfma_f32_16x16x32_bf16 v[104:107], a[92:95], a[220:223], v[104:107]
  s_waitcnt lgkmcnt(6)
  ds_read_b64_tr_b16 a[104:105], v59 offset:24576
  ds_read_b64_tr_b16 a[106:107], v59 offset:25088
  v_mfma_f32_16x16x32_bf16 v[116:119], a[96:99], v[192:195], v[116:119]
  s_waitcnt lgkmcnt(6)
  ds_read_b64_tr_b16 a[116:117], v59 offset:28672
  ds_read_b64_tr_b16 a[118:119], v59 offset:29184
  v_mfma_f32_16x16x32_bf16 v[116:119], a[108:111], v[196:199], v[116:119]
  v_cvt_pk_bf16_f32 v16, v124, v125
  v_cvt_pk_bf16_f32 v17, v126, v127
  v_mfma_f32_16x16x32_bf16 v[156:159], a[96:99], v[216:219], v[156:159]
  v_mul_f32 v120, s42, v120
  v_mul_f32 v121, s42, v121
  v_mfma_f32_16x16x32_bf16 v[156:159], a[108:111], v[220:223], v[156:159]
  v_mul_f32 v122, s42, v122
  v_mul_f32 v123, s42, v123
  v_mfma_f32_16x16x32_bf16 v[166:169], a[96:99], v[240:243], v[166:169]
  v_cvt_pk_bf16_f32 v18, v120, v121
  v_cvt_pk_bf16_f32 v19, v122, v123
  v_mfma_f32_16x16x32_bf16 v[166:169], a[108:111], v[244:247], v[166:169]
  s_add_u32 s5, s44, 74496
  s_add_u32 m0, s46, 73728
  v_mul_f32 v148, s42, v148
  v_mfma_f32_16x16x32_bf16 v[172:175], a[96:99], a[224:227], v[172:175]
  v_mul_f32 v149, s42, v149
  v_mul_f32 v150, s42, v150
  v_mfma_f32_16x16x32_bf16 v[172:175], a[108:111], a[228:231], v[172:175]
  s_waitcnt lgkmcnt(0)
  v_mul_f32 v151, s42, v151
  v_cvt_pk_bf16_f32 v124, v148, v149
  v_mfma_f32_16x16x32_bf16 v[136:139], a[100:103], v[192:195], v[136:139]
  buffer_load_dwordx4 v58, s[12:15], s5 offen offset:0 lds
  v_mfma_f32_16x16x32_bf16 v[136:139], a[112:115], v[196:199], v[136:139]
  s_add_u32 m0, s46, 81792
  v_cvt_pk_bf16_f32 v125, v150, v151
  v_mul_f32 v100, s42, v100
  v_mfma_f32_16x16x32_bf16 v[140:143], a[100:103], v[216:219], v[140:143]
  buffer_load_dwordx4 v58, s[12:15], s5 offen offset:128 lds
  v_mfma_f32_16x16x32_bf16 v[140:143], a[112:115], v[220:223], v[140:143]
  s_add_u32 m0, s46, 89856
  v_mul_f32 v101, s42, v101
  v_mul_f32 v102, s42, v102
  v_mfma_f32_16x16x32_bf16 v[160:163], a[100:103], v[240:243], v[160:163]
  buffer_load_dwordx4 v58, s[12:15], s5 offen offset:256 lds
  v_mfma_f32_16x16x32_bf16 v[160:163], a[112:115], v[244:247], v[160:163]
  s_add_u32 s5, s44, 111360
  s_add_u32 m0, s46, 77824
  v_mul_f32 v103, s42, v103
  v_mfma_f32_16x16x32_bf16 v[96:99], a[100:103], a[224:227], v[96:99]
  v_add_f32 v120, v70, v36
  v_add_f32 v121, v70, v37
  v_mfma_f32_16x16x32_bf16 v[96:99], a[112:115], a[228:231], v[96:99]
  s_waitcnt vmcnt(9)
  s_barrier
  v_mfma_f32_16x16x32_bf16 v[152:155], a[104:107], v[192:195], v[152:155]
  buffer_load_dwordx4 v58, s[12:15], s5 offen offset:0 lds
  v_mfma_f32_16x16x32_bf16 v[152:155], a[116:119], v[196:199], v[152:155]
  s_add_u32 m0, s46, 85888
  ds_read_b64_tr_b16 a[120:121], v61 offset:0
  ds_read_b64_tr_b16 a[122:123], v61 offset:512
  v_mfma_f32_16x16x32_bf16 v[176:179], a[104:107], v[216:219], v[176:179]
  buffer_load_dwordx4 v58, s[12:15], s5 offen offset:128 lds
  v_mfma_f32_16x16x32_bf16 v[176:179], a[116:119], v[220:223], v[176:179]
  s_add_u32 m0, s46, 93952
  ds_read_b64_tr_b16 a[132:133], v61 offset:4096
  ds_read_b64_tr_b16 a[134:135], v61 offset:4608
  v_mfma_f32_16x16x32_bf16 v[128:131], a[104:107], v[240:243], v[128:131]
  buffer_load_dwordx4 v58, s[12:15], s5 offen offset:256 lds
  v_mfma_f32_16x16x32_bf16 v[128:131], a[116:119], v[244:247], v[128:131]
  ds_read_b64_tr_b16 a[124:125], v62 offset:0
  ds_read_b64_tr_b16 a[126:127], v62 offset:512
  v_mfma_f32_16x16x32_bf16 v[104:107], a[104:107], a[224:227], v[104:107]
  ds_read_b64_tr_b16 a[136:137], v62 offset:4096
  ds_read_b64_tr_b16 a[138:139], v62 offset:4608
  v_mfma_f32_16x16x32_bf16 v[104:107], a[116:119], a[228:231], v[104:107]
  s_waitcnt lgkmcnt(6)
  ds_read_b64_tr_b16 a[128:129], v63 offset:0
  ds_read_b64_tr_b16 a[130:131], v63 offset:512
  v_mfma_f32_16x16x32_bf16 v[116:119], a[120:123], v[200:203], v[116:119]
  s_waitcnt lgkmcnt(6)
  ds_read_b64_tr_b16 a[140:141], v63 offset:4096
  ds_read_b64_tr_b16 a[142:143], v63 offset:4608
  v_mfma_f32_16x16x32_bf16 v[116:119], a[132:135], v[204:207], v[116:119]
  v_add_f32 v122, v70, v38
  v_add_f32 v123, v70, v39
  v_mfma_f32_16x16x32_bf16 v[156:159], a[120:123], v[224:227], v[156:159]
  v_add_f32 v148, v70, v32
  v_add_f32 v149, v70, v33
  v_mfma_f32_16x16x32_bf16 v[156:159], a[132:135], v[228:231], v[156:159]
  v_add_f32 v150, v70, v34
  v_add_f32 v151, v70, v35
  v_mfma_f32_16x16x32_bf16 v[166:169], a[120:123], v[248:251], v[166:169]
  v_cvt_pk_bf16_f32 v132, v116, v117
  v_cvt_pk_bf16_f32 v133, v118, v119
  v_mfma_f32_16x16x32_bf16 v[166:169], a[132:135], v[252:255], v[166:169]
  s_add_u32 s5, s44, 148224
  s_add_u32 m0, s46, 98304
  v_add_f32 v116, v70, v40
  v_mfma_f32_16x16x32_bf16 v[172:175], a[120:123], a[232:235], v[172:175]
  v_cvt_pk_bf16_f32 v170, v156, v157
  v_cvt_pk_bf16_f32 v171, v158, v159
  v_mfma_f32_16x16x32_bf16 v[172:175], a[132:135], a[236:239], v[172:175]
  s_waitcnt lgkmcnt(0)
  v_add_f32 v117, v70, v41
  v_add_f32 v118, v70, v42
  v_mfma_f32_16x16x32_bf16 v[136:139], a[124:127], v[200:203], v[136:139]
  buffer_load_dwordx4 v58, s[12:15], s5 offen offset:0 lds
  v_mfma_f32_16x16x32_bf16 v[136:139], a[136:139], v[204:207], v[136:139]
  s_add_u32 m0, s46, 106368
  v_cvt_pk_bf16_f32 v164, v166, v167
  v_cvt_pk_bf16_f32 v165, v168, v169
  v_mfma_f32_16x16x32_bf16 v[140:143], a[124:127], v[224:227], v[140:143]
  buffer_load_dwordx4 v58, s[12:15], s5 offen offset:128 lds
  v_mfma_f32_16x16x32_bf16 v[140:143], a[136:139], v[228:231], v[140:143]
  s_add_u32 m0, s46, 114432
  v_cvt_pk_bf16_f32 v158, v172, v173
  v_cvt_pk_bf16_f32 v159, v174, v175
  v_mfma_f32_16x16x32_bf16 v[160:163], a[124:127], v[248:251], v[160:163]
  buffer_load_dwordx4 v58, s[12:15], s5 offen offset:256 lds
  v_mfma_f32_16x16x32_bf16 v[160:163], a[136:139], v[252:255], v[160:163]
  s_add_u32 s5, s44, 185088
  s_add_u32 m0, s46, 102400
  v_cvt_pk_bf16_f32 v134, v136, v137
  v_mfma_f32_16x16x32_bf16 v[96:99], a[124:127], a[232:235], v[96:99]
  v_cvt_pk_bf16_f32 v135, v138, v139
  v_cvt_pk_bf16_f32 v172, v140, v141
  v_mfma_f32_16x16x32_bf16 v[96:99], a[136:139], a[236:239], v[96:99]
  v_cvt_pk_bf16_f32 v173, v142, v143
  v_add_f32 v119, v70, v43
  v_mfma_f32_16x16x32_bf16 v[152:155], a[128:131], v[200:203], v[152:155]
  buffer_load_dwordx4 v58, s[12:15], s5 offen offset:0 lds
  v_mfma_f32_16x16x32_bf16 v[152:155], a[140:143], v[204:207], v[152:155]
  s_add_u32 m0, s46, 110464
  v_cvt_pk_bf16_f32 v166, v160, v161
  v_cvt_pk_bf16_f32 v167, v162, v163
  v_mfma_f32_16x16x32_bf16 v[176:179], a[128:131], v[224:227], v[176:179]
  buffer_load_dwordx4 v58, s[12:15], s5 offen offset:128 lds
  v_mfma_f32_16x16x32_bf16 v[176:179], a[140:143], v[228:231], v[176:179]
L_hop_0_0:
  s_cbranch_execz L_hop_0_1
  s_add_u32 m0, s46, 118528
  v_cvt_pk_bf16_f32 v160, v96, v97
  v_cvt_pk_bf16_f32 v161, v98, v99
  v_mfma_f32_16x16x32_bf16 v[128:131], a[128:131], v[248:251], v[128:131]
  buffer_load_dwordx4 v58, s[12:15], s5 offen offset:256 lds
  v_mfma_f32_16x16x32_bf16 v[128:131], a[140:143], v[252:255], v[128:131]
  v_cvt_pk_bf16_f32 v136, v152, v153
  v_cvt_pk_bf16_f32 v137, v154, v155
  v_mfma_f32_16x16x32_bf16 v[104:107], a[128:131], a[232:235], v[104:107]
  v_cvt_pk_bf16_f32 v174, v176, v177
  v_cvt_pk_bf16_f32 v175, v178, v179
  v_mfma_f32_16x16x32_bf16 v[104:107], a[140:143], a[236:239], v[104:107]
  v_cvt_pk_bf16_f32 v126, v100, v101
  v_cvt_pk_bf16_f32 v127, v102, v103
  v_mfma_f32_16x16x32_bf16 v[96:99], v[134:137], v[144:147], v[120:123]
  v_cvt_pk_bf16_f32 v168, v128, v129
  v_cvt_pk_bf16_f32 v169, v130, v131
  v_mfma_f32_16x16x32_bf16 v[96:99], v[132:135], v[12:15], v[96:99]
  v_mul_f32 v92, s42, v92
  v_mul_f32 v93, s42, v93
  v_mfma_f32_16x16x32_bf16 v[100:103], v[172:175], v[144:147], v[148:151]
  v_cvt_pk_bf16_f32 v162, v104, v105
  v_cvt_pk_bf16_f32 v163, v106, v107
  v_mfma_f32_16x16x32_bf16 v[100:103], v[170:173], v[12:15], v[100:103]
  v_mul_f32 v94, s42, v94
  v_mul_f32 v95, s42, v95
  v_mfma_f32_16x16x32_bf16 v[176:179], v[166:169], v[144:147], v[80:83]
  v_cvt_pk_bf16_f32 v128, v92, v93
  v_cvt_pk_bf16_f32 v129, v94, v95
  v_mfma_f32_16x16x32_bf16 v[176:179], v[164:167], v[12:15], v[176:179]
  v_mul_f32 v108, s42, v108
  v_mul_f32 v109, s42, v109
  v_mfma_f32_16x16x32_bf16 v[152:155], v[160:163], v[144:147], v[88:91]
  v_mul_f32 v110, s42, v110
  v_mul_f32 v111, s42, v111
  v_mfma_f32_16x16x32_bf16 v[152:155], v[158:161], v[12:15], v[152:155]
  v_cvt_pk_bf16_f32 v130, v108, v109
  v_cvt_pk_bf16_f32 v131, v110, v111
  v_mfma_f32_16x16x32_bf16 v[104:107], v[132:135], v[180:183], v[116:119]
  v_mul_f32 v112, s42, v112
  v_mul_f32 v113, s42, v113
  v_mfma_f32_16x16x32_bf16 v[104:107], v[134:137], v[14:17], v[104:107]
  v_mul_f32 v114, s42, v114
  v_mul_f32 v115, s42, v115
  v_mfma_f32_16x16x32_bf16 v[108:111], v[170:173], v[180:183], v[120:123]
  v_cvt_pk_bf16_f32 v22, v112, v113
  v_cvt_pk_bf16_f32 v23, v114, v115
  v_mfma_f32_16x16x32_bf16 v[108:111], v[172:175], v[14:17], v[108:111]
  v_exp_f32 v96, v96
  v_mfma_f32_16x16x32_bf16 v[140:143], v[164:167], v[180:183], v[84:87]
  s_add_u32 m0, s28, 0
  v_exp_f32 v97, v97
  v_mfma_f32_16x16x32_bf16 v[140:143], v[166:169], v[14:17], v[140:143]
  v_exp_f32 v98, v98
  v_mfma_f32_16x16x32_bf16 v[144:147], v[158:161], v[180:183], v[80:83]
  s_waitcnt vmcnt(6)
  s_barrier
  v_mfma_f32_16x16x32_bf16 v[144:147], v[160:163], v[14:17], v[144:147]
  buffer_load_dwordx4 v6, s[8:11], s31 offen offset:0 nt lds
  v_mfma_f32_16x16x32_bf16 v[80:83], v[166:169], v[124:127], v[120:123]
  s_add_u32 m0, s28, 8064
  ds_read_b64_tr_b16 a[144:145], v61 offset:24576
  ds_read_b64_tr_b16 a[146:147], v61 offset:25088
  v_mfma_f32_16x16x32_bf16 v[80:83], v[164:167], v[18:21], v[80:83]
  ds_read_b64_tr_b16 a[156:157], v61 offset:28672
  ds_read_b64_tr_b16 a[158:159], v61 offset:29184
  v_mfma_f32_16x16x32_bf16 v[84:87], v[160:163], v[124:127], v[148:151]
  buffer_load_dwordx4 v6, s[8:11], s31 offen offset:128 nt lds
  v_mfma_f32_16x16x32_bf16 v[84:87], v[158:161], v[18:21], v[84:87]
  s_add_u32 m0, s28, 16128
  ds_read_b64_tr_b16 a[148:149], v62 offset:24576
  ds_read_b64_tr_b16 a[150:151], v62 offset:25088
  v_mfma_f32_16x16x32_bf16 v[112:115], v[134:137], v[124:127], v[64:67]
  ds_read_b64_tr_b16 a[160:161], v62 offset:28672
  ds_read_b64_tr_b16 a[162:163], v62 offset:29184
  v_mfma_f32_16x16x32_bf16 v[112:115], v[132:135], v[18:21], v[112:115]
  buffer_load_dwordx4 v6, s[8:11], s31 offen offset:256 nt lds
  v_mfma_f32_16x16x32_bf16 v[180:183], v[172:175], v[124:127], v[76:79]
  s_add_u32 s31, s31, s43
  ds_read_b64_tr_b16 a[152:153], v63 offset:24576
  ds_read_b64_tr_b16 a[154:155], v63 offset:25088
  v_mfma_f32_16x16x32_bf16 v[180:183], v[170:173], v[18:21], v[180:183]
  ds_read_b64_tr_b16 a[164:165], v63 offset:28672
  ds_read_b64_tr_b16 a[166:167], v63 offset:29184
  v_mfma_f32_16x16x32_bf16 v[88:91], v[164:167], v[128:131], v[116:119]
  ds_read_b64_tr_b16 a[168:169], v61 offset:49152
  ds_read_b64_tr_b16 a[170:171], v61 offset:49664
  v_mfma_f32_16x16x32_bf16 v[88:91], v[166:169], v[20:23], v[88:91]
  ds_read_b64_tr_b16 a[180:181], v61 offset:53248
  ds_read_b64_tr_b16 a[182:183], v61 offset:53760
  v_mfma_f32_16x16x32_bf16 v[92:95], v[158:161], v[128:131], v[120:123]
  ds_read_b64_tr_b16 a[172:173], v62 offset:49152
  ds_read_b64_tr_b16 a[174:175], v62 offset:49664
  v_mfma_f32_16x16x32_bf16 v[92:95], v[160:163], v[20:23], v[92:95]
  ds_read_b64_tr_b16 a[184:185], v62 offset:53248
  ds_read_b64_tr_b16 a[186:187], v62 offset:53760
  v_mfma_f32_16x16x32_bf16 v[148:151], v[132:135], v[128:131], v[72:75]
  ds_read_b64_tr_b16 a[176:177], v63 offset:49152
  ds_read_b64_tr_b16 a[178:179], v63 offset:49664
  v_mfma_f32_16x16x32_bf16 v[148:151], v[134:137], v[20:23], v[148:151]
  ds_read_b64_tr_b16 a[188:189], v63 offset:53248
  ds_read_b64_tr_b16 a[190:191], v63 offset:53760
  v_mfma_f32_16x16x32_bf16 v[164:167], v[170:173], v[128:131], v[64:67]
  v_exp_f32 v99, v99
  v_mfma_f32_16x16x32_bf16 v[164:167], v[172:175], v[20:23], v[164:167]
  s_waitcnt lgkmcnt(6)
  v_exp_f32 v100, v100
  v_mfma_f32_16x16x32_bf16 v[72:75], v[184:187], a[144:147], 0
  v_exp_f32 v101, v101
  v_mfma_f32_16x16x32_bf16 v[72:75], v[188:191], a[156:159], v[72:75]
  v_exp_f32 v102, v102
  v_mfma_f32_16x16x32_bf16 v[120:123], v[184:187], a[148:151], 0
  v_exp_f32 v103, v103
  v_mfma_f32_16x16x32_bf16 v[120:123], v[188:191], a[160:163], v[120:123]
  v_exp_f32 v176, v176
  v_mfma_f32_16x16x32_bf16 v[128:131], v[184:187], a[152:155], 0
  v_exp_f32 v177, v177
  v_mfma_f32_16x16x32_bf16 v[128:131], v[188:191], a[164:167], v[128:131]
  v_exp_f32 v178, v178
  v_mfma_f32_16x16x32_bf16 v[132:135], v[208:211], a[144:147], 0
  v_exp_f32 v179, v179
  v_mfma_f32_16x16x32_bf16 v[132:135], v[212:215], a[156:159], v[132:135]
  v_exp_f32 v152, v152
  v_mfma_f32_16x16x32_bf16 v[124:127], v[208:211], a[148:151], 0
  v_exp_f32 v153, v153
  v_mfma_f32_16x16x32_bf16 v[124:127], v[212:215], a[160:163], v[124:127]
  v_exp_f32 v154, v154
  v_mfma_f32_16x16x32_bf16 v[64:67], v[208:211], a[152:155], 0
  v_exp_f32 v155, v155
  v_mfma_f32_16x16x32_bf16 v[64:67], v[212:215], a[164:167], v[64:67]
  v_cvt_pk_bf16_f32 v96, v96, v97
  v_cvt_pk_bf16_f32 v97, v98, v99
  v_mfma_f32_16x16x32_bf16 v[72:75], v[192:195], a[168:171], v[72:75]
  v_cvt_pk_bf16_f32 v98, v100, v101
  v_cvt_pk_bf16_f32 v99, v102, v103
  v_mfma_f32_16x16x32_bf16 v[72:75], v[196:199], a[180:183], v[72:75]
  v_cvt_pk_bf16_f32 v100, v176, v177
  v_cvt_pk_bf16_f32 v101, v178, v179
  v_mfma_f32_16x16x32_bf16 v[120:123], v[192:195], a[172:175], v[120:123]
  s_waitcnt lgkmcnt(0)
  v_cvt_pk_bf16_f32 v102, v152, v153
  v_cvt_pk_bf16_f32 v103, v154, v155
  v_mfma_f32_16x16x32_bf16 v[120:123], v[196:199], a[184:187], v[120:123]
  s_waitcnt vmcnt(3)
  s_barrier
  v_mfma_f32_16x16x32_bf16 v[128:131], v[192:195], a[176:179], v[128:131]
  ds_read_b64_tr_b16 a[192:193], v57 offset:0
  ds_read_b64_tr_b16 a[194:195], v57 offset:512
  v_mfma_f32_16x16x32_bf16 v[128:131], v[196:199], a[188:191], v[128:131]
  ds_read_b64_tr_b16 a[204:205], v57 offset:4096
  ds_read_b64_tr_b16 a[206:207], v57 offset:4608
  v_mfma_f32_16x16x32_bf16 v[132:135], v[216:219], a[168:171], v[132:135]
  ds_read_b64_tr_b16 a[196:197], v60 offset:0
  ds_read_b64_tr_b16 a[198:199], v60 offset:512
  v_mfma_f32_16x16x32_bf16 v[132:135], v[220:223], a[180:183], v[132:135]
  ds_read_b64_tr_b16 a[208:209], v60 offset:4096
  ds_read_b64_tr_b16 a[210:211], v60 offset:4608
  v_mfma_f32_16x16x32_bf16 v[124:127], v[216:219], a[172:175], v[124:127]
  s_add_u32 s5, s45, 0
  s_add_u32 m0, s46, 122880
  ds_read_b64_tr_b16 a[200:201], v59 offset:0
  v_mfma_f32_16x16x32_bf16 v[124:127], v[220:223], a[184:187], v[124:127]
  ds_read_b64_tr_b16 a[202:203], v59 offset:512
  ds_read_b64_tr_b16 a[212:213], v59 offset:4096
  v_mfma_f32_16x16x32_bf16 v[64:67], v[216:219], a[176:179], v[64:67]
  s_waitcnt lgkmcnt(5)
  ds_read_b64_tr_b16 a[214:215], v59 offset:4608
  v_add_u32 v0, s28, v2
  v_mfma_f32_16x16x32_bf16 v[64:67], v[220:223], a[188:191], v[64:67]
  buffer_load_dwordx4 v71, s[16:19], s5 offen offset:0 lds
  v_mfma_f32_16x16x32_bf16 v[72:75], v[200:203], a[192:195], v[72:75]
  s_add_u32 m0, s46, 130944
  v_exp_f32 v104, v104
  v_mfma_f32_16x16x32_bf16 v[72:75], v[204:207], a[204:207], v[72:75]
  s_waitcnt lgkmcnt(1)
  v_exp_f32 v105, v105
  v_mfma_f32_16x16x32_bf16 v[120:123], v[200:203], a[196:199], v[120:123]
  buffer_load_dwordx4 v71, s[16:19], s5 offen offset:128 lds
  v_mfma_f32_16x16x32_bf16 v[120:123], v[204:207], a[208:211], v[120:123]
  s_add_u32 m0, s46, 139008
  v_exp_f32 v106, v106
  v_mfma_f32_16x16x32_bf16 v[128:131], v[200:203], a[200:203], v[128:131]
  s_waitcnt lgkmcnt(0)
  v_cvt_pk_bf16_f32 v56, v72, v73
  v_cvt_pk_bf16_f32 v57, v74, v75
  v_mfma_f32_16x16x32_bf16 v[128:131], v[204:207], a[212:215], v[128:131]
  buffer_load_dwordx4 v71, s[16:19], s5 offen offset:256 lds
  v_mfma_f32_16x16x32_bf16 v[132:135], v[224:227], a[192:195], v[132:135]
  s_add_u32 s5, s45, 12288
  v_cvt_pk_bf16_f32 v116, v120, v121
  v_cvt_pk_bf16_f32 v117, v122, v123
  v_mfma_f32_16x16x32_bf16 v[132:135], v[228:231], a[204:207], v[132:135]
  s_add_u32 m0, s46, 126976
  v_exp_f32 v107, v107
  v_mfma_f32_16x16x32_bf16 v[124:127], v[224:227], a[196:199], v[124:127]
  buffer_load_dwordx4 v71, s[16:19], s5 offen offset:0 lds
  v_mfma_f32_16x16x32_bf16 v[124:127], v[228:231], a[208:211], v[124:127]
  s_add_u32 m0, s46, 135040
  v_cvt_pk_bf16_f32 v72, v128, v129
  v_cvt_pk_bf16_f32 v73, v130, v131
  v_mfma_f32_16x16x32_bf16 v[64:67], v[224:227], a[200:203], v[64:67]
  v_cvt_pk_bf16_f32 v58, v132, v133
  v_cvt_pk_bf16_f32 v59, v134, v135
  v_mfma_f32_16x16x32_bf16 v[64:67], v[228:231], a[212:215], v[64:67]
  buffer_load_dwordx4 v71, s[16:19], s5 offen offset:128 lds
  v_mfma_f32_16x16x32_bf16 v[60:63], v[232:235], a[144:147], 0
  s_add_u32 m0, s46, 143104
  v_cvt_pk_bf16_f32 v118, v124, v125
  v_cvt_pk_bf16_f32 v119, v126, v127
  v_mfma_f32_16x16x32_bf16 v[60:63], v[236:239], a[156:159], v[60:63]
  v_exp_f32 v108, v108
  v_mfma_f32_16x16x32_bf16 v[60:63], v[240:243], a[168:171], v[60:63]
  buffer_load_dwordx4 v71, s[16:19], s5 offen offset:256 lds
  v_mfma_f32_16x16x32_bf16 v[60:63], v[244:247], a[180:183], v[60:63]
  v_cvt_pk_bf16_f32 v74, v64, v65
  v_cvt_pk_bf16_f32 v75, v66, v67
  v_mfma_f32_16x16x32_bf16 v[60:63], v[248:251], a[192:195], v[60:63]
  v_exp_f32 v109, v109
  v_mfma_f32_16x16x32_bf16 v[60:63], v[252:255], a[204:207], v[60:63]
  v_exp_f32 v110, v110
  v_mfma_f32_16x16x32_bf16 v[64:67], v[232:235], a[148:151], 0
  v_exp_f32 v111, v111
  v_mfma_f32_16x16x32_bf16 v[64:67], v[236:239], a[160:163], v[64:67]
  v_exp_f32 v140, v140
  v_mfma_f32_16x16x32_bf16 v[64:67], v[240:243], a[172:175], v[64:67]
  v_cvt_pk_bf16_f32 v120, v60, v61
  v_cvt_pk_bf16_f32 v121, v62, v63
  v_mfma_f32_16x16x32_bf16 v[64:67], v[244:247], a[184:187], v[64:67]
  v_exp_f32 v141, v141
  v_mfma_f32_16x16x32_bf16 v[64:67], v[248:251], a[196:199], v[64:67]
  v_exp_f32 v142, v142
  v_mfma_f32_16x16x32_bf16 v[64:67], v[252:255], a[208:211], v[64:67]
  v_exp_f32 v143, v143
  v_mfma_f32_16x16x32_bf16 v[60:63], v[232:235], a[152:155], 0
  v_exp_f32 v144, v144
  v_mfma_f32_16x16x32_bf16 v[60:63], v[236:239], a[164:167], v[60:63]
  v_exp_f32 v145, v145
  v_mfma_f32_16x16x32_bf16 v[60:63], v[240:243], a[176:179], v[60:63]
  v_cvt_pk_bf16_f32 v76, v64, v65
  v_cvt_pk_bf16_f32 v77, v66, v67
  v_cvt_pk_bf16_f32 v104, v104, v105
  v_mfma_f32_16x16x32_bf16 v[60:63], v[244:247], a[188:191], v[60:63]
  v_exp_f32 v146, v146
  v_cvt_pk_bf16_f32 v105, v106, v107
  v_mfma_f32_16x16x32_bf16 v[60:63], v[248:251], a[200:203], v[60:63]
  v_exp_f32 v147, v147
  v_cvt_pk_bf16_f32 v106, v108, v109
  v_mfma_f32_16x16x32_bf16 v[60:63], v[252:255], a[212:215], v[60:63]
  v_cvt_pk_bf16_f32 v107, v110, v111
  v_cvt_pk_bf16_f32 v108, v140, v141
  v_cvt_pk_bf16_f32 v109, v142, v143
  v_mfma_f32_16x16x32_bf16 v[64:67], a[216:219], a[144:147], 0
  v_cvt_pk_bf16_f32 v110, v144, v145
  v_cvt_pk_bf16_f32 v111, v146, v147
  v_xor_b32 v1, 64, v0
  v_mfma_f32_16x16x32_bf16 v[64:67], a[220:223], a[156:159], v[64:67]
  s_add_u32 s5, s45, 24576
  s_add_u32 m0, s46, 0
  v_exp_f32 v80, v80
  v_mfma_f32_16x16x32_bf16 v[64:67], a[224:227], a[168:171], v[64:67]
  v_cvt_pk_bf16_f32 v160, v60, v61
  v_cvt_pk_bf16_f32 v161, v62, v63
  v_mfma_f32_16x16x32_bf16 v[64:67], a[228:231], a[180:183], v[64:67]
  v_exp_f32 v81, v81
  v_mfma_f32_16x16x32_bf16 v[64:67], a[232:235], a[192:195], v[64:67]
  buffer_load_dwordx4 v71, s[16:19], s5 offen offset:0 lds
  v_cvt_pk_bf16_f32 v80, v80, v81
  v_mfma_f32_16x16x32_bf16 v[64:67], a[236:239], a[204:207], v[64:67]
  s_add_u32 m0, s46, 8064
  v_exp_f32 v82, v82
  v_mfma_f32_16x16x32_bf16 v[124:127], a[216:219], a[148:151], 0
  v_exp_f32 v83, v83
  v_mfma_f32_16x16x32_bf16 v[124:127], a[220:223], a[160:163], v[124:127]
  buffer_load_dwordx4 v71, s[16:19], s5 offen offset:128 lds
  v_cvt_pk_bf16_f32 v81, v82, v83
  v_mfma_f32_16x16x32_bf16 v[124:127], a[224:227], a[172:175], v[124:127]
  s_add_u32 m0, s46, 16128
  v_cvt_pk_bf16_f32 v122, v64, v65
  v_cvt_pk_bf16_f32 v123, v66, v67
  v_mfma_f32_16x16x32_bf16 v[124:127], a[228:231], a[184:187], v[124:127]
  v_exp_f32 v84, v84
  v_mfma_f32_16x16x32_bf16 v[124:127], a[232:235], a[196:199], v[124:127]
  buffer_load_dwordx4 v71, s[16:19], s5 offen offset:256 lds
  v_mov_b64 v[168:169], 0
  v_mfma_f32_16x16x32_bf16 v[124:127], a[236:239], a[208:211], v[124:127]
  s_add_u32 s5, s45, 36864
  s_add_u32 m0, s46, 4096
  v_exp_f32 v85, v85
  v_mfma_f32_16x16x32_bf16 v[64:67], a[216:219], a[152:155], 0
  v_exp_f32 v86, v86
  v_cvt_pk_bf16_f32 v82, v84, v85
  v_mfma_f32_16x16x32_bf16 v[64:67], a[220:223], a[164:167], v[64:67]
  buffer_load_dwordx4 v71, s[16:19], s5 offen offset:0 lds
  v_mfma_f32_16x16x32_bf16 v[64:67], a[224:227], a[176:179], v[64:67]
  s_add_u32 m0, s46, 12160
  v_cvt_pk_bf16_f32 v78, v124, v125
  v_cvt_pk_bf16_f32 v79, v126, v127
  v_mfma_f32_16x16x32_bf16 v[64:67], a[228:231], a[188:191], v[64:67]
  v_exp_f32 v87, v87
  v_mfma_f32_16x16x32_bf16 v[64:67], a[232:235], a[200:203], v[64:67]
  buffer_load_dwordx4 v71, s[16:19], s5 offen offset:128 lds
  v_cvt_pk_bf16_f32 v83, v86, v87
  v_mfma_f32_16x16x32_bf16 v[64:67], a[236:239], a[212:215], v[64:67]
  s_add_u32 m0, s46, 20224
  v_mov_b64 v[132:133], 0
  v_exp_f32 v112, v112
  v_smfmac_f32_16x16x64_bf16 v[168:171], a[240:243], v[96:103], v10
  v_exp_f32 v113, v113
  v_mfma_f32_16x16x32_bf16 v[176:179], v[120:123], v[100:103], 0
  buffer_load_dwordx4 v71, s[16:19], s5 offen offset:256 lds
  v_cvt_pk_bf16_f32 v84, v112, v113
  v_mfma_f32_16x16x32_bf16 v[176:179], v[56:59], v[96:99], v[176:179]
  v_cvt_pk_bf16_f32 v162, v64, v65
  v_cvt_pk_bf16_f32 v163, v66, v67
  v_mfma_f32_16x16x32_bf16 v[172:175], v[116:119], v[96:99], 0
  v_exp_f32 v114, v114
  v_mfma_f32_16x16x32_bf16 v[172:175], v[76:79], v[100:103], v[172:175]
  v_exp_f32 v115, v115
  v_mfma_f32_16x16x32_bf16 v[124:127], v[160:163], v[100:103], 0
  v_exp_f32 v180, v180
  v_cvt_pk_bf16_f32 v85, v114, v115
  v_mfma_f32_16x16x32_bf16 v[124:127], v[72:75], v[96:99], v[124:127]
  v_exp_f32 v181, v181
  v_mov_b64 v[112:113], 0
  v_smfmac_f32_16x16x64_bf16 v[132:135], a[240:243], v[104:111], v10
  v_exp_f32 v182, v182
  v_cvt_pk_bf16_f32 v86, v180, v181
  v_mfma_f32_16x16x32_bf16 v[152:155], v[120:123], v[108:111], 0
  v_exp_f32 v183, v183
  v_add_f32 v168, v168, v169
  v_mfma_f32_16x16x32_bf16 v[152:155], v[56:59], v[104:107], v[152:155]
  v_cvt_pk_bf16_f32 v87, v182, v183
  v_exp_f32 v88, v88
  v_mfma_f32_16x16x32_bf16 v[140:143], v[116:119], v[104:107], 0
  v_exp_f32 v89, v89
  v_mfma_f32_16x16x32_bf16 v[140:143], v[76:79], v[108:111], v[140:143]
  v_exp_f32 v90, v90
  v_cvt_pk_bf16_f32 v88, v88, v89
  v_mfma_f32_16x16x32_bf16 v[180:183], v[160:163], v[108:111], 0
  v_exp_f32 v91, v91
  v_add_f32 v132, v132, v133
  v_mfma_f32_16x16x32_bf16 v[180:183], v[72:75], v[104:107], v[180:183]
  v_exp_f32 v92, v92
  v_cvt_pk_bf16_f32 v89, v90, v91
  v_smfmac_f32_16x16x64_bf16 v[112:115], a[240:243], v[80:87], v10
  v_exp_f32 v93, v93
  v_exp_f32 v94, v94
  v_exp_f32 v95, v95
  v_exp_f32 v148, v148
  v_exp_f32 v149, v149
  v_exp_f32 v150, v150
  v_exp_f32 v151, v151
  v_exp_f32 v164, v164
  v_exp_f32 v165, v165
  v_exp_f32 v166, v166
  v_exp_f32 v167, v167
  v_mfma_f32_16x16x32_bf16 v[136:139], v[56:59], v[84:87], 0
  s_add_u32 s5, s45, 49152
  v_cvt_pk_bf16_f32 v90, v92, v93
  v_cvt_pk_bf16_f32 v91, v94, v95
  v_cvt_pk_bf16_f32 v92, v148, v149
  v_cvt_pk_bf16_f32 v93, v150, v151
  v_cvt_pk_bf16_f32 v94, v164, v165
  v_cvt_pk_bf16_f32 v95, v166, v167
  v_mfma_f32_16x16x32_bf16 v[136:139], v[120:123], v[80:83], v[136:139]
  s_waitcnt vmcnt(6) lgkmcnt(0)
  s_barrier
  v_mfma_f32_16x16x32_bf16 v[156:159], v[76:79], v[80:83], 0
  s_add_u32 m0, s46, 98304
  ds_read_b128 v[60:63], v0 offset:0
  v_mov_b64 v[104:105], 0
  v_mfma_f32_16x16x32_bf16 v[156:159], v[116:119], v[84:87], v[156:159]
  buffer_load_dwordx4 v71, s[16:19], s5 offen offset:0 lds
  v_mfma_f32_16x16x32_bf16 v[148:151], v[72:75], v[84:87], 0
  s_add_u32 m0, s46, 106368
  ds_read_b128 a[244:247], v1 offset:0
  ds_read_b128 v[164:167], v0 offset:8192
  v_mfma_f32_16x16x32_bf16 v[148:151], v[160:163], v[80:83], v[148:151]
  ds_read_b128 v[64:67], v1 offset:8192
  ds_read_b128 v[128:131], v0 offset:16384
  v_smfmac_f32_16x16x64_bf16 v[104:107], a[240:243], v[88:95], v10
  buffer_load_dwordx4 v71, s[16:19], s5 offen offset:128 lds
  v_mfma_f32_16x16x32_bf16 v[100:103], v[56:59], v[92:95], 0
  s_add_u32 m0, s46, 114432
  ds_read_b128 v[144:147], v1 offset:16384
  ds_read2st64_b32 v[84:85], v68 offset0:0 offset1:2
  v_mfma_f32_16x16x32_bf16 v[100:103], v[120:123], v[88:91], v[100:103]
  ds_read2st64_b32 v[96:97], v69 offset0:0 offset1:2
  ds_read2st64_b32 v[86:87], v68 offset0:4 offset1:6
  v_mfma_f32_16x16x32_bf16 v[108:111], v[76:79], v[88:91], 0
  buffer_load_dwordx4 v71, s[16:19], s5 offen offset:256 lds
  v_mfma_f32_16x16x32_bf16 v[108:111], v[116:119], v[92:95], v[108:111]
  s_add_u32 s5, s45, 61440
  s_add_u32 m0, s46, 102400
  ds_read2st64_b32 v[98:99], v69 offset0:4 offset1:6
  v_mfma_f32_16x16x32_bf16 v[116:119], v[72:75], v[92:95], 0
  s_waitcnt lgkmcnt(3)
  ds_read2st64_b32 v[76:77], v54 offset0:0 offset1:2
  ds_read2st64_b32 v[80:81], v55 offset0:0 offset1:2
  v_mfma_f32_16x16x32_bf16 v[116:119], v[160:163], v[88:91], v[116:119]
  buffer_load_dwordx4 v71, s[16:19], s5 offen offset:0 lds
  v_mfma_f32_16x16x32_bf16 v[72:75], a[0:3], v[60:63], 0
  s_add_u32 m0, s46, 110464
  ds_read2st64_b32 v[78:79], v54 offset0:4 offset1:6
  ds_read2st64_b32 v[82:83], v55 offset0:4 offset1:6
  v_mfma_f32_16x16x32_bf16 v[72:75], a[12:15], a[244:247], v[72:75]
  v_rcp_f32 v170, v168
  v_mfma_f32_16x16x32_bf16 v[72:75], a[24:27], v[164:167], v[72:75]
  buffer_load_dwordx4 v71, s[16:19], s5 offen offset:128 lds
  v_mfma_f32_16x16x32_bf16 v[72:75], a[36:39], v[64:67], v[72:75]
  s_add_u32 m0, s46, 118528
  v_mul_f32 v176, v170, v176
  v_mul_f32 v177, v170, v177
  v_mfma_f32_16x16x32_bf16 v[72:75], a[48:51], v[128:131], v[72:75]
  s_waitcnt lgkmcnt(4)
  v_perm_b32 v184, v96, v84, s58
  v_perm_b32 v188, v96, v84, s59
  v_mfma_f32_16x16x32_bf16 v[72:75], a[60:63], v[144:147], v[72:75]
  buffer_load_dwordx4 v71, s[16:19], s5 offen offset:256 lds
  v_mfma_f32_16x16x32_bf16 v[88:91], a[64:67], v[144:147], 0
  s_waitcnt lgkmcnt(0)
  v_perm_b32 v185, v97, v85, s58
  v_perm_b32 v189, v97, v85, s59
  v_mfma_f32_16x16x32_bf16 v[88:91], a[52:55], v[128:131], v[88:91]
  s_add_u32 m0, s28, 4096
  v_perm_b32 v186, v98, v86, s58
  v_perm_b32 v190, v98, v86, s59
  v_mfma_f32_16x16x32_bf16 v[88:91], a[40:43], v[64:67], v[88:91]
  s_mov_b32 s5, s28
  v_mul_f32 v72, s42, v72
  v_mul_f32 v73, s42, v73
  v_mfma_f32_16x16x32_bf16 v[88:91], a[28:31], v[164:167], v[88:91]
  v_mul_f32 v74, s42, v74
  v_mul_f32 v75, s42, v75
  v_mfma_f32_16x16x32_bf16 v[88:91], a[16:19], a[244:247], v[88:91]
  buffer_load_dwordx4 v6, s[8:11], s32 offen offset:0 nt lds
  v_mfma_f32_16x16x32_bf16 v[88:91], a[4:7], v[60:63], v[88:91]
  s_add_u32 m0, s28, 12160
  v_cvt_pk_bf16_f32 v12, v72, v73
  v_cvt_pk_bf16_f32 v13, v74, v75
  v_mfma_f32_16x16x32_bf16 v[56:59], a[8:11], v[60:63], 0
  v_perm_b32 v187, v99, v87, s58
  v_perm_b32 v191, v99, v87, s59
  v_perm_b32 v192, v80, v76, s58
  v_mfma_f32_16x16x32_bf16 v[56:59], a[20:23], a[244:247], v[56:59]
  buffer_load_dwordx4 v6, s[8:11], s32 offen offset:128 nt lds
  v_perm_b32 v196, v80, v76, s59
  v_mfma_f32_16x16x32_bf16 v[56:59], a[32:35], v[164:167], v[56:59]
  s_add_u32 m0, s28, 20224
  v_mul_f32 v88, s42, v88
  v_mul_f32 v89, s42, v89
  v_mul_f32 v90, s42, v90
  v_mfma_f32_16x16x32_bf16 v[56:59], a[44:47], v[64:67], v[56:59]
  s_mov_b32 s28, s29
  v_mul_f32 v91, s42, v91
  v_cvt_pk_bf16_f32 v72, v88, v89
  v_cvt_pk_bf16_f32 v73, v90, v91
  v_mfma_f32_16x16x32_bf16 v[56:59], a[56:59], v[128:131], v[56:59]
  buffer_load_dwordx4 v6, s[8:11], s32 offen offset:256 nt lds
  v_perm_b32 v193, v81, v77, s58
  v_mfma_f32_16x16x32_bf16 v[56:59], a[68:71], v[144:147], v[56:59]
  s_add_u32 s32, s32, s43
  v_perm_b32 v197, v81, v77, s59
  v_perm_b32 v194, v82, v78, s58
  v_perm_b32 v198, v82, v78, s59
  v_mfma_f32_16x16x32_bf16 v[88:91], a[132:135], v[144:147], 0
  ds_read2st64_b32 v[84:85], v68 offset0:16 offset1:18
  v_perm_b32 v195, v83, v79, s58
  v_perm_b32 v199, v83, v79, s59
  v_mfma_f32_16x16x32_bf16 v[88:91], a[120:123], v[128:131], v[88:91]
  ds_read2st64_b32 v[96:97], v69 offset0:16 offset1:18
  ds_read2st64_b32 v[86:87], v68 offset0:20 offset1:22
  v_mul_f32 v178, v170, v178
  v_mfma_f32_16x16x32_bf16 v[88:91], a[108:111], v[64:67], v[88:91]
  v_mul_f32 v56, s42, v56
  v_mul_f32 v57, s42, v57
  v_mul_f32 v58, s42, v58
  v_mfma_f32_16x16x32_bf16 v[88:91], a[96:99], v[164:167], v[88:91]
  v_mul_f32 v59, s42, v59
  v_cvt_pk_bf16_f32 v74, v56, v57
  v_cvt_pk_bf16_f32 v75, v58, v59
  v_mfma_f32_16x16x32_bf16 v[88:91], a[84:87], a[244:247], v[88:91]
  ds_read2st64_b32 v[98:99], v69 offset0:20 offset1:22
  ds_read2st64_b32 v[76:77], v54 offset0:16 offset1:18
  v_mul_f32 v179, v170, v179
  v_mfma_f32_16x16x32_bf16 v[88:91], a[72:75], v[60:63], v[88:91]
  ds_read2st64_b32 v[80:81], v55 offset0:16 offset1:18
  ds_read2st64_b32 v[78:79], v54 offset0:20 offset1:22
  v_cvt_pk_bf16_f32 v176, v176, v177
  v_mfma_f32_16x16x32_bf16 v[56:59], a[76:79], v[60:63], 0
  ds_read2st64_b32 v[82:83], v55 offset0:20 offset1:22
  v_cvt_pk_bf16_f32 v177, v178, v179
  v_mul_f32 v172, v170, v172
  v_mfma_f32_16x16x32_bf16 v[56:59], a[88:91], a[244:247], v[56:59]
  v_mul_f32 v173, v170, v173
  v_mul_f32 v174, v170, v174
  v_mul_f32 v175, v170, v175
  v_mfma_f32_16x16x32_bf16 v[56:59], a[100:103], v[164:167], v[56:59]
  v_cvt_pk_bf16_f32 v120, v88, v89
  v_cvt_pk_bf16_f32 v121, v90, v91
  v_cvt_pk_bf16_f32 v172, v172, v173
  v_mfma_f32_16x16x32_bf16 v[56:59], a[112:115], v[64:67], v[56:59]
  s_waitcnt lgkmcnt(4)
  v_cvt_pk_bf16_f32 v173, v174, v175
  v_mul_f32 v124, v170, v124
  v_mul_f32 v125, v170, v125
  v_mfma_f32_16x16x32_bf16 v[56:59], a[124:127], v[128:131], v[56:59]
  v_mul_f32 v126, v170, v126
  v_mul_f32 v127, v170, v127
  v_cvt_pk_bf16_f32 v124, v124, v125
  v_mfma_f32_16x16x32_bf16 v[56:59], a[136:139], v[144:147], v[56:59]
  s_waitcnt lgkmcnt(0)
  v_cvt_pk_bf16_f32 v125, v126, v127
  v_max3_f32 v9, v168, v170, v9
  v_perm_b32 v200, v96, v84, s58
  v_mfma_f32_16x16x32_bf16 v[92:95], a[140:143], v[144:147], 0
  ds_write2st64_b32 v5, v176, v177 offset0:0 offset1:4
  v_mfma_f32_16x16x32_bf16 v[92:95], a[128:131], v[128:131], v[92:95]
  ds_write2st64_b32 v5, v172, v173 offset0:8 offset1:12
  v_mfma_f32_16x16x32_bf16 v[92:95], a[116:119], v[64:67], v[92:95]
  v_cvt_pk_bf16_f32 v122, v56, v57
  v_cvt_pk_bf16_f32 v123, v58, v59
  v_perm_b32 v204, v96, v84, s59
  v_mfma_f32_16x16x32_bf16 v[92:95], a[104:107], v[164:167], v[92:95]
  ds_write2st64_b32 v5, v124, v125 offset0:16 offset1:20
  v_mfma_f32_16x16x32_bf16 v[92:95], a[92:95], a[244:247], v[92:95]
  v_perm_b32 v201, v97, v85, s58
  v_perm_b32 v205, v97, v85, s59
  v_perm_b32 v202, v98, v86, s58
  v_mfma_f32_16x16x32_bf16 v[92:95], a[80:83], v[60:63], v[92:95]
  v_perm_b32 v206, v98, v86, s59
  v_perm_b32 v203, v99, v87, s58
  v_perm_b32 v207, v99, v87, s59
  v_mfma_f32_16x16x32_bf16 v[168:171], v[60:63], a[144:147], 0
  v_perm_b32 v208, v80, v76, s58
  v_perm_b32 v212, v80, v76, s59
  v_perm_b32 v209, v81, v77, s58
  v_mfma_f32_16x16x32_bf16 v[168:171], a[244:247], a[156:159], v[168:171]
  v_perm_b32 v213, v81, v77, s59
  v_perm_b32 v210, v82, v78, s58
  v_perm_b32 v214, v82, v78, s59
  v_mfma_f32_16x16x32_bf16 v[168:171], v[164:167], a[168:171], v[168:171]
  ds_read_b128 a[248:251], v0 offset:2048
  v_cvt_pk_bf16_f32 v124, v92, v93
  v_cvt_pk_bf16_f32 v125, v94, v95
  v_mfma_f32_16x16x32_bf16 v[168:171], v[64:67], a[180:183], v[168:171]
  ds_read_b128 v[172:175], v1 offset:2048
  ds_read_b128 v[88:91], v0 offset:10240
  v_perm_b32 v211, v83, v79, s58
  v_mfma_f32_16x16x32_bf16 v[168:171], v[128:131], a[192:195], v[168:171]
  s_add_u32 m0, s29, 0
  ds_read_b128 v[160:163], v1 offset:10240
  ds_read_b128 a[252:255], v0 offset:18432
  v_perm_b32 v215, v83, v79, s59
  v_mfma_f32_16x16x32_bf16 v[168:171], v[144:147], a[204:207], v[168:171]
  ds_read_b128 v[92:95], v1 offset:18432
  v_add_u32 v68, 4294844416, v68
  v_add_u32 v69, 4294844416, v69
  v_mfma_f32_16x16x32_bf16 v[176:179], v[144:147], a[208:211], 0
  s_waitcnt vmcnt(3)
  s_barrier
  v_mfma_f32_16x16x32_bf16 v[176:179], v[128:131], a[196:199], v[176:179]
  buffer_load_dwordx4 v6, s[8:11], s31 offen offset:0 nt lds
  v_add_u32 v54, 4294844416, v54
  v_mfma_f32_16x16x32_bf16 v[176:179], v[64:67], a[184:187], v[176:179]
  s_add_u32 m0, s29, 8064
  v_cvt_pk_bf16_f32 v56, v168, v169
  v_cvt_pk_bf16_f32 v57, v170, v171
  v_add_u32 v55, 4294844416, v55
  v_mfma_f32_16x16x32_bf16 v[176:179], v[164:167], a[172:175], v[176:179]
  ds_read2st64_b32 v[84:85], v68 offset0:0 offset1:2
  ds_read2st64_b32 v[96:97], v69 offset0:0 offset1:2
  v_add_f32 v112, v112, v113
  v_mfma_f32_16x16x32_bf16 v[176:179], a[244:247], a[160:163], v[176:179]
  ds_read2st64_b32 v[86:87], v68 offset0:4 offset1:6
  ds_read2st64_b32 v[98:99], v69 offset0:4 offset1:6
  v_add_f32 v104, v104, v105
  v_mfma_f32_16x16x32_bf16 v[176:179], v[60:63], a[148:151], v[176:179]
  buffer_load_dwordx4 v6, s[8:11], s31 offen offset:128 nt lds
  v_mfma_f32_16x16x32_bf16 v[168:171], v[60:63], a[152:155], 0
L_hop_1_0:
  s_cbranch_execz L_hop_1_1
  s_add_u32 m0, s29, 16128
  ds_read2st64_b32 v[76:77], v54 offset0:0 offset1:2
  ds_read2st64_b32 v[80:81], v55 offset0:0 offset1:2
  v_mfma_f32_16x16x32_bf16 v[168:171], a[244:247], a[164:167], v[168:171]
  ds_read2st64_b32 v[78:79], v54 offset0:4 offset1:6
  ds_read2st64_b32 v[82:83], v55 offset0:4 offset1:6
  v_mfma_f32_16x16x32_bf16 v[168:171], v[164:167], a[176:179], v[168:171]
  v_cvt_pk_bf16_f32 v60, v176, v177
  v_cvt_pk_bf16_f32 v61, v178, v179
  v_mfma_f32_16x16x32_bf16 v[168:171], v[64:67], a[188:191], v[168:171]
  buffer_load_dwordx4 v6, s[8:11], s31 offen offset:256 nt lds
  v_mfma_f32_16x16x32_bf16 v[168:171], v[128:131], a[200:203], v[168:171]
  s_add_u32 m0, s29, 4096
  v_rcp_f32 v134, v132
  v_mfma_f32_16x16x32_bf16 v[168:171], v[144:147], a[212:215], v[168:171]
  s_waitcnt lgkmcnt(4)
  v_perm_b32 v216, v96, v84, s58
  v_perm_b32 v220, v96, v84, s59
  v_perm_b32 v217, v97, v85, s58
  v_mfma_f32_16x16x32_bf16 v[164:167], a[0:3], a[248:251], 0
  s_waitcnt lgkmcnt(0)
  v_perm_b32 v221, v97, v85, s59
  v_perm_b32 v218, v98, v86, s58
  v_perm_b32 v222, v98, v86, s59
  v_mfma_f32_16x16x32_bf16 v[164:167], a[12:15], v[172:175], v[164:167]
  buffer_load_dwordx4 v6, s[8:11], s32 offen offset:0 nt lds
  v_perm_b32 v219, v99, v87, s58
  v_mfma_f32_16x16x32_bf16 v[164:167], a[24:27], v[88:91], v[164:167]
  s_add_u32 m0, s29, 12160
  v_cvt_pk_bf16_f32 v64, v168, v169
  v_cvt_pk_bf16_f32 v65, v170, v171
  v_perm_b32 v223, v99, v87, s59
  v_mfma_f32_16x16x32_bf16 v[164:167], a[36:39], v[160:163], v[164:167]
  s_add_u32 s31, s31, s43
  v_perm_b32 v224, v80, v76, s58
  v_perm_b32 v228, v80, v76, s59
  v_perm_b32 v225, v81, v77, s58
  v_mfma_f32_16x16x32_bf16 v[164:167], a[48:51], a[252:255], v[164:167]
  v_perm_b32 v229, v81, v77, s59
  v_perm_b32 v226, v82, v78, s58
  v_perm_b32 v230, v82, v78, s59
  v_mfma_f32_16x16x32_bf16 v[164:167], a[60:63], v[92:95], v[164:167]
  buffer_load_dwordx4 v6, s[8:11], s32 offen offset:128 nt lds
  v_perm_b32 v227, v83, v79, s58
  v_mfma_f32_16x16x32_bf16 v[168:171], a[64:67], v[92:95], 0
  s_add_u32 m0, s29, 20224
  ds_read2st64_b32 v[84:85], v68 offset0:16 offset1:18
  ds_read2st64_b32 v[96:97], v69 offset0:16 offset1:18
  v_perm_b32 v231, v83, v79, s59
  v_mfma_f32_16x16x32_bf16 v[168:171], a[52:55], a[252:255], v[168:171]
  s_mov_b32 s29, s30
  ds_read2st64_b32 v[86:87], v68 offset0:20 offset1:22
  ds_read2st64_b32 v[98:99], v69 offset0:20 offset1:22
  v_mul_f32 v152, v134, v152
  v_mfma_f32_16x16x32_bf16 v[168:171], a[40:43], v[160:163], v[168:171]
  v_mul_f32 v164, s42, v164
  v_mul_f32 v165, s42, v165
  v_mul_f32 v166, s42, v166
  v_mfma_f32_16x16x32_bf16 v[168:171], a[28:31], v[88:91], v[168:171]
  buffer_load_dwordx4 v6, s[8:11], s32 offen offset:256 nt lds
  v_mul_f32 v167, s42, v167
  v_mfma_f32_16x16x32_bf16 v[168:171], a[16:19], v[172:175], v[168:171]
  s_add_u32 s32, s32, s43
  ds_read2st64_b32 v[76:77], v54 offset0:16 offset1:18
  v_cvt_pk_bf16_f32 v128, v164, v165
  v_cvt_pk_bf16_f32 v129, v166, v167
  v_mfma_f32_16x16x32_bf16 v[168:171], a[4:7], a[248:251], v[168:171]
  ds_read2st64_b32 v[80:81], v55 offset0:16 offset1:18
  ds_read2st64_b32 v[78:79], v54 offset0:20 offset1:22
  v_mul_f32 v153, v134, v153
  v_mfma_f32_16x16x32_bf16 v[164:167], a[8:11], a[248:251], 0
  s_waitcnt lgkmcnt(3)
  ds_read2st64_b32 v[82:83], v55 offset0:20 offset1:22
  v_mul_f32 v154, v134, v154
  v_mul_f32 v155, v134, v155
  v_mfma_f32_16x16x32_bf16 v[164:167], a[20:23], v[172:175], v[164:167]
  v_cvt_pk_bf16_f32 v152, v152, v153
  v_cvt_pk_bf16_f32 v153, v154, v155
  v_mul_f32 v140, v134, v140
  v_mfma_f32_16x16x32_bf16 v[164:167], a[32:35], v[88:91], v[164:167]
  v_mul_f32 v168, s42, v168
  v_mul_f32 v169, s42, v169
  v_mul_f32 v170, s42, v170
  v_mfma_f32_16x16x32_bf16 v[164:167], a[44:47], v[160:163], v[164:167]
  v_mul_f32 v171, s42, v171
  v_cvt_pk_bf16_f32 v130, v168, v169
  v_cvt_pk_bf16_f32 v131, v170, v171
  v_mfma_f32_16x16x32_bf16 v[164:167], a[56:59], a[252:255], v[164:167]
  v_mul_f32 v141, v134, v141
  v_mul_f32 v142, v134, v142
  v_mul_f32 v143, v134, v143
  v_mfma_f32_16x16x32_bf16 v[164:167], a[68:71], v[92:95], v[164:167]
  s_waitcnt lgkmcnt(0)
  v_cvt_pk_bf16_f32 v140, v140, v141
  v_cvt_pk_bf16_f32 v141, v142, v143
  v_mul_f32 v180, v134, v180
  v_mfma_f32_16x16x32_bf16 v[168:171], a[132:135], v[92:95], 0
  v_mul_f32 v181, v134, v181
  v_mul_f32 v182, v134, v182
  v_mul_f32 v183, v134, v183
  v_mfma_f32_16x16x32_bf16 v[168:171], a[120:123], a[252:255], v[168:171]
  v_cvt_pk_bf16_f32 v180, v180, v181
  v_cvt_pk_bf16_f32 v181, v182, v183
  v_max3_f32 v9, v132, v134, v9
  v_mfma_f32_16x16x32_bf16 v[168:171], a[108:111], v[160:163], v[168:171]
  v_mul_f32 v164, s42, v164
  v_mul_f32 v165, s42, v165
  v_mul_f32 v166, s42, v166
  v_mfma_f32_16x16x32_bf16 v[168:171], a[96:99], v[88:91], v[168:171]
  v_mul_f32 v167, s42, v167
  v_cvt_pk_bf16_f32 v16, v164, v165
  v_cvt_pk_bf16_f32 v17, v166, v167
  v_mfma_f32_16x16x32_bf16 v[168:171], a[84:87], v[172:175], v[168:171]
  ds_write2st64_b32 v5, v152, v153 offset0:1 offset1:5
  v_mfma_f32_16x16x32_bf16 v[168:171], a[72:75], a[248:251], v[168:171]
  ds_write2st64_b32 v5, v140, v141 offset0:9 offset1:13
  v_mfma_f32_16x16x32_bf16 v[132:135], a[76:79], a[248:251], 0
  ds_write2st64_b32 v5, v180, v181 offset0:17 offset1:21
  v_mfma_f32_16x16x32_bf16 v[132:135], a[88:91], v[172:175], v[132:135]
  v_rcp_f32 v114, v112
  v_perm_b32 v232, v96, v84, s58
  v_mfma_f32_16x16x32_bf16 v[132:135], a[100:103], v[88:91], v[132:135]
  v_cvt_pk_bf16_f32 v144, v168, v169
  v_cvt_pk_bf16_f32 v145, v170, v171
  v_mul_f32 v136, v114, v136
  v_mfma_f32_16x16x32_bf16 v[132:135], a[112:115], v[160:163], v[132:135]
  v_mul_f32 v137, v114, v137
  v_mul_f32 v138, v114, v138
  v_mul_f32 v139, v114, v139
  v_mfma_f32_16x16x32_bf16 v[132:135], a[124:127], a[252:255], v[132:135]
  v_cvt_pk_bf16_f32 v136, v136, v137
  v_cvt_pk_bf16_f32 v137, v138, v139
  v_mul_f32 v156, v114, v156
  v_mfma_f32_16x16x32_bf16 v[132:135], a[136:139], v[92:95], v[132:135]
  v_mul_f32 v157, v114, v157
  v_mul_f32 v158, v114, v158
  v_mul_f32 v159, v114, v159
  v_mfma_f32_16x16x32_bf16 v[152:155], a[140:143], v[92:95], 0
  v_cvt_pk_bf16_f32 v156, v156, v157
  v_cvt_pk_bf16_f32 v157, v158, v159
  v_mul_f32 v148, v114, v148
  v_mfma_f32_16x16x32_bf16 v[152:155], a[128:131], a[252:255], v[152:155]
  v_mul_f32 v149, v114, v149
  v_mul_f32 v150, v114, v150
  v_mul_f32 v151, v114, v151
  v_mfma_f32_16x16x32_bf16 v[152:155], a[116:119], v[160:163], v[152:155]
  v_cvt_pk_bf16_f32 v146, v132, v133
  v_cvt_pk_bf16_f32 v147, v134, v135
  v_cvt_pk_bf16_f32 v148, v148, v149
  v_mfma_f32_16x16x32_bf16 v[152:155], a[104:107], v[88:91], v[152:155]
  v_cvt_pk_bf16_f32 v149, v150, v151
  v_max3_f32 v9, v112, v114, v9
  v_perm_b32 v236, v96, v84, s59
  v_mfma_f32_16x16x32_bf16 v[152:155], a[92:95], v[172:175], v[152:155]
  ds_write2st64_b32 v5, v136, v137 offset0:2 offset1:6
  v_mfma_f32_16x16x32_bf16 v[152:155], a[80:83], a[248:251], v[152:155]
  ds_write2st64_b32 v5, v156, v157 offset0:10 offset1:14
  v_mfma_f32_16x16x32_bf16 v[168:171], a[248:251], a[144:147], 0
  ds_write2st64_b32 v5, v148, v149 offset0:18 offset1:22
  v_mfma_f32_16x16x32_bf16 v[168:171], v[172:175], a[156:159], v[168:171]
  v_rcp_f32 v106, v104
  v_perm_b32 v233, v97, v85, s58
  v_mfma_f32_16x16x32_bf16 v[168:171], v[88:91], a[168:171], v[168:171]
  v_cvt_pk_bf16_f32 v148, v152, v153
  v_cvt_pk_bf16_f32 v149, v154, v155
  v_mfma_f32_16x16x32_bf16 v[168:171], v[160:163], a[180:183], v[168:171]
  v_mul_f32 v100, v106, v100
  v_mul_f32 v101, v106, v101
  v_mfma_f32_16x16x32_bf16 v[168:171], a[252:255], a[192:195], v[168:171]
  s_waitcnt vmcnt(6) lgkmcnt(0)
  s_barrier
  v_mfma_f32_16x16x32_bf16 v[168:171], v[92:95], a[204:207], v[168:171]
  ds_read_b128 v[156:159], v0 offset:4096
  ds_read_b128 v[112:115], v1 offset:4096
  v_mfma_f32_16x16x32_bf16 v[132:135], v[92:95], a[208:211], 0
  ds_read_b128 v[180:183], v0 offset:12288
  ds_read_b128 v[140:143], v1 offset:12288
  v_mfma_f32_16x16x32_bf16 v[132:135], a[252:255], a[196:199], v[132:135]
  ds_read_b128 v[164:167], v0 offset:20480
  ds_read_b128 v[176:179], v1 offset:20480
  v_mfma_f32_16x16x32_bf16 v[132:135], v[160:163], a[184:187], v[132:135]
  v_cvt_pk_bf16_f32 v58, v168, v169
  v_cvt_pk_bf16_f32 v59, v170, v171
  v_mfma_f32_16x16x32_bf16 v[132:135], v[88:91], a[172:175], v[132:135]
  v_mul_f32 v102, v106, v102
  v_mul_f32 v103, v106, v103
  v_mfma_f32_16x16x32_bf16 v[132:135], v[172:175], a[160:163], v[132:135]
  v_cvt_pk_bf16_f32 v100, v100, v101
  v_cvt_pk_bf16_f32 v101, v102, v103
  v_mfma_f32_16x16x32_bf16 v[132:135], a[248:251], a[148:151], v[132:135]
  v_mul_f32 v108, v106, v108
  v_mul_f32 v109, v106, v109
  v_mfma_f32_16x16x32_bf16 v[136:139], a[248:251], a[152:155], 0
  v_mul_f32 v110, v106, v110
  v_mul_f32 v111, v106, v111
  v_mfma_f32_16x16x32_bf16 v[136:139], v[172:175], a[164:167], v[136:139]
  v_cvt_pk_bf16_f32 v108, v108, v109
  v_cvt_pk_bf16_f32 v109, v110, v111
  v_mfma_f32_16x16x32_bf16 v[136:139], v[88:91], a[176:179], v[136:139]
  v_cvt_pk_bf16_f32 v62, v132, v133
  v_cvt_pk_bf16_f32 v63, v134, v135
  v_mfma_f32_16x16x32_bf16 v[136:139], v[160:163], a[188:191], v[136:139]
  v_mul_f32 v116, v106, v116
  v_mul_f32 v117, v106, v117
  v_mfma_f32_16x16x32_bf16 v[136:139], a[252:255], a[200:203], v[136:139]
  v_mul_f32 v118, v106, v118
  v_mul_f32 v119, v106, v119
  v_mfma_f32_16x16x32_bf16 v[136:139], v[92:95], a[212:215], v[136:139]
  s_waitcnt lgkmcnt(0)
  v_cvt_pk_bf16_f32 v116, v116, v117
  v_cvt_pk_bf16_f32 v117, v118, v119
  v_mfma_f32_16x16x32_bf16 v[92:95], a[0:3], v[156:159], 0
  v_max3_f32 v9, v104, v106, v9
  v_perm_b32 v237, v97, v85, s59
  v_mfma_f32_16x16x32_bf16 v[92:95], a[12:15], v[112:115], v[92:95]
  ds_write2st64_b32 v5, v100, v101 offset0:3 offset1:7
  v_mfma_f32_16x16x32_bf16 v[92:95], a[24:27], v[180:183], v[92:95]
  v_cvt_pk_bf16_f32 v66, v136, v137
  v_cvt_pk_bf16_f32 v67, v138, v139
  v_mfma_f32_16x16x32_bf16 v[92:95], a[36:39], v[140:143], v[92:95]
  ds_write2st64_b32 v5, v108, v109 offset0:11 offset1:15
  v_mfma_f32_16x16x32_bf16 v[92:95], a[48:51], v[164:167], v[92:95]
  ds_write2st64_b32 v5, v116, v117 offset0:19 offset1:23
  v_mfma_f32_16x16x32_bf16 v[92:95], a[60:63], v[176:179], v[92:95]
  v_perm_b32 v234, v98, v86, s58
  v_perm_b32 v238, v98, v86, s59
  v_mfma_f32_16x16x32_bf16 v[88:91], a[64:67], v[176:179], 0
  v_perm_b32 v235, v99, v87, s58
  v_perm_b32 v239, v99, v87, s59
  v_mfma_f32_16x16x32_bf16 v[88:91], a[52:55], v[164:167], v[88:91]
  v_perm_b32 v240, v80, v76, s58
  v_perm_b32 v244, v80, v76, s59
  v_mfma_f32_16x16x32_bf16 v[88:91], a[40:43], v[140:143], v[88:91]
  v_mul_f32 v92, s42, v92
  v_mul_f32 v93, s42, v93
  v_mfma_f32_16x16x32_bf16 v[88:91], a[28:31], v[180:183], v[88:91]
  v_mul_f32 v94, s42, v94
  v_mul_f32 v95, s42, v95
  v_mfma_f32_16x16x32_bf16 v[88:91], a[16:19], v[112:115], v[88:91]
  v_cvt_pk_bf16_f32 v18, v92, v93
  v_cvt_pk_bf16_f32 v19, v94, v95
  v_mfma_f32_16x16x32_bf16 v[88:91], a[4:7], v[156:159], v[88:91]
  v_perm_b32 v241, v81, v77, s58
  v_perm_b32 v245, v81, v77, s59
  v_mfma_f32_16x16x32_bf16 v[92:95], a[8:11], v[156:159], 0
  v_perm_b32 v242, v82, v78, s58
  v_perm_b32 v246, v82, v78, s59
  v_mfma_f32_16x16x32_bf16 v[92:95], a[20:23], v[112:115], v[92:95]
  v_perm_b32 v243, v83, v79, s58
  v_perm_b32 v247, v83, v79, s59
  v_mfma_f32_16x16x32_bf16 v[92:95], a[32:35], v[180:183], v[92:95]
  v_mul_f32 v88, s42, v88
  v_mul_f32 v89, s42, v89
  v_mfma_f32_16x16x32_bf16 v[92:95], a[44:47], v[140:143], v[92:95]
  v_mul_f32 v90, s42, v90
  v_mul_f32 v91, s42, v91
  v_mfma_f32_16x16x32_bf16 v[92:95], a[56:59], v[164:167], v[92:95]
  v_cvt_pk_bf16_f32 v100, v88, v89
  v_cvt_pk_bf16_f32 v101, v90, v91
  v_mfma_f32_16x16x32_bf16 v[92:95], a[68:71], v[176:179], v[92:95]
  v_add_u32 v68, 98304, v68
  v_add_u32 v69, 98304, v69
  v_mfma_f32_16x16x32_bf16 v[88:91], a[132:135], v[176:179], 0
  v_add_u32 v54, 98304, v54
  v_add_u32 v55, 98304, v55
  v_mfma_f32_16x16x32_bf16 v[88:91], a[120:123], v[164:167], v[88:91]
  ds_read2st64_b32 v[84:85], v68 offset0:0 offset1:2
  ds_read2st64_b32 v[96:97], v69 offset0:0 offset1:2
  v_mfma_f32_16x16x32_bf16 v[88:91], a[108:111], v[140:143], v[88:91]
  v_mul_f32 v92, s42, v92
  v_mul_f32 v93, s42, v93
  v_mfma_f32_16x16x32_bf16 v[88:91], a[96:99], v[180:183], v[88:91]
  v_mul_f32 v94, s42, v94
  v_mul_f32 v95, s42, v95
  v_mfma_f32_16x16x32_bf16 v[88:91], a[84:87], v[112:115], v[88:91]
  v_cvt_pk_bf16_f32 v102, v92, v93
  v_cvt_pk_bf16_f32 v103, v94, v95
  v_mfma_f32_16x16x32_bf16 v[88:91], a[72:75], v[156:159], v[88:91]
  ds_read2st64_b32 v[86:87], v68 offset0:4 offset1:6
  ds_read2st64_b32 v[98:99], v69 offset0:4 offset1:6
  v_mfma_f32_16x16x32_bf16 v[92:95], a[76:79], v[156:159], 0
  ds_read2st64_b32 v[76:77], v54 offset0:0 offset1:2
  ds_read2st64_b32 v[80:81], v55 offset0:0 offset1:2
  v_mfma_f32_16x16x32_bf16 v[92:95], a[88:91], v[112:115], v[92:95]
  ds_read2st64_b32 v[78:79], v54 offset0:4 offset1:6
  ds_read2st64_b32 v[82:83], v55 offset0:4 offset1:6
  v_mfma_f32_16x16x32_bf16 v[92:95], a[100:103], v[180:183], v[92:95]
  v_cvt_pk_bf16_f32 v132, v88, v89
  v_cvt_pk_bf16_f32 v133, v90, v91
  v_mfma_f32_16x16x32_bf16 v[92:95], a[112:115], v[140:143], v[92:95]
  v_xor_b32 v5, s41, v5
  v_mfma_f32_16x16x32_bf16 v[92:95], a[124:127], v[164:167], v[92:95]
  s_waitcnt lgkmcnt(4)
  v_perm_b32 v248, v96, v84, s58
  v_perm_b32 v252, v96, v84, s59
  v_mfma_f32_16x16x32_bf16 v[92:95], a[136:139], v[176:179], v[92:95]
  v_perm_b32 v249, v97, v85, s58
  v_perm_b32 v253, v97, v85, s59
  v_mfma_f32_16x16x32_bf16 v[88:91], a[140:143], v[176:179], 0
  s_waitcnt lgkmcnt(0)
  v_perm_b32 v250, v98, v86, s58
  v_perm_b32 v254, v98, v86, s59
  v_mfma_f32_16x16x32_bf16 v[88:91], a[128:131], v[164:167], v[88:91]
  v_perm_b32 v251, v99, v87, s58
  v_perm_b32 v255, v99, v87, s59
  v_mfma_f32_16x16x32_bf16 v[88:91], a[116:119], v[140:143], v[88:91]
  v_cvt_pk_bf16_f32 v134, v92, v93
  v_cvt_pk_bf16_f32 v135, v94, v95
  v_mfma_f32_16x16x32_bf16 v[88:91], a[104:107], v[180:183], v[88:91]
  s_add_u32 m0, s30, 0
  v_perm_b32 v104, v80, v76, s58
  v_perm_b32 v76, v80, v76, s59
  v_mfma_f32_16x16x32_bf16 v[88:91], a[92:95], v[112:115], v[88:91]
  v_accvgpr_write_b32 a220, v76
  v_perm_b32 v105, v81, v77, s58
  v_mfma_f32_16x16x32_bf16 v[88:91], a[80:83], v[156:159], v[88:91]
  v_perm_b32 v77, v81, v77, s59
  v_accvgpr_write_b32 a221, v77
  v_mfma_f32_16x16x32_bf16 v[84:87], v[156:159], a[144:147], 0
  buffer_load_dwordx4 v6, s[8:11], s31 offen offset:0 nt lds
  v_mfma_f32_16x16x32_bf16 v[84:87], v[112:115], a[156:159], v[84:87]
  s_add_u32 m0, s30, 8064
  v_perm_b32 v106, v82, v78, s58
  v_perm_b32 v78, v82, v78, s59
  v_mfma_f32_16x16x32_bf16 v[84:87], v[180:183], a[168:171], v[84:87]
  v_cvt_pk_bf16_f32 v136, v88, v89
  v_cvt_pk_bf16_f32 v137, v90, v91
  v_mfma_f32_16x16x32_bf16 v[84:87], v[140:143], a[180:183], v[84:87]
  ds_read_b128 a[252:255], v1 offset:22528
  ds_read_b128 v[152:155], v0 offset:22528
  v_mfma_f32_16x16x32_bf16 v[84:87], v[164:167], a[192:195], v[84:87]
  buffer_load_dwordx4 v6, s[8:11], s31 offen offset:128 nt lds
  v_mfma_f32_16x16x32_bf16 v[84:87], v[176:179], a[204:207], v[84:87]
  s_add_u32 m0, s30, 16128
  ds_read_b128 a[244:247], v1 offset:14336
  ds_read_b128 a[248:251], v0 offset:14336
  v_mfma_f32_16x16x32_bf16 v[92:95], v[176:179], a[208:211], 0
  ds_read_b128 v[172:175], v1 offset:6144
  ds_read_b128 v[168:171], v0 offset:6144
  v_mfma_f32_16x16x32_bf16 v[92:95], v[164:167], a[196:199], v[92:95]
  v_accvgpr_write_b32 a222, v78
  v_perm_b32 v107, v83, v79, s58
  v_mfma_f32_16x16x32_bf16 v[92:95], v[140:143], a[184:187], v[92:95]
  buffer_load_dwordx4 v6, s[8:11], s31 offen offset:256 nt lds
  v_mfma_f32_16x16x32_bf16 v[92:95], v[180:183], a[172:175], v[92:95]
  s_add_u32 m0, s30, 4096
  v_cvt_pk_bf16_f32 v108, v84, v85
  v_cvt_pk_bf16_f32 v109, v86, v87
  v_mfma_f32_16x16x32_bf16 v[92:95], v[112:115], a[160:163], v[92:95]
  s_add_u32 s31, s31, s43
  v_perm_b32 v79, v83, v79, s59
  v_accvgpr_write_b32 a223, v79
  v_mfma_f32_16x16x32_bf16 v[92:95], v[156:159], a[148:151], v[92:95]
  ds_read2st64_b32 v[84:85], v68 offset0:16 offset1:18
  ds_read2st64_b32 v[96:97], v69 offset0:16 offset1:18
  v_mfma_f32_16x16x32_bf16 v[88:91], v[156:159], a[152:155], 0
  buffer_load_dwordx4 v6, s[8:11], s32 offen offset:0 nt lds
  v_mfma_f32_16x16x32_bf16 v[88:91], v[112:115], a[164:167], v[88:91]
  s_add_u32 m0, s30, 12160
  ds_read2st64_b32 v[86:87], v68 offset0:20 offset1:22
  ds_read2st64_b32 v[98:99], v69 offset0:20 offset1:22
  v_mfma_f32_16x16x32_bf16 v[88:91], v[180:183], a[176:179], v[88:91]
  v_cvt_pk_bf16_f32 v112, v92, v93
  v_cvt_pk_bf16_f32 v113, v94, v95
  v_mfma_f32_16x16x32_bf16 v[88:91], v[140:143], a[188:191], v[88:91]
  s_waitcnt lgkmcnt(2)
  ds_read2st64_b32 v[76:77], v54 offset0:16 offset1:18
  ds_read2st64_b32 v[80:81], v55 offset0:16 offset1:18
  v_mfma_f32_16x16x32_bf16 v[88:91], v[164:167], a[200:203], v[88:91]
  buffer_load_dwordx4 v6, s[8:11], s32 offen offset:128 nt lds
  v_mfma_f32_16x16x32_bf16 v[88:91], v[176:179], a[212:215], v[88:91]
  s_add_u32 m0, s30, 20224
  ds_read2st64_b32 v[78:79], v54 offset0:20 offset1:22
  ds_read2st64_b32 v[82:83], v55 offset0:20 offset1:22
  v_mfma_f32_16x16x32_bf16 v[68:71], a[132:135], a[252:255], 0
  s_waitcnt lgkmcnt(4)
  v_accvgpr_write_b32 a216, v104
  v_accvgpr_write_b32 a217, v105
  v_mfma_f32_16x16x32_bf16 v[68:71], a[120:123], v[152:155], v[68:71]
  s_mov_b32 s30, s5
  v_accvgpr_write_b32 a218, v106
  v_accvgpr_write_b32 a219, v107
  v_mfma_f32_16x16x32_bf16 v[68:71], a[108:111], a[244:247], v[68:71]
  buffer_load_dwordx4 v6, s[8:11], s32 offen offset:256 nt lds
  v_mfma_f32_16x16x32_bf16 v[68:71], a[96:99], a[248:251], v[68:71]
  s_add_u32 s32, s32, s43
  v_cvt_pk_bf16_f32 v116, v88, v89
  v_cvt_pk_bf16_f32 v117, v90, v91
  v_mfma_f32_16x16x32_bf16 v[68:71], a[84:87], v[172:175], v[68:71]
  s_waitcnt lgkmcnt(0)
  v_perm_b32 v54, v96, v84, s58
  v_perm_b32 v84, v96, v84, s59
  v_mfma_f32_16x16x32_bf16 v[68:71], a[72:75], v[168:171], v[68:71]
  v_accvgpr_write_b32 a224, v54
  v_accvgpr_write_b32 a228, v84
  v_mfma_f32_16x16x32_bf16 v[88:91], a[76:79], v[168:171], 0
  v_perm_b32 v55, v97, v85, s58
  v_perm_b32 v85, v97, v85, s59
  v_mfma_f32_16x16x32_bf16 v[88:91], a[88:91], v[172:175], v[88:91]
  v_accvgpr_write_b32 a225, v55
  v_accvgpr_write_b32 a229, v85
  v_mfma_f32_16x16x32_bf16 v[88:91], a[100:103], a[248:251], v[88:91]
  v_cvt_pk_bf16_f32 v176, v68, v69
  v_cvt_pk_bf16_f32 v177, v70, v71
  v_mfma_f32_16x16x32_bf16 v[88:91], a[112:115], a[244:247], v[88:91]
  v_perm_b32 v54, v98, v86, s58
  v_perm_b32 v86, v98, v86, s59
  v_mfma_f32_16x16x32_bf16 v[88:91], a[124:127], v[152:155], v[88:91]
  v_accvgpr_write_b32 a226, v54
  v_accvgpr_write_b32 a230, v86
  v_mfma_f32_16x16x32_bf16 v[88:91], a[136:139], a[252:255], v[88:91]
  v_perm_b32 v55, v99, v87, s58
  v_perm_b32 v87, v99, v87, s59
  v_mfma_f32_16x16x32_bf16 v[68:71], a[140:143], a[252:255], 0
  v_accvgpr_write_b32 a227, v55
  v_accvgpr_write_b32 a231, v87
  v_mfma_f32_16x16x32_bf16 v[68:71], a[128:131], v[152:155], v[68:71]
  v_perm_b32 v54, v80, v76, s58
  v_perm_b32 v76, v80, v76, s59
  v_mfma_f32_16x16x32_bf16 v[68:71], a[116:119], a[244:247], v[68:71]
  v_cvt_pk_bf16_f32 v178, v88, v89
  v_cvt_pk_bf16_f32 v179, v90, v91
  v_mfma_f32_16x16x32_bf16 v[68:71], a[104:107], a[248:251], v[68:71]
  v_accvgpr_write_b32 a232, v54
  v_accvgpr_write_b32 a236, v76
  v_mfma_f32_16x16x32_bf16 v[68:71], a[92:95], v[172:175], v[68:71]
  v_perm_b32 v55, v81, v77, s58
  v_perm_b32 v77, v81, v77, s59
  v_mfma_f32_16x16x32_bf16 v[68:71], a[80:83], v[168:171], v[68:71]
  v_accvgpr_write_b32 a233, v55
  v_accvgpr_write_b32 a237, v77
  v_mfma_f32_16x16x32_bf16 v[92:95], v[122:125], v[72:75], v[36:39]
  v_perm_b32 v54, v82, v78, s58
  v_perm_b32 v78, v82, v78, s59
  v_mfma_f32_16x16x32_bf16 v[92:95], v[120:123], v[12:15], v[92:95]
  v_accvgpr_write_b32 a234, v54
  v_accvgpr_write_b32 a238, v78
  v_mfma_f32_16x16x32_bf16 v[96:99], v[146:149], v[72:75], v[32:35]
  v_perm_b32 v55, v83, v79, s58
  v_perm_b32 v79, v83, v79, s59
  v_mfma_f32_16x16x32_bf16 v[96:99], v[144:147], v[12:15], v[96:99]
  v_accvgpr_write_b32 a235, v55
  v_accvgpr_write_b32 a239, v79
  v_mfma_f32_16x16x32_bf16 v[104:107], v[134:137], v[72:75], v[28:31]
  v_cvt_pk_bf16_f32 v180, v68, v69
  v_cvt_pk_bf16_f32 v181, v70, v71
  v_mfma_f32_16x16x32_bf16 v[104:107], v[132:135], v[12:15], v[104:107]
  v_exp_f32 v92, v92
  v_mfma_f32_16x16x32_bf16 v[140:143], v[178:181], v[72:75], v[24:27]
  s_lshr_b32 s44, s2, 3
  v_exp_f32 v93, v93
  v_mfma_f32_16x16x32_bf16 v[140:143], v[176:179], v[12:15], v[140:143]
  s_lshl_b32 s44, s44, 9
  v_exp_f32 v94, v94
  v_mfma_f32_16x16x32_bf16 v[84:87], v[120:123], v[128:131], v[40:43]
  s_add_u32 s44, s44, 1048576
  v_exp_f32 v95, v95
  v_mfma_f32_16x16x32_bf16 v[84:87], v[122:125], v[14:17], v[84:87]
  s_mov_b32 s45, 0
  v_exp_f32 v96, v96
  v_mfma_f32_16x16x32_bf16 v[88:91], v[144:147], v[128:131], v[36:39]
  s_mov_b32 s59, 0
  v_exp_f32 v97, v97
  v_mfma_f32_16x16x32_bf16 v[88:91], v[146:149], v[14:17], v[88:91]
  s_mov_b32 s58, 0
  v_exp_f32 v98, v98
  v_mfma_f32_16x16x32_bf16 v[68:71], v[132:135], v[128:131], v[32:35]
  s_mov_b64 s[12:13], 0
  v_exp_f32 v99, v99
  v_mfma_f32_16x16x32_bf16 v[68:71], v[134:137], v[14:17], v[68:71]
  s_mov_b64 s[16:17], 0
  v_exp_f32 v104, v104
  v_mfma_f32_16x16x32_bf16 v[72:75], v[176:179], v[128:131], v[28:31]
  s_mov_b64 s[18:19], 0
  v_exp_f32 v105, v105
  v_mfma_f32_16x16x32_bf16 v[72:75], v[178:181], v[14:17], v[72:75]
  s_mov_b64 s[60:61], 0
  v_exp_f32 v106, v106
  v_mfma_f32_16x16x32_bf16 v[76:79], v[134:137], v[100:103], v[36:39]
  s_mov_b32 s15, 0
  v_exp_f32 v107, v107
  v_mfma_f32_16x16x32_bf16 v[76:79], v[132:135], v[18:21], v[76:79]
  s_mov_b32 s99, 0
  v_exp_f32 v140, v140
  v_mfma_f32_16x16x32_bf16 v[80:83], v[178:181], v[100:103], v[32:35]
  s_mov_b64 s[100:101], 0
  v_exp_f32 v141, v141
  v_mfma_f32_16x16x32_bf16 v[80:83], v[176:179], v[18:21], v[80:83]
  s_mov_b32 s14, 0
  v_exp_f32 v142, v142
  v_mfma_f32_16x16x32_bf16 v[160:163], v[122:125], v[100:103], v[44:47]
  v_exp_f32 v143, v143
  v_mfma_f32_16x16x32_bf16 v[160:163], v[120:123], v[18:21], v[160:163]
  v_cvt_pk_bf16_f32 v92, v92, v93
  v_cvt_pk_bf16_f32 v93, v94, v95
  v_mfma_f32_16x16x32_bf16 v[156:159], v[146:149], v[100:103], v[40:43]
  v_cvt_pk_bf16_f32 v94, v96, v97
  v_cvt_pk_bf16_f32 v95, v98, v99
  v_mfma_f32_16x16x32_bf16 v[156:159], v[144:147], v[18:21], v[156:159]
  v_cvt_pk_bf16_f32 v96, v104, v105
  v_cvt_pk_bf16_f32 v97, v106, v107
  v_mfma_f32_16x16x32_bf16 v[128:131], a[0:3], v[168:171], 0
  v_cvt_pk_bf16_f32 v98, v140, v141
  v_cvt_pk_bf16_f32 v99, v142, v143
  v_mfma_f32_16x16x32_bf16 v[128:131], a[12:15], v[172:175], v[128:131]
  v_exp_f32 v84, v84
  v_mfma_f32_16x16x32_bf16 v[128:131], a[24:27], a[248:251], v[128:131]
  v_exp_f32 v85, v85
  v_mfma_f32_16x16x32_bf16 v[128:131], a[36:39], a[244:247], v[128:131]
  v_exp_f32 v86, v86
  v_mfma_f32_16x16x32_bf16 v[128:131], a[48:51], v[152:155], v[128:131]
  v_exp_f32 v87, v87
  v_mfma_f32_16x16x32_bf16 v[128:131], a[60:63], a[252:255], v[128:131]
  v_exp_f32 v88, v88
  v_mfma_f32_16x16x32_bf16 v[100:103], a[64:67], a[252:255], 0
  v_exp_f32 v89, v89
  v_mfma_f32_16x16x32_bf16 v[100:103], a[52:55], v[152:155], v[100:103]
  v_exp_f32 v90, v90
  v_mfma_f32_16x16x32_bf16 v[100:103], a[40:43], a[244:247], v[100:103]
  v_exp_f32 v91, v91
  v_mfma_f32_16x16x32_bf16 v[100:103], a[28:31], a[248:251], v[100:103]
  v_mul_f32 v128, s42, v128
  v_mul_f32 v129, s42, v129
  v_mfma_f32_16x16x32_bf16 v[100:103], a[16:19], v[172:175], v[100:103]
  v_mul_f32 v130, s42, v130
  v_mul_f32 v131, s42, v131
  v_mfma_f32_16x16x32_bf16 v[100:103], a[4:7], v[168:171], v[100:103]
  v_cvt_pk_bf16_f32 v140, v128, v129
  v_cvt_pk_bf16_f32 v141, v130, v131
  v_mfma_f32_16x16x32_bf16 v[104:107], a[8:11], v[168:171], 0
  v_exp_f32 v68, v68
  v_mfma_f32_16x16x32_bf16 v[104:107], a[20:23], v[172:175], v[104:107]
  v_exp_f32 v69, v69
  v_mfma_f32_16x16x32_bf16 v[104:107], a[32:35], a[248:251], v[104:107]
  v_exp_f32 v70, v70
  v_mfma_f32_16x16x32_bf16 v[104:107], a[44:47], a[244:247], v[104:107]
  v_mul_f32 v100, s42, v100
  v_mul_f32 v101, s42, v101
  v_mfma_f32_16x16x32_bf16 v[104:107], a[56:59], v[152:155], v[104:107]
  v_mul_f32 v102, s42, v102
  v_mul_f32 v103, s42, v103
  v_mfma_f32_16x16x32_bf16 v[104:107], a[68:71], a[252:255], v[104:107]
  v_cvt_pk_bf16_f32 v142, v100, v101
  v_cvt_pk_bf16_f32 v143, v102, v103
  v_mfma_f32_16x16x32_bf16 v[128:131], v[168:171], a[144:147], 0
  v_exp_f32 v71, v71
  v_mfma_f32_16x16x32_bf16 v[128:131], v[172:175], a[156:159], v[128:131]
  v_exp_f32 v72, v72
  v_mfma_f32_16x16x32_bf16 v[128:131], a[248:251], a[168:171], v[128:131]
  v_mul_f32 v104, s42, v104
  v_mul_f32 v105, s42, v105
  v_mfma_f32_16x16x32_bf16 v[128:131], a[244:247], a[180:183], v[128:131]
  v_mul_f32 v106, s42, v106
  v_mul_f32 v107, s42, v107
  v_cvt_pk_bf16_f32 v22, v104, v105
  v_cvt_pk_bf16_f32 v23, v106, v107
  v_mfma_f32_16x16x32_bf16 v[128:131], v[152:155], a[192:195], v[128:131]
  s_waitcnt vmcnt(6) lgkmcnt(0)
  s_barrier
  v_mfma_f32_16x16x32_bf16 v[128:131], a[252:255], a[204:207], v[128:131]
  v_exp_f32 v73, v73
  v_mfma_f32_16x16x32_bf16 v[100:103], v[132:135], v[140:143], v[40:43]
  v_exp_f32 v74, v74
  v_mfma_f32_16x16x32_bf16 v[100:103], v[134:137], v[20:23], v[100:103]
  v_exp_f32 v75, v75
  v_mfma_f32_16x16x32_bf16 v[104:107], v[176:179], v[140:143], v[36:39]
  v_cvt_pk_bf16_f32 v84, v84, v85
  v_cvt_pk_bf16_f32 v85, v86, v87
  v_mfma_f32_16x16x32_bf16 v[104:107], v[178:181], v[20:23], v[104:107]
  v_cvt_pk_bf16_f32 v110, v128, v129
  v_cvt_pk_bf16_f32 v111, v130, v131
  v_mfma_f32_16x16x32_bf16 v[132:135], v[120:123], v[140:143], v[48:51]
  v_cvt_pk_bf16_f32 v86, v88, v89
  v_cvt_pk_bf16_f32 v87, v90, v91
  v_mfma_f32_16x16x32_bf16 v[132:135], v[122:125], v[20:23], v[132:135]
  v_cvt_pk_bf16_f32 v88, v68, v69
  v_cvt_pk_bf16_f32 v89, v70, v71
  v_mfma_f32_16x16x32_bf16 v[128:131], v[144:147], v[140:143], v[44:47]
  v_cvt_pk_bf16_f32 v90, v72, v73
  v_cvt_pk_bf16_f32 v91, v74, v75
  v_mfma_f32_16x16x32_bf16 v[128:131], v[146:149], v[20:23], v[128:131]
L_hop_2_0:
  s_cbranch_execz L_hop_2_1
  ds_read_b128 v[136:139], v3 offset:0
  ds_read_b128 v[140:143], v3 offset:4096
  v_mfma_f32_16x16x32_bf16 v[176:179], a[252:255], a[208:211], 0
  ds_read_b128 v[68:71], v3 offset:8192
  ds_read_b128 v[72:75], v3 offset:12288
  v_mfma_f32_16x16x32_bf16 v[176:179], v[152:155], a[196:199], v[176:179]
  ds_read_b128 v[120:123], v3 offset:16384
  ds_read_b128 v[124:127], v3 offset:20480
  v_mfma_f32_16x16x32_bf16 v[176:179], a[244:247], a[184:187], v[176:179]
  v_exp_f32 v76, v76
  v_mfma_f32_16x16x32_bf16 v[176:179], a[248:251], a[172:175], v[176:179]
  v_exp_f32 v77, v77
  v_mfma_f32_16x16x32_bf16 v[176:179], v[172:175], a[160:163], v[176:179]
  v_exp_f32 v78, v78
  v_mfma_f32_16x16x32_bf16 v[176:179], v[168:171], a[148:151], v[176:179]
  v_exp_f32 v79, v79
  v_mfma_f32_16x16x32_bf16 v[164:167], v[168:171], a[152:155], 0
  v_exp_f32 v80, v80
  v_mfma_f32_16x16x32_bf16 v[164:167], v[172:175], a[164:167], v[164:167]
  v_exp_f32 v81, v81
  v_mfma_f32_16x16x32_bf16 v[164:167], a[248:251], a[176:179], v[164:167]
  v_exp_f32 v82, v82
  v_mfma_f32_16x16x32_bf16 v[164:167], a[244:247], a[188:191], v[164:167]
  v_exp_f32 v83, v83
  v_mfma_f32_16x16x32_bf16 v[164:167], v[152:155], a[200:203], v[164:167]
  v_cvt_pk_bf16_f32 v114, v176, v177
  v_cvt_pk_bf16_f32 v115, v178, v179
  v_mfma_f32_16x16x32_bf16 v[164:167], a[252:255], a[212:215], v[164:167]
  v_add_u32 v0, s28, v2
  v_xor_b32 v1, 64, v0
  s_waitcnt lgkmcnt(0)
  s_nop 1
L_loop:
  v_mfma_f32_16x16x32_bf16 v[148:151], v[136:139], v[184:187], 0
  v_exp_f32 v160, v160
  v_mfma_f32_16x16x32_bf16 v[148:151], v[140:143], v[200:203], v[148:151]
  v_exp_f32 v161, v161
  v_mfma_f32_16x16x32_bf16 v[148:151], v[68:71], v[216:219], v[148:151]
  v_cvt_pk_bf16_f32 v118, v164, v165
  v_cvt_pk_bf16_f32 v119, v166, v167
  v_mfma_f32_16x16x32_bf16 v[148:151], v[72:75], v[232:235], v[148:151]
  v_exp_f32 v162, v162
  v_mfma_f32_16x16x32_bf16 v[148:151], v[120:123], v[248:251], v[148:151]
  v_exp_f32 v163, v163
  v_mfma_f32_16x16x32_bf16 v[148:151], v[124:127], a[224:227], v[148:151]
  v_exp_f32 v156, v156
  v_mfma_f32_16x16x32_bf16 v[172:175], v[124:127], a[228:231], 0
  v_exp_f32 v157, v157
  v_mfma_f32_16x16x32_bf16 v[172:175], v[120:123], v[252:255], v[172:175]
  v_exp_f32 v158, v158
  v_mfma_f32_16x16x32_bf16 v[172:175], v[72:75], v[236:239], v[172:175]
  ds_read_b128 v[144:147], v4 offset:0
  v_cvt_pk_bf16_f32 v76, v76, v77
  v_mfma_f32_16x16x32_bf16 v[172:175], v[68:71], v[220:223], v[172:175]
  ds_read_b128 v[176:179], v4 offset:4096
  v_cvt_pk_bf16_f32 v77, v78, v79
  v_mfma_f32_16x16x32_bf16 v[172:175], v[140:143], v[204:207], v[172:175]
  ds_read_b128 v[152:155], v4 offset:8192
  v_cvt_pk_bf16_f32 v78, v80, v81
  v_mfma_f32_16x16x32_bf16 v[172:175], v[136:139], v[188:191], v[172:175]
  ds_read_b128 v[180:183], v4 offset:12288
  v_cvt_pk_bf16_f32 v79, v82, v83
  v_mfma_f32_16x16x32_bf16 v[168:171], v[136:139], v[192:195], 0
  ds_read_b128 v[164:167], v4 offset:16384
  v_cvt_pk_bf16_f32 v80, v160, v161
  v_mfma_f32_16x16x32_bf16 v[168:171], v[140:143], v[208:211], v[168:171]
  ds_read_b128 a[252:255], v4 offset:20480
  v_cvt_pk_bf16_f32 v81, v162, v163
  v_mfma_f32_16x16x32_bf16 v[168:171], v[68:71], v[224:227], v[168:171]
  v_cvt_pk_bf16_f32 v148, v148, v172
  v_cvt_pk_bf16_f32 v149, v149, v173
  v_mfma_f32_16x16x32_bf16 v[168:171], v[72:75], v[240:243], v[168:171]
  v_cvt_pk_bf16_f32 v150, v150, v174
  v_cvt_pk_bf16_f32 v151, v151, v175
  v_mfma_f32_16x16x32_bf16 v[168:171], v[120:123], a[216:219], v[168:171]
  buffer_store_dword v148, v7, s[24:27], s33 offen offset:0 nt
  v_mfma_f32_16x16x32_bf16 v[168:171], v[124:127], a[232:235], v[168:171]
  v_exp_f32 v159, v159
  v_mfma_f32_16x16x32_bf16 v[160:163], v[124:127], a[236:239], 0
  v_cvt_pk_bf16_f32 v82, v156, v157
  v_cvt_pk_bf16_f32 v83, v158, v159
  v_mfma_f32_16x16x32_bf16 v[160:163], v[120:123], a[220:223], v[160:163]
  buffer_store_dword v149, v7, s[24:27], s33 offen offset:384 nt
  v_mfma_f32_16x16x32_bf16 v[160:163], v[72:75], v[244:247], v[160:163]
  ds_read_b128 a[244:247], v3 offset:512
  v_mfma_f32_16x16x32_bf16 v[160:163], v[68:71], v[228:231], v[160:163]
  ds_read_b128 a[248:251], v3 offset:4608
  v_mfma_f32_16x16x32_bf16 v[160:163], v[140:143], v[212:215], v[160:163]
  buffer_store_dword v150, v7, s[24:27], s33 offen offset:768 nt
  v_mfma_f32_16x16x32_bf16 v[160:163], v[136:139], v[196:199], v[160:163]
  s_waitcnt lgkmcnt(2)
  ds_read_b128 v[172:175], v3 offset:8704
  v_mfma_f32_16x16x32_bf16 v[124:127], v[144:147], v[184:187], 0
  ds_read_b128 v[68:71], v3 offset:12800
  v_mfma_f32_16x16x32_bf16 v[124:127], v[176:179], v[200:203], v[124:127]
  buffer_store_dword v151, v7, s[24:27], s33 offen offset:1152 nt
  v_mfma_f32_16x16x32_bf16 v[124:127], v[152:155], v[216:219], v[124:127]
  v_cvt_pk_bf16_f32 v168, v168, v160
  v_cvt_pk_bf16_f32 v169, v169, v161
  v_mfma_f32_16x16x32_bf16 v[124:127], v[180:183], v[232:235], v[124:127]
  v_cvt_pk_bf16_f32 v170, v170, v162
  v_cvt_pk_bf16_f32 v171, v171, v163
  v_mfma_f32_16x16x32_bf16 v[124:127], v[164:167], v[248:251], v[124:127]
  buffer_store_dword v168, v8, s[24:27], s33 offen offset:0 nt
  v_mfma_f32_16x16x32_bf16 v[124:127], a[252:255], a[224:227], v[124:127]
  ds_read_b128 v[72:75], v3 offset:16896
  v_mfma_f32_16x16x32_bf16 v[120:123], a[252:255], a[228:231], 0
  ds_read_b128 v[148:151], v3 offset:20992
  v_xor_b32 v3, 40960, v3
  v_mfma_f32_16x16x32_bf16 v[120:123], v[164:167], v[252:255], v[120:123]
  buffer_store_dword v169, v8, s[24:27], s33 offen offset:384 nt
  v_mfma_f32_16x16x32_bf16 v[120:123], v[180:183], v[236:239], v[120:123]
  v_exp_f32 v100, v100
  v_mfma_f32_16x16x32_bf16 v[120:123], v[152:155], v[220:223], v[120:123]
  v_exp_f32 v101, v101
  v_mfma_f32_16x16x32_bf16 v[120:123], v[176:179], v[204:207], v[120:123]
  buffer_store_dword v170, v8, s[24:27], s33 offen offset:768 nt
  v_mfma_f32_16x16x32_bf16 v[120:123], v[144:147], v[188:191], v[120:123]
  s_waitcnt lgkmcnt(0)
  v_exp_f32 v102, v102
  v_mfma_f32_16x16x32_bf16 v[136:139], a[244:247], v[184:187], 0
  v_exp_f32 v103, v103
  v_mfma_f32_16x16x32_bf16 v[136:139], a[248:251], v[200:203], v[136:139]
  buffer_store_dword v171, v8, s[24:27], s33 offen offset:1152 nt
  v_mfma_f32_16x16x32_bf16 v[136:139], v[172:175], v[216:219], v[136:139]
  v_cvt_pk_bf16_f32 v124, v124, v120
  v_cvt_pk_bf16_f32 v125, v125, v121
  v_mfma_f32_16x16x32_bf16 v[136:139], v[68:71], v[232:235], v[136:139]
  v_cvt_pk_bf16_f32 v126, v126, v122
  v_cvt_pk_bf16_f32 v127, v127, v123
  v_mfma_f32_16x16x32_bf16 v[136:139], v[72:75], v[248:251], v[136:139]
  buffer_store_dword v124, v7, s[24:27], s34 offen offset:0 nt
  v_mfma_f32_16x16x32_bf16 v[136:139], v[148:151], a[224:227], v[136:139]
  v_exp_f32 v104, v104
  v_mfma_f32_16x16x32_bf16 v[160:163], v[148:151], a[228:231], 0
  v_exp_f32 v105, v105
  v_mfma_f32_16x16x32_bf16 v[160:163], v[72:75], v[252:255], v[160:163]
  buffer_store_dword v125, v7, s[24:27], s34 offen offset:384 nt
  v_mfma_f32_16x16x32_bf16 v[160:163], v[68:71], v[236:239], v[160:163]
  ds_read_b128 v[120:123], v4 offset:512
  v_cvt_pk_bf16_f32 v100, v100, v101
  v_mfma_f32_16x16x32_bf16 v[160:163], v[172:175], v[220:223], v[160:163]
  ds_read_b128 v[140:143], v4 offset:4608
  v_cvt_pk_bf16_f32 v101, v102, v103
  v_mfma_f32_16x16x32_bf16 v[160:163], a[248:251], v[204:207], v[160:163]
  buffer_store_dword v126, v7, s[24:27], s34 offen offset:768 nt
  v_mfma_f32_16x16x32_bf16 v[160:163], a[244:247], v[188:191], v[160:163]
  ds_read_b128 v[152:155], v4 offset:8704
  v_cvt_pk_bf16_f32 v102, v104, v105
  v_mfma_f32_16x16x32_bf16 v[144:147], a[244:247], v[192:195], 0
  ds_read_b128 v[156:159], v4 offset:12800
  v_mfma_f32_16x16x32_bf16 v[144:147], a[248:251], v[208:211], v[144:147]
  buffer_store_dword v127, v7, s[24:27], s34 offen offset:1152 nt
  v_mfma_f32_16x16x32_bf16 v[144:147], v[172:175], v[224:227], v[144:147]
  v_cvt_pk_bf16_f32 v136, v136, v160
  v_cvt_pk_bf16_f32 v137, v137, v161
  v_mfma_f32_16x16x32_bf16 v[144:147], v[68:71], v[240:243], v[144:147]
  v_cvt_pk_bf16_f32 v138, v138, v162
  v_cvt_pk_bf16_f32 v139, v139, v163
  v_mfma_f32_16x16x32_bf16 v[144:147], v[72:75], a[216:219], v[144:147]
  buffer_store_dword v136, v7, s[24:27], s35 offen offset:0 nt
  v_mfma_f32_16x16x32_bf16 v[144:147], v[148:151], a[232:235], v[144:147]
  ds_read_b128 v[160:163], v4 offset:16896
  v_mfma_f32_16x16x32_bf16 v[168:171], v[148:151], a[236:239], 0
  ds_read_b128 v[164:167], v4 offset:20992
  v_xor_b32 v4, 40960, v4
  v_mfma_f32_16x16x32_bf16 v[168:171], v[72:75], a[220:223], v[168:171]
  buffer_store_dword v137, v7, s[24:27], s35 offen offset:384 nt
  v_mfma_f32_16x16x32_bf16 v[168:171], v[68:71], v[244:247], v[168:171]
  v_exp_f32 v106, v106
  v_mfma_f32_16x16x32_bf16 v[168:171], v[172:175], v[228:231], v[168:171]
  v_exp_f32 v107, v107
  v_mfma_f32_16x16x32_bf16 v[168:171], a[248:251], v[212:215], v[168:171]
  buffer_store_dword v138, v7, s[24:27], s35 offen offset:768 nt
  v_mfma_f32_16x16x32_bf16 v[168:171], a[244:247], v[196:199], v[168:171]
  s_waitcnt lgkmcnt(0)
  v_exp_f32 v132, v132
  v_mfma_f32_16x16x32_bf16 v[124:127], v[120:123], v[184:187], 0
  v_exp_f32 v133, v133
  v_mfma_f32_16x16x32_bf16 v[124:127], v[140:143], v[200:203], v[124:127]
  buffer_store_dword v139, v7, s[24:27], s35 offen offset:1152 nt
  v_mfma_f32_16x16x32_bf16 v[124:127], v[152:155], v[216:219], v[124:127]
  v_cvt_pk_bf16_f32 v144, v144, v168
  v_cvt_pk_bf16_f32 v145, v145, v169
  v_mfma_f32_16x16x32_bf16 v[124:127], v[156:159], v[232:235], v[124:127]
  v_cvt_pk_bf16_f32 v146, v146, v170
  v_cvt_pk_bf16_f32 v147, v147, v171
  v_mfma_f32_16x16x32_bf16 v[124:127], v[160:163], v[248:251], v[124:127]
  buffer_store_dword v144, v8, s[24:27], s35 offen offset:0 nt
  v_mfma_f32_16x16x32_bf16 v[124:127], v[164:167], a[224:227], v[124:127]
  v_mov_b64 v[172:173], 0
  v_cvt_pk_bf16_f32 v103, v106, v107
  v_mfma_f32_16x16x32_bf16 v[136:139], v[164:167], a[228:231], 0
  v_exp_f32 v134, v134
  v_mfma_f32_16x16x32_bf16 v[136:139], v[160:163], v[252:255], v[136:139]
  buffer_store_dword v145, v8, s[24:27], s35 offen offset:384 nt
  v_mfma_f32_16x16x32_bf16 v[136:139], v[156:159], v[236:239], v[136:139]
  v_exp_f32 v135, v135
  v_mfma_f32_16x16x32_bf16 v[136:139], v[152:155], v[220:223], v[136:139]
  v_mov_b64 v[72:73], 0
  v_cvt_pk_bf16_f32 v104, v132, v133
  v_mfma_f32_16x16x32_bf16 v[136:139], v[140:143], v[204:207], v[136:139]
  buffer_store_dword v146, v8, s[24:27], s35 offen offset:768 nt
  v_mfma_f32_16x16x32_bf16 v[136:139], v[120:123], v[188:191], v[136:139]
  v_exp_f32 v128, v128
  v_smfmac_f32_16x16x64_bf16 v[172:175], a[240:243], v[92:99], v10
  v_exp_f32 v129, v129
  v_mfma_f32_16x16x32_bf16 v[176:179], v[108:111], v[96:99], 0
  buffer_store_dword v147, v8, s[24:27], s35 offen offset:1152 nt
  v_mfma_f32_16x16x32_bf16 v[176:179], v[56:59], v[92:95], v[176:179]
  v_cvt_pk_bf16_f32 v124, v124, v136
  v_cvt_pk_bf16_f32 v125, v125, v137
  v_mfma_f32_16x16x32_bf16 v[68:71], v[60:63], v[92:95], 0
  v_cvt_pk_bf16_f32 v126, v126, v138
  v_cvt_pk_bf16_f32 v127, v127, v139
  v_mfma_f32_16x16x32_bf16 v[68:71], v[112:115], v[96:99], v[68:71]
  buffer_store_dword v124, v7, s[24:27], s36 offen offset:0 nt
  v_mfma_f32_16x16x32_bf16 v[168:171], v[116:119], v[96:99], 0
  v_mov_b64 v[132:133], 0
  v_cvt_pk_bf16_f32 v105, v134, v135
  v_mfma_f32_16x16x32_bf16 v[168:171], v[64:67], v[92:95], v[168:171]
  v_exp_f32 v130, v130
  v_smfmac_f32_16x16x64_bf16 v[72:75], a[240:243], v[84:91], v10
  buffer_store_dword v125, v7, s[24:27], s36 offen offset:384 nt
  v_mfma_f32_16x16x32_bf16 v[160:163], v[108:111], v[88:91], 0
  v_exp_f32 v131, v131
  v_mfma_f32_16x16x32_bf16 v[160:163], v[56:59], v[84:87], v[160:163]
  v_cvt_pk_bf16_f32 v106, v128, v129
  v_cvt_pk_bf16_f32 v107, v130, v131
  v_mfma_f32_16x16x32_bf16 v[164:167], v[60:63], v[84:87], 0
  buffer_store_dword v126, v7, s[24:27], s36 offen offset:768 nt
  v_mfma_f32_16x16x32_bf16 v[164:167], v[112:115], v[88:91], v[164:167]
  v_mov_b64 v[92:93], 0
  v_add_f32 v172, v172, v173
  v_mfma_f32_16x16x32_bf16 v[156:159], v[116:119], v[88:91], 0
  ds_read_b128 v[128:131], v0 offset:0
  v_add_f32 v72, v72, v73
  v_mfma_f32_16x16x32_bf16 v[156:159], v[64:67], v[84:87], v[156:159]
  buffer_store_dword v127, v7, s[24:27], s36 offen offset:1152 nt
  v_smfmac_f32_16x16x64_bf16 v[132:135], a[240:243], v[76:83], v10
  ds_read_b128 v[144:147], v1 offset:0
  v_cndmask_b32 v7, v7, v52, s[62:63]
  v_mfma_f32_16x16x32_bf16 v[120:123], v[56:59], v[80:83], 0
  ds_read_b128 v[148:151], v0 offset:8192
  v_cndmask_b32 v8, v8, v53, s[62:63]
  v_mfma_f32_16x16x32_bf16 v[120:123], v[108:111], v[76:79], v[120:123]
  s_mov_b64 s[62:63], 0
  ds_read_b128 v[152:155], v1 offset:8192
  v_mfma_f32_16x16x32_bf16 v[124:127], v[112:115], v[76:79], 0
  ds_read_b128 v[140:143], v0 offset:16384
  v_mfma_f32_16x16x32_bf16 v[124:127], v[60:63], v[80:83], v[124:127]
  ds_read_b128 v[136:139], v1 offset:16384
  v_mfma_f32_16x16x32_bf16 v[96:99], v[64:67], v[80:83], 0
  v_rcp_f32 v174, v172
  v_mfma_f32_16x16x32_bf16 v[96:99], v[116:119], v[76:79], v[96:99]
  v_mul_f32 v176, v174, v176
  v_mul_f32 v177, v174, v177
  v_smfmac_f32_16x16x64_bf16 v[92:95], a[240:243], v[100:107], v10
  v_mul_f32 v178, v174, v178
  v_mul_f32 v179, v174, v179
  v_mfma_f32_16x16x32_bf16 v[84:87], v[56:59], v[104:107], 0
  v_cvt_pk_bf16_f32 v176, v176, v177
  v_cvt_pk_bf16_f32 v177, v178, v179
  v_mfma_f32_16x16x32_bf16 v[84:87], v[108:111], v[100:103], v[84:87]
  v_mul_f32 v68, v174, v68
  v_mul_f32 v69, v174, v69
  v_mfma_f32_16x16x32_bf16 v[80:83], v[112:115], v[100:103], 0
  v_mul_f32 v70, v174, v70
  v_mul_f32 v71, v174, v71
  v_mfma_f32_16x16x32_bf16 v[80:83], v[60:63], v[104:107], v[80:83]
  v_cvt_pk_bf16_f32 v68, v68, v69
  v_cvt_pk_bf16_f32 v69, v70, v71
  v_mfma_f32_16x16x32_bf16 v[88:91], v[64:67], v[104:107], 0
  v_mul_f32 v168, v174, v168
  v_mul_f32 v169, v174, v169
  v_mfma_f32_16x16x32_bf16 v[88:91], v[116:119], v[100:103], v[88:91]
  s_waitcnt lgkmcnt(0)
  v_mul_f32 v170, v174, v170
  v_mul_f32 v171, v174, v171
  v_mfma_f32_16x16x32_bf16 v[64:67], a[0:3], v[128:131], 0
  v_cvt_pk_bf16_f32 v168, v168, v169
  v_cvt_pk_bf16_f32 v169, v170, v171
  v_mfma_f32_16x16x32_bf16 v[64:67], a[12:15], v[144:147], v[64:67]
  v_max3_f32 v9, v172, v174, v9
  v_add_f32 v132, v132, v133
  v_mfma_f32_16x16x32_bf16 v[64:67], a[24:27], v[148:151], v[64:67]
  ds_write_b32 v5, v176 offset:0
  v_mfma_f32_16x16x32_bf16 v[64:67], a[36:39], v[152:155], v[64:67]
  ds_write_b32 v5, v177 offset:1024
  v_mfma_f32_16x16x32_bf16 v[64:67], a[48:51], v[140:143], v[64:67]
  s_add_u32 m0, s30, 0
  v_rcp_f32 v74, v72
  v_mfma_f32_16x16x32_bf16 v[64:67], a[60:63], v[136:139], v[64:67]
  buffer_load_dwordx4 v6, s[8:11], s31 offen offset:0 nt lds
  v_mfma_f32_16x16x32_bf16 v[60:63], a[64:67], v[136:139], 0
  v_mul_f32 v160, v74, v160
  v_mul_f32 v161, v74, v161
  v_mfma_f32_16x16x32_bf16 v[60:63], a[52:55], v[140:143], v[60:63]
  ds_write_b32 v5, v68 offset:2048
  v_mfma_f32_16x16x32_bf16 v[60:63], a[40:43], v[152:155], v[60:63]
  v_mul_f32 v64, s42, v64
  v_mul_f32 v65, s42, v65
  v_mfma_f32_16x16x32_bf16 v[60:63], a[28:31], v[148:151], v[60:63]
  v_mul_f32 v66, s42, v66
  v_mul_f32 v67, s42, v67
  v_mfma_f32_16x16x32_bf16 v[60:63], a[16:19], v[144:147], v[60:63]
  v_cvt_pk_bf16_f32 v12, v64, v65
  v_cvt_pk_bf16_f32 v13, v66, v67
  v_mfma_f32_16x16x32_bf16 v[60:63], a[4:7], v[128:131], v[60:63]
  ds_write_b32 v5, v69 offset:3072
  v_mfma_f32_16x16x32_bf16 v[56:59], a[8:11], v[128:131], 0
  ds_write_b32 v5, v168 offset:4096
  v_mfma_f32_16x16x32_bf16 v[56:59], a[20:23], v[144:147], v[56:59]
  ds_write_b32 v5, v169 offset:5120
  v_mfma_f32_16x16x32_bf16 v[56:59], a[32:35], v[148:151], v[56:59]
  v_mul_f32 v60, s42, v60
  v_mul_f32 v61, s42, v61
  v_mfma_f32_16x16x32_bf16 v[56:59], a[44:47], v[152:155], v[56:59]
  v_mul_f32 v62, s42, v62
  v_mul_f32 v63, s42, v63
  v_mfma_f32_16x16x32_bf16 v[56:59], a[56:59], v[140:143], v[56:59]
  s_add_u32 m0, s30, 8064
  v_cvt_pk_bf16_f32 v76, v60, v61
  v_cvt_pk_bf16_f32 v77, v62, v63
  v_mfma_f32_16x16x32_bf16 v[56:59], a[68:71], v[136:139], v[56:59]
  buffer_load_dwordx4 v6, s[8:11], s31 offen offset:128 nt lds
  v_mfma_f32_16x16x32_bf16 v[64:67], a[132:135], v[136:139], 0
  v_mul_f32 v162, v74, v162
  v_mul_f32 v163, v74, v163
  v_mfma_f32_16x16x32_bf16 v[64:67], a[120:123], v[140:143], v[64:67]
  v_cvt_pk_bf16_f32 v160, v160, v161
  v_cvt_pk_bf16_f32 v161, v162, v163
  v_mfma_f32_16x16x32_bf16 v[64:67], a[108:111], v[152:155], v[64:67]
  v_mul_f32 v56, s42, v56
  v_mul_f32 v57, s42, v57
  v_mfma_f32_16x16x32_bf16 v[64:67], a[96:99], v[148:151], v[64:67]
  v_mul_f32 v58, s42, v58
  v_mul_f32 v59, s42, v59
  v_mfma_f32_16x16x32_bf16 v[64:67], a[84:87], v[144:147], v[64:67]
  v_cvt_pk_bf16_f32 v78, v56, v57
  v_cvt_pk_bf16_f32 v79, v58, v59
  v_mfma_f32_16x16x32_bf16 v[64:67], a[72:75], v[128:131], v[64:67]
  v_mul_f32 v164, v74, v164
  v_mul_f32 v165, v74, v165
  v_mfma_f32_16x16x32_bf16 v[56:59], a[76:79], v[128:131], 0
  v_mul_f32 v166, v74, v166
  v_mul_f32 v167, v74, v167
  v_mfma_f32_16x16x32_bf16 v[56:59], a[88:91], v[144:147], v[56:59]
  v_cvt_pk_bf16_f32 v164, v164, v165
  v_cvt_pk_bf16_f32 v165, v166, v167
  v_mfma_f32_16x16x32_bf16 v[56:59], a[100:103], v[148:151], v[56:59]
  v_cvt_pk_bf16_f32 v68, v64, v65
  v_cvt_pk_bf16_f32 v69, v66, v67
  v_mfma_f32_16x16x32_bf16 v[56:59], a[112:115], v[152:155], v[56:59]
  v_mul_f32 v156, v74, v156
  v_mul_f32 v157, v74, v157
  v_mfma_f32_16x16x32_bf16 v[56:59], a[124:127], v[140:143], v[56:59]
  s_add_u32 m0, s30, 16128
  v_mul_f32 v158, v74, v158
  v_mul_f32 v159, v74, v159
  v_mfma_f32_16x16x32_bf16 v[56:59], a[136:139], v[136:139], v[56:59]
  buffer_load_dwordx4 v6, s[8:11], s31 offen offset:256 nt lds
  v_mfma_f32_16x16x32_bf16 v[60:63], a[140:143], v[136:139], 0
  v_cvt_pk_bf16_f32 v156, v156, v157
  v_cvt_pk_bf16_f32 v157, v158, v159
  v_mfma_f32_16x16x32_bf16 v[60:63], a[128:131], v[140:143], v[60:63]
  v_max3_f32 v9, v72, v74, v9
  v_add_f32 v92, v92, v93
  v_mfma_f32_16x16x32_bf16 v[60:63], a[116:119], v[152:155], v[60:63]
  v_cvt_pk_bf16_f32 v70, v56, v57
  v_cvt_pk_bf16_f32 v71, v58, v59
  v_mfma_f32_16x16x32_bf16 v[60:63], a[104:107], v[148:151], v[60:63]
  ds_write_b32 v5, v160 offset:256
  v_mfma_f32_16x16x32_bf16 v[60:63], a[92:95], v[144:147], v[60:63]
  ds_write_b32 v5, v161 offset:1280
  v_mfma_f32_16x16x32_bf16 v[60:63], a[80:83], v[128:131], v[60:63]
  ds_write_b32 v5, v164 offset:2304
  v_mfma_f32_16x16x32_bf16 v[64:67], v[128:131], a[144:147], 0
  ds_write_b32 v5, v165 offset:3328
  v_mfma_f32_16x16x32_bf16 v[64:67], v[144:147], a[156:159], v[64:67]
  ds_write_b32 v5, v156 offset:4352
  v_mfma_f32_16x16x32_bf16 v[64:67], v[148:151], a[168:171], v[64:67]
  v_cvt_pk_bf16_f32 v72, v60, v61
  v_cvt_pk_bf16_f32 v73, v62, v63
  v_mfma_f32_16x16x32_bf16 v[64:67], v[152:155], a[180:183], v[64:67]
  ds_read_b128 a[244:247], v0 offset:2048
  v_mfma_f32_16x16x32_bf16 v[64:67], v[140:143], a[192:195], v[64:67]
  s_add_u32 m0, s30, 4096
  ds_read_b128 a[248:251], v1 offset:2048
  v_mfma_f32_16x16x32_bf16 v[64:67], v[136:139], a[204:207], v[64:67]
  buffer_load_dwordx4 v6, s[8:11], s32 offen offset:0 nt lds
  v_mfma_f32_16x16x32_bf16 v[116:119], v[136:139], a[208:211], 0
  ds_read_b128 a[252:255], v0 offset:10240
  v_mfma_f32_16x16x32_bf16 v[116:119], v[140:143], a[196:199], v[116:119]
  ds_write_b32 v5, v157 offset:5376
  v_mfma_f32_16x16x32_bf16 v[116:119], v[152:155], a[184:187], v[116:119]
  v_cvt_pk_bf16_f32 v56, v64, v65
  v_cvt_pk_bf16_f32 v57, v66, v67
  v_mfma_f32_16x16x32_bf16 v[116:119], v[148:151], a[172:175], v[116:119]
  ds_read_b128 v[112:115], v1 offset:10240
  v_mfma_f32_16x16x32_bf16 v[116:119], v[144:147], a[160:163], v[116:119]
  ds_read_b128 v[104:107], v0 offset:18432
  v_mfma_f32_16x16x32_bf16 v[116:119], v[128:131], a[148:151], v[116:119]
  ds_read_b128 v[108:111], v1 offset:18432
  v_mfma_f32_16x16x32_bf16 v[100:103], v[128:131], a[152:155], 0
  v_rcp_f32 v134, v132
  v_mfma_f32_16x16x32_bf16 v[100:103], v[144:147], a[164:167], v[100:103]
  v_mul_f32 v120, v134, v120
  v_mul_f32 v121, v134, v121
  v_mfma_f32_16x16x32_bf16 v[100:103], v[148:151], a[176:179], v[100:103]
  v_cvt_pk_bf16_f32 v60, v116, v117
  v_cvt_pk_bf16_f32 v61, v118, v119
  v_mfma_f32_16x16x32_bf16 v[100:103], v[152:155], a[188:191], v[100:103]
  s_waitcnt lgkmcnt(0)
  v_mul_f32 v122, v134, v122
  v_mul_f32 v123, v134, v123
  v_mfma_f32_16x16x32_bf16 v[100:103], v[140:143], a[200:203], v[100:103]
  s_add_u32 m0, s30, 12160
  v_cvt_pk_bf16_f32 v120, v120, v121
  v_cvt_pk_bf16_f32 v121, v122, v123
  v_mfma_f32_16x16x32_bf16 v[100:103], v[136:139], a[212:215], v[100:103]
  buffer_load_dwordx4 v6, s[8:11], s32 offen offset:128 nt lds
  v_mfma_f32_16x16x32_bf16 v[140:143], a[0:3], a[244:247], 0
  v_mul_f32 v124, v134, v124
  v_mul_f32 v125, v134, v125
  v_mfma_f32_16x16x32_bf16 v[140:143], a[12:15], a[248:251], v[140:143]
  v_mul_f32 v126, v134, v126
  v_mul_f32 v127, v134, v127
  v_mfma_f32_16x16x32_bf16 v[140:143], a[24:27], a[252:255], v[140:143]
  v_cvt_pk_bf16_f32 v64, v100, v101
  v_cvt_pk_bf16_f32 v65, v102, v103
  v_mfma_f32_16x16x32_bf16 v[140:143], a[36:39], v[112:115], v[140:143]
  v_cvt_pk_bf16_f32 v124, v124, v125
  v_cvt_pk_bf16_f32 v125, v126, v127
  v_mfma_f32_16x16x32_bf16 v[140:143], a[48:51], v[104:107], v[140:143]
  v_mul_f32 v96, v134, v96
  v_mul_f32 v97, v134, v97
  v_mfma_f32_16x16x32_bf16 v[140:143], a[60:63], v[108:111], v[140:143]
  v_mul_f32 v98, v134, v98
  v_mul_f32 v99, v134, v99
  v_mfma_f32_16x16x32_bf16 v[128:131], a[64:67], v[108:111], 0
  v_cvt_pk_bf16_f32 v96, v96, v97
  v_cvt_pk_bf16_f32 v97, v98, v99
  v_mfma_f32_16x16x32_bf16 v[128:131], a[52:55], v[104:107], v[128:131]
  v_max3_f32 v9, v132, v134, v9
  v_mfma_f32_16x16x32_bf16 v[128:131], a[40:43], v[112:115], v[128:131]
  v_mul_f32 v140, s42, v140
  v_mul_f32 v141, s42, v141
  v_mfma_f32_16x16x32_bf16 v[128:131], a[28:31], a[252:255], v[128:131]
  v_mul_f32 v142, s42, v142
  v_mul_f32 v143, s42, v143
  v_mfma_f32_16x16x32_bf16 v[128:131], a[16:19], a[248:251], v[128:131]
  s_add_u32 m0, s30, 20224
  v_cvt_pk_bf16_f32 v100, v140, v141
  v_cvt_pk_bf16_f32 v101, v142, v143
  v_mfma_f32_16x16x32_bf16 v[128:131], a[4:7], a[244:247], v[128:131]
  buffer_load_dwordx4 v6, s[8:11], s32 offen offset:256 nt lds
  v_mfma_f32_16x16x32_bf16 v[116:119], a[8:11], a[244:247], 0
  s_add_u32 s33, s31, s37
  v_rcp_f32 v94, v92
  v_mfma_f32_16x16x32_bf16 v[116:119], a[20:23], a[248:251], v[116:119]
  s_add_u32 s34, s31, s38
  ds_write_b32 v5, v120 offset:512
  v_mfma_f32_16x16x32_bf16 v[116:119], a[32:35], a[252:255], v[116:119]
  s_add_u32 s35, s31, s39
  v_mul_f32 v128, s42, v128
  v_mul_f32 v129, s42, v129
  v_mfma_f32_16x16x32_bf16 v[116:119], a[44:47], v[112:115], v[116:119]
  s_add_u32 s36, s31, s40
  v_mul_f32 v130, s42, v130
  v_mul_f32 v131, s42, v131
  v_mfma_f32_16x16x32_bf16 v[116:119], a[56:59], v[104:107], v[116:119]
  s_add_u32 s31, s31, s43
  v_cvt_pk_bf16_f32 v102, v128, v129
  v_cvt_pk_bf16_f32 v103, v130, v131
  v_mfma_f32_16x16x32_bf16 v[116:119], a[68:71], v[108:111], v[116:119]
  s_add_u32 s32, s32, s43
  ds_write_b32 v5, v121 offset:1536
  v_mfma_f32_16x16x32_bf16 v[128:131], a[132:135], v[108:111], 0
  s_mov_b32 s5, s28
  ds_write_b32 v5, v124 offset:2560
  v_mfma_f32_16x16x32_bf16 v[128:131], a[120:123], v[104:107], v[128:131]
  s_mov_b32 s28, s29
  ds_write_b32 v5, v125 offset:3584
  v_mfma_f32_16x16x32_bf16 v[128:131], a[108:111], v[112:115], v[128:131]
  s_mov_b32 s29, s30
  ds_write_b32 v5, v96 offset:4608
  v_mfma_f32_16x16x32_bf16 v[128:131], a[96:99], a[252:255], v[128:131]
  s_mov_b32 s30, s5
  ds_write_b32 v5, v97 offset:5632
  v_mfma_f32_16x16x32_bf16 v[128:131], a[84:87], a[248:251], v[128:131]
  v_mul_f32 v116, s42, v116
  v_mul_f32 v117, s42, v117
  v_mfma_f32_16x16x32_bf16 v[128:131], a[72:75], a[244:247], v[128:131]
  v_mul_f32 v118, s42, v118
  v_mul_f32 v119, s42, v119
  v_mfma_f32_16x16x32_bf16 v[96:99], a[76:79], a[244:247], 0
  v_cvt_pk_bf16_f32 v16, v116, v117
  v_cvt_pk_bf16_f32 v17, v118, v119
  v_mfma_f32_16x16x32_bf16 v[96:99], a[88:91], a[248:251], v[96:99]
  v_mul_f32 v84, v94, v84
  v_mul_f32 v85, v94, v85
  v_mfma_f32_16x16x32_bf16 v[96:99], a[100:103], a[252:255], v[96:99]
  s_add_u32 s59, s59, 1
  v_cvt_pk_bf16_f32 v120, v128, v129
  v_cvt_pk_bf16_f32 v121, v130, v131
  v_mfma_f32_16x16x32_bf16 v[96:99], a[112:115], v[112:115], v[96:99]
  s_cmp_eq_u32 s59, 4
  v_mul_f32 v86, v94, v86
  v_mul_f32 v87, v94, v87
  v_mfma_f32_16x16x32_bf16 v[96:99], a[124:127], v[104:107], v[96:99]
  s_cselect_b32 s18, s16, s18
  v_cvt_pk_bf16_f32 v84, v84, v85
  v_cvt_pk_bf16_f32 v85, v86, v87
  v_mfma_f32_16x16x32_bf16 v[96:99], a[136:139], v[108:111], v[96:99]
  s_cselect_b32 s15, s60, s15
  v_mul_f32 v80, v94, v80
  v_mul_f32 v81, v94, v81
  v_mfma_f32_16x16x32_bf16 v[116:119], a[140:143], v[108:111], 0
  s_cmp_eq_u32 s59, 8
  v_mul_f32 v82, v94, v82
  v_mul_f32 v83, v94, v83
  v_mfma_f32_16x16x32_bf16 v[116:119], a[128:131], v[104:107], v[116:119]
  s_cselect_b32 s19, s16, s19
  v_cvt_pk_bf16_f32 v80, v80, v81
  v_cvt_pk_bf16_f32 v81, v82, v83
  v_mfma_f32_16x16x32_bf16 v[116:119], a[116:119], v[112:115], v[116:119]
  s_cselect_b32 s99, s60, s99
  v_cvt_pk_bf16_f32 v122, v96, v97
  v_cvt_pk_bf16_f32 v123, v98, v99
  v_mfma_f32_16x16x32_bf16 v[116:119], a[104:107], a[252:255], v[116:119]
  s_memrealtime s[16:17]
  v_mul_f32 v88, v94, v88
  v_mul_f32 v89, v94, v89
  v_mfma_f32_16x16x32_bf16 v[116:119], a[92:95], a[248:251], v[116:119]
  s_memtime s[60:61]
  v_mul_f32 v90, v94, v90
  v_mul_f32 v91, v94, v91
  v_mfma_f32_16x16x32_bf16 v[116:119], a[80:83], a[244:247], v[116:119]
  v_cvt_pk_bf16_f32 v88, v88, v89
  v_cvt_pk_bf16_f32 v89, v90, v91
  v_mfma_f32_16x16x32_bf16 v[132:135], a[244:247], a[144:147], 0
  v_max3_f32 v9, v92, v94, v9
  v_mfma_f32_16x16x32_bf16 v[132:135], a[248:251], a[156:159], v[132:135]
  ds_write_b32 v5, v84 offset:768
  v_mfma_f32_16x16x32_bf16 v[132:135], a[252:255], a[168:171], v[132:135]
  v_cvt_pk_bf16_f32 v124, v116, v117
  v_cvt_pk_bf16_f32 v125, v118, v119
  v_mfma_f32_16x16x32_bf16 v[132:135], v[112:115], a[180:183], v[132:135]
  ds_read_b128 v[92:95], v0 offset:4096
  v_mfma_f32_16x16x32_bf16 v[132:135], v[104:107], a[192:195], v[132:135]
  ds_read_b128 v[96:99], v1 offset:4096
  v_mfma_f32_16x16x32_bf16 v[132:135], v[108:111], a[204:207], v[132:135]
  ds_read_b128 v[136:139], v0 offset:12288
  v_mfma_f32_16x16x32_bf16 v[128:131], v[108:111], a[208:211], 0
  ds_read_b128 v[116:119], v1 offset:12288
  v_mfma_f32_16x16x32_bf16 v[128:131], v[104:107], a[196:199], v[128:131]
  ds_write_b32 v5, v85 offset:1792
  v_mfma_f32_16x16x32_bf16 v[128:131], v[112:115], a[184:187], v[128:131]
  v_cvt_pk_bf16_f32 v58, v132, v133
  v_cvt_pk_bf16_f32 v59, v134, v135
  v_mfma_f32_16x16x32_bf16 v[128:131], a[252:255], a[172:175], v[128:131]
  ds_write_b32 v5, v80 offset:2816
  v_mfma_f32_16x16x32_bf16 v[128:131], a[248:251], a[160:163], v[128:131]
  ds_write_b32 v5, v81 offset:3840
  v_mfma_f32_16x16x32_bf16 v[128:131], a[244:247], a[148:151], v[128:131]
  ds_write_b32 v5, v88 offset:4864
  v_mfma_f32_16x16x32_bf16 v[132:135], a[244:247], a[152:155], 0
  ds_write_b32 v5, v89 offset:5888
  v_mfma_f32_16x16x32_bf16 v[132:135], a[248:251], a[164:167], v[132:135]
  ds_read_b128 v[80:83], v0 offset:20480
  v_xor_b32 v5, s41, v5
  v_mfma_f32_16x16x32_bf16 v[132:135], a[252:255], a[176:179], v[132:135]
  ds_read_b128 v[84:87], v1 offset:20480
  v_cvt_pk_bf16_f32 v62, v128, v129
  v_mfma_f32_16x16x32_bf16 v[132:135], v[112:115], a[188:191], v[132:135]
  s_waitcnt lgkmcnt(7)
  v_cvt_pk_bf16_f32 v63, v130, v131
  v_mfma_f32_16x16x32_bf16 v[132:135], v[104:107], a[200:203], v[132:135]
  s_bitcmp1_b32 s96, s59
  v_mfma_f32_16x16x32_bf16 v[132:135], v[108:111], a[212:215], v[132:135]
  s_cbranch_scc1 L_k2
L_k2r:
  v_mfma_f32_16x16x32_bf16 v[104:107], a[0:3], v[92:95], 0
L_hop_3_0:
  s_cbranch_execz L_hop_3_1
L_r208:
  v_mfma_f32_16x16x32_bf16 v[104:107], a[12:15], v[96:99], v[104:107]
L_r209:
  v_mfma_f32_16x16x32_bf16 v[104:107], a[24:27], v[136:139], v[104:107]
  v_cvt_pk_bf16_f32 v66, v132, v133
  v_cvt_pk_bf16_f32 v67, v134, v135
L_r210:
  v_mfma_f32_16x16x32_bf16 v[104:107], a[36:39], v[116:119], v[104:107]
  s_waitcnt lgkmcnt(0)
L_r211:
  v_mfma_f32_16x16x32_bf16 v[104:107], a[48:51], v[80:83], v[104:107]
L_r212:
  v_mfma_f32_16x16x32_bf16 v[104:107], a[60:63], v[84:87], v[104:107]
L_r213:
  v_mfma_f32_16x16x32_bf16 v[88:91], a[64:67], v[84:87], 0
L_r214:
  v_mfma_f32_16x16x32_bf16 v[88:91], a[52:55], v[80:83], v[88:91]
L_r215:
  v_mfma_f32_16x16x32_bf16 v[88:91], a[40:43], v[116:119], v[88:91]
  v_mul_f32 v104, s42, v104
  v_mul_f32 v105, s42, v105
L_r216:
  v_mfma_f32_16x16x32_bf16 v[88:91], a[28:31], v[136:139], v[88:91]
  v_mul_f32 v106, s42, v106
  v_mul_f32 v107, s42, v107
L_r217:
  v_mfma_f32_16x16x32_bf16 v[88:91], a[16:19], v[96:99], v[88:91]
  v_cvt_pk_bf16_f32 v18, v104, v105
  v_cvt_pk_bf16_f32 v19, v106, v107
L_r218:
  v_mfma_f32_16x16x32_bf16 v[88:91], a[4:7], v[92:95], v[88:91]
L_r219:
  v_mfma_f32_16x16x32_bf16 v[108:111], a[8:11], v[92:95], 0
L_r220:
  v_mfma_f32_16x16x32_bf16 v[108:111], a[20:23], v[96:99], v[108:111]
L_r221:
  v_mfma_f32_16x16x32_bf16 v[108:111], a[32:35], v[136:139], v[108:111]
  v_mul_f32 v88, s42, v88
  v_mul_f32 v89, s42, v89
L_r222:
  v_mfma_f32_16x16x32_bf16 v[108:111], a[44:47], v[116:119], v[108:111]
  v_mul_f32 v90, s42, v90
  v_mul_f32 v91, s42, v91
L_r223:
  v_mfma_f32_16x16x32_bf16 v[108:111], a[56:59], v[80:83], v[108:111]
  v_cvt_pk_bf16_f32 v104, v88, v89
  v_cvt_pk_bf16_f32 v105, v90, v91
L_r224:
  v_mfma_f32_16x16x32_bf16 v[108:111], a[68:71], v[84:87], v[108:111]
L_r225:
  v_mfma_f32_16x16x32_bf16 v[112:115], a[132:135], v[84:87], 0
L_r226:
  v_mfma_f32_16x16x32_bf16 v[112:115], a[120:123], v[80:83], v[112:115]
L_r227:
  v_mfma_f32_16x16x32_bf16 v[112:115], a[108:111], v[116:119], v[112:115]
  v_mul_f32 v108, s42, v108
  v_mul_f32 v109, s42, v109
L_r228:
  v_mfma_f32_16x16x32_bf16 v[112:115], a[96:99], v[136:139], v[112:115]
  v_mul_f32 v110, s42, v110
  v_mul_f32 v111, s42, v111
L_r229:
  v_mfma_f32_16x16x32_bf16 v[112:115], a[84:87], v[96:99], v[112:115]
  v_cvt_pk_bf16_f32 v106, v108, v109
  v_cvt_pk_bf16_f32 v107, v110, v111
L_r230:
  v_mfma_f32_16x16x32_bf16 v[112:115], a[72:75], v[92:95], v[112:115]
L_r231:
  v_mfma_f32_16x16x32_bf16 v[88:91], a[76:79], v[92:95], 0
L_r232:
  v_mfma_f32_16x16x32_bf16 v[88:91], a[88:91], v[96:99], v[88:91]
L_r233:
  v_mfma_f32_16x16x32_bf16 v[88:91], a[100:103], v[136:139], v[88:91]
  v_cvt_pk_bf16_f32 v128, v112, v113
  v_cvt_pk_bf16_f32 v129, v114, v115
L_r234:
  v_mfma_f32_16x16x32_bf16 v[88:91], a[112:115], v[116:119], v[88:91]
L_r235:
  v_mfma_f32_16x16x32_bf16 v[88:91], a[124:127], v[80:83], v[88:91]
L_r236:
  v_mfma_f32_16x16x32_bf16 v[88:91], a[136:139], v[84:87], v[88:91]
L_r237:
  v_mfma_f32_16x16x32_bf16 v[108:111], a[140:143], v[84:87], 0
L_r238:
  v_mfma_f32_16x16x32_bf16 v[108:111], a[128:131], v[80:83], v[108:111]
L_r239:
  v_mfma_f32_16x16x32_bf16 v[108:111], a[116:119], v[116:119], v[108:111]
  v_cvt_pk_bf16_f32 v130, v88, v89
  v_cvt_pk_bf16_f32 v131, v90, v91
L_r240:
  v_mfma_f32_16x16x32_bf16 v[108:111], a[104:107], v[136:139], v[108:111]
L_r241:
  v_mfma_f32_16x16x32_bf16 v[108:111], a[92:95], v[96:99], v[108:111]
L_r242:
  v_mfma_f32_16x16x32_bf16 v[108:111], a[80:83], v[92:95], v[108:111]
L_r243:
  v_mfma_f32_16x16x32_bf16 v[88:91], v[92:95], a[144:147], 0
L_r244:
  v_mfma_f32_16x16x32_bf16 v[88:91], v[96:99], a[156:159], v[88:91]
L_r245:
  v_mfma_f32_16x16x32_bf16 v[88:91], v[136:139], a[168:171], v[88:91]
  v_cvt_pk_bf16_f32 v132, v108, v109
  v_cvt_pk_bf16_f32 v133, v110, v111
L_r246:
  v_mfma_f32_16x16x32_bf16 v[88:91], v[116:119], a[180:183], v[88:91]
  ds_read_b128 a[244:247], v1 offset:22528
L_r247:
  v_mfma_f32_16x16x32_bf16 v[88:91], v[80:83], a[192:195], v[88:91]
  ds_read_b128 a[248:251], v0 offset:22528
L_r248:
  v_mfma_f32_16x16x32_bf16 v[88:91], v[84:87], a[204:207], v[88:91]
  ds_read_b128 a[252:255], v1 offset:14336
L_r249:
  v_mfma_f32_16x16x32_bf16 v[140:143], v[84:87], a[208:211], 0
  ds_read_b128 v[144:147], v0 offset:14336
L_r250:
  v_mfma_f32_16x16x32_bf16 v[140:143], v[80:83], a[196:199], v[140:143]
  ds_read_b128 v[148:151], v1 offset:6144
L_r251:
  v_mfma_f32_16x16x32_bf16 v[140:143], v[116:119], a[184:187], v[140:143]
  v_cvt_pk_bf16_f32 v108, v88, v89
  v_cvt_pk_bf16_f32 v109, v90, v91
L_r252:
  v_mfma_f32_16x16x32_bf16 v[140:143], v[136:139], a[172:175], v[140:143]
  ds_read_b128 v[152:155], v0 offset:6144
L_r253:
  v_mfma_f32_16x16x32_bf16 v[140:143], v[96:99], a[160:163], v[140:143]
L_r254:
  v_mfma_f32_16x16x32_bf16 v[140:143], v[92:95], a[148:151], v[140:143]
L_r255:
  v_mfma_f32_16x16x32_bf16 v[88:91], v[92:95], a[152:155], 0
L_r256:
  v_mfma_f32_16x16x32_bf16 v[88:91], v[96:99], a[164:167], v[88:91]
L_r257:
  v_mfma_f32_16x16x32_bf16 v[88:91], v[136:139], a[176:179], v[88:91]
  v_cvt_pk_bf16_f32 v112, v140, v141
  v_cvt_pk_bf16_f32 v113, v142, v143
L_r258:
  v_mfma_f32_16x16x32_bf16 v[88:91], v[116:119], a[188:191], v[88:91]
L_r259:
  v_mfma_f32_16x16x32_bf16 v[88:91], v[80:83], a[200:203], v[88:91]
  buffer_load_dwordx2 v[52:53], v11, s[20:23], s44 offen sc1
  v_mfma_f32_16x16x32_bf16 v[88:91], v[84:87], a[212:215], v[88:91]
  s_waitcnt lgkmcnt(0)
  v_mfma_f32_16x16x32_bf16 v[80:83], a[132:135], a[244:247], 0
  v_mfma_f32_16x16x32_bf16 v[80:83], a[120:123], a[248:251], v[80:83]
  v_mfma_f32_16x16x32_bf16 v[80:83], a[108:111], a[252:255], v[80:83]
  v_cvt_pk_bf16_f32 v116, v88, v89
  v_cvt_pk_bf16_f32 v117, v90, v91
  v_mfma_f32_16x16x32_bf16 v[80:83], a[96:99], v[144:147], v[80:83]
  v_mfma_f32_16x16x32_bf16 v[80:83], a[84:87], v[148:151], v[80:83]
  s_waitcnt vmcnt(31)
  s_barrier
  v_mfma_f32_16x16x32_bf16 v[80:83], a[72:75], v[152:155], v[80:83]
  v_add_u32 v0, s28, v2
  v_xor_b32 v1, 64, v0
  v_mfma_f32_16x16x32_bf16 v[84:87], a[76:79], v[152:155], 0
  v_mfma_f32_16x16x32_bf16 v[84:87], a[88:91], v[148:151], v[84:87]
  v_mfma_f32_16x16x32_bf16 v[84:87], a[100:103], v[144:147], v[84:87]
  v_cvt_pk_bf16_f32 v136, v80, v81
  v_cvt_pk_bf16_f32 v137, v82, v83
  v_mfma_f32_16x16x32_bf16 v[84:87], a[112:115], a[252:255], v[84:87]
  v_mfma_f32_16x16x32_bf16 v[84:87], a[124:127], a[248:251], v[84:87]
  v_mfma_f32_16x16x32_bf16 v[84:87], a[136:139], a[244:247], v[84:87]
  v_mfma_f32_16x16x32_bf16 v[80:83], a[140:143], a[244:247], 0
  v_mfma_f32_16x16x32_bf16 v[80:83], a[128:131], a[248:251], v[80:83]
  v_mfma_f32_16x16x32_bf16 v[80:83], a[116:119], a[252:255], v[80:83]
  v_cvt_pk_bf16_f32 v138, v84, v85
  v_cvt_pk_bf16_f32 v139, v86, v87
  v_mfma_f32_16x16x32_bf16 v[80:83], a[104:107], v[144:147], v[80:83]
  v_mfma_f32_16x16x32_bf16 v[80:83], a[92:95], v[148:151], v[80:83]
  v_mfma_f32_16x16x32_bf16 v[80:83], a[80:83], v[152:155], v[80:83]
  v_mfma_f32_16x16x32_bf16 v[92:95], v[70:73], v[76:79], v[36:39]
  v_mfma_f32_16x16x32_bf16 v[92:95], v[68:71], v[12:15], v[92:95]
  v_mfma_f32_16x16x32_bf16 v[96:99], v[122:125], v[76:79], v[32:35]
  v_cvt_pk_bf16_f32 v140, v80, v81
  v_cvt_pk_bf16_f32 v141, v82, v83
  v_mfma_f32_16x16x32_bf16 v[96:99], v[120:123], v[12:15], v[96:99]
  v_mfma_f32_16x16x32_bf16 v[172:175], v[130:133], v[76:79], v[28:31]
  v_exp_f32 v92, v92
  v_mfma_f32_16x16x32_bf16 v[172:175], v[128:131], v[12:15], v[172:175]
  v_exp_f32 v93, v93
  v_mfma_f32_16x16x32_bf16 v[176:179], v[138:141], v[76:79], v[24:27]
  v_exp_f32 v94, v94
  v_mfma_f32_16x16x32_bf16 v[176:179], v[136:139], v[12:15], v[176:179]
  v_exp_f32 v95, v95
  v_mfma_f32_16x16x32_bf16 v[84:87], v[68:71], v[100:103], v[40:43]
  v_exp_f32 v96, v96
  v_mfma_f32_16x16x32_bf16 v[84:87], v[70:73], v[14:17], v[84:87]
  v_exp_f32 v97, v97
  v_mfma_f32_16x16x32_bf16 v[88:91], v[120:123], v[100:103], v[36:39]
  v_exp_f32 v98, v98
  v_mfma_f32_16x16x32_bf16 v[88:91], v[122:125], v[14:17], v[88:91]
  v_exp_f32 v99, v99
  v_mfma_f32_16x16x32_bf16 v[168:171], v[128:131], v[100:103], v[32:35]
  v_exp_f32 v172, v172
  v_mfma_f32_16x16x32_bf16 v[168:171], v[130:133], v[14:17], v[168:171]
  v_exp_f32 v173, v173
  v_mfma_f32_16x16x32_bf16 v[164:167], v[136:139], v[100:103], v[28:31]
  v_exp_f32 v174, v174
  v_mfma_f32_16x16x32_bf16 v[164:167], v[138:141], v[14:17], v[164:167]
  v_exp_f32 v175, v175
  v_mfma_f32_16x16x32_bf16 v[76:79], v[130:133], v[104:107], v[36:39]
  v_exp_f32 v176, v176
  v_mfma_f32_16x16x32_bf16 v[76:79], v[128:131], v[18:21], v[76:79]
  v_exp_f32 v177, v177
  v_mfma_f32_16x16x32_bf16 v[80:83], v[138:141], v[104:107], v[32:35]
  v_exp_f32 v178, v178
  v_mfma_f32_16x16x32_bf16 v[80:83], v[136:139], v[18:21], v[80:83]
  v_exp_f32 v179, v179
  v_mfma_f32_16x16x32_bf16 v[160:163], v[70:73], v[104:107], v[44:47]
  v_cvt_pk_bf16_f32 v92, v92, v93
  v_cvt_pk_bf16_f32 v93, v94, v95
  v_mfma_f32_16x16x32_bf16 v[160:163], v[68:71], v[18:21], v[160:163]
  v_cvt_pk_bf16_f32 v94, v96, v97
  v_cvt_pk_bf16_f32 v95, v98, v99
  v_mfma_f32_16x16x32_bf16 v[156:159], v[122:125], v[104:107], v[40:43]
  v_cvt_pk_bf16_f32 v96, v172, v173
  v_cvt_pk_bf16_f32 v97, v174, v175
  v_mfma_f32_16x16x32_bf16 v[156:159], v[120:123], v[18:21], v[156:159]
  v_cvt_pk_bf16_f32 v98, v176, v177
  v_cvt_pk_bf16_f32 v99, v178, v179
  v_mfma_f32_16x16x32_bf16 v[180:183], a[0:3], v[152:155], 0
  v_exp_f32 v84, v84
  v_mfma_f32_16x16x32_bf16 v[180:183], a[12:15], v[148:151], v[180:183]
  v_exp_f32 v85, v85
  v_mfma_f32_16x16x32_bf16 v[180:183], a[24:27], v[144:147], v[180:183]
  v_exp_f32 v86, v86
  v_mfma_f32_16x16x32_bf16 v[180:183], a[36:39], a[252:255], v[180:183]
  v_exp_f32 v87, v87
  v_mfma_f32_16x16x32_bf16 v[180:183], a[48:51], a[248:251], v[180:183]
  v_exp_f32 v88, v88
  v_mfma_f32_16x16x32_bf16 v[180:183], a[60:63], a[244:247], v[180:183]
  v_exp_f32 v89, v89
  v_mfma_f32_16x16x32_bf16 v[100:103], a[64:67], a[244:247], 0
  v_exp_f32 v90, v90
  v_mfma_f32_16x16x32_bf16 v[100:103], a[52:55], a[248:251], v[100:103]
  v_exp_f32 v91, v91
  v_mfma_f32_16x16x32_bf16 v[100:103], a[40:43], a[252:255], v[100:103]
  v_mul_f32 v180, s42, v180
  v_mul_f32 v181, s42, v181
  v_mfma_f32_16x16x32_bf16 v[100:103], a[28:31], v[144:147], v[100:103]
  v_mul_f32 v182, s42, v182
  v_mul_f32 v183, s42, v183
  v_mfma_f32_16x16x32_bf16 v[100:103], a[16:19], v[148:151], v[100:103]
  v_cvt_pk_bf16_f32 v172, v180, v181
  v_cvt_pk_bf16_f32 v173, v182, v183
  v_mfma_f32_16x16x32_bf16 v[100:103], a[4:7], v[152:155], v[100:103]
  v_exp_f32 v168, v168
  v_mfma_f32_16x16x32_bf16 v[104:107], a[8:11], v[152:155], 0
  v_exp_f32 v169, v169
  v_mfma_f32_16x16x32_bf16 v[104:107], a[20:23], v[148:151], v[104:107]
  v_exp_f32 v170, v170
  v_mfma_f32_16x16x32_bf16 v[104:107], a[32:35], v[144:147], v[104:107]
  v_mul_f32 v100, s42, v100
  v_mul_f32 v101, s42, v101
  v_mfma_f32_16x16x32_bf16 v[104:107], a[44:47], a[252:255], v[104:107]
  v_mul_f32 v102, s42, v102
  v_mul_f32 v103, s42, v103
  v_mfma_f32_16x16x32_bf16 v[104:107], a[56:59], a[248:251], v[104:107]
  v_cvt_pk_bf16_f32 v174, v100, v101
  v_cvt_pk_bf16_f32 v175, v102, v103
  v_mfma_f32_16x16x32_bf16 v[104:107], a[68:71], a[244:247], v[104:107]
  v_exp_f32 v171, v171
  v_mfma_f32_16x16x32_bf16 v[176:179], v[152:155], a[144:147], 0
  v_exp_f32 v164, v164
  v_mfma_f32_16x16x32_bf16 v[176:179], v[148:151], a[156:159], v[176:179]
  v_exp_f32 v165, v165
  v_mfma_f32_16x16x32_bf16 v[176:179], v[144:147], a[168:171], v[176:179]
  v_mul_f32 v104, s42, v104
  v_mul_f32 v105, s42, v105
  v_mfma_f32_16x16x32_bf16 v[176:179], a[252:255], a[180:183], v[176:179]
  v_mul_f32 v106, s42, v106
  v_mul_f32 v107, s42, v107
  v_mfma_f32_16x16x32_bf16 v[176:179], a[248:251], a[192:195], v[176:179]
  v_cvt_pk_bf16_f32 v22, v104, v105
  v_cvt_pk_bf16_f32 v23, v106, v107
  v_mfma_f32_16x16x32_bf16 v[176:179], a[244:247], a[204:207], v[176:179]
  v_exp_f32 v166, v166
  v_mfma_f32_16x16x32_bf16 v[100:103], v[128:131], v[172:175], v[40:43]
  v_exp_f32 v167, v167
  v_mfma_f32_16x16x32_bf16 v[100:103], v[130:133], v[20:23], v[100:103]
  v_cvt_pk_bf16_f32 v84, v84, v85
  v_cvt_pk_bf16_f32 v85, v86, v87
  v_mfma_f32_16x16x32_bf16 v[104:107], v[136:139], v[172:175], v[36:39]
  v_cvt_pk_bf16_f32 v110, v176, v177
  v_cvt_pk_bf16_f32 v111, v178, v179
  v_mfma_f32_16x16x32_bf16 v[104:107], v[138:141], v[20:23], v[104:107]
  v_cvt_pk_bf16_f32 v86, v88, v89
  v_cvt_pk_bf16_f32 v87, v90, v91
  v_mfma_f32_16x16x32_bf16 v[132:135], v[68:71], v[172:175], v[48:51]
  ds_read_b128 v[136:139], v3 offset:0
  v_cvt_pk_bf16_f32 v88, v168, v169
  v_mfma_f32_16x16x32_bf16 v[132:135], v[70:73], v[20:23], v[132:135]
  ds_read_b128 v[140:143], v3 offset:4096
  v_cvt_pk_bf16_f32 v89, v170, v171
  v_mfma_f32_16x16x32_bf16 v[128:131], v[120:123], v[172:175], v[44:47]
  ds_read_b128 v[68:71], v3 offset:8192
  v_cvt_pk_bf16_f32 v90, v164, v165
  v_mfma_f32_16x16x32_bf16 v[128:131], v[122:125], v[20:23], v[128:131]
  ds_read_b128 v[72:75], v3 offset:12288
  v_cvt_pk_bf16_f32 v91, v166, v167
  v_mfma_f32_16x16x32_bf16 v[168:171], a[244:247], a[208:211], 0
  ds_read_b128 v[120:123], v3 offset:16384
  v_mfma_f32_16x16x32_bf16 v[168:171], a[248:251], a[196:199], v[168:171]
  ds_read_b128 v[124:127], v3 offset:20480
  v_mfma_f32_16x16x32_bf16 v[168:171], a[252:255], a[184:187], v[168:171]
  v_exp_f32 v76, v76
  v_mfma_f32_16x16x32_bf16 v[168:171], v[144:147], a[172:175], v[168:171]
  v_exp_f32 v77, v77
  v_mfma_f32_16x16x32_bf16 v[168:171], v[148:151], a[160:163], v[168:171]
  v_exp_f32 v78, v78
  v_mfma_f32_16x16x32_bf16 v[168:171], v[152:155], a[148:151], v[168:171]
  v_exp_f32 v79, v79
  v_mfma_f32_16x16x32_bf16 v[164:167], v[152:155], a[152:155], 0
  v_exp_f32 v80, v80
  v_mfma_f32_16x16x32_bf16 v[164:167], v[148:151], a[164:167], v[164:167]
  v_exp_f32 v81, v81
  v_mfma_f32_16x16x32_bf16 v[164:167], v[144:147], a[176:179], v[164:167]
  v_cvt_pk_bf16_f32 v114, v168, v169
  v_cvt_pk_bf16_f32 v115, v170, v171
  v_mfma_f32_16x16x32_bf16 v[164:167], a[252:255], a[188:191], v[164:167]
  s_cmp_lt_u32 s31, s97
  v_exp_f32 v82, v82
  v_mfma_f32_16x16x32_bf16 v[164:167], a[248:251], a[200:203], v[164:167]
  s_waitcnt lgkmcnt(0)
  v_exp_f32 v83, v83
  v_mfma_f32_16x16x32_bf16 v[164:167], a[244:247], a[212:215], v[164:167]
  s_cbranch_scc1 L_loop
L_epi:
  v_mfma_f32_16x16x32_bf16 v[180:183], v[136:139], v[184:187], 0
L_hop_0_1:
  s_cbranch_execz L_hop_0_2
  s_lshl_b32 s5, s3, 3
  v_mov_b64 v[144:145], 0
  v_cvt_pk_bf16_f32 v76, v76, v77
  v_mfma_f32_16x16x32_bf16 v[180:183], v[140:143], v[200:203], v[180:183]
  s_add_u32 s5, s5, 155648
  v_exp_f32 v160, v160
  v_mfma_f32_16x16x32_bf16 v[180:183], v[68:71], v[216:219], v[180:183]
  v_cvt_pk_bf16_f32 v118, v164, v165
  v_cvt_pk_bf16_f32 v119, v166, v167
  v_mfma_f32_16x16x32_bf16 v[180:183], v[72:75], v[232:235], v[180:183]
  v_mov_b64 v[148:149], 0
  v_cvt_pk_bf16_f32 v77, v78, v79
  v_mfma_f32_16x16x32_bf16 v[180:183], v[120:123], v[248:251], v[180:183]
  v_exp_f32 v161, v161
  v_mfma_f32_16x16x32_bf16 v[180:183], v[124:127], a[224:227], v[180:183]
  v_exp_f32 v162, v162
  v_smfmac_f32_16x16x64_bf16 v[144:147], a[240:243], v[92:99], v10
  v_exp_f32 v163, v163
  v_mfma_f32_16x16x32_bf16 v[152:155], v[108:111], v[96:99], 0
  v_exp_f32 v156, v156
  v_mfma_f32_16x16x32_bf16 v[152:155], v[56:59], v[92:95], v[152:155]
  v_exp_f32 v157, v157
  v_mfma_f32_16x16x32_bf16 v[164:167], v[60:63], v[92:95], 0
  v_exp_f32 v158, v158
  v_mfma_f32_16x16x32_bf16 v[164:167], v[112:115], v[96:99], v[164:167]
  v_exp_f32 v159, v159
  v_mfma_f32_16x16x32_bf16 v[168:171], v[116:119], v[96:99], 0
  v_cvt_pk_bf16_f32 v78, v80, v81
  v_cvt_pk_bf16_f32 v79, v82, v83
  v_mfma_f32_16x16x32_bf16 v[168:171], v[64:67], v[92:95], v[168:171]
  v_cvt_pk_bf16_f32 v80, v160, v161
  v_cvt_pk_bf16_f32 v81, v162, v163
  v_smfmac_f32_16x16x64_bf16 v[148:151], a[240:243], v[84:91], v10
  v_cvt_pk_bf16_f32 v82, v156, v157
  v_cvt_pk_bf16_f32 v83, v158, v159
  v_mfma_f32_16x16x32_bf16 v[92:95], v[108:111], v[88:91], 0
  v_exp_f32 v100, v100
  v_mfma_f32_16x16x32_bf16 v[92:95], v[56:59], v[84:87], v[92:95]
  v_exp_f32 v101, v101
  v_mfma_f32_16x16x32_bf16 v[96:99], v[60:63], v[84:87], 0
  v_exp_f32 v102, v102
  v_mfma_f32_16x16x32_bf16 v[96:99], v[112:115], v[88:91], v[96:99]
  v_exp_f32 v103, v103
  v_mfma_f32_16x16x32_bf16 v[156:159], v[116:119], v[88:91], 0
  v_exp_f32 v104, v104
  v_mfma_f32_16x16x32_bf16 v[156:159], v[64:67], v[84:87], v[156:159]
  v_exp_f32 v105, v105
  v_mfma_f32_16x16x32_bf16 v[172:175], v[124:127], a[228:231], 0
  v_exp_f32 v106, v106
  v_mfma_f32_16x16x32_bf16 v[172:175], v[120:123], v[252:255], v[172:175]
  v_exp_f32 v107, v107
  v_mfma_f32_16x16x32_bf16 v[172:175], v[72:75], v[236:239], v[172:175]
  ds_read_b128 a[248:251], v4 offset:0
  ds_read_b128 v[16:19], v4 offset:4096
  v_mfma_f32_16x16x32_bf16 v[172:175], v[68:71], v[220:223], v[172:175]
  ds_read_b128 v[160:163], v4 offset:8192
  ds_read_b128 v[176:179], v4 offset:12288
  v_mfma_f32_16x16x32_bf16 v[172:175], v[140:143], v[204:207], v[172:175]
  ds_read_b128 a[244:247], v4 offset:16384
  ds_read_b128 a[252:255], v4 offset:20480
  v_mfma_f32_16x16x32_bf16 v[172:175], v[136:139], v[188:191], v[172:175]
  v_exp_f32 v132, v132
  v_mfma_f32_16x16x32_bf16 v[88:91], v[136:139], v[192:195], 0
  v_exp_f32 v133, v133
  v_mfma_f32_16x16x32_bf16 v[88:91], v[140:143], v[208:211], v[88:91]
  v_exp_f32 v134, v134
  v_mfma_f32_16x16x32_bf16 v[88:91], v[68:71], v[224:227], v[88:91]
  v_cvt_pk_bf16_f32 v180, v180, v172
  v_cvt_pk_bf16_f32 v181, v181, v173
  v_mfma_f32_16x16x32_bf16 v[88:91], v[72:75], v[240:243], v[88:91]
  v_cvt_pk_bf16_f32 v182, v182, v174
  v_cvt_pk_bf16_f32 v183, v183, v175
  v_mfma_f32_16x16x32_bf16 v[88:91], v[120:123], a[216:219], v[88:91]
  buffer_store_dword v180, v7, s[24:27], s33 offen offset:0 nt
  v_mfma_f32_16x16x32_bf16 v[88:91], v[124:127], a[232:235], v[88:91]
  v_exp_f32 v135, v135
  v_mfma_f32_16x16x32_bf16 v[84:87], v[124:127], a[236:239], 0
  buffer_store_dword v181, v7, s[24:27], s33 offen offset:384 nt
  v_mfma_f32_16x16x32_bf16 v[84:87], v[120:123], a[220:223], v[84:87]
  v_exp_f32 v128, v128
  v_mfma_f32_16x16x32_bf16 v[84:87], v[72:75], v[244:247], v[84:87]
  buffer_store_dword v182, v7, s[24:27], s33 offen offset:768 nt
  v_mfma_f32_16x16x32_bf16 v[84:87], v[68:71], v[228:231], v[84:87]
  v_exp_f32 v129, v129
  v_mfma_f32_16x16x32_bf16 v[84:87], v[140:143], v[212:215], v[84:87]
  buffer_store_dword v183, v7, s[24:27], s33 offen offset:1152 nt
  v_mfma_f32_16x16x32_bf16 v[84:87], v[136:139], v[196:199], v[84:87]
  s_waitcnt lgkmcnt(0)
  v_exp_f32 v130, v130
  v_mfma_f32_16x16x32_bf16 v[140:143], a[248:251], v[184:187], 0
  v_exp_f32 v131, v131
  v_mfma_f32_16x16x32_bf16 v[140:143], v[16:19], v[200:203], v[140:143]
  v_cvt_pk_bf16_f32 v100, v100, v101
  v_cvt_pk_bf16_f32 v101, v102, v103
  v_mfma_f32_16x16x32_bf16 v[140:143], v[160:163], v[216:219], v[140:143]
  v_cvt_pk_bf16_f32 v88, v88, v84
  v_cvt_pk_bf16_f32 v89, v89, v85
  v_mfma_f32_16x16x32_bf16 v[140:143], v[176:179], v[232:235], v[140:143]
  v_cvt_pk_bf16_f32 v90, v90, v86
  v_cvt_pk_bf16_f32 v91, v91, v87
  v_mfma_f32_16x16x32_bf16 v[140:143], a[244:247], v[248:251], v[140:143]
  buffer_store_dword v88, v8, s[24:27], s33 offen offset:0 nt
  v_mfma_f32_16x16x32_bf16 v[140:143], a[252:255], a[224:227], v[140:143]
  ds_read_b128 v[172:175], v3 offset:512
  v_mov_b64 v[84:85], 0
  v_mfma_f32_16x16x32_bf16 v[136:139], a[252:255], a[228:231], 0
  buffer_store_dword v89, v8, s[24:27], s33 offen offset:384 nt
  v_mfma_f32_16x16x32_bf16 v[136:139], a[244:247], v[252:255], v[136:139]
  ds_read_b128 v[180:183], v3 offset:4608
  ds_read_b128 a[252:255], v3 offset:8704
  v_mfma_f32_16x16x32_bf16 v[136:139], v[176:179], v[236:239], v[136:139]
  buffer_store_dword v90, v8, s[24:27], s33 offen offset:768 nt
  v_mfma_f32_16x16x32_bf16 v[136:139], v[160:163], v[220:223], v[136:139]
  ds_read_b128 v[120:123], v3 offset:12800
  ds_read_b128 v[124:127], v3 offset:16896
  v_mfma_f32_16x16x32_bf16 v[136:139], v[16:19], v[204:207], v[136:139]
  buffer_store_dword v91, v8, s[24:27], s33 offen offset:1152 nt
  v_mfma_f32_16x16x32_bf16 v[136:139], a[248:251], v[188:191], v[136:139]
  s_add_u32 s33, s33, s98
  ds_read_b128 a[244:247], v3 offset:20992
  v_cvt_pk_bf16_f32 v102, v104, v105
  v_smfmac_f32_16x16x64_bf16 v[84:87], a[240:243], v[76:83], v10
  v_cvt_pk_bf16_f32 v103, v106, v107
  v_cvt_pk_bf16_f32 v104, v132, v133
  v_mfma_f32_16x16x32_bf16 v[16:19], v[56:59], v[80:83], 0
  v_cvt_pk_bf16_f32 v105, v134, v135
  v_cvt_pk_bf16_f32 v106, v128, v129
  v_mfma_f32_16x16x32_bf16 v[16:19], v[108:111], v[76:79], v[16:19]
  v_cvt_pk_bf16_f32 v140, v140, v136
  v_cvt_pk_bf16_f32 v141, v141, v137
  v_mfma_f32_16x16x32_bf16 v[68:71], v[112:115], v[76:79], 0
  v_cvt_pk_bf16_f32 v142, v142, v138
  v_cvt_pk_bf16_f32 v143, v143, v139
  v_mfma_f32_16x16x32_bf16 v[68:71], v[60:63], v[80:83], v[68:71]
  buffer_store_dword v140, v7, s[24:27], s34 offen offset:0 nt
  v_mfma_f32_16x16x32_bf16 v[72:75], v[64:67], v[80:83], 0
  s_waitcnt lgkmcnt(0)
  v_cvt_pk_bf16_f32 v107, v130, v131
  v_add_f32 v144, v144, v145
  v_mfma_f32_16x16x32_bf16 v[72:75], v[116:119], v[76:79], v[72:75]
  buffer_store_dword v141, v7, s[24:27], s34 offen offset:384 nt
  v_mfma_f32_16x16x32_bf16 v[128:131], v[172:175], v[184:187], 0
  v_rcp_f32 v146, v144
  v_mfma_f32_16x16x32_bf16 v[128:131], v[180:183], v[200:203], v[128:131]
  buffer_store_dword v142, v7, s[24:27], s34 offen offset:768 nt
  v_mfma_f32_16x16x32_bf16 v[128:131], a[252:255], v[216:219], v[128:131]
L_hop_1_1:
  s_cbranch_execz L_hop_1_2
  v_mov_b64 v[76:77], 0
  v_add_f32 v148, v148, v149
  v_mfma_f32_16x16x32_bf16 v[128:131], v[120:123], v[232:235], v[128:131]
  buffer_store_dword v143, v7, s[24:27], s34 offen offset:1152 nt
  v_mul_f32 v152, v146, v152
  v_mfma_f32_16x16x32_bf16 v[128:131], v[124:127], v[248:251], v[128:131]
  s_add_u32 s34, s34, s98
  v_rcp_f32 v150, v148
  v_mul_f32 v153, v146, v153
  v_mfma_f32_16x16x32_bf16 v[128:131], a[244:247], a[224:227], v[128:131]
  v_mul_f32 v154, v146, v154
  v_mul_f32 v155, v146, v155
  v_cvt_pk_bf16_f32 v152, v152, v153
  v_mfma_f32_16x16x32_bf16 v[88:91], a[244:247], a[228:231], 0
  v_cvt_pk_bf16_f32 v153, v154, v155
  v_mul_f32 v164, v146, v164
  v_mul_f32 v165, v146, v165
  v_mfma_f32_16x16x32_bf16 v[88:91], v[124:127], v[252:255], v[88:91]
  v_mul_f32 v166, v146, v166
  v_mul_f32 v167, v146, v167
  v_cvt_pk_bf16_f32 v164, v164, v165
  v_mfma_f32_16x16x32_bf16 v[88:91], v[120:123], v[236:239], v[88:91]
  v_cvt_pk_bf16_f32 v165, v166, v167
  v_mul_f32 v168, v146, v168
  v_mul_f32 v169, v146, v169
  v_mfma_f32_16x16x32_bf16 v[88:91], a[252:255], v[220:223], v[88:91]
  v_mul_f32 v170, v146, v170
  v_mul_f32 v171, v146, v171
  v_cvt_pk_bf16_f32 v168, v168, v169
  v_mfma_f32_16x16x32_bf16 v[88:91], v[180:183], v[204:207], v[88:91]
  v_cvt_pk_bf16_f32 v169, v170, v171
  v_mul_f32 v92, v150, v92
  v_mul_f32 v93, v150, v93
  v_mfma_f32_16x16x32_bf16 v[88:91], v[172:175], v[188:191], v[88:91]
  v_mul_f32 v94, v150, v94
  v_mul_f32 v95, v150, v95
  v_cvt_pk_bf16_f32 v92, v92, v93
  v_smfmac_f32_16x16x64_bf16 v[76:79], a[240:243], v[100:107], v10
  v_cvt_pk_bf16_f32 v93, v94, v95
  v_mul_f32 v96, v150, v96
  v_mul_f32 v97, v150, v97
  v_mfma_f32_16x16x32_bf16 v[80:83], v[56:59], v[104:107], 0
  v_mul_f32 v98, v150, v98
  v_mul_f32 v99, v150, v99
  v_cvt_pk_bf16_f32 v96, v96, v97
  v_mfma_f32_16x16x32_bf16 v[80:83], v[108:111], v[100:103], v[80:83]
  v_cvt_pk_bf16_f32 v128, v128, v88
  v_cvt_pk_bf16_f32 v129, v129, v89
  v_cvt_pk_bf16_f32 v97, v98, v99
  v_mfma_f32_16x16x32_bf16 v[56:59], v[112:115], v[100:103], 0
  ds_read_b128 v[108:111], v4 offset:512
  v_cvt_pk_bf16_f32 v130, v130, v90
  v_cvt_pk_bf16_f32 v131, v131, v91
  v_mfma_f32_16x16x32_bf16 v[56:59], v[60:63], v[104:107], v[56:59]
  buffer_store_dword v128, v7, s[24:27], s35 offen offset:0 nt
  v_mul_f32 v156, v150, v156
  v_mfma_f32_16x16x32_bf16 v[88:91], v[64:67], v[104:107], 0
  ds_read_b128 v[112:115], v4 offset:4608
  ds_read_b128 v[132:135], v4 offset:8704
  v_mul_f32 v157, v150, v157
  v_mfma_f32_16x16x32_bf16 v[88:91], v[116:119], v[100:103], v[88:91]
  buffer_store_dword v129, v7, s[24:27], s35 offen offset:384 nt
  v_mul_f32 v158, v150, v158
  v_mfma_f32_16x16x32_bf16 v[104:107], v[172:175], v[192:195], 0
  ds_read_b128 v[100:103], v4 offset:12800
  ds_read_b128 v[60:63], v4 offset:16896
  v_mul_f32 v159, v150, v159
  v_mfma_f32_16x16x32_bf16 v[104:107], v[180:183], v[208:211], v[104:107]
  buffer_store_dword v130, v7, s[24:27], s35 offen offset:768 nt
  v_cvt_pk_bf16_f32 v156, v156, v157
  v_mfma_f32_16x16x32_bf16 v[104:107], a[252:255], v[224:227], v[104:107]
  ds_read_b128 v[116:119], v4 offset:20992
  v_cvt_pk_bf16_f32 v157, v158, v159
  v_max3_f32 v9, v144, v146, v9
  v_mfma_f32_16x16x32_bf16 v[104:107], v[120:123], v[240:243], v[104:107]
  buffer_store_dword v131, v7, s[24:27], s35 offen offset:1152 nt
  v_max3_f32 v9, v148, v150, v9
  v_mfma_f32_16x16x32_bf16 v[104:107], v[124:127], a[216:219], v[104:107]
  ds_write2st64_b32 v5, v152, v153 offset0:0 offset1:4
  v_mfma_f32_16x16x32_bf16 v[104:107], a[244:247], a[232:235], v[104:107]
  ds_write2st64_b32 v5, v164, v165 offset0:8 offset1:12
  v_mfma_f32_16x16x32_bf16 v[128:131], a[244:247], a[236:239], 0
  ds_write2st64_b32 v5, v168, v169 offset0:16 offset1:20
  v_mfma_f32_16x16x32_bf16 v[128:131], v[124:127], a[220:223], v[128:131]
  ds_write2st64_b32 v5, v92, v93 offset0:1 offset1:5
  v_mfma_f32_16x16x32_bf16 v[128:131], v[120:123], v[244:247], v[128:131]
  ds_write2st64_b32 v5, v96, v97 offset0:9 offset1:13
  v_mfma_f32_16x16x32_bf16 v[128:131], a[252:255], v[228:231], v[128:131]
  ds_write2st64_b32 v5, v156, v157 offset0:17 offset1:21
  v_mfma_f32_16x16x32_bf16 v[128:131], v[180:183], v[212:215], v[128:131]
  v_xor_b32 v3, 40960, v3
  v_xor_b32 v4, 40960, v4
  v_add_f32 v84, v84, v85
  v_mfma_f32_16x16x32_bf16 v[128:131], v[172:175], v[196:199], v[128:131]
  s_waitcnt lgkmcnt(6)
  v_rcp_f32 v86, v84
  v_add_f32 v76, v76, v77
  v_mfma_f32_16x16x32_bf16 v[64:67], v[108:111], v[184:187], 0
  v_rcp_f32 v78, v76
  v_max3_f32 v9, v84, v86, v9
  v_mfma_f32_16x16x32_bf16 v[64:67], v[112:115], v[200:203], v[64:67]
  v_max3_f32 v9, v76, v78, v9
  v_cmp_nge_f32 vcc, 0x53800000, v9
  v_mul_f32 v16, v86, v16
  v_mfma_f32_16x16x32_bf16 v[64:67], v[132:135], v[216:219], v[64:67]
  v_cvt_pk_bf16_f32 v104, v104, v128
  v_cvt_pk_bf16_f32 v105, v105, v129
  v_mul_f32 v17, v86, v17
  v_mfma_f32_16x16x32_bf16 v[64:67], v[100:103], v[232:235], v[64:67]
  s_waitcnt lgkmcnt(0)
  s_barrier
  v_mfma_f32_16x16x32_bf16 v[64:67], v[60:63], v[248:251], v[64:67]
  s_or_b32 s6, vcc_lo, vcc_hi
  ds_read_b128 a[244:247], v3 offset:0
  v_cvt_pk_bf16_f32 v106, v106, v130
  v_cvt_pk_bf16_f32 v107, v107, v131
  v_mfma_f32_16x16x32_bf16 v[64:67], v[116:119], a[224:227], v[64:67]
  buffer_store_dword v104, v8, s[24:27], s35 offen offset:0 nt
  v_mul_f32 v18, v86, v18
  v_mfma_f32_16x16x32_bf16 v[120:123], v[116:119], a[228:231], 0
  ds_read_b128 a[248:251], v3 offset:4096
  ds_read_b128 a[252:255], v3 offset:8192
  v_mul_f32 v19, v86, v19
  v_mfma_f32_16x16x32_bf16 v[120:123], v[60:63], v[252:255], v[120:123]
  buffer_store_dword v105, v8, s[24:27], s35 offen offset:384 nt
  v_cvt_pk_bf16_f32 v16, v16, v17
  v_mfma_f32_16x16x32_bf16 v[120:123], v[100:103], v[236:239], v[120:123]
  ds_read_b128 v[60:63], v3 offset:12288
  ds_read_b128 v[92:95], v3 offset:16384
  v_cvt_pk_bf16_f32 v17, v18, v19
  v_mfma_f32_16x16x32_bf16 v[120:123], v[132:135], v[220:223], v[120:123]
  buffer_store_dword v106, v8, s[24:27], s35 offen offset:768 nt
  v_mul_f32 v68, v86, v68
  v_mfma_f32_16x16x32_bf16 v[120:123], v[112:115], v[204:207], v[120:123]
  s_waitcnt lgkmcnt(2)
  ds_read_b128 v[100:103], v3 offset:20480
  v_mul_f32 v69, v86, v69
  v_mul_f32 v70, v86, v70
  v_mfma_f32_16x16x32_bf16 v[120:123], v[108:111], v[188:191], v[120:123]
  buffer_store_dword v107, v8, s[24:27], s35 offen offset:1152 nt
  v_mul_f32 v71, v86, v71
  v_mfma_f32_16x16x32_bf16 v[96:99], a[244:247], v[184:187], 0
  s_add_u32 s35, s35, s98
  v_cvt_pk_bf16_f32 v68, v68, v69
  v_cvt_pk_bf16_f32 v69, v70, v71
  v_mul_f32 v72, v86, v72
  v_mfma_f32_16x16x32_bf16 v[96:99], a[248:251], v[200:203], v[96:99]
  v_mul_f32 v73, v86, v73
  v_mul_f32 v74, v86, v74
  v_mul_f32 v75, v86, v75
  v_mfma_f32_16x16x32_bf16 v[96:99], a[252:255], v[216:219], v[96:99]
  s_waitcnt lgkmcnt(1)
  v_cvt_pk_bf16_f32 v64, v64, v120
  v_cvt_pk_bf16_f32 v65, v65, v121
  v_cvt_pk_bf16_f32 v72, v72, v73
  v_mfma_f32_16x16x32_bf16 v[96:99], v[60:63], v[232:235], v[96:99]
L_hop_2_1:
  s_cbranch_execz L_hop_2_2
  s_waitcnt lgkmcnt(0)
  v_cvt_pk_bf16_f32 v66, v66, v122
  v_cvt_pk_bf16_f32 v67, v67, v123
  v_cvt_pk_bf16_f32 v73, v74, v75
  v_mfma_f32_16x16x32_bf16 v[96:99], v[92:95], v[248:251], v[96:99]
  buffer_store_dword v64, v7, s[24:27], s36 offen offset:0 nt
  v_mul_f32 v80, v78, v80
  v_mfma_f32_16x16x32_bf16 v[96:99], v[100:103], a[224:227], v[96:99]
  v_mul_f32 v81, v78, v81
  v_mul_f32 v82, v78, v82
  v_mul_f32 v83, v78, v83
  v_mfma_f32_16x16x32_bf16 v[124:127], v[100:103], a[228:231], 0
  buffer_store_dword v65, v7, s[24:27], s36 offen offset:384 nt
  v_cvt_pk_bf16_f32 v80, v80, v81
  v_mfma_f32_16x16x32_bf16 v[124:127], v[92:95], v[252:255], v[124:127]
L_hop_3_1:
  s_cbranch_execz L_hop_3_2
  v_cvt_pk_bf16_f32 v81, v82, v83
  v_mul_f32 v56, v78, v56
  v_mul_f32 v57, v78, v57
  v_mfma_f32_16x16x32_bf16 v[124:127], v[60:63], v[236:239], v[124:127]
  buffer_store_dword v66, v7, s[24:27], s36 offen offset:768 nt
  v_mul_f32 v58, v78, v58
  v_mfma_f32_16x16x32_bf16 v[124:127], a[252:255], v[220:223], v[124:127]
  ds_read_b128 v[84:87], v4 offset:0
  ds_read_b128 v[104:107], v4 offset:4096
  v_mul_f32 v59, v78, v59
  v_mfma_f32_16x16x32_bf16 v[124:127], a[248:251], v[204:207], v[124:127]
  buffer_store_dword v67, v7, s[24:27], s36 offen offset:1152 nt
  v_cvt_pk_bf16_f32 v56, v56, v57
  v_mfma_f32_16x16x32_bf16 v[124:127], a[244:247], v[188:191], v[124:127]
  s_add_u32 s36, s36, s98
  ds_read_b128 v[108:111], v4 offset:8192
  ds_read_b128 v[112:115], v4 offset:12288
  v_cvt_pk_bf16_f32 v57, v58, v59
  v_mfma_f32_16x16x32_bf16 v[64:67], a[244:247], v[192:195], 0
  ds_read_b128 v[116:119], v4 offset:16384
  ds_read_b128 v[120:123], v4 offset:20480
  v_mul_f32 v88, v78, v88
  v_mfma_f32_16x16x32_bf16 v[64:67], a[248:251], v[208:211], v[64:67]
  v_mul_f32 v89, v78, v89
  v_mul_f32 v90, v78, v90
  v_mul_f32 v91, v78, v91
  v_mfma_f32_16x16x32_bf16 v[64:67], a[252:255], v[224:227], v[64:67]
  v_cvt_pk_bf16_f32 v96, v96, v124
  v_cvt_pk_bf16_f32 v97, v97, v125
  v_cvt_pk_bf16_f32 v88, v88, v89
  v_mfma_f32_16x16x32_bf16 v[64:67], v[60:63], v[240:243], v[64:67]
  v_cvt_pk_bf16_f32 v98, v98, v126
  v_cvt_pk_bf16_f32 v99, v99, v127
  v_cvt_pk_bf16_f32 v89, v90, v91
  v_mfma_f32_16x16x32_bf16 v[64:67], v[92:95], a[216:219], v[64:67]
  buffer_store_dword v96, v7, s[24:27], s33 offen offset:0 nt
  v_mov_b32 v0, s5
  v_mfma_f32_16x16x32_bf16 v[64:67], v[100:103], a[232:235], v[64:67]
  v_mov_b32 v1, s6
  v_mfma_f32_16x16x32_bf16 v[124:127], v[100:103], a[236:239], 0
  buffer_store_dword v97, v7, s[24:27], s33 offen offset:384 nt
  v_mfma_f32_16x16x32_bf16 v[124:127], v[92:95], a[220:223], v[124:127]
  ds_write2st64_b32 v5, v16, v17 offset0:2 offset1:6
  v_mfma_f32_16x16x32_bf16 v[124:127], v[60:63], v[244:247], v[124:127]
  buffer_store_dword v98, v7, s[24:27], s33 offen offset:768 nt
  v_mfma_f32_16x16x32_bf16 v[124:127], a[252:255], v[228:231], v[124:127]
  ds_write2st64_b32 v5, v68, v69 offset0:10 offset1:14
  v_mfma_f32_16x16x32_bf16 v[124:127], a[248:251], v[212:215], v[124:127]
  buffer_store_dword v99, v7, s[24:27], s33 offen offset:1152 nt
  v_mfma_f32_16x16x32_bf16 v[124:127], a[244:247], v[196:199], v[124:127]
  s_waitcnt lgkmcnt(2)
  ds_write2st64_b32 v5, v72, v73 offset0:18 offset1:22
  v_mfma_f32_16x16x32_bf16 v[16:19], v[84:87], v[184:187], 0
  ds_write2st64_b32 v5, v80, v81 offset0:3 offset1:7
  v_mfma_f32_16x16x32_bf16 v[16:19], v[104:107], v[200:203], v[16:19]
  ds_write2st64_b32 v5, v56, v57 offset0:11 offset1:15
  ds_write2st64_b32 v5, v88, v89 offset0:19 offset1:23
  ds_write_b32 v0, v1
  v_mfma_f32_16x16x32_bf16 v[16:19], v[108:111], v[216:219], v[16:19]
  v_cvt_pk_bf16_f32 v64, v64, v124
  v_cvt_pk_bf16_f32 v65, v65, v125
  v_mfma_f32_16x16x32_bf16 v[16:19], v[112:115], v[232:235], v[16:19]
  s_waitcnt lgkmcnt(0)
  s_barrier
  v_mfma_f32_16x16x32_bf16 v[16:19], v[116:119], v[248:251], v[16:19]
  v_cvt_pk_bf16_f32 v66, v66, v126
  v_cvt_pk_bf16_f32 v67, v67, v127
  v_mfma_f32_16x16x32_bf16 v[16:19], v[120:123], a[224:227], v[16:19]
  buffer_store_dword v64, v8, s[24:27], s33 offen offset:0 nt
  v_mfma_f32_16x16x32_bf16 v[76:79], v[120:123], a[228:231], 0
  ds_read_b128 a[244:247], v3 offset:512
  ds_read_b128 a[248:251], v3 offset:4608
  v_mfma_f32_16x16x32_bf16 v[76:79], v[116:119], v[252:255], v[76:79]
  buffer_store_dword v65, v8, s[24:27], s33 offen offset:384 nt
  v_mfma_f32_16x16x32_bf16 v[76:79], v[112:115], v[236:239], v[76:79]
  ds_read_b128 a[252:255], v3 offset:8704
  ds_read_b128 v[56:59], v3 offset:12800
  v_mfma_f32_16x16x32_bf16 v[76:79], v[108:111], v[220:223], v[76:79]
  buffer_store_dword v66, v8, s[24:27], s33 offen offset:768 nt
  v_mfma_f32_16x16x32_bf16 v[76:79], v[104:107], v[204:207], v[76:79]
  s_waitcnt lgkmcnt(2)
  ds_read_b128 v[68:71], v3 offset:16896
  ds_read_b128 v[72:75], v3 offset:20992
  v_mfma_f32_16x16x32_bf16 v[76:79], v[84:87], v[188:191], v[76:79]
  buffer_store_dword v67, v8, s[24:27], s33 offen offset:1152 nt
  v_mfma_f32_16x16x32_bf16 v[60:63], a[244:247], v[184:187], 0
  v_mov_b32 v0, 155648
  v_mfma_f32_16x16x32_bf16 v[60:63], a[248:251], v[200:203], v[60:63]
  s_waitcnt lgkmcnt(2)
  ds_read2_b32 v[96:97], v0 offset0:0 offset1:2
  ds_read2_b32 v[98:99], v0 offset0:4 offset1:6
  v_mfma_f32_16x16x32_bf16 v[60:63], a[252:255], v[216:219], v[60:63]
  v_cvt_pk_bf16_f32 v16, v16, v76
  v_cvt_pk_bf16_f32 v17, v17, v77
  v_mfma_f32_16x16x32_bf16 v[60:63], v[56:59], v[232:235], v[60:63]
  s_waitcnt lgkmcnt(2)
  v_cvt_pk_bf16_f32 v18, v18, v78
  v_cvt_pk_bf16_f32 v19, v19, v79
  v_mfma_f32_16x16x32_bf16 v[60:63], v[68:71], v[248:251], v[60:63]
  buffer_store_dword v16, v7, s[24:27], s34 offen offset:0 nt
  v_mfma_f32_16x16x32_bf16 v[60:63], v[72:75], a[224:227], v[60:63]
  v_mfma_f32_16x16x32_bf16 v[100:103], v[72:75], a[228:231], 0
  buffer_store_dword v17, v7, s[24:27], s34 offen offset:384 nt
  v_mfma_f32_16x16x32_bf16 v[100:103], v[68:71], v[252:255], v[100:103]
  s_waitcnt lgkmcnt(0)
  v_or3_b32 v96, v96, v97, v98
  v_or_b32 v96, v96, v99
  v_mfma_f32_16x16x32_bf16 v[100:103], v[56:59], v[236:239], v[100:103]
  buffer_store_dword v18, v7, s[24:27], s34 offen offset:768 nt
  v_mfma_f32_16x16x32_bf16 v[100:103], a[252:255], v[220:223], v[100:103]
  ds_read_b128 v[64:67], v4 offset:512
  ds_read_b128 v[76:79], v4 offset:4608
  v_mfma_f32_16x16x32_bf16 v[100:103], a[248:251], v[204:207], v[100:103]
  buffer_store_dword v19, v7, s[24:27], s34 offen offset:1152 nt
  v_mfma_f32_16x16x32_bf16 v[100:103], a[244:247], v[188:191], v[100:103]
  ds_read_b128 v[80:83], v4 offset:8704
  ds_read_b128 v[84:87], v4 offset:12800
  v_mfma_f32_16x16x32_bf16 v[16:19], a[244:247], v[192:195], 0
  ds_read_b128 v[88:91], v4 offset:16896
  ds_read_b128 v[92:95], v4 offset:20992
  v_mfma_f32_16x16x32_bf16 v[16:19], a[248:251], v[208:211], v[16:19]
  v_readfirstlane_b32 s49, v96
  v_mfma_f32_16x16x32_bf16 v[16:19], a[252:255], v[224:227], v[16:19]
  v_cvt_pk_bf16_f32 v60, v60, v100
  v_cvt_pk_bf16_f32 v61, v61, v101
  v_mfma_f32_16x16x32_bf16 v[16:19], v[56:59], v[240:243], v[16:19]
  v_cvt_pk_bf16_f32 v62, v62, v102
  v_cvt_pk_bf16_f32 v63, v63, v103
  v_mfma_f32_16x16x32_bf16 v[16:19], v[68:71], a[216:219], v[16:19]
  buffer_store_dword v60, v7, s[24:27], s35 offen offset:0 nt
  v_mfma_f32_16x16x32_bf16 v[16:19], v[72:75], a[232:235], v[16:19]
  v_mfma_f32_16x16x32_bf16 v[96:99], v[72:75], a[236:239], 0
  buffer_store_dword v61, v7, s[24:27], s35 offen offset:384 nt
  v_mfma_f32_16x16x32_bf16 v[96:99], v[68:71], a[220:223], v[96:99]
  v_mfma_f32_16x16x32_bf16 v[96:99], v[56:59], v[244:247], v[96:99]
  buffer_store_dword v62, v7, s[24:27], s35 offen offset:768 nt
  v_mfma_f32_16x16x32_bf16 v[96:99], a[252:255], v[228:231], v[96:99]
  v_mfma_f32_16x16x32_bf16 v[96:99], a[248:251], v[212:215], v[96:99]
L_hop_0_2:
  s_cbranch_execz L_hop_0_3
  buffer_store_dword v63, v7, s[24:27], s35 offen offset:1152 nt
  v_mfma_f32_16x16x32_bf16 v[96:99], a[244:247], v[196:199], v[96:99]
  s_waitcnt lgkmcnt(0)
  v_mfma_f32_16x16x32_bf16 v[56:59], v[64:67], v[184:187], 0
  v_mfma_f32_16x16x32_bf16 v[56:59], v[76:79], v[200:203], v[56:59]
  v_mfma_f32_16x16x32_bf16 v[56:59], v[80:83], v[216:219], v[56:59]
  v_cvt_pk_bf16_f32 v16, v16, v96
  v_cvt_pk_bf16_f32 v17, v17, v97
  v_mfma_f32_16x16x32_bf16 v[56:59], v[84:87], v[232:235], v[56:59]
  v_cvt_pk_bf16_f32 v18, v18, v98
  v_cvt_pk_bf16_f32 v19, v19, v99
  v_mfma_f32_16x16x32_bf16 v[56:59], v[88:91], v[248:251], v[56:59]
  buffer_store_dword v16, v8, s[24:27], s35 offen offset:0 nt
  v_mfma_f32_16x16x32_bf16 v[56:59], v[92:95], a[224:227], v[56:59]
  v_mfma_f32_16x16x32_bf16 v[60:63], v[92:95], a[228:231], 0
  buffer_store_dword v17, v8, s[24:27], s35 offen offset:384 nt
  v_mfma_f32_16x16x32_bf16 v[60:63], v[88:91], v[252:255], v[60:63]
  v_mfma_f32_16x16x32_bf16 v[60:63], v[84:87], v[236:239], v[60:63]
  buffer_store_dword v18, v8, s[24:27], s35 offen offset:768 nt
  v_mfma_f32_16x16x32_bf16 v[60:63], v[80:83], v[220:223], v[60:63]
  v_mfma_f32_16x16x32_bf16 v[60:63], v[76:79], v[204:207], v[60:63]
  buffer_store_dword v19, v8, s[24:27], s35 offen offset:1152 nt
  v_mfma_f32_16x16x32_bf16 v[60:63], v[64:67], v[188:191], v[60:63]
  s_nop 7
  v_cvt_pk_bf16_f32 v56, v56, v60
  v_cvt_pk_bf16_f32 v57, v57, v61
  v_cvt_pk_bf16_f32 v58, v58, v62
  v_cvt_pk_bf16_f32 v59, v59, v63
  buffer_store_dword v56, v7, s[24:27], s36 offen offset:0 nt
  buffer_store_dword v57, v7, s[24:27], s36 offen offset:384 nt
  buffer_store_dword v58, v7, s[24:27], s36 offen offset:768 nt
  buffer_store_dword v59, v7, s[24:27], s36 offen offset:1152 nt
  s_cmp_lg_u32 s49, 0
  s_cbranch_scc1 L_safe
L_fin:
L_end:
  s_endpgm
L_hop_1_2:
  s_cbranch_execz L_hop_1_3
L_pad3489:
L_k2:
  s_cmp_lg_u32 s59, 10
  s_cbranch_scc1 L_k7
  s_waitcnt vmcnt(30)
  v_mfma_f32_16x16x32_bf16 v[104:107], a[0:3], v[92:95], 0
  s_sub_u32 s49, s19, s18
  s_sub_u32 s50, s15, s99
  s_add_u32 s50, s50, 45360
  v_mfma_f32_16x16x32_bf16 v[104:107], a[12:15], v[96:99], v[104:107]
  s_mul_i32 s49, s49, s50
  s_mul_hi_u32 s49, s49, 384088
  s_add_u32 s49, s49, s19
  v_mfma_f32_16x16x32_bf16 v[104:107], a[24:27], v[136:139], v[104:107]
  s_and_b32 s50, s2, 7
  v_cvt_pk_bf16_f32 v66, v132, v133
  v_cvt_pk_bf16_f32 v67, v134, v135
  v_mfma_f32_16x16x32_bf16 v[104:107], a[36:39], v[116:119], v[104:107]
  s_waitcnt lgkmcnt(0)
  s_sub_u32 s49, s49, 1024
  v_subrev_u32 v54, s49, v52
  v_mfma_f32_16x16x32_bf16 v[104:107], a[48:51], v[80:83], v[104:107]
  v_subrev_u32 v55, s49, v53
  v_max_u32 v126, v54, v55
  v_mfma_f32_16x16x32_bf16 v[104:107], a[60:63], v[84:87], v[104:107]
  v_bfe_u32 v74, v11, 3, 3
  v_lshrrev_b32 v75, 6, v11
  v_mfma_f32_16x16x32_bf16 v[88:91], a[64:67], v[84:87], 0
  v_lshl_add_u32 v54, v54, 3, v74
  v_lshl_add_u32 v55, v55, 3, v75
  v_mfma_f32_16x16x32_bf16 v[88:91], a[52:55], v[80:83], v[88:91]
  v_readlane_b32 s12, v52, s50
  v_cmp_lt_u32 vcc, 2047, v126
  v_mfma_f32_16x16x32_bf16 v[88:91], a[40:43], v[116:119], v[88:91]
  v_mul_f32 v104, s42, v104
  v_mul_f32 v105, s42, v105
  v_mfma_f32_16x16x32_bf16 v[88:91], a[28:31], v[136:139], v[88:91]
  v_mul_f32 v106, s42, v106
  v_mul_f32 v107, s42, v107
  v_mfma_f32_16x16x32_bf16 v[88:91], a[16:19], v[96:99], v[88:91]
  v_cvt_pk_bf16_f32 v18, v104, v105
  v_cvt_pk_bf16_f32 v19, v106, v107
  v_mfma_f32_16x16x32_bf16 v[88:91], a[4:7], v[92:95], v[88:91]
  v_and_b32 v126, 56, v11
  v_mfma_f32_16x16x32_bf16 v[108:111], a[8:11], v[92:95], 0
  s_or_b32 s51, vcc_lo, vcc_hi
  v_cmp_lt_u32 vcc, v54, v55
  v_mfma_f32_16x16x32_bf16 v[108:111], a[20:23], v[96:99], v[108:111]
  s_sub_u32 s52, s12, s49
  s_sub_u32 s52, s52, 960
  s_lshr_b32 s52, s52, 7
  v_mfma_f32_16x16x32_bf16 v[108:111], a[32:35], v[136:139], v[108:111]
  s_or_b32 s51, s51, s52
  v_mul_f32 v88, s42, v88
  v_mul_f32 v89, s42, v89
  v_mfma_f32_16x16x32_bf16 v[108:111], a[44:47], v[116:119], v[108:111]
  v_mul_f32 v90, s42, v90
  v_mul_f32 v91, s42, v91
  v_mfma_f32_16x16x32_bf16 v[108:111], a[56:59], v[80:83], v[108:111]
  v_cvt_pk_bf16_f32 v104, v88, v89
  v_cvt_pk_bf16_f32 v105, v90, v91
  v_mfma_f32_16x16x32_bf16 v[108:111], a[68:71], v[84:87], v[108:111]
  v_lshrrev_b64 v[74:75], v126, vcc
  v_and_b32 v55, 0xff, v74
  v_mfma_f32_16x16x32_bf16 v[112:115], a[132:135], v[84:87], 0
  v_bcnt_u32_b32 v55, v55, 0
  v_mfma_f32_16x16x32_bf16 v[112:115], a[120:123], v[80:83], v[112:115]
  v_readlane_b32 s52, v55, s50
  v_mfma_f32_16x16x32_bf16 v[112:115], a[108:111], v[116:119], v[112:115]
  v_mul_f32 v108, s42, v108
  v_mul_f32 v109, s42, v109
  v_mfma_f32_16x16x32_bf16 v[112:115], a[96:99], v[136:139], v[112:115]
  s_sub_u32 s52, 7, s52
  v_mul_f32 v110, s42, v110
  v_mul_f32 v111, s42, v111
  v_mfma_f32_16x16x32_bf16 v[112:115], a[84:87], v[96:99], v[112:115]
  v_cvt_pk_bf16_f32 v106, v108, v109
  v_cvt_pk_bf16_f32 v107, v110, v111
  v_mfma_f32_16x16x32_bf16 v[112:115], a[72:75], v[92:95], v[112:115]
  v_cmp_eq_u32 vcc, s52, v55
  v_mfma_f32_16x16x32_bf16 v[88:91], a[76:79], v[92:95], 0
  v_mfma_f32_16x16x32_bf16 v[88:91], a[88:91], v[96:99], v[88:91]
  s_ff1_i32_b32 s52, vcc_lo
  s_and_b32 s52, s52, 7
  v_readlane_b32 s53, v54, s52
  v_mfma_f32_16x16x32_bf16 v[88:91], a[100:103], v[136:139], v[88:91]
  v_cvt_pk_bf16_f32 v128, v112, v113
  v_cvt_pk_bf16_f32 v129, v114, v115
  v_mfma_f32_16x16x32_bf16 v[88:91], a[112:115], v[116:119], v[88:91]
  s_lshr_b32 s53, s53, 3
  s_add_u32 s53, s53, s49
  s_sub_u32 s49, s53, s12
  v_mfma_f32_16x16x32_bf16 v[88:91], a[124:127], v[80:83], v[88:91]
  s_cmp_gt_i32 s49, 0
  s_cselect_b32 s45, 2, 1
  s_cselect_b32 s12, s53, s12
  v_mfma_f32_16x16x32_bf16 v[88:91], a[136:139], v[84:87], v[88:91]
  s_cselect_b32 s53, s52, s50
  s_cselect_b32 s96, 1, 6
  s_lshl_b32 s96, s96, 11
  v_mfma_f32_16x16x32_bf16 v[108:111], a[140:143], v[84:87], 0
  s_abs_i32 s49, s49
  s_cmp_lt_u32 s49, 235
  s_cselect_b32 s51, 1, s51
  v_mfma_f32_16x16x32_bf16 v[108:111], a[128:131], v[80:83], v[108:111]
  s_cmp_lt_u32 s49, 400
  s_cselect_b32 s14, 8, 0
  s_xnor_b32 s13, s12, s14
  v_mfma_f32_16x16x32_bf16 v[108:111], a[116:119], v[116:119], v[108:111]
  s_cmp_eq_u32 s51, 0
  v_cvt_pk_bf16_f32 v130, v88, v89
  v_cvt_pk_bf16_f32 v131, v90, v91
  v_mfma_f32_16x16x32_bf16 v[108:111], a[104:107], v[136:139], v[108:111]
  s_cselect_b32 s45, s45, 0
  s_cselect_b32 s96, s96, 0
  s_andn2_b32 s51, s2, 7
  v_mfma_f32_16x16x32_bf16 v[108:111], a[92:95], v[96:99], v[108:111]
  s_add_u32 s51, s51, s53
  s_lshl_b32 s51, s51, 9
  s_add_u32 s44, s51, 2097152
  v_mfma_f32_16x16x32_bf16 v[108:111], a[80:83], v[92:95], v[108:111]
  s_lshr_b32 s49, s45, 1
  s_lshl_b32 s49, s49, s52
  s_lshl_b32 s49, s49, s14
  v_mfma_f32_16x16x32_bf16 v[88:91], v[92:95], a[144:147], 0
  s_lshl_b32 s54, s3, 2
  s_add_u32 s54, s54, 155712
  v_mov_b32 v54, s54
  v_mfma_f32_16x16x32_bf16 v[88:91], v[96:99], a[156:159], v[88:91]
  v_mov_b32 v55, s49
  v_mfma_f32_16x16x32_bf16 v[88:91], v[136:139], a[168:171], v[88:91]
  v_cvt_pk_bf16_f32 v132, v108, v109
  v_cvt_pk_bf16_f32 v133, v110, v111
  v_mfma_f32_16x16x32_bf16 v[88:91], v[116:119], a[180:183], v[88:91]
  ds_read_b128 a[244:247], v1 offset:22528
  v_mfma_f32_16x16x32_bf16 v[88:91], v[80:83], a[192:195], v[88:91]
  ds_read_b128 a[248:251], v0 offset:22528
  v_mfma_f32_16x16x32_bf16 v[88:91], v[84:87], a[204:207], v[88:91]
  ds_read_b128 a[252:255], v1 offset:14336
  v_mfma_f32_16x16x32_bf16 v[140:143], v[84:87], a[208:211], 0
  ds_read_b128 v[144:147], v0 offset:14336
  v_mfma_f32_16x16x32_bf16 v[140:143], v[80:83], a[196:199], v[140:143]
  ds_read_b128 v[148:151], v1 offset:6144
  v_mfma_f32_16x16x32_bf16 v[140:143], v[116:119], a[184:187], v[140:143]
  v_cvt_pk_bf16_f32 v108, v88, v89
  v_cvt_pk_bf16_f32 v109, v90, v91
  v_mfma_f32_16x16x32_bf16 v[140:143], v[136:139], a[172:175], v[140:143]
  ds_read_b128 v[152:155], v0 offset:6144
  v_mfma_f32_16x16x32_bf16 v[140:143], v[96:99], a[160:163], v[140:143]
  ds_write_b32 v54, v55
  v_mfma_f32_16x16x32_bf16 v[140:143], v[92:95], a[148:151], v[140:143]
  v_mfma_f32_16x16x32_bf16 v[88:91], v[92:95], a[152:155], 0
  v_mfma_f32_16x16x32_bf16 v[88:91], v[96:99], a[164:167], v[88:91]
  v_mfma_f32_16x16x32_bf16 v[88:91], v[136:139], a[176:179], v[88:91]
  s_waitcnt lgkmcnt(0)
  v_cvt_pk_bf16_f32 v112, v140, v141
  v_cvt_pk_bf16_f32 v113, v142, v143
  v_mfma_f32_16x16x32_bf16 v[88:91], v[116:119], a[188:191], v[88:91]
  s_branch L_r259
L_hop_2_2:
  s_cbranch_execz L_walk
L_pad3648:
L_k7:
  s_cmp_lg_u32 s59, 7
  s_cbranch_scc1 L_kh
  v_mfma_f32_16x16x32_bf16 v[104:107], a[0:3], v[92:95], 0
  s_waitcnt lgkmcnt(0)
  s_sub_u32 s49, s16, s18
  s_sub_u32 s50, s15, s60
  v_mfma_f32_16x16x32_bf16 v[104:107], a[12:15], v[96:99], v[104:107]
  s_add_u32 s50, s50, 45360
  s_mul_i32 s49, s49, s50
  s_mul_hi_u32 s49, s49, 384088
  v_mfma_f32_16x16x32_bf16 v[104:107], a[24:27], v[136:139], v[104:107]
  s_add_u32 s49, s49, s16
  v_cvt_pk_bf16_f32 v66, v132, v133
  v_cvt_pk_bf16_f32 v67, v134, v135
  v_mfma_f32_16x16x32_bf16 v[104:107], a[36:39], v[116:119], v[104:107]
  s_and_b32 s51, s2, 7
  s_lshl_b32 s51, s51, 3
  v_mfma_f32_16x16x32_bf16 v[104:107], a[48:51], v[80:83], v[104:107]
  v_and_b32 v74, 56, v11
  v_lshl_add_u32 v54, v74, 3, s51
  v_mfma_f32_16x16x32_bf16 v[104:107], a[60:63], v[84:87], v[104:107]
  s_lshl_b32 s51, s51, 3
  v_add_u32 v55, s51, v74
  v_mov_b32 v74, s49
  v_mfma_f32_16x16x32_bf16 v[88:91], a[64:67], v[84:87], 0
  buffer_store_dword v74, v54, s[20:23], s44 offen sc1
  v_mfma_f32_16x16x32_bf16 v[88:91], a[52:55], v[80:83], v[88:91]
  v_mfma_f32_16x16x32_bf16 v[88:91], a[40:43], v[116:119], v[88:91]
  v_mul_f32 v104, s42, v104
  v_mul_f32 v105, s42, v105
  v_mfma_f32_16x16x32_bf16 v[88:91], a[28:31], v[136:139], v[88:91]
  v_mul_f32 v106, s42, v106
  v_mul_f32 v107, s42, v107
  v_mfma_f32_16x16x32_bf16 v[88:91], a[16:19], v[96:99], v[88:91]
  v_cvt_pk_bf16_f32 v18, v104, v105
  v_cvt_pk_bf16_f32 v19, v106, v107
  v_mfma_f32_16x16x32_bf16 v[88:91], a[4:7], v[92:95], v[88:91]
  buffer_store_dword v74, v55, s[20:23], s44 offen offset:4 sc1
  v_mfma_f32_16x16x32_bf16 v[108:111], a[8:11], v[92:95], 0
  s_branch L_r220
L_hop_3_2:
  s_cbranch_execz L_walk
L_pad3690:
L_kh:
  s_cmp_lt_u32 s59, 14
  s_cbranch_scc1 L_k11
  s_waitcnt lgkmcnt(0)
  v_mfma_f32_16x16x32_bf16 v[104:107], a[132:135], v[84:87], 0
  s_lshl_b32 s5, s3, 3
  v_mfma_f32_16x16x32_bf16 v[104:107], a[120:123], v[80:83], v[104:107]
  s_add_u32 s5, s5, 155648
  v_mov_b32 v54, s5
  v_mfma_f32_16x16x32_bf16 v[104:107], a[108:111], v[116:119], v[104:107]
  v_cvt_pk_bf16_f32 v66, v132, v133
  v_cvt_pk_bf16_f32 v67, v134, v135
  v_mfma_f32_16x16x32_bf16 v[104:107], a[96:99], v[136:139], v[104:107]
  ds_read_b128 a[244:247], v1 offset:22528
  v_mfma_f32_16x16x32_bf16 v[104:107], a[84:87], v[96:99], v[104:107]
  ds_read_b128 a[248:251], v0 offset:22528
  v_mfma_f32_16x16x32_bf16 v[104:107], a[72:75], v[92:95], v[104:107]
  ds_read_b128 a[252:255], v1 offset:14336
  v_mfma_f32_16x16x32_bf16 v[108:111], a[76:79], v[92:95], 0
  ds_read_b128 v[88:91], v0 offset:14336
  v_mfma_f32_16x16x32_bf16 v[108:111], a[88:91], v[96:99], v[108:111]
  ds_read_b128 v[112:115], v1 offset:6144
  v_mfma_f32_16x16x32_bf16 v[108:111], a[100:103], v[136:139], v[108:111]
  v_cvt_pk_bf16_f32 v140, v104, v105
  v_cvt_pk_bf16_f32 v141, v106, v107
  v_mfma_f32_16x16x32_bf16 v[108:111], a[112:115], v[116:119], v[108:111]
  ds_read_b128 v[148:151], v0 offset:6144
  v_cndmask_b32 v160, v32, v48, s[100:101]
  v_mfma_f32_16x16x32_bf16 v[108:111], a[124:127], v[80:83], v[108:111]
  v_cndmask_b32 v161, v33, v49, s[100:101]
  v_cndmask_b32 v162, v34, v50, s[100:101]
  v_mfma_f32_16x16x32_bf16 v[108:111], a[136:139], v[84:87], v[108:111]
  v_cndmask_b32 v163, v35, v51, s[100:101]
  v_cndmask_b32 v164, v28, v44, s[100:101]
  v_mfma_f32_16x16x32_bf16 v[128:131], a[140:143], v[84:87], 0
  v_cndmask_b32 v165, v29, v45, s[100:101]
  v_cndmask_b32 v166, v30, v46, s[100:101]
  v_mfma_f32_16x16x32_bf16 v[128:131], a[128:131], v[80:83], v[128:131]
  v_cndmask_b32 v167, v31, v47, s[100:101]
  v_cndmask_b32 v104, v24, v40, s[100:101]
  v_mfma_f32_16x16x32_bf16 v[128:131], a[116:119], v[116:119], v[128:131]
  v_cvt_pk_bf16_f32 v142, v108, v109
  v_cvt_pk_bf16_f32 v143, v110, v111
  v_mfma_f32_16x16x32_bf16 v[128:131], a[104:107], v[136:139], v[128:131]
  v_cndmask_b32 v105, v25, v41, s[100:101]
  v_cndmask_b32 v106, v26, v42, s[100:101]
  v_mfma_f32_16x16x32_bf16 v[128:131], a[92:95], v[96:99], v[128:131]
  v_cndmask_b32 v107, v27, v43, s[100:101]
  v_mfma_f32_16x16x32_bf16 v[128:131], a[80:83], v[92:95], v[128:131]
  s_waitcnt lgkmcnt(0)
  v_mfma_f32_16x16x32_bf16 v[108:111], a[132:135], a[244:247], 0
  v_mfma_f32_16x16x32_bf16 v[108:111], a[120:123], a[248:251], v[108:111]
  v_mfma_f32_16x16x32_bf16 v[108:111], a[108:111], a[252:255], v[108:111]
  v_cvt_pk_bf16_f32 v144, v128, v129
  v_cvt_pk_bf16_f32 v145, v130, v131
  v_mfma_f32_16x16x32_bf16 v[108:111], a[96:99], v[88:91], v[108:111]
  v_mfma_f32_16x16x32_bf16 v[108:111], a[84:87], v[112:115], v[108:111]
  s_waitcnt lgkmcnt(0)
  s_barrier
  v_mfma_f32_16x16x32_bf16 v[108:111], a[72:75], v[148:151], v[108:111]
  v_mfma_f32_16x16x32_bf16 v[128:131], a[76:79], v[148:151], 0
  v_mfma_f32_16x16x32_bf16 v[128:131], a[88:91], v[112:115], v[128:131]
  v_mfma_f32_16x16x32_bf16 v[128:131], a[100:103], v[88:91], v[128:131]
  v_cvt_pk_bf16_f32 v152, v108, v109
  v_cvt_pk_bf16_f32 v153, v110, v111
  v_mfma_f32_16x16x32_bf16 v[128:131], a[112:115], a[252:255], v[128:131]
  v_mfma_f32_16x16x32_bf16 v[128:131], a[124:127], a[248:251], v[128:131]
  v_mfma_f32_16x16x32_bf16 v[128:131], a[136:139], a[244:247], v[128:131]
  v_mfma_f32_16x16x32_bf16 v[108:111], a[140:143], a[244:247], 0
  v_mfma_f32_16x16x32_bf16 v[108:111], a[128:131], a[248:251], v[108:111]
  v_mfma_f32_16x16x32_bf16 v[108:111], a[116:119], a[252:255], v[108:111]
  v_cvt_pk_bf16_f32 v154, v128, v129
  v_cvt_pk_bf16_f32 v155, v130, v131
  v_mfma_f32_16x16x32_bf16 v[108:111], a[104:107], v[88:91], v[108:111]
  v_mfma_f32_16x16x32_bf16 v[108:111], a[92:95], v[112:115], v[108:111]
  v_mfma_f32_16x16x32_bf16 v[108:111], a[80:83], v[148:151], v[108:111]
  v_mfma_f32_16x16x32_bf16 v[128:131], v[70:73], v[76:79], v[36:39]
  v_mfma_f32_16x16x32_bf16 v[128:131], v[68:71], v[12:15], v[128:131]
  v_mfma_f32_16x16x32_bf16 v[132:135], v[122:125], v[76:79], v[32:35]
  v_cvt_pk_bf16_f32 v156, v108, v109
  v_cvt_pk_bf16_f32 v157, v110, v111
  v_mfma_f32_16x16x32_bf16 v[132:135], v[120:123], v[12:15], v[132:135]
  v_mfma_f32_16x16x32_bf16 v[168:171], v[142:145], v[76:79], v[164:167]
  v_exp_f32 v128, v128
  v_mfma_f32_16x16x32_bf16 v[168:171], v[140:143], v[12:15], v[168:171]
  v_exp_f32 v129, v129
  v_mfma_f32_16x16x32_bf16 v[172:175], v[154:157], v[76:79], v[104:107]
  v_exp_f32 v130, v130
  v_mfma_f32_16x16x32_bf16 v[172:175], v[152:155], v[12:15], v[172:175]
  v_exp_f32 v131, v131
  v_mfma_f32_16x16x32_bf16 v[104:107], v[68:71], v[100:103], v[40:43]
  v_exp_f32 v132, v132
  v_mfma_f32_16x16x32_bf16 v[104:107], v[70:73], v[14:17], v[104:107]
  v_exp_f32 v133, v133
  v_mfma_f32_16x16x32_bf16 v[108:111], v[120:123], v[100:103], v[36:39]
  v_exp_f32 v134, v134
  v_mfma_f32_16x16x32_bf16 v[108:111], v[122:125], v[14:17], v[108:111]
  v_exp_f32 v135, v135
  v_mfma_f32_16x16x32_bf16 v[72:75], v[140:143], v[100:103], v[160:163]
  v_exp_f32 v168, v168
  v_mfma_f32_16x16x32_bf16 v[72:75], v[142:145], v[14:17], v[72:75]
  v_exp_f32 v169, v169
  v_mfma_f32_16x16x32_bf16 v[68:71], v[152:155], v[100:103], v[164:167]
  v_exp_f32 v170, v170
  v_mfma_f32_16x16x32_bf16 v[68:71], v[154:157], v[14:17], v[68:71]
  v_exp_f32 v171, v171
  v_mfma_f32_16x16x32_bf16 v[100:103], v[92:95], a[144:147], 0
  v_exp_f32 v172, v172
  v_mfma_f32_16x16x32_bf16 v[100:103], v[96:99], a[156:159], v[100:103]
  v_exp_f32 v173, v173
  v_mfma_f32_16x16x32_bf16 v[100:103], v[136:139], a[168:171], v[100:103]
  v_exp_f32 v174, v174
  v_mfma_f32_16x16x32_bf16 v[100:103], v[116:119], a[180:183], v[100:103]
  v_exp_f32 v175, v175
  v_mfma_f32_16x16x32_bf16 v[100:103], v[80:83], a[192:195], v[100:103]
  v_cvt_pk_bf16_f32 v128, v128, v129
  v_cvt_pk_bf16_f32 v129, v130, v131
  v_mfma_f32_16x16x32_bf16 v[100:103], v[84:87], a[204:207], v[100:103]
  v_cvt_pk_bf16_f32 v130, v132, v133
  v_cvt_pk_bf16_f32 v131, v134, v135
  v_mfma_f32_16x16x32_bf16 v[124:127], v[84:87], a[208:211], 0
  v_cvt_pk_bf16_f32 v132, v168, v169
  v_cvt_pk_bf16_f32 v133, v170, v171
  v_mfma_f32_16x16x32_bf16 v[124:127], v[80:83], a[196:199], v[124:127]
  v_cvt_pk_bf16_f32 v134, v172, v173
  v_cvt_pk_bf16_f32 v135, v174, v175
  v_mfma_f32_16x16x32_bf16 v[124:127], v[116:119], a[184:187], v[124:127]
  v_cvt_pk_bf16_f32 v76, v100, v101
  v_cvt_pk_bf16_f32 v77, v102, v103
  v_mfma_f32_16x16x32_bf16 v[124:127], v[136:139], a[172:175], v[124:127]
  v_exp_f32 v104, v104
  v_mfma_f32_16x16x32_bf16 v[124:127], v[96:99], a[160:163], v[124:127]
  v_exp_f32 v105, v105
  v_mfma_f32_16x16x32_bf16 v[124:127], v[92:95], a[148:151], v[124:127]
  v_exp_f32 v106, v106
  v_mfma_f32_16x16x32_bf16 v[100:103], v[92:95], a[152:155], 0
  v_exp_f32 v107, v107
  v_mfma_f32_16x16x32_bf16 v[100:103], v[96:99], a[164:167], v[100:103]
  v_exp_f32 v108, v108
  v_mfma_f32_16x16x32_bf16 v[100:103], v[136:139], a[176:179], v[100:103]
  v_cvt_pk_bf16_f32 v120, v124, v125
  v_cvt_pk_bf16_f32 v121, v126, v127
  v_mfma_f32_16x16x32_bf16 v[100:103], v[116:119], a[188:191], v[100:103]
  v_exp_f32 v109, v109
  v_mfma_f32_16x16x32_bf16 v[100:103], v[80:83], a[200:203], v[100:103]
  v_exp_f32 v110, v110
  v_mfma_f32_16x16x32_bf16 v[100:103], v[84:87], a[212:215], v[100:103]
  v_exp_f32 v111, v111
  v_mfma_f32_16x16x32_bf16 v[136:139], v[148:151], a[144:147], 0
  v_exp_f32 v72, v72
  v_mfma_f32_16x16x32_bf16 v[136:139], v[112:115], a[156:159], v[136:139]
  v_exp_f32 v73, v73
  v_mfma_f32_16x16x32_bf16 v[136:139], v[88:91], a[168:171], v[136:139]
  v_cvt_pk_bf16_f32 v124, v100, v101
  v_cvt_pk_bf16_f32 v125, v102, v103
  v_mfma_f32_16x16x32_bf16 v[136:139], a[252:255], a[180:183], v[136:139]
  ds_read_b128 v[80:83], v3 offset:0
  v_cvt_pk_bf16_f32 v104, v104, v105
  v_mfma_f32_16x16x32_bf16 v[136:139], a[248:251], a[192:195], v[136:139]
  ds_read_b128 v[84:87], v3 offset:4096
  v_cvt_pk_bf16_f32 v105, v106, v107
  v_mfma_f32_16x16x32_bf16 v[136:139], a[244:247], a[204:207], v[136:139]
  ds_read_b128 v[92:95], v3 offset:8192
  v_cvt_pk_bf16_f32 v106, v108, v109
  v_mfma_f32_16x16x32_bf16 v[140:143], a[244:247], a[208:211], 0
  ds_read_b128 v[96:99], v3 offset:12288
  v_cvt_pk_bf16_f32 v107, v110, v111
  v_mfma_f32_16x16x32_bf16 v[140:143], a[248:251], a[196:199], v[140:143]
  ds_read_b128 v[100:103], v3 offset:16384
  v_cvt_pk_bf16_f32 v108, v72, v73
  v_mfma_f32_16x16x32_bf16 v[140:143], a[252:255], a[184:187], v[140:143]
  v_cvt_pk_bf16_f32 v78, v136, v137
  v_cvt_pk_bf16_f32 v79, v138, v139
  v_mfma_f32_16x16x32_bf16 v[140:143], v[88:91], a[172:175], v[140:143]
  ds_read_b128 v[116:119], v3 offset:20480
  v_mfma_f32_16x16x32_bf16 v[140:143], v[112:115], a[160:163], v[140:143]
  v_exp_f32 v74, v74
  v_mfma_f32_16x16x32_bf16 v[140:143], v[148:151], a[148:151], v[140:143]
  v_exp_f32 v75, v75
  v_mfma_f32_16x16x32_bf16 v[144:147], v[148:151], a[152:155], 0
  v_exp_f32 v68, v68
  v_mfma_f32_16x16x32_bf16 v[144:147], v[112:115], a[164:167], v[144:147]
  v_exp_f32 v69, v69
  v_mfma_f32_16x16x32_bf16 v[144:147], v[88:91], a[176:179], v[144:147]
  v_cvt_pk_bf16_f32 v122, v140, v141
  v_cvt_pk_bf16_f32 v123, v142, v143
  v_mfma_f32_16x16x32_bf16 v[144:147], a[252:255], a[188:191], v[144:147]
  v_mov_b64 v[136:137], 0
  v_cvt_pk_bf16_f32 v109, v74, v75
  v_mfma_f32_16x16x32_bf16 v[144:147], a[248:251], a[200:203], v[144:147]
  v_exp_f32 v70, v70
  v_mfma_f32_16x16x32_bf16 v[144:147], a[244:247], a[212:215], v[144:147]
  s_waitcnt lgkmcnt(0)
  v_exp_f32 v71, v71
  v_mfma_f32_16x16x32_bf16 v[88:91], v[80:83], v[184:187], 0
  v_cvt_pk_bf16_f32 v110, v68, v69
  v_cvt_pk_bf16_f32 v111, v70, v71
  v_mfma_f32_16x16x32_bf16 v[88:91], v[84:87], v[200:203], v[88:91]
  v_mfma_f32_16x16x32_bf16 v[88:91], v[92:95], v[216:219], v[88:91]
  v_cvt_pk_bf16_f32 v126, v144, v145
  v_cvt_pk_bf16_f32 v127, v146, v147
  v_mfma_f32_16x16x32_bf16 v[88:91], v[96:99], v[232:235], v[88:91]
  v_mov_b64 v[68:69], 0
  v_mfma_f32_16x16x32_bf16 v[88:91], v[100:103], v[248:251], v[88:91]
  v_mfma_f32_16x16x32_bf16 v[88:91], v[116:119], a[224:227], v[88:91]
  v_smfmac_f32_16x16x64_bf16 v[136:139], a[240:243], v[128:135], v10
  v_mfma_f32_16x16x32_bf16 v[144:147], v[76:79], v[132:135], 0
  v_mfma_f32_16x16x32_bf16 v[144:147], v[56:59], v[128:131], v[144:147]
  v_mfma_f32_16x16x32_bf16 v[148:151], v[60:63], v[128:131], 0
L_hop_0_3:
  s_cbranch_execz L_walk
  v_mfma_f32_16x16x32_bf16 v[148:151], v[120:123], v[132:135], v[148:151]
  v_mfma_f32_16x16x32_bf16 v[140:143], v[124:127], v[132:135], 0
  v_add_f32 v136, v136, v137
  v_mfma_f32_16x16x32_bf16 v[140:143], v[64:67], v[128:131], v[140:143]
  v_rcp_f32 v138, v136
  v_smfmac_f32_16x16x64_bf16 v[68:71], a[240:243], v[104:111], v10
  v_mul_f32 v144, v138, v144
  v_mul_f32 v145, v138, v145
  v_mfma_f32_16x16x32_bf16 v[72:75], v[76:79], v[108:111], 0
  v_mul_f32 v146, v138, v146
  v_mul_f32 v147, v138, v147
  v_mfma_f32_16x16x32_bf16 v[72:75], v[56:59], v[104:107], v[72:75]
  v_cvt_pk_bf16_f32 v144, v144, v145
  v_cvt_pk_bf16_f32 v145, v146, v147
  v_mfma_f32_16x16x32_bf16 v[76:79], v[60:63], v[104:107], 0
  v_mul_f32 v148, v138, v148
  v_mul_f32 v149, v138, v149
  v_mfma_f32_16x16x32_bf16 v[76:79], v[120:123], v[108:111], v[76:79]
  v_mul_f32 v150, v138, v150
  v_mul_f32 v151, v138, v151
  v_mfma_f32_16x16x32_bf16 v[56:59], v[124:127], v[108:111], 0
  v_cvt_pk_bf16_f32 v148, v148, v149
  v_cvt_pk_bf16_f32 v149, v150, v151
  v_mfma_f32_16x16x32_bf16 v[56:59], v[64:67], v[104:107], v[56:59]
  v_mul_f32 v140, v138, v140
  v_mul_f32 v141, v138, v141
  v_mfma_f32_16x16x32_bf16 v[60:63], v[116:119], a[228:231], 0
  v_mul_f32 v142, v138, v142
  v_mul_f32 v143, v138, v143
  v_mfma_f32_16x16x32_bf16 v[60:63], v[100:103], v[252:255], v[60:63]
  v_cvt_pk_bf16_f32 v140, v140, v141
  v_cvt_pk_bf16_f32 v141, v142, v143
  v_mfma_f32_16x16x32_bf16 v[60:63], v[96:99], v[236:239], v[60:63]
  ds_read_b128 v[104:107], v4 offset:0
  ds_read_b128 v[108:111], v4 offset:4096
  v_mfma_f32_16x16x32_bf16 v[60:63], v[92:95], v[220:223], v[60:63]
  ds_read_b128 v[120:123], v4 offset:8192
  ds_read_b128 v[124:127], v4 offset:12288
  v_mfma_f32_16x16x32_bf16 v[60:63], v[84:87], v[204:207], v[60:63]
  ds_read_b128 v[128:131], v4 offset:16384
  ds_read_b128 v[132:135], v4 offset:20480
  v_mfma_f32_16x16x32_bf16 v[60:63], v[80:83], v[188:191], v[60:63]
  v_max3_f32 v9, v136, v138, v9
  v_add_f32 v68, v68, v69
  v_mfma_f32_16x16x32_bf16 v[112:115], v[80:83], v[192:195], 0
  ds_write2st64_b32 v5, v144, v145 offset0:0 offset1:4
  v_mfma_f32_16x16x32_bf16 v[112:115], v[84:87], v[208:211], v[112:115]
  ds_write2st64_b32 v5, v148, v149 offset0:8 offset1:12
  v_mfma_f32_16x16x32_bf16 v[112:115], v[92:95], v[224:227], v[112:115]
  v_cvt_pk_bf16_f32 v88, v88, v60
  v_cvt_pk_bf16_f32 v89, v89, v61
  v_mfma_f32_16x16x32_bf16 v[112:115], v[96:99], v[240:243], v[112:115]
  v_cvt_pk_bf16_f32 v90, v90, v62
  v_cvt_pk_bf16_f32 v91, v91, v63
  v_mfma_f32_16x16x32_bf16 v[112:115], v[100:103], a[216:219], v[112:115]
  buffer_store_dword v88, v7, s[24:27], s33 offen offset:0 nt
  v_mfma_f32_16x16x32_bf16 v[112:115], v[116:119], a[232:235], v[112:115]
  ds_write2st64_b32 v5, v140, v141 offset0:16 offset1:20
  v_mfma_f32_16x16x32_bf16 v[136:139], v[116:119], a[236:239], 0
  v_rcp_f32 v70, v68
  v_mfma_f32_16x16x32_bf16 v[136:139], v[100:103], a[220:223], v[136:139]
  buffer_store_dword v89, v7, s[24:27], s33 offen offset:384 nt
  v_mfma_f32_16x16x32_bf16 v[136:139], v[96:99], v[244:247], v[136:139]
  ds_read_b128 a[244:247], v3 offset:512
  ds_read_b128 a[248:251], v3 offset:4608
  v_mfma_f32_16x16x32_bf16 v[136:139], v[92:95], v[228:231], v[136:139]
  ds_read_b128 a[252:255], v3 offset:8704
  ds_read_b128 v[60:63], v3 offset:12800
  v_mfma_f32_16x16x32_bf16 v[136:139], v[84:87], v[212:215], v[136:139]
  buffer_store_dword v90, v7, s[24:27], s33 offen offset:768 nt
  v_mfma_f32_16x16x32_bf16 v[136:139], v[80:83], v[196:199], v[136:139]
  s_waitcnt lgkmcnt(7)
  ds_read_b128 v[64:67], v3 offset:16896
  ds_read_b128 v[84:87], v3 offset:20992
  v_mfma_f32_16x16x32_bf16 v[92:95], v[104:107], v[184:187], 0
  v_mul_f32 v72, v70, v72
  v_mul_f32 v73, v70, v73
  v_mfma_f32_16x16x32_bf16 v[92:95], v[108:111], v[200:203], v[92:95]
  buffer_store_dword v91, v7, s[24:27], s33 offen offset:1152 nt
  v_mfma_f32_16x16x32_bf16 v[92:95], v[120:123], v[216:219], v[92:95]
  v_cvt_pk_bf16_f32 v112, v112, v136
  v_cvt_pk_bf16_f32 v113, v113, v137
  v_mfma_f32_16x16x32_bf16 v[92:95], v[124:127], v[232:235], v[92:95]
  v_cvt_pk_bf16_f32 v114, v114, v138
  v_cvt_pk_bf16_f32 v115, v115, v139
  v_mfma_f32_16x16x32_bf16 v[92:95], v[128:131], v[248:251], v[92:95]
  buffer_store_dword v112, v8, s[24:27], s33 offen offset:0 nt
  v_mfma_f32_16x16x32_bf16 v[92:95], v[132:135], a[224:227], v[92:95]
  v_mul_f32 v74, v70, v74
  v_mul_f32 v75, v70, v75
  v_mfma_f32_16x16x32_bf16 v[80:83], v[132:135], a[228:231], 0
  v_cvt_pk_bf16_f32 v72, v72, v73
  v_cvt_pk_bf16_f32 v73, v74, v75
  v_mfma_f32_16x16x32_bf16 v[80:83], v[128:131], v[252:255], v[80:83]
  buffer_store_dword v113, v8, s[24:27], s33 offen offset:384 nt
  v_mfma_f32_16x16x32_bf16 v[80:83], v[124:127], v[236:239], v[80:83]
  v_mul_f32 v76, v70, v76
  v_mul_f32 v77, v70, v77
  v_mfma_f32_16x16x32_bf16 v[80:83], v[120:123], v[220:223], v[80:83]
  v_mul_f32 v78, v70, v78
  v_mul_f32 v79, v70, v79
  v_mfma_f32_16x16x32_bf16 v[80:83], v[108:111], v[204:207], v[80:83]
  buffer_store_dword v114, v8, s[24:27], s33 offen offset:768 nt
  v_mfma_f32_16x16x32_bf16 v[80:83], v[104:107], v[188:191], v[80:83]
  s_waitcnt lgkmcnt(0)
  v_cvt_pk_bf16_f32 v76, v76, v77
  v_cvt_pk_bf16_f32 v77, v78, v79
  v_mfma_f32_16x16x32_bf16 v[88:91], a[244:247], v[184:187], 0
  v_mul_f32 v56, v70, v56
  v_mul_f32 v57, v70, v57
  v_mfma_f32_16x16x32_bf16 v[88:91], a[248:251], v[200:203], v[88:91]
  buffer_store_dword v115, v8, s[24:27], s33 offen offset:1152 nt
  v_mfma_f32_16x16x32_bf16 v[88:91], a[252:255], v[216:219], v[88:91]
  s_add_u32 s33, s33, s98
  v_cvt_pk_bf16_f32 v92, v92, v80
  v_cvt_pk_bf16_f32 v93, v93, v81
  v_mfma_f32_16x16x32_bf16 v[88:91], v[60:63], v[232:235], v[88:91]
  v_cvt_pk_bf16_f32 v94, v94, v82
  v_cvt_pk_bf16_f32 v95, v95, v83
  v_mfma_f32_16x16x32_bf16 v[88:91], v[64:67], v[248:251], v[88:91]
  buffer_store_dword v92, v7, s[24:27], s34 offen offset:0 nt
  v_mfma_f32_16x16x32_bf16 v[88:91], v[84:87], a[224:227], v[88:91]
  v_mul_f32 v58, v70, v58
  v_mul_f32 v59, v70, v59
  v_mfma_f32_16x16x32_bf16 v[96:99], v[84:87], a[228:231], 0
  v_cvt_pk_bf16_f32 v56, v56, v57
  v_cvt_pk_bf16_f32 v57, v58, v59
  v_mfma_f32_16x16x32_bf16 v[96:99], v[64:67], v[252:255], v[96:99]
  buffer_store_dword v93, v7, s[24:27], s34 offen offset:384 nt
  v_mfma_f32_16x16x32_bf16 v[96:99], v[60:63], v[236:239], v[96:99]
  ds_read_b128 v[80:83], v4 offset:512
  v_max3_f32 v9, v68, v70, v9
  v_mfma_f32_16x16x32_bf16 v[96:99], a[252:255], v[220:223], v[96:99]
  ds_write2st64_b32 v5, v72, v73 offset0:1 offset1:5
  v_mfma_f32_16x16x32_bf16 v[96:99], a[248:251], v[204:207], v[96:99]
  buffer_store_dword v94, v7, s[24:27], s34 offen offset:768 nt
  v_mfma_f32_16x16x32_bf16 v[96:99], a[244:247], v[188:191], v[96:99]
  ds_write2st64_b32 v5, v76, v77 offset0:9 offset1:13
  v_mfma_f32_16x16x32_bf16 v[68:71], a[244:247], v[192:195], 0
  ds_write2st64_b32 v5, v56, v57 offset0:17 offset1:21
  v_mfma_f32_16x16x32_bf16 v[68:71], a[248:251], v[208:211], v[68:71]
  buffer_store_dword v95, v7, s[24:27], s34 offen offset:1152 nt
  v_mfma_f32_16x16x32_bf16 v[68:71], a[252:255], v[224:227], v[68:71]
  s_add_u32 s34, s34, s98
  v_cvt_pk_bf16_f32 v88, v88, v96
  v_cvt_pk_bf16_f32 v89, v89, v97
  v_mfma_f32_16x16x32_bf16 v[68:71], v[60:63], v[240:243], v[68:71]
  v_cvt_pk_bf16_f32 v90, v90, v98
  v_cvt_pk_bf16_f32 v91, v91, v99
  v_mfma_f32_16x16x32_bf16 v[68:71], v[64:67], a[216:219], v[68:71]
  buffer_store_dword v88, v7, s[24:27], s35 offen offset:0 nt
  v_mfma_f32_16x16x32_bf16 v[68:71], v[84:87], a[232:235], v[68:71]
  ds_read_b128 v[72:75], v4 offset:4608
  v_cmp_nge_f32 vcc, 0x53800000, v9
  v_mfma_f32_16x16x32_bf16 v[100:103], v[84:87], a[236:239], 0
  ds_read_b128 v[92:95], v4 offset:8704
  ds_read_b128 v[96:99], v4 offset:12800
  v_mfma_f32_16x16x32_bf16 v[100:103], v[64:67], a[220:223], v[100:103]
  buffer_store_dword v89, v7, s[24:27], s35 offen offset:384 nt
  v_mfma_f32_16x16x32_bf16 v[100:103], v[60:63], v[244:247], v[100:103]
  s_or_b32 s6, vcc_lo, vcc_hi
  ds_read_b128 v[76:79], v4 offset:16896
  v_mov_b32 v55, s6
  v_mfma_f32_16x16x32_bf16 v[100:103], a[252:255], v[228:231], v[100:103]
  ds_write_b32 v54, v55
  v_mfma_f32_16x16x32_bf16 v[100:103], a[248:251], v[212:215], v[100:103]
  buffer_store_dword v90, v7, s[24:27], s35 offen offset:768 nt
  v_mfma_f32_16x16x32_bf16 v[100:103], a[244:247], v[196:199], v[100:103]
  s_waitcnt lgkmcnt(8)
  ds_read_b128 v[64:67], v4 offset:20992
  v_xor_b32 v3, 40960, v3
  v_xor_b32 v4, 40960, v4
  v_mfma_f32_16x16x32_bf16 v[56:59], v[80:83], v[184:187], 0
  s_waitcnt lgkmcnt(1)
  s_barrier
  v_mfma_f32_16x16x32_bf16 v[56:59], v[72:75], v[200:203], v[56:59]
  buffer_store_dword v91, v7, s[24:27], s35 offen offset:1152 nt
  v_mfma_f32_16x16x32_bf16 v[56:59], v[92:95], v[216:219], v[56:59]
  s_waitcnt lgkmcnt(0)
  v_cvt_pk_bf16_f32 v68, v68, v100
  v_cvt_pk_bf16_f32 v69, v69, v101
  v_mfma_f32_16x16x32_bf16 v[56:59], v[96:99], v[232:235], v[56:59]
  v_cvt_pk_bf16_f32 v70, v70, v102
  v_cvt_pk_bf16_f32 v71, v71, v103
  v_mfma_f32_16x16x32_bf16 v[56:59], v[76:79], v[248:251], v[56:59]
  buffer_store_dword v68, v8, s[24:27], s35 offen offset:0 nt
  v_mfma_f32_16x16x32_bf16 v[56:59], v[64:67], a[224:227], v[56:59]
  ds_read_b128 a[244:247], v3 offset:0
  ds_read_b128 a[248:251], v3 offset:4096
  v_mfma_f32_16x16x32_bf16 v[84:87], v[64:67], a[228:231], 0
  ds_read_b128 a[252:255], v3 offset:8192
  ds_read_b128 v[60:63], v3 offset:12288
  v_mfma_f32_16x16x32_bf16 v[84:87], v[76:79], v[252:255], v[84:87]
  buffer_store_dword v69, v8, s[24:27], s35 offen offset:384 nt
  v_mfma_f32_16x16x32_bf16 v[84:87], v[96:99], v[236:239], v[84:87]
  ds_read_b128 v[64:67], v3 offset:16384
  ds_read_b128 v[76:79], v3 offset:20480
  v_mfma_f32_16x16x32_bf16 v[84:87], v[92:95], v[220:223], v[84:87]
  v_mov_b32 v54, 155648
  v_mfma_f32_16x16x32_bf16 v[84:87], v[72:75], v[204:207], v[84:87]
  buffer_store_dword v70, v8, s[24:27], s35 offen offset:768 nt
  v_mfma_f32_16x16x32_bf16 v[84:87], v[80:83], v[188:191], v[84:87]
  s_waitcnt lgkmcnt(2)
  ds_read2_b32 v[88:89], v54 offset0:0 offset1:2
  ds_read2_b32 v[90:91], v54 offset0:4 offset1:6
  v_mfma_f32_16x16x32_bf16 v[72:75], a[244:247], v[184:187], 0
  v_mfma_f32_16x16x32_bf16 v[72:75], a[248:251], v[200:203], v[72:75]
  buffer_store_dword v71, v8, s[24:27], s35 offen offset:1152 nt
  v_mfma_f32_16x16x32_bf16 v[72:75], a[252:255], v[216:219], v[72:75]
  v_cvt_pk_bf16_f32 v56, v56, v84
  v_cvt_pk_bf16_f32 v57, v57, v85
  v_mfma_f32_16x16x32_bf16 v[72:75], v[60:63], v[232:235], v[72:75]
  s_waitcnt lgkmcnt(2)
  v_cvt_pk_bf16_f32 v58, v58, v86
  v_cvt_pk_bf16_f32 v59, v59, v87
  v_mfma_f32_16x16x32_bf16 v[72:75], v[64:67], v[248:251], v[72:75]
  buffer_store_dword v56, v7, s[24:27], s36 offen offset:0 nt
  v_mfma_f32_16x16x32_bf16 v[72:75], v[76:79], a[224:227], v[72:75]
  s_waitcnt lgkmcnt(0)
  v_or3_b32 v88, v88, v89, v90
  v_or_b32 v88, v88, v91
  v_mfma_f32_16x16x32_bf16 v[104:107], v[76:79], a[228:231], 0
  v_readfirstlane_b32 s49, v88
  v_mfma_f32_16x16x32_bf16 v[104:107], v[64:67], v[252:255], v[104:107]
  buffer_store_dword v57, v7, s[24:27], s36 offen offset:384 nt
  v_mfma_f32_16x16x32_bf16 v[104:107], v[60:63], v[236:239], v[104:107]
  ds_read_b128 v[68:71], v4 offset:0
  ds_read_b128 v[80:83], v4 offset:4096
  v_mfma_f32_16x16x32_bf16 v[104:107], a[252:255], v[220:223], v[104:107]
  ds_read_b128 v[84:87], v4 offset:8192
  ds_read_b128 v[88:91], v4 offset:12288
  v_mfma_f32_16x16x32_bf16 v[104:107], a[248:251], v[204:207], v[104:107]
  buffer_store_dword v58, v7, s[24:27], s36 offen offset:768 nt
  v_mfma_f32_16x16x32_bf16 v[104:107], a[244:247], v[188:191], v[104:107]
  ds_read_b128 v[96:99], v4 offset:16384
  ds_read_b128 v[100:103], v4 offset:20480
  v_mfma_f32_16x16x32_bf16 v[92:95], a[244:247], v[192:195], 0
  v_mfma_f32_16x16x32_bf16 v[92:95], a[248:251], v[208:211], v[92:95]
  buffer_store_dword v59, v7, s[24:27], s36 offen offset:1152 nt
  v_mfma_f32_16x16x32_bf16 v[92:95], a[252:255], v[224:227], v[92:95]
  v_cvt_pk_bf16_f32 v72, v72, v104
  v_cvt_pk_bf16_f32 v73, v73, v105
  v_mfma_f32_16x16x32_bf16 v[92:95], v[60:63], v[240:243], v[92:95]
  v_cvt_pk_bf16_f32 v74, v74, v106
  v_cvt_pk_bf16_f32 v75, v75, v107
  v_mfma_f32_16x16x32_bf16 v[92:95], v[64:67], a[216:219], v[92:95]
  buffer_store_dword v72, v7, s[24:27], s33 offen offset:0 nt
  v_mfma_f32_16x16x32_bf16 v[92:95], v[76:79], a[232:235], v[92:95]
  v_mfma_f32_16x16x32_bf16 v[104:107], v[76:79], a[236:239], 0
  v_mfma_f32_16x16x32_bf16 v[104:107], v[64:67], a[220:223], v[104:107]
  buffer_store_dword v73, v7, s[24:27], s33 offen offset:384 nt
  v_mfma_f32_16x16x32_bf16 v[104:107], v[60:63], v[244:247], v[104:107]
  v_mfma_f32_16x16x32_bf16 v[104:107], a[252:255], v[228:231], v[104:107]
  v_mfma_f32_16x16x32_bf16 v[104:107], a[248:251], v[212:215], v[104:107]
  buffer_store_dword v74, v7, s[24:27], s33 offen offset:768 nt
  v_mfma_f32_16x16x32_bf16 v[104:107], a[244:247], v[196:199], v[104:107]
  s_waitcnt lgkmcnt(0)
  v_mfma_f32_16x16x32_bf16 v[56:59], v[68:71], v[184:187], 0
  v_mfma_f32_16x16x32_bf16 v[56:59], v[80:83], v[200:203], v[56:59]
  buffer_store_dword v75, v7, s[24:27], s33 offen offset:1152 nt
  v_mfma_f32_16x16x32_bf16 v[56:59], v[84:87], v[216:219], v[56:59]
  v_cvt_pk_bf16_f32 v92, v92, v104
  v_cvt_pk_bf16_f32 v93, v93, v105
  v_mfma_f32_16x16x32_bf16 v[56:59], v[88:91], v[232:235], v[56:59]
  v_cvt_pk_bf16_f32 v94, v94, v106
  v_cvt_pk_bf16_f32 v95, v95, v107
  v_mfma_f32_16x16x32_bf16 v[56:59], v[96:99], v[248:251], v[56:59]
  buffer_store_dword v92, v8, s[24:27], s33 offen offset:0 nt
  v_mfma_f32_16x16x32_bf16 v[56:59], v[100:103], a[224:227], v[56:59]
  v_mfma_f32_16x16x32_bf16 v[60:63], v[100:103], a[228:231], 0
  v_mfma_f32_16x16x32_bf16 v[60:63], v[96:99], v[252:255], v[60:63]
  buffer_store_dword v93, v8, s[24:27], s33 offen offset:384 nt
  v_mfma_f32_16x16x32_bf16 v[60:63], v[88:91], v[236:239], v[60:63]
  v_mfma_f32_16x16x32_bf16 v[60:63], v[84:87], v[220:223], v[60:63]
  v_mfma_f32_16x16x32_bf16 v[60:63], v[80:83], v[204:207], v[60:63]
  buffer_store_dword v94, v8, s[24:27], s33 offen offset:768 nt
  v_mfma_f32_16x16x32_bf16 v[60:63], v[68:71], v[188:191], v[60:63]
  buffer_store_dword v95, v8, s[24:27], s33 offen offset:1152 nt
  s_nop 6
  v_cvt_pk_bf16_f32 v56, v56, v60
  v_cvt_pk_bf16_f32 v57, v57, v61
  v_cvt_pk_bf16_f32 v58, v58, v62
  v_cvt_pk_bf16_f32 v59, v59, v63
  buffer_store_dword v56, v7, s[24:27], s34 offen offset:0 nt
  buffer_store_dword v57, v7, s[24:27], s34 offen offset:384 nt
  buffer_store_dword v58, v7, s[24:27], s34 offen offset:768 nt
  buffer_store_dword v59, v7, s[24:27], s34 offen offset:1152 nt
  s_cmp_lg_u32 s49, 0
  s_cbranch_scc1 L_safe
  s_endpgm
L_hop_1_3:
  s_cbranch_execz L_walk
L_pad4190:
L_k11:
  s_cmp_lg_u32 s59, 11
  s_cbranch_scc1 L_k12
  v_mfma_f32_16x16x32_bf16 v[104:107], a[0:3], v[92:95], 0
  v_mov_b32 v54, s12
  v_mov_b32 v55, s13
  v_mfma_f32_16x16x32_bf16 v[104:107], a[12:15], v[96:99], v[104:107]
  v_mov_b32 v74, 155712
  v_mfma_f32_16x16x32_bf16 v[104:107], a[24:27], v[136:139], v[104:107]
  v_cvt_pk_bf16_f32 v66, v132, v133
  v_cvt_pk_bf16_f32 v67, v134, v135
  v_mfma_f32_16x16x32_bf16 v[104:107], a[36:39], v[116:119], v[104:107]
  s_waitcnt lgkmcnt(0)
  ds_read_b128 v[112:115], v74
  v_mfma_f32_16x16x32_bf16 v[104:107], a[48:51], v[80:83], v[104:107]
  v_mfma_f32_16x16x32_bf16 v[104:107], a[60:63], v[84:87], v[104:107]
  v_mfma_f32_16x16x32_bf16 v[88:91], a[64:67], v[84:87], 0
  v_mfma_f32_16x16x32_bf16 v[88:91], a[52:55], v[80:83], v[88:91]
  v_mfma_f32_16x16x32_bf16 v[88:91], a[40:43], v[116:119], v[88:91]
  s_waitcnt lgkmcnt(0)
  v_mul_f32 v104, s42, v104
  v_mul_f32 v105, s42, v105
  v_mfma_f32_16x16x32_bf16 v[88:91], a[28:31], v[136:139], v[88:91]
  v_mul_f32 v106, s42, v106
  v_mul_f32 v107, s42, v107
  v_mfma_f32_16x16x32_bf16 v[88:91], a[16:19], v[96:99], v[88:91]
  v_cvt_pk_bf16_f32 v18, v104, v105
  v_cvt_pk_bf16_f32 v19, v106, v107
  v_mfma_f32_16x16x32_bf16 v[88:91], a[4:7], v[92:95], v[88:91]
  v_and_b32 v112, v112, v113
  v_and_b32 v114, v114, v115
  v_mfma_f32_16x16x32_bf16 v[108:111], a[8:11], v[92:95], 0
  v_and_b32 v112, v112, v114
  v_mfma_f32_16x16x32_bf16 v[108:111], a[20:23], v[96:99], v[108:111]
  v_readfirstlane_b32 s49, v112
  v_mfma_f32_16x16x32_bf16 v[108:111], a[32:35], v[136:139], v[108:111]
  v_mul_f32 v88, s42, v88
  v_mul_f32 v89, s42, v89
  v_mfma_f32_16x16x32_bf16 v[108:111], a[44:47], v[116:119], v[108:111]
  s_cmp_lg_u32 s49, 0
  v_mul_f32 v90, s42, v90
  v_mul_f32 v91, s42, v91
  v_mfma_f32_16x16x32_bf16 v[108:111], a[56:59], v[80:83], v[108:111]
  s_cselect_b32 s49, s44, s22
  v_cvt_pk_bf16_f32 v104, v88, v89
  v_cvt_pk_bf16_f32 v105, v90, v91
  v_mfma_f32_16x16x32_bf16 v[108:111], a[68:71], v[84:87], v[108:111]
  s_cselect_b32 s96, 4096, 0
  v_mfma_f32_16x16x32_bf16 v[112:115], a[132:135], v[84:87], 0
  buffer_store_dwordx2 v[54:55], off, s[20:23], s49 sc1
  v_mfma_f32_16x16x32_bf16 v[112:115], a[120:123], v[80:83], v[112:115]
  s_branch L_r227
L_k12:
  s_cmp_lg_u32 s45, 2
  s_cbranch_scc1 L_k12g
  v_mfma_f32_16x16x32_bf16 v[104:107], a[0:3], v[92:95], 0
  s_sub_u32 s49, s44, 2097152
  s_lshr_b32 s49, s49, 9
  s_lshr_b32 s52, s49, 6
  v_mfma_f32_16x16x32_bf16 v[104:107], a[12:15], v[96:99], v[104:107]
  s_and_b32 s53, s49, 63
  s_mul_i32 s50, s52, 15
  s_lshl_b32 s51, s57, 5
  v_mfma_f32_16x16x32_bf16 v[104:107], a[24:27], v[136:139], v[104:107]
  s_cmp_eq_u32 s53, 63
  v_cvt_pk_bf16_f32 v66, v132, v133
  v_cvt_pk_bf16_f32 v67, v134, v135
  v_mfma_f32_16x16x32_bf16 v[104:107], a[36:39], v[116:119], v[104:107]
  s_waitcnt lgkmcnt(0)
  s_cselect_b32 s53, s50, s53
  s_cselect_b32 s52, 60, s52
  v_mfma_f32_16x16x32_bf16 v[104:107], a[48:51], v[80:83], v[104:107]
  s_cselect_b32 s51, 3072, s51
  s_mul_i32 s52, s52, 1572864
  s_mul_i32 s53, s53, 3072
  v_mfma_f32_16x16x32_bf16 v[104:107], a[60:63], v[84:87], v[104:107]
  s_add_u32 s52, s52, s53
  s_add_u32 s50, s52, 787968
  s_cmp_eq_u32 s51, 3072
  v_mfma_f32_16x16x32_bf16 v[88:91], a[64:67], v[84:87], 0
  s_cselect_b32 s10, 100663296, s10
  s_sub_u32 s51, s51, s43
  s_mul_i32 s51, s51, 14
  v_mfma_f32_16x16x32_bf16 v[88:91], a[52:55], v[80:83], v[88:91]
  s_sub_u32 s50, s50, s56
  s_add_u32 s58, s50, s51
  s_mul_i32 s50, s14, 98304
  v_mfma_f32_16x16x32_bf16 v[88:91], a[40:43], v[116:119], v[88:91]
  s_add_u32 s98, s58, s50
  v_mul_f32 v104, s42, v104
  v_mul_f32 v105, s42, v105
  v_mfma_f32_16x16x32_bf16 v[88:91], a[28:31], v[136:139], v[88:91]
  s_sub_u32 s49, s98, s43
  v_mul_f32 v106, s42, v106
  v_mul_f32 v107, s42, v107
  v_mfma_f32_16x16x32_bf16 v[88:91], a[16:19], v[96:99], v[88:91]
  s_add_u32 s31, s31, s49
  v_cvt_pk_bf16_f32 v18, v104, v105
  v_cvt_pk_bf16_f32 v19, v106, v107
  v_mfma_f32_16x16x32_bf16 v[88:91], a[4:7], v[92:95], v[88:91]
  s_add_u32 s32, s32, s49
  s_lshl_b32 s50, s50, 1
  s_sub_u32 s32, s32, s50
  v_mfma_f32_16x16x32_bf16 v[108:111], a[8:11], v[92:95], 0
  s_sub_u32 s37, s37, s49
  s_sub_u32 s38, s38, s49
  s_sub_u32 s39, s39, s49
  v_mfma_f32_16x16x32_bf16 v[108:111], a[20:23], v[96:99], v[108:111]
  s_sub_u32 s40, s40, s49
  s_add_u32 s97, s97, s98
  s_mov_b32 s45, 4
  v_mfma_f32_16x16x32_bf16 v[108:111], a[32:35], v[136:139], v[108:111]
  s_lshl_b32 s96, s14, 12
  v_mul_f32 v88, s42, v88
  v_mul_f32 v89, s42, v89
  v_mfma_f32_16x16x32_bf16 v[108:111], a[44:47], v[116:119], v[108:111]
  s_mov_b64 s[100:101], -1
  v_mul_f32 v90, s42, v90
  v_mul_f32 v91, s42, v91
  v_mfma_f32_16x16x32_bf16 v[108:111], a[56:59], v[80:83], v[108:111]
  v_cvt_pk_bf16_f32 v104, v88, v89
  v_cvt_pk_bf16_f32 v105, v90, v91
  v_mfma_f32_16x16x32_bf16 v[108:111], a[68:71], v[84:87], v[108:111]
  s_branch L_r225
L_k12g:
  s_cmp_lg_u32 s59, 12
  s_cbranch_scc1 L_k13
  s_waitcnt vmcnt(30)
  v_mfma_f32_16x16x32_bf16 v[104:107], a[0:3], v[92:95], 0
  v_cmp_eq_u64 vcc, s[12:13], v[52:53]
  v_mfma_f32_16x16x32_bf16 v[104:107], a[12:15], v[96:99], v[104:107]
  v_mfma_f32_16x16x32_bf16 v[104:107], a[24:27], v[136:139], v[104:107]
  s_and_b32 s49, vcc_lo, 1
  v_cvt_pk_bf16_f32 v66, v132, v133
  v_cvt_pk_bf16_f32 v67, v134, v135
  v_mfma_f32_16x16x32_bf16 v[104:107], a[36:39], v[116:119], v[104:107]
  s_waitcnt lgkmcnt(0)
  s_lshl_b32 s49, s49, s14
  s_lshl_b32 s54, s3, 2
  v_mfma_f32_16x16x32_bf16 v[104:107], a[48:51], v[80:83], v[104:107]
  s_add_u32 s54, s54, 155728
  v_mov_b32 v54, s54
  v_mov_b32 v55, s49
  v_mfma_f32_16x16x32_bf16 v[104:107], a[60:63], v[84:87], v[104:107]
  ds_write_b32 v54, v55
  v_mfma_f32_16x16x32_bf16 v[88:91], a[64:67], v[84:87], 0
  v_mfma_f32_16x16x32_bf16 v[88:91], a[52:55], v[80:83], v[88:91]
  v_mfma_f32_16x16x32_bf16 v[88:91], a[40:43], v[116:119], v[88:91]
  v_mul_f32 v104, s42, v104
  v_mul_f32 v105, s42, v105
  v_mfma_f32_16x16x32_bf16 v[88:91], a[28:31], v[136:139], v[88:91]
  s_waitcnt lgkmcnt(0)
  v_mul_f32 v106, s42, v106
  v_mul_f32 v107, s42, v107
  v_mfma_f32_16x16x32_bf16 v[88:91], a[16:19], v[96:99], v[88:91]
  v_cvt_pk_bf16_f32 v18, v104, v105
  v_cvt_pk_bf16_f32 v19, v106, v107
  v_mfma_f32_16x16x32_bf16 v[88:91], a[4:7], v[92:95], v[88:91]
  s_branch L_r219
L_k13:
  v_mfma_f32_16x16x32_bf16 v[104:107], a[0:3], v[92:95], 0
  v_mov_b32 v54, 155728
  v_mfma_f32_16x16x32_bf16 v[104:107], a[12:15], v[96:99], v[104:107]
  ds_read_b128 v[112:115], v54
  v_mfma_f32_16x16x32_bf16 v[104:107], a[24:27], v[136:139], v[104:107]
  v_cvt_pk_bf16_f32 v66, v132, v133
  v_cvt_pk_bf16_f32 v67, v134, v135
  v_mfma_f32_16x16x32_bf16 v[104:107], a[36:39], v[116:119], v[104:107]
  s_waitcnt lgkmcnt(1)
  v_mfma_f32_16x16x32_bf16 v[104:107], a[48:51], v[80:83], v[104:107]
  v_mfma_f32_16x16x32_bf16 v[104:107], a[60:63], v[84:87], v[104:107]
  v_mfma_f32_16x16x32_bf16 v[88:91], a[64:67], v[84:87], 0
  s_waitcnt lgkmcnt(0)
  v_and_b32 v112, v112, v113
  v_and_b32 v114, v114, v115
  v_mfma_f32_16x16x32_bf16 v[88:91], a[52:55], v[80:83], v[88:91]
  v_and_b32 v112, v112, v114
  v_mfma_f32_16x16x32_bf16 v[88:91], a[40:43], v[116:119], v[88:91]
  v_mul_f32 v104, s42, v104
  v_mul_f32 v105, s42, v105
  v_mfma_f32_16x16x32_bf16 v[88:91], a[28:31], v[136:139], v[88:91]
  v_mul_f32 v106, s42, v106
  v_mul_f32 v107, s42, v107
  v_mfma_f32_16x16x32_bf16 v[88:91], a[16:19], v[96:99], v[88:91]
  v_cvt_pk_bf16_f32 v18, v104, v105
  v_cvt_pk_bf16_f32 v19, v106, v107
  v_mfma_f32_16x16x32_bf16 v[88:91], a[4:7], v[92:95], v[88:91]
  v_readfirstlane_b32 s49, v112
  v_mfma_f32_16x16x32_bf16 v[108:111], a[8:11], v[92:95], 0
  v_mfma_f32_16x16x32_bf16 v[108:111], a[20:23], v[96:99], v[108:111]
  s_lshl_b32 s96, s49, 6
  s_cmp_eq_u32 s49, 1
  s_cselect_b32 s49, s43, 0
  v_mfma_f32_16x16x32_bf16 v[108:111], a[32:35], v[136:139], v[108:111]
  s_cselect_b32 s45, 3, 0
  v_mul_f32 v88, s42, v88
  v_mul_f32 v89, s42, v89
  v_mfma_f32_16x16x32_bf16 v[108:111], a[44:47], v[116:119], v[108:111]
  s_sub_u32 s97, s97, s49
  v_mul_f32 v90, s42, v90
  v_mul_f32 v91, s42, v91
  v_mfma_f32_16x16x32_bf16 v[108:111], a[56:59], v[80:83], v[108:111]
  v_cvt_pk_bf16_f32 v104, v88, v89
  v_cvt_pk_bf16_f32 v105, v90, v91
  v_mfma_f32_16x16x32_bf16 v[108:111], a[68:71], v[84:87], v[108:111]
  s_branch L_r225
L_safe:
  s_nop 15
  s_waitcnt vmcnt(0) lgkmcnt(0)
  s_mov_b32 s10, 100663296
  v_mbcnt_lo_u32_b32 v58, -1, 0
  v_mbcnt_hi_u32_b32 v58, -1, v58
  v_lshrrev_b32 v59, 2, v58
  v_and_b32 v59, 4, v59
  v_xor_b32 v60, v59, v58
  s_cmp_eq_u32 s47, 63
  s_cselect_b32 s5, 4, 0
  v_and_b32 v60, s5, v60
  v_cmp_eq_u32 vcc, 0, v60
  s_cmp_eq_u32 s48, 63
  s_cselect_b32 s5, 0xc31044fe, 0
  v_mov_b32 v55, s5
  v_mov_b32 v54, 0xc31044fe
  v_cndmask_b32 v55, 0, v55, vcc
  v_cndmask_b32 v54, v54, 0, vcc
  v_add_u32 v0, s46, v2
  v_xor_b32 v1, 64, v0
  s_lshl_b32 s5, s48, 3
  s_add_u32 s5, s5, s3
  s_add_u32 s5, s5, 4
  s_mul_i32 s31, s5, s57
  s_add_u32 s5, s5, 4
  s_and_b32 s5, s5, 511
  s_mul_i32 s32, s5, s57
  v_lshrrev_b32 v59, 2, v59
  s_lshl_b32 s5, s47, 3
  s_add_u32 s5, s5, 4
  s_mul_i32 s5, s5, 384
  s_cmp_eq_u32 s47, 63
  s_cselect_b32 s49, 0, s5
  s_cselect_b32 s5, s5, 0
  s_cselect_b32 s6, s57, 0
  v_mul_u32_u24 v57, s6, v59
  v_sub_u32 v57, s5, v57
  s_lshl_b32 s50, s48, 3
  s_add_u32 s50, s50, 4
  s_xor_b32 s6, s4, 0
  s_lshl_b32 s6, s6, 1
  s_add_u32 s6, s6, s50
  s_and_b32 s6, s6, 511
  s_mul_i32 s6, s6, s57
  s_add_u32 s33, s6, s49
  s_xor_b32 s6, s4, 1
  s_lshl_b32 s6, s6, 1
  s_add_u32 s6, s6, s50
  s_and_b32 s6, s6, 511
  s_mul_i32 s6, s6, s57
  s_add_u32 s34, s6, s49
  s_xor_b32 s6, s4, 2
  s_lshl_b32 s6, s6, 1
  s_add_u32 s6, s6, s50
  s_and_b32 s6, s6, 511
  s_mul_i32 s6, s6, s57
  s_add_u32 s35, s6, s49
  s_xor_b32 s6, s4, 3
  s_lshl_b32 s6, s6, 1
  s_add_u32 s6, s6, s50
  s_and_b32 s6, s6, 511
  s_mul_i32 s6, s6, s57
  s_add_u32 s36, s6, s49
  s_lshl_b32 s5, s47, 3
  s_add_u32 s5, s5, 4
  v_lshrrev_b32 v59, 3, v58
  v_add_u32 v60, s5, v59
  v_and_b32 v60, 511, v60
  v_sub_u32 v60, v60, v59
  v_mul_i32_i24 v56, 0x180, v60
  v_add_u32 v6, v6, v56
  v_add_u32 v7, v7, v57
  v_add_u32 v8, v8, v57
  v_add_f32 v55, v54, v55
  s_cmp_eq_u32 s45, 3
  s_cselect_b32 s49, 15, 16
  s_cmp_eq_u32 s45, 4
  s_cselect_b32 s49, 17, s49
  s_mov_b32 s50, 0
  s_sub_u32 s56, s56, s43
  s_nop 7
L_sloop:
  s_barrier
  s_add_u32 m0, s46, 0
  s_nop 0
  buffer_load_dwordx4 v6, s[8:11], s31 offen offset:0 nt lds
  s_add_u32 m0, s46, 8064
  s_nop 0
  buffer_load_dwordx4 v6, s[8:11], s31 offen offset:128 nt lds
  s_add_u32 m0, s46, 16128
  s_nop 0
  buffer_load_dwordx4 v6, s[8:11], s31 offen offset:256 nt lds
  s_add_u32 m0, s46, 4096
  s_nop 0
  buffer_load_dwordx4 v6, s[8:11], s32 offen offset:0 nt lds
  s_add_u32 m0, s46, 12160
  s_nop 0
  buffer_load_dwordx4 v6, s[8:11], s32 offen offset:128 nt lds
  s_add_u32 m0, s46, 20224
  s_nop 0
  buffer_load_dwordx4 v6, s[8:11], s32 offen offset:256 nt lds
  s_waitcnt vmcnt(0)
  s_barrier
  ds_read_b128 a[244:247], v0 offset:0
  ds_read_b128 a[248:251], v1 offset:0
  ds_read_b128 a[252:255], v0 offset:8192
  ds_read_b128 v[76:79], v1 offset:8192
  ds_read_b128 v[80:83], v0 offset:16384
  ds_read_b128 v[84:87], v1 offset:16384
  s_waitcnt lgkmcnt(5)
  v_mfma_f32_16x16x32_bf16 v[68:71], a[0:3], a[244:247], 0
  s_waitcnt lgkmcnt(4)
  v_mfma_f32_16x16x32_bf16 v[68:71], a[12:15], a[248:251], v[68:71]
  s_waitcnt lgkmcnt(3)
  v_mfma_f32_16x16x32_bf16 v[68:71], a[24:27], a[252:255], v[68:71]
  s_waitcnt lgkmcnt(2)
  v_mfma_f32_16x16x32_bf16 v[68:71], a[36:39], v[76:79], v[68:71]
  s_waitcnt lgkmcnt(1)
  v_mfma_f32_16x16x32_bf16 v[68:71], a[48:51], v[80:83], v[68:71]
  s_waitcnt lgkmcnt(0)
  v_mfma_f32_16x16x32_bf16 v[68:71], a[60:63], v[84:87], v[68:71]
  v_mfma_f32_16x16x32_bf16 v[60:63], a[64:67], v[84:87], 0
  v_mfma_f32_16x16x32_bf16 v[60:63], a[52:55], v[80:83], v[60:63]
  v_mfma_f32_16x16x32_bf16 v[60:63], a[40:43], v[76:79], v[60:63]
  v_mfma_f32_16x16x32_bf16 v[60:63], a[28:31], a[252:255], v[60:63]
  v_mfma_f32_16x16x32_bf16 v[60:63], a[16:19], a[248:251], v[60:63]
  v_mfma_f32_16x16x32_bf16 v[60:63], a[4:7], a[244:247], v[60:63]
  v_mul_f32 v68, s42, v68
  v_mul_f32 v69, s42, v69
  v_mul_f32 v70, s42, v70
  v_mul_f32 v71, s42, v71
  v_cvt_pk_bf16_f32 v12, v68, v69
  v_cvt_pk_bf16_f32 v13, v70, v71
  v_mfma_f32_16x16x32_bf16 v[64:67], a[8:11], a[244:247], 0
  v_mfma_f32_16x16x32_bf16 v[64:67], a[20:23], a[248:251], v[64:67]
  v_mfma_f32_16x16x32_bf16 v[64:67], a[32:35], a[252:255], v[64:67]
  v_mfma_f32_16x16x32_bf16 v[64:67], a[44:47], v[76:79], v[64:67]
  v_mfma_f32_16x16x32_bf16 v[64:67], a[56:59], v[80:83], v[64:67]
  v_mfma_f32_16x16x32_bf16 v[64:67], a[68:71], v[84:87], v[64:67]
  v_mul_f32 v60, s42, v60
  v_mul_f32 v61, s42, v61
  v_mul_f32 v62, s42, v62
  v_mul_f32 v63, s42, v63
  v_cvt_pk_bf16_f32 v128, v60, v61
  v_cvt_pk_bf16_f32 v129, v62, v63
  v_mfma_f32_16x16x32_bf16 v[68:71], a[132:135], v[84:87], 0
  v_mfma_f32_16x16x32_bf16 v[68:71], a[120:123], v[80:83], v[68:71]
  v_mfma_f32_16x16x32_bf16 v[68:71], a[108:111], v[76:79], v[68:71]
  v_mfma_f32_16x16x32_bf16 v[68:71], a[96:99], a[252:255], v[68:71]
  v_mfma_f32_16x16x32_bf16 v[68:71], a[84:87], a[248:251], v[68:71]
  v_mfma_f32_16x16x32_bf16 v[68:71], a[72:75], a[244:247], v[68:71]
  v_mul_f32 v64, s42, v64
  v_mul_f32 v65, s42, v65
  v_mul_f32 v66, s42, v66
  v_mul_f32 v67, s42, v67
  v_cvt_pk_bf16_f32 v130, v64, v65
  v_cvt_pk_bf16_f32 v131, v66, v67
  v_mfma_f32_16x16x32_bf16 v[72:75], a[76:79], a[244:247], 0
  v_mfma_f32_16x16x32_bf16 v[72:75], a[88:91], a[248:251], v[72:75]
  v_mfma_f32_16x16x32_bf16 v[72:75], a[100:103], a[252:255], v[72:75]
  v_mfma_f32_16x16x32_bf16 v[72:75], a[112:115], v[76:79], v[72:75]
  v_mfma_f32_16x16x32_bf16 v[72:75], a[124:127], v[80:83], v[72:75]
  v_mfma_f32_16x16x32_bf16 v[72:75], a[136:139], v[84:87], v[72:75]
  v_cvt_pk_bf16_f32 v60, v68, v69
  v_cvt_pk_bf16_f32 v61, v70, v71
  v_mfma_f32_16x16x32_bf16 v[88:91], a[140:143], v[84:87], 0
  v_mfma_f32_16x16x32_bf16 v[88:91], a[128:131], v[80:83], v[88:91]
  v_mfma_f32_16x16x32_bf16 v[88:91], a[116:119], v[76:79], v[88:91]
  v_mfma_f32_16x16x32_bf16 v[88:91], a[104:107], a[252:255], v[88:91]
  v_mfma_f32_16x16x32_bf16 v[88:91], a[92:95], a[248:251], v[88:91]
  v_mfma_f32_16x16x32_bf16 v[88:91], a[80:83], a[244:247], v[88:91]
  v_cvt_pk_bf16_f32 v62, v72, v73
  v_cvt_pk_bf16_f32 v63, v74, v75
  v_mfma_f32_16x16x32_bf16 v[92:95], a[244:247], a[144:147], 0
  v_mfma_f32_16x16x32_bf16 v[92:95], a[248:251], a[156:159], v[92:95]
  v_mfma_f32_16x16x32_bf16 v[92:95], a[252:255], a[168:171], v[92:95]
  v_mfma_f32_16x16x32_bf16 v[92:95], v[76:79], a[180:183], v[92:95]
  v_mfma_f32_16x16x32_bf16 v[92:95], v[80:83], a[192:195], v[92:95]
  v_mfma_f32_16x16x32_bf16 v[92:95], v[84:87], a[204:207], v[92:95]
  v_cvt_pk_bf16_f32 v64, v88, v89
  v_cvt_pk_bf16_f32 v65, v90, v91
  v_mfma_f32_16x16x32_bf16 v[96:99], v[84:87], a[208:211], 0
  v_mfma_f32_16x16x32_bf16 v[96:99], v[80:83], a[196:199], v[96:99]
  v_mfma_f32_16x16x32_bf16 v[96:99], v[76:79], a[184:187], v[96:99]
  v_mfma_f32_16x16x32_bf16 v[96:99], a[252:255], a[172:175], v[96:99]
  v_mfma_f32_16x16x32_bf16 v[96:99], a[248:251], a[160:163], v[96:99]
  v_mfma_f32_16x16x32_bf16 v[96:99], a[244:247], a[148:151], v[96:99]
  v_cvt_pk_bf16_f32 v68, v92, v93
  v_cvt_pk_bf16_f32 v69, v94, v95
  v_mfma_f32_16x16x32_bf16 v[104:107], a[244:247], a[152:155], 0
  v_mfma_f32_16x16x32_bf16 v[104:107], a[248:251], a[164:167], v[104:107]
  v_mfma_f32_16x16x32_bf16 v[104:107], a[252:255], a[176:179], v[104:107]
  v_mfma_f32_16x16x32_bf16 v[104:107], v[76:79], a[188:191], v[104:107]
  v_mfma_f32_16x16x32_bf16 v[104:107], v[80:83], a[200:203], v[104:107]
  v_mfma_f32_16x16x32_bf16 v[104:107], v[84:87], a[212:215], v[104:107]
  v_cvt_pk_bf16_f32 v72, v96, v97
  v_cvt_pk_bf16_f32 v73, v98, v99
  s_nop 5
  v_cvt_pk_bf16_f32 v76, v104, v105
  v_cvt_pk_bf16_f32 v77, v106, v107
  ds_read_b128 a[244:247], v0 offset:2048
  ds_read_b128 a[248:251], v1 offset:2048
  ds_read_b128 a[252:255], v0 offset:10240
  ds_read_b128 v[88:91], v1 offset:10240
  ds_read_b128 v[92:95], v0 offset:18432
  ds_read_b128 v[96:99], v1 offset:18432
  s_waitcnt lgkmcnt(5)
  v_mfma_f32_16x16x32_bf16 v[100:103], a[0:3], a[244:247], 0
  s_waitcnt lgkmcnt(4)
  v_mfma_f32_16x16x32_bf16 v[100:103], a[12:15], a[248:251], v[100:103]
  s_waitcnt lgkmcnt(3)
  v_mfma_f32_16x16x32_bf16 v[100:103], a[24:27], a[252:255], v[100:103]
  s_waitcnt lgkmcnt(2)
  v_mfma_f32_16x16x32_bf16 v[100:103], a[36:39], v[88:91], v[100:103]
  s_waitcnt lgkmcnt(1)
  v_mfma_f32_16x16x32_bf16 v[100:103], a[48:51], v[92:95], v[100:103]
  s_waitcnt lgkmcnt(0)
  v_mfma_f32_16x16x32_bf16 v[100:103], a[60:63], v[96:99], v[100:103]
  v_mfma_f32_16x16x32_bf16 v[80:83], a[64:67], v[96:99], 0
  v_mfma_f32_16x16x32_bf16 v[80:83], a[52:55], v[92:95], v[80:83]
  v_mfma_f32_16x16x32_bf16 v[80:83], a[40:43], v[88:91], v[80:83]
  v_mfma_f32_16x16x32_bf16 v[80:83], a[28:31], a[252:255], v[80:83]
  v_mfma_f32_16x16x32_bf16 v[80:83], a[16:19], a[248:251], v[80:83]
  v_mfma_f32_16x16x32_bf16 v[80:83], a[4:7], a[244:247], v[80:83]
  v_mul_f32 v100, s42, v100
  v_mul_f32 v101, s42, v101
  v_mul_f32 v102, s42, v102
  v_mul_f32 v103, s42, v103
  v_cvt_pk_bf16_f32 v124, v100, v101
  v_cvt_pk_bf16_f32 v125, v102, v103
  v_mfma_f32_16x16x32_bf16 v[84:87], a[8:11], a[244:247], 0
  v_mfma_f32_16x16x32_bf16 v[84:87], a[20:23], a[248:251], v[84:87]
  v_mfma_f32_16x16x32_bf16 v[84:87], a[32:35], a[252:255], v[84:87]
  v_mfma_f32_16x16x32_bf16 v[84:87], a[44:47], v[88:91], v[84:87]
  v_mfma_f32_16x16x32_bf16 v[84:87], a[56:59], v[92:95], v[84:87]
  v_mfma_f32_16x16x32_bf16 v[84:87], a[68:71], v[96:99], v[84:87]
  v_mul_f32 v80, s42, v80
  v_mul_f32 v81, s42, v81
  v_mul_f32 v82, s42, v82
  v_mul_f32 v83, s42, v83
  v_cvt_pk_bf16_f32 v126, v80, v81
  v_cvt_pk_bf16_f32 v127, v82, v83
  v_mfma_f32_16x16x32_bf16 v[100:103], a[132:135], v[96:99], 0
  v_mfma_f32_16x16x32_bf16 v[100:103], a[120:123], v[92:95], v[100:103]
  v_mfma_f32_16x16x32_bf16 v[100:103], a[108:111], v[88:91], v[100:103]
  v_mfma_f32_16x16x32_bf16 v[100:103], a[96:99], a[252:255], v[100:103]
  v_mfma_f32_16x16x32_bf16 v[100:103], a[84:87], a[248:251], v[100:103]
  v_mfma_f32_16x16x32_bf16 v[100:103], a[72:75], a[244:247], v[100:103]
  v_mul_f32 v84, s42, v84
  v_mul_f32 v85, s42, v85
  v_mul_f32 v86, s42, v86
  v_mul_f32 v87, s42, v87
  v_cvt_pk_bf16_f32 v16, v84, v85
  v_cvt_pk_bf16_f32 v17, v86, v87
  v_mfma_f32_16x16x32_bf16 v[104:107], a[76:79], a[244:247], 0
  v_mfma_f32_16x16x32_bf16 v[104:107], a[88:91], a[248:251], v[104:107]
  v_mfma_f32_16x16x32_bf16 v[104:107], a[100:103], a[252:255], v[104:107]
  v_mfma_f32_16x16x32_bf16 v[104:107], a[112:115], v[88:91], v[104:107]
  v_mfma_f32_16x16x32_bf16 v[104:107], a[124:127], v[92:95], v[104:107]
  v_mfma_f32_16x16x32_bf16 v[104:107], a[136:139], v[96:99], v[104:107]
  v_cvt_pk_bf16_f32 v80, v100, v101
  v_cvt_pk_bf16_f32 v81, v102, v103
  v_mfma_f32_16x16x32_bf16 v[108:111], a[140:143], v[96:99], 0
  v_mfma_f32_16x16x32_bf16 v[108:111], a[128:131], v[92:95], v[108:111]
  v_mfma_f32_16x16x32_bf16 v[108:111], a[116:119], v[88:91], v[108:111]
  v_mfma_f32_16x16x32_bf16 v[108:111], a[104:107], a[252:255], v[108:111]
  v_mfma_f32_16x16x32_bf16 v[108:111], a[92:95], a[248:251], v[108:111]
  v_mfma_f32_16x16x32_bf16 v[108:111], a[80:83], a[244:247], v[108:111]
  v_cvt_pk_bf16_f32 v82, v104, v105
  v_cvt_pk_bf16_f32 v83, v106, v107
  v_mfma_f32_16x16x32_bf16 v[100:103], a[244:247], a[144:147], 0
  v_mfma_f32_16x16x32_bf16 v[100:103], a[248:251], a[156:159], v[100:103]
  v_mfma_f32_16x16x32_bf16 v[100:103], a[252:255], a[168:171], v[100:103]
  v_mfma_f32_16x16x32_bf16 v[100:103], v[88:91], a[180:183], v[100:103]
  v_mfma_f32_16x16x32_bf16 v[100:103], v[92:95], a[192:195], v[100:103]
  v_mfma_f32_16x16x32_bf16 v[100:103], v[96:99], a[204:207], v[100:103]
  v_cvt_pk_bf16_f32 v84, v108, v109
  v_cvt_pk_bf16_f32 v85, v110, v111
  v_mfma_f32_16x16x32_bf16 v[104:107], v[96:99], a[208:211], 0
  v_mfma_f32_16x16x32_bf16 v[104:107], v[92:95], a[196:199], v[104:107]
  v_mfma_f32_16x16x32_bf16 v[104:107], v[88:91], a[184:187], v[104:107]
  v_mfma_f32_16x16x32_bf16 v[104:107], a[252:255], a[172:175], v[104:107]
  v_mfma_f32_16x16x32_bf16 v[104:107], a[248:251], a[160:163], v[104:107]
  v_mfma_f32_16x16x32_bf16 v[104:107], a[244:247], a[148:151], v[104:107]
  v_cvt_pk_bf16_f32 v70, v100, v101
  v_cvt_pk_bf16_f32 v71, v102, v103
  v_mfma_f32_16x16x32_bf16 v[116:119], a[244:247], a[152:155], 0
  v_mfma_f32_16x16x32_bf16 v[116:119], a[248:251], a[164:167], v[116:119]
  v_mfma_f32_16x16x32_bf16 v[116:119], a[252:255], a[176:179], v[116:119]
  v_mfma_f32_16x16x32_bf16 v[116:119], v[88:91], a[188:191], v[116:119]
  v_mfma_f32_16x16x32_bf16 v[116:119], v[92:95], a[200:203], v[116:119]
  v_mfma_f32_16x16x32_bf16 v[116:119], v[96:99], a[212:215], v[116:119]
  v_cvt_pk_bf16_f32 v74, v104, v105
  v_cvt_pk_bf16_f32 v75, v106, v107
  s_nop 5
  v_cvt_pk_bf16_f32 v78, v116, v117
  v_cvt_pk_bf16_f32 v79, v118, v119
  ds_read_b128 a[244:247], v0 offset:4096
  ds_read_b128 a[248:251], v1 offset:4096
  ds_read_b128 a[252:255], v0 offset:12288
  ds_read_b128 v[100:103], v1 offset:12288
  ds_read_b128 v[108:111], v0 offset:20480
  ds_read_b128 v[112:115], v1 offset:20480
  s_waitcnt lgkmcnt(5)
  v_mfma_f32_16x16x32_bf16 v[96:99], a[0:3], a[244:247], 0
  s_waitcnt lgkmcnt(4)
  v_mfma_f32_16x16x32_bf16 v[96:99], a[12:15], a[248:251], v[96:99]
  s_waitcnt lgkmcnt(3)
  v_mfma_f32_16x16x32_bf16 v[96:99], a[24:27], a[252:255], v[96:99]
  s_waitcnt lgkmcnt(2)
  v_mfma_f32_16x16x32_bf16 v[96:99], a[36:39], v[100:103], v[96:99]
  s_waitcnt lgkmcnt(1)
  v_mfma_f32_16x16x32_bf16 v[96:99], a[48:51], v[108:111], v[96:99]
  s_waitcnt lgkmcnt(0)
  v_mfma_f32_16x16x32_bf16 v[96:99], a[60:63], v[112:115], v[96:99]
  v_mfma_f32_16x16x32_bf16 v[88:91], a[64:67], v[112:115], 0
  v_mfma_f32_16x16x32_bf16 v[88:91], a[52:55], v[108:111], v[88:91]
  v_mfma_f32_16x16x32_bf16 v[88:91], a[40:43], v[100:103], v[88:91]
  v_mfma_f32_16x16x32_bf16 v[88:91], a[28:31], a[252:255], v[88:91]
  v_mfma_f32_16x16x32_bf16 v[88:91], a[16:19], a[248:251], v[88:91]
  v_mfma_f32_16x16x32_bf16 v[88:91], a[4:7], a[244:247], v[88:91]
  v_mul_f32 v96, s42, v96
  v_mul_f32 v97, s42, v97
  v_mul_f32 v98, s42, v98
  v_mul_f32 v99, s42, v99
  v_cvt_pk_bf16_f32 v18, v96, v97
  v_cvt_pk_bf16_f32 v19, v98, v99
  v_mfma_f32_16x16x32_bf16 v[92:95], a[8:11], a[244:247], 0
  v_mfma_f32_16x16x32_bf16 v[92:95], a[20:23], a[248:251], v[92:95]
  v_mfma_f32_16x16x32_bf16 v[92:95], a[32:35], a[252:255], v[92:95]
  v_mfma_f32_16x16x32_bf16 v[92:95], a[44:47], v[100:103], v[92:95]
  v_mfma_f32_16x16x32_bf16 v[92:95], a[56:59], v[108:111], v[92:95]
  v_mfma_f32_16x16x32_bf16 v[92:95], a[68:71], v[112:115], v[92:95]
  v_mul_f32 v88, s42, v88
  v_mul_f32 v89, s42, v89
  v_mul_f32 v90, s42, v90
  v_mul_f32 v91, s42, v91
  v_cvt_pk_bf16_f32 v120, v88, v89
  v_cvt_pk_bf16_f32 v121, v90, v91
  v_mfma_f32_16x16x32_bf16 v[96:99], a[132:135], v[112:115], 0
  v_mfma_f32_16x16x32_bf16 v[96:99], a[120:123], v[108:111], v[96:99]
  v_mfma_f32_16x16x32_bf16 v[96:99], a[108:111], v[100:103], v[96:99]
  v_mfma_f32_16x16x32_bf16 v[96:99], a[96:99], a[252:255], v[96:99]
  v_mfma_f32_16x16x32_bf16 v[96:99], a[84:87], a[248:251], v[96:99]
  v_mfma_f32_16x16x32_bf16 v[96:99], a[72:75], a[244:247], v[96:99]
  v_mul_f32 v92, s42, v92
  v_mul_f32 v93, s42, v93
  v_mul_f32 v94, s42, v94
  v_mul_f32 v95, s42, v95
  v_cvt_pk_bf16_f32 v122, v92, v93
  v_cvt_pk_bf16_f32 v123, v94, v95
  v_mfma_f32_16x16x32_bf16 v[104:107], a[76:79], a[244:247], 0
  v_mfma_f32_16x16x32_bf16 v[104:107], a[88:91], a[248:251], v[104:107]
  v_mfma_f32_16x16x32_bf16 v[104:107], a[100:103], a[252:255], v[104:107]
  v_mfma_f32_16x16x32_bf16 v[104:107], a[112:115], v[100:103], v[104:107]
  v_mfma_f32_16x16x32_bf16 v[104:107], a[124:127], v[108:111], v[104:107]
  v_mfma_f32_16x16x32_bf16 v[104:107], a[136:139], v[112:115], v[104:107]
  v_cvt_pk_bf16_f32 v88, v96, v97
  v_cvt_pk_bf16_f32 v89, v98, v99
  v_mfma_f32_16x16x32_bf16 v[116:119], a[140:143], v[112:115], 0
  v_mfma_f32_16x16x32_bf16 v[116:119], a[128:131], v[108:111], v[116:119]
  v_mfma_f32_16x16x32_bf16 v[116:119], a[116:119], v[100:103], v[116:119]
  v_mfma_f32_16x16x32_bf16 v[116:119], a[104:107], a[252:255], v[116:119]
  v_mfma_f32_16x16x32_bf16 v[116:119], a[92:95], a[248:251], v[116:119]
  v_mfma_f32_16x16x32_bf16 v[116:119], a[80:83], a[244:247], v[116:119]
  v_cvt_pk_bf16_f32 v90, v104, v105
  v_cvt_pk_bf16_f32 v91, v106, v107
  v_mfma_f32_16x16x32_bf16 v[132:135], a[244:247], a[144:147], 0
  v_mfma_f32_16x16x32_bf16 v[132:135], a[248:251], a[156:159], v[132:135]
  v_mfma_f32_16x16x32_bf16 v[132:135], a[252:255], a[168:171], v[132:135]
  v_mfma_f32_16x16x32_bf16 v[132:135], v[100:103], a[180:183], v[132:135]
  v_mfma_f32_16x16x32_bf16 v[132:135], v[108:111], a[192:195], v[132:135]
  v_mfma_f32_16x16x32_bf16 v[132:135], v[112:115], a[204:207], v[132:135]
  v_cvt_pk_bf16_f32 v92, v116, v117
  v_cvt_pk_bf16_f32 v93, v118, v119
  v_mfma_f32_16x16x32_bf16 v[136:139], v[112:115], a[208:211], 0
  v_mfma_f32_16x16x32_bf16 v[136:139], v[108:111], a[196:199], v[136:139]
  v_mfma_f32_16x16x32_bf16 v[136:139], v[100:103], a[184:187], v[136:139]
  v_mfma_f32_16x16x32_bf16 v[136:139], a[252:255], a[172:175], v[136:139]
  v_mfma_f32_16x16x32_bf16 v[136:139], a[248:251], a[160:163], v[136:139]
  v_mfma_f32_16x16x32_bf16 v[136:139], a[244:247], a[148:151], v[136:139]
  v_cvt_pk_bf16_f32 v96, v132, v133
  v_cvt_pk_bf16_f32 v97, v134, v135
  v_mfma_f32_16x16x32_bf16 v[116:119], a[244:247], a[152:155], 0
  v_mfma_f32_16x16x32_bf16 v[116:119], a[248:251], a[164:167], v[116:119]
  v_mfma_f32_16x16x32_bf16 v[116:119], a[252:255], a[176:179], v[116:119]
  v_mfma_f32_16x16x32_bf16 v[116:119], v[100:103], a[188:191], v[116:119]
  v_mfma_f32_16x16x32_bf16 v[116:119], v[108:111], a[200:203], v[116:119]
  v_mfma_f32_16x16x32_bf16 v[116:119], v[112:115], a[212:215], v[116:119]
  v_cvt_pk_bf16_f32 v104, v136, v137
  v_cvt_pk_bf16_f32 v105, v138, v139
  s_nop 5
  v_cvt_pk_bf16_f32 v100, v116, v117
  v_cvt_pk_bf16_f32 v101, v118, v119
  ds_read_b128 a[244:247], v0 offset:6144
  ds_read_b128 a[248:251], v1 offset:6144
  ds_read_b128 a[252:255], v0 offset:14336
  ds_read_b128 v[132:135], v1 offset:14336
  ds_read_b128 v[136:139], v0 offset:22528
  ds_read_b128 v[140:143], v1 offset:22528
  s_waitcnt lgkmcnt(5)
  v_mfma_f32_16x16x32_bf16 v[144:147], a[0:3], a[244:247], 0
  s_waitcnt lgkmcnt(4)
  v_mfma_f32_16x16x32_bf16 v[144:147], a[12:15], a[248:251], v[144:147]
  s_waitcnt lgkmcnt(3)
  v_mfma_f32_16x16x32_bf16 v[144:147], a[24:27], a[252:255], v[144:147]
  s_waitcnt lgkmcnt(2)
  v_mfma_f32_16x16x32_bf16 v[144:147], a[36:39], v[132:135], v[144:147]
  s_waitcnt lgkmcnt(1)
  v_mfma_f32_16x16x32_bf16 v[144:147], a[48:51], v[136:139], v[144:147]
  s_waitcnt lgkmcnt(0)
  v_mfma_f32_16x16x32_bf16 v[144:147], a[60:63], v[140:143], v[144:147]
  v_mfma_f32_16x16x32_bf16 v[108:111], a[64:67], v[140:143], 0
  v_mfma_f32_16x16x32_bf16 v[108:111], a[52:55], v[136:139], v[108:111]
  v_mfma_f32_16x16x32_bf16 v[108:111], a[40:43], v[132:135], v[108:111]
  v_mfma_f32_16x16x32_bf16 v[108:111], a[28:31], a[252:255], v[108:111]
  v_mfma_f32_16x16x32_bf16 v[108:111], a[16:19], a[248:251], v[108:111]
  v_mfma_f32_16x16x32_bf16 v[108:111], a[4:7], a[244:247], v[108:111]
  v_mul_f32 v144, s42, v144
  v_mul_f32 v145, s42, v145
  v_mul_f32 v146, s42, v146
  v_mul_f32 v147, s42, v147
  v_cvt_pk_bf16_f32 v116, v144, v145
  v_cvt_pk_bf16_f32 v117, v146, v147
  v_mfma_f32_16x16x32_bf16 v[112:115], a[8:11], a[244:247], 0
  v_mfma_f32_16x16x32_bf16 v[112:115], a[20:23], a[248:251], v[112:115]
  v_mfma_f32_16x16x32_bf16 v[112:115], a[32:35], a[252:255], v[112:115]
  v_mfma_f32_16x16x32_bf16 v[112:115], a[44:47], v[132:135], v[112:115]
  v_mfma_f32_16x16x32_bf16 v[112:115], a[56:59], v[136:139], v[112:115]
  v_mfma_f32_16x16x32_bf16 v[112:115], a[68:71], v[140:143], v[112:115]
  v_mul_f32 v108, s42, v108
  v_mul_f32 v109, s42, v109
  v_mul_f32 v110, s42, v110
  v_mul_f32 v111, s42, v111
  v_cvt_pk_bf16_f32 v118, v108, v109
  v_cvt_pk_bf16_f32 v119, v110, v111
  v_mfma_f32_16x16x32_bf16 v[144:147], a[132:135], v[140:143], 0
  v_mfma_f32_16x16x32_bf16 v[144:147], a[120:123], v[136:139], v[144:147]
  v_mfma_f32_16x16x32_bf16 v[144:147], a[108:111], v[132:135], v[144:147]
  v_mfma_f32_16x16x32_bf16 v[144:147], a[96:99], a[252:255], v[144:147]
  v_mfma_f32_16x16x32_bf16 v[144:147], a[84:87], a[248:251], v[144:147]
  v_mfma_f32_16x16x32_bf16 v[144:147], a[72:75], a[244:247], v[144:147]
  v_mul_f32 v112, s42, v112
  v_mul_f32 v113, s42, v113
  v_mul_f32 v114, s42, v114
  v_mul_f32 v115, s42, v115
  v_cvt_pk_bf16_f32 v22, v112, v113
  v_cvt_pk_bf16_f32 v23, v114, v115
  v_mfma_f32_16x16x32_bf16 v[148:151], a[76:79], a[244:247], 0
  v_mfma_f32_16x16x32_bf16 v[148:151], a[88:91], a[248:251], v[148:151]
  v_mfma_f32_16x16x32_bf16 v[148:151], a[100:103], a[252:255], v[148:151]
  v_mfma_f32_16x16x32_bf16 v[148:151], a[112:115], v[132:135], v[148:151]
  v_mfma_f32_16x16x32_bf16 v[148:151], a[124:127], v[136:139], v[148:151]
  v_mfma_f32_16x16x32_bf16 v[148:151], a[136:139], v[140:143], v[148:151]
  v_cvt_pk_bf16_f32 v108, v144, v145
  v_cvt_pk_bf16_f32 v109, v146, v147
  v_mfma_f32_16x16x32_bf16 v[152:155], a[140:143], v[140:143], 0
  v_mfma_f32_16x16x32_bf16 v[152:155], a[128:131], v[136:139], v[152:155]
  v_mfma_f32_16x16x32_bf16 v[152:155], a[116:119], v[132:135], v[152:155]
  v_mfma_f32_16x16x32_bf16 v[152:155], a[104:107], a[252:255], v[152:155]
  v_mfma_f32_16x16x32_bf16 v[152:155], a[92:95], a[248:251], v[152:155]
  v_mfma_f32_16x16x32_bf16 v[152:155], a[80:83], a[244:247], v[152:155]
  v_cvt_pk_bf16_f32 v110, v148, v149
  v_cvt_pk_bf16_f32 v111, v150, v151
  v_mfma_f32_16x16x32_bf16 v[144:147], a[244:247], a[144:147], 0
  v_mfma_f32_16x16x32_bf16 v[144:147], a[248:251], a[156:159], v[144:147]
  v_mfma_f32_16x16x32_bf16 v[144:147], a[252:255], a[168:171], v[144:147]
  v_mfma_f32_16x16x32_bf16 v[144:147], v[132:135], a[180:183], v[144:147]
  v_mfma_f32_16x16x32_bf16 v[144:147], v[136:139], a[192:195], v[144:147]
  v_mfma_f32_16x16x32_bf16 v[144:147], v[140:143], a[204:207], v[144:147]
  v_cvt_pk_bf16_f32 v112, v152, v153
  v_cvt_pk_bf16_f32 v113, v154, v155
  v_mfma_f32_16x16x32_bf16 v[148:151], v[140:143], a[208:211], 0
  v_mfma_f32_16x16x32_bf16 v[148:151], v[136:139], a[196:199], v[148:151]
  v_mfma_f32_16x16x32_bf16 v[148:151], v[132:135], a[184:187], v[148:151]
  v_mfma_f32_16x16x32_bf16 v[148:151], a[252:255], a[172:175], v[148:151]
  v_mfma_f32_16x16x32_bf16 v[148:151], a[248:251], a[160:163], v[148:151]
  v_mfma_f32_16x16x32_bf16 v[148:151], a[244:247], a[148:151], v[148:151]
  v_cvt_pk_bf16_f32 v98, v144, v145
  v_cvt_pk_bf16_f32 v99, v146, v147
  v_mfma_f32_16x16x32_bf16 v[152:155], a[244:247], a[152:155], 0
  v_mfma_f32_16x16x32_bf16 v[152:155], a[248:251], a[164:167], v[152:155]
  v_mfma_f32_16x16x32_bf16 v[152:155], a[252:255], a[176:179], v[152:155]
  v_mfma_f32_16x16x32_bf16 v[152:155], v[132:135], a[188:191], v[152:155]
  v_mfma_f32_16x16x32_bf16 v[152:155], v[136:139], a[200:203], v[152:155]
  v_mfma_f32_16x16x32_bf16 v[152:155], v[140:143], a[212:215], v[152:155]
  v_cvt_pk_bf16_f32 v106, v148, v149
  v_cvt_pk_bf16_f32 v107, v150, v151
  s_nop 5
  v_cvt_pk_bf16_f32 v102, v152, v153
  v_cvt_pk_bf16_f32 v103, v154, v155
  v_mfma_f32_16x16x32_bf16 v[132:135], v[62:65], v[128:131], v[36:39]
  v_mfma_f32_16x16x32_bf16 v[132:135], v[60:63], v[12:15], v[132:135]
  v_mfma_f32_16x16x32_bf16 v[136:139], v[82:85], v[128:131], v[32:35]
  v_mfma_f32_16x16x32_bf16 v[136:139], v[80:83], v[12:15], v[136:139]
  v_mfma_f32_16x16x32_bf16 v[140:143], v[90:93], v[128:131], v[28:31]
  v_mfma_f32_16x16x32_bf16 v[140:143], v[88:91], v[12:15], v[140:143]
  v_mfma_f32_16x16x32_bf16 v[144:147], v[110:113], v[128:131], v[24:27]
  v_mfma_f32_16x16x32_bf16 v[144:147], v[108:111], v[12:15], v[144:147]
  v_add_f32 v132, v54, v132
  v_add_f32 v133, v54, v133
  v_add_f32 v134, v54, v134
  v_add_f32 v135, v54, v135
  v_add_f32 v136, v54, v136
  v_add_f32 v137, v54, v137
  v_add_f32 v138, v54, v138
  v_add_f32 v139, v54, v139
  v_add_f32 v140, v55, v140
  v_add_f32 v141, v55, v141
  v_add_f32 v142, v55, v142
  v_add_f32 v143, v55, v143
  v_add_f32 v144, v55, v144
  v_add_f32 v145, v55, v145
  v_add_f32 v146, v55, v146
  v_add_f32 v147, v55, v147
  v_max_f32 v58, v132, v133
  v_max3_f32 v58, v134, v135, v58
  v_max3_f32 v58, v136, v137, v58
  v_max3_f32 v58, v138, v139, v58
  v_max3_f32 v58, v140, v141, v58
  v_max3_f32 v58, v142, v143, v58
  v_max3_f32 v58, v144, v145, v58
  v_max3_f32 v58, v146, v147, v58
  v_mov_b32 v59, v58
  s_nop 1
  v_permlane32_swap_b32 v58, v59
  v_max_f32 v58, v58, v59
  v_mov_b32 v59, v58
  s_nop 1
  v_permlane16_swap_b32 v58, v59
  v_max_f32 v58, v58, v59
  v_sub_f32 v132, v132, v58
  v_sub_f32 v133, v133, v58
  v_sub_f32 v134, v134, v58
  v_sub_f32 v135, v135, v58
  v_sub_f32 v136, v136, v58
  v_sub_f32 v137, v137, v58
  v_sub_f32 v138, v138, v58
  v_sub_f32 v139, v139, v58
  v_sub_f32 v140, v140, v58
  v_sub_f32 v141, v141, v58
  v_sub_f32 v142, v142, v58
  v_sub_f32 v143, v143, v58
  v_sub_f32 v144, v144, v58
  v_sub_f32 v145, v145, v58
  v_sub_f32 v146, v146, v58
  v_sub_f32 v147, v147, v58
  v_exp_f32 v132, v132
  v_exp_f32 v133, v133
  v_exp_f32 v134, v134
  v_exp_f32 v135, v135
  v_cvt_pk_bf16_f32 v132, v132, v133
  v_cvt_pk_bf16_f32 v133, v134, v135
  v_exp_f32 v136, v136
  v_exp_f32 v137, v137
  v_exp_f32 v138, v138
  v_exp_f32 v139, v139
  v_cvt_pk_bf16_f32 v134, v136, v137
  v_cvt_pk_bf16_f32 v135, v138, v139
  v_exp_f32 v140, v140
  v_exp_f32 v141, v141
  v_exp_f32 v142, v142
  v_exp_f32 v143, v143
  v_cvt_pk_bf16_f32 v136, v140, v141
  v_cvt_pk_bf16_f32 v137, v142, v143
  v_exp_f32 v144, v144
  v_exp_f32 v145, v145
  v_exp_f32 v146, v146
  v_exp_f32 v147, v147
  v_cvt_pk_bf16_f32 v138, v144, v145
  v_cvt_pk_bf16_f32 v139, v146, v147
  v_mov_b64 v[128:129], 0
  s_nop 1
  v_smfmac_f32_16x16x64_bf16 v[128:131], a[240:243], v[132:139], v10
  v_mfma_f32_16x16x32_bf16 v[148:151], v[96:99], v[136:139], 0
  v_mfma_f32_16x16x32_bf16 v[148:151], v[68:71], v[132:135], v[148:151]
  v_mfma_f32_16x16x32_bf16 v[140:143], v[72:75], v[132:135], 0
  v_mfma_f32_16x16x32_bf16 v[140:143], v[104:107], v[136:139], v[140:143]
  v_mfma_f32_16x16x32_bf16 v[144:147], v[100:103], v[136:139], 0
  v_mfma_f32_16x16x32_bf16 v[144:147], v[76:79], v[132:135], v[144:147]
  v_add_f32 v128, v128, v129
  v_rcp_f32 v130, v128
  s_nop 0
  v_mul_f32 v148, v130, v148
  v_mul_f32 v149, v130, v149
  v_mul_f32 v150, v130, v150
  v_mul_f32 v151, v130, v151
  v_cvt_pk_bf16_f32 v148, v148, v149
  v_cvt_pk_bf16_f32 v149, v150, v151
  ds_write_b32 v5, v148 offset:0
  ds_write_b32 v5, v149 offset:1024
  v_mul_f32 v140, v130, v140
  v_mul_f32 v141, v130, v141
  v_mul_f32 v142, v130, v142
  v_mul_f32 v143, v130, v143
  v_cvt_pk_bf16_f32 v140, v140, v141
  v_cvt_pk_bf16_f32 v141, v142, v143
  ds_write_b32 v5, v140 offset:2048
  ds_write_b32 v5, v141 offset:3072
  v_mul_f32 v144, v130, v144
  v_mul_f32 v145, v130, v145
  v_mul_f32 v146, v130, v146
  v_mul_f32 v147, v130, v147
  v_cvt_pk_bf16_f32 v144, v144, v145
  v_cvt_pk_bf16_f32 v145, v146, v147
  ds_write_b32 v5, v144 offset:4096
  ds_write_b32 v5, v145 offset:5120
  v_mfma_f32_16x16x32_bf16 v[128:131], v[60:63], v[124:127], v[40:43]
  v_mfma_f32_16x16x32_bf16 v[128:131], v[62:65], v[14:17], v[128:131]
  v_mfma_f32_16x16x32_bf16 v[132:135], v[80:83], v[124:127], v[36:39]
  v_mfma_f32_16x16x32_bf16 v[132:135], v[82:85], v[14:17], v[132:135]
  v_mfma_f32_16x16x32_bf16 v[136:139], v[88:91], v[124:127], v[32:35]
  v_mfma_f32_16x16x32_bf16 v[136:139], v[90:93], v[14:17], v[136:139]
  v_mfma_f32_16x16x32_bf16 v[140:143], v[108:111], v[124:127], v[28:31]
  v_mfma_f32_16x16x32_bf16 v[140:143], v[110:113], v[14:17], v[140:143]
  v_add_f32 v128, v54, v128
  v_add_f32 v129, v54, v129
  v_add_f32 v130, v54, v130
  v_add_f32 v131, v54, v131
  v_add_f32 v132, v54, v132
  v_add_f32 v133, v54, v133
  v_add_f32 v134, v54, v134
  v_add_f32 v135, v54, v135
  v_add_f32 v136, v55, v136
  v_add_f32 v137, v55, v137
  v_add_f32 v138, v55, v138
  v_add_f32 v139, v55, v139
  v_add_f32 v140, v55, v140
  v_add_f32 v141, v55, v141
  v_add_f32 v142, v55, v142
  v_add_f32 v143, v55, v143
  v_max_f32 v58, v128, v129
  v_max3_f32 v58, v130, v131, v58
  v_max3_f32 v58, v132, v133, v58
  v_max3_f32 v58, v134, v135, v58
  v_max3_f32 v58, v136, v137, v58
  v_max3_f32 v58, v138, v139, v58
  v_max3_f32 v58, v140, v141, v58
  v_max3_f32 v58, v142, v143, v58
  v_mov_b32 v59, v58
  s_nop 1
  v_permlane32_swap_b32 v58, v59
  v_max_f32 v58, v58, v59
  v_mov_b32 v59, v58
  s_nop 1
  v_permlane16_swap_b32 v58, v59
  v_max_f32 v58, v58, v59
  v_sub_f32 v128, v128, v58
  v_sub_f32 v129, v129, v58
  v_sub_f32 v130, v130, v58
  v_sub_f32 v131, v131, v58
  v_sub_f32 v132, v132, v58
  v_sub_f32 v133, v133, v58
  v_sub_f32 v134, v134, v58
  v_sub_f32 v135, v135, v58
  v_sub_f32 v136, v136, v58
  v_sub_f32 v137, v137, v58
  v_sub_f32 v138, v138, v58
  v_sub_f32 v139, v139, v58
  v_sub_f32 v140, v140, v58
  v_sub_f32 v141, v141, v58
  v_sub_f32 v142, v142, v58
  v_sub_f32 v143, v143, v58
  v_exp_f32 v128, v128
  v_exp_f32 v129, v129
  v_exp_f32 v130, v130
  v_exp_f32 v131, v131
  v_cvt_pk_bf16_f32 v128, v128, v129
  v_cvt_pk_bf16_f32 v129, v130, v131
  v_exp_f32 v132, v132
  v_exp_f32 v133, v133
  v_exp_f32 v134, v134
  v_exp_f32 v135, v135
  v_cvt_pk_bf16_f32 v130, v132, v133
  v_cvt_pk_bf16_f32 v131, v134, v135
  v_exp_f32 v136, v136
  v_exp_f32 v137, v137
  v_exp_f32 v138, v138
  v_exp_f32 v139, v139
  v_cvt_pk_bf16_f32 v132, v136, v137
  v_cvt_pk_bf16_f32 v133, v138, v139
  v_exp_f32 v140, v140
  v_exp_f32 v141, v141
  v_exp_f32 v142, v142
  v_exp_f32 v143, v143
  v_cvt_pk_bf16_f32 v134, v140, v141
  v_cvt_pk_bf16_f32 v135, v142, v143
  v_mov_b64 v[124:125], 0
  s_nop 1
  v_smfmac_f32_16x16x64_bf16 v[124:127], a[240:243], v[128:135], v10
  v_mfma_f32_16x16x32_bf16 v[144:147], v[96:99], v[132:135], 0
  v_mfma_f32_16x16x32_bf16 v[144:147], v[68:71], v[128:131], v[144:147]
  v_mfma_f32_16x16x32_bf16 v[136:139], v[72:75], v[128:131], 0
  v_mfma_f32_16x16x32_bf16 v[136:139], v[104:107], v[132:135], v[136:139]
  v_mfma_f32_16x16x32_bf16 v[140:143], v[100:103], v[132:135], 0
  v_mfma_f32_16x16x32_bf16 v[140:143], v[76:79], v[128:131], v[140:143]
  v_add_f32 v124, v124, v125
  v_rcp_f32 v126, v124
  s_nop 0
  v_mul_f32 v144, v126, v144
  v_mul_f32 v145, v126, v145
  v_mul_f32 v146, v126, v146
  v_mul_f32 v147, v126, v147
  v_cvt_pk_bf16_f32 v144, v144, v145
  v_cvt_pk_bf16_f32 v145, v146, v147
  ds_write_b32 v5, v144 offset:256
  ds_write_b32 v5, v145 offset:1280
  v_mul_f32 v136, v126, v136
  v_mul_f32 v137, v126, v137
  v_mul_f32 v138, v126, v138
  v_mul_f32 v139, v126, v139
  v_cvt_pk_bf16_f32 v136, v136, v137
  v_cvt_pk_bf16_f32 v137, v138, v139
  ds_write_b32 v5, v136 offset:2304
  ds_write_b32 v5, v137 offset:3328
  v_mul_f32 v140, v126, v140
  v_mul_f32 v141, v126, v141
  v_mul_f32 v142, v126, v142
  v_mul_f32 v143, v126, v143
  v_cvt_pk_bf16_f32 v140, v140, v141
  v_cvt_pk_bf16_f32 v141, v142, v143
  ds_write_b32 v5, v140 offset:4352
  ds_write_b32 v5, v141 offset:5376
  v_mfma_f32_16x16x32_bf16 v[124:127], v[90:93], v[120:123], v[36:39]
  v_mfma_f32_16x16x32_bf16 v[124:127], v[88:91], v[18:21], v[124:127]
  v_mfma_f32_16x16x32_bf16 v[128:131], v[110:113], v[120:123], v[32:35]
  v_mfma_f32_16x16x32_bf16 v[128:131], v[108:111], v[18:21], v[128:131]
  v_mfma_f32_16x16x32_bf16 v[132:135], v[62:65], v[120:123], v[44:47]
  v_mfma_f32_16x16x32_bf16 v[132:135], v[60:63], v[18:21], v[132:135]
  v_mfma_f32_16x16x32_bf16 v[136:139], v[82:85], v[120:123], v[40:43]
  v_mfma_f32_16x16x32_bf16 v[136:139], v[80:83], v[18:21], v[136:139]
  v_add_f32 v124, v54, v124
  v_add_f32 v125, v54, v125
  v_add_f32 v126, v54, v126
  v_add_f32 v127, v54, v127
  v_add_f32 v128, v54, v128
  v_add_f32 v129, v54, v129
  v_add_f32 v130, v54, v130
  v_add_f32 v131, v54, v131
  v_add_f32 v132, v55, v132
  v_add_f32 v133, v55, v133
  v_add_f32 v134, v55, v134
  v_add_f32 v135, v55, v135
  v_add_f32 v136, v55, v136
  v_add_f32 v137, v55, v137
  v_add_f32 v138, v55, v138
  v_add_f32 v139, v55, v139
  v_max_f32 v58, v124, v125
  v_max3_f32 v58, v126, v127, v58
  v_max3_f32 v58, v128, v129, v58
  v_max3_f32 v58, v130, v131, v58
  v_max3_f32 v58, v132, v133, v58
  v_max3_f32 v58, v134, v135, v58
  v_max3_f32 v58, v136, v137, v58
  v_max3_f32 v58, v138, v139, v58
  v_mov_b32 v59, v58
  s_nop 1
  v_permlane32_swap_b32 v58, v59
  v_max_f32 v58, v58, v59
  v_mov_b32 v59, v58
  s_nop 1
  v_permlane16_swap_b32 v58, v59
  v_max_f32 v58, v58, v59
  v_sub_f32 v124, v124, v58
  v_sub_f32 v125, v125, v58
  v_sub_f32 v126, v126, v58
  v_sub_f32 v127, v127, v58
  v_sub_f32 v128, v128, v58
  v_sub_f32 v129, v129, v58
  v_sub_f32 v130, v130, v58
  v_sub_f32 v131, v131, v58
  v_sub_f32 v132, v132, v58
  v_sub_f32 v133, v133, v58
  v_sub_f32 v134, v134, v58
  v_sub_f32 v135, v135, v58
  v_sub_f32 v136, v136, v58
  v_sub_f32 v137, v137, v58
  v_sub_f32 v138, v138, v58
  v_sub_f32 v139, v139, v58
  v_exp_f32 v124, v124
  v_exp_f32 v125, v125
  v_exp_f32 v126, v126
  v_exp_f32 v127, v127
  v_cvt_pk_bf16_f32 v124, v124, v125
  v_cvt_pk_bf16_f32 v125, v126, v127
  v_exp_f32 v128, v128
  v_exp_f32 v129, v129
  v_exp_f32 v130, v130
  v_exp_f32 v131, v131
  v_cvt_pk_bf16_f32 v126, v128, v129
  v_cvt_pk_bf16_f32 v127, v130, v131
  v_exp_f32 v132, v132
  v_exp_f32 v133, v133
  v_exp_f32 v134, v134
  v_exp_f32 v135, v135
  v_cvt_pk_bf16_f32 v128, v132, v133
  v_cvt_pk_bf16_f32 v129, v134, v135
  v_exp_f32 v136, v136
  v_exp_f32 v137, v137
  v_exp_f32 v138, v138
  v_exp_f32 v139, v139
  v_cvt_pk_bf16_f32 v130, v136, v137
  v_cvt_pk_bf16_f32 v131, v138, v139
  v_mov_b64 v[120:121], 0
  s_nop 1
  v_smfmac_f32_16x16x64_bf16 v[120:123], a[240:243], v[124:131], v10
  v_mfma_f32_16x16x32_bf16 v[140:143], v[68:71], v[128:131], 0
  v_mfma_f32_16x16x32_bf16 v[140:143], v[96:99], v[124:127], v[140:143]
  v_mfma_f32_16x16x32_bf16 v[132:135], v[104:107], v[124:127], 0
  v_mfma_f32_16x16x32_bf16 v[132:135], v[72:75], v[128:131], v[132:135]
  v_mfma_f32_16x16x32_bf16 v[136:139], v[76:79], v[128:131], 0
  v_mfma_f32_16x16x32_bf16 v[136:139], v[100:103], v[124:127], v[136:139]
  v_add_f32 v120, v120, v121
  v_rcp_f32 v122, v120
  s_nop 0
  v_mul_f32 v140, v122, v140
  v_mul_f32 v141, v122, v141
  v_mul_f32 v142, v122, v142
  v_mul_f32 v143, v122, v143
  v_cvt_pk_bf16_f32 v140, v140, v141
  v_cvt_pk_bf16_f32 v141, v142, v143
  ds_write_b32 v5, v140 offset:512
  ds_write_b32 v5, v141 offset:1536
  v_mul_f32 v132, v122, v132
  v_mul_f32 v133, v122, v133
  v_mul_f32 v134, v122, v134
  v_mul_f32 v135, v122, v135
  v_cvt_pk_bf16_f32 v132, v132, v133
  v_cvt_pk_bf16_f32 v133, v134, v135
  ds_write_b32 v5, v132 offset:2560
  s_waitcnt lgkmcnt(12)
  ds_write_b32 v5, v133 offset:3584
  v_mul_f32 v136, v122, v136
  v_mul_f32 v137, v122, v137
  v_mul_f32 v138, v122, v138
  v_mul_f32 v139, v122, v139
  v_cvt_pk_bf16_f32 v136, v136, v137
  v_cvt_pk_bf16_f32 v137, v138, v139
  ds_write_b32 v5, v136 offset:4608
  ds_write_b32 v5, v137 offset:5632
  v_mfma_f32_16x16x32_bf16 v[120:123], v[88:91], v[116:119], v[40:43]
  v_mfma_f32_16x16x32_bf16 v[120:123], v[90:93], v[20:23], v[120:123]
  v_mfma_f32_16x16x32_bf16 v[124:127], v[108:111], v[116:119], v[36:39]
  v_mfma_f32_16x16x32_bf16 v[124:127], v[110:113], v[20:23], v[124:127]
  v_mfma_f32_16x16x32_bf16 v[128:131], v[60:63], v[116:119], v[48:51]
  v_mfma_f32_16x16x32_bf16 v[128:131], v[62:65], v[20:23], v[128:131]
  v_mfma_f32_16x16x32_bf16 v[88:91], v[80:83], v[116:119], v[44:47]
  v_mfma_f32_16x16x32_bf16 v[88:91], v[82:85], v[20:23], v[88:91]
  v_add_f32 v120, v54, v120
  v_add_f32 v121, v54, v121
  v_add_f32 v122, v54, v122
  v_add_f32 v123, v54, v123
  v_add_f32 v124, v54, v124
  v_add_f32 v125, v54, v125
  v_add_f32 v126, v54, v126
  v_add_f32 v127, v54, v127
  v_add_f32 v128, v55, v128
  v_add_f32 v129, v55, v129
  v_add_f32 v130, v55, v130
  v_add_f32 v131, v55, v131
  v_add_f32 v88, v55, v88
  v_add_f32 v89, v55, v89
  v_add_f32 v90, v55, v90
  v_add_f32 v91, v55, v91
  v_max_f32 v58, v120, v121
  v_max3_f32 v58, v122, v123, v58
  v_max3_f32 v58, v124, v125, v58
  v_max3_f32 v58, v126, v127, v58
  v_max3_f32 v58, v128, v129, v58
  v_max3_f32 v58, v130, v131, v58
  v_max3_f32 v58, v88, v89, v58
  v_max3_f32 v58, v90, v91, v58
  v_mov_b32 v59, v58
  s_nop 1
  v_permlane32_swap_b32 v58, v59
  v_max_f32 v58, v58, v59
  v_mov_b32 v59, v58
  s_nop 1
  v_permlane16_swap_b32 v58, v59
  v_max_f32 v58, v58, v59
  v_sub_f32 v120, v120, v58
  v_sub_f32 v121, v121, v58
  v_sub_f32 v122, v122, v58
  v_sub_f32 v123, v123, v58
  v_sub_f32 v124, v124, v58
  v_sub_f32 v125, v125, v58
  v_sub_f32 v126, v126, v58
  v_sub_f32 v127, v127, v58
  v_sub_f32 v128, v128, v58
  v_sub_f32 v129, v129, v58
  v_sub_f32 v130, v130, v58
  v_sub_f32 v131, v131, v58
  v_sub_f32 v88, v88, v58
  v_sub_f32 v89, v89, v58
  v_sub_f32 v90, v90, v58
  v_sub_f32 v91, v91, v58
  v_exp_f32 v120, v120
  v_exp_f32 v121, v121
  v_exp_f32 v122, v122
  v_exp_f32 v123, v123
  v_cvt_pk_bf16_f32 v120, v120, v121
  v_cvt_pk_bf16_f32 v121, v122, v123
  v_exp_f32 v124, v124
  v_exp_f32 v125, v125
  v_exp_f32 v126, v126
  v_exp_f32 v127, v127
  v_cvt_pk_bf16_f32 v122, v124, v125
  v_cvt_pk_bf16_f32 v123, v126, v127
  v_exp_f32 v128, v128
  v_exp_f32 v129, v129
  v_exp_f32 v130, v130
  v_exp_f32 v131, v131
  v_cvt_pk_bf16_f32 v124, v128, v129
  v_cvt_pk_bf16_f32 v125, v130, v131
  v_exp_f32 v88, v88
  v_exp_f32 v89, v89
  v_exp_f32 v90, v90
  v_exp_f32 v91, v91
  v_cvt_pk_bf16_f32 v126, v88, v89
  v_cvt_pk_bf16_f32 v127, v90, v91
  v_mov_b64 v[80:81], 0
  s_nop 1
  v_smfmac_f32_16x16x64_bf16 v[80:83], a[240:243], v[120:127], v10
  v_mfma_f32_16x16x32_bf16 v[84:87], v[68:71], v[124:127], 0
  v_mfma_f32_16x16x32_bf16 v[84:87], v[96:99], v[120:123], v[84:87]
  v_mfma_f32_16x16x32_bf16 v[60:63], v[104:107], v[120:123], 0
  v_mfma_f32_16x16x32_bf16 v[60:63], v[72:75], v[124:127], v[60:63]
  v_mfma_f32_16x16x32_bf16 v[64:67], v[76:79], v[124:127], 0
  v_mfma_f32_16x16x32_bf16 v[64:67], v[100:103], v[120:123], v[64:67]
  v_add_f32 v80, v80, v81
  v_rcp_f32 v82, v80
  s_nop 0
  v_mul_f32 v84, v82, v84
  v_mul_f32 v85, v82, v85
  v_mul_f32 v86, v82, v86
  v_mul_f32 v87, v82, v87
  v_cvt_pk_bf16_f32 v84, v84, v85
  v_cvt_pk_bf16_f32 v85, v86, v87
  s_waitcnt lgkmcnt(12)
  ds_write_b32 v5, v84 offset:768
  ds_write_b32 v5, v85 offset:1792
  v_mul_f32 v60, v82, v60
  v_mul_f32 v61, v82, v61
  v_mul_f32 v62, v82, v62
  v_mul_f32 v63, v82, v63
  v_cvt_pk_bf16_f32 v60, v60, v61
  v_cvt_pk_bf16_f32 v61, v62, v63
  ds_write_b32 v5, v60 offset:2816
  s_waitcnt lgkmcnt(12)
  ds_write_b32 v5, v61 offset:3840
  v_mul_f32 v64, v82, v64
  v_mul_f32 v65, v82, v65
  v_mul_f32 v66, v82, v66
  v_mul_f32 v67, v82, v67
  v_cvt_pk_bf16_f32 v64, v64, v65
  v_cvt_pk_bf16_f32 v65, v66, v67
  ds_write_b32 v5, v64 offset:4864
  ds_write_b32 v5, v65 offset:5888
  s_waitcnt lgkmcnt(0)
  s_barrier
  ds_read_b128 a[244:247], v3 offset:0
  ds_read_b128 a[248:251], v3 offset:4096
  ds_read_b128 a[252:255], v3 offset:8192
  ds_read_b128 v[72:75], v3 offset:12288
  ds_read_b128 v[76:79], v3 offset:16384
  ds_read_b128 v[84:87], v3 offset:20480
  s_waitcnt lgkmcnt(5)
  v_mfma_f32_16x16x32_bf16 v[68:71], a[244:247], v[184:187], 0
  s_waitcnt lgkmcnt(4)
  v_mfma_f32_16x16x32_bf16 v[68:71], a[248:251], v[200:203], v[68:71]
  s_waitcnt lgkmcnt(3)
  v_mfma_f32_16x16x32_bf16 v[68:71], a[252:255], v[216:219], v[68:71]
  s_waitcnt lgkmcnt(2)
  v_mfma_f32_16x16x32_bf16 v[68:71], v[72:75], v[232:235], v[68:71]
  s_waitcnt lgkmcnt(1)
  v_mfma_f32_16x16x32_bf16 v[68:71], v[76:79], v[248:251], v[68:71]
  s_waitcnt lgkmcnt(0)
  v_mfma_f32_16x16x32_bf16 v[68:71], v[84:87], a[224:227], v[68:71]
  v_mfma_f32_16x16x32_bf16 v[80:83], v[84:87], a[228:231], 0
  v_mfma_f32_16x16x32_bf16 v[80:83], v[76:79], v[252:255], v[80:83]
  v_mfma_f32_16x16x32_bf16 v[80:83], v[72:75], v[236:239], v[80:83]
  v_mfma_f32_16x16x32_bf16 v[80:83], a[252:255], v[220:223], v[80:83]
  v_mfma_f32_16x16x32_bf16 v[80:83], a[248:251], v[204:207], v[80:83]
  v_mfma_f32_16x16x32_bf16 v[80:83], a[244:247], v[188:191], v[80:83]
  v_mfma_f32_16x16x32_bf16 v[60:63], a[244:247], v[192:195], 0
  v_mfma_f32_16x16x32_bf16 v[60:63], a[248:251], v[208:211], v[60:63]
  v_mfma_f32_16x16x32_bf16 v[60:63], a[252:255], v[224:227], v[60:63]
  v_mfma_f32_16x16x32_bf16 v[60:63], v[72:75], v[240:243], v[60:63]
  v_mfma_f32_16x16x32_bf16 v[60:63], v[76:79], a[216:219], v[60:63]
  v_mfma_f32_16x16x32_bf16 v[60:63], v[84:87], a[232:235], v[60:63]
  v_mfma_f32_16x16x32_bf16 v[64:67], v[84:87], a[236:239], 0
  v_mfma_f32_16x16x32_bf16 v[64:67], v[76:79], a[220:223], v[64:67]
  v_mfma_f32_16x16x32_bf16 v[64:67], v[72:75], v[244:247], v[64:67]
  v_mfma_f32_16x16x32_bf16 v[64:67], a[252:255], v[228:231], v[64:67]
  v_mfma_f32_16x16x32_bf16 v[64:67], a[248:251], v[212:215], v[64:67]
  v_mfma_f32_16x16x32_bf16 v[64:67], a[244:247], v[196:199], v[64:67]
  v_cvt_pk_bf16_f32 v68, v68, v80
  v_cvt_pk_bf16_f32 v69, v69, v81
  v_cvt_pk_bf16_f32 v70, v70, v82
  v_cvt_pk_bf16_f32 v71, v71, v83
  buffer_store_dword v68, v7, s[24:27], s33 offen offset:0 nt
  buffer_store_dword v69, v7, s[24:27], s33 offen offset:384 nt
  buffer_store_dword v70, v7, s[24:27], s33 offen offset:768 nt
  buffer_store_dword v71, v7, s[24:27], s33 offen offset:1152 nt
  v_cvt_pk_bf16_f32 v60, v60, v64
  v_cvt_pk_bf16_f32 v61, v61, v65
  v_cvt_pk_bf16_f32 v62, v62, v66
  v_cvt_pk_bf16_f32 v63, v63, v67
  buffer_store_dword v60, v8, s[24:27], s33 offen offset:0 nt
  buffer_store_dword v61, v8, s[24:27], s33 offen offset:384 nt
  buffer_store_dword v62, v8, s[24:27], s33 offen offset:768 nt
  buffer_store_dword v63, v8, s[24:27], s33 offen offset:1152 nt
  ds_read_b128 a[244:247], v4 offset:0
  ds_read_b128 a[248:251], v4 offset:4096
  ds_read_b128 a[252:255], v4 offset:8192
  ds_read_b128 v[68:71], v4 offset:12288
  ds_read_b128 v[72:75], v4 offset:16384
  ds_read_b128 v[76:79], v4 offset:20480
  s_waitcnt lgkmcnt(5)
  v_mfma_f32_16x16x32_bf16 v[60:63], a[244:247], v[184:187], 0
  s_waitcnt lgkmcnt(4)
  v_mfma_f32_16x16x32_bf16 v[60:63], a[248:251], v[200:203], v[60:63]
  s_waitcnt lgkmcnt(3)
  v_mfma_f32_16x16x32_bf16 v[60:63], a[252:255], v[216:219], v[60:63]
  s_waitcnt lgkmcnt(2)
  v_mfma_f32_16x16x32_bf16 v[60:63], v[68:71], v[232:235], v[60:63]
  s_waitcnt lgkmcnt(1)
  v_mfma_f32_16x16x32_bf16 v[60:63], v[72:75], v[248:251], v[60:63]
  s_waitcnt lgkmcnt(0)
  v_mfma_f32_16x16x32_bf16 v[60:63], v[76:79], a[224:227], v[60:63]
  v_mfma_f32_16x16x32_bf16 v[64:67], v[76:79], a[228:231], 0
  v_mfma_f32_16x16x32_bf16 v[64:67], v[72:75], v[252:255], v[64:67]
  v_mfma_f32_16x16x32_bf16 v[64:67], v[68:71], v[236:239], v[64:67]
  v_mfma_f32_16x16x32_bf16 v[64:67], a[252:255], v[220:223], v[64:67]
  v_mfma_f32_16x16x32_bf16 v[64:67], a[248:251], v[204:207], v[64:67]
  v_mfma_f32_16x16x32_bf16 v[64:67], a[244:247], v[188:191], v[64:67]
  s_nop 7
  v_cvt_pk_bf16_f32 v60, v60, v64
  v_cvt_pk_bf16_f32 v61, v61, v65
  v_cvt_pk_bf16_f32 v62, v62, v66
  v_cvt_pk_bf16_f32 v63, v63, v67
  buffer_store_dword v60, v7, s[24:27], s34 offen offset:0 nt
  buffer_store_dword v61, v7, s[24:27], s34 offen offset:384 nt
  buffer_store_dword v62, v7, s[24:27], s34 offen offset:768 nt
  buffer_store_dword v63, v7, s[24:27], s34 offen offset:1152 nt
  ds_read_b128 a[244:247], v3 offset:512
  ds_read_b128 a[248:251], v3 offset:4608
  ds_read_b128 a[252:255], v3 offset:8704
  ds_read_b128 v[72:75], v3 offset:12800
  ds_read_b128 v[76:79], v3 offset:16896
  ds_read_b128 v[84:87], v3 offset:20992
  s_waitcnt lgkmcnt(5)
  v_mfma_f32_16x16x32_bf16 v[60:63], a[244:247], v[184:187], 0
  s_waitcnt lgkmcnt(4)
  v_mfma_f32_16x16x32_bf16 v[60:63], a[248:251], v[200:203], v[60:63]
  s_waitcnt lgkmcnt(3)
  v_mfma_f32_16x16x32_bf16 v[60:63], a[252:255], v[216:219], v[60:63]
  s_waitcnt lgkmcnt(2)
  v_mfma_f32_16x16x32_bf16 v[60:63], v[72:75], v[232:235], v[60:63]
  s_waitcnt lgkmcnt(1)
  v_mfma_f32_16x16x32_bf16 v[60:63], v[76:79], v[248:251], v[60:63]
  s_waitcnt lgkmcnt(0)
  v_mfma_f32_16x16x32_bf16 v[60:63], v[84:87], a[224:227], v[60:63]
  v_mfma_f32_16x16x32_bf16 v[80:83], v[84:87], a[228:231], 0
  v_mfma_f32_16x16x32_bf16 v[80:83], v[76:79], v[252:255], v[80:83]
  v_mfma_f32_16x16x32_bf16 v[80:83], v[72:75], v[236:239], v[80:83]
  v_mfma_f32_16x16x32_bf16 v[80:83], a[252:255], v[220:223], v[80:83]
  v_mfma_f32_16x16x32_bf16 v[80:83], a[248:251], v[204:207], v[80:83]
  v_mfma_f32_16x16x32_bf16 v[80:83], a[244:247], v[188:191], v[80:83]
  v_mfma_f32_16x16x32_bf16 v[64:67], a[244:247], v[192:195], 0
  v_mfma_f32_16x16x32_bf16 v[64:67], a[248:251], v[208:211], v[64:67]
  v_mfma_f32_16x16x32_bf16 v[64:67], a[252:255], v[224:227], v[64:67]
  v_mfma_f32_16x16x32_bf16 v[64:67], v[72:75], v[240:243], v[64:67]
  v_mfma_f32_16x16x32_bf16 v[64:67], v[76:79], a[216:219], v[64:67]
  v_mfma_f32_16x16x32_bf16 v[64:67], v[84:87], a[232:235], v[64:67]
  v_mfma_f32_16x16x32_bf16 v[68:71], v[84:87], a[236:239], 0
  v_mfma_f32_16x16x32_bf16 v[68:71], v[76:79], a[220:223], v[68:71]
  v_mfma_f32_16x16x32_bf16 v[68:71], v[72:75], v[244:247], v[68:71]
  v_mfma_f32_16x16x32_bf16 v[68:71], a[252:255], v[228:231], v[68:71]
  v_mfma_f32_16x16x32_bf16 v[68:71], a[248:251], v[212:215], v[68:71]
  v_mfma_f32_16x16x32_bf16 v[68:71], a[244:247], v[196:199], v[68:71]
  v_cvt_pk_bf16_f32 v60, v60, v80
  v_cvt_pk_bf16_f32 v61, v61, v81
  v_cvt_pk_bf16_f32 v62, v62, v82
  v_cvt_pk_bf16_f32 v63, v63, v83
  buffer_store_dword v60, v7, s[24:27], s35 offen offset:0 nt
  buffer_store_dword v61, v7, s[24:27], s35 offen offset:384 nt
  buffer_store_dword v62, v7, s[24:27], s35 offen offset:768 nt
  buffer_store_dword v63, v7, s[24:27], s35 offen offset:1152 nt
  v_cvt_pk_bf16_f32 v64, v64, v68
  v_cvt_pk_bf16_f32 v65, v65, v69
  v_cvt_pk_bf16_f32 v66, v66, v70
  v_cvt_pk_bf16_f32 v67, v67, v71
  buffer_store_dword v64, v8, s[24:27], s35 offen offset:0 nt
  buffer_store_dword v65, v8, s[24:27], s35 offen offset:384 nt
  buffer_store_dword v66, v8, s[24:27], s35 offen offset:768 nt
  buffer_store_dword v67, v8, s[24:27], s35 offen offset:1152 nt
  ds_read_b128 a[244:247], v4 offset:512
  ds_read_b128 a[248:251], v4 offset:4608
  ds_read_b128 a[252:255], v4 offset:8704
  ds_read_b128 v[72:75], v4 offset:12800
  ds_read_b128 v[76:79], v4 offset:16896
  ds_read_b128 v[80:83], v4 offset:20992
  s_waitcnt lgkmcnt(5)
  v_mfma_f32_16x16x32_bf16 v[60:63], a[244:247], v[184:187], 0
  s_waitcnt lgkmcnt(4)
  v_mfma_f32_16x16x32_bf16 v[60:63], a[248:251], v[200:203], v[60:63]
  s_waitcnt lgkmcnt(3)
  v_mfma_f32_16x16x32_bf16 v[60:63], a[252:255], v[216:219], v[60:63]
  s_waitcnt lgkmcnt(2)
  v_mfma_f32_16x16x32_bf16 v[60:63], v[72:75], v[232:235], v[60:63]
  s_waitcnt lgkmcnt(1)
  v_mfma_f32_16x16x32_bf16 v[60:63], v[76:79], v[248:251], v[60:63]
  s_waitcnt lgkmcnt(0)
  v_mfma_f32_16x16x32_bf16 v[60:63], v[80:83], a[224:227], v[60:63]
  v_mfma_f32_16x16x32_bf16 v[64:67], v[80:83], a[228:231], 0
  v_mfma_f32_16x16x32_bf16 v[64:67], v[76:79], v[252:255], v[64:67]
  v_mfma_f32_16x16x32_bf16 v[64:67], v[72:75], v[236:239], v[64:67]
  v_mfma_f32_16x16x32_bf16 v[64:67], a[252:255], v[220:223], v[64:67]
  v_mfma_f32_16x16x32_bf16 v[64:67], a[248:251], v[204:207], v[64:67]
  v_mfma_f32_16x16x32_bf16 v[64:67], a[244:247], v[188:191], v[64:67]
  s_nop 7
  v_cvt_pk_bf16_f32 v60, v60, v64
  v_cvt_pk_bf16_f32 v61, v61, v65
  v_cvt_pk_bf16_f32 v62, v62, v66
  v_cvt_pk_bf16_f32 v63, v63, v67
  buffer_store_dword v60, v7, s[24:27], s36 offen offset:0 nt
  buffer_store_dword v61, v7, s[24:27], s36 offen offset:384 nt
  buffer_store_dword v62, v7, s[24:27], s36 offen offset:768 nt
  buffer_store_dword v63, v7, s[24:27], s36 offen offset:1152 nt
  v_sub_u32 v6, v6, v56
  v_sub_u32 v7, v7, v57
  v_sub_u32 v8, v8, v57
  v_mov_b32 v54, 0
  v_mov_b32 v55, 0
  v_mov_b32 v56, 0
  v_mov_b32 v57, 0
  s_add_u32 s50, s50, 1
  s_cmp_eq_u32 s50, 16
  s_cselect_b32 s5, s58, s43
  s_add_u32 s56, s56, s5
  s_mul_i32 s5, s3, s57
  s_add_u32 s31, s56, s5
  s_add_u32 s32, s31, 786432
  s_xor_b32 s5, s4, 0
  s_mul_i32 s5, s5, 393216
  s_add_u32 s33, s5, s56
  s_xor_b32 s5, s4, 1
  s_mul_i32 s5, s5, 393216
  s_add_u32 s34, s5, s56
  s_xor_b32 s5, s4, 2
  s_mul_i32 s5, s5, 393216
  s_add_u32 s35, s5, s56
  s_xor_b32 s5, s4, 3
  s_mul_i32 s5, s5, 393216
  s_add_u32 s36, s5, s56
  s_cmp_lt_u32 s50, s49
  s_nop 7
  s_cbranch_scc1 L_sloop
  s_branch L_fin
.section .rodata,"a"
.p2align 6
.amdhsa_kernel standalone__window_attn_swin__vision_kernel
  .amdhsa_next_free_vgpr 512
  .amdhsa_next_free_sgpr 102
  .amdhsa_accum_offset 256
  .amdhsa_group_segment_fixed_size 0
  .amdhsa_kernarg_size 72
  .amdhsa_user_sgpr_count 2
  .amdhsa_user_sgpr_kernarg_segment_ptr 1
  .amdhsa_system_sgpr_workgroup_id_x 1
.end_amdhsa_kernel
```

```asm
; @launch grid=(256,1,1) block=(256,1,1) lds=163840
.amdgcn_target "amdgcn-amd-amdhsa--gfx950"
.text
.globl standalone__window_attn_swin__vision_kernel
.p2align 12
.p2align 8
.type standalone__window_attn_swin__vision_kernel,@function
standalone__window_attn_swin__vision_kernel:
  s_cmpk_ge_u32 s2, 256
  s_cbranch_scc1 L_end
  s_load_dwordx2 s[8:9], s[0:1], 0
  s_load_dwordx2 s[20:21], s[0:1], 24
  s_load_dwordx2 s[12:13], s[0:1], 8
  s_load_dwordx2 s[16:17], s[0:1], 16
  s_load_dwordx2 s[24:25], s[0:1], 48
  s_load_dwordx2 s[62:63], s[0:1], 64
  v_lshrrev_b32 v73, 6, v0
  s_lshr_b32 s49, s2, 3
  v_readfirstlane_b32 s3, v73
  s_getpc_b64 s[50:51]
  v_and_b32 v73, 15, v0
  v_mad_u32_u24 v73, s49, 9, v73
  v_lshlrev_b32 v73, 7, v73
  v_min_u32 v73, L_safe-standalone__window_attn_swin__vision_kernel-256, v73
  v_mov_b32 v59, s51
  v_add_co_u32 v58, vcc, s50, v73
  s_and_b32 s47, s2, 63
  s_lshr_b32 s48, s2, 6
  v_addc_co_u32 v59, vcc, 0, v59, vcc
  global_load_dword v94, v[58:59], off
  v_bfe_u32 v56, v0, 3, 4
  v_and_b32 v54, 7, v0
  v_lshrrev_b32 v66, 1, v56
  v_lshlrev_b32 v74, 2, v56
  v_and_b32 v74, 4, v74
  v_xor_b32 v66, v66, v74
  v_xor_b32 v66, v54, v66
  v_and_b32 v55, 7, v56
  s_add_u32 s48, s48, 60
  s_cmp_lt_u32 s2, 60
  s_cselect_b32 s48, s2, s48
  s_cselect_b32 s47, 63, s47
  s_lshl_b32 s5, s47, 3
  s_add_u32 s5, s5, 4
  v_add_u32 v74, s5, v55
  v_and_b32 v74, 511, v74
  v_mul_u32_u24 v74, 0x180, v74
  v_lshlrev_b32 v57, 4, v66
  v_add_u32 v6, v57, v74
  v_and_b32 v64, 63, v0
  v_lshlrev_b32 v58, 4, v64
  s_mov_b32 s57, 196608
  s_lshl_b32 s5, s48, 3
  s_add_u32 s5, s5, s3
  s_add_u32 s5, s5, 4
  s_mul_i32 s31, s5, s57
  s_add_u32 s5, s5, 4
  s_and_b32 s5, s5, 511
  s_mul_i32 s32, s5, s57
  s_lshl_b32 s46, s3, 10
  s_lshl_b32 s5, s3, 11
  s_add_u32 m0, s5, 147456
  s_mov_b32 s11, 0x20000
  s_mov_b32 s10, 100663296
  s_mov_b32 s23, s11
  s_movk_i32 s22, 1800
  s_mov_b32 s15, s11
  s_mov_b32 s14, 221184
  s_waitcnt lgkmcnt(0)
  buffer_load_dwordx4 v58, s[20:23], 0 offen lds
  buffer_load_dwordx4 v58, s[20:23], 0 offen offset:1024 lds
  s_add_u32 m0, s46, 0
  v_and_b32 v66, 2, v56
  buffer_load_dwordx4 v6, s[8:11], s31 offen offset:0 nt lds
  s_add_u32 m0, s46, 8064
  v_lshrrev_b32 v74, 1, v56
  buffer_load_dwordx4 v6, s[8:11], s31 offen offset:128 nt lds
  s_add_u32 m0, s46, 16128
  v_and_b32 v74, 4, v74
  buffer_load_dwordx4 v6, s[8:11], s31 offen offset:256 nt lds
  s_add_u32 m0, s46, 4096
  v_or_b32 v74, v66, v74
  buffer_load_dwordx4 v6, s[8:11], s32 offen offset:0 nt lds
  s_add_u32 m0, s46, 12160
  v_xor_b32 v74, v54, v74
  buffer_load_dwordx4 v6, s[8:11], s32 offen offset:128 nt lds
  s_add_u32 m0, s46, 20224
  v_lshlrev_b32 v74, 4, v74
  buffer_load_dwordx4 v6, s[8:11], s32 offen offset:256 nt lds
  v_mul_u32_u24 v56, 1152, v55
  v_add_u32 v58, v74, v56
  s_mul_i32 s44, s3, 9216
  s_mov_b32 s19, s11
  s_mov_b32 s18, 73728
  s_lshl_b32 s49, s49, 2
  s_add_u32 s49, s49, s3
  s_mul_i32 s50, s49, 2304
  v_min_u32 v92, 17, v64
  v_lshlrev_b32 v92, 7, v92
  v_lshlrev_b32 v66, 1, v66
  v_xor_b32 v66, v54, v66
  v_mul_u32_u24 v74, 0x180, v55
  v_lshl_add_u32 v71, v66, 4, v74
  s_mul_i32 s45, s3, 3072
  v_add_u32 v6, v57, v74
  s_mov_b32 s27, s11
  s_mov_b32 s26, 100663296
  v_and_b32 v54, 15, v64
  v_lshrrev_b32 v55, 4, v64
  v_lshrrev_b32 v73, 1, v54
  v_lshlrev_b32 v66, 2, v54
  v_and_b32 v66, 4, v66
  v_xor_b32 v73, v73, v66
  v_xor_b32 v73, v55, v73
  v_lshlrev_b32 v73, 4, v73
  v_lshl_add_u32 v0, v54, 7, v73
  v_xor_b32 v1, 64, v0
  v_subrev_u32 v2, s46, v0
  s_add_u32 s28, s46, 24576
  s_add_u32 s29, s46, 49152
  s_mov_b32 s30, s46
  s_and_b32 s4, s3, 1
  v_lshlrev_b32 v73, 4, v54
  v_lshl_add_u32 v66, v55, 10, v73
  s_lshl_b32 s5, s4, 8
  s_add_u32 s5, s5, 73728
  v_add_u32 v3, s5, v66
  v_xor_b32 v4, 0x100, v3
  s_mul_i32 s5, s3, 6144
  s_add_u32 s6, s5, 98304
  s_add_u32 s5, s5, 73728
  s_xor_b32 s41, s5, s6
  v_lshl_add_u32 v66, v55, 2, v73
  v_add_u32 v5, s5, v66
  v_and_b32 v65, 7, v54
  v_lshrrev_b32 v70, 3, v54
  v_and_b32 v67, 1, v55
  v_lshrrev_b32 v72, 1, v55
  v_mul_u32_u24 v73, 0x600, v67
  v_mul_u32_u24 v66, s57, v72
  v_add_u32 v73, v73, v66
  v_lshl_add_u32 v73, v54, 2, v73
  s_lshr_b32 s49, s3, 1
  s_lshl_b32 s5, s49, 6
  s_add_u32 s6, s5, 256
  v_add_u32 v53, s6, v73
  s_lshl_b32 s6, s4, 7
  s_add_u32 s5, s5, s6
  v_add_u32 v52, s5, v73
  s_lshl_b32 s5, s47, 3
  s_add_u32 s5, s5, 4
  s_mul_i32 s5, s5, 384
  s_cmp_eq_u32 s47, 63
  s_cselect_b32 s37, 0, s5
  s_cselect_b32 s5, s5, 0
  s_cselect_b32 s6, s57, 0
  v_mul_u32_u24 v66, s6, v67
  v_sub_u32 v66, s5, v66
  s_lshl_b32 s38, s48, 3
  s_add_u32 s38, s38, 4
  s_xor_b32 s6, s4, 0
  s_lshl_b32 s6, s6, 1
  s_add_u32 s6, s6, s38
  s_and_b32 s6, s6, 511
  s_mul_i32 s6, s6, s57
  s_add_u32 s33, s6, s37
  s_xor_b32 s6, s4, 1
  s_lshl_b32 s6, s6, 1
  s_add_u32 s6, s6, s38
  s_and_b32 s6, s6, 511
  s_mul_i32 s6, s6, s57
  s_add_u32 s34, s6, s37
  s_xor_b32 s6, s4, 2
  s_lshl_b32 s6, s6, 1
  s_add_u32 s6, s6, s38
  s_and_b32 s6, s6, 511
  s_mul_i32 s6, s6, s57
  s_add_u32 s35, s6, s37
  s_xor_b32 s6, s4, 3
  s_lshl_b32 s6, s6, 1
  s_add_u32 s6, s6, s38
  s_and_b32 s6, s6, 511
  s_mul_i32 s6, s6, s57
  s_add_u32 s36, s6, s37
  v_add_u32 v7, v52, v66
  v_add_u32 v8, v53, v66
  s_lshr_b32 s5, s2, 6
  s_and_b32 s6, s2, 63
  s_mul_i32 s56, s5, 15
  s_lshl_b32 s43, s57, 5
  s_cmp_eq_u32 s6, 63
  s_cselect_b32 s6, s56, s6
  s_cselect_b32 s5, 60, s5
  s_cselect_b32 s43, 3072, s43
  s_mul_i32 s5, s5, 1572864
  s_mul_i32 s6, s6, 3072
  s_add_u32 s5, s5, s6
  s_add_u32 s56, s5, 787968
  s_cmp_eq_u32 s43, 3072
  s_cselect_b32 s10, s10, 95158272
  s_mul_i32 s5, s3, s57
  s_add_u32 s31, s56, s5
  s_add_u32 s32, s31, 786432
  s_mul_i32 s6, s43, 3
  s_add_u32 s5, s5, s6
  s_xor_b32 s6, s4, 0
  s_mul_i32 s6, s6, 393216
  s_sub_u32 s37, s6, s5
  s_xor_b32 s6, s4, 1
  s_mul_i32 s6, s6, 393216
  s_sub_u32 s38, s6, s5
  s_xor_b32 s6, s4, 2
  s_mul_i32 s6, s6, 393216
  s_sub_u32 s39, s6, s5
  s_xor_b32 s6, s4, 3
  s_mul_i32 s6, s6, 393216
  s_sub_u32 s40, s6, s5
  s_mul_i32 s97, s43, 17
  s_add_u32 s97, s97, s31
  s_mov_b32 s42, 0x3e553b95
  v_lshrrev_b32 v73, 2, v54
  v_lshl_add_u32 v66, v67, 1, v70
  v_lshl_add_u32 v73, v55, 3, v73
  v_lshlrev_b32 v73, 7, v73
  v_lshl_add_u32 v73, v66, 5, v73
  v_and_b32 v75, 3, v54
  v_lshl_add_u32 v73, v75, 3, v73
  s_mul_i32 s5, s3, 3
  s_and_b32 s6, s5, 3
  s_lshl_b32 s6, s6, 5
  s_lshr_b32 s7, s5, 2
  s_lshl_b32 s7, s7, 13
  s_add_u32 s7, s7, 24576
  v_xor_b32 v66, s6, v73
  v_add_u32 v61, s7, v66
  v_add_u32 v57, 73728, v61
  s_add_u32 s5, s5, 1
  s_and_b32 s6, s5, 3
  s_lshl_b32 s6, s6, 5
  s_lshr_b32 s7, s5, 2
  s_lshl_b32 s7, s7, 13
  s_add_u32 s7, s7, 24576
  v_xor_b32 v66, s6, v73
  v_add_u32 v62, s7, v66
  v_add_u32 v60, 73728, v62
  s_add_u32 s5, s5, 1
  s_and_b32 s6, s5, 3
  s_lshl_b32 s6, s6, 5
  s_lshr_b32 s7, s5, 2
  s_lshl_b32 s7, s7, 13
  s_add_u32 s7, s7, 24576
  v_xor_b32 v66, s6, v73
  v_add_u32 v63, s7, v66
  v_add_u32 v59, 73728, v63
  v_xor_b32 v66, s49, v67
  s_lshl_b32 s5, s4, 13
  v_lshl_add_u32 v73, v72, 3, v67
  v_lshl_add_u32 v73, v73, 2, v66
  v_lshl_add_u32 v73, v73, 4, v54
  v_lshlrev_b32 v73, 2, v73
  s_add_u32 s5, s5, 122880
  v_add_u32 v68, s5, v73
  v_add_u32 v69, 128, v68
  v_add_u32 v54, 139264, v73
  v_add_u32 v55, 128, v54
  s_mov_b32 s58, 0x05040100
  s_mov_b32 s59, 0x07060302
  v_cmp_gt_u32 vcc, 2, v75
  v_mov_b32 v73, 0x3f803f80
  v_mov_b32 v66, 0x44444444
  v_cndmask_b32 v73, 0, v73, vcc
  v_cmp_eq_u32 vcc, 1, v75
  v_mov_b32 v74, 0xeeeeeeee
  v_accvgpr_write_b32 a240, v73
  v_accvgpr_write_b32 a241, v73
  v_accvgpr_write_b32 a242, v73
  v_accvgpr_write_b32 a243, v73
  v_cndmask_b32 v10, v66, v74, vcc
  v_mov_b32 v9, 1.0
  s_mov_b32 s98, s43
  s_mov_b64 s[20:21], s[62:63]
  s_mov_b32 s22, 402653184
  s_min_u32 s96, s3, 1
  s_lshl_b32 s96, s96, 7
  s_xor_b32 s96, s96, 1152
  s_mov_b64 s[62:63], -1
  v_lshlrev_b32 v11, 3, v64
  v_lshlrev_b32 v73, 2, v65
  v_add_u32 v73, 155712, v73
  v_mov_b32 v66, 0
  ds_write_b32 v73, v66
  v_mov_b64 v[14:15], 0
  v_mov_b64 v[20:21], 0
  v_sub_u32 v73, v70, v72
  v_mul_i32_i24 v73, 15, v73
  v_lshlrev_b32 v66, 2, v67
  v_sub_u32 v74, v65, v66
  v_add3_u32 v73, v73, v74, 19
  s_mul_i32 s5, s3, 2050
  s_add_u32 s5, s5, 147456
  v_lshl_add_u32 v64, v73, 3, s5
  v_mov_b64 v[24:25], 0
  v_mov_b64 v[26:27], 0
  v_mov_b64 v[28:29], 0
  v_mov_b64 v[30:31], 0
  v_mov_b64 v[32:33], 0
  v_mov_b64 v[34:35], 0
  v_mov_b64 v[36:37], 0
  v_mov_b64 v[38:39], 0
  v_mov_b64 v[40:41], 0
  v_mov_b64 v[42:43], 0
  v_mov_b64 v[44:45], 0
  v_mov_b64 v[46:47], 0
  v_mov_b64 v[48:49], 0
  v_mov_b64 v[50:51], 0
  v_xor_b32 v73, v66, v65
  s_cmp_eq_u32 s47, 63
  s_cselect_b32 s5, 4, 0
  v_and_b32 v73, s5, v73
  v_cmp_eq_u32 vcc, 0, v73
  s_cmp_eq_u32 s48, 63
  s_cselect_b32 s5, 0xc31044fe, 0
  v_mov_b32 v93, s5
  v_mov_b32 v70, 0xc31044fe
  v_cndmask_b32 v93, 0, v93, vcc
  v_cndmask_b32 v70, v70, 0, vcc
  s_add_u32 s5, s44, 0
  s_add_u32 m0, s46, 24576
  s_nop 0
  buffer_load_dwordx4 v58, s[12:15], s5 offen offset:0 lds
  s_add_u32 m0, s46, 32640
  s_nop 0
  buffer_load_dwordx4 v58, s[12:15], s5 offen offset:128 lds
  s_add_u32 m0, s46, 40704
  s_nop 0
  buffer_load_dwordx4 v58, s[12:15], s5 offen offset:256 lds
  s_add_u32 s5, s44, 36864
  s_add_u32 m0, s46, 28672
  s_nop 0
  buffer_load_dwordx4 v58, s[12:15], s5 offen offset:0 lds
  s_add_u32 m0, s46, 36736
  s_nop 0
  buffer_load_dwordx4 v58, s[12:15], s5 offen offset:128 lds
  s_add_u32 m0, s46, 44800
  s_nop 0
  buffer_load_dwordx4 v58, s[12:15], s5 offen offset:256 lds
  s_waitcnt vmcnt(12)
  ds_read_u16_d16_hi v24, v64 offset:24
  ds_read_u16_d16_hi v25, v64 offset:16
  ds_read_u16_d16_hi v26, v64 offset:8
  ds_read_u16_d16_hi v27, v64 offset:0
  ds_read_u16_d16_hi v28, v64 offset:264
  ds_read_u16_d16_hi v29, v64 offset:256
  ds_read_u16_d16_hi v30, v64 offset:248
  ds_read_u16_d16_hi v31, v64 offset:240
  ds_read_u16_d16_hi v32, v64 offset:504
  ds_read_u16_d16_hi v33, v64 offset:496
  ds_read_u16_d16_hi v34, v64 offset:488
  ds_read_u16_d16_hi v35, v64 offset:480
  ds_read_u16_d16_hi v36, v64 offset:744
  ds_read_u16_d16_hi v37, v64 offset:736
  ds_read_u16_d16_hi v38, v64 offset:728
  ds_read_u16_d16_hi v39, v64 offset:720
  ds_read_u16_d16_hi v40, v64 offset:984
  ds_read_u16_d16_hi v41, v64 offset:976
  ds_read_u16_d16_hi v42, v64 offset:968
  ds_read_u16_d16_hi v43, v64 offset:960
  ds_read_u16_d16_hi v44, v64 offset:1224
  ds_read_u16_d16_hi v45, v64 offset:1216
  ds_read_u16_d16_hi v46, v64 offset:1208
  ds_read_u16_d16_hi v47, v64 offset:1200
  ds_read_u16_d16_hi v48, v64 offset:1464
  ds_read_u16_d16_hi v49, v64 offset:1456
  ds_read_u16_d16_hi v50, v64 offset:1448
  ds_read_u16_d16_hi v51, v64 offset:1440
  s_mov_b32 s5, 0x3fb8aa3b
  v_add_f32 v93, v70, v93
  s_waitcnt lgkmcnt(15)
  v_mul_f32 v24, s5, v24
  v_mul_f32 v25, s5, v25
  v_mul_f32 v26, s5, v26
  v_mul_f32 v27, s5, v27
  v_mul_f32 v28, s5, v28
  v_mul_f32 v29, s5, v29
  v_mul_f32 v30, s5, v30
  v_mul_f32 v31, s5, v31
  v_mul_f32 v32, s5, v32
  v_mul_f32 v33, s5, v33
  v_mul_f32 v34, s5, v34
  v_mul_f32 v35, s5, v35
  v_mul_f32 v36, s5, v36
  s_waitcnt lgkmcnt(14)
  v_mul_f32 v37, s5, v37
  s_waitcnt lgkmcnt(13)
  v_mul_f32 v38, s5, v38
  s_waitcnt lgkmcnt(12)
  v_mul_f32 v39, s5, v39
  s_waitcnt lgkmcnt(11)
  v_mul_f32 v40, s5, v40
  s_waitcnt lgkmcnt(10)
  v_mul_f32 v41, s5, v41
  s_waitcnt lgkmcnt(9)
  v_mul_f32 v42, s5, v42
  s_waitcnt lgkmcnt(8)
  v_mul_f32 v43, s5, v43
  s_waitcnt lgkmcnt(7)
  v_mul_f32 v44, s5, v44
  s_waitcnt lgkmcnt(6)
  v_mul_f32 v45, s5, v45
  s_waitcnt lgkmcnt(5)
  v_mul_f32 v46, s5, v46
  s_waitcnt lgkmcnt(4)
  v_mul_f32 v47, s5, v47
  s_waitcnt lgkmcnt(3)
  v_mul_f32 v48, s5, v48
  s_waitcnt lgkmcnt(2)
  v_mul_f32 v49, s5, v49
  s_waitcnt lgkmcnt(1)
  v_mul_f32 v50, s5, v50
  s_waitcnt lgkmcnt(0)
  v_mul_f32 v51, s5, v51
  v_add_f32 v72, v93, v48
  v_add_f32 v73, v93, v49
  v_add_f32 v74, v93, v50
  v_add_f32 v75, v93, v51
  v_add_f32 v64, v93, v44
  v_add_f32 v65, v93, v45
  v_add_f32 v66, v93, v46
  v_add_f32 v67, v93, v47
  v_add_f32 v76, v93, v40
  v_add_f32 v77, v93, v41
  v_add_f32 v78, v93, v42
  v_add_f32 v79, v93, v43
  v_add_f32 v84, v93, v32
  v_add_f32 v85, v93, v33
  v_add_f32 v86, v93, v34
  v_add_f32 v87, v93, v35
  v_add_f32 v80, v93, v28
  v_add_f32 v81, v93, v29
  v_add_f32 v82, v93, v30
  v_add_f32 v83, v93, v31
  v_add_f32 v88, v93, v24
  v_add_f32 v89, v93, v25
  v_add_f32 v90, v93, v26
  v_add_f32 v91, v93, v27
  s_add_u32 s5, s44, 73728
  s_add_u32 m0, s46, 49152
  s_nop 0
  buffer_load_dwordx4 v58, s[12:15], s5 offen offset:0 lds
  s_add_u32 m0, s46, 57216
  s_nop 0
  buffer_load_dwordx4 v58, s[12:15], s5 offen offset:128 lds
  s_add_u32 m0, s46, 65280
  s_nop 0
  buffer_load_dwordx4 v58, s[12:15], s5 offen offset:256 lds
  s_add_u32 s5, s44, 110592
  s_add_u32 m0, s46, 53248
  s_nop 0
  buffer_load_dwordx4 v58, s[12:15], s5 offen offset:0 lds
  s_add_u32 m0, s46, 61312
  s_nop 0
  buffer_load_dwordx4 v58, s[12:15], s5 offen offset:128 lds
  s_add_u32 m0, s46, 69376
  s_nop 0
  buffer_load_dwordx4 v58, s[12:15], s5 offen offset:256 lds
  s_cmp_ge_u32 s50, s14
  s_cselect_b64 s[52:53], s[16:17], s[12:13]
  s_cselect_b64 s[54:55], s[18:19], s[14:15]
  s_cselect_b32 s5, s14, 0
  s_sub_u32 s50, s50, s5
  buffer_load_dword v96, v92, s[52:55], s50 offen
  s_mov_b64 exec, 0
  s_cmp_eq_u32 s3, 0
  s_cbranch_scc1 L_hop_0_0
  s_cmp_eq_u32 s3, 1
  s_cbranch_scc1 L_hop_1_0
  s_cmp_eq_u32 s3, 2
  s_cbranch_scc1 L_hop_2_0
  s_branch L_hop_3_0
  s_nop 0
  s_nop 0
  s_nop 0
  s_nop 0
  s_nop 0
  s_nop 0
  s_nop 0
  s_nop 0
  s_nop 0
  s_nop 0
  s_nop 0
  s_nop 0
  s_nop 0
  s_nop 0
  s_nop 0
  s_nop 0
  s_nop 0
  s_nop 0
  s_nop 0
  s_nop 0
  s_nop 0
  s_nop 0
  s_nop 0
  s_nop 0
  s_nop 0
  s_nop 0
  s_nop 0
  s_nop 0
  s_nop 0
  s_nop 0
  s_nop 0
  s_nop 0
  s_nop 0
  s_nop 0
  s_nop 0
  s_nop 0
  s_nop 0
  s_nop 0
  s_nop 0
  s_nop 0
  s_nop 0
  s_nop 0
  s_nop 0
  s_nop 0
  s_nop 0
  s_nop 0
  s_nop 0
  s_nop 0
  s_nop 0
  s_nop 0
  s_nop 0
  s_nop 0
  s_nop 0
  s_nop 0
  s_nop 0
  s_nop 0
  s_nop 0
  s_nop 0
  s_nop 0
  s_nop 0
  s_nop 0
  s_nop 0
  s_nop 0
  s_nop 0
  s_nop 0
  s_nop 0
  s_nop 0
  s_nop 0
  s_nop 0
  s_nop 0
  s_nop 0
  s_nop 0
  s_nop 0
  s_nop 0
  s_nop 0
  s_nop 0
  s_nop 0
  s_nop 0
  s_nop 0
  s_nop 0
  s_nop 0
  s_nop 0
  s_nop 0
  s_nop 0
  s_nop 0
  s_nop 0
  s_nop 0
  s_nop 0
  s_nop 0
  s_nop 0
  s_nop 0
  s_nop 0
  s_nop 0
  s_nop 0
  s_nop 0
  s_nop 0
  s_nop 0
  s_nop 0
  s_nop 0
  s_nop 0
  s_nop 0
  s_nop 0
  s_nop 0
  s_nop 0
  s_nop 0
  s_nop 0
  s_nop 0
  s_nop 0
  s_nop 0
  s_nop 0
  s_nop 0
  s_nop 0
  s_nop 0
  s_nop 0
  s_nop 0
  s_nop 0
  s_nop 0
  s_nop 0
  s_nop 0
  s_nop 0
  s_nop 0
  s_nop 0
  s_nop 0
  s_nop 0
  s_nop 0
  s_nop 0
  s_nop 0
  s_nop 0
  s_nop 0
  s_nop 0
  s_nop 0
  s_nop 0
  s_nop 0
  s_nop 0
  s_nop 0
  s_nop 0
  s_nop 0
  s_nop 0
  s_nop 0
  s_nop 0
  s_nop 0
  s_nop 0
  s_nop 0
  s_nop 0
  s_nop 0
  s_nop 0
  s_nop 0
  s_nop 0
  s_nop 0
  s_nop 0
  s_nop 0
  s_nop 0
  s_nop 0
  s_nop 0
  s_nop 0
  s_nop 0
  s_nop 0
  s_nop 0
  s_nop 0
  s_nop 0
  s_nop 0
  s_nop 0
  s_nop 0
  s_nop 0
  s_nop 0
  s_nop 0
  s_nop 0
  s_nop 0
  s_nop 0
  s_nop 0
  s_nop 0
  s_nop 0
  s_nop 0
  s_nop 0
  s_nop 0
  s_nop 0
  s_nop 0
  s_nop 0
  s_nop 0
  s_nop 0
  s_nop 0
  s_nop 0
  s_nop 0
  s_nop 0
  s_nop 0
  s_nop 0
  s_nop 0
  s_nop 0
  s_nop 0
  s_nop 0
  s_nop 0
  s_nop 0
  s_nop 0
  s_nop 0
  s_nop 0
  s_nop 0
  s_nop 0
  s_nop 0
  s_nop 0
  s_nop 0
  s_nop 0
  s_nop 0
  s_nop 0
  s_nop 0
  s_nop 0
  s_nop 0
  s_nop 0
  s_nop 0
  s_nop 0
  s_nop 0
  s_nop 0
  s_nop 0
  s_nop 0
  s_nop 0
  s_nop 0
  s_nop 0
  s_nop 0
  s_nop 0
  s_nop 0
  s_nop 0
  s_nop 0
  s_nop 0
  s_nop 0
  s_nop 0
  s_nop 0
  s_nop 0
  s_nop 0
  s_nop 0
  s_nop 0
  s_nop 0
  s_nop 0
  s_nop 0
  s_nop 0
  s_nop 0
  s_nop 0
  s_nop 0
  s_nop 0
  s_nop 0
  s_nop 0
  s_nop 0
  s_nop 0
  s_nop 0
  s_nop 0
  s_nop 0
  s_nop 0
  s_nop 0
  s_nop 0
  s_nop 0
  s_nop 0
  s_nop 0
  s_nop 0
  s_nop 0
  s_nop 0
  s_nop 0
  s_nop 0
  s_nop 0
  s_nop 0
  s_nop 0
  s_nop 0
  s_nop 0
  s_nop 0
  s_nop 0
  s_nop 0
  s_nop 0
  s_nop 0
  s_nop 0
  s_nop 0
  s_nop 0
  s_nop 0
  s_nop 0
  s_nop 0
  s_nop 0
  s_nop 0
  s_nop 0
  s_nop 0
  s_nop 0
  s_nop 0
  s_nop 0
  s_nop 0
  s_nop 0
  s_nop 0
  s_nop 0
  s_nop 0
  s_nop 0
  s_nop 0
  s_nop 0
  s_nop 0
  s_nop 0
  s_nop 0
  s_nop 0
  s_nop 0
  s_nop 0
  s_nop 0
  s_nop 0
  s_nop 0
  s_nop 0
  s_nop 0
  s_nop 0
  s_nop 0
  s_nop 0
  s_nop 0
  s_nop 0
  s_nop 0
  s_nop 0
  s_nop 0
  s_nop 0
  s_nop 0
  s_nop 0
  s_nop 0
  s_nop 0
  s_nop 0
  s_nop 0
  s_nop 0
  s_nop 0
  s_nop 0
  s_nop 0
  s_nop 0
  s_nop 0
  s_nop 0
  s_nop 0
  s_nop 0
  s_nop 0
  s_nop 0
  s_nop 0
  s_nop 0
  s_nop 0
  s_nop 0
  s_nop 0
  s_nop 0
  s_nop 0
  s_nop 0
  s_nop 0
  s_nop 0
  s_nop 0
  s_nop 0
  s_nop 0
  s_nop 0
  s_nop 0
  s_nop 0
  s_nop 0
  s_nop 0
  s_nop 0
  s_nop 0
  s_nop 0
  s_nop 0
  s_nop 0
  s_nop 0
  s_nop 0
  s_nop 0
  s_nop 0
  s_nop 0
  s_nop 0
  s_nop 0
  s_nop 0
  s_nop 0
  s_nop 0
  s_nop 0
  s_nop 0
  s_nop 0
  s_nop 0
  s_nop 0
  s_nop 0
  s_nop 0
  s_nop 0
  s_nop 0
  s_nop 0
  s_nop 0
  s_nop 0
  s_nop 0
  s_nop 0
  s_nop 0
  s_nop 0
  s_nop 0
  s_nop 0
  s_nop 0
  s_nop 0
  s_nop 0
  s_nop 0
L_walk:
  s_mov_b64 exec, -1
L_walked:
  s_waitcnt vmcnt(13)
  s_barrier
  ds_read_b128 v[184:187], v0 offset:0
  ds_read_b128 v[188:191], v1 offset:0
  ds_read_b128 v[208:211], v0 offset:2048
  ds_read_b128 v[212:215], v1 offset:2048
  ds_read_b128 v[232:235], v0 offset:4096
  ds_read_b128 v[236:239], v1 offset:4096
  ds_read_b128 a[216:219], v0 offset:6144
  ds_read_b128 a[220:223], v1 offset:6144
  s_add_u32 s5, s44, 147456
  s_add_u32 m0, s46, 73728
  s_nop 0
  buffer_load_dwordx4 v58, s[12:15], s5 offen offset:0 lds
  s_add_u32 m0, s46, 81792
  s_nop 0
  buffer_load_dwordx4 v58, s[12:15], s5 offen offset:128 lds
  s_add_u32 m0, s46, 89856
  s_nop 0
  buffer_load_dwordx4 v58, s[12:15], s5 offen offset:256 lds
  s_waitcnt vmcnt(10)
  s_barrier
  ds_read_b64_tr_b16 a[0:1], v61 offset:0
  ds_read_b64_tr_b16 a[2:3], v61 offset:512
  ds_read_b64_tr_b16 a[12:13], v61 offset:4096
  ds_read_b64_tr_b16 a[14:15], v61 offset:4608
  s_waitcnt lgkmcnt(2)
  v_mfma_f32_16x16x32_bf16 v[116:119], a[0:3], v[184:187], 0
  s_add_u32 s5, s44, 184320
  s_add_u32 m0, s46, 77824
  ds_read_b64_tr_b16 a[4:5], v62 offset:0
  s_waitcnt lgkmcnt(1)
  v_mfma_f32_16x16x32_bf16 v[116:119], a[12:15], v[188:191], v[116:119]
  buffer_load_dwordx4 v58, s[12:15], s5 offen offset:0 lds
  v_mfma_f32_16x16x32_bf16 v[128:131], a[0:3], v[208:211], 0
  s_add_u32 m0, s46, 85888
  ds_read_b64_tr_b16 a[6:7], v62 offset:512
  ds_read_b64_tr_b16 a[16:17], v62 offset:4096
  v_mfma_f32_16x16x32_bf16 v[128:131], a[12:15], v[212:215], v[128:131]
  buffer_load_dwordx4 v58, s[12:15], s5 offen offset:128 lds
  v_mfma_f32_16x16x32_bf16 v[120:123], a[0:3], v[232:235], 0
  s_add_u32 m0, s46, 93952
  ds_read_b64_tr_b16 a[18:19], v62 offset:4608
  ds_read_b64_tr_b16 a[8:9], v63 offset:0
  v_mfma_f32_16x16x32_bf16 v[120:123], a[12:15], v[236:239], v[120:123]
  buffer_load_dwordx4 v58, s[12:15], s5 offen offset:256 lds
  v_mfma_f32_16x16x32_bf16 v[92:95], a[0:3], a[216:219], 0
  s_add_u32 s5, s44, 384
  s_add_u32 m0, s46, 98304
  ds_read_b64_tr_b16 a[10:11], v63 offset:512
  v_mfma_f32_16x16x32_bf16 v[92:95], a[12:15], a[220:223], v[92:95]
  s_waitcnt lgkmcnt(3)
  ds_read_b64_tr_b16 a[20:21], v63 offset:4096
  ds_read_b64_tr_b16 a[22:23], v63 offset:4608
  v_mfma_f32_16x16x32_bf16 v[136:139], a[4:7], v[184:187], 0
  buffer_load_dwordx4 v58, s[12:15], s5 offen offset:0 lds
  s_waitcnt lgkmcnt(4)
  v_mfma_f32_16x16x32_bf16 v[136:139], a[16:19], v[188:191], v[136:139]
  s_add_u32 m0, s46, 106368
  ds_read_b128 v[192:195], v0 offset:8192
  ds_read_b128 v[196:199], v1 offset:8192
  v_mfma_f32_16x16x32_bf16 v[132:135], a[4:7], v[208:211], 0
  buffer_load_dwordx4 v58, s[12:15], s5 offen offset:128 lds
  v_mfma_f32_16x16x32_bf16 v[132:135], a[16:19], v[212:215], v[132:135]
  s_add_u32 m0, s46, 114432
  ds_read_b128 v[216:219], v0 offset:10240
  ds_read_b128 v[220:223], v1 offset:10240
  v_mfma_f32_16x16x32_bf16 v[148:151], a[4:7], v[232:235], 0
  buffer_load_dwordx4 v58, s[12:15], s5 offen offset:256 lds
  v_mfma_f32_16x16x32_bf16 v[148:151], a[16:19], v[236:239], v[148:151]
  s_add_u32 s5, s44, 37248
  s_add_u32 m0, s46, 102400
  ds_read_b128 v[240:243], v0 offset:12288
  v_mfma_f32_16x16x32_bf16 v[108:111], a[4:7], a[216:219], 0
  s_waitcnt lgkmcnt(3)
  ds_read_b128 v[244:247], v1 offset:12288
  ds_read_b128 a[224:227], v0 offset:14336
  v_mfma_f32_16x16x32_bf16 v[108:111], a[16:19], a[220:223], v[108:111]
  s_waitcnt vmcnt(10)
  s_barrier
  v_mfma_f32_16x16x32_bf16 v[140:143], a[8:11], v[184:187], 0
  buffer_load_dwordx4 v58, s[12:15], s5 offen offset:0 lds
  v_mfma_f32_16x16x32_bf16 v[140:143], a[20:23], v[188:191], v[140:143]
  s_add_u32 m0, s46, 110464
  ds_read_b64_tr_b16 a[24:25], v61 offset:24576
  ds_read_b64_tr_b16 a[26:27], v61 offset:25088
  v_mfma_f32_16x16x32_bf16 v[124:127], a[8:11], v[208:211], 0
  buffer_load_dwordx4 v58, s[12:15], s5 offen offset:128 lds
  v_mfma_f32_16x16x32_bf16 v[124:127], a[20:23], v[212:215], v[124:127]
  s_add_u32 m0, s46, 118528
  ds_read_b64_tr_b16 a[36:37], v61 offset:28672
  ds_read_b64_tr_b16 a[38:39], v61 offset:29184
  v_mfma_f32_16x16x32_bf16 v[100:103], a[8:11], v[232:235], 0
  buffer_load_dwordx4 v58, s[12:15], s5 offen offset:256 lds
  v_mfma_f32_16x16x32_bf16 v[100:103], a[20:23], v[236:239], v[100:103]
  ds_read_b128 a[228:231], v1 offset:14336
  ds_read_b64_tr_b16 a[28:29], v62 offset:24576
  v_mfma_f32_16x16x32_bf16 v[112:115], a[8:11], a[216:219], 0
  ds_read_b64_tr_b16 a[30:31], v62 offset:25088
  ds_read_b64_tr_b16 a[40:41], v62 offset:28672
  v_mfma_f32_16x16x32_bf16 v[112:115], a[20:23], a[220:223], v[112:115]
  s_waitcnt lgkmcnt(6)
  ds_read_b64_tr_b16 a[42:43], v62 offset:29184
  ds_read_b64_tr_b16 a[32:33], v63 offset:24576
  v_mfma_f32_16x16x32_bf16 v[116:119], a[24:27], v[192:195], v[116:119]
  s_waitcnt lgkmcnt(6)
  ds_read_b64_tr_b16 a[34:35], v63 offset:25088
  ds_read_b64_tr_b16 a[44:45], v63 offset:28672
  v_mfma_f32_16x16x32_bf16 v[116:119], a[36:39], v[196:199], v[116:119]
  ds_read_b64_tr_b16 a[46:47], v63 offset:29184
  ds_read_b128 v[200:203], v0 offset:16384
  v_mfma_f32_16x16x32_bf16 v[128:131], a[24:27], v[216:219], v[128:131]
  ds_read_b128 v[204:207], v1 offset:16384
  ds_read_b128 v[224:227], v0 offset:18432
  v_mfma_f32_16x16x32_bf16 v[128:131], a[36:39], v[220:223], v[128:131]
  ds_read_b128 v[228:231], v1 offset:18432
  ds_read_b128 v[248:251], v0 offset:20480
  v_mfma_f32_16x16x32_bf16 v[120:123], a[24:27], v[240:243], v[120:123]
  ds_read_b128 v[252:255], v1 offset:20480
  ds_read_b128 a[232:235], v0 offset:22528
  v_mfma_f32_16x16x32_bf16 v[120:123], a[36:39], v[244:247], v[120:123]
  s_add_u32 s5, s44, 74112
  s_add_u32 m0, s46, 122880
  ds_read_b128 a[236:239], v1 offset:22528
  v_mfma_f32_16x16x32_bf16 v[92:95], a[24:27], a[224:227], v[92:95]
  s_waitcnt lgkmcnt(7)
  v_mfma_f32_16x16x32_bf16 v[92:95], a[36:39], a[228:231], v[92:95]
  v_mfma_f32_16x16x32_bf16 v[136:139], a[28:31], v[192:195], v[136:139]
  buffer_load_dwordx4 v58, s[12:15], s5 offen offset:0 lds
  v_mfma_f32_16x16x32_bf16 v[136:139], a[40:43], v[196:199], v[136:139]
  s_add_u32 m0, s46, 130944
  v_mfma_f32_16x16x32_bf16 v[132:135], a[28:31], v[216:219], v[132:135]
  buffer_load_dwordx4 v58, s[12:15], s5 offen offset:128 lds
  v_mfma_f32_16x16x32_bf16 v[132:135], a[40:43], v[220:223], v[132:135]
  s_add_u32 m0, s46, 139008
  v_mfma_f32_16x16x32_bf16 v[148:151], a[28:31], v[240:243], v[148:151]
  buffer_load_dwordx4 v58, s[12:15], s5 offen offset:256 lds
  v_mfma_f32_16x16x32_bf16 v[148:151], a[40:43], v[244:247], v[148:151]
  s_add_u32 s5, s44, 110976
  s_add_u32 m0, s46, 126976
  v_mfma_f32_16x16x32_bf16 v[108:111], a[28:31], a[224:227], v[108:111]
  v_mfma_f32_16x16x32_bf16 v[108:111], a[40:43], a[228:231], v[108:111]
  s_waitcnt vmcnt(9)
  s_barrier
  v_mfma_f32_16x16x32_bf16 v[140:143], a[32:35], v[192:195], v[140:143]
  buffer_load_dwordx4 v58, s[12:15], s5 offen offset:0 lds
  v_mfma_f32_16x16x32_bf16 v[140:143], a[44:47], v[196:199], v[140:143]
  s_add_u32 m0, s46, 135040
  ds_read_b64_tr_b16 a[48:49], v61 offset:49152
  ds_read_b64_tr_b16 a[50:51], v61 offset:49664
  v_mfma_f32_16x16x32_bf16 v[124:127], a[32:35], v[216:219], v[124:127]
  buffer_load_dwordx4 v58, s[12:15], s5 offen offset:128 lds
  v_mfma_f32_16x16x32_bf16 v[124:127], a[44:47], v[220:223], v[124:127]
  s_add_u32 m0, s46, 143104
  ds_read_b64_tr_b16 a[60:61], v61 offset:53248
  ds_read_b64_tr_b16 a[62:63], v61 offset:53760
  v_mfma_f32_16x16x32_bf16 v[100:103], a[32:35], v[240:243], v[100:103]
  buffer_load_dwordx4 v58, s[12:15], s5 offen offset:256 lds
  v_mfma_f32_16x16x32_bf16 v[100:103], a[44:47], v[244:247], v[100:103]
  ds_read_b64_tr_b16 a[52:53], v62 offset:49152
  ds_read_b64_tr_b16 a[54:55], v62 offset:49664
  v_mfma_f32_16x16x32_bf16 v[112:115], a[32:35], a[224:227], v[112:115]
  ds_read_b64_tr_b16 a[64:65], v62 offset:53248
  ds_read_b64_tr_b16 a[66:67], v62 offset:53760
  v_mfma_f32_16x16x32_bf16 v[112:115], a[44:47], a[228:231], v[112:115]
  s_waitcnt lgkmcnt(6)
  ds_read_b64_tr_b16 a[56:57], v63 offset:49152
  ds_read_b64_tr_b16 a[58:59], v63 offset:49664
  v_mfma_f32_16x16x32_bf16 v[116:119], a[48:51], v[200:203], v[116:119]
  s_waitcnt lgkmcnt(6)
  ds_read_b64_tr_b16 a[68:69], v63 offset:53248
  ds_read_b64_tr_b16 a[70:71], v63 offset:53760
  v_mfma_f32_16x16x32_bf16 v[116:119], a[60:63], v[204:207], v[116:119]
  v_mfma_f32_16x16x32_bf16 v[128:131], a[48:51], v[224:227], v[128:131]
  v_mfma_f32_16x16x32_bf16 v[128:131], a[60:63], v[228:231], v[128:131]
  v_mfma_f32_16x16x32_bf16 v[120:123], a[48:51], v[248:251], v[120:123]
  v_mul_f32 v116, s42, v116
  v_mul_f32 v117, s42, v117
  v_mfma_f32_16x16x32_bf16 v[120:123], a[60:63], v[252:255], v[120:123]
  s_add_u32 s5, s44, 147840
  s_add_u32 m0, s46, 24576
  v_mul_f32 v118, s42, v118
  v_mfma_f32_16x16x32_bf16 v[92:95], a[48:51], a[232:235], v[92:95]
  v_mul_f32 v119, s42, v119
  v_cvt_pk_bf16_f32 v12, v116, v117
  v_mfma_f32_16x16x32_bf16 v[92:95], a[60:63], a[236:239], v[92:95]
  s_waitcnt lgkmcnt(0)
  v_cvt_pk_bf16_f32 v13, v118, v119
  v_mul_f32 v128, s42, v128
  v_mfma_f32_16x16x32_bf16 v[136:139], a[52:55], v[200:203], v[136:139]
  buffer_load_dwordx4 v58, s[12:15], s5 offen offset:0 lds
  v_mfma_f32_16x16x32_bf16 v[136:139], a[64:67], v[204:207], v[136:139]
  s_add_u32 m0, s46, 32640
  v_mul_f32 v129, s42, v129
  v_mul_f32 v130, s42, v130
  v_mfma_f32_16x16x32_bf16 v[132:135], a[52:55], v[224:227], v[132:135]
  buffer_load_dwordx4 v58, s[12:15], s5 offen offset:128 lds
  v_mfma_f32_16x16x32_bf16 v[132:135], a[64:67], v[228:231], v[132:135]
  s_add_u32 m0, s46, 40704
  v_mul_f32 v131, s42, v131
  v_cvt_pk_bf16_f32 v180, v128, v129
  v_mfma_f32_16x16x32_bf16 v[148:151], a[52:55], v[248:251], v[148:151]
  buffer_load_dwordx4 v58, s[12:15], s5 offen offset:256 lds
  v_mfma_f32_16x16x32_bf16 v[148:151], a[64:67], v[252:255], v[148:151]
  s_add_u32 s5, s44, 184704
  s_add_u32 m0, s46, 28672
  v_mul_f32 v136, s42, v136
  v_mfma_f32_16x16x32_bf16 v[108:111], a[52:55], a[232:235], v[108:111]
  v_mul_f32 v137, s42, v137
  v_mul_f32 v138, s42, v138
  v_mfma_f32_16x16x32_bf16 v[108:111], a[64:67], a[236:239], v[108:111]
  s_waitcnt vmcnt(9)
  s_barrier
  v_mfma_f32_16x16x32_bf16 v[140:143], a[56:59], v[200:203], v[140:143]
  buffer_load_dwordx4 v58, s[12:15], s5 offen offset:0 lds
  v_mfma_f32_16x16x32_bf16 v[140:143], a[68:71], v[204:207], v[140:143]
  s_add_u32 m0, s46, 36736
  ds_read_b64_tr_b16 a[72:73], v57 offset:0
  ds_read_b64_tr_b16 a[74:75], v57 offset:512
  v_mfma_f32_16x16x32_bf16 v[124:127], a[56:59], v[224:227], v[124:127]
  buffer_load_dwordx4 v58, s[12:15], s5 offen offset:128 lds
  v_mfma_f32_16x16x32_bf16 v[124:127], a[68:71], v[228:231], v[124:127]
  s_add_u32 m0, s46, 44800
  ds_read_b64_tr_b16 a[84:85], v57 offset:4096
  ds_read_b64_tr_b16 a[86:87], v57 offset:4608
  v_mfma_f32_16x16x32_bf16 v[100:103], a[56:59], v[248:251], v[100:103]
  buffer_load_dwordx4 v58, s[12:15], s5 offen offset:256 lds
  v_mfma_f32_16x16x32_bf16 v[100:103], a[68:71], v[252:255], v[100:103]
  ds_read_b64_tr_b16 a[76:77], v60 offset:0
  ds_read_b64_tr_b16 a[78:79], v60 offset:512
  v_mfma_f32_16x16x32_bf16 v[112:115], a[56:59], a[232:235], v[112:115]
  ds_read_b64_tr_b16 a[88:89], v60 offset:4096
  ds_read_b64_tr_b16 a[90:91], v60 offset:4608
  v_mfma_f32_16x16x32_bf16 v[112:115], a[68:71], a[236:239], v[112:115]
  s_waitcnt lgkmcnt(6)
  ds_read_b64_tr_b16 a[80:81], v59 offset:0
  ds_read_b64_tr_b16 a[82:83], v59 offset:512
  v_mfma_f32_16x16x32_bf16 v[116:119], a[72:75], v[184:187], 0
  s_waitcnt lgkmcnt(6)
  ds_read_b64_tr_b16 a[92:93], v59 offset:4096
  ds_read_b64_tr_b16 a[94:95], v59 offset:4608
  v_mfma_f32_16x16x32_bf16 v[116:119], a[84:87], v[188:191], v[116:119]
  v_mul_f32 v139, s42, v139
  v_cvt_pk_bf16_f32 v144, v136, v137
  v_mfma_f32_16x16x32_bf16 v[156:159], a[72:75], v[208:211], 0
  v_cvt_pk_bf16_f32 v145, v138, v139
  v_mul_f32 v140, s42, v140
  v_mfma_f32_16x16x32_bf16 v[156:159], a[84:87], v[212:215], v[156:159]
  v_mul_f32 v141, s42, v141
  v_mul_f32 v142, s42, v142
  v_mfma_f32_16x16x32_bf16 v[166:169], a[72:75], v[232:235], 0
  v_mul_f32 v143, s42, v143
  v_cvt_pk_bf16_f32 v146, v140, v141
  v_mfma_f32_16x16x32_bf16 v[166:169], a[84:87], v[236:239], v[166:169]
  s_add_u32 s5, s44, 768
  s_add_u32 m0, s46, 49152
  v_cvt_pk_bf16_f32 v147, v142, v143
  v_mfma_f32_16x16x32_bf16 v[172:175], a[72:75], a[216:219], 0
  v_cvt_pk_bf16_f32 v181, v130, v131
  v_mul_f32 v132, s42, v132
  v_mfma_f32_16x16x32_bf16 v[172:175], a[84:87], a[220:223], v[172:175]
  s_waitcnt lgkmcnt(0)
  v_mul_f32 v133, s42, v133
  v_mul_f32 v134, s42, v134
  v_mfma_f32_16x16x32_bf16 v[136:139], a[76:79], v[184:187], 0
  buffer_load_dwordx4 v58, s[12:15], s5 offen offset:0 lds
  v_mfma_f32_16x16x32_bf16 v[136:139], a[88:91], v[188:191], v[136:139]
  s_add_u32 m0, s46, 57216
  v_mul_f32 v135, s42, v135
  v_cvt_pk_bf16_f32 v182, v132, v133
  v_mfma_f32_16x16x32_bf16 v[140:143], a[76:79], v[208:211], 0
  buffer_load_dwordx4 v58, s[12:15], s5 offen offset:128 lds
  v_mfma_f32_16x16x32_bf16 v[140:143], a[88:91], v[212:215], v[140:143]
  s_add_u32 m0, s46, 65280
  v_cvt_pk_bf16_f32 v183, v134, v135
  v_mul_f32 v124, s42, v124
  v_mfma_f32_16x16x32_bf16 v[160:163], a[76:79], v[232:235], 0
  buffer_load_dwordx4 v58, s[12:15], s5 offen offset:256 lds
  v_mfma_f32_16x16x32_bf16 v[160:163], a[88:91], v[236:239], v[160:163]
  s_add_u32 s5, s44, 37632
  s_add_u32 m0, s46, 53248
  v_mul_f32 v125, s42, v125
  v_mfma_f32_16x16x32_bf16 v[96:99], a[76:79], a[216:219], 0
  v_mul_f32 v126, s42, v126
  v_mul_f32 v127, s42, v127
  v_mfma_f32_16x16x32_bf16 v[96:99], a[88:91], a[220:223], v[96:99]
  s_waitcnt vmcnt(9)
  s_barrier
  v_mfma_f32_16x16x32_bf16 v[152:155], a[80:83], v[184:187], 0
  buffer_load_dwordx4 v58, s[12:15], s5 offen offset:0 lds
  v_mfma_f32_16x16x32_bf16 v[152:155], a[92:95], v[188:191], v[152:155]
  s_add_u32 m0, s46, 61312
  ds_read_b64_tr_b16 a[96:97], v57 offset:24576
  ds_read_b64_tr_b16 a[98:99], v57 offset:25088
  v_mfma_f32_16x16x32_bf16 v[176:179], a[80:83], v[208:211], 0
  buffer_load_dwordx4 v58, s[12:15], s5 offen offset:128 lds
  v_mfma_f32_16x16x32_bf16 v[176:179], a[92:95], v[212:215], v[176:179]
  s_add_u32 m0, s46, 69376
  ds_read_b64_tr_b16 a[108:109], v57 offset:28672
  ds_read_b64_tr_b16 a[110:111], v57 offset:29184
  v_mfma_f32_16x16x32_bf16 v[128:131], a[80:83], v[232:235], 0
  buffer_load_dwordx4 v58, s[12:15], s5 offen offset:256 lds
  v_mfma_f32_16x16x32_bf16 v[128:131], a[92:95], v[236:239], v[128:131]
  ds_read_b64_tr_b16 a[100:101], v60 offset:24576
  ds_read_b64_tr_b16 a[102:103], v60 offset:25088
  v_mfma_f32_16x16x32_bf16 v[104:107], a[80:83], a[216:219], 0
  ds_read_b64_tr_b16 a[112:113], v60 offset:28672
  ds_read_b64_tr_b16 a[114:115], v60 offset:29184
  v_mfma_f32_16x16x32_bf16 v[104:107], a[92:95], a[220:223], v[104:107]
  s_waitcnt lgkmcnt(6)
  ds_read_b64_tr_b16 a[104:105], v59 offset:24576
  ds_read_b64_tr_b16 a[106:107], v59 offset:25088
  v_mfma_f32_16x16x32_bf16 v[116:119], a[96:99], v[192:195], v[116:119]
  s_waitcnt lgkmcnt(6)
  ds_read_b64_tr_b16 a[116:117], v59 offset:28672
  ds_read_b64_tr_b16 a[118:119], v59 offset:29184
  v_mfma_f32_16x16x32_bf16 v[116:119], a[108:111], v[196:199], v[116:119]
  v_cvt_pk_bf16_f32 v16, v124, v125
  v_cvt_pk_bf16_f32 v17, v126, v127
  v_mfma_f32_16x16x32_bf16 v[156:159], a[96:99], v[216:219], v[156:159]
  v_mul_f32 v120, s42, v120
  v_mul_f32 v121, s42, v121
  v_mfma_f32_16x16x32_bf16 v[156:159], a[108:111], v[220:223], v[156:159]
  v_mul_f32 v122, s42, v122
  v_mul_f32 v123, s42, v123
  v_mfma_f32_16x16x32_bf16 v[166:169], a[96:99], v[240:243], v[166:169]
  v_cvt_pk_bf16_f32 v18, v120, v121
  v_cvt_pk_bf16_f32 v19, v122, v123
  v_mfma_f32_16x16x32_bf16 v[166:169], a[108:111], v[244:247], v[166:169]
  s_add_u32 s5, s44, 74496
  s_add_u32 m0, s46, 73728
  v_mul_f32 v148, s42, v148
  v_mfma_f32_16x16x32_bf16 v[172:175], a[96:99], a[224:227], v[172:175]
  v_mul_f32 v149, s42, v149
  v_mul_f32 v150, s42, v150
  v_mfma_f32_16x16x32_bf16 v[172:175], a[108:111], a[228:231], v[172:175]
  s_waitcnt lgkmcnt(0)
  v_mul_f32 v151, s42, v151
  v_cvt_pk_bf16_f32 v124, v148, v149
  v_mfma_f32_16x16x32_bf16 v[136:139], a[100:103], v[192:195], v[136:139]
  buffer_load_dwordx4 v58, s[12:15], s5 offen offset:0 lds
  v_mfma_f32_16x16x32_bf16 v[136:139], a[112:115], v[196:199], v[136:139]
  s_add_u32 m0, s46, 81792
  v_cvt_pk_bf16_f32 v125, v150, v151
  v_mul_f32 v100, s42, v100
  v_mfma_f32_16x16x32_bf16 v[140:143], a[100:103], v[216:219], v[140:143]
  buffer_load_dwordx4 v58, s[12:15], s5 offen offset:128 lds
  v_mfma_f32_16x16x32_bf16 v[140:143], a[112:115], v[220:223], v[140:143]
  s_add_u32 m0, s46, 89856
  v_mul_f32 v101, s42, v101
  v_mul_f32 v102, s42, v102
  v_mfma_f32_16x16x32_bf16 v[160:163], a[100:103], v[240:243], v[160:163]
  buffer_load_dwordx4 v58, s[12:15], s5 offen offset:256 lds
  v_mfma_f32_16x16x32_bf16 v[160:163], a[112:115], v[244:247], v[160:163]
  s_add_u32 s5, s44, 111360
  s_add_u32 m0, s46, 77824
  v_mul_f32 v103, s42, v103
  v_mfma_f32_16x16x32_bf16 v[96:99], a[100:103], a[224:227], v[96:99]
  v_add_f32 v120, v70, v36
  v_add_f32 v121, v70, v37
  v_mfma_f32_16x16x32_bf16 v[96:99], a[112:115], a[228:231], v[96:99]
  s_waitcnt vmcnt(9)
  s_barrier
  v_mfma_f32_16x16x32_bf16 v[152:155], a[104:107], v[192:195], v[152:155]
  buffer_load_dwordx4 v58, s[12:15], s5 offen offset:0 lds
  v_mfma_f32_16x16x32_bf16 v[152:155], a[116:119], v[196:199], v[152:155]
  s_add_u32 m0, s46, 85888
  ds_read_b64_tr_b16 a[120:121], v61 offset:0
  ds_read_b64_tr_b16 a[122:123], v61 offset:512
  v_mfma_f32_16x16x32_bf16 v[176:179], a[104:107], v[216:219], v[176:179]
  buffer_load_dwordx4 v58, s[12:15], s5 offen offset:128 lds
  v_mfma_f32_16x16x32_bf16 v[176:179], a[116:119], v[220:223], v[176:179]
  s_add_u32 m0, s46, 93952
  ds_read_b64_tr_b16 a[132:133], v61 offset:4096
  ds_read_b64_tr_b16 a[134:135], v61 offset:4608
  v_mfma_f32_16x16x32_bf16 v[128:131], a[104:107], v[240:243], v[128:131]
  buffer_load_dwordx4 v58, s[12:15], s5 offen offset:256 lds
  v_mfma_f32_16x16x32_bf16 v[128:131], a[116:119], v[244:247], v[128:131]
  ds_read_b64_tr_b16 a[124:125], v62 offset:0
  ds_read_b64_tr_b16 a[126:127], v62 offset:512
  v_mfma_f32_16x16x32_bf16 v[104:107], a[104:107], a[224:227], v[104:107]
  ds_read_b64_tr_b16 a[136:137], v62 offset:4096
  ds_read_b64_tr_b16 a[138:139], v62 offset:4608
  v_mfma_f32_16x16x32_bf16 v[104:107], a[116:119], a[228:231], v[104:107]
  s_waitcnt lgkmcnt(6)
  ds_read_b64_tr_b16 a[128:129], v63 offset:0
  ds_read_b64_tr_b16 a[130:131], v63 offset:512
  v_mfma_f32_16x16x32_bf16 v[116:119], a[120:123], v[200:203], v[116:119]
  s_waitcnt lgkmcnt(6)
  ds_read_b64_tr_b16 a[140:141], v63 offset:4096
  ds_read_b64_tr_b16 a[142:143], v63 offset:4608
  v_mfma_f32_16x16x32_bf16 v[116:119], a[132:135], v[204:207], v[116:119]
  v_add_f32 v122, v70, v38
  v_add_f32 v123, v70, v39
  v_mfma_f32_16x16x32_bf16 v[156:159], a[120:123], v[224:227], v[156:159]
  v_add_f32 v148, v70, v32
  v_add_f32 v149, v70, v33
  v_mfma_f32_16x16x32_bf16 v[156:159], a[132:135], v[228:231], v[156:159]
  v_add_f32 v150, v70, v34
  v_add_f32 v151, v70, v35
  v_mfma_f32_16x16x32_bf16 v[166:169], a[120:123], v[248:251], v[166:169]
  v_cvt_pk_bf16_f32 v132, v116, v117
  v_cvt_pk_bf16_f32 v133, v118, v119
  v_mfma_f32_16x16x32_bf16 v[166:169], a[132:135], v[252:255], v[166:169]
  s_add_u32 s5, s44, 148224
  s_add_u32 m0, s46, 98304
  v_add_f32 v116, v70, v40
  v_mfma_f32_16x16x32_bf16 v[172:175], a[120:123], a[232:235], v[172:175]
  v_cvt_pk_bf16_f32 v170, v156, v157
  v_cvt_pk_bf16_f32 v171, v158, v159
  v_mfma_f32_16x16x32_bf16 v[172:175], a[132:135], a[236:239], v[172:175]
  s_waitcnt lgkmcnt(0)
  v_add_f32 v117, v70, v41
  v_add_f32 v118, v70, v42
  v_mfma_f32_16x16x32_bf16 v[136:139], a[124:127], v[200:203], v[136:139]
  buffer_load_dwordx4 v58, s[12:15], s5 offen offset:0 lds
  v_mfma_f32_16x16x32_bf16 v[136:139], a[136:139], v[204:207], v[136:139]
  s_add_u32 m0, s46, 106368
  v_cvt_pk_bf16_f32 v164, v166, v167
  v_cvt_pk_bf16_f32 v165, v168, v169
  v_mfma_f32_16x16x32_bf16 v[140:143], a[124:127], v[224:227], v[140:143]
  buffer_load_dwordx4 v58, s[12:15], s5 offen offset:128 lds
  v_mfma_f32_16x16x32_bf16 v[140:143], a[136:139], v[228:231], v[140:143]
  s_add_u32 m0, s46, 114432
  v_cvt_pk_bf16_f32 v158, v172, v173
  v_cvt_pk_bf16_f32 v159, v174, v175
  v_mfma_f32_16x16x32_bf16 v[160:163], a[124:127], v[248:251], v[160:163]
  buffer_load_dwordx4 v58, s[12:15], s5 offen offset:256 lds
  v_mfma_f32_16x16x32_bf16 v[160:163], a[136:139], v[252:255], v[160:163]
  s_add_u32 s5, s44, 185088
  s_add_u32 m0, s46, 102400
  v_cvt_pk_bf16_f32 v134, v136, v137
  v_mfma_f32_16x16x32_bf16 v[96:99], a[124:127], a[232:235], v[96:99]
  v_cvt_pk_bf16_f32 v135, v138, v139
  v_cvt_pk_bf16_f32 v172, v140, v141
  v_mfma_f32_16x16x32_bf16 v[96:99], a[136:139], a[236:239], v[96:99]
  v_cvt_pk_bf16_f32 v173, v142, v143
  v_add_f32 v119, v70, v43
  v_mfma_f32_16x16x32_bf16 v[152:155], a[128:131], v[200:203], v[152:155]
  buffer_load_dwordx4 v58, s[12:15], s5 offen offset:0 lds
  v_mfma_f32_16x16x32_bf16 v[152:155], a[140:143], v[204:207], v[152:155]
  s_add_u32 m0, s46, 110464
  v_cvt_pk_bf16_f32 v166, v160, v161
  v_cvt_pk_bf16_f32 v167, v162, v163
  v_mfma_f32_16x16x32_bf16 v[176:179], a[128:131], v[224:227], v[176:179]
  buffer_load_dwordx4 v58, s[12:15], s5 offen offset:128 lds
  v_mfma_f32_16x16x32_bf16 v[176:179], a[140:143], v[228:231], v[176:179]
  s_add_u32 m0, s46, 118528
  v_cvt_pk_bf16_f32 v160, v96, v97
  v_cvt_pk_bf16_f32 v161, v98, v99
  v_mfma_f32_16x16x32_bf16 v[128:131], a[128:131], v[248:251], v[128:131]
  buffer_load_dwordx4 v58, s[12:15], s5 offen offset:256 lds
  v_mfma_f32_16x16x32_bf16 v[128:131], a[140:143], v[252:255], v[128:131]
  v_cvt_pk_bf16_f32 v136, v152, v153
  v_cvt_pk_bf16_f32 v137, v154, v155
  v_mfma_f32_16x16x32_bf16 v[104:107], a[128:131], a[232:235], v[104:107]
  v_cvt_pk_bf16_f32 v174, v176, v177
  v_cvt_pk_bf16_f32 v175, v178, v179
  v_mfma_f32_16x16x32_bf16 v[104:107], a[140:143], a[236:239], v[104:107]
  v_cvt_pk_bf16_f32 v126, v100, v101
  v_cvt_pk_bf16_f32 v127, v102, v103
  v_mfma_f32_16x16x32_bf16 v[96:99], v[134:137], v[144:147], v[120:123]
  v_cvt_pk_bf16_f32 v168, v128, v129
  v_cvt_pk_bf16_f32 v169, v130, v131
  v_mfma_f32_16x16x32_bf16 v[96:99], v[132:135], v[12:15], v[96:99]
  v_mul_f32 v92, s42, v92
  v_mul_f32 v93, s42, v93
  v_mfma_f32_16x16x32_bf16 v[100:103], v[172:175], v[144:147], v[148:151]
  v_cvt_pk_bf16_f32 v162, v104, v105
  v_cvt_pk_bf16_f32 v163, v106, v107
  v_mfma_f32_16x16x32_bf16 v[100:103], v[170:173], v[12:15], v[100:103]
L_hop_0_0:
  s_cbranch_execz L_hop_0_1
  v_mul_f32 v94, s42, v94
  v_mul_f32 v95, s42, v95
  v_mfma_f32_16x16x32_bf16 v[176:179], v[166:169], v[144:147], v[80:83]
  v_cvt_pk_bf16_f32 v128, v92, v93
  v_cvt_pk_bf16_f32 v129, v94, v95
  v_mfma_f32_16x16x32_bf16 v[176:179], v[164:167], v[12:15], v[176:179]
  v_mul_f32 v108, s42, v108
  v_mul_f32 v109, s42, v109
  v_mfma_f32_16x16x32_bf16 v[152:155], v[160:163], v[144:147], v[88:91]
  v_mul_f32 v110, s42, v110
  v_mul_f32 v111, s42, v111
  v_mfma_f32_16x16x32_bf16 v[152:155], v[158:161], v[12:15], v[152:155]
  v_cvt_pk_bf16_f32 v130, v108, v109
  v_cvt_pk_bf16_f32 v131, v110, v111
  v_mfma_f32_16x16x32_bf16 v[104:107], v[132:135], v[180:183], v[116:119]
  v_mul_f32 v112, s42, v112
  v_mul_f32 v113, s42, v113
  v_mfma_f32_16x16x32_bf16 v[104:107], v[134:137], v[14:17], v[104:107]
  v_mul_f32 v114, s42, v114
  v_mul_f32 v115, s42, v115
  v_mfma_f32_16x16x32_bf16 v[108:111], v[170:173], v[180:183], v[120:123]
  v_cvt_pk_bf16_f32 v22, v112, v113
  v_cvt_pk_bf16_f32 v23, v114, v115
  v_mfma_f32_16x16x32_bf16 v[108:111], v[172:175], v[14:17], v[108:111]
  v_exp_f32 v96, v96
  v_mfma_f32_16x16x32_bf16 v[140:143], v[164:167], v[180:183], v[84:87]
  s_add_u32 m0, s28, 0
  v_exp_f32 v97, v97
  v_mfma_f32_16x16x32_bf16 v[140:143], v[166:169], v[14:17], v[140:143]
  v_exp_f32 v98, v98
  v_mfma_f32_16x16x32_bf16 v[144:147], v[158:161], v[180:183], v[80:83]
  s_waitcnt vmcnt(6)
  s_barrier
  v_mfma_f32_16x16x32_bf16 v[144:147], v[160:163], v[14:17], v[144:147]
  buffer_load_dwordx4 v6, s[8:11], s31 offen offset:0 nt lds
  v_mfma_f32_16x16x32_bf16 v[80:83], v[166:169], v[124:127], v[120:123]
  s_add_u32 m0, s28, 8064
  ds_read_b64_tr_b16 a[144:145], v61 offset:24576
  ds_read_b64_tr_b16 a[146:147], v61 offset:25088
  v_mfma_f32_16x16x32_bf16 v[80:83], v[164:167], v[18:21], v[80:83]
  ds_read_b64_tr_b16 a[156:157], v61 offset:28672
  ds_read_b64_tr_b16 a[158:159], v61 offset:29184
  v_mfma_f32_16x16x32_bf16 v[84:87], v[160:163], v[124:127], v[148:151]
  buffer_load_dwordx4 v6, s[8:11], s31 offen offset:128 nt lds
  v_mfma_f32_16x16x32_bf16 v[84:87], v[158:161], v[18:21], v[84:87]
  s_add_u32 m0, s28, 16128
  ds_read_b64_tr_b16 a[148:149], v62 offset:24576
  ds_read_b64_tr_b16 a[150:151], v62 offset:25088
  v_mfma_f32_16x16x32_bf16 v[112:115], v[134:137], v[124:127], v[64:67]
  ds_read_b64_tr_b16 a[160:161], v62 offset:28672
  ds_read_b64_tr_b16 a[162:163], v62 offset:29184
  v_mfma_f32_16x16x32_bf16 v[112:115], v[132:135], v[18:21], v[112:115]
  buffer_load_dwordx4 v6, s[8:11], s31 offen offset:256 nt lds
  v_mfma_f32_16x16x32_bf16 v[180:183], v[172:175], v[124:127], v[76:79]
  s_add_u32 s31, s31, s43
  ds_read_b64_tr_b16 a[152:153], v63 offset:24576
  ds_read_b64_tr_b16 a[154:155], v63 offset:25088
  v_mfma_f32_16x16x32_bf16 v[180:183], v[170:173], v[18:21], v[180:183]
  ds_read_b64_tr_b16 a[164:165], v63 offset:28672
  ds_read_b64_tr_b16 a[166:167], v63 offset:29184
  v_mfma_f32_16x16x32_bf16 v[88:91], v[164:167], v[128:131], v[116:119]
  ds_read_b64_tr_b16 a[168:169], v61 offset:49152
  ds_read_b64_tr_b16 a[170:171], v61 offset:49664
  v_mfma_f32_16x16x32_bf16 v[88:91], v[166:169], v[20:23], v[88:91]
  ds_read_b64_tr_b16 a[180:181], v61 offset:53248
  ds_read_b64_tr_b16 a[182:183], v61 offset:53760
  v_mfma_f32_16x16x32_bf16 v[92:95], v[158:161], v[128:131], v[120:123]
  ds_read_b64_tr_b16 a[172:173], v62 offset:49152
  ds_read_b64_tr_b16 a[174:175], v62 offset:49664
  v_mfma_f32_16x16x32_bf16 v[92:95], v[160:163], v[20:23], v[92:95]
  ds_read_b64_tr_b16 a[184:185], v62 offset:53248
  ds_read_b64_tr_b16 a[186:187], v62 offset:53760
  v_mfma_f32_16x16x32_bf16 v[148:151], v[132:135], v[128:131], v[72:75]
  ds_read_b64_tr_b16 a[176:177], v63 offset:49152
  ds_read_b64_tr_b16 a[178:179], v63 offset:49664
  v_mfma_f32_16x16x32_bf16 v[148:151], v[134:137], v[20:23], v[148:151]
  ds_read_b64_tr_b16 a[188:189], v63 offset:53248
  ds_read_b64_tr_b16 a[190:191], v63 offset:53760
  v_mfma_f32_16x16x32_bf16 v[164:167], v[170:173], v[128:131], v[64:67]
  v_exp_f32 v99, v99
  v_mfma_f32_16x16x32_bf16 v[164:167], v[172:175], v[20:23], v[164:167]
  s_waitcnt lgkmcnt(6)
  v_exp_f32 v100, v100
  v_mfma_f32_16x16x32_bf16 v[72:75], v[184:187], a[144:147], 0
  v_exp_f32 v101, v101
  v_mfma_f32_16x16x32_bf16 v[72:75], v[188:191], a[156:159], v[72:75]
  v_exp_f32 v102, v102
  v_mfma_f32_16x16x32_bf16 v[120:123], v[184:187], a[148:151], 0
  v_exp_f32 v103, v103
  v_mfma_f32_16x16x32_bf16 v[120:123], v[188:191], a[160:163], v[120:123]
  v_exp_f32 v176, v176
  v_mfma_f32_16x16x32_bf16 v[128:131], v[184:187], a[152:155], 0
  v_exp_f32 v177, v177
  v_mfma_f32_16x16x32_bf16 v[128:131], v[188:191], a[164:167], v[128:131]
  v_exp_f32 v178, v178
  v_mfma_f32_16x16x32_bf16 v[132:135], v[208:211], a[144:147], 0
  v_exp_f32 v179, v179
  v_mfma_f32_16x16x32_bf16 v[132:135], v[212:215], a[156:159], v[132:135]
  v_exp_f32 v152, v152
  v_mfma_f32_16x16x32_bf16 v[124:127], v[208:211], a[148:151], 0
  v_exp_f32 v153, v153
  v_mfma_f32_16x16x32_bf16 v[124:127], v[212:215], a[160:163], v[124:127]
  v_exp_f32 v154, v154
  v_mfma_f32_16x16x32_bf16 v[64:67], v[208:211], a[152:155], 0
  v_exp_f32 v155, v155
  v_mfma_f32_16x16x32_bf16 v[64:67], v[212:215], a[164:167], v[64:67]
  v_cvt_pk_bf16_f32 v96, v96, v97
  v_cvt_pk_bf16_f32 v97, v98, v99
  v_mfma_f32_16x16x32_bf16 v[72:75], v[192:195], a[168:171], v[72:75]
  v_cvt_pk_bf16_f32 v98, v100, v101
  v_cvt_pk_bf16_f32 v99, v102, v103
  v_mfma_f32_16x16x32_bf16 v[72:75], v[196:199], a[180:183], v[72:75]
  v_cvt_pk_bf16_f32 v100, v176, v177
  v_cvt_pk_bf16_f32 v101, v178, v179
  v_mfma_f32_16x16x32_bf16 v[120:123], v[192:195], a[172:175], v[120:123]
  s_waitcnt lgkmcnt(0)
  v_cvt_pk_bf16_f32 v102, v152, v153
  v_cvt_pk_bf16_f32 v103, v154, v155
  v_mfma_f32_16x16x32_bf16 v[120:123], v[196:199], a[184:187], v[120:123]
  s_waitcnt vmcnt(3)
  s_barrier
  v_mfma_f32_16x16x32_bf16 v[128:131], v[192:195], a[176:179], v[128:131]
  ds_read_b64_tr_b16 a[192:193], v57 offset:0
  ds_read_b64_tr_b16 a[194:195], v57 offset:512
  v_mfma_f32_16x16x32_bf16 v[128:131], v[196:199], a[188:191], v[128:131]
  ds_read_b64_tr_b16 a[204:205], v57 offset:4096
  ds_read_b64_tr_b16 a[206:207], v57 offset:4608
  v_mfma_f32_16x16x32_bf16 v[132:135], v[216:219], a[168:171], v[132:135]
  ds_read_b64_tr_b16 a[196:197], v60 offset:0
  ds_read_b64_tr_b16 a[198:199], v60 offset:512
  v_mfma_f32_16x16x32_bf16 v[132:135], v[220:223], a[180:183], v[132:135]
  ds_read_b64_tr_b16 a[208:209], v60 offset:4096
  ds_read_b64_tr_b16 a[210:211], v60 offset:4608
  v_mfma_f32_16x16x32_bf16 v[124:127], v[216:219], a[172:175], v[124:127]
  s_add_u32 s5, s45, 0
  s_add_u32 m0, s46, 122880
  ds_read_b64_tr_b16 a[200:201], v59 offset:0
  v_mfma_f32_16x16x32_bf16 v[124:127], v[220:223], a[184:187], v[124:127]
  ds_read_b64_tr_b16 a[202:203], v59 offset:512
  ds_read_b64_tr_b16 a[212:213], v59 offset:4096
  v_mfma_f32_16x16x32_bf16 v[64:67], v[216:219], a[176:179], v[64:67]
  s_waitcnt lgkmcnt(5)
  ds_read_b64_tr_b16 a[214:215], v59 offset:4608
  v_add_u32 v0, s28, v2
  v_mfma_f32_16x16x32_bf16 v[64:67], v[220:223], a[188:191], v[64:67]
  buffer_load_dwordx4 v71, s[16:19], s5 offen offset:0 lds
  v_mfma_f32_16x16x32_bf16 v[72:75], v[200:203], a[192:195], v[72:75]
  s_add_u32 m0, s46, 130944
  v_exp_f32 v104, v104
  v_mfma_f32_16x16x32_bf16 v[72:75], v[204:207], a[204:207], v[72:75]
  s_waitcnt lgkmcnt(1)
  v_exp_f32 v105, v105
  v_mfma_f32_16x16x32_bf16 v[120:123], v[200:203], a[196:199], v[120:123]
  buffer_load_dwordx4 v71, s[16:19], s5 offen offset:128 lds
  v_mfma_f32_16x16x32_bf16 v[120:123], v[204:207], a[208:211], v[120:123]
  s_add_u32 m0, s46, 139008
  v_exp_f32 v106, v106
  v_mfma_f32_16x16x32_bf16 v[128:131], v[200:203], a[200:203], v[128:131]
  s_waitcnt lgkmcnt(0)
  v_cvt_pk_bf16_f32 v56, v72, v73
  v_cvt_pk_bf16_f32 v57, v74, v75
  v_mfma_f32_16x16x32_bf16 v[128:131], v[204:207], a[212:215], v[128:131]
  buffer_load_dwordx4 v71, s[16:19], s5 offen offset:256 lds
  v_mfma_f32_16x16x32_bf16 v[132:135], v[224:227], a[192:195], v[132:135]
  s_add_u32 s5, s45, 12288
  v_cvt_pk_bf16_f32 v116, v120, v121
  v_cvt_pk_bf16_f32 v117, v122, v123
  v_mfma_f32_16x16x32_bf16 v[132:135], v[228:231], a[204:207], v[132:135]
  s_add_u32 m0, s46, 126976
  v_exp_f32 v107, v107
  v_mfma_f32_16x16x32_bf16 v[124:127], v[224:227], a[196:199], v[124:127]
  buffer_load_dwordx4 v71, s[16:19], s5 offen offset:0 lds
  v_mfma_f32_16x16x32_bf16 v[124:127], v[228:231], a[208:211], v[124:127]
  s_add_u32 m0, s46, 135040
  v_cvt_pk_bf16_f32 v72, v128, v129
  v_cvt_pk_bf16_f32 v73, v130, v131
  v_mfma_f32_16x16x32_bf16 v[64:67], v[224:227], a[200:203], v[64:67]
  v_cvt_pk_bf16_f32 v58, v132, v133
  v_cvt_pk_bf16_f32 v59, v134, v135
  v_mfma_f32_16x16x32_bf16 v[64:67], v[228:231], a[212:215], v[64:67]
  buffer_load_dwordx4 v71, s[16:19], s5 offen offset:128 lds
  v_mfma_f32_16x16x32_bf16 v[60:63], v[232:235], a[144:147], 0
  s_add_u32 m0, s46, 143104
  v_cvt_pk_bf16_f32 v118, v124, v125
  v_cvt_pk_bf16_f32 v119, v126, v127
  v_mfma_f32_16x16x32_bf16 v[60:63], v[236:239], a[156:159], v[60:63]
  v_exp_f32 v108, v108
  v_mfma_f32_16x16x32_bf16 v[60:63], v[240:243], a[168:171], v[60:63]
  buffer_load_dwordx4 v71, s[16:19], s5 offen offset:256 lds
  v_mfma_f32_16x16x32_bf16 v[60:63], v[244:247], a[180:183], v[60:63]
  v_cvt_pk_bf16_f32 v74, v64, v65
  v_cvt_pk_bf16_f32 v75, v66, v67
  v_mfma_f32_16x16x32_bf16 v[60:63], v[248:251], a[192:195], v[60:63]
  v_exp_f32 v109, v109
  v_mfma_f32_16x16x32_bf16 v[60:63], v[252:255], a[204:207], v[60:63]
  v_exp_f32 v110, v110
  v_mfma_f32_16x16x32_bf16 v[64:67], v[232:235], a[148:151], 0
  v_exp_f32 v111, v111
  v_mfma_f32_16x16x32_bf16 v[64:67], v[236:239], a[160:163], v[64:67]
  v_exp_f32 v140, v140
  v_mfma_f32_16x16x32_bf16 v[64:67], v[240:243], a[172:175], v[64:67]
  v_cvt_pk_bf16_f32 v120, v60, v61
  v_cvt_pk_bf16_f32 v121, v62, v63
  v_mfma_f32_16x16x32_bf16 v[64:67], v[244:247], a[184:187], v[64:67]
  v_exp_f32 v141, v141
  v_mfma_f32_16x16x32_bf16 v[64:67], v[248:251], a[196:199], v[64:67]
  v_exp_f32 v142, v142
  v_mfma_f32_16x16x32_bf16 v[64:67], v[252:255], a[208:211], v[64:67]
  v_exp_f32 v143, v143
  v_mfma_f32_16x16x32_bf16 v[60:63], v[232:235], a[152:155], 0
  v_exp_f32 v144, v144
  v_mfma_f32_16x16x32_bf16 v[60:63], v[236:239], a[164:167], v[60:63]
  v_exp_f32 v145, v145
  v_mfma_f32_16x16x32_bf16 v[60:63], v[240:243], a[176:179], v[60:63]
  v_cvt_pk_bf16_f32 v76, v64, v65
  v_cvt_pk_bf16_f32 v77, v66, v67
  v_cvt_pk_bf16_f32 v104, v104, v105
  v_mfma_f32_16x16x32_bf16 v[60:63], v[244:247], a[188:191], v[60:63]
  v_exp_f32 v146, v146
  v_cvt_pk_bf16_f32 v105, v106, v107
  v_mfma_f32_16x16x32_bf16 v[60:63], v[248:251], a[200:203], v[60:63]
  v_exp_f32 v147, v147
  v_cvt_pk_bf16_f32 v106, v108, v109
  v_mfma_f32_16x16x32_bf16 v[60:63], v[252:255], a[212:215], v[60:63]
  v_cvt_pk_bf16_f32 v107, v110, v111
  v_cvt_pk_bf16_f32 v108, v140, v141
  v_cvt_pk_bf16_f32 v109, v142, v143
  v_mfma_f32_16x16x32_bf16 v[64:67], a[216:219], a[144:147], 0
  v_cvt_pk_bf16_f32 v110, v144, v145
  v_cvt_pk_bf16_f32 v111, v146, v147
  v_xor_b32 v1, 64, v0
  v_mfma_f32_16x16x32_bf16 v[64:67], a[220:223], a[156:159], v[64:67]
  s_add_u32 s5, s45, 24576
  s_add_u32 m0, s46, 0
  v_exp_f32 v80, v80
  v_mfma_f32_16x16x32_bf16 v[64:67], a[224:227], a[168:171], v[64:67]
  v_cvt_pk_bf16_f32 v160, v60, v61
  v_cvt_pk_bf16_f32 v161, v62, v63
  v_mfma_f32_16x16x32_bf16 v[64:67], a[228:231], a[180:183], v[64:67]
  v_exp_f32 v81, v81
  v_mfma_f32_16x16x32_bf16 v[64:67], a[232:235], a[192:195], v[64:67]
  buffer_load_dwordx4 v71, s[16:19], s5 offen offset:0 lds
  v_cvt_pk_bf16_f32 v80, v80, v81
  v_mfma_f32_16x16x32_bf16 v[64:67], a[236:239], a[204:207], v[64:67]
  s_add_u32 m0, s46, 8064
  v_exp_f32 v82, v82
  v_mfma_f32_16x16x32_bf16 v[124:127], a[216:219], a[148:151], 0
  v_exp_f32 v83, v83
  v_mfma_f32_16x16x32_bf16 v[124:127], a[220:223], a[160:163], v[124:127]
  buffer_load_dwordx4 v71, s[16:19], s5 offen offset:128 lds
  v_cvt_pk_bf16_f32 v81, v82, v83
  v_mfma_f32_16x16x32_bf16 v[124:127], a[224:227], a[172:175], v[124:127]
  s_add_u32 m0, s46, 16128
  v_cvt_pk_bf16_f32 v122, v64, v65
  v_cvt_pk_bf16_f32 v123, v66, v67
  v_mfma_f32_16x16x32_bf16 v[124:127], a[228:231], a[184:187], v[124:127]
  v_exp_f32 v84, v84
  v_mfma_f32_16x16x32_bf16 v[124:127], a[232:235], a[196:199], v[124:127]
  buffer_load_dwordx4 v71, s[16:19], s5 offen offset:256 lds
  v_mov_b64 v[168:169], 0
  v_mfma_f32_16x16x32_bf16 v[124:127], a[236:239], a[208:211], v[124:127]
  s_add_u32 s5, s45, 36864
  s_add_u32 m0, s46, 4096
  v_exp_f32 v85, v85
  v_mfma_f32_16x16x32_bf16 v[64:67], a[216:219], a[152:155], 0
  v_exp_f32 v86, v86
  v_cvt_pk_bf16_f32 v82, v84, v85
  v_mfma_f32_16x16x32_bf16 v[64:67], a[220:223], a[164:167], v[64:67]
  buffer_load_dwordx4 v71, s[16:19], s5 offen offset:0 lds
  v_mfma_f32_16x16x32_bf16 v[64:67], a[224:227], a[176:179], v[64:67]
  s_add_u32 m0, s46, 12160
  v_cvt_pk_bf16_f32 v78, v124, v125
  v_cvt_pk_bf16_f32 v79, v126, v127
  v_mfma_f32_16x16x32_bf16 v[64:67], a[228:231], a[188:191], v[64:67]
  v_exp_f32 v87, v87
  v_mfma_f32_16x16x32_bf16 v[64:67], a[232:235], a[200:203], v[64:67]
  buffer_load_dwordx4 v71, s[16:19], s5 offen offset:128 lds
  v_cvt_pk_bf16_f32 v83, v86, v87
  v_mfma_f32_16x16x32_bf16 v[64:67], a[236:239], a[212:215], v[64:67]
  s_add_u32 m0, s46, 20224
  v_mov_b64 v[132:133], 0
  v_exp_f32 v112, v112
  v_smfmac_f32_16x16x64_bf16 v[168:171], a[240:243], v[96:103], v10
  v_exp_f32 v113, v113
  v_mfma_f32_16x16x32_bf16 v[176:179], v[120:123], v[100:103], 0
  buffer_load_dwordx4 v71, s[16:19], s5 offen offset:256 lds
  v_cvt_pk_bf16_f32 v84, v112, v113
  v_mfma_f32_16x16x32_bf16 v[176:179], v[56:59], v[96:99], v[176:179]
  v_cvt_pk_bf16_f32 v162, v64, v65
  v_cvt_pk_bf16_f32 v163, v66, v67
  v_mfma_f32_16x16x32_bf16 v[172:175], v[116:119], v[96:99], 0
  v_exp_f32 v114, v114
  v_mfma_f32_16x16x32_bf16 v[172:175], v[76:79], v[100:103], v[172:175]
  v_exp_f32 v115, v115
  v_mfma_f32_16x16x32_bf16 v[124:127], v[160:163], v[100:103], 0
  v_exp_f32 v180, v180
  v_cvt_pk_bf16_f32 v85, v114, v115
  v_mfma_f32_16x16x32_bf16 v[124:127], v[72:75], v[96:99], v[124:127]
  v_exp_f32 v181, v181
  v_mov_b64 v[112:113], 0
  v_smfmac_f32_16x16x64_bf16 v[132:135], a[240:243], v[104:111], v10
  v_exp_f32 v182, v182
  v_cvt_pk_bf16_f32 v86, v180, v181
  v_mfma_f32_16x16x32_bf16 v[152:155], v[120:123], v[108:111], 0
  v_exp_f32 v183, v183
  v_add_f32 v168, v168, v169
  v_mfma_f32_16x16x32_bf16 v[152:155], v[56:59], v[104:107], v[152:155]
  v_cvt_pk_bf16_f32 v87, v182, v183
  v_exp_f32 v88, v88
  v_mfma_f32_16x16x32_bf16 v[140:143], v[116:119], v[104:107], 0
  v_exp_f32 v89, v89
  v_mfma_f32_16x16x32_bf16 v[140:143], v[76:79], v[108:111], v[140:143]
  v_exp_f32 v90, v90
  v_cvt_pk_bf16_f32 v88, v88, v89
  v_mfma_f32_16x16x32_bf16 v[180:183], v[160:163], v[108:111], 0
  v_exp_f32 v91, v91
  v_add_f32 v132, v132, v133
  v_mfma_f32_16x16x32_bf16 v[180:183], v[72:75], v[104:107], v[180:183]
  v_exp_f32 v92, v92
  v_cvt_pk_bf16_f32 v89, v90, v91
  v_smfmac_f32_16x16x64_bf16 v[112:115], a[240:243], v[80:87], v10
  v_exp_f32 v93, v93
  v_exp_f32 v94, v94
  v_exp_f32 v95, v95
  v_exp_f32 v148, v148
  v_exp_f32 v149, v149
  v_exp_f32 v150, v150
  v_exp_f32 v151, v151
  v_exp_f32 v164, v164
  v_exp_f32 v165, v165
  v_exp_f32 v166, v166
  v_exp_f32 v167, v167
  v_mfma_f32_16x16x32_bf16 v[136:139], v[56:59], v[84:87], 0
  s_add_u32 s5, s45, 49152
  v_cvt_pk_bf16_f32 v90, v92, v93
  v_cvt_pk_bf16_f32 v91, v94, v95
  v_cvt_pk_bf16_f32 v92, v148, v149
  v_cvt_pk_bf16_f32 v93, v150, v151
  v_cvt_pk_bf16_f32 v94, v164, v165
  v_cvt_pk_bf16_f32 v95, v166, v167
  v_mfma_f32_16x16x32_bf16 v[136:139], v[120:123], v[80:83], v[136:139]
  s_waitcnt vmcnt(6) lgkmcnt(0)
  s_barrier
  v_mfma_f32_16x16x32_bf16 v[156:159], v[76:79], v[80:83], 0
  s_add_u32 m0, s46, 98304
  ds_read_b128 v[60:63], v0 offset:0
  v_mov_b64 v[104:105], 0
  v_mfma_f32_16x16x32_bf16 v[156:159], v[116:119], v[84:87], v[156:159]
  buffer_load_dwordx4 v71, s[16:19], s5 offen offset:0 lds
  v_mfma_f32_16x16x32_bf16 v[148:151], v[72:75], v[84:87], 0
  s_add_u32 m0, s46, 106368
  ds_read_b128 a[244:247], v1 offset:0
  ds_read_b128 v[164:167], v0 offset:8192
  v_mfma_f32_16x16x32_bf16 v[148:151], v[160:163], v[80:83], v[148:151]
  ds_read_b128 v[64:67], v1 offset:8192
  ds_read_b128 v[128:131], v0 offset:16384
  v_smfmac_f32_16x16x64_bf16 v[104:107], a[240:243], v[88:95], v10
  buffer_load_dwordx4 v71, s[16:19], s5 offen offset:128 lds
  v_mfma_f32_16x16x32_bf16 v[100:103], v[56:59], v[92:95], 0
  s_add_u32 m0, s46, 114432
  ds_read_b128 v[144:147], v1 offset:16384
  ds_read2st64_b32 v[84:85], v68 offset0:0 offset1:2
  v_mfma_f32_16x16x32_bf16 v[100:103], v[120:123], v[88:91], v[100:103]
  ds_read2st64_b32 v[96:97], v69 offset0:0 offset1:2
  ds_read2st64_b32 v[86:87], v68 offset0:4 offset1:6
  v_mfma_f32_16x16x32_bf16 v[108:111], v[76:79], v[88:91], 0
  buffer_load_dwordx4 v71, s[16:19], s5 offen offset:256 lds
  v_mfma_f32_16x16x32_bf16 v[108:111], v[116:119], v[92:95], v[108:111]
  s_add_u32 s5, s45, 61440
  s_add_u32 m0, s46, 102400
  ds_read2st64_b32 v[98:99], v69 offset0:4 offset1:6
  v_mfma_f32_16x16x32_bf16 v[116:119], v[72:75], v[92:95], 0
  s_waitcnt lgkmcnt(3)
  ds_read2st64_b32 v[76:77], v54 offset0:0 offset1:2
  ds_read2st64_b32 v[80:81], v55 offset0:0 offset1:2
  v_mfma_f32_16x16x32_bf16 v[116:119], v[160:163], v[88:91], v[116:119]
  buffer_load_dwordx4 v71, s[16:19], s5 offen offset:0 lds
  v_mfma_f32_16x16x32_bf16 v[72:75], a[0:3], v[60:63], 0
  s_add_u32 m0, s46, 110464
  ds_read2st64_b32 v[78:79], v54 offset0:4 offset1:6
  ds_read2st64_b32 v[82:83], v55 offset0:4 offset1:6
  v_mfma_f32_16x16x32_bf16 v[72:75], a[12:15], a[244:247], v[72:75]
  v_rcp_f32 v170, v168
  v_mfma_f32_16x16x32_bf16 v[72:75], a[24:27], v[164:167], v[72:75]
  buffer_load_dwordx4 v71, s[16:19], s5 offen offset:128 lds
  v_mfma_f32_16x16x32_bf16 v[72:75], a[36:39], v[64:67], v[72:75]
  s_add_u32 m0, s46, 118528
  v_mul_f32 v176, v170, v176
  v_mul_f32 v177, v170, v177
  v_mfma_f32_16x16x32_bf16 v[72:75], a[48:51], v[128:131], v[72:75]
  s_waitcnt lgkmcnt(4)
  v_perm_b32 v184, v96, v84, s58
  v_perm_b32 v188, v96, v84, s59
  v_mfma_f32_16x16x32_bf16 v[72:75], a[60:63], v[144:147], v[72:75]
  buffer_load_dwordx4 v71, s[16:19], s5 offen offset:256 lds
  v_mfma_f32_16x16x32_bf16 v[88:91], a[64:67], v[144:147], 0
  s_waitcnt lgkmcnt(0)
  v_perm_b32 v185, v97, v85, s58
  v_perm_b32 v189, v97, v85, s59
  v_mfma_f32_16x16x32_bf16 v[88:91], a[52:55], v[128:131], v[88:91]
  s_add_u32 m0, s28, 4096
  v_perm_b32 v186, v98, v86, s58
  v_perm_b32 v190, v98, v86, s59
  v_mfma_f32_16x16x32_bf16 v[88:91], a[40:43], v[64:67], v[88:91]
  s_mov_b32 s5, s28
  v_mul_f32 v72, s42, v72
  v_mul_f32 v73, s42, v73
  v_mfma_f32_16x16x32_bf16 v[88:91], a[28:31], v[164:167], v[88:91]
  v_mul_f32 v74, s42, v74
  v_mul_f32 v75, s42, v75
  v_mfma_f32_16x16x32_bf16 v[88:91], a[16:19], a[244:247], v[88:91]
  buffer_load_dwordx4 v6, s[8:11], s32 offen offset:0 nt lds
  v_mfma_f32_16x16x32_bf16 v[88:91], a[4:7], v[60:63], v[88:91]
  s_add_u32 m0, s28, 12160
  v_cvt_pk_bf16_f32 v12, v72, v73
  v_cvt_pk_bf16_f32 v13, v74, v75
  v_mfma_f32_16x16x32_bf16 v[56:59], a[8:11], v[60:63], 0
  v_perm_b32 v187, v99, v87, s58
  v_perm_b32 v191, v99, v87, s59
  v_perm_b32 v192, v80, v76, s58
  v_mfma_f32_16x16x32_bf16 v[56:59], a[20:23], a[244:247], v[56:59]
  buffer_load_dwordx4 v6, s[8:11], s32 offen offset:128 nt lds
  v_perm_b32 v196, v80, v76, s59
  v_mfma_f32_16x16x32_bf16 v[56:59], a[32:35], v[164:167], v[56:59]
  s_add_u32 m0, s28, 20224
  v_mul_f32 v88, s42, v88
  v_mul_f32 v89, s42, v89
  v_mul_f32 v90, s42, v90
  v_mfma_f32_16x16x32_bf16 v[56:59], a[44:47], v[64:67], v[56:59]
  s_mov_b32 s28, s29
  v_mul_f32 v91, s42, v91
  v_cvt_pk_bf16_f32 v72, v88, v89
  v_cvt_pk_bf16_f32 v73, v90, v91
  v_mfma_f32_16x16x32_bf16 v[56:59], a[56:59], v[128:131], v[56:59]
  buffer_load_dwordx4 v6, s[8:11], s32 offen offset:256 nt lds
  v_perm_b32 v193, v81, v77, s58
  v_mfma_f32_16x16x32_bf16 v[56:59], a[68:71], v[144:147], v[56:59]
  s_add_u32 s32, s32, s43
  v_perm_b32 v197, v81, v77, s59
  v_perm_b32 v194, v82, v78, s58
  v_perm_b32 v198, v82, v78, s59
  v_mfma_f32_16x16x32_bf16 v[88:91], a[132:135], v[144:147], 0
  ds_read2st64_b32 v[84:85], v68 offset0:16 offset1:18
  v_perm_b32 v195, v83, v79, s58
  v_perm_b32 v199, v83, v79, s59
  v_mfma_f32_16x16x32_bf16 v[88:91], a[120:123], v[128:131], v[88:91]
  ds_read2st64_b32 v[96:97], v69 offset0:16 offset1:18
  ds_read2st64_b32 v[86:87], v68 offset0:20 offset1:22
  v_mul_f32 v178, v170, v178
  v_mfma_f32_16x16x32_bf16 v[88:91], a[108:111], v[64:67], v[88:91]
  v_mul_f32 v56, s42, v56
  v_mul_f32 v57, s42, v57
  v_mul_f32 v58, s42, v58
  v_mfma_f32_16x16x32_bf16 v[88:91], a[96:99], v[164:167], v[88:91]
  v_mul_f32 v59, s42, v59
  v_cvt_pk_bf16_f32 v74, v56, v57
  v_cvt_pk_bf16_f32 v75, v58, v59
  v_mfma_f32_16x16x32_bf16 v[88:91], a[84:87], a[244:247], v[88:91]
  ds_read2st64_b32 v[98:99], v69 offset0:20 offset1:22
  ds_read2st64_b32 v[76:77], v54 offset0:16 offset1:18
  v_mul_f32 v179, v170, v179
  v_mfma_f32_16x16x32_bf16 v[88:91], a[72:75], v[60:63], v[88:91]
  ds_read2st64_b32 v[80:81], v55 offset0:16 offset1:18
  ds_read2st64_b32 v[78:79], v54 offset0:20 offset1:22
  v_cvt_pk_bf16_f32 v176, v176, v177
  v_mfma_f32_16x16x32_bf16 v[56:59], a[76:79], v[60:63], 0
  ds_read2st64_b32 v[82:83], v55 offset0:20 offset1:22
  v_cvt_pk_bf16_f32 v177, v178, v179
  v_mul_f32 v172, v170, v172
  v_mfma_f32_16x16x32_bf16 v[56:59], a[88:91], a[244:247], v[56:59]
  v_mul_f32 v173, v170, v173
  v_mul_f32 v174, v170, v174
  v_mul_f32 v175, v170, v175
  v_mfma_f32_16x16x32_bf16 v[56:59], a[100:103], v[164:167], v[56:59]
  v_cvt_pk_bf16_f32 v120, v88, v89
  v_cvt_pk_bf16_f32 v121, v90, v91
  v_cvt_pk_bf16_f32 v172, v172, v173
  v_mfma_f32_16x16x32_bf16 v[56:59], a[112:115], v[64:67], v[56:59]
  s_waitcnt lgkmcnt(4)
  v_cvt_pk_bf16_f32 v173, v174, v175
  v_mul_f32 v124, v170, v124
  v_mul_f32 v125, v170, v125
  v_mfma_f32_16x16x32_bf16 v[56:59], a[124:127], v[128:131], v[56:59]
  v_mul_f32 v126, v170, v126
  v_mul_f32 v127, v170, v127
  v_cvt_pk_bf16_f32 v124, v124, v125
  v_mfma_f32_16x16x32_bf16 v[56:59], a[136:139], v[144:147], v[56:59]
  s_waitcnt lgkmcnt(0)
  v_cvt_pk_bf16_f32 v125, v126, v127
  v_max3_f32 v9, v168, v170, v9
  v_perm_b32 v200, v96, v84, s58
  v_mfma_f32_16x16x32_bf16 v[92:95], a[140:143], v[144:147], 0
  ds_write2st64_b32 v5, v176, v177 offset0:0 offset1:4
  v_mfma_f32_16x16x32_bf16 v[92:95], a[128:131], v[128:131], v[92:95]
  ds_write2st64_b32 v5, v172, v173 offset0:8 offset1:12
  v_mfma_f32_16x16x32_bf16 v[92:95], a[116:119], v[64:67], v[92:95]
  v_cvt_pk_bf16_f32 v122, v56, v57
  v_cvt_pk_bf16_f32 v123, v58, v59
  v_perm_b32 v204, v96, v84, s59
  v_mfma_f32_16x16x32_bf16 v[92:95], a[104:107], v[164:167], v[92:95]
  ds_write2st64_b32 v5, v124, v125 offset0:16 offset1:20
  v_mfma_f32_16x16x32_bf16 v[92:95], a[92:95], a[244:247], v[92:95]
  v_perm_b32 v201, v97, v85, s58
  v_perm_b32 v205, v97, v85, s59
  v_perm_b32 v202, v98, v86, s58
  v_mfma_f32_16x16x32_bf16 v[92:95], a[80:83], v[60:63], v[92:95]
  v_perm_b32 v206, v98, v86, s59
  v_perm_b32 v203, v99, v87, s58
  v_perm_b32 v207, v99, v87, s59
  v_mfma_f32_16x16x32_bf16 v[168:171], v[60:63], a[144:147], 0
  v_perm_b32 v208, v80, v76, s58
  v_perm_b32 v212, v80, v76, s59
  v_perm_b32 v209, v81, v77, s58
  v_mfma_f32_16x16x32_bf16 v[168:171], a[244:247], a[156:159], v[168:171]
  v_perm_b32 v213, v81, v77, s59
  v_perm_b32 v210, v82, v78, s58
  v_perm_b32 v214, v82, v78, s59
  v_mfma_f32_16x16x32_bf16 v[168:171], v[164:167], a[168:171], v[168:171]
  ds_read_b128 a[248:251], v0 offset:2048
  v_cvt_pk_bf16_f32 v124, v92, v93
  v_cvt_pk_bf16_f32 v125, v94, v95
  v_mfma_f32_16x16x32_bf16 v[168:171], v[64:67], a[180:183], v[168:171]
  ds_read_b128 v[172:175], v1 offset:2048
  ds_read_b128 v[88:91], v0 offset:10240
  v_perm_b32 v211, v83, v79, s58
  v_mfma_f32_16x16x32_bf16 v[168:171], v[128:131], a[192:195], v[168:171]
  s_add_u32 m0, s29, 0
  ds_read_b128 v[160:163], v1 offset:10240
  ds_read_b128 a[252:255], v0 offset:18432
  v_perm_b32 v215, v83, v79, s59
  v_mfma_f32_16x16x32_bf16 v[168:171], v[144:147], a[204:207], v[168:171]
  ds_read_b128 v[92:95], v1 offset:18432
  v_add_u32 v68, 4294844416, v68
  v_add_u32 v69, 4294844416, v69
  v_mfma_f32_16x16x32_bf16 v[176:179], v[144:147], a[208:211], 0
  s_waitcnt vmcnt(3)
  s_barrier
  v_mfma_f32_16x16x32_bf16 v[176:179], v[128:131], a[196:199], v[176:179]
  buffer_load_dwordx4 v6, s[8:11], s31 offen offset:0 nt lds
  v_add_u32 v54, 4294844416, v54
  v_mfma_f32_16x16x32_bf16 v[176:179], v[64:67], a[184:187], v[176:179]
  s_add_u32 m0, s29, 8064
  v_cvt_pk_bf16_f32 v56, v168, v169
  v_cvt_pk_bf16_f32 v57, v170, v171
  v_add_u32 v55, 4294844416, v55
  v_mfma_f32_16x16x32_bf16 v[176:179], v[164:167], a[172:175], v[176:179]
  ds_read2st64_b32 v[84:85], v68 offset0:0 offset1:2
  ds_read2st64_b32 v[96:97], v69 offset0:0 offset1:2
  v_add_f32 v112, v112, v113
  v_mfma_f32_16x16x32_bf16 v[176:179], a[244:247], a[160:163], v[176:179]
  ds_read2st64_b32 v[86:87], v68 offset0:4 offset1:6
  ds_read2st64_b32 v[98:99], v69 offset0:4 offset1:6
  v_add_f32 v104, v104, v105
  v_mfma_f32_16x16x32_bf16 v[176:179], v[60:63], a[148:151], v[176:179]
  buffer_load_dwordx4 v6, s[8:11], s31 offen offset:128 nt lds
  v_mfma_f32_16x16x32_bf16 v[168:171], v[60:63], a[152:155], 0
  s_add_u32 m0, s29, 16128
  ds_read2st64_b32 v[76:77], v54 offset0:0 offset1:2
  ds_read2st64_b32 v[80:81], v55 offset0:0 offset1:2
  v_mfma_f32_16x16x32_bf16 v[168:171], a[244:247], a[164:167], v[168:171]
  ds_read2st64_b32 v[78:79], v54 offset0:4 offset1:6
  ds_read2st64_b32 v[82:83], v55 offset0:4 offset1:6
  v_mfma_f32_16x16x32_bf16 v[168:171], v[164:167], a[176:179], v[168:171]
  v_cvt_pk_bf16_f32 v60, v176, v177
  v_cvt_pk_bf16_f32 v61, v178, v179
  v_mfma_f32_16x16x32_bf16 v[168:171], v[64:67], a[188:191], v[168:171]
  buffer_load_dwordx4 v6, s[8:11], s31 offen offset:256 nt lds
  v_mfma_f32_16x16x32_bf16 v[168:171], v[128:131], a[200:203], v[168:171]
  s_add_u32 m0, s29, 4096
  v_rcp_f32 v134, v132
  v_mfma_f32_16x16x32_bf16 v[168:171], v[144:147], a[212:215], v[168:171]
  s_waitcnt lgkmcnt(4)
  v_perm_b32 v216, v96, v84, s58
  v_perm_b32 v220, v96, v84, s59
  v_perm_b32 v217, v97, v85, s58
  v_mfma_f32_16x16x32_bf16 v[164:167], a[0:3], a[248:251], 0
  s_waitcnt lgkmcnt(0)
  v_perm_b32 v221, v97, v85, s59
  v_perm_b32 v218, v98, v86, s58
  v_perm_b32 v222, v98, v86, s59
  v_mfma_f32_16x16x32_bf16 v[164:167], a[12:15], v[172:175], v[164:167]
L_hop_1_0:
  s_cbranch_execz L_hop_1_1
  buffer_load_dwordx4 v6, s[8:11], s32 offen offset:0 nt lds
  v_perm_b32 v219, v99, v87, s58
  v_mfma_f32_16x16x32_bf16 v[164:167], a[24:27], v[88:91], v[164:167]
  s_add_u32 m0, s29, 12160
  v_cvt_pk_bf16_f32 v64, v168, v169
  v_cvt_pk_bf16_f32 v65, v170, v171
  v_perm_b32 v223, v99, v87, s59
  v_mfma_f32_16x16x32_bf16 v[164:167], a[36:39], v[160:163], v[164:167]
  s_add_u32 s31, s31, s43
  v_perm_b32 v224, v80, v76, s58
  v_perm_b32 v228, v80, v76, s59
  v_perm_b32 v225, v81, v77, s58
  v_mfma_f32_16x16x32_bf16 v[164:167], a[48:51], a[252:255], v[164:167]
  v_perm_b32 v229, v81, v77, s59
  v_perm_b32 v226, v82, v78, s58
  v_perm_b32 v230, v82, v78, s59
  v_mfma_f32_16x16x32_bf16 v[164:167], a[60:63], v[92:95], v[164:167]
  buffer_load_dwordx4 v6, s[8:11], s32 offen offset:128 nt lds
  v_perm_b32 v227, v83, v79, s58
  v_mfma_f32_16x16x32_bf16 v[168:171], a[64:67], v[92:95], 0
  s_add_u32 m0, s29, 20224
  ds_read2st64_b32 v[84:85], v68 offset0:16 offset1:18
  ds_read2st64_b32 v[96:97], v69 offset0:16 offset1:18
  v_perm_b32 v231, v83, v79, s59
  v_mfma_f32_16x16x32_bf16 v[168:171], a[52:55], a[252:255], v[168:171]
  s_mov_b32 s29, s30
  ds_read2st64_b32 v[86:87], v68 offset0:20 offset1:22
  ds_read2st64_b32 v[98:99], v69 offset0:20 offset1:22
  v_mul_f32 v152, v134, v152
  v_mfma_f32_16x16x32_bf16 v[168:171], a[40:43], v[160:163], v[168:171]
  v_mul_f32 v164, s42, v164
  v_mul_f32 v165, s42, v165
  v_mul_f32 v166, s42, v166
  v_mfma_f32_16x16x32_bf16 v[168:171], a[28:31], v[88:91], v[168:171]
  buffer_load_dwordx4 v6, s[8:11], s32 offen offset:256 nt lds
  v_mul_f32 v167, s42, v167
  v_mfma_f32_16x16x32_bf16 v[168:171], a[16:19], v[172:175], v[168:171]
  s_add_u32 s32, s32, s43
  ds_read2st64_b32 v[76:77], v54 offset0:16 offset1:18
  v_cvt_pk_bf16_f32 v128, v164, v165
  v_cvt_pk_bf16_f32 v129, v166, v167
  v_mfma_f32_16x16x32_bf16 v[168:171], a[4:7], a[248:251], v[168:171]
  ds_read2st64_b32 v[80:81], v55 offset0:16 offset1:18
  ds_read2st64_b32 v[78:79], v54 offset0:20 offset1:22
  v_mul_f32 v153, v134, v153
  v_mfma_f32_16x16x32_bf16 v[164:167], a[8:11], a[248:251], 0
  s_waitcnt lgkmcnt(3)
  ds_read2st64_b32 v[82:83], v55 offset0:20 offset1:22
  v_mul_f32 v154, v134, v154
  v_mul_f32 v155, v134, v155
  v_mfma_f32_16x16x32_bf16 v[164:167], a[20:23], v[172:175], v[164:167]
  v_cvt_pk_bf16_f32 v152, v152, v153
  v_cvt_pk_bf16_f32 v153, v154, v155
  v_mul_f32 v140, v134, v140
  v_mfma_f32_16x16x32_bf16 v[164:167], a[32:35], v[88:91], v[164:167]
  v_mul_f32 v168, s42, v168
  v_mul_f32 v169, s42, v169
  v_mul_f32 v170, s42, v170
  v_mfma_f32_16x16x32_bf16 v[164:167], a[44:47], v[160:163], v[164:167]
  v_mul_f32 v171, s42, v171
  v_cvt_pk_bf16_f32 v130, v168, v169
  v_cvt_pk_bf16_f32 v131, v170, v171
  v_mfma_f32_16x16x32_bf16 v[164:167], a[56:59], a[252:255], v[164:167]
  v_mul_f32 v141, v134, v141
  v_mul_f32 v142, v134, v142
  v_mul_f32 v143, v134, v143
  v_mfma_f32_16x16x32_bf16 v[164:167], a[68:71], v[92:95], v[164:167]
  s_waitcnt lgkmcnt(0)
  v_cvt_pk_bf16_f32 v140, v140, v141
  v_cvt_pk_bf16_f32 v141, v142, v143
  v_mul_f32 v180, v134, v180
  v_mfma_f32_16x16x32_bf16 v[168:171], a[132:135], v[92:95], 0
  v_mul_f32 v181, v134, v181
  v_mul_f32 v182, v134, v182
  v_mul_f32 v183, v134, v183
  v_mfma_f32_16x16x32_bf16 v[168:171], a[120:123], a[252:255], v[168:171]
  v_cvt_pk_bf16_f32 v180, v180, v181
  v_cvt_pk_bf16_f32 v181, v182, v183
  v_max3_f32 v9, v132, v134, v9
  v_mfma_f32_16x16x32_bf16 v[168:171], a[108:111], v[160:163], v[168:171]
  v_mul_f32 v164, s42, v164
  v_mul_f32 v165, s42, v165
  v_mul_f32 v166, s42, v166
  v_mfma_f32_16x16x32_bf16 v[168:171], a[96:99], v[88:91], v[168:171]
  v_mul_f32 v167, s42, v167
  v_cvt_pk_bf16_f32 v16, v164, v165
  v_cvt_pk_bf16_f32 v17, v166, v167
  v_mfma_f32_16x16x32_bf16 v[168:171], a[84:87], v[172:175], v[168:171]
  ds_write2st64_b32 v5, v152, v153 offset0:1 offset1:5
  v_mfma_f32_16x16x32_bf16 v[168:171], a[72:75], a[248:251], v[168:171]
  ds_write2st64_b32 v5, v140, v141 offset0:9 offset1:13
  v_mfma_f32_16x16x32_bf16 v[132:135], a[76:79], a[248:251], 0
  ds_write2st64_b32 v5, v180, v181 offset0:17 offset1:21
  v_mfma_f32_16x16x32_bf16 v[132:135], a[88:91], v[172:175], v[132:135]
  v_rcp_f32 v114, v112
  v_perm_b32 v232, v96, v84, s58
  v_mfma_f32_16x16x32_bf16 v[132:135], a[100:103], v[88:91], v[132:135]
  v_cvt_pk_bf16_f32 v144, v168, v169
  v_cvt_pk_bf16_f32 v145, v170, v171
  v_mul_f32 v136, v114, v136
  v_mfma_f32_16x16x32_bf16 v[132:135], a[112:115], v[160:163], v[132:135]
  v_mul_f32 v137, v114, v137
  v_mul_f32 v138, v114, v138
  v_mul_f32 v139, v114, v139
  v_mfma_f32_16x16x32_bf16 v[132:135], a[124:127], a[252:255], v[132:135]
  v_cvt_pk_bf16_f32 v136, v136, v137
  v_cvt_pk_bf16_f32 v137, v138, v139
  v_mul_f32 v156, v114, v156
  v_mfma_f32_16x16x32_bf16 v[132:135], a[136:139], v[92:95], v[132:135]
  v_mul_f32 v157, v114, v157
  v_mul_f32 v158, v114, v158
  v_mul_f32 v159, v114, v159
  v_mfma_f32_16x16x32_bf16 v[152:155], a[140:143], v[92:95], 0
  v_cvt_pk_bf16_f32 v156, v156, v157
  v_cvt_pk_bf16_f32 v157, v158, v159
  v_mul_f32 v148, v114, v148
  v_mfma_f32_16x16x32_bf16 v[152:155], a[128:131], a[252:255], v[152:155]
  v_mul_f32 v149, v114, v149
  v_mul_f32 v150, v114, v150
  v_mul_f32 v151, v114, v151
  v_mfma_f32_16x16x32_bf16 v[152:155], a[116:119], v[160:163], v[152:155]
  v_cvt_pk_bf16_f32 v146, v132, v133
  v_cvt_pk_bf16_f32 v147, v134, v135
  v_cvt_pk_bf16_f32 v148, v148, v149
  v_mfma_f32_16x16x32_bf16 v[152:155], a[104:107], v[88:91], v[152:155]
  v_cvt_pk_bf16_f32 v149, v150, v151
  v_max3_f32 v9, v112, v114, v9
  v_perm_b32 v236, v96, v84, s59
  v_mfma_f32_16x16x32_bf16 v[152:155], a[92:95], v[172:175], v[152:155]
  ds_write2st64_b32 v5, v136, v137 offset0:2 offset1:6
  v_mfma_f32_16x16x32_bf16 v[152:155], a[80:83], a[248:251], v[152:155]
  ds_write2st64_b32 v5, v156, v157 offset0:10 offset1:14
  v_mfma_f32_16x16x32_bf16 v[168:171], a[248:251], a[144:147], 0
  ds_write2st64_b32 v5, v148, v149 offset0:18 offset1:22
  v_mfma_f32_16x16x32_bf16 v[168:171], v[172:175], a[156:159], v[168:171]
  v_rcp_f32 v106, v104
  v_perm_b32 v233, v97, v85, s58
  v_mfma_f32_16x16x32_bf16 v[168:171], v[88:91], a[168:171], v[168:171]
  v_cvt_pk_bf16_f32 v148, v152, v153
  v_cvt_pk_bf16_f32 v149, v154, v155
  v_mfma_f32_16x16x32_bf16 v[168:171], v[160:163], a[180:183], v[168:171]
  v_mul_f32 v100, v106, v100
  v_mul_f32 v101, v106, v101
  v_mfma_f32_16x16x32_bf16 v[168:171], a[252:255], a[192:195], v[168:171]
  s_waitcnt vmcnt(6) lgkmcnt(0)
  s_barrier
  v_mfma_f32_16x16x32_bf16 v[168:171], v[92:95], a[204:207], v[168:171]
  ds_read_b128 v[156:159], v0 offset:4096
  ds_read_b128 v[112:115], v1 offset:4096
  v_mfma_f32_16x16x32_bf16 v[132:135], v[92:95], a[208:211], 0
  ds_read_b128 v[180:183], v0 offset:12288
  ds_read_b128 v[140:143], v1 offset:12288
  v_mfma_f32_16x16x32_bf16 v[132:135], a[252:255], a[196:199], v[132:135]
  ds_read_b128 v[164:167], v0 offset:20480
  ds_read_b128 v[176:179], v1 offset:20480
  v_mfma_f32_16x16x32_bf16 v[132:135], v[160:163], a[184:187], v[132:135]
  v_cvt_pk_bf16_f32 v58, v168, v169
  v_cvt_pk_bf16_f32 v59, v170, v171
  v_mfma_f32_16x16x32_bf16 v[132:135], v[88:91], a[172:175], v[132:135]
  v_mul_f32 v102, v106, v102
  v_mul_f32 v103, v106, v103
  v_mfma_f32_16x16x32_bf16 v[132:135], v[172:175], a[160:163], v[132:135]
  v_cvt_pk_bf16_f32 v100, v100, v101
  v_cvt_pk_bf16_f32 v101, v102, v103
  v_mfma_f32_16x16x32_bf16 v[132:135], a[248:251], a[148:151], v[132:135]
  v_mul_f32 v108, v106, v108
  v_mul_f32 v109, v106, v109
  v_mfma_f32_16x16x32_bf16 v[136:139], a[248:251], a[152:155], 0
  v_mul_f32 v110, v106, v110
  v_mul_f32 v111, v106, v111
  v_mfma_f32_16x16x32_bf16 v[136:139], v[172:175], a[164:167], v[136:139]
  v_cvt_pk_bf16_f32 v108, v108, v109
  v_cvt_pk_bf16_f32 v109, v110, v111
  v_mfma_f32_16x16x32_bf16 v[136:139], v[88:91], a[176:179], v[136:139]
  v_cvt_pk_bf16_f32 v62, v132, v133
  v_cvt_pk_bf16_f32 v63, v134, v135
  v_mfma_f32_16x16x32_bf16 v[136:139], v[160:163], a[188:191], v[136:139]
  v_mul_f32 v116, v106, v116
  v_mul_f32 v117, v106, v117
  v_mfma_f32_16x16x32_bf16 v[136:139], a[252:255], a[200:203], v[136:139]
  v_mul_f32 v118, v106, v118
  v_mul_f32 v119, v106, v119
  v_mfma_f32_16x16x32_bf16 v[136:139], v[92:95], a[212:215], v[136:139]
  s_waitcnt lgkmcnt(0)
  v_cvt_pk_bf16_f32 v116, v116, v117
  v_cvt_pk_bf16_f32 v117, v118, v119
  v_mfma_f32_16x16x32_bf16 v[92:95], a[0:3], v[156:159], 0
  v_max3_f32 v9, v104, v106, v9
  v_perm_b32 v237, v97, v85, s59
  v_mfma_f32_16x16x32_bf16 v[92:95], a[12:15], v[112:115], v[92:95]
  ds_write2st64_b32 v5, v100, v101 offset0:3 offset1:7
  v_mfma_f32_16x16x32_bf16 v[92:95], a[24:27], v[180:183], v[92:95]
  v_cvt_pk_bf16_f32 v66, v136, v137
  v_cvt_pk_bf16_f32 v67, v138, v139
  v_mfma_f32_16x16x32_bf16 v[92:95], a[36:39], v[140:143], v[92:95]
  ds_write2st64_b32 v5, v108, v109 offset0:11 offset1:15
  v_mfma_f32_16x16x32_bf16 v[92:95], a[48:51], v[164:167], v[92:95]
  ds_write2st64_b32 v5, v116, v117 offset0:19 offset1:23
  v_mfma_f32_16x16x32_bf16 v[92:95], a[60:63], v[176:179], v[92:95]
  v_perm_b32 v234, v98, v86, s58
  v_perm_b32 v238, v98, v86, s59
  v_mfma_f32_16x16x32_bf16 v[88:91], a[64:67], v[176:179], 0
  v_perm_b32 v235, v99, v87, s58
  v_perm_b32 v239, v99, v87, s59
  v_mfma_f32_16x16x32_bf16 v[88:91], a[52:55], v[164:167], v[88:91]
  v_perm_b32 v240, v80, v76, s58
  v_perm_b32 v244, v80, v76, s59
  v_mfma_f32_16x16x32_bf16 v[88:91], a[40:43], v[140:143], v[88:91]
  v_mul_f32 v92, s42, v92
  v_mul_f32 v93, s42, v93
  v_mfma_f32_16x16x32_bf16 v[88:91], a[28:31], v[180:183], v[88:91]
  v_mul_f32 v94, s42, v94
  v_mul_f32 v95, s42, v95
  v_mfma_f32_16x16x32_bf16 v[88:91], a[16:19], v[112:115], v[88:91]
  v_cvt_pk_bf16_f32 v18, v92, v93
  v_cvt_pk_bf16_f32 v19, v94, v95
  v_mfma_f32_16x16x32_bf16 v[88:91], a[4:7], v[156:159], v[88:91]
  v_perm_b32 v241, v81, v77, s58
  v_perm_b32 v245, v81, v77, s59
  v_mfma_f32_16x16x32_bf16 v[92:95], a[8:11], v[156:159], 0
  v_perm_b32 v242, v82, v78, s58
  v_perm_b32 v246, v82, v78, s59
  v_mfma_f32_16x16x32_bf16 v[92:95], a[20:23], v[112:115], v[92:95]
  v_perm_b32 v243, v83, v79, s58
  v_perm_b32 v247, v83, v79, s59
  v_mfma_f32_16x16x32_bf16 v[92:95], a[32:35], v[180:183], v[92:95]
  v_mul_f32 v88, s42, v88
  v_mul_f32 v89, s42, v89
  v_mfma_f32_16x16x32_bf16 v[92:95], a[44:47], v[140:143], v[92:95]
  v_mul_f32 v90, s42, v90
  v_mul_f32 v91, s42, v91
  v_mfma_f32_16x16x32_bf16 v[92:95], a[56:59], v[164:167], v[92:95]
  v_cvt_pk_bf16_f32 v100, v88, v89
  v_cvt_pk_bf16_f32 v101, v90, v91
  v_mfma_f32_16x16x32_bf16 v[92:95], a[68:71], v[176:179], v[92:95]
  v_add_u32 v68, 98304, v68
  v_add_u32 v69, 98304, v69
  v_mfma_f32_16x16x32_bf16 v[88:91], a[132:135], v[176:179], 0
  v_add_u32 v54, 98304, v54
  v_add_u32 v55, 98304, v55
  v_mfma_f32_16x16x32_bf16 v[88:91], a[120:123], v[164:167], v[88:91]
  ds_read2st64_b32 v[84:85], v68 offset0:0 offset1:2
  ds_read2st64_b32 v[96:97], v69 offset0:0 offset1:2
  v_mfma_f32_16x16x32_bf16 v[88:91], a[108:111], v[140:143], v[88:91]
  v_mul_f32 v92, s42, v92
  v_mul_f32 v93, s42, v93
  v_mfma_f32_16x16x32_bf16 v[88:91], a[96:99], v[180:183], v[88:91]
  v_mul_f32 v94, s42, v94
  v_mul_f32 v95, s42, v95
  v_mfma_f32_16x16x32_bf16 v[88:91], a[84:87], v[112:115], v[88:91]
  v_cvt_pk_bf16_f32 v102, v92, v93
  v_cvt_pk_bf16_f32 v103, v94, v95
  v_mfma_f32_16x16x32_bf16 v[88:91], a[72:75], v[156:159], v[88:91]
  ds_read2st64_b32 v[86:87], v68 offset0:4 offset1:6
  ds_read2st64_b32 v[98:99], v69 offset0:4 offset1:6
  v_mfma_f32_16x16x32_bf16 v[92:95], a[76:79], v[156:159], 0
  ds_read2st64_b32 v[76:77], v54 offset0:0 offset1:2
  ds_read2st64_b32 v[80:81], v55 offset0:0 offset1:2
  v_mfma_f32_16x16x32_bf16 v[92:95], a[88:91], v[112:115], v[92:95]
  ds_read2st64_b32 v[78:79], v54 offset0:4 offset1:6
  ds_read2st64_b32 v[82:83], v55 offset0:4 offset1:6
  v_mfma_f32_16x16x32_bf16 v[92:95], a[100:103], v[180:183], v[92:95]
  v_cvt_pk_bf16_f32 v132, v88, v89
  v_cvt_pk_bf16_f32 v133, v90, v91
  v_mfma_f32_16x16x32_bf16 v[92:95], a[112:115], v[140:143], v[92:95]
  v_xor_b32 v5, s41, v5
  v_mfma_f32_16x16x32_bf16 v[92:95], a[124:127], v[164:167], v[92:95]
  s_waitcnt lgkmcnt(4)
  v_perm_b32 v248, v96, v84, s58
  v_perm_b32 v252, v96, v84, s59
  v_mfma_f32_16x16x32_bf16 v[92:95], a[136:139], v[176:179], v[92:95]
  v_perm_b32 v249, v97, v85, s58
  v_perm_b32 v253, v97, v85, s59
  v_mfma_f32_16x16x32_bf16 v[88:91], a[140:143], v[176:179], 0
  s_waitcnt lgkmcnt(0)
  v_perm_b32 v250, v98, v86, s58
  v_perm_b32 v254, v98, v86, s59
  v_mfma_f32_16x16x32_bf16 v[88:91], a[128:131], v[164:167], v[88:91]
  v_perm_b32 v251, v99, v87, s58
  v_perm_b32 v255, v99, v87, s59
  v_mfma_f32_16x16x32_bf16 v[88:91], a[116:119], v[140:143], v[88:91]
  v_cvt_pk_bf16_f32 v134, v92, v93
  v_cvt_pk_bf16_f32 v135, v94, v95
  v_mfma_f32_16x16x32_bf16 v[88:91], a[104:107], v[180:183], v[88:91]
  s_add_u32 m0, s30, 0
  v_perm_b32 v104, v80, v76, s58
  v_perm_b32 v76, v80, v76, s59
  v_mfma_f32_16x16x32_bf16 v[88:91], a[92:95], v[112:115], v[88:91]
  v_accvgpr_write_b32 a220, v76
  v_perm_b32 v105, v81, v77, s58
  v_mfma_f32_16x16x32_bf16 v[88:91], a[80:83], v[156:159], v[88:91]
  v_perm_b32 v77, v81, v77, s59
  v_accvgpr_write_b32 a221, v77
  v_mfma_f32_16x16x32_bf16 v[84:87], v[156:159], a[144:147], 0
  buffer_load_dwordx4 v6, s[8:11], s31 offen offset:0 nt lds
  v_mfma_f32_16x16x32_bf16 v[84:87], v[112:115], a[156:159], v[84:87]
  s_add_u32 m0, s30, 8064
  v_perm_b32 v106, v82, v78, s58
  v_perm_b32 v78, v82, v78, s59
  v_mfma_f32_16x16x32_bf16 v[84:87], v[180:183], a[168:171], v[84:87]
  v_cvt_pk_bf16_f32 v136, v88, v89
  v_cvt_pk_bf16_f32 v137, v90, v91
  v_mfma_f32_16x16x32_bf16 v[84:87], v[140:143], a[180:183], v[84:87]
  ds_read_b128 a[252:255], v1 offset:22528
  ds_read_b128 v[152:155], v0 offset:22528
  v_mfma_f32_16x16x32_bf16 v[84:87], v[164:167], a[192:195], v[84:87]
  buffer_load_dwordx4 v6, s[8:11], s31 offen offset:128 nt lds
  v_mfma_f32_16x16x32_bf16 v[84:87], v[176:179], a[204:207], v[84:87]
  s_add_u32 m0, s30, 16128
  ds_read_b128 a[244:247], v1 offset:14336
  ds_read_b128 a[248:251], v0 offset:14336
  v_mfma_f32_16x16x32_bf16 v[92:95], v[176:179], a[208:211], 0
  ds_read_b128 v[172:175], v1 offset:6144
  ds_read_b128 v[168:171], v0 offset:6144
  v_mfma_f32_16x16x32_bf16 v[92:95], v[164:167], a[196:199], v[92:95]
  v_accvgpr_write_b32 a222, v78
  v_perm_b32 v107, v83, v79, s58
  v_mfma_f32_16x16x32_bf16 v[92:95], v[140:143], a[184:187], v[92:95]
  buffer_load_dwordx4 v6, s[8:11], s31 offen offset:256 nt lds
  v_mfma_f32_16x16x32_bf16 v[92:95], v[180:183], a[172:175], v[92:95]
  s_add_u32 m0, s30, 4096
  v_cvt_pk_bf16_f32 v108, v84, v85
  v_cvt_pk_bf16_f32 v109, v86, v87
  v_mfma_f32_16x16x32_bf16 v[92:95], v[112:115], a[160:163], v[92:95]
  s_add_u32 s31, s31, s43
  v_perm_b32 v79, v83, v79, s59
  v_accvgpr_write_b32 a223, v79
  v_mfma_f32_16x16x32_bf16 v[92:95], v[156:159], a[148:151], v[92:95]
  ds_read2st64_b32 v[84:85], v68 offset0:16 offset1:18
  ds_read2st64_b32 v[96:97], v69 offset0:16 offset1:18
  v_mfma_f32_16x16x32_bf16 v[88:91], v[156:159], a[152:155], 0
  buffer_load_dwordx4 v6, s[8:11], s32 offen offset:0 nt lds
  v_mfma_f32_16x16x32_bf16 v[88:91], v[112:115], a[164:167], v[88:91]
  s_add_u32 m0, s30, 12160
  ds_read2st64_b32 v[86:87], v68 offset0:20 offset1:22
  ds_read2st64_b32 v[98:99], v69 offset0:20 offset1:22
  v_mfma_f32_16x16x32_bf16 v[88:91], v[180:183], a[176:179], v[88:91]
  v_cvt_pk_bf16_f32 v112, v92, v93
  v_cvt_pk_bf16_f32 v113, v94, v95
  v_mfma_f32_16x16x32_bf16 v[88:91], v[140:143], a[188:191], v[88:91]
  s_waitcnt lgkmcnt(2)
  ds_read2st64_b32 v[76:77], v54 offset0:16 offset1:18
  ds_read2st64_b32 v[80:81], v55 offset0:16 offset1:18
  v_mfma_f32_16x16x32_bf16 v[88:91], v[164:167], a[200:203], v[88:91]
  buffer_load_dwordx4 v6, s[8:11], s32 offen offset:128 nt lds
  v_mfma_f32_16x16x32_bf16 v[88:91], v[176:179], a[212:215], v[88:91]
  s_add_u32 m0, s30, 20224
  ds_read2st64_b32 v[78:79], v54 offset0:20 offset1:22
  ds_read2st64_b32 v[82:83], v55 offset0:20 offset1:22
  v_mfma_f32_16x16x32_bf16 v[68:71], a[132:135], a[252:255], 0
  s_waitcnt lgkmcnt(4)
  v_accvgpr_write_b32 a216, v104
  v_accvgpr_write_b32 a217, v105
  v_mfma_f32_16x16x32_bf16 v[68:71], a[120:123], v[152:155], v[68:71]
  s_mov_b32 s30, s5
  v_accvgpr_write_b32 a218, v106
  v_accvgpr_write_b32 a219, v107
  v_mfma_f32_16x16x32_bf16 v[68:71], a[108:111], a[244:247], v[68:71]
  buffer_load_dwordx4 v6, s[8:11], s32 offen offset:256 nt lds
  v_mfma_f32_16x16x32_bf16 v[68:71], a[96:99], a[248:251], v[68:71]
  s_add_u32 s32, s32, s43
  v_cvt_pk_bf16_f32 v116, v88, v89
  v_cvt_pk_bf16_f32 v117, v90, v91
  v_mfma_f32_16x16x32_bf16 v[68:71], a[84:87], v[172:175], v[68:71]
  s_waitcnt lgkmcnt(0)
  v_perm_b32 v54, v96, v84, s58
  v_perm_b32 v84, v96, v84, s59
  v_mfma_f32_16x16x32_bf16 v[68:71], a[72:75], v[168:171], v[68:71]
  v_accvgpr_write_b32 a224, v54
  v_accvgpr_write_b32 a228, v84
  v_mfma_f32_16x16x32_bf16 v[88:91], a[76:79], v[168:171], 0
  v_perm_b32 v55, v97, v85, s58
  v_perm_b32 v85, v97, v85, s59
  v_mfma_f32_16x16x32_bf16 v[88:91], a[88:91], v[172:175], v[88:91]
  v_accvgpr_write_b32 a225, v55
  v_accvgpr_write_b32 a229, v85
  v_mfma_f32_16x16x32_bf16 v[88:91], a[100:103], a[248:251], v[88:91]
  v_cvt_pk_bf16_f32 v176, v68, v69
  v_cvt_pk_bf16_f32 v177, v70, v71
  v_mfma_f32_16x16x32_bf16 v[88:91], a[112:115], a[244:247], v[88:91]
  v_perm_b32 v54, v98, v86, s58
  v_perm_b32 v86, v98, v86, s59
  v_mfma_f32_16x16x32_bf16 v[88:91], a[124:127], v[152:155], v[88:91]
  v_accvgpr_write_b32 a226, v54
  v_accvgpr_write_b32 a230, v86
  v_mfma_f32_16x16x32_bf16 v[88:91], a[136:139], a[252:255], v[88:91]
  v_perm_b32 v55, v99, v87, s58
  v_perm_b32 v87, v99, v87, s59
  v_mfma_f32_16x16x32_bf16 v[68:71], a[140:143], a[252:255], 0
  v_accvgpr_write_b32 a227, v55
  v_accvgpr_write_b32 a231, v87
  v_mfma_f32_16x16x32_bf16 v[68:71], a[128:131], v[152:155], v[68:71]
  v_perm_b32 v54, v80, v76, s58
  v_perm_b32 v76, v80, v76, s59
  v_mfma_f32_16x16x32_bf16 v[68:71], a[116:119], a[244:247], v[68:71]
  v_cvt_pk_bf16_f32 v178, v88, v89
  v_cvt_pk_bf16_f32 v179, v90, v91
  v_mfma_f32_16x16x32_bf16 v[68:71], a[104:107], a[248:251], v[68:71]
  v_accvgpr_write_b32 a232, v54
  v_accvgpr_write_b32 a236, v76
  v_mfma_f32_16x16x32_bf16 v[68:71], a[92:95], v[172:175], v[68:71]
  v_perm_b32 v55, v81, v77, s58
  v_perm_b32 v77, v81, v77, s59
  v_mfma_f32_16x16x32_bf16 v[68:71], a[80:83], v[168:171], v[68:71]
  v_accvgpr_write_b32 a233, v55
  v_accvgpr_write_b32 a237, v77
  v_mfma_f32_16x16x32_bf16 v[92:95], v[122:125], v[72:75], v[36:39]
  v_perm_b32 v54, v82, v78, s58
  v_perm_b32 v78, v82, v78, s59
  v_mfma_f32_16x16x32_bf16 v[92:95], v[120:123], v[12:15], v[92:95]
  v_accvgpr_write_b32 a234, v54
  v_accvgpr_write_b32 a238, v78
  v_mfma_f32_16x16x32_bf16 v[96:99], v[146:149], v[72:75], v[32:35]
  v_perm_b32 v55, v83, v79, s58
  v_perm_b32 v79, v83, v79, s59
  v_mfma_f32_16x16x32_bf16 v[96:99], v[144:147], v[12:15], v[96:99]
  v_accvgpr_write_b32 a235, v55
  v_accvgpr_write_b32 a239, v79
  v_mfma_f32_16x16x32_bf16 v[104:107], v[134:137], v[72:75], v[28:31]
  v_cvt_pk_bf16_f32 v180, v68, v69
  v_cvt_pk_bf16_f32 v181, v70, v71
  v_mfma_f32_16x16x32_bf16 v[104:107], v[132:135], v[12:15], v[104:107]
  v_exp_f32 v92, v92
  v_mfma_f32_16x16x32_bf16 v[140:143], v[178:181], v[72:75], v[24:27]
  s_lshr_b32 s44, s2, 3
  v_exp_f32 v93, v93
  v_mfma_f32_16x16x32_bf16 v[140:143], v[176:179], v[12:15], v[140:143]
  s_lshl_b32 s44, s44, 9
  v_exp_f32 v94, v94
  v_mfma_f32_16x16x32_bf16 v[84:87], v[120:123], v[128:131], v[40:43]
  s_add_u32 s44, s44, 1048576
  v_exp_f32 v95, v95
  v_mfma_f32_16x16x32_bf16 v[84:87], v[122:125], v[14:17], v[84:87]
  s_mov_b32 s45, 0
  v_exp_f32 v96, v96
  v_mfma_f32_16x16x32_bf16 v[88:91], v[144:147], v[128:131], v[36:39]
  s_mov_b32 s59, 0
  v_exp_f32 v97, v97
  v_mfma_f32_16x16x32_bf16 v[88:91], v[146:149], v[14:17], v[88:91]
  s_mov_b32 s58, 0
  v_exp_f32 v98, v98
  v_mfma_f32_16x16x32_bf16 v[68:71], v[132:135], v[128:131], v[32:35]
  s_mov_b64 s[12:13], 0
  v_exp_f32 v99, v99
  v_mfma_f32_16x16x32_bf16 v[68:71], v[134:137], v[14:17], v[68:71]
  s_mov_b64 s[16:17], 0
  v_exp_f32 v104, v104
  v_mfma_f32_16x16x32_bf16 v[72:75], v[176:179], v[128:131], v[28:31]
  s_mov_b64 s[18:19], 0
  v_exp_f32 v105, v105
  v_mfma_f32_16x16x32_bf16 v[72:75], v[178:181], v[14:17], v[72:75]
  s_mov_b64 s[60:61], 0
  v_exp_f32 v106, v106
  v_mfma_f32_16x16x32_bf16 v[76:79], v[134:137], v[100:103], v[36:39]
  s_mov_b32 s15, 0
  v_exp_f32 v107, v107
  v_mfma_f32_16x16x32_bf16 v[76:79], v[132:135], v[18:21], v[76:79]
  s_mov_b32 s99, 0
  v_exp_f32 v140, v140
  v_mfma_f32_16x16x32_bf16 v[80:83], v[178:181], v[100:103], v[32:35]
  s_mov_b64 s[100:101], 0
  v_exp_f32 v141, v141
  v_mfma_f32_16x16x32_bf16 v[80:83], v[176:179], v[18:21], v[80:83]
  s_mov_b32 s14, 0
  v_exp_f32 v142, v142
  v_mfma_f32_16x16x32_bf16 v[160:163], v[122:125], v[100:103], v[44:47]
  v_exp_f32 v143, v143
  v_mfma_f32_16x16x32_bf16 v[160:163], v[120:123], v[18:21], v[160:163]
  v_cvt_pk_bf16_f32 v92, v92, v93
  v_cvt_pk_bf16_f32 v93, v94, v95
  v_mfma_f32_16x16x32_bf16 v[156:159], v[146:149], v[100:103], v[40:43]
  v_cvt_pk_bf16_f32 v94, v96, v97
  v_cvt_pk_bf16_f32 v95, v98, v99
  v_mfma_f32_16x16x32_bf16 v[156:159], v[144:147], v[18:21], v[156:159]
  v_cvt_pk_bf16_f32 v96, v104, v105
  v_cvt_pk_bf16_f32 v97, v106, v107
  v_mfma_f32_16x16x32_bf16 v[128:131], a[0:3], v[168:171], 0
  v_cvt_pk_bf16_f32 v98, v140, v141
  v_cvt_pk_bf16_f32 v99, v142, v143
  v_mfma_f32_16x16x32_bf16 v[128:131], a[12:15], v[172:175], v[128:131]
  v_exp_f32 v84, v84
  v_mfma_f32_16x16x32_bf16 v[128:131], a[24:27], a[248:251], v[128:131]
  v_exp_f32 v85, v85
  v_mfma_f32_16x16x32_bf16 v[128:131], a[36:39], a[244:247], v[128:131]
  v_exp_f32 v86, v86
  v_mfma_f32_16x16x32_bf16 v[128:131], a[48:51], v[152:155], v[128:131]
  v_exp_f32 v87, v87
  v_mfma_f32_16x16x32_bf16 v[128:131], a[60:63], a[252:255], v[128:131]
  v_exp_f32 v88, v88
  v_mfma_f32_16x16x32_bf16 v[100:103], a[64:67], a[252:255], 0
  v_exp_f32 v89, v89
  v_mfma_f32_16x16x32_bf16 v[100:103], a[52:55], v[152:155], v[100:103]
  v_exp_f32 v90, v90
  v_mfma_f32_16x16x32_bf16 v[100:103], a[40:43], a[244:247], v[100:103]
  v_exp_f32 v91, v91
  v_mfma_f32_16x16x32_bf16 v[100:103], a[28:31], a[248:251], v[100:103]
  v_mul_f32 v128, s42, v128
  v_mul_f32 v129, s42, v129
  v_mfma_f32_16x16x32_bf16 v[100:103], a[16:19], v[172:175], v[100:103]
  v_mul_f32 v130, s42, v130
  v_mul_f32 v131, s42, v131
  v_mfma_f32_16x16x32_bf16 v[100:103], a[4:7], v[168:171], v[100:103]
  v_cvt_pk_bf16_f32 v140, v128, v129
  v_cvt_pk_bf16_f32 v141, v130, v131
  v_mfma_f32_16x16x32_bf16 v[104:107], a[8:11], v[168:171], 0
  v_exp_f32 v68, v68
  v_mfma_f32_16x16x32_bf16 v[104:107], a[20:23], v[172:175], v[104:107]
  v_exp_f32 v69, v69
  v_mfma_f32_16x16x32_bf16 v[104:107], a[32:35], a[248:251], v[104:107]
  v_exp_f32 v70, v70
  v_mfma_f32_16x16x32_bf16 v[104:107], a[44:47], a[244:247], v[104:107]
  v_mul_f32 v100, s42, v100
  v_mul_f32 v101, s42, v101
  v_mfma_f32_16x16x32_bf16 v[104:107], a[56:59], v[152:155], v[104:107]
  v_mul_f32 v102, s42, v102
  v_mul_f32 v103, s42, v103
  v_mfma_f32_16x16x32_bf16 v[104:107], a[68:71], a[252:255], v[104:107]
  v_cvt_pk_bf16_f32 v142, v100, v101
  v_cvt_pk_bf16_f32 v143, v102, v103
  v_mfma_f32_16x16x32_bf16 v[128:131], v[168:171], a[144:147], 0
  v_exp_f32 v71, v71
  v_mfma_f32_16x16x32_bf16 v[128:131], v[172:175], a[156:159], v[128:131]
  v_exp_f32 v72, v72
  v_mfma_f32_16x16x32_bf16 v[128:131], a[248:251], a[168:171], v[128:131]
  v_mul_f32 v104, s42, v104
  v_mul_f32 v105, s42, v105
  v_mfma_f32_16x16x32_bf16 v[128:131], a[244:247], a[180:183], v[128:131]
  v_mul_f32 v106, s42, v106
  v_mul_f32 v107, s42, v107
  v_cvt_pk_bf16_f32 v22, v104, v105
  v_cvt_pk_bf16_f32 v23, v106, v107
  v_mfma_f32_16x16x32_bf16 v[128:131], v[152:155], a[192:195], v[128:131]
  s_waitcnt vmcnt(6) lgkmcnt(0)
  s_barrier
  v_mfma_f32_16x16x32_bf16 v[128:131], a[252:255], a[204:207], v[128:131]
  v_exp_f32 v73, v73
  v_mfma_f32_16x16x32_bf16 v[100:103], v[132:135], v[140:143], v[40:43]
  v_exp_f32 v74, v74
  v_mfma_f32_16x16x32_bf16 v[100:103], v[134:137], v[20:23], v[100:103]
  v_exp_f32 v75, v75
  v_mfma_f32_16x16x32_bf16 v[104:107], v[176:179], v[140:143], v[36:39]
  v_cvt_pk_bf16_f32 v84, v84, v85
  v_cvt_pk_bf16_f32 v85, v86, v87
  v_mfma_f32_16x16x32_bf16 v[104:107], v[178:181], v[20:23], v[104:107]
  v_cvt_pk_bf16_f32 v110, v128, v129
  v_cvt_pk_bf16_f32 v111, v130, v131
  v_mfma_f32_16x16x32_bf16 v[132:135], v[120:123], v[140:143], v[48:51]
  v_cvt_pk_bf16_f32 v86, v88, v89
  v_cvt_pk_bf16_f32 v87, v90, v91
  v_mfma_f32_16x16x32_bf16 v[132:135], v[122:125], v[20:23], v[132:135]
  v_cvt_pk_bf16_f32 v88, v68, v69
  v_cvt_pk_bf16_f32 v89, v70, v71
  v_mfma_f32_16x16x32_bf16 v[128:131], v[144:147], v[140:143], v[44:47]
  v_cvt_pk_bf16_f32 v90, v72, v73
  v_cvt_pk_bf16_f32 v91, v74, v75
  v_mfma_f32_16x16x32_bf16 v[128:131], v[146:149], v[20:23], v[128:131]
  ds_read_b128 v[136:139], v3 offset:0
  ds_read_b128 v[140:143], v3 offset:4096
  v_mfma_f32_16x16x32_bf16 v[176:179], a[252:255], a[208:211], 0
  ds_read_b128 v[68:71], v3 offset:8192
  ds_read_b128 v[72:75], v3 offset:12288
  v_mfma_f32_16x16x32_bf16 v[176:179], v[152:155], a[196:199], v[176:179]
  ds_read_b128 v[120:123], v3 offset:16384
  ds_read_b128 v[124:127], v3 offset:20480
  v_mfma_f32_16x16x32_bf16 v[176:179], a[244:247], a[184:187], v[176:179]
  v_exp_f32 v76, v76
  v_mfma_f32_16x16x32_bf16 v[176:179], a[248:251], a[172:175], v[176:179]
  v_exp_f32 v77, v77
  v_mfma_f32_16x16x32_bf16 v[176:179], v[172:175], a[160:163], v[176:179]
  v_exp_f32 v78, v78
  v_mfma_f32_16x16x32_bf16 v[176:179], v[168:171], a[148:151], v[176:179]
  v_exp_f32 v79, v79
  v_mfma_f32_16x16x32_bf16 v[164:167], v[168:171], a[152:155], 0
  v_exp_f32 v80, v80
  v_mfma_f32_16x16x32_bf16 v[164:167], v[172:175], a[164:167], v[164:167]
  v_exp_f32 v81, v81
  v_mfma_f32_16x16x32_bf16 v[164:167], a[248:251], a[176:179], v[164:167]
  v_exp_f32 v82, v82
  v_mfma_f32_16x16x32_bf16 v[164:167], a[244:247], a[188:191], v[164:167]
  v_exp_f32 v83, v83
  v_mfma_f32_16x16x32_bf16 v[164:167], v[152:155], a[200:203], v[164:167]
  v_cvt_pk_bf16_f32 v114, v176, v177
  v_cvt_pk_bf16_f32 v115, v178, v179
  v_mfma_f32_16x16x32_bf16 v[164:167], a[252:255], a[212:215], v[164:167]
L_hop_2_0:
  s_cbranch_execz L_hop_2_1
  v_add_u32 v0, s28, v2
  v_xor_b32 v1, 64, v0
  s_waitcnt lgkmcnt(0)
  s_nop 1
L_loop:
  v_mfma_f32_16x16x32_bf16 v[148:151], v[136:139], v[184:187], 0
  v_exp_f32 v160, v160
  v_mfma_f32_16x16x32_bf16 v[148:151], v[140:143], v[200:203], v[148:151]
  v_exp_f32 v161, v161
  v_mfma_f32_16x16x32_bf16 v[148:151], v[68:71], v[216:219], v[148:151]
  v_cvt_pk_bf16_f32 v118, v164, v165
  v_cvt_pk_bf16_f32 v119, v166, v167
  v_mfma_f32_16x16x32_bf16 v[148:151], v[72:75], v[232:235], v[148:151]
  v_exp_f32 v162, v162
  v_mfma_f32_16x16x32_bf16 v[148:151], v[120:123], v[248:251], v[148:151]
  v_exp_f32 v163, v163
  v_mfma_f32_16x16x32_bf16 v[148:151], v[124:127], a[224:227], v[148:151]
  v_exp_f32 v156, v156
  v_mfma_f32_16x16x32_bf16 v[172:175], v[124:127], a[228:231], 0
  v_exp_f32 v157, v157
  v_mfma_f32_16x16x32_bf16 v[172:175], v[120:123], v[252:255], v[172:175]
  v_exp_f32 v158, v158
  v_mfma_f32_16x16x32_bf16 v[172:175], v[72:75], v[236:239], v[172:175]
  ds_read_b128 v[144:147], v4 offset:0
  v_cvt_pk_bf16_f32 v76, v76, v77
  v_mfma_f32_16x16x32_bf16 v[172:175], v[68:71], v[220:223], v[172:175]
  ds_read_b128 v[176:179], v4 offset:4096
  v_cvt_pk_bf16_f32 v77, v78, v79
  v_mfma_f32_16x16x32_bf16 v[172:175], v[140:143], v[204:207], v[172:175]
  ds_read_b128 v[152:155], v4 offset:8192
  v_cvt_pk_bf16_f32 v78, v80, v81
  v_mfma_f32_16x16x32_bf16 v[172:175], v[136:139], v[188:191], v[172:175]
  ds_read_b128 v[180:183], v4 offset:12288
  v_cvt_pk_bf16_f32 v79, v82, v83
  v_mfma_f32_16x16x32_bf16 v[168:171], v[136:139], v[192:195], 0
  ds_read_b128 v[164:167], v4 offset:16384
  v_cvt_pk_bf16_f32 v80, v160, v161
  v_mfma_f32_16x16x32_bf16 v[168:171], v[140:143], v[208:211], v[168:171]
  ds_read_b128 a[252:255], v4 offset:20480
  v_cvt_pk_bf16_f32 v81, v162, v163
  v_mfma_f32_16x16x32_bf16 v[168:171], v[68:71], v[224:227], v[168:171]
  v_cvt_pk_bf16_f32 v148, v148, v172
  v_cvt_pk_bf16_f32 v149, v149, v173
  v_mfma_f32_16x16x32_bf16 v[168:171], v[72:75], v[240:243], v[168:171]
  v_cvt_pk_bf16_f32 v150, v150, v174
  v_cvt_pk_bf16_f32 v151, v151, v175
  v_mfma_f32_16x16x32_bf16 v[168:171], v[120:123], a[216:219], v[168:171]
  buffer_store_dword v148, v7, s[24:27], s33 offen offset:0 nt
  v_mfma_f32_16x16x32_bf16 v[168:171], v[124:127], a[232:235], v[168:171]
  v_exp_f32 v159, v159
  v_mfma_f32_16x16x32_bf16 v[160:163], v[124:127], a[236:239], 0
  v_cvt_pk_bf16_f32 v82, v156, v157
  v_cvt_pk_bf16_f32 v83, v158, v159
  v_mfma_f32_16x16x32_bf16 v[160:163], v[120:123], a[220:223], v[160:163]
  buffer_store_dword v149, v7, s[24:27], s33 offen offset:384 nt
  v_mfma_f32_16x16x32_bf16 v[160:163], v[72:75], v[244:247], v[160:163]
  ds_read_b128 a[244:247], v3 offset:512
  v_mfma_f32_16x16x32_bf16 v[160:163], v[68:71], v[228:231], v[160:163]
  ds_read_b128 a[248:251], v3 offset:4608
  v_mfma_f32_16x16x32_bf16 v[160:163], v[140:143], v[212:215], v[160:163]
  buffer_store_dword v150, v7, s[24:27], s33 offen offset:768 nt
  v_mfma_f32_16x16x32_bf16 v[160:163], v[136:139], v[196:199], v[160:163]
  s_waitcnt lgkmcnt(2)
  ds_read_b128 v[172:175], v3 offset:8704
  v_mfma_f32_16x16x32_bf16 v[124:127], v[144:147], v[184:187], 0
  ds_read_b128 v[68:71], v3 offset:12800
  v_mfma_f32_16x16x32_bf16 v[124:127], v[176:179], v[200:203], v[124:127]
  buffer_store_dword v151, v7, s[24:27], s33 offen offset:1152 nt
  v_mfma_f32_16x16x32_bf16 v[124:127], v[152:155], v[216:219], v[124:127]
  v_cvt_pk_bf16_f32 v168, v168, v160
  v_cvt_pk_bf16_f32 v169, v169, v161
  v_mfma_f32_16x16x32_bf16 v[124:127], v[180:183], v[232:235], v[124:127]
  v_cvt_pk_bf16_f32 v170, v170, v162
  v_cvt_pk_bf16_f32 v171, v171, v163
  v_mfma_f32_16x16x32_bf16 v[124:127], v[164:167], v[248:251], v[124:127]
  buffer_store_dword v168, v8, s[24:27], s33 offen offset:0 nt
  v_mfma_f32_16x16x32_bf16 v[124:127], a[252:255], a[224:227], v[124:127]
  ds_read_b128 v[72:75], v3 offset:16896
  v_mfma_f32_16x16x32_bf16 v[120:123], a[252:255], a[228:231], 0
  ds_read_b128 v[148:151], v3 offset:20992
  v_xor_b32 v3, 40960, v3
  v_mfma_f32_16x16x32_bf16 v[120:123], v[164:167], v[252:255], v[120:123]
  buffer_store_dword v169, v8, s[24:27], s33 offen offset:384 nt
  v_mfma_f32_16x16x32_bf16 v[120:123], v[180:183], v[236:239], v[120:123]
  v_exp_f32 v100, v100
  v_mfma_f32_16x16x32_bf16 v[120:123], v[152:155], v[220:223], v[120:123]
  v_exp_f32 v101, v101
  v_mfma_f32_16x16x32_bf16 v[120:123], v[176:179], v[204:207], v[120:123]
  buffer_store_dword v170, v8, s[24:27], s33 offen offset:768 nt
  v_mfma_f32_16x16x32_bf16 v[120:123], v[144:147], v[188:191], v[120:123]
  s_waitcnt lgkmcnt(0)
  v_exp_f32 v102, v102
  v_mfma_f32_16x16x32_bf16 v[136:139], a[244:247], v[184:187], 0
  v_exp_f32 v103, v103
  v_mfma_f32_16x16x32_bf16 v[136:139], a[248:251], v[200:203], v[136:139]
  buffer_store_dword v171, v8, s[24:27], s33 offen offset:1152 nt
  v_mfma_f32_16x16x32_bf16 v[136:139], v[172:175], v[216:219], v[136:139]
  v_cvt_pk_bf16_f32 v124, v124, v120
  v_cvt_pk_bf16_f32 v125, v125, v121
  v_mfma_f32_16x16x32_bf16 v[136:139], v[68:71], v[232:235], v[136:139]
  v_cvt_pk_bf16_f32 v126, v126, v122
  v_cvt_pk_bf16_f32 v127, v127, v123
  v_mfma_f32_16x16x32_bf16 v[136:139], v[72:75], v[248:251], v[136:139]
  buffer_store_dword v124, v7, s[24:27], s34 offen offset:0 nt
  v_mfma_f32_16x16x32_bf16 v[136:139], v[148:151], a[224:227], v[136:139]
  v_exp_f32 v104, v104
  v_mfma_f32_16x16x32_bf16 v[160:163], v[148:151], a[228:231], 0
  v_exp_f32 v105, v105
  v_mfma_f32_16x16x32_bf16 v[160:163], v[72:75], v[252:255], v[160:163]
  buffer_store_dword v125, v7, s[24:27], s34 offen offset:384 nt
  v_mfma_f32_16x16x32_bf16 v[160:163], v[68:71], v[236:239], v[160:163]
  ds_read_b128 v[120:123], v4 offset:512
  v_cvt_pk_bf16_f32 v100, v100, v101
  v_mfma_f32_16x16x32_bf16 v[160:163], v[172:175], v[220:223], v[160:163]
  ds_read_b128 v[140:143], v4 offset:4608
  v_cvt_pk_bf16_f32 v101, v102, v103
  v_mfma_f32_16x16x32_bf16 v[160:163], a[248:251], v[204:207], v[160:163]
  buffer_store_dword v126, v7, s[24:27], s34 offen offset:768 nt
  v_mfma_f32_16x16x32_bf16 v[160:163], a[244:247], v[188:191], v[160:163]
  ds_read_b128 v[152:155], v4 offset:8704
  v_cvt_pk_bf16_f32 v102, v104, v105
  v_mfma_f32_16x16x32_bf16 v[144:147], a[244:247], v[192:195], 0
  ds_read_b128 v[156:159], v4 offset:12800
  v_mfma_f32_16x16x32_bf16 v[144:147], a[248:251], v[208:211], v[144:147]
  buffer_store_dword v127, v7, s[24:27], s34 offen offset:1152 nt
  v_mfma_f32_16x16x32_bf16 v[144:147], v[172:175], v[224:227], v[144:147]
  v_cvt_pk_bf16_f32 v136, v136, v160
  v_cvt_pk_bf16_f32 v137, v137, v161
  v_mfma_f32_16x16x32_bf16 v[144:147], v[68:71], v[240:243], v[144:147]
  v_cvt_pk_bf16_f32 v138, v138, v162
  v_cvt_pk_bf16_f32 v139, v139, v163
  v_mfma_f32_16x16x32_bf16 v[144:147], v[72:75], a[216:219], v[144:147]
  buffer_store_dword v136, v7, s[24:27], s35 offen offset:0 nt
  v_mfma_f32_16x16x32_bf16 v[144:147], v[148:151], a[232:235], v[144:147]
  ds_read_b128 v[160:163], v4 offset:16896
  v_mfma_f32_16x16x32_bf16 v[168:171], v[148:151], a[236:239], 0
  ds_read_b128 v[164:167], v4 offset:20992
  v_xor_b32 v4, 40960, v4
  v_mfma_f32_16x16x32_bf16 v[168:171], v[72:75], a[220:223], v[168:171]
  buffer_store_dword v137, v7, s[24:27], s35 offen offset:384 nt
  v_mfma_f32_16x16x32_bf16 v[168:171], v[68:71], v[244:247], v[168:171]
  v_exp_f32 v106, v106
  v_mfma_f32_16x16x32_bf16 v[168:171], v[172:175], v[228:231], v[168:171]
  v_exp_f32 v107, v107
  v_mfma_f32_16x16x32_bf16 v[168:171], a[248:251], v[212:215], v[168:171]
  buffer_store_dword v138, v7, s[24:27], s35 offen offset:768 nt
  v_mfma_f32_16x16x32_bf16 v[168:171], a[244:247], v[196:199], v[168:171]
  s_waitcnt lgkmcnt(0)
  v_exp_f32 v132, v132
  v_mfma_f32_16x16x32_bf16 v[124:127], v[120:123], v[184:187], 0
  v_exp_f32 v133, v133
  v_mfma_f32_16x16x32_bf16 v[124:127], v[140:143], v[200:203], v[124:127]
  buffer_store_dword v139, v7, s[24:27], s35 offen offset:1152 nt
  v_mfma_f32_16x16x32_bf16 v[124:127], v[152:155], v[216:219], v[124:127]
  v_cvt_pk_bf16_f32 v144, v144, v168
  v_cvt_pk_bf16_f32 v145, v145, v169
  v_mfma_f32_16x16x32_bf16 v[124:127], v[156:159], v[232:235], v[124:127]
  v_cvt_pk_bf16_f32 v146, v146, v170
  v_cvt_pk_bf16_f32 v147, v147, v171
  v_mfma_f32_16x16x32_bf16 v[124:127], v[160:163], v[248:251], v[124:127]
  buffer_store_dword v144, v8, s[24:27], s35 offen offset:0 nt
  v_mfma_f32_16x16x32_bf16 v[124:127], v[164:167], a[224:227], v[124:127]
  v_mov_b64 v[172:173], 0
  v_cvt_pk_bf16_f32 v103, v106, v107
  v_mfma_f32_16x16x32_bf16 v[136:139], v[164:167], a[228:231], 0
  v_exp_f32 v134, v134
  v_mfma_f32_16x16x32_bf16 v[136:139], v[160:163], v[252:255], v[136:139]
  buffer_store_dword v145, v8, s[24:27], s35 offen offset:384 nt
  v_mfma_f32_16x16x32_bf16 v[136:139], v[156:159], v[236:239], v[136:139]
  v_exp_f32 v135, v135
  v_mfma_f32_16x16x32_bf16 v[136:139], v[152:155], v[220:223], v[136:139]
  v_mov_b64 v[72:73], 0
  v_cvt_pk_bf16_f32 v104, v132, v133
  v_mfma_f32_16x16x32_bf16 v[136:139], v[140:143], v[204:207], v[136:139]
  buffer_store_dword v146, v8, s[24:27], s35 offen offset:768 nt
  v_mfma_f32_16x16x32_bf16 v[136:139], v[120:123], v[188:191], v[136:139]
  v_exp_f32 v128, v128
  v_smfmac_f32_16x16x64_bf16 v[172:175], a[240:243], v[92:99], v10
  v_exp_f32 v129, v129
  v_mfma_f32_16x16x32_bf16 v[176:179], v[108:111], v[96:99], 0
  buffer_store_dword v147, v8, s[24:27], s35 offen offset:1152 nt
  v_mfma_f32_16x16x32_bf16 v[176:179], v[56:59], v[92:95], v[176:179]
  v_cvt_pk_bf16_f32 v124, v124, v136
  v_cvt_pk_bf16_f32 v125, v125, v137
  v_mfma_f32_16x16x32_bf16 v[68:71], v[60:63], v[92:95], 0
  v_cvt_pk_bf16_f32 v126, v126, v138
  v_cvt_pk_bf16_f32 v127, v127, v139
  v_mfma_f32_16x16x32_bf16 v[68:71], v[112:115], v[96:99], v[68:71]
  buffer_store_dword v124, v7, s[24:27], s36 offen offset:0 nt
  v_mfma_f32_16x16x32_bf16 v[168:171], v[116:119], v[96:99], 0
  v_mov_b64 v[132:133], 0
  v_cvt_pk_bf16_f32 v105, v134, v135
  v_mfma_f32_16x16x32_bf16 v[168:171], v[64:67], v[92:95], v[168:171]
  v_exp_f32 v130, v130
  v_smfmac_f32_16x16x64_bf16 v[72:75], a[240:243], v[84:91], v10
  buffer_store_dword v125, v7, s[24:27], s36 offen offset:384 nt
  v_mfma_f32_16x16x32_bf16 v[160:163], v[108:111], v[88:91], 0
  v_exp_f32 v131, v131
  v_mfma_f32_16x16x32_bf16 v[160:163], v[56:59], v[84:87], v[160:163]
  v_cvt_pk_bf16_f32 v106, v128, v129
  v_cvt_pk_bf16_f32 v107, v130, v131
  v_mfma_f32_16x16x32_bf16 v[164:167], v[60:63], v[84:87], 0
  buffer_store_dword v126, v7, s[24:27], s36 offen offset:768 nt
  v_mfma_f32_16x16x32_bf16 v[164:167], v[112:115], v[88:91], v[164:167]
  v_mov_b64 v[92:93], 0
  v_add_f32 v172, v172, v173
  v_mfma_f32_16x16x32_bf16 v[156:159], v[116:119], v[88:91], 0
  ds_read_b128 v[128:131], v0 offset:0
  v_add_f32 v72, v72, v73
  v_mfma_f32_16x16x32_bf16 v[156:159], v[64:67], v[84:87], v[156:159]
  buffer_store_dword v127, v7, s[24:27], s36 offen offset:1152 nt
  v_smfmac_f32_16x16x64_bf16 v[132:135], a[240:243], v[76:83], v10
  ds_read_b128 v[144:147], v1 offset:0
  v_cndmask_b32 v7, v7, v52, s[62:63]
  v_mfma_f32_16x16x32_bf16 v[120:123], v[56:59], v[80:83], 0
  ds_read_b128 v[148:151], v0 offset:8192
  v_cndmask_b32 v8, v8, v53, s[62:63]
  v_mfma_f32_16x16x32_bf16 v[120:123], v[108:111], v[76:79], v[120:123]
  s_mov_b64 s[62:63], 0
  ds_read_b128 v[152:155], v1 offset:8192
  v_mfma_f32_16x16x32_bf16 v[124:127], v[112:115], v[76:79], 0
  ds_read_b128 v[140:143], v0 offset:16384
  v_mfma_f32_16x16x32_bf16 v[124:127], v[60:63], v[80:83], v[124:127]
  ds_read_b128 v[136:139], v1 offset:16384
  v_mfma_f32_16x16x32_bf16 v[96:99], v[64:67], v[80:83], 0
  v_rcp_f32 v174, v172
  v_mfma_f32_16x16x32_bf16 v[96:99], v[116:119], v[76:79], v[96:99]
  v_mul_f32 v176, v174, v176
  v_mul_f32 v177, v174, v177
  v_smfmac_f32_16x16x64_bf16 v[92:95], a[240:243], v[100:107], v10
  v_mul_f32 v178, v174, v178
  v_mul_f32 v179, v174, v179
  v_mfma_f32_16x16x32_bf16 v[84:87], v[56:59], v[104:107], 0
  v_cvt_pk_bf16_f32 v176, v176, v177
  v_cvt_pk_bf16_f32 v177, v178, v179
  v_mfma_f32_16x16x32_bf16 v[84:87], v[108:111], v[100:103], v[84:87]
  v_mul_f32 v68, v174, v68
  v_mul_f32 v69, v174, v69
  v_mfma_f32_16x16x32_bf16 v[80:83], v[112:115], v[100:103], 0
  v_mul_f32 v70, v174, v70
  v_mul_f32 v71, v174, v71
  v_mfma_f32_16x16x32_bf16 v[80:83], v[60:63], v[104:107], v[80:83]
  v_cvt_pk_bf16_f32 v68, v68, v69
  v_cvt_pk_bf16_f32 v69, v70, v71
  v_mfma_f32_16x16x32_bf16 v[88:91], v[64:67], v[104:107], 0
  v_mul_f32 v168, v174, v168
  v_mul_f32 v169, v174, v169
  v_mfma_f32_16x16x32_bf16 v[88:91], v[116:119], v[100:103], v[88:91]
  s_waitcnt lgkmcnt(0)
  v_mul_f32 v170, v174, v170
  v_mul_f32 v171, v174, v171
  v_mfma_f32_16x16x32_bf16 v[64:67], a[0:3], v[128:131], 0
  v_cvt_pk_bf16_f32 v168, v168, v169
  v_cvt_pk_bf16_f32 v169, v170, v171
  v_mfma_f32_16x16x32_bf16 v[64:67], a[12:15], v[144:147], v[64:67]
  v_max3_f32 v9, v172, v174, v9
  v_add_f32 v132, v132, v133
  v_mfma_f32_16x16x32_bf16 v[64:67], a[24:27], v[148:151], v[64:67]
  ds_write_b32 v5, v176 offset:0
  v_mfma_f32_16x16x32_bf16 v[64:67], a[36:39], v[152:155], v[64:67]
  ds_write_b32 v5, v177 offset:1024
  v_mfma_f32_16x16x32_bf16 v[64:67], a[48:51], v[140:143], v[64:67]
  s_add_u32 m0, s30, 0
  v_rcp_f32 v74, v72
  v_mfma_f32_16x16x32_bf16 v[64:67], a[60:63], v[136:139], v[64:67]
  buffer_load_dwordx4 v6, s[8:11], s31 offen offset:0 nt lds
  v_mfma_f32_16x16x32_bf16 v[60:63], a[64:67], v[136:139], 0
  v_mul_f32 v160, v74, v160
  v_mul_f32 v161, v74, v161
  v_mfma_f32_16x16x32_bf16 v[60:63], a[52:55], v[140:143], v[60:63]
  ds_write_b32 v5, v68 offset:2048
  v_mfma_f32_16x16x32_bf16 v[60:63], a[40:43], v[152:155], v[60:63]
  v_mul_f32 v64, s42, v64
  v_mul_f32 v65, s42, v65
  v_mfma_f32_16x16x32_bf16 v[60:63], a[28:31], v[148:151], v[60:63]
  v_mul_f32 v66, s42, v66
  v_mul_f32 v67, s42, v67
  v_mfma_f32_16x16x32_bf16 v[60:63], a[16:19], v[144:147], v[60:63]
  v_cvt_pk_bf16_f32 v12, v64, v65
  v_cvt_pk_bf16_f32 v13, v66, v67
  v_mfma_f32_16x16x32_bf16 v[60:63], a[4:7], v[128:131], v[60:63]
  ds_write_b32 v5, v69 offset:3072
  v_mfma_f32_16x16x32_bf16 v[56:59], a[8:11], v[128:131], 0
  ds_write_b32 v5, v168 offset:4096
  v_mfma_f32_16x16x32_bf16 v[56:59], a[20:23], v[144:147], v[56:59]
  ds_write_b32 v5, v169 offset:5120
  v_mfma_f32_16x16x32_bf16 v[56:59], a[32:35], v[148:151], v[56:59]
  v_mul_f32 v60, s42, v60
  v_mul_f32 v61, s42, v61
  v_mfma_f32_16x16x32_bf16 v[56:59], a[44:47], v[152:155], v[56:59]
  v_mul_f32 v62, s42, v62
  v_mul_f32 v63, s42, v63
  v_mfma_f32_16x16x32_bf16 v[56:59], a[56:59], v[140:143], v[56:59]
  s_add_u32 m0, s30, 8064
  v_cvt_pk_bf16_f32 v76, v60, v61
  v_cvt_pk_bf16_f32 v77, v62, v63
  v_mfma_f32_16x16x32_bf16 v[56:59], a[68:71], v[136:139], v[56:59]
  buffer_load_dwordx4 v6, s[8:11], s31 offen offset:128 nt lds
  v_mfma_f32_16x16x32_bf16 v[64:67], a[132:135], v[136:139], 0
  v_mul_f32 v162, v74, v162
  v_mul_f32 v163, v74, v163
  v_mfma_f32_16x16x32_bf16 v[64:67], a[120:123], v[140:143], v[64:67]
  v_cvt_pk_bf16_f32 v160, v160, v161
  v_cvt_pk_bf16_f32 v161, v162, v163
  v_mfma_f32_16x16x32_bf16 v[64:67], a[108:111], v[152:155], v[64:67]
  v_mul_f32 v56, s42, v56
  v_mul_f32 v57, s42, v57
  v_mfma_f32_16x16x32_bf16 v[64:67], a[96:99], v[148:151], v[64:67]
  v_mul_f32 v58, s42, v58
  v_mul_f32 v59, s42, v59
  v_mfma_f32_16x16x32_bf16 v[64:67], a[84:87], v[144:147], v[64:67]
  v_cvt_pk_bf16_f32 v78, v56, v57
  v_cvt_pk_bf16_f32 v79, v58, v59
  v_mfma_f32_16x16x32_bf16 v[64:67], a[72:75], v[128:131], v[64:67]
  v_mul_f32 v164, v74, v164
  v_mul_f32 v165, v74, v165
  v_mfma_f32_16x16x32_bf16 v[56:59], a[76:79], v[128:131], 0
  v_mul_f32 v166, v74, v166
  v_mul_f32 v167, v74, v167
  v_mfma_f32_16x16x32_bf16 v[56:59], a[88:91], v[144:147], v[56:59]
  v_cvt_pk_bf16_f32 v164, v164, v165
  v_cvt_pk_bf16_f32 v165, v166, v167
  v_mfma_f32_16x16x32_bf16 v[56:59], a[100:103], v[148:151], v[56:59]
  v_cvt_pk_bf16_f32 v68, v64, v65
  v_cvt_pk_bf16_f32 v69, v66, v67
  v_mfma_f32_16x16x32_bf16 v[56:59], a[112:115], v[152:155], v[56:59]
  v_mul_f32 v156, v74, v156
  v_mul_f32 v157, v74, v157
  v_mfma_f32_16x16x32_bf16 v[56:59], a[124:127], v[140:143], v[56:59]
  s_add_u32 m0, s30, 16128
  v_mul_f32 v158, v74, v158
  v_mul_f32 v159, v74, v159
  v_mfma_f32_16x16x32_bf16 v[56:59], a[136:139], v[136:139], v[56:59]
  buffer_load_dwordx4 v6, s[8:11], s31 offen offset:256 nt lds
  v_mfma_f32_16x16x32_bf16 v[60:63], a[140:143], v[136:139], 0
  v_cvt_pk_bf16_f32 v156, v156, v157
  v_cvt_pk_bf16_f32 v157, v158, v159
  v_mfma_f32_16x16x32_bf16 v[60:63], a[128:131], v[140:143], v[60:63]
  v_max3_f32 v9, v72, v74, v9
  v_add_f32 v92, v92, v93
  v_mfma_f32_16x16x32_bf16 v[60:63], a[116:119], v[152:155], v[60:63]
  v_cvt_pk_bf16_f32 v70, v56, v57
  v_cvt_pk_bf16_f32 v71, v58, v59
  v_mfma_f32_16x16x32_bf16 v[60:63], a[104:107], v[148:151], v[60:63]
  ds_write_b32 v5, v160 offset:256
  v_mfma_f32_16x16x32_bf16 v[60:63], a[92:95], v[144:147], v[60:63]
  ds_write_b32 v5, v161 offset:1280
  v_mfma_f32_16x16x32_bf16 v[60:63], a[80:83], v[128:131], v[60:63]
  ds_write_b32 v5, v164 offset:2304
  v_mfma_f32_16x16x32_bf16 v[64:67], v[128:131], a[144:147], 0
  ds_write_b32 v5, v165 offset:3328
  v_mfma_f32_16x16x32_bf16 v[64:67], v[144:147], a[156:159], v[64:67]
  ds_write_b32 v5, v156 offset:4352
  v_mfma_f32_16x16x32_bf16 v[64:67], v[148:151], a[168:171], v[64:67]
  v_cvt_pk_bf16_f32 v72, v60, v61
  v_cvt_pk_bf16_f32 v73, v62, v63
  v_mfma_f32_16x16x32_bf16 v[64:67], v[152:155], a[180:183], v[64:67]
  ds_read_b128 a[244:247], v0 offset:2048
  v_mfma_f32_16x16x32_bf16 v[64:67], v[140:143], a[192:195], v[64:67]
  s_add_u32 m0, s30, 4096
  ds_read_b128 a[248:251], v1 offset:2048
  v_mfma_f32_16x16x32_bf16 v[64:67], v[136:139], a[204:207], v[64:67]
  buffer_load_dwordx4 v6, s[8:11], s32 offen offset:0 nt lds
  v_mfma_f32_16x16x32_bf16 v[116:119], v[136:139], a[208:211], 0
  ds_read_b128 a[252:255], v0 offset:10240
  v_mfma_f32_16x16x32_bf16 v[116:119], v[140:143], a[196:199], v[116:119]
  ds_write_b32 v5, v157 offset:5376
  v_mfma_f32_16x16x32_bf16 v[116:119], v[152:155], a[184:187], v[116:119]
  v_cvt_pk_bf16_f32 v56, v64, v65
  v_cvt_pk_bf16_f32 v57, v66, v67
  v_mfma_f32_16x16x32_bf16 v[116:119], v[148:151], a[172:175], v[116:119]
  ds_read_b128 v[112:115], v1 offset:10240
  v_mfma_f32_16x16x32_bf16 v[116:119], v[144:147], a[160:163], v[116:119]
  ds_read_b128 v[104:107], v0 offset:18432
  v_mfma_f32_16x16x32_bf16 v[116:119], v[128:131], a[148:151], v[116:119]
  ds_read_b128 v[108:111], v1 offset:18432
  v_mfma_f32_16x16x32_bf16 v[100:103], v[128:131], a[152:155], 0
  v_rcp_f32 v134, v132
  v_mfma_f32_16x16x32_bf16 v[100:103], v[144:147], a[164:167], v[100:103]
  v_mul_f32 v120, v134, v120
  v_mul_f32 v121, v134, v121
  v_mfma_f32_16x16x32_bf16 v[100:103], v[148:151], a[176:179], v[100:103]
  v_cvt_pk_bf16_f32 v60, v116, v117
  v_cvt_pk_bf16_f32 v61, v118, v119
  v_mfma_f32_16x16x32_bf16 v[100:103], v[152:155], a[188:191], v[100:103]
  s_waitcnt lgkmcnt(0)
  v_mul_f32 v122, v134, v122
  v_mul_f32 v123, v134, v123
  v_mfma_f32_16x16x32_bf16 v[100:103], v[140:143], a[200:203], v[100:103]
  s_add_u32 m0, s30, 12160
  v_cvt_pk_bf16_f32 v120, v120, v121
  v_cvt_pk_bf16_f32 v121, v122, v123
  v_mfma_f32_16x16x32_bf16 v[100:103], v[136:139], a[212:215], v[100:103]
  buffer_load_dwordx4 v6, s[8:11], s32 offen offset:128 nt lds
  v_mfma_f32_16x16x32_bf16 v[140:143], a[0:3], a[244:247], 0
  v_mul_f32 v124, v134, v124
  v_mul_f32 v125, v134, v125
  v_mfma_f32_16x16x32_bf16 v[140:143], a[12:15], a[248:251], v[140:143]
  v_mul_f32 v126, v134, v126
  v_mul_f32 v127, v134, v127
  v_mfma_f32_16x16x32_bf16 v[140:143], a[24:27], a[252:255], v[140:143]
  v_cvt_pk_bf16_f32 v64, v100, v101
  v_cvt_pk_bf16_f32 v65, v102, v103
  v_mfma_f32_16x16x32_bf16 v[140:143], a[36:39], v[112:115], v[140:143]
  v_cvt_pk_bf16_f32 v124, v124, v125
  v_cvt_pk_bf16_f32 v125, v126, v127
  v_mfma_f32_16x16x32_bf16 v[140:143], a[48:51], v[104:107], v[140:143]
  v_mul_f32 v96, v134, v96
  v_mul_f32 v97, v134, v97
  v_mfma_f32_16x16x32_bf16 v[140:143], a[60:63], v[108:111], v[140:143]
  v_mul_f32 v98, v134, v98
  v_mul_f32 v99, v134, v99
  v_mfma_f32_16x16x32_bf16 v[128:131], a[64:67], v[108:111], 0
  v_cvt_pk_bf16_f32 v96, v96, v97
  v_cvt_pk_bf16_f32 v97, v98, v99
  v_mfma_f32_16x16x32_bf16 v[128:131], a[52:55], v[104:107], v[128:131]
  v_max3_f32 v9, v132, v134, v9
  v_mfma_f32_16x16x32_bf16 v[128:131], a[40:43], v[112:115], v[128:131]
  v_mul_f32 v140, s42, v140
  v_mul_f32 v141, s42, v141
  v_mfma_f32_16x16x32_bf16 v[128:131], a[28:31], a[252:255], v[128:131]
  v_mul_f32 v142, s42, v142
  v_mul_f32 v143, s42, v143
  v_mfma_f32_16x16x32_bf16 v[128:131], a[16:19], a[248:251], v[128:131]
  s_add_u32 m0, s30, 20224
  v_cvt_pk_bf16_f32 v100, v140, v141
  v_cvt_pk_bf16_f32 v101, v142, v143
  v_mfma_f32_16x16x32_bf16 v[128:131], a[4:7], a[244:247], v[128:131]
  buffer_load_dwordx4 v6, s[8:11], s32 offen offset:256 nt lds
  v_mfma_f32_16x16x32_bf16 v[116:119], a[8:11], a[244:247], 0
  s_add_u32 s33, s31, s37
  v_rcp_f32 v94, v92
  v_mfma_f32_16x16x32_bf16 v[116:119], a[20:23], a[248:251], v[116:119]
  s_add_u32 s34, s31, s38
  ds_write_b32 v5, v120 offset:512
  v_mfma_f32_16x16x32_bf16 v[116:119], a[32:35], a[252:255], v[116:119]
  s_add_u32 s35, s31, s39
  v_mul_f32 v128, s42, v128
  v_mul_f32 v129, s42, v129
  v_mfma_f32_16x16x32_bf16 v[116:119], a[44:47], v[112:115], v[116:119]
  s_add_u32 s36, s31, s40
  v_mul_f32 v130, s42, v130
  v_mul_f32 v131, s42, v131
  v_mfma_f32_16x16x32_bf16 v[116:119], a[56:59], v[104:107], v[116:119]
  s_add_u32 s31, s31, s43
  v_cvt_pk_bf16_f32 v102, v128, v129
  v_cvt_pk_bf16_f32 v103, v130, v131
  v_mfma_f32_16x16x32_bf16 v[116:119], a[68:71], v[108:111], v[116:119]
  s_add_u32 s32, s32, s43
  ds_write_b32 v5, v121 offset:1536
  v_mfma_f32_16x16x32_bf16 v[128:131], a[132:135], v[108:111], 0
  s_mov_b32 s5, s28
  ds_write_b32 v5, v124 offset:2560
  v_mfma_f32_16x16x32_bf16 v[128:131], a[120:123], v[104:107], v[128:131]
  s_mov_b32 s28, s29
  ds_write_b32 v5, v125 offset:3584
  v_mfma_f32_16x16x32_bf16 v[128:131], a[108:111], v[112:115], v[128:131]
  s_mov_b32 s29, s30
  ds_write_b32 v5, v96 offset:4608
  v_mfma_f32_16x16x32_bf16 v[128:131], a[96:99], a[252:255], v[128:131]
  s_mov_b32 s30, s5
  ds_write_b32 v5, v97 offset:5632
  v_mfma_f32_16x16x32_bf16 v[128:131], a[84:87], a[248:251], v[128:131]
  v_mul_f32 v116, s42, v116
  v_mul_f32 v117, s42, v117
  v_mfma_f32_16x16x32_bf16 v[128:131], a[72:75], a[244:247], v[128:131]
  v_mul_f32 v118, s42, v118
  v_mul_f32 v119, s42, v119
  v_mfma_f32_16x16x32_bf16 v[96:99], a[76:79], a[244:247], 0
  v_cvt_pk_bf16_f32 v16, v116, v117
  v_cvt_pk_bf16_f32 v17, v118, v119
  v_mfma_f32_16x16x32_bf16 v[96:99], a[88:91], a[248:251], v[96:99]
  v_mul_f32 v84, v94, v84
  v_mul_f32 v85, v94, v85
  v_mfma_f32_16x16x32_bf16 v[96:99], a[100:103], a[252:255], v[96:99]
  s_add_u32 s59, s59, 1
  v_cvt_pk_bf16_f32 v120, v128, v129
  v_cvt_pk_bf16_f32 v121, v130, v131
  v_mfma_f32_16x16x32_bf16 v[96:99], a[112:115], v[112:115], v[96:99]
  s_cmp_eq_u32 s59, 4
  v_mul_f32 v86, v94, v86
  v_mul_f32 v87, v94, v87
  v_mfma_f32_16x16x32_bf16 v[96:99], a[124:127], v[104:107], v[96:99]
  s_cselect_b32 s18, s16, s18
  v_cvt_pk_bf16_f32 v84, v84, v85
  v_cvt_pk_bf16_f32 v85, v86, v87
  v_mfma_f32_16x16x32_bf16 v[96:99], a[136:139], v[108:111], v[96:99]
  s_cselect_b32 s15, s60, s15
  v_mul_f32 v80, v94, v80
  v_mul_f32 v81, v94, v81
  v_mfma_f32_16x16x32_bf16 v[116:119], a[140:143], v[108:111], 0
  s_cmp_eq_u32 s59, 8
  v_mul_f32 v82, v94, v82
  v_mul_f32 v83, v94, v83
  v_mfma_f32_16x16x32_bf16 v[116:119], a[128:131], v[104:107], v[116:119]
  s_cselect_b32 s19, s16, s19
  v_cvt_pk_bf16_f32 v80, v80, v81
  v_cvt_pk_bf16_f32 v81, v82, v83
  v_mfma_f32_16x16x32_bf16 v[116:119], a[116:119], v[112:115], v[116:119]
  s_cselect_b32 s99, s60, s99
  v_cvt_pk_bf16_f32 v122, v96, v97
  v_cvt_pk_bf16_f32 v123, v98, v99
  v_mfma_f32_16x16x32_bf16 v[116:119], a[104:107], a[252:255], v[116:119]
  s_memrealtime s[16:17]
  v_mul_f32 v88, v94, v88
  v_mul_f32 v89, v94, v89
  v_mfma_f32_16x16x32_bf16 v[116:119], a[92:95], a[248:251], v[116:119]
  s_memtime s[60:61]
  v_mul_f32 v90, v94, v90
  v_mul_f32 v91, v94, v91
  v_mfma_f32_16x16x32_bf16 v[116:119], a[80:83], a[244:247], v[116:119]
  v_cvt_pk_bf16_f32 v88, v88, v89
  v_cvt_pk_bf16_f32 v89, v90, v91
  v_mfma_f32_16x16x32_bf16 v[132:135], a[244:247], a[144:147], 0
  v_max3_f32 v9, v92, v94, v9
  v_mfma_f32_16x16x32_bf16 v[132:135], a[248:251], a[156:159], v[132:135]
  ds_write_b32 v5, v84 offset:768
  v_mfma_f32_16x16x32_bf16 v[132:135], a[252:255], a[168:171], v[132:135]
  v_cvt_pk_bf16_f32 v124, v116, v117
  v_cvt_pk_bf16_f32 v125, v118, v119
  v_mfma_f32_16x16x32_bf16 v[132:135], v[112:115], a[180:183], v[132:135]
  ds_read_b128 v[92:95], v0 offset:4096
  v_mfma_f32_16x16x32_bf16 v[132:135], v[104:107], a[192:195], v[132:135]
  ds_read_b128 v[96:99], v1 offset:4096
  v_mfma_f32_16x16x32_bf16 v[132:135], v[108:111], a[204:207], v[132:135]
  ds_read_b128 v[136:139], v0 offset:12288
  v_mfma_f32_16x16x32_bf16 v[128:131], v[108:111], a[208:211], 0
  ds_read_b128 v[116:119], v1 offset:12288
  v_mfma_f32_16x16x32_bf16 v[128:131], v[104:107], a[196:199], v[128:131]
  ds_write_b32 v5, v85 offset:1792
  v_mfma_f32_16x16x32_bf16 v[128:131], v[112:115], a[184:187], v[128:131]
  v_cvt_pk_bf16_f32 v58, v132, v133
  v_cvt_pk_bf16_f32 v59, v134, v135
  v_mfma_f32_16x16x32_bf16 v[128:131], a[252:255], a[172:175], v[128:131]
  ds_write_b32 v5, v80 offset:2816
  v_mfma_f32_16x16x32_bf16 v[128:131], a[248:251], a[160:163], v[128:131]
  ds_write_b32 v5, v81 offset:3840
  v_mfma_f32_16x16x32_bf16 v[128:131], a[244:247], a[148:151], v[128:131]
  ds_write_b32 v5, v88 offset:4864
  v_mfma_f32_16x16x32_bf16 v[132:135], a[244:247], a[152:155], 0
  ds_write_b32 v5, v89 offset:5888
  v_mfma_f32_16x16x32_bf16 v[132:135], a[248:251], a[164:167], v[132:135]
  ds_read_b128 v[80:83], v0 offset:20480
  v_xor_b32 v5, s41, v5
  v_mfma_f32_16x16x32_bf16 v[132:135], a[252:255], a[176:179], v[132:135]
  ds_read_b128 v[84:87], v1 offset:20480
  v_cvt_pk_bf16_f32 v62, v128, v129
  v_mfma_f32_16x16x32_bf16 v[132:135], v[112:115], a[188:191], v[132:135]
  s_waitcnt lgkmcnt(7)
  v_cvt_pk_bf16_f32 v63, v130, v131
  v_mfma_f32_16x16x32_bf16 v[132:135], v[104:107], a[200:203], v[132:135]
  s_bitcmp1_b32 s96, s59
  v_mfma_f32_16x16x32_bf16 v[132:135], v[108:111], a[212:215], v[132:135]
  s_cbranch_scc1 L_k2
L_k2r:
  v_mfma_f32_16x16x32_bf16 v[104:107], a[0:3], v[92:95], 0
L_r208:
  v_mfma_f32_16x16x32_bf16 v[104:107], a[12:15], v[96:99], v[104:107]
L_r209:
  v_mfma_f32_16x16x32_bf16 v[104:107], a[24:27], v[136:139], v[104:107]
  v_cvt_pk_bf16_f32 v66, v132, v133
  v_cvt_pk_bf16_f32 v67, v134, v135
L_r210:
  v_mfma_f32_16x16x32_bf16 v[104:107], a[36:39], v[116:119], v[104:107]
  s_waitcnt lgkmcnt(0)
L_r211:
  v_mfma_f32_16x16x32_bf16 v[104:107], a[48:51], v[80:83], v[104:107]
L_r212:
  v_mfma_f32_16x16x32_bf16 v[104:107], a[60:63], v[84:87], v[104:107]
L_r213:
  v_mfma_f32_16x16x32_bf16 v[88:91], a[64:67], v[84:87], 0
L_r214:
  v_mfma_f32_16x16x32_bf16 v[88:91], a[52:55], v[80:83], v[88:91]
L_r215:
  v_mfma_f32_16x16x32_bf16 v[88:91], a[40:43], v[116:119], v[88:91]
  v_mul_f32 v104, s42, v104
  v_mul_f32 v105, s42, v105
L_r216:
  v_mfma_f32_16x16x32_bf16 v[88:91], a[28:31], v[136:139], v[88:91]
  v_mul_f32 v106, s42, v106
  v_mul_f32 v107, s42, v107
L_r217:
  v_mfma_f32_16x16x32_bf16 v[88:91], a[16:19], v[96:99], v[88:91]
  v_cvt_pk_bf16_f32 v18, v104, v105
  v_cvt_pk_bf16_f32 v19, v106, v107
L_r218:
  v_mfma_f32_16x16x32_bf16 v[88:91], a[4:7], v[92:95], v[88:91]
L_r219:
  v_mfma_f32_16x16x32_bf16 v[108:111], a[8:11], v[92:95], 0
L_r220:
  v_mfma_f32_16x16x32_bf16 v[108:111], a[20:23], v[96:99], v[108:111]
L_r221:
  v_mfma_f32_16x16x32_bf16 v[108:111], a[32:35], v[136:139], v[108:111]
  v_mul_f32 v88, s42, v88
  v_mul_f32 v89, s42, v89
L_r222:
  v_mfma_f32_16x16x32_bf16 v[108:111], a[44:47], v[116:119], v[108:111]
  v_mul_f32 v90, s42, v90
  v_mul_f32 v91, s42, v91
L_r223:
  v_mfma_f32_16x16x32_bf16 v[108:111], a[56:59], v[80:83], v[108:111]
  v_cvt_pk_bf16_f32 v104, v88, v89
  v_cvt_pk_bf16_f32 v105, v90, v91
L_r224:
  v_mfma_f32_16x16x32_bf16 v[108:111], a[68:71], v[84:87], v[108:111]
L_hop_3_0:
  s_cbranch_execz L_hop_3_1
L_r225:
  v_mfma_f32_16x16x32_bf16 v[112:115], a[132:135], v[84:87], 0
L_r226:
  v_mfma_f32_16x16x32_bf16 v[112:115], a[120:123], v[80:83], v[112:115]
L_r227:
  v_mfma_f32_16x16x32_bf16 v[112:115], a[108:111], v[116:119], v[112:115]
  v_mul_f32 v108, s42, v108
  v_mul_f32 v109, s42, v109
L_r228:
  v_mfma_f32_16x16x32_bf16 v[112:115], a[96:99], v[136:139], v[112:115]
  v_mul_f32 v110, s42, v110
  v_mul_f32 v111, s42, v111
L_r229:
  v_mfma_f32_16x16x32_bf16 v[112:115], a[84:87], v[96:99], v[112:115]
  v_cvt_pk_bf16_f32 v106, v108, v109
  v_cvt_pk_bf16_f32 v107, v110, v111
L_r230:
  v_mfma_f32_16x16x32_bf16 v[112:115], a[72:75], v[92:95], v[112:115]
L_r231:
  v_mfma_f32_16x16x32_bf16 v[88:91], a[76:79], v[92:95], 0
L_r232:
  v_mfma_f32_16x16x32_bf16 v[88:91], a[88:91], v[96:99], v[88:91]
L_r233:
  v_mfma_f32_16x16x32_bf16 v[88:91], a[100:103], v[136:139], v[88:91]
  v_cvt_pk_bf16_f32 v128, v112, v113
  v_cvt_pk_bf16_f32 v129, v114, v115
L_r234:
  v_mfma_f32_16x16x32_bf16 v[88:91], a[112:115], v[116:119], v[88:91]
L_r235:
  v_mfma_f32_16x16x32_bf16 v[88:91], a[124:127], v[80:83], v[88:91]
L_r236:
  v_mfma_f32_16x16x32_bf16 v[88:91], a[136:139], v[84:87], v[88:91]
L_r237:
  v_mfma_f32_16x16x32_bf16 v[108:111], a[140:143], v[84:87], 0
L_r238:
  v_mfma_f32_16x16x32_bf16 v[108:111], a[128:131], v[80:83], v[108:111]
L_r239:
  v_mfma_f32_16x16x32_bf16 v[108:111], a[116:119], v[116:119], v[108:111]
  v_cvt_pk_bf16_f32 v130, v88, v89
  v_cvt_pk_bf16_f32 v131, v90, v91
L_r240:
  v_mfma_f32_16x16x32_bf16 v[108:111], a[104:107], v[136:139], v[108:111]
L_r241:
  v_mfma_f32_16x16x32_bf16 v[108:111], a[92:95], v[96:99], v[108:111]
L_r242:
  v_mfma_f32_16x16x32_bf16 v[108:111], a[80:83], v[92:95], v[108:111]
L_r243:
  v_mfma_f32_16x16x32_bf16 v[88:91], v[92:95], a[144:147], 0
L_r244:
  v_mfma_f32_16x16x32_bf16 v[88:91], v[96:99], a[156:159], v[88:91]
L_r245:
  v_mfma_f32_16x16x32_bf16 v[88:91], v[136:139], a[168:171], v[88:91]
  v_cvt_pk_bf16_f32 v132, v108, v109
  v_cvt_pk_bf16_f32 v133, v110, v111
L_r246:
  v_mfma_f32_16x16x32_bf16 v[88:91], v[116:119], a[180:183], v[88:91]
  ds_read_b128 a[244:247], v1 offset:22528
L_r247:
  v_mfma_f32_16x16x32_bf16 v[88:91], v[80:83], a[192:195], v[88:91]
  ds_read_b128 a[248:251], v0 offset:22528
L_r248:
  v_mfma_f32_16x16x32_bf16 v[88:91], v[84:87], a[204:207], v[88:91]
  ds_read_b128 a[252:255], v1 offset:14336
L_r249:
  v_mfma_f32_16x16x32_bf16 v[140:143], v[84:87], a[208:211], 0
  ds_read_b128 v[144:147], v0 offset:14336
L_r250:
  v_mfma_f32_16x16x32_bf16 v[140:143], v[80:83], a[196:199], v[140:143]
  ds_read_b128 v[148:151], v1 offset:6144
L_r251:
  v_mfma_f32_16x16x32_bf16 v[140:143], v[116:119], a[184:187], v[140:143]
  v_cvt_pk_bf16_f32 v108, v88, v89
  v_cvt_pk_bf16_f32 v109, v90, v91
L_r252:
  v_mfma_f32_16x16x32_bf16 v[140:143], v[136:139], a[172:175], v[140:143]
  ds_read_b128 v[152:155], v0 offset:6144
L_r253:
  v_mfma_f32_16x16x32_bf16 v[140:143], v[96:99], a[160:163], v[140:143]
L_r254:
  v_mfma_f32_16x16x32_bf16 v[140:143], v[92:95], a[148:151], v[140:143]
L_r255:
  v_mfma_f32_16x16x32_bf16 v[88:91], v[92:95], a[152:155], 0
L_r256:
  v_mfma_f32_16x16x32_bf16 v[88:91], v[96:99], a[164:167], v[88:91]
L_r257:
  v_mfma_f32_16x16x32_bf16 v[88:91], v[136:139], a[176:179], v[88:91]
  v_cvt_pk_bf16_f32 v112, v140, v141
  v_cvt_pk_bf16_f32 v113, v142, v143
L_r258:
  v_mfma_f32_16x16x32_bf16 v[88:91], v[116:119], a[188:191], v[88:91]
L_r259:
  v_mfma_f32_16x16x32_bf16 v[88:91], v[80:83], a[200:203], v[88:91]
  buffer_load_dwordx2 v[52:53], v11, s[20:23], s44 offen sc1
  v_mfma_f32_16x16x32_bf16 v[88:91], v[84:87], a[212:215], v[88:91]
  s_waitcnt lgkmcnt(0)
  v_mfma_f32_16x16x32_bf16 v[80:83], a[132:135], a[244:247], 0
  v_mfma_f32_16x16x32_bf16 v[80:83], a[120:123], a[248:251], v[80:83]
  v_mfma_f32_16x16x32_bf16 v[80:83], a[108:111], a[252:255], v[80:83]
  v_cvt_pk_bf16_f32 v116, v88, v89
  v_cvt_pk_bf16_f32 v117, v90, v91
  v_mfma_f32_16x16x32_bf16 v[80:83], a[96:99], v[144:147], v[80:83]
  v_mfma_f32_16x16x32_bf16 v[80:83], a[84:87], v[148:151], v[80:83]
  s_waitcnt vmcnt(31)
  s_barrier
  v_mfma_f32_16x16x32_bf16 v[80:83], a[72:75], v[152:155], v[80:83]
  v_add_u32 v0, s28, v2
  v_xor_b32 v1, 64, v0
  v_mfma_f32_16x16x32_bf16 v[84:87], a[76:79], v[152:155], 0
  v_mfma_f32_16x16x32_bf16 v[84:87], a[88:91], v[148:151], v[84:87]
  v_mfma_f32_16x16x32_bf16 v[84:87], a[100:103], v[144:147], v[84:87]
  v_cvt_pk_bf16_f32 v136, v80, v81
  v_cvt_pk_bf16_f32 v137, v82, v83
  v_mfma_f32_16x16x32_bf16 v[84:87], a[112:115], a[252:255], v[84:87]
  v_mfma_f32_16x16x32_bf16 v[84:87], a[124:127], a[248:251], v[84:87]
  v_mfma_f32_16x16x32_bf16 v[84:87], a[136:139], a[244:247], v[84:87]
  v_mfma_f32_16x16x32_bf16 v[80:83], a[140:143], a[244:247], 0
  v_mfma_f32_16x16x32_bf16 v[80:83], a[128:131], a[248:251], v[80:83]
  v_mfma_f32_16x16x32_bf16 v[80:83], a[116:119], a[252:255], v[80:83]
  v_cvt_pk_bf16_f32 v138, v84, v85
  v_cvt_pk_bf16_f32 v139, v86, v87
  v_mfma_f32_16x16x32_bf16 v[80:83], a[104:107], v[144:147], v[80:83]
  v_mfma_f32_16x16x32_bf16 v[80:83], a[92:95], v[148:151], v[80:83]
  v_mfma_f32_16x16x32_bf16 v[80:83], a[80:83], v[152:155], v[80:83]
  v_mfma_f32_16x16x32_bf16 v[92:95], v[70:73], v[76:79], v[36:39]
  v_mfma_f32_16x16x32_bf16 v[92:95], v[68:71], v[12:15], v[92:95]
  v_mfma_f32_16x16x32_bf16 v[96:99], v[122:125], v[76:79], v[32:35]
  v_cvt_pk_bf16_f32 v140, v80, v81
  v_cvt_pk_bf16_f32 v141, v82, v83
  v_mfma_f32_16x16x32_bf16 v[96:99], v[120:123], v[12:15], v[96:99]
  v_mfma_f32_16x16x32_bf16 v[172:175], v[130:133], v[76:79], v[28:31]
  v_exp_f32 v92, v92
  v_mfma_f32_16x16x32_bf16 v[172:175], v[128:131], v[12:15], v[172:175]
  v_exp_f32 v93, v93
  v_mfma_f32_16x16x32_bf16 v[176:179], v[138:141], v[76:79], v[24:27]
  v_exp_f32 v94, v94
  v_mfma_f32_16x16x32_bf16 v[176:179], v[136:139], v[12:15], v[176:179]
  v_exp_f32 v95, v95
  v_mfma_f32_16x16x32_bf16 v[84:87], v[68:71], v[100:103], v[40:43]
  v_exp_f32 v96, v96
  v_mfma_f32_16x16x32_bf16 v[84:87], v[70:73], v[14:17], v[84:87]
  v_exp_f32 v97, v97
  v_mfma_f32_16x16x32_bf16 v[88:91], v[120:123], v[100:103], v[36:39]
  v_exp_f32 v98, v98
  v_mfma_f32_16x16x32_bf16 v[88:91], v[122:125], v[14:17], v[88:91]
  v_exp_f32 v99, v99
  v_mfma_f32_16x16x32_bf16 v[168:171], v[128:131], v[100:103], v[32:35]
  v_exp_f32 v172, v172
  v_mfma_f32_16x16x32_bf16 v[168:171], v[130:133], v[14:17], v[168:171]
  v_exp_f32 v173, v173
  v_mfma_f32_16x16x32_bf16 v[164:167], v[136:139], v[100:103], v[28:31]
  v_exp_f32 v174, v174
  v_mfma_f32_16x16x32_bf16 v[164:167], v[138:141], v[14:17], v[164:167]
  v_exp_f32 v175, v175
  v_mfma_f32_16x16x32_bf16 v[76:79], v[130:133], v[104:107], v[36:39]
  v_exp_f32 v176, v176
  v_mfma_f32_16x16x32_bf16 v[76:79], v[128:131], v[18:21], v[76:79]
  v_exp_f32 v177, v177
  v_mfma_f32_16x16x32_bf16 v[80:83], v[138:141], v[104:107], v[32:35]
  v_exp_f32 v178, v178
  v_mfma_f32_16x16x32_bf16 v[80:83], v[136:139], v[18:21], v[80:83]
  v_exp_f32 v179, v179
  v_mfma_f32_16x16x32_bf16 v[160:163], v[70:73], v[104:107], v[44:47]
  v_cvt_pk_bf16_f32 v92, v92, v93
  v_cvt_pk_bf16_f32 v93, v94, v95
  v_mfma_f32_16x16x32_bf16 v[160:163], v[68:71], v[18:21], v[160:163]
  v_cvt_pk_bf16_f32 v94, v96, v97
  v_cvt_pk_bf16_f32 v95, v98, v99
  v_mfma_f32_16x16x32_bf16 v[156:159], v[122:125], v[104:107], v[40:43]
  v_cvt_pk_bf16_f32 v96, v172, v173
  v_cvt_pk_bf16_f32 v97, v174, v175
  v_mfma_f32_16x16x32_bf16 v[156:159], v[120:123], v[18:21], v[156:159]
  v_cvt_pk_bf16_f32 v98, v176, v177
  v_cvt_pk_bf16_f32 v99, v178, v179
  v_mfma_f32_16x16x32_bf16 v[180:183], a[0:3], v[152:155], 0
  v_exp_f32 v84, v84
  v_mfma_f32_16x16x32_bf16 v[180:183], a[12:15], v[148:151], v[180:183]
  v_exp_f32 v85, v85
  v_mfma_f32_16x16x32_bf16 v[180:183], a[24:27], v[144:147], v[180:183]
  v_exp_f32 v86, v86
  v_mfma_f32_16x16x32_bf16 v[180:183], a[36:39], a[252:255], v[180:183]
  v_exp_f32 v87, v87
  v_mfma_f32_16x16x32_bf16 v[180:183], a[48:51], a[248:251], v[180:183]
  v_exp_f32 v88, v88
  v_mfma_f32_16x16x32_bf16 v[180:183], a[60:63], a[244:247], v[180:183]
  v_exp_f32 v89, v89
  v_mfma_f32_16x16x32_bf16 v[100:103], a[64:67], a[244:247], 0
  v_exp_f32 v90, v90
  v_mfma_f32_16x16x32_bf16 v[100:103], a[52:55], a[248:251], v[100:103]
  v_exp_f32 v91, v91
  v_mfma_f32_16x16x32_bf16 v[100:103], a[40:43], a[252:255], v[100:103]
  v_mul_f32 v180, s42, v180
  v_mul_f32 v181, s42, v181
  v_mfma_f32_16x16x32_bf16 v[100:103], a[28:31], v[144:147], v[100:103]
  v_mul_f32 v182, s42, v182
  v_mul_f32 v183, s42, v183
  v_mfma_f32_16x16x32_bf16 v[100:103], a[16:19], v[148:151], v[100:103]
  v_cvt_pk_bf16_f32 v172, v180, v181
  v_cvt_pk_bf16_f32 v173, v182, v183
  v_mfma_f32_16x16x32_bf16 v[100:103], a[4:7], v[152:155], v[100:103]
  v_exp_f32 v168, v168
  v_mfma_f32_16x16x32_bf16 v[104:107], a[8:11], v[152:155], 0
  v_exp_f32 v169, v169
  v_mfma_f32_16x16x32_bf16 v[104:107], a[20:23], v[148:151], v[104:107]
  v_exp_f32 v170, v170
  v_mfma_f32_16x16x32_bf16 v[104:107], a[32:35], v[144:147], v[104:107]
  v_mul_f32 v100, s42, v100
  v_mul_f32 v101, s42, v101
  v_mfma_f32_16x16x32_bf16 v[104:107], a[44:47], a[252:255], v[104:107]
  v_mul_f32 v102, s42, v102
  v_mul_f32 v103, s42, v103
  v_mfma_f32_16x16x32_bf16 v[104:107], a[56:59], a[248:251], v[104:107]
  v_cvt_pk_bf16_f32 v174, v100, v101
  v_cvt_pk_bf16_f32 v175, v102, v103
  v_mfma_f32_16x16x32_bf16 v[104:107], a[68:71], a[244:247], v[104:107]
  v_exp_f32 v171, v171
  v_mfma_f32_16x16x32_bf16 v[176:179], v[152:155], a[144:147], 0
  v_exp_f32 v164, v164
  v_mfma_f32_16x16x32_bf16 v[176:179], v[148:151], a[156:159], v[176:179]
  v_exp_f32 v165, v165
  v_mfma_f32_16x16x32_bf16 v[176:179], v[144:147], a[168:171], v[176:179]
  v_mul_f32 v104, s42, v104
  v_mul_f32 v105, s42, v105
  v_mfma_f32_16x16x32_bf16 v[176:179], a[252:255], a[180:183], v[176:179]
  v_mul_f32 v106, s42, v106
  v_mul_f32 v107, s42, v107
  v_mfma_f32_16x16x32_bf16 v[176:179], a[248:251], a[192:195], v[176:179]
  v_cvt_pk_bf16_f32 v22, v104, v105
  v_cvt_pk_bf16_f32 v23, v106, v107
  v_mfma_f32_16x16x32_bf16 v[176:179], a[244:247], a[204:207], v[176:179]
  v_exp_f32 v166, v166
  v_mfma_f32_16x16x32_bf16 v[100:103], v[128:131], v[172:175], v[40:43]
  v_exp_f32 v167, v167
  v_mfma_f32_16x16x32_bf16 v[100:103], v[130:133], v[20:23], v[100:103]
  v_cvt_pk_bf16_f32 v84, v84, v85
  v_cvt_pk_bf16_f32 v85, v86, v87
  v_mfma_f32_16x16x32_bf16 v[104:107], v[136:139], v[172:175], v[36:39]
  v_cvt_pk_bf16_f32 v110, v176, v177
  v_cvt_pk_bf16_f32 v111, v178, v179
  v_mfma_f32_16x16x32_bf16 v[104:107], v[138:141], v[20:23], v[104:107]
  v_cvt_pk_bf16_f32 v86, v88, v89
  v_cvt_pk_bf16_f32 v87, v90, v91
  v_mfma_f32_16x16x32_bf16 v[132:135], v[68:71], v[172:175], v[48:51]
  ds_read_b128 v[136:139], v3 offset:0
  v_cvt_pk_bf16_f32 v88, v168, v169
  v_mfma_f32_16x16x32_bf16 v[132:135], v[70:73], v[20:23], v[132:135]
  ds_read_b128 v[140:143], v3 offset:4096
  v_cvt_pk_bf16_f32 v89, v170, v171
  v_mfma_f32_16x16x32_bf16 v[128:131], v[120:123], v[172:175], v[44:47]
  ds_read_b128 v[68:71], v3 offset:8192
  v_cvt_pk_bf16_f32 v90, v164, v165
  v_mfma_f32_16x16x32_bf16 v[128:131], v[122:125], v[20:23], v[128:131]
  ds_read_b128 v[72:75], v3 offset:12288
  v_cvt_pk_bf16_f32 v91, v166, v167
  v_mfma_f32_16x16x32_bf16 v[168:171], a[244:247], a[208:211], 0
  ds_read_b128 v[120:123], v3 offset:16384
  v_mfma_f32_16x16x32_bf16 v[168:171], a[248:251], a[196:199], v[168:171]
  ds_read_b128 v[124:127], v3 offset:20480
  v_mfma_f32_16x16x32_bf16 v[168:171], a[252:255], a[184:187], v[168:171]
  v_exp_f32 v76, v76
  v_mfma_f32_16x16x32_bf16 v[168:171], v[144:147], a[172:175], v[168:171]
  v_exp_f32 v77, v77
  v_mfma_f32_16x16x32_bf16 v[168:171], v[148:151], a[160:163], v[168:171]
  v_exp_f32 v78, v78
  v_mfma_f32_16x16x32_bf16 v[168:171], v[152:155], a[148:151], v[168:171]
  v_exp_f32 v79, v79
  v_mfma_f32_16x16x32_bf16 v[164:167], v[152:155], a[152:155], 0
  v_exp_f32 v80, v80
  v_mfma_f32_16x16x32_bf16 v[164:167], v[148:151], a[164:167], v[164:167]
  v_exp_f32 v81, v81
  v_mfma_f32_16x16x32_bf16 v[164:167], v[144:147], a[176:179], v[164:167]
  v_cvt_pk_bf16_f32 v114, v168, v169
  v_cvt_pk_bf16_f32 v115, v170, v171
  v_mfma_f32_16x16x32_bf16 v[164:167], a[252:255], a[188:191], v[164:167]
  s_cmp_lt_u32 s31, s97
  v_exp_f32 v82, v82
  v_mfma_f32_16x16x32_bf16 v[164:167], a[248:251], a[200:203], v[164:167]
  s_waitcnt lgkmcnt(0)
  v_exp_f32 v83, v83
  v_mfma_f32_16x16x32_bf16 v[164:167], a[244:247], a[212:215], v[164:167]
  s_cbranch_scc1 L_loop
L_epi:
  v_mfma_f32_16x16x32_bf16 v[180:183], v[136:139], v[184:187], 0
  s_lshl_b32 s5, s3, 3
  v_mov_b64 v[144:145], 0
  v_cvt_pk_bf16_f32 v76, v76, v77
  v_mfma_f32_16x16x32_bf16 v[180:183], v[140:143], v[200:203], v[180:183]
  s_add_u32 s5, s5, 155648
  v_exp_f32 v160, v160
  v_mfma_f32_16x16x32_bf16 v[180:183], v[68:71], v[216:219], v[180:183]
  v_cvt_pk_bf16_f32 v118, v164, v165
  v_cvt_pk_bf16_f32 v119, v166, v167
  v_mfma_f32_16x16x32_bf16 v[180:183], v[72:75], v[232:235], v[180:183]
  v_mov_b64 v[148:149], 0
  v_cvt_pk_bf16_f32 v77, v78, v79
  v_mfma_f32_16x16x32_bf16 v[180:183], v[120:123], v[248:251], v[180:183]
  v_exp_f32 v161, v161
  v_mfma_f32_16x16x32_bf16 v[180:183], v[124:127], a[224:227], v[180:183]
  v_exp_f32 v162, v162
  v_smfmac_f32_16x16x64_bf16 v[144:147], a[240:243], v[92:99], v10
  v_exp_f32 v163, v163
  v_mfma_f32_16x16x32_bf16 v[152:155], v[108:111], v[96:99], 0
  v_exp_f32 v156, v156
  v_mfma_f32_16x16x32_bf16 v[152:155], v[56:59], v[92:95], v[152:155]
  v_exp_f32 v157, v157
  v_mfma_f32_16x16x32_bf16 v[164:167], v[60:63], v[92:95], 0
  v_exp_f32 v158, v158
  v_mfma_f32_16x16x32_bf16 v[164:167], v[112:115], v[96:99], v[164:167]
  v_exp_f32 v159, v159
  v_mfma_f32_16x16x32_bf16 v[168:171], v[116:119], v[96:99], 0
  v_cvt_pk_bf16_f32 v78, v80, v81
  v_cvt_pk_bf16_f32 v79, v82, v83
  v_mfma_f32_16x16x32_bf16 v[168:171], v[64:67], v[92:95], v[168:171]
  v_cvt_pk_bf16_f32 v80, v160, v161
  v_cvt_pk_bf16_f32 v81, v162, v163
  v_smfmac_f32_16x16x64_bf16 v[148:151], a[240:243], v[84:91], v10
  v_cvt_pk_bf16_f32 v82, v156, v157
  v_cvt_pk_bf16_f32 v83, v158, v159
  v_mfma_f32_16x16x32_bf16 v[92:95], v[108:111], v[88:91], 0
  v_exp_f32 v100, v100
  v_mfma_f32_16x16x32_bf16 v[92:95], v[56:59], v[84:87], v[92:95]
  v_exp_f32 v101, v101
  v_mfma_f32_16x16x32_bf16 v[96:99], v[60:63], v[84:87], 0
  v_exp_f32 v102, v102
  v_mfma_f32_16x16x32_bf16 v[96:99], v[112:115], v[88:91], v[96:99]
  v_exp_f32 v103, v103
  v_mfma_f32_16x16x32_bf16 v[156:159], v[116:119], v[88:91], 0
  v_exp_f32 v104, v104
  v_mfma_f32_16x16x32_bf16 v[156:159], v[64:67], v[84:87], v[156:159]
  v_exp_f32 v105, v105
  v_mfma_f32_16x16x32_bf16 v[172:175], v[124:127], a[228:231], 0
  v_exp_f32 v106, v106
  v_mfma_f32_16x16x32_bf16 v[172:175], v[120:123], v[252:255], v[172:175]
  v_exp_f32 v107, v107
  v_mfma_f32_16x16x32_bf16 v[172:175], v[72:75], v[236:239], v[172:175]
  ds_read_b128 a[248:251], v4 offset:0
  ds_read_b128 v[16:19], v4 offset:4096
  v_mfma_f32_16x16x32_bf16 v[172:175], v[68:71], v[220:223], v[172:175]
  ds_read_b128 v[160:163], v4 offset:8192
  ds_read_b128 v[176:179], v4 offset:12288
  v_mfma_f32_16x16x32_bf16 v[172:175], v[140:143], v[204:207], v[172:175]
  ds_read_b128 a[244:247], v4 offset:16384
  ds_read_b128 a[252:255], v4 offset:20480
  v_mfma_f32_16x16x32_bf16 v[172:175], v[136:139], v[188:191], v[172:175]
  v_exp_f32 v132, v132
  v_mfma_f32_16x16x32_bf16 v[88:91], v[136:139], v[192:195], 0
  v_exp_f32 v133, v133
  v_mfma_f32_16x16x32_bf16 v[88:91], v[140:143], v[208:211], v[88:91]
  v_exp_f32 v134, v134
  v_mfma_f32_16x16x32_bf16 v[88:91], v[68:71], v[224:227], v[88:91]
  v_cvt_pk_bf16_f32 v180, v180, v172
  v_cvt_pk_bf16_f32 v181, v181, v173
  v_mfma_f32_16x16x32_bf16 v[88:91], v[72:75], v[240:243], v[88:91]
  v_cvt_pk_bf16_f32 v182, v182, v174
  v_cvt_pk_bf16_f32 v183, v183, v175
  v_mfma_f32_16x16x32_bf16 v[88:91], v[120:123], a[216:219], v[88:91]
  buffer_store_dword v180, v7, s[24:27], s33 offen offset:0 nt
  v_mfma_f32_16x16x32_bf16 v[88:91], v[124:127], a[232:235], v[88:91]
  v_exp_f32 v135, v135
  v_mfma_f32_16x16x32_bf16 v[84:87], v[124:127], a[236:239], 0
  buffer_store_dword v181, v7, s[24:27], s33 offen offset:384 nt
  v_mfma_f32_16x16x32_bf16 v[84:87], v[120:123], a[220:223], v[84:87]
  v_exp_f32 v128, v128
  v_mfma_f32_16x16x32_bf16 v[84:87], v[72:75], v[244:247], v[84:87]
  buffer_store_dword v182, v7, s[24:27], s33 offen offset:768 nt
  v_mfma_f32_16x16x32_bf16 v[84:87], v[68:71], v[228:231], v[84:87]
  v_exp_f32 v129, v129
  v_mfma_f32_16x16x32_bf16 v[84:87], v[140:143], v[212:215], v[84:87]
  buffer_store_dword v183, v7, s[24:27], s33 offen offset:1152 nt
  v_mfma_f32_16x16x32_bf16 v[84:87], v[136:139], v[196:199], v[84:87]
  s_waitcnt lgkmcnt(0)
  v_exp_f32 v130, v130
  v_mfma_f32_16x16x32_bf16 v[140:143], a[248:251], v[184:187], 0
  v_exp_f32 v131, v131
  v_mfma_f32_16x16x32_bf16 v[140:143], v[16:19], v[200:203], v[140:143]
  v_cvt_pk_bf16_f32 v100, v100, v101
  v_cvt_pk_bf16_f32 v101, v102, v103
  v_mfma_f32_16x16x32_bf16 v[140:143], v[160:163], v[216:219], v[140:143]
  v_cvt_pk_bf16_f32 v88, v88, v84
  v_cvt_pk_bf16_f32 v89, v89, v85
  v_mfma_f32_16x16x32_bf16 v[140:143], v[176:179], v[232:235], v[140:143]
  v_cvt_pk_bf16_f32 v90, v90, v86
  v_cvt_pk_bf16_f32 v91, v91, v87
  v_mfma_f32_16x16x32_bf16 v[140:143], a[244:247], v[248:251], v[140:143]
  buffer_store_dword v88, v8, s[24:27], s33 offen offset:0 nt
  v_mfma_f32_16x16x32_bf16 v[140:143], a[252:255], a[224:227], v[140:143]
  ds_read_b128 v[172:175], v3 offset:512
  v_mov_b64 v[84:85], 0
  v_mfma_f32_16x16x32_bf16 v[136:139], a[252:255], a[228:231], 0
  buffer_store_dword v89, v8, s[24:27], s33 offen offset:384 nt
  v_mfma_f32_16x16x32_bf16 v[136:139], a[244:247], v[252:255], v[136:139]
  ds_read_b128 v[180:183], v3 offset:4608
  ds_read_b128 a[252:255], v3 offset:8704
  v_mfma_f32_16x16x32_bf16 v[136:139], v[176:179], v[236:239], v[136:139]
  buffer_store_dword v90, v8, s[24:27], s33 offen offset:768 nt
  v_mfma_f32_16x16x32_bf16 v[136:139], v[160:163], v[220:223], v[136:139]
  ds_read_b128 v[120:123], v3 offset:12800
  ds_read_b128 v[124:127], v3 offset:16896
  v_mfma_f32_16x16x32_bf16 v[136:139], v[16:19], v[204:207], v[136:139]
  buffer_store_dword v91, v8, s[24:27], s33 offen offset:1152 nt
  v_mfma_f32_16x16x32_bf16 v[136:139], a[248:251], v[188:191], v[136:139]
  s_add_u32 s33, s33, s98
  ds_read_b128 a[244:247], v3 offset:20992
  v_cvt_pk_bf16_f32 v102, v104, v105
  v_smfmac_f32_16x16x64_bf16 v[84:87], a[240:243], v[76:83], v10
  v_cvt_pk_bf16_f32 v103, v106, v107
  v_cvt_pk_bf16_f32 v104, v132, v133
  v_mfma_f32_16x16x32_bf16 v[16:19], v[56:59], v[80:83], 0
  v_cvt_pk_bf16_f32 v105, v134, v135
  v_cvt_pk_bf16_f32 v106, v128, v129
  v_mfma_f32_16x16x32_bf16 v[16:19], v[108:111], v[76:79], v[16:19]
  v_cvt_pk_bf16_f32 v140, v140, v136
  v_cvt_pk_bf16_f32 v141, v141, v137
  v_mfma_f32_16x16x32_bf16 v[68:71], v[112:115], v[76:79], 0
  v_cvt_pk_bf16_f32 v142, v142, v138
  v_cvt_pk_bf16_f32 v143, v143, v139
  v_mfma_f32_16x16x32_bf16 v[68:71], v[60:63], v[80:83], v[68:71]
  buffer_store_dword v140, v7, s[24:27], s34 offen offset:0 nt
  v_mfma_f32_16x16x32_bf16 v[72:75], v[64:67], v[80:83], 0
  s_waitcnt lgkmcnt(0)
  v_cvt_pk_bf16_f32 v107, v130, v131
  v_add_f32 v144, v144, v145
  v_mfma_f32_16x16x32_bf16 v[72:75], v[116:119], v[76:79], v[72:75]
  buffer_store_dword v141, v7, s[24:27], s34 offen offset:384 nt
  v_mfma_f32_16x16x32_bf16 v[128:131], v[172:175], v[184:187], 0
  v_rcp_f32 v146, v144
  v_mfma_f32_16x16x32_bf16 v[128:131], v[180:183], v[200:203], v[128:131]
  buffer_store_dword v142, v7, s[24:27], s34 offen offset:768 nt
  v_mfma_f32_16x16x32_bf16 v[128:131], a[252:255], v[216:219], v[128:131]
  v_mov_b64 v[76:77], 0
  v_add_f32 v148, v148, v149
  v_mfma_f32_16x16x32_bf16 v[128:131], v[120:123], v[232:235], v[128:131]
  buffer_store_dword v143, v7, s[24:27], s34 offen offset:1152 nt
  v_mul_f32 v152, v146, v152
  v_mfma_f32_16x16x32_bf16 v[128:131], v[124:127], v[248:251], v[128:131]
  s_add_u32 s34, s34, s98
  v_rcp_f32 v150, v148
  v_mul_f32 v153, v146, v153
  v_mfma_f32_16x16x32_bf16 v[128:131], a[244:247], a[224:227], v[128:131]
  v_mul_f32 v154, v146, v154
  v_mul_f32 v155, v146, v155
  v_cvt_pk_bf16_f32 v152, v152, v153
  v_mfma_f32_16x16x32_bf16 v[88:91], a[244:247], a[228:231], 0
  v_cvt_pk_bf16_f32 v153, v154, v155
  v_mul_f32 v164, v146, v164
  v_mul_f32 v165, v146, v165
  v_mfma_f32_16x16x32_bf16 v[88:91], v[124:127], v[252:255], v[88:91]
  v_mul_f32 v166, v146, v166
  v_mul_f32 v167, v146, v167
  v_cvt_pk_bf16_f32 v164, v164, v165
  v_mfma_f32_16x16x32_bf16 v[88:91], v[120:123], v[236:239], v[88:91]
  v_cvt_pk_bf16_f32 v165, v166, v167
  v_mul_f32 v168, v146, v168
  v_mul_f32 v169, v146, v169
  v_mfma_f32_16x16x32_bf16 v[88:91], a[252:255], v[220:223], v[88:91]
  v_mul_f32 v170, v146, v170
  v_mul_f32 v171, v146, v171
  v_cvt_pk_bf16_f32 v168, v168, v169
  v_mfma_f32_16x16x32_bf16 v[88:91], v[180:183], v[204:207], v[88:91]
  v_cvt_pk_bf16_f32 v169, v170, v171
  v_mul_f32 v92, v150, v92
  v_mul_f32 v93, v150, v93
  v_mfma_f32_16x16x32_bf16 v[88:91], v[172:175], v[188:191], v[88:91]
  v_mul_f32 v94, v150, v94
  v_mul_f32 v95, v150, v95
  v_cvt_pk_bf16_f32 v92, v92, v93
  v_smfmac_f32_16x16x64_bf16 v[76:79], a[240:243], v[100:107], v10
  v_cvt_pk_bf16_f32 v93, v94, v95
  v_mul_f32 v96, v150, v96
  v_mul_f32 v97, v150, v97
  v_mfma_f32_16x16x32_bf16 v[80:83], v[56:59], v[104:107], 0
  v_mul_f32 v98, v150, v98
  v_mul_f32 v99, v150, v99
  v_cvt_pk_bf16_f32 v96, v96, v97
  v_mfma_f32_16x16x32_bf16 v[80:83], v[108:111], v[100:103], v[80:83]
  v_cvt_pk_bf16_f32 v128, v128, v88
  v_cvt_pk_bf16_f32 v129, v129, v89
  v_cvt_pk_bf16_f32 v97, v98, v99
  v_mfma_f32_16x16x32_bf16 v[56:59], v[112:115], v[100:103], 0
  ds_read_b128 v[108:111], v4 offset:512
  v_cvt_pk_bf16_f32 v130, v130, v90
  v_cvt_pk_bf16_f32 v131, v131, v91
  v_mfma_f32_16x16x32_bf16 v[56:59], v[60:63], v[104:107], v[56:59]
  buffer_store_dword v128, v7, s[24:27], s35 offen offset:0 nt
  v_mul_f32 v156, v150, v156
  v_mfma_f32_16x16x32_bf16 v[88:91], v[64:67], v[104:107], 0
  ds_read_b128 v[112:115], v4 offset:4608
  ds_read_b128 v[132:135], v4 offset:8704
  v_mul_f32 v157, v150, v157
  v_mfma_f32_16x16x32_bf16 v[88:91], v[116:119], v[100:103], v[88:91]
  buffer_store_dword v129, v7, s[24:27], s35 offen offset:384 nt
  v_mul_f32 v158, v150, v158
  v_mfma_f32_16x16x32_bf16 v[104:107], v[172:175], v[192:195], 0
  ds_read_b128 v[100:103], v4 offset:12800
  ds_read_b128 v[60:63], v4 offset:16896
  v_mul_f32 v159, v150, v159
  v_mfma_f32_16x16x32_bf16 v[104:107], v[180:183], v[208:211], v[104:107]
  buffer_store_dword v130, v7, s[24:27], s35 offen offset:768 nt
  v_cvt_pk_bf16_f32 v156, v156, v157
  v_mfma_f32_16x16x32_bf16 v[104:107], a[252:255], v[224:227], v[104:107]
  ds_read_b128 v[116:119], v4 offset:20992
  v_cvt_pk_bf16_f32 v157, v158, v159
  v_max3_f32 v9, v144, v146, v9
  v_mfma_f32_16x16x32_bf16 v[104:107], v[120:123], v[240:243], v[104:107]
  buffer_store_dword v131, v7, s[24:27], s35 offen offset:1152 nt
  v_max3_f32 v9, v148, v150, v9
  v_mfma_f32_16x16x32_bf16 v[104:107], v[124:127], a[216:219], v[104:107]
  ds_write2st64_b32 v5, v152, v153 offset0:0 offset1:4
  v_mfma_f32_16x16x32_bf16 v[104:107], a[244:247], a[232:235], v[104:107]
  ds_write2st64_b32 v5, v164, v165 offset0:8 offset1:12
  v_mfma_f32_16x16x32_bf16 v[128:131], a[244:247], a[236:239], 0
  ds_write2st64_b32 v5, v168, v169 offset0:16 offset1:20
  v_mfma_f32_16x16x32_bf16 v[128:131], v[124:127], a[220:223], v[128:131]
  ds_write2st64_b32 v5, v92, v93 offset0:1 offset1:5
  v_mfma_f32_16x16x32_bf16 v[128:131], v[120:123], v[244:247], v[128:131]
  ds_write2st64_b32 v5, v96, v97 offset0:9 offset1:13
  v_mfma_f32_16x16x32_bf16 v[128:131], a[252:255], v[228:231], v[128:131]
  ds_write2st64_b32 v5, v156, v157 offset0:17 offset1:21
  v_mfma_f32_16x16x32_bf16 v[128:131], v[180:183], v[212:215], v[128:131]
  v_xor_b32 v3, 40960, v3
  v_xor_b32 v4, 40960, v4
  v_add_f32 v84, v84, v85
  v_mfma_f32_16x16x32_bf16 v[128:131], v[172:175], v[196:199], v[128:131]
  s_waitcnt lgkmcnt(6)
  v_rcp_f32 v86, v84
  v_add_f32 v76, v76, v77
  v_mfma_f32_16x16x32_bf16 v[64:67], v[108:111], v[184:187], 0
  v_rcp_f32 v78, v76
  v_max3_f32 v9, v84, v86, v9
  v_mfma_f32_16x16x32_bf16 v[64:67], v[112:115], v[200:203], v[64:67]
  v_max3_f32 v9, v76, v78, v9
  v_cmp_nge_f32 vcc, 0x53800000, v9
  v_mul_f32 v16, v86, v16
  v_mfma_f32_16x16x32_bf16 v[64:67], v[132:135], v[216:219], v[64:67]
  v_cvt_pk_bf16_f32 v104, v104, v128
  v_cvt_pk_bf16_f32 v105, v105, v129
  v_mul_f32 v17, v86, v17
  v_mfma_f32_16x16x32_bf16 v[64:67], v[100:103], v[232:235], v[64:67]
  s_waitcnt lgkmcnt(0)
  s_barrier
  v_mfma_f32_16x16x32_bf16 v[64:67], v[60:63], v[248:251], v[64:67]
  s_or_b32 s6, vcc_lo, vcc_hi
  ds_read_b128 a[244:247], v3 offset:0
  v_cvt_pk_bf16_f32 v106, v106, v130
  v_cvt_pk_bf16_f32 v107, v107, v131
  v_mfma_f32_16x16x32_bf16 v[64:67], v[116:119], a[224:227], v[64:67]
  buffer_store_dword v104, v8, s[24:27], s35 offen offset:0 nt
  v_mul_f32 v18, v86, v18
  v_mfma_f32_16x16x32_bf16 v[120:123], v[116:119], a[228:231], 0
  ds_read_b128 a[248:251], v3 offset:4096
  ds_read_b128 a[252:255], v3 offset:8192
  v_mul_f32 v19, v86, v19
  v_mfma_f32_16x16x32_bf16 v[120:123], v[60:63], v[252:255], v[120:123]
  buffer_store_dword v105, v8, s[24:27], s35 offen offset:384 nt
  v_cvt_pk_bf16_f32 v16, v16, v17
  v_mfma_f32_16x16x32_bf16 v[120:123], v[100:103], v[236:239], v[120:123]
  ds_read_b128 v[60:63], v3 offset:12288
  ds_read_b128 v[92:95], v3 offset:16384
  v_cvt_pk_bf16_f32 v17, v18, v19
  v_mfma_f32_16x16x32_bf16 v[120:123], v[132:135], v[220:223], v[120:123]
  buffer_store_dword v106, v8, s[24:27], s35 offen offset:768 nt
  v_mul_f32 v68, v86, v68
  v_mfma_f32_16x16x32_bf16 v[120:123], v[112:115], v[204:207], v[120:123]
  s_waitcnt lgkmcnt(2)
  ds_read_b128 v[100:103], v3 offset:20480
  v_mul_f32 v69, v86, v69
  v_mul_f32 v70, v86, v70
  v_mfma_f32_16x16x32_bf16 v[120:123], v[108:111], v[188:191], v[120:123]
  buffer_store_dword v107, v8, s[24:27], s35 offen offset:1152 nt
  v_mul_f32 v71, v86, v71
  v_mfma_f32_16x16x32_bf16 v[96:99], a[244:247], v[184:187], 0
  s_add_u32 s35, s35, s98
  v_cvt_pk_bf16_f32 v68, v68, v69
  v_cvt_pk_bf16_f32 v69, v70, v71
  v_mul_f32 v72, v86, v72
  v_mfma_f32_16x16x32_bf16 v[96:99], a[248:251], v[200:203], v[96:99]
  v_mul_f32 v73, v86, v73
  v_mul_f32 v74, v86, v74
  v_mul_f32 v75, v86, v75
  v_mfma_f32_16x16x32_bf16 v[96:99], a[252:255], v[216:219], v[96:99]
  s_waitcnt lgkmcnt(1)
  v_cvt_pk_bf16_f32 v64, v64, v120
  v_cvt_pk_bf16_f32 v65, v65, v121
  v_cvt_pk_bf16_f32 v72, v72, v73
  v_mfma_f32_16x16x32_bf16 v[96:99], v[60:63], v[232:235], v[96:99]
  s_waitcnt lgkmcnt(0)
  v_cvt_pk_bf16_f32 v66, v66, v122
  v_cvt_pk_bf16_f32 v67, v67, v123
  v_cvt_pk_bf16_f32 v73, v74, v75
  v_mfma_f32_16x16x32_bf16 v[96:99], v[92:95], v[248:251], v[96:99]
  buffer_store_dword v64, v7, s[24:27], s36 offen offset:0 nt
  v_mul_f32 v80, v78, v80
  v_mfma_f32_16x16x32_bf16 v[96:99], v[100:103], a[224:227], v[96:99]
  v_mul_f32 v81, v78, v81
  v_mul_f32 v82, v78, v82
  v_mul_f32 v83, v78, v83
  v_mfma_f32_16x16x32_bf16 v[124:127], v[100:103], a[228:231], 0
  buffer_store_dword v65, v7, s[24:27], s36 offen offset:384 nt
  v_cvt_pk_bf16_f32 v80, v80, v81
  v_mfma_f32_16x16x32_bf16 v[124:127], v[92:95], v[252:255], v[124:127]
  v_cvt_pk_bf16_f32 v81, v82, v83
  v_mul_f32 v56, v78, v56
  v_mul_f32 v57, v78, v57
  v_mfma_f32_16x16x32_bf16 v[124:127], v[60:63], v[236:239], v[124:127]
  buffer_store_dword v66, v7, s[24:27], s36 offen offset:768 nt
  v_mul_f32 v58, v78, v58
  v_mfma_f32_16x16x32_bf16 v[124:127], a[252:255], v[220:223], v[124:127]
  ds_read_b128 v[84:87], v4 offset:0
  ds_read_b128 v[104:107], v4 offset:4096
  v_mul_f32 v59, v78, v59
  v_mfma_f32_16x16x32_bf16 v[124:127], a[248:251], v[204:207], v[124:127]
  buffer_store_dword v67, v7, s[24:27], s36 offen offset:1152 nt
  v_cvt_pk_bf16_f32 v56, v56, v57
  v_mfma_f32_16x16x32_bf16 v[124:127], a[244:247], v[188:191], v[124:127]
  s_add_u32 s36, s36, s98
  ds_read_b128 v[108:111], v4 offset:8192
  ds_read_b128 v[112:115], v4 offset:12288
  v_cvt_pk_bf16_f32 v57, v58, v59
  v_mfma_f32_16x16x32_bf16 v[64:67], a[244:247], v[192:195], 0
  ds_read_b128 v[116:119], v4 offset:16384
  ds_read_b128 v[120:123], v4 offset:20480
  v_mul_f32 v88, v78, v88
  v_mfma_f32_16x16x32_bf16 v[64:67], a[248:251], v[208:211], v[64:67]
  v_mul_f32 v89, v78, v89
  v_mul_f32 v90, v78, v90
  v_mul_f32 v91, v78, v91
  v_mfma_f32_16x16x32_bf16 v[64:67], a[252:255], v[224:227], v[64:67]
  v_cvt_pk_bf16_f32 v96, v96, v124
  v_cvt_pk_bf16_f32 v97, v97, v125
  v_cvt_pk_bf16_f32 v88, v88, v89
  v_mfma_f32_16x16x32_bf16 v[64:67], v[60:63], v[240:243], v[64:67]
L_hop_0_1:
  s_cbranch_execz L_hop_0_2
  v_cvt_pk_bf16_f32 v98, v98, v126
  v_cvt_pk_bf16_f32 v99, v99, v127
  v_cvt_pk_bf16_f32 v89, v90, v91
  v_mfma_f32_16x16x32_bf16 v[64:67], v[92:95], a[216:219], v[64:67]
  buffer_store_dword v96, v7, s[24:27], s33 offen offset:0 nt
  v_mov_b32 v0, s5
  v_mfma_f32_16x16x32_bf16 v[64:67], v[100:103], a[232:235], v[64:67]
  v_mov_b32 v1, s6
  v_mfma_f32_16x16x32_bf16 v[124:127], v[100:103], a[236:239], 0
  buffer_store_dword v97, v7, s[24:27], s33 offen offset:384 nt
  v_mfma_f32_16x16x32_bf16 v[124:127], v[92:95], a[220:223], v[124:127]
  ds_write2st64_b32 v5, v16, v17 offset0:2 offset1:6
  v_mfma_f32_16x16x32_bf16 v[124:127], v[60:63], v[244:247], v[124:127]
  buffer_store_dword v98, v7, s[24:27], s33 offen offset:768 nt
  v_mfma_f32_16x16x32_bf16 v[124:127], a[252:255], v[228:231], v[124:127]
  ds_write2st64_b32 v5, v68, v69 offset0:10 offset1:14
  v_mfma_f32_16x16x32_bf16 v[124:127], a[248:251], v[212:215], v[124:127]
  buffer_store_dword v99, v7, s[24:27], s33 offen offset:1152 nt
  v_mfma_f32_16x16x32_bf16 v[124:127], a[244:247], v[196:199], v[124:127]
  s_waitcnt lgkmcnt(2)
  ds_write2st64_b32 v5, v72, v73 offset0:18 offset1:22
  v_mfma_f32_16x16x32_bf16 v[16:19], v[84:87], v[184:187], 0
  ds_write2st64_b32 v5, v80, v81 offset0:3 offset1:7
  v_mfma_f32_16x16x32_bf16 v[16:19], v[104:107], v[200:203], v[16:19]
  ds_write2st64_b32 v5, v56, v57 offset0:11 offset1:15
  ds_write2st64_b32 v5, v88, v89 offset0:19 offset1:23
  ds_write_b32 v0, v1
  v_mfma_f32_16x16x32_bf16 v[16:19], v[108:111], v[216:219], v[16:19]
  v_cvt_pk_bf16_f32 v64, v64, v124
  v_cvt_pk_bf16_f32 v65, v65, v125
  v_mfma_f32_16x16x32_bf16 v[16:19], v[112:115], v[232:235], v[16:19]
  s_waitcnt lgkmcnt(0)
  s_barrier
  v_mfma_f32_16x16x32_bf16 v[16:19], v[116:119], v[248:251], v[16:19]
  v_cvt_pk_bf16_f32 v66, v66, v126
  v_cvt_pk_bf16_f32 v67, v67, v127
  v_mfma_f32_16x16x32_bf16 v[16:19], v[120:123], a[224:227], v[16:19]
  buffer_store_dword v64, v8, s[24:27], s33 offen offset:0 nt
  v_mfma_f32_16x16x32_bf16 v[76:79], v[120:123], a[228:231], 0
  ds_read_b128 a[244:247], v3 offset:512
  ds_read_b128 a[248:251], v3 offset:4608
  v_mfma_f32_16x16x32_bf16 v[76:79], v[116:119], v[252:255], v[76:79]
  buffer_store_dword v65, v8, s[24:27], s33 offen offset:384 nt
  v_mfma_f32_16x16x32_bf16 v[76:79], v[112:115], v[236:239], v[76:79]
  ds_read_b128 a[252:255], v3 offset:8704
  ds_read_b128 v[56:59], v3 offset:12800
  v_mfma_f32_16x16x32_bf16 v[76:79], v[108:111], v[220:223], v[76:79]
  buffer_store_dword v66, v8, s[24:27], s33 offen offset:768 nt
  v_mfma_f32_16x16x32_bf16 v[76:79], v[104:107], v[204:207], v[76:79]
  s_waitcnt lgkmcnt(2)
  ds_read_b128 v[68:71], v3 offset:16896
  ds_read_b128 v[72:75], v3 offset:20992
  v_mfma_f32_16x16x32_bf16 v[76:79], v[84:87], v[188:191], v[76:79]
  buffer_store_dword v67, v8, s[24:27], s33 offen offset:1152 nt
  v_mfma_f32_16x16x32_bf16 v[60:63], a[244:247], v[184:187], 0
  v_mov_b32 v0, 155648
  v_mfma_f32_16x16x32_bf16 v[60:63], a[248:251], v[200:203], v[60:63]
  s_waitcnt lgkmcnt(2)
  ds_read2_b32 v[96:97], v0 offset0:0 offset1:2
  ds_read2_b32 v[98:99], v0 offset0:4 offset1:6
  v_mfma_f32_16x16x32_bf16 v[60:63], a[252:255], v[216:219], v[60:63]
  v_cvt_pk_bf16_f32 v16, v16, v76
  v_cvt_pk_bf16_f32 v17, v17, v77
  v_mfma_f32_16x16x32_bf16 v[60:63], v[56:59], v[232:235], v[60:63]
  s_waitcnt lgkmcnt(2)
  v_cvt_pk_bf16_f32 v18, v18, v78
  v_cvt_pk_bf16_f32 v19, v19, v79
  v_mfma_f32_16x16x32_bf16 v[60:63], v[68:71], v[248:251], v[60:63]
  buffer_store_dword v16, v7, s[24:27], s34 offen offset:0 nt
  v_mfma_f32_16x16x32_bf16 v[60:63], v[72:75], a[224:227], v[60:63]
  v_mfma_f32_16x16x32_bf16 v[100:103], v[72:75], a[228:231], 0
  buffer_store_dword v17, v7, s[24:27], s34 offen offset:384 nt
  v_mfma_f32_16x16x32_bf16 v[100:103], v[68:71], v[252:255], v[100:103]
  s_waitcnt lgkmcnt(0)
  v_or3_b32 v96, v96, v97, v98
  v_or_b32 v96, v96, v99
  v_mfma_f32_16x16x32_bf16 v[100:103], v[56:59], v[236:239], v[100:103]
  buffer_store_dword v18, v7, s[24:27], s34 offen offset:768 nt
  v_mfma_f32_16x16x32_bf16 v[100:103], a[252:255], v[220:223], v[100:103]
  ds_read_b128 v[64:67], v4 offset:512
  ds_read_b128 v[76:79], v4 offset:4608
  v_mfma_f32_16x16x32_bf16 v[100:103], a[248:251], v[204:207], v[100:103]
  buffer_store_dword v19, v7, s[24:27], s34 offen offset:1152 nt
  v_mfma_f32_16x16x32_bf16 v[100:103], a[244:247], v[188:191], v[100:103]
  ds_read_b128 v[80:83], v4 offset:8704
  ds_read_b128 v[84:87], v4 offset:12800
  v_mfma_f32_16x16x32_bf16 v[16:19], a[244:247], v[192:195], 0
  ds_read_b128 v[88:91], v4 offset:16896
  ds_read_b128 v[92:95], v4 offset:20992
  v_mfma_f32_16x16x32_bf16 v[16:19], a[248:251], v[208:211], v[16:19]
  v_readfirstlane_b32 s49, v96
  v_mfma_f32_16x16x32_bf16 v[16:19], a[252:255], v[224:227], v[16:19]
  v_cvt_pk_bf16_f32 v60, v60, v100
  v_cvt_pk_bf16_f32 v61, v61, v101
  v_mfma_f32_16x16x32_bf16 v[16:19], v[56:59], v[240:243], v[16:19]
  v_cvt_pk_bf16_f32 v62, v62, v102
  v_cvt_pk_bf16_f32 v63, v63, v103
  v_mfma_f32_16x16x32_bf16 v[16:19], v[68:71], a[216:219], v[16:19]
  buffer_store_dword v60, v7, s[24:27], s35 offen offset:0 nt
  v_mfma_f32_16x16x32_bf16 v[16:19], v[72:75], a[232:235], v[16:19]
  v_mfma_f32_16x16x32_bf16 v[96:99], v[72:75], a[236:239], 0
  buffer_store_dword v61, v7, s[24:27], s35 offen offset:384 nt
  v_mfma_f32_16x16x32_bf16 v[96:99], v[68:71], a[220:223], v[96:99]
  v_mfma_f32_16x16x32_bf16 v[96:99], v[56:59], v[244:247], v[96:99]
  buffer_store_dword v62, v7, s[24:27], s35 offen offset:768 nt
  v_mfma_f32_16x16x32_bf16 v[96:99], a[252:255], v[228:231], v[96:99]
  v_mfma_f32_16x16x32_bf16 v[96:99], a[248:251], v[212:215], v[96:99]
  buffer_store_dword v63, v7, s[24:27], s35 offen offset:1152 nt
  v_mfma_f32_16x16x32_bf16 v[96:99], a[244:247], v[196:199], v[96:99]
  s_waitcnt lgkmcnt(0)
  v_mfma_f32_16x16x32_bf16 v[56:59], v[64:67], v[184:187], 0
  v_mfma_f32_16x16x32_bf16 v[56:59], v[76:79], v[200:203], v[56:59]
  v_mfma_f32_16x16x32_bf16 v[56:59], v[80:83], v[216:219], v[56:59]
  v_cvt_pk_bf16_f32 v16, v16, v96
  v_cvt_pk_bf16_f32 v17, v17, v97
  v_mfma_f32_16x16x32_bf16 v[56:59], v[84:87], v[232:235], v[56:59]
  v_cvt_pk_bf16_f32 v18, v18, v98
  v_cvt_pk_bf16_f32 v19, v19, v99
  v_mfma_f32_16x16x32_bf16 v[56:59], v[88:91], v[248:251], v[56:59]
  buffer_store_dword v16, v8, s[24:27], s35 offen offset:0 nt
  v_mfma_f32_16x16x32_bf16 v[56:59], v[92:95], a[224:227], v[56:59]
  v_mfma_f32_16x16x32_bf16 v[60:63], v[92:95], a[228:231], 0
  buffer_store_dword v17, v8, s[24:27], s35 offen offset:384 nt
  v_mfma_f32_16x16x32_bf16 v[60:63], v[88:91], v[252:255], v[60:63]
  v_mfma_f32_16x16x32_bf16 v[60:63], v[84:87], v[236:239], v[60:63]
  buffer_store_dword v18, v8, s[24:27], s35 offen offset:768 nt
  v_mfma_f32_16x16x32_bf16 v[60:63], v[80:83], v[220:223], v[60:63]
  v_mfma_f32_16x16x32_bf16 v[60:63], v[76:79], v[204:207], v[60:63]
  buffer_store_dword v19, v8, s[24:27], s35 offen offset:1152 nt
  v_mfma_f32_16x16x32_bf16 v[60:63], v[64:67], v[188:191], v[60:63]
  s_nop 7
  v_cvt_pk_bf16_f32 v56, v56, v60
  v_cvt_pk_bf16_f32 v57, v57, v61
  v_cvt_pk_bf16_f32 v58, v58, v62
  v_cvt_pk_bf16_f32 v59, v59, v63
  buffer_store_dword v56, v7, s[24:27], s36 offen offset:0 nt
  buffer_store_dword v57, v7, s[24:27], s36 offen offset:384 nt
  buffer_store_dword v58, v7, s[24:27], s36 offen offset:768 nt
  buffer_store_dword v59, v7, s[24:27], s36 offen offset:1152 nt
  s_cmp_lg_u32 s49, 0
  s_cbranch_scc1 L_safe
L_fin:
L_end:
  s_endpgm
L_hop_1_1:
  s_cbranch_execz L_hop_1_2
L_pad3489:
L_k2:
  s_cmp_lg_u32 s59, 10
  s_cbranch_scc1 L_k7
  s_waitcnt vmcnt(30)
  v_mfma_f32_16x16x32_bf16 v[104:107], a[0:3], v[92:95], 0
  s_sub_u32 s49, s19, s18
  s_sub_u32 s50, s15, s99
  s_add_u32 s50, s50, 45360
  v_mfma_f32_16x16x32_bf16 v[104:107], a[12:15], v[96:99], v[104:107]
  s_mul_i32 s49, s49, s50
  s_mul_hi_u32 s49, s49, 384088
  s_add_u32 s49, s49, s19
  v_mfma_f32_16x16x32_bf16 v[104:107], a[24:27], v[136:139], v[104:107]
  s_and_b32 s50, s2, 7
  v_cvt_pk_bf16_f32 v66, v132, v133
  v_cvt_pk_bf16_f32 v67, v134, v135
  v_mfma_f32_16x16x32_bf16 v[104:107], a[36:39], v[116:119], v[104:107]
  s_waitcnt lgkmcnt(0)
  s_sub_u32 s49, s49, 1024
  v_subrev_u32 v54, s49, v52
  v_mfma_f32_16x16x32_bf16 v[104:107], a[48:51], v[80:83], v[104:107]
  v_subrev_u32 v55, s49, v53
  v_max_u32 v126, v54, v55
  v_mfma_f32_16x16x32_bf16 v[104:107], a[60:63], v[84:87], v[104:107]
  v_bfe_u32 v74, v11, 3, 3
  v_lshrrev_b32 v75, 6, v11
  v_mfma_f32_16x16x32_bf16 v[88:91], a[64:67], v[84:87], 0
  v_lshl_add_u32 v54, v54, 3, v74
  v_lshl_add_u32 v55, v55, 3, v75
  v_mfma_f32_16x16x32_bf16 v[88:91], a[52:55], v[80:83], v[88:91]
  v_readlane_b32 s12, v52, s50
  v_cmp_lt_u32 vcc, 2047, v126
  v_mfma_f32_16x16x32_bf16 v[88:91], a[40:43], v[116:119], v[88:91]
  v_mul_f32 v104, s42, v104
  v_mul_f32 v105, s42, v105
  v_mfma_f32_16x16x32_bf16 v[88:91], a[28:31], v[136:139], v[88:91]
  v_mul_f32 v106, s42, v106
  v_mul_f32 v107, s42, v107
  v_mfma_f32_16x16x32_bf16 v[88:91], a[16:19], v[96:99], v[88:91]
  v_cvt_pk_bf16_f32 v18, v104, v105
  v_cvt_pk_bf16_f32 v19, v106, v107
  v_mfma_f32_16x16x32_bf16 v[88:91], a[4:7], v[92:95], v[88:91]
  v_and_b32 v126, 56, v11
  v_mfma_f32_16x16x32_bf16 v[108:111], a[8:11], v[92:95], 0
  s_or_b32 s51, vcc_lo, vcc_hi
  v_cmp_lt_u32 vcc, v54, v55
  v_mfma_f32_16x16x32_bf16 v[108:111], a[20:23], v[96:99], v[108:111]
  s_sub_u32 s52, s12, s49
  s_sub_u32 s52, s52, 960
  s_lshr_b32 s52, s52, 7
  v_mfma_f32_16x16x32_bf16 v[108:111], a[32:35], v[136:139], v[108:111]
  s_or_b32 s51, s51, s52
  v_mul_f32 v88, s42, v88
  v_mul_f32 v89, s42, v89
  v_mfma_f32_16x16x32_bf16 v[108:111], a[44:47], v[116:119], v[108:111]
  v_mul_f32 v90, s42, v90
  v_mul_f32 v91, s42, v91
  v_mfma_f32_16x16x32_bf16 v[108:111], a[56:59], v[80:83], v[108:111]
  v_cvt_pk_bf16_f32 v104, v88, v89
  v_cvt_pk_bf16_f32 v105, v90, v91
  v_mfma_f32_16x16x32_bf16 v[108:111], a[68:71], v[84:87], v[108:111]
  v_lshrrev_b64 v[74:75], v126, vcc
  v_and_b32 v55, 0xff, v74
  v_mfma_f32_16x16x32_bf16 v[112:115], a[132:135], v[84:87], 0
  v_bcnt_u32_b32 v55, v55, 0
  v_mfma_f32_16x16x32_bf16 v[112:115], a[120:123], v[80:83], v[112:115]
  v_readlane_b32 s52, v55, s50
  v_mfma_f32_16x16x32_bf16 v[112:115], a[108:111], v[116:119], v[112:115]
  v_mul_f32 v108, s42, v108
  v_mul_f32 v109, s42, v109
  v_mfma_f32_16x16x32_bf16 v[112:115], a[96:99], v[136:139], v[112:115]
  s_sub_u32 s52, 7, s52
  v_mul_f32 v110, s42, v110
  v_mul_f32 v111, s42, v111
  v_mfma_f32_16x16x32_bf16 v[112:115], a[84:87], v[96:99], v[112:115]
  v_cvt_pk_bf16_f32 v106, v108, v109
  v_cvt_pk_bf16_f32 v107, v110, v111
  v_mfma_f32_16x16x32_bf16 v[112:115], a[72:75], v[92:95], v[112:115]
  v_cmp_eq_u32 vcc, s52, v55
  v_mfma_f32_16x16x32_bf16 v[88:91], a[76:79], v[92:95], 0
  v_mfma_f32_16x16x32_bf16 v[88:91], a[88:91], v[96:99], v[88:91]
  s_ff1_i32_b32 s52, vcc_lo
  s_and_b32 s52, s52, 7
  v_readlane_b32 s53, v54, s52
  v_mfma_f32_16x16x32_bf16 v[88:91], a[100:103], v[136:139], v[88:91]
  v_cvt_pk_bf16_f32 v128, v112, v113
  v_cvt_pk_bf16_f32 v129, v114, v115
  v_mfma_f32_16x16x32_bf16 v[88:91], a[112:115], v[116:119], v[88:91]
  s_lshr_b32 s53, s53, 3
  s_add_u32 s53, s53, s49
  s_sub_u32 s49, s53, s12
  v_mfma_f32_16x16x32_bf16 v[88:91], a[124:127], v[80:83], v[88:91]
  s_cmp_gt_i32 s49, 0
  s_cselect_b32 s45, 2, 1
  s_cselect_b32 s12, s53, s12
  v_mfma_f32_16x16x32_bf16 v[88:91], a[136:139], v[84:87], v[88:91]
  s_cselect_b32 s53, s52, s50
  s_cselect_b32 s96, 1, 6
  s_lshl_b32 s96, s96, 11
  v_mfma_f32_16x16x32_bf16 v[108:111], a[140:143], v[84:87], 0
  s_abs_i32 s49, s49
  s_cmp_lt_u32 s49, 235
  s_cselect_b32 s51, 1, s51
  v_mfma_f32_16x16x32_bf16 v[108:111], a[128:131], v[80:83], v[108:111]
  s_cmp_lt_u32 s49, 400
  s_cselect_b32 s14, 8, 0
  s_xnor_b32 s13, s12, s14
  v_mfma_f32_16x16x32_bf16 v[108:111], a[116:119], v[116:119], v[108:111]
  s_cmp_eq_u32 s51, 0
  v_cvt_pk_bf16_f32 v130, v88, v89
  v_cvt_pk_bf16_f32 v131, v90, v91
  v_mfma_f32_16x16x32_bf16 v[108:111], a[104:107], v[136:139], v[108:111]
  s_cselect_b32 s45, s45, 0
  s_cselect_b32 s96, s96, 0
  s_andn2_b32 s51, s2, 7
  v_mfma_f32_16x16x32_bf16 v[108:111], a[92:95], v[96:99], v[108:111]
  s_add_u32 s51, s51, s53
  s_lshl_b32 s51, s51, 9
  s_add_u32 s44, s51, 2097152
  v_mfma_f32_16x16x32_bf16 v[108:111], a[80:83], v[92:95], v[108:111]
  s_lshr_b32 s49, s45, 1
  s_lshl_b32 s49, s49, s52
  s_lshl_b32 s49, s49, s14
  v_mfma_f32_16x16x32_bf16 v[88:91], v[92:95], a[144:147], 0
  s_lshl_b32 s54, s3, 2
  s_add_u32 s54, s54, 155712
  v_mov_b32 v54, s54
  v_mfma_f32_16x16x32_bf16 v[88:91], v[96:99], a[156:159], v[88:91]
  v_mov_b32 v55, s49
  v_mfma_f32_16x16x32_bf16 v[88:91], v[136:139], a[168:171], v[88:91]
  v_cvt_pk_bf16_f32 v132, v108, v109
  v_cvt_pk_bf16_f32 v133, v110, v111
  v_mfma_f32_16x16x32_bf16 v[88:91], v[116:119], a[180:183], v[88:91]
  ds_read_b128 a[244:247], v1 offset:22528
  v_mfma_f32_16x16x32_bf16 v[88:91], v[80:83], a[192:195], v[88:91]
  ds_read_b128 a[248:251], v0 offset:22528
  v_mfma_f32_16x16x32_bf16 v[88:91], v[84:87], a[204:207], v[88:91]
  ds_read_b128 a[252:255], v1 offset:14336
  v_mfma_f32_16x16x32_bf16 v[140:143], v[84:87], a[208:211], 0
  ds_read_b128 v[144:147], v0 offset:14336
  v_mfma_f32_16x16x32_bf16 v[140:143], v[80:83], a[196:199], v[140:143]
  ds_read_b128 v[148:151], v1 offset:6144
  v_mfma_f32_16x16x32_bf16 v[140:143], v[116:119], a[184:187], v[140:143]
  v_cvt_pk_bf16_f32 v108, v88, v89
  v_cvt_pk_bf16_f32 v109, v90, v91
  v_mfma_f32_16x16x32_bf16 v[140:143], v[136:139], a[172:175], v[140:143]
  ds_read_b128 v[152:155], v0 offset:6144
  v_mfma_f32_16x16x32_bf16 v[140:143], v[96:99], a[160:163], v[140:143]
  ds_write_b32 v54, v55
  v_mfma_f32_16x16x32_bf16 v[140:143], v[92:95], a[148:151], v[140:143]
  v_mfma_f32_16x16x32_bf16 v[88:91], v[92:95], a[152:155], 0
  v_mfma_f32_16x16x32_bf16 v[88:91], v[96:99], a[164:167], v[88:91]
  v_mfma_f32_16x16x32_bf16 v[88:91], v[136:139], a[176:179], v[88:91]
  s_waitcnt lgkmcnt(0)
  v_cvt_pk_bf16_f32 v112, v140, v141
  v_cvt_pk_bf16_f32 v113, v142, v143
  v_mfma_f32_16x16x32_bf16 v[88:91], v[116:119], a[188:191], v[88:91]
  s_branch L_r259
L_hop_2_1:
  s_cbranch_execz L_walk
L_pad3648:
L_k7:
  s_cmp_lg_u32 s59, 7
  s_cbranch_scc1 L_kh
  v_mfma_f32_16x16x32_bf16 v[104:107], a[0:3], v[92:95], 0
  s_waitcnt lgkmcnt(0)
  s_sub_u32 s49, s16, s18
  s_sub_u32 s50, s15, s60
  v_mfma_f32_16x16x32_bf16 v[104:107], a[12:15], v[96:99], v[104:107]
  s_add_u32 s50, s50, 45360
  s_mul_i32 s49, s49, s50
  s_mul_hi_u32 s49, s49, 384088
  v_mfma_f32_16x16x32_bf16 v[104:107], a[24:27], v[136:139], v[104:107]
  s_add_u32 s49, s49, s16
  v_cvt_pk_bf16_f32 v66, v132, v133
  v_cvt_pk_bf16_f32 v67, v134, v135
  v_mfma_f32_16x16x32_bf16 v[104:107], a[36:39], v[116:119], v[104:107]
  s_and_b32 s51, s2, 7
  s_lshl_b32 s51, s51, 3
  v_mfma_f32_16x16x32_bf16 v[104:107], a[48:51], v[80:83], v[104:107]
  v_and_b32 v74, 56, v11
  v_lshl_add_u32 v54, v74, 3, s51
  v_mfma_f32_16x16x32_bf16 v[104:107], a[60:63], v[84:87], v[104:107]
  s_lshl_b32 s51, s51, 3
  v_add_u32 v55, s51, v74
  v_mov_b32 v74, s49
  v_mfma_f32_16x16x32_bf16 v[88:91], a[64:67], v[84:87], 0
  buffer_store_dword v74, v54, s[20:23], s44 offen sc1
  v_mfma_f32_16x16x32_bf16 v[88:91], a[52:55], v[80:83], v[88:91]
  v_mfma_f32_16x16x32_bf16 v[88:91], a[40:43], v[116:119], v[88:91]
  v_mul_f32 v104, s42, v104
  v_mul_f32 v105, s42, v105
  v_mfma_f32_16x16x32_bf16 v[88:91], a[28:31], v[136:139], v[88:91]
  v_mul_f32 v106, s42, v106
  v_mul_f32 v107, s42, v107
  v_mfma_f32_16x16x32_bf16 v[88:91], a[16:19], v[96:99], v[88:91]
  v_cvt_pk_bf16_f32 v18, v104, v105
  v_cvt_pk_bf16_f32 v19, v106, v107
  v_mfma_f32_16x16x32_bf16 v[88:91], a[4:7], v[92:95], v[88:91]
  buffer_store_dword v74, v55, s[20:23], s44 offen offset:4 sc1
  v_mfma_f32_16x16x32_bf16 v[108:111], a[8:11], v[92:95], 0
  s_branch L_r220
L_hop_3_1:
  s_cbranch_execz L_walk
L_pad3690:
L_kh:
  s_cmp_lt_u32 s59, 14
  s_cbranch_scc1 L_k11
  s_waitcnt lgkmcnt(0)
  v_mfma_f32_16x16x32_bf16 v[104:107], a[132:135], v[84:87], 0
  s_lshl_b32 s5, s3, 3
  v_mfma_f32_16x16x32_bf16 v[104:107], a[120:123], v[80:83], v[104:107]
  s_add_u32 s5, s5, 155648
  v_mov_b32 v54, s5
  v_mfma_f32_16x16x32_bf16 v[104:107], a[108:111], v[116:119], v[104:107]
  v_cvt_pk_bf16_f32 v66, v132, v133
  v_cvt_pk_bf16_f32 v67, v134, v135
  v_mfma_f32_16x16x32_bf16 v[104:107], a[96:99], v[136:139], v[104:107]
  ds_read_b128 a[244:247], v1 offset:22528
  v_mfma_f32_16x16x32_bf16 v[104:107], a[84:87], v[96:99], v[104:107]
  ds_read_b128 a[248:251], v0 offset:22528
  v_mfma_f32_16x16x32_bf16 v[104:107], a[72:75], v[92:95], v[104:107]
  ds_read_b128 a[252:255], v1 offset:14336
  v_mfma_f32_16x16x32_bf16 v[108:111], a[76:79], v[92:95], 0
  ds_read_b128 v[88:91], v0 offset:14336
  v_mfma_f32_16x16x32_bf16 v[108:111], a[88:91], v[96:99], v[108:111]
  ds_read_b128 v[112:115], v1 offset:6144
  v_mfma_f32_16x16x32_bf16 v[108:111], a[100:103], v[136:139], v[108:111]
  v_cvt_pk_bf16_f32 v140, v104, v105
  v_cvt_pk_bf16_f32 v141, v106, v107
  v_mfma_f32_16x16x32_bf16 v[108:111], a[112:115], v[116:119], v[108:111]
  ds_read_b128 v[148:151], v0 offset:6144
  v_cndmask_b32 v160, v32, v48, s[100:101]
  v_mfma_f32_16x16x32_bf16 v[108:111], a[124:127], v[80:83], v[108:111]
  v_cndmask_b32 v161, v33, v49, s[100:101]
  v_cndmask_b32 v162, v34, v50, s[100:101]
  v_mfma_f32_16x16x32_bf16 v[108:111], a[136:139], v[84:87], v[108:111]
  v_cndmask_b32 v163, v35, v51, s[100:101]
  v_cndmask_b32 v164, v28, v44, s[100:101]
  v_mfma_f32_16x16x32_bf16 v[128:131], a[140:143], v[84:87], 0
  v_cndmask_b32 v165, v29, v45, s[100:101]
  v_cndmask_b32 v166, v30, v46, s[100:101]
  v_mfma_f32_16x16x32_bf16 v[128:131], a[128:131], v[80:83], v[128:131]
  v_cndmask_b32 v167, v31, v47, s[100:101]
  v_cndmask_b32 v104, v24, v40, s[100:101]
  v_mfma_f32_16x16x32_bf16 v[128:131], a[116:119], v[116:119], v[128:131]
  v_cvt_pk_bf16_f32 v142, v108, v109
  v_cvt_pk_bf16_f32 v143, v110, v111
  v_mfma_f32_16x16x32_bf16 v[128:131], a[104:107], v[136:139], v[128:131]
  v_cndmask_b32 v105, v25, v41, s[100:101]
  v_cndmask_b32 v106, v26, v42, s[100:101]
  v_mfma_f32_16x16x32_bf16 v[128:131], a[92:95], v[96:99], v[128:131]
  v_cndmask_b32 v107, v27, v43, s[100:101]
  v_mfma_f32_16x16x32_bf16 v[128:131], a[80:83], v[92:95], v[128:131]
  s_waitcnt lgkmcnt(0)
  v_mfma_f32_16x16x32_bf16 v[108:111], a[132:135], a[244:247], 0
  v_mfma_f32_16x16x32_bf16 v[108:111], a[120:123], a[248:251], v[108:111]
  v_mfma_f32_16x16x32_bf16 v[108:111], a[108:111], a[252:255], v[108:111]
  v_cvt_pk_bf16_f32 v144, v128, v129
  v_cvt_pk_bf16_f32 v145, v130, v131
  v_mfma_f32_16x16x32_bf16 v[108:111], a[96:99], v[88:91], v[108:111]
  v_mfma_f32_16x16x32_bf16 v[108:111], a[84:87], v[112:115], v[108:111]
  s_waitcnt lgkmcnt(0)
  s_barrier
  v_mfma_f32_16x16x32_bf16 v[108:111], a[72:75], v[148:151], v[108:111]
  v_mfma_f32_16x16x32_bf16 v[128:131], a[76:79], v[148:151], 0
  v_mfma_f32_16x16x32_bf16 v[128:131], a[88:91], v[112:115], v[128:131]
  v_mfma_f32_16x16x32_bf16 v[128:131], a[100:103], v[88:91], v[128:131]
  v_cvt_pk_bf16_f32 v152, v108, v109
  v_cvt_pk_bf16_f32 v153, v110, v111
  v_mfma_f32_16x16x32_bf16 v[128:131], a[112:115], a[252:255], v[128:131]
  v_mfma_f32_16x16x32_bf16 v[128:131], a[124:127], a[248:251], v[128:131]
  v_mfma_f32_16x16x32_bf16 v[128:131], a[136:139], a[244:247], v[128:131]
  v_mfma_f32_16x16x32_bf16 v[108:111], a[140:143], a[244:247], 0
  v_mfma_f32_16x16x32_bf16 v[108:111], a[128:131], a[248:251], v[108:111]
  v_mfma_f32_16x16x32_bf16 v[108:111], a[116:119], a[252:255], v[108:111]
  v_cvt_pk_bf16_f32 v154, v128, v129
  v_cvt_pk_bf16_f32 v155, v130, v131
  v_mfma_f32_16x16x32_bf16 v[108:111], a[104:107], v[88:91], v[108:111]
  v_mfma_f32_16x16x32_bf16 v[108:111], a[92:95], v[112:115], v[108:111]
  v_mfma_f32_16x16x32_bf16 v[108:111], a[80:83], v[148:151], v[108:111]
  v_mfma_f32_16x16x32_bf16 v[128:131], v[70:73], v[76:79], v[36:39]
  v_mfma_f32_16x16x32_bf16 v[128:131], v[68:71], v[12:15], v[128:131]
  v_mfma_f32_16x16x32_bf16 v[132:135], v[122:125], v[76:79], v[32:35]
  v_cvt_pk_bf16_f32 v156, v108, v109
  v_cvt_pk_bf16_f32 v157, v110, v111
  v_mfma_f32_16x16x32_bf16 v[132:135], v[120:123], v[12:15], v[132:135]
  v_mfma_f32_16x16x32_bf16 v[168:171], v[142:145], v[76:79], v[164:167]
  v_exp_f32 v128, v128
  v_mfma_f32_16x16x32_bf16 v[168:171], v[140:143], v[12:15], v[168:171]
  v_exp_f32 v129, v129
  v_mfma_f32_16x16x32_bf16 v[172:175], v[154:157], v[76:79], v[104:107]
  v_exp_f32 v130, v130
  v_mfma_f32_16x16x32_bf16 v[172:175], v[152:155], v[12:15], v[172:175]
  v_exp_f32 v131, v131
  v_mfma_f32_16x16x32_bf16 v[104:107], v[68:71], v[100:103], v[40:43]
  v_exp_f32 v132, v132
  v_mfma_f32_16x16x32_bf16 v[104:107], v[70:73], v[14:17], v[104:107]
  v_exp_f32 v133, v133
  v_mfma_f32_16x16x32_bf16 v[108:111], v[120:123], v[100:103], v[36:39]
  v_exp_f32 v134, v134
  v_mfma_f32_16x16x32_bf16 v[108:111], v[122:125], v[14:17], v[108:111]
  v_exp_f32 v135, v135
  v_mfma_f32_16x16x32_bf16 v[72:75], v[140:143], v[100:103], v[160:163]
  v_exp_f32 v168, v168
  v_mfma_f32_16x16x32_bf16 v[72:75], v[142:145], v[14:17], v[72:75]
  v_exp_f32 v169, v169
  v_mfma_f32_16x16x32_bf16 v[68:71], v[152:155], v[100:103], v[164:167]
  v_exp_f32 v170, v170
  v_mfma_f32_16x16x32_bf16 v[68:71], v[154:157], v[14:17], v[68:71]
  v_exp_f32 v171, v171
  v_mfma_f32_16x16x32_bf16 v[100:103], v[92:95], a[144:147], 0
  v_exp_f32 v172, v172
  v_mfma_f32_16x16x32_bf16 v[100:103], v[96:99], a[156:159], v[100:103]
  v_exp_f32 v173, v173
  v_mfma_f32_16x16x32_bf16 v[100:103], v[136:139], a[168:171], v[100:103]
  v_exp_f32 v174, v174
  v_mfma_f32_16x16x32_bf16 v[100:103], v[116:119], a[180:183], v[100:103]
  v_exp_f32 v175, v175
  v_mfma_f32_16x16x32_bf16 v[100:103], v[80:83], a[192:195], v[100:103]
  v_cvt_pk_bf16_f32 v128, v128, v129
  v_cvt_pk_bf16_f32 v129, v130, v131
  v_mfma_f32_16x16x32_bf16 v[100:103], v[84:87], a[204:207], v[100:103]
  v_cvt_pk_bf16_f32 v130, v132, v133
  v_cvt_pk_bf16_f32 v131, v134, v135
  v_mfma_f32_16x16x32_bf16 v[124:127], v[84:87], a[208:211], 0
  v_cvt_pk_bf16_f32 v132, v168, v169
  v_cvt_pk_bf16_f32 v133, v170, v171
  v_mfma_f32_16x16x32_bf16 v[124:127], v[80:83], a[196:199], v[124:127]
  v_cvt_pk_bf16_f32 v134, v172, v173
  v_cvt_pk_bf16_f32 v135, v174, v175
  v_mfma_f32_16x16x32_bf16 v[124:127], v[116:119], a[184:187], v[124:127]
  v_cvt_pk_bf16_f32 v76, v100, v101
  v_cvt_pk_bf16_f32 v77, v102, v103
  v_mfma_f32_16x16x32_bf16 v[124:127], v[136:139], a[172:175], v[124:127]
  v_exp_f32 v104, v104
  v_mfma_f32_16x16x32_bf16 v[124:127], v[96:99], a[160:163], v[124:127]
  v_exp_f32 v105, v105
  v_mfma_f32_16x16x32_bf16 v[124:127], v[92:95], a[148:151], v[124:127]
  v_exp_f32 v106, v106
  v_mfma_f32_16x16x32_bf16 v[100:103], v[92:95], a[152:155], 0
  v_exp_f32 v107, v107
  v_mfma_f32_16x16x32_bf16 v[100:103], v[96:99], a[164:167], v[100:103]
  v_exp_f32 v108, v108
  v_mfma_f32_16x16x32_bf16 v[100:103], v[136:139], a[176:179], v[100:103]
  v_cvt_pk_bf16_f32 v120, v124, v125
  v_cvt_pk_bf16_f32 v121, v126, v127
  v_mfma_f32_16x16x32_bf16 v[100:103], v[116:119], a[188:191], v[100:103]
  v_exp_f32 v109, v109
  v_mfma_f32_16x16x32_bf16 v[100:103], v[80:83], a[200:203], v[100:103]
  v_exp_f32 v110, v110
  v_mfma_f32_16x16x32_bf16 v[100:103], v[84:87], a[212:215], v[100:103]
  v_exp_f32 v111, v111
  v_mfma_f32_16x16x32_bf16 v[136:139], v[148:151], a[144:147], 0
  v_exp_f32 v72, v72
  v_mfma_f32_16x16x32_bf16 v[136:139], v[112:115], a[156:159], v[136:139]
  v_exp_f32 v73, v73
  v_mfma_f32_16x16x32_bf16 v[136:139], v[88:91], a[168:171], v[136:139]
  v_cvt_pk_bf16_f32 v124, v100, v101
  v_cvt_pk_bf16_f32 v125, v102, v103
  v_mfma_f32_16x16x32_bf16 v[136:139], a[252:255], a[180:183], v[136:139]
  ds_read_b128 v[80:83], v3 offset:0
  v_cvt_pk_bf16_f32 v104, v104, v105
  v_mfma_f32_16x16x32_bf16 v[136:139], a[248:251], a[192:195], v[136:139]
  ds_read_b128 v[84:87], v3 offset:4096
  v_cvt_pk_bf16_f32 v105, v106, v107
  v_mfma_f32_16x16x32_bf16 v[136:139], a[244:247], a[204:207], v[136:139]
  ds_read_b128 v[92:95], v3 offset:8192
  v_cvt_pk_bf16_f32 v106, v108, v109
  v_mfma_f32_16x16x32_bf16 v[140:143], a[244:247], a[208:211], 0
  ds_read_b128 v[96:99], v3 offset:12288
  v_cvt_pk_bf16_f32 v107, v110, v111
  v_mfma_f32_16x16x32_bf16 v[140:143], a[248:251], a[196:199], v[140:143]
  ds_read_b128 v[100:103], v3 offset:16384
  v_cvt_pk_bf16_f32 v108, v72, v73
  v_mfma_f32_16x16x32_bf16 v[140:143], a[252:255], a[184:187], v[140:143]
  v_cvt_pk_bf16_f32 v78, v136, v137
  v_cvt_pk_bf16_f32 v79, v138, v139
  v_mfma_f32_16x16x32_bf16 v[140:143], v[88:91], a[172:175], v[140:143]
  ds_read_b128 v[116:119], v3 offset:20480
  v_mfma_f32_16x16x32_bf16 v[140:143], v[112:115], a[160:163], v[140:143]
  v_exp_f32 v74, v74
  v_mfma_f32_16x16x32_bf16 v[140:143], v[148:151], a[148:151], v[140:143]
  v_exp_f32 v75, v75
  v_mfma_f32_16x16x32_bf16 v[144:147], v[148:151], a[152:155], 0
  v_exp_f32 v68, v68
  v_mfma_f32_16x16x32_bf16 v[144:147], v[112:115], a[164:167], v[144:147]
  v_exp_f32 v69, v69
  v_mfma_f32_16x16x32_bf16 v[144:147], v[88:91], a[176:179], v[144:147]
  v_cvt_pk_bf16_f32 v122, v140, v141
  v_cvt_pk_bf16_f32 v123, v142, v143
  v_mfma_f32_16x16x32_bf16 v[144:147], a[252:255], a[188:191], v[144:147]
  v_mov_b64 v[136:137], 0
  v_cvt_pk_bf16_f32 v109, v74, v75
  v_mfma_f32_16x16x32_bf16 v[144:147], a[248:251], a[200:203], v[144:147]
  v_exp_f32 v70, v70
  v_mfma_f32_16x16x32_bf16 v[144:147], a[244:247], a[212:215], v[144:147]
  s_waitcnt lgkmcnt(0)
  v_exp_f32 v71, v71
  v_mfma_f32_16x16x32_bf16 v[88:91], v[80:83], v[184:187], 0
  v_cvt_pk_bf16_f32 v110, v68, v69
  v_cvt_pk_bf16_f32 v111, v70, v71
  v_mfma_f32_16x16x32_bf16 v[88:91], v[84:87], v[200:203], v[88:91]
  v_mfma_f32_16x16x32_bf16 v[88:91], v[92:95], v[216:219], v[88:91]
  v_cvt_pk_bf16_f32 v126, v144, v145
  v_cvt_pk_bf16_f32 v127, v146, v147
  v_mfma_f32_16x16x32_bf16 v[88:91], v[96:99], v[232:235], v[88:91]
  v_mov_b64 v[68:69], 0
  v_mfma_f32_16x16x32_bf16 v[88:91], v[100:103], v[248:251], v[88:91]
  v_mfma_f32_16x16x32_bf16 v[88:91], v[116:119], a[224:227], v[88:91]
  v_smfmac_f32_16x16x64_bf16 v[136:139], a[240:243], v[128:135], v10
  v_mfma_f32_16x16x32_bf16 v[144:147], v[76:79], v[132:135], 0
  v_mfma_f32_16x16x32_bf16 v[144:147], v[56:59], v[128:131], v[144:147]
  v_mfma_f32_16x16x32_bf16 v[148:151], v[60:63], v[128:131], 0
  v_mfma_f32_16x16x32_bf16 v[148:151], v[120:123], v[132:135], v[148:151]
  v_mfma_f32_16x16x32_bf16 v[140:143], v[124:127], v[132:135], 0
  v_add_f32 v136, v136, v137
  v_mfma_f32_16x16x32_bf16 v[140:143], v[64:67], v[128:131], v[140:143]
  v_rcp_f32 v138, v136
  v_smfmac_f32_16x16x64_bf16 v[68:71], a[240:243], v[104:111], v10
  v_mul_f32 v144, v138, v144
  v_mul_f32 v145, v138, v145
  v_mfma_f32_16x16x32_bf16 v[72:75], v[76:79], v[108:111], 0
  v_mul_f32 v146, v138, v146
  v_mul_f32 v147, v138, v147
  v_mfma_f32_16x16x32_bf16 v[72:75], v[56:59], v[104:107], v[72:75]
  v_cvt_pk_bf16_f32 v144, v144, v145
  v_cvt_pk_bf16_f32 v145, v146, v147
  v_mfma_f32_16x16x32_bf16 v[76:79], v[60:63], v[104:107], 0
  v_mul_f32 v148, v138, v148
  v_mul_f32 v149, v138, v149
  v_mfma_f32_16x16x32_bf16 v[76:79], v[120:123], v[108:111], v[76:79]
  v_mul_f32 v150, v138, v150
  v_mul_f32 v151, v138, v151
  v_mfma_f32_16x16x32_bf16 v[56:59], v[124:127], v[108:111], 0
  v_cvt_pk_bf16_f32 v148, v148, v149
  v_cvt_pk_bf16_f32 v149, v150, v151
  v_mfma_f32_16x16x32_bf16 v[56:59], v[64:67], v[104:107], v[56:59]
  v_mul_f32 v140, v138, v140
  v_mul_f32 v141, v138, v141
  v_mfma_f32_16x16x32_bf16 v[60:63], v[116:119], a[228:231], 0
  v_mul_f32 v142, v138, v142
  v_mul_f32 v143, v138, v143
  v_mfma_f32_16x16x32_bf16 v[60:63], v[100:103], v[252:255], v[60:63]
  v_cvt_pk_bf16_f32 v140, v140, v141
  v_cvt_pk_bf16_f32 v141, v142, v143
  v_mfma_f32_16x16x32_bf16 v[60:63], v[96:99], v[236:239], v[60:63]
  ds_read_b128 v[104:107], v4 offset:0
  ds_read_b128 v[108:111], v4 offset:4096
  v_mfma_f32_16x16x32_bf16 v[60:63], v[92:95], v[220:223], v[60:63]
  ds_read_b128 v[120:123], v4 offset:8192
  ds_read_b128 v[124:127], v4 offset:12288
  v_mfma_f32_16x16x32_bf16 v[60:63], v[84:87], v[204:207], v[60:63]
L_hop_0_2:
  s_cbranch_execz L_walk
  ds_read_b128 v[128:131], v4 offset:16384
  ds_read_b128 v[132:135], v4 offset:20480
  v_mfma_f32_16x16x32_bf16 v[60:63], v[80:83], v[188:191], v[60:63]
  v_max3_f32 v9, v136, v138, v9
  v_add_f32 v68, v68, v69
  v_mfma_f32_16x16x32_bf16 v[112:115], v[80:83], v[192:195], 0
  ds_write2st64_b32 v5, v144, v145 offset0:0 offset1:4
  v_mfma_f32_16x16x32_bf16 v[112:115], v[84:87], v[208:211], v[112:115]
  ds_write2st64_b32 v5, v148, v149 offset0:8 offset1:12
  v_mfma_f32_16x16x32_bf16 v[112:115], v[92:95], v[224:227], v[112:115]
  v_cvt_pk_bf16_f32 v88, v88, v60
  v_cvt_pk_bf16_f32 v89, v89, v61
  v_mfma_f32_16x16x32_bf16 v[112:115], v[96:99], v[240:243], v[112:115]
  v_cvt_pk_bf16_f32 v90, v90, v62
  v_cvt_pk_bf16_f32 v91, v91, v63
  v_mfma_f32_16x16x32_bf16 v[112:115], v[100:103], a[216:219], v[112:115]
  buffer_store_dword v88, v7, s[24:27], s33 offen offset:0 nt
  v_mfma_f32_16x16x32_bf16 v[112:115], v[116:119], a[232:235], v[112:115]
  ds_write2st64_b32 v5, v140, v141 offset0:16 offset1:20
  v_mfma_f32_16x16x32_bf16 v[136:139], v[116:119], a[236:239], 0
  v_rcp_f32 v70, v68
  v_mfma_f32_16x16x32_bf16 v[136:139], v[100:103], a[220:223], v[136:139]
  buffer_store_dword v89, v7, s[24:27], s33 offen offset:384 nt
  v_mfma_f32_16x16x32_bf16 v[136:139], v[96:99], v[244:247], v[136:139]
  ds_read_b128 a[244:247], v3 offset:512
  ds_read_b128 a[248:251], v3 offset:4608
  v_mfma_f32_16x16x32_bf16 v[136:139], v[92:95], v[228:231], v[136:139]
  ds_read_b128 a[252:255], v3 offset:8704
  ds_read_b128 v[60:63], v3 offset:12800
  v_mfma_f32_16x16x32_bf16 v[136:139], v[84:87], v[212:215], v[136:139]
  buffer_store_dword v90, v7, s[24:27], s33 offen offset:768 nt
  v_mfma_f32_16x16x32_bf16 v[136:139], v[80:83], v[196:199], v[136:139]
  s_waitcnt lgkmcnt(7)
  ds_read_b128 v[64:67], v3 offset:16896
  ds_read_b128 v[84:87], v3 offset:20992
  v_mfma_f32_16x16x32_bf16 v[92:95], v[104:107], v[184:187], 0
  v_mul_f32 v72, v70, v72
  v_mul_f32 v73, v70, v73
  v_mfma_f32_16x16x32_bf16 v[92:95], v[108:111], v[200:203], v[92:95]
  buffer_store_dword v91, v7, s[24:27], s33 offen offset:1152 nt
  v_mfma_f32_16x16x32_bf16 v[92:95], v[120:123], v[216:219], v[92:95]
  v_cvt_pk_bf16_f32 v112, v112, v136
  v_cvt_pk_bf16_f32 v113, v113, v137
  v_mfma_f32_16x16x32_bf16 v[92:95], v[124:127], v[232:235], v[92:95]
  v_cvt_pk_bf16_f32 v114, v114, v138
  v_cvt_pk_bf16_f32 v115, v115, v139
  v_mfma_f32_16x16x32_bf16 v[92:95], v[128:131], v[248:251], v[92:95]
  buffer_store_dword v112, v8, s[24:27], s33 offen offset:0 nt
  v_mfma_f32_16x16x32_bf16 v[92:95], v[132:135], a[224:227], v[92:95]
  v_mul_f32 v74, v70, v74
  v_mul_f32 v75, v70, v75
  v_mfma_f32_16x16x32_bf16 v[80:83], v[132:135], a[228:231], 0
  v_cvt_pk_bf16_f32 v72, v72, v73
  v_cvt_pk_bf16_f32 v73, v74, v75
  v_mfma_f32_16x16x32_bf16 v[80:83], v[128:131], v[252:255], v[80:83]
  buffer_store_dword v113, v8, s[24:27], s33 offen offset:384 nt
  v_mfma_f32_16x16x32_bf16 v[80:83], v[124:127], v[236:239], v[80:83]
  v_mul_f32 v76, v70, v76
  v_mul_f32 v77, v70, v77
  v_mfma_f32_16x16x32_bf16 v[80:83], v[120:123], v[220:223], v[80:83]
  v_mul_f32 v78, v70, v78
  v_mul_f32 v79, v70, v79
  v_mfma_f32_16x16x32_bf16 v[80:83], v[108:111], v[204:207], v[80:83]
  buffer_store_dword v114, v8, s[24:27], s33 offen offset:768 nt
  v_mfma_f32_16x16x32_bf16 v[80:83], v[104:107], v[188:191], v[80:83]
  s_waitcnt lgkmcnt(0)
  v_cvt_pk_bf16_f32 v76, v76, v77
  v_cvt_pk_bf16_f32 v77, v78, v79
  v_mfma_f32_16x16x32_bf16 v[88:91], a[244:247], v[184:187], 0
  v_mul_f32 v56, v70, v56
  v_mul_f32 v57, v70, v57
  v_mfma_f32_16x16x32_bf16 v[88:91], a[248:251], v[200:203], v[88:91]
  buffer_store_dword v115, v8, s[24:27], s33 offen offset:1152 nt
  v_mfma_f32_16x16x32_bf16 v[88:91], a[252:255], v[216:219], v[88:91]
  s_add_u32 s33, s33, s98
  v_cvt_pk_bf16_f32 v92, v92, v80
  v_cvt_pk_bf16_f32 v93, v93, v81
  v_mfma_f32_16x16x32_bf16 v[88:91], v[60:63], v[232:235], v[88:91]
  v_cvt_pk_bf16_f32 v94, v94, v82
  v_cvt_pk_bf16_f32 v95, v95, v83
  v_mfma_f32_16x16x32_bf16 v[88:91], v[64:67], v[248:251], v[88:91]
  buffer_store_dword v92, v7, s[24:27], s34 offen offset:0 nt
  v_mfma_f32_16x16x32_bf16 v[88:91], v[84:87], a[224:227], v[88:91]
  v_mul_f32 v58, v70, v58
  v_mul_f32 v59, v70, v59
  v_mfma_f32_16x16x32_bf16 v[96:99], v[84:87], a[228:231], 0
  v_cvt_pk_bf16_f32 v56, v56, v57
  v_cvt_pk_bf16_f32 v57, v58, v59
  v_mfma_f32_16x16x32_bf16 v[96:99], v[64:67], v[252:255], v[96:99]
  buffer_store_dword v93, v7, s[24:27], s34 offen offset:384 nt
  v_mfma_f32_16x16x32_bf16 v[96:99], v[60:63], v[236:239], v[96:99]
  ds_read_b128 v[80:83], v4 offset:512
  v_max3_f32 v9, v68, v70, v9
  v_mfma_f32_16x16x32_bf16 v[96:99], a[252:255], v[220:223], v[96:99]
  ds_write2st64_b32 v5, v72, v73 offset0:1 offset1:5
  v_mfma_f32_16x16x32_bf16 v[96:99], a[248:251], v[204:207], v[96:99]
  buffer_store_dword v94, v7, s[24:27], s34 offen offset:768 nt
  v_mfma_f32_16x16x32_bf16 v[96:99], a[244:247], v[188:191], v[96:99]
  ds_write2st64_b32 v5, v76, v77 offset0:9 offset1:13
  v_mfma_f32_16x16x32_bf16 v[68:71], a[244:247], v[192:195], 0
  ds_write2st64_b32 v5, v56, v57 offset0:17 offset1:21
  v_mfma_f32_16x16x32_bf16 v[68:71], a[248:251], v[208:211], v[68:71]
  buffer_store_dword v95, v7, s[24:27], s34 offen offset:1152 nt
  v_mfma_f32_16x16x32_bf16 v[68:71], a[252:255], v[224:227], v[68:71]
  s_add_u32 s34, s34, s98
  v_cvt_pk_bf16_f32 v88, v88, v96
  v_cvt_pk_bf16_f32 v89, v89, v97
  v_mfma_f32_16x16x32_bf16 v[68:71], v[60:63], v[240:243], v[68:71]
  v_cvt_pk_bf16_f32 v90, v90, v98
  v_cvt_pk_bf16_f32 v91, v91, v99
  v_mfma_f32_16x16x32_bf16 v[68:71], v[64:67], a[216:219], v[68:71]
  buffer_store_dword v88, v7, s[24:27], s35 offen offset:0 nt
  v_mfma_f32_16x16x32_bf16 v[68:71], v[84:87], a[232:235], v[68:71]
  ds_read_b128 v[72:75], v4 offset:4608
  v_cmp_nge_f32 vcc, 0x53800000, v9
  v_mfma_f32_16x16x32_bf16 v[100:103], v[84:87], a[236:239], 0
  ds_read_b128 v[92:95], v4 offset:8704
  ds_read_b128 v[96:99], v4 offset:12800
  v_mfma_f32_16x16x32_bf16 v[100:103], v[64:67], a[220:223], v[100:103]
  buffer_store_dword v89, v7, s[24:27], s35 offen offset:384 nt
  v_mfma_f32_16x16x32_bf16 v[100:103], v[60:63], v[244:247], v[100:103]
  s_or_b32 s6, vcc_lo, vcc_hi
  ds_read_b128 v[76:79], v4 offset:16896
  v_mov_b32 v55, s6
  v_mfma_f32_16x16x32_bf16 v[100:103], a[252:255], v[228:231], v[100:103]
  ds_write_b32 v54, v55
  v_mfma_f32_16x16x32_bf16 v[100:103], a[248:251], v[212:215], v[100:103]
  buffer_store_dword v90, v7, s[24:27], s35 offen offset:768 nt
  v_mfma_f32_16x16x32_bf16 v[100:103], a[244:247], v[196:199], v[100:103]
  s_waitcnt lgkmcnt(8)
  ds_read_b128 v[64:67], v4 offset:20992
  v_xor_b32 v3, 40960, v3
  v_xor_b32 v4, 40960, v4
  v_mfma_f32_16x16x32_bf16 v[56:59], v[80:83], v[184:187], 0
  s_waitcnt lgkmcnt(1)
  s_barrier
  v_mfma_f32_16x16x32_bf16 v[56:59], v[72:75], v[200:203], v[56:59]
  buffer_store_dword v91, v7, s[24:27], s35 offen offset:1152 nt
  v_mfma_f32_16x16x32_bf16 v[56:59], v[92:95], v[216:219], v[56:59]
  s_waitcnt lgkmcnt(0)
  v_cvt_pk_bf16_f32 v68, v68, v100
  v_cvt_pk_bf16_f32 v69, v69, v101
  v_mfma_f32_16x16x32_bf16 v[56:59], v[96:99], v[232:235], v[56:59]
  v_cvt_pk_bf16_f32 v70, v70, v102
  v_cvt_pk_bf16_f32 v71, v71, v103
  v_mfma_f32_16x16x32_bf16 v[56:59], v[76:79], v[248:251], v[56:59]
  buffer_store_dword v68, v8, s[24:27], s35 offen offset:0 nt
  v_mfma_f32_16x16x32_bf16 v[56:59], v[64:67], a[224:227], v[56:59]
  ds_read_b128 a[244:247], v3 offset:0
  ds_read_b128 a[248:251], v3 offset:4096
  v_mfma_f32_16x16x32_bf16 v[84:87], v[64:67], a[228:231], 0
  ds_read_b128 a[252:255], v3 offset:8192
  ds_read_b128 v[60:63], v3 offset:12288
  v_mfma_f32_16x16x32_bf16 v[84:87], v[76:79], v[252:255], v[84:87]
  buffer_store_dword v69, v8, s[24:27], s35 offen offset:384 nt
  v_mfma_f32_16x16x32_bf16 v[84:87], v[96:99], v[236:239], v[84:87]
  ds_read_b128 v[64:67], v3 offset:16384
  ds_read_b128 v[76:79], v3 offset:20480
  v_mfma_f32_16x16x32_bf16 v[84:87], v[92:95], v[220:223], v[84:87]
  v_mov_b32 v54, 155648
  v_mfma_f32_16x16x32_bf16 v[84:87], v[72:75], v[204:207], v[84:87]
  buffer_store_dword v70, v8, s[24:27], s35 offen offset:768 nt
  v_mfma_f32_16x16x32_bf16 v[84:87], v[80:83], v[188:191], v[84:87]
  s_waitcnt lgkmcnt(2)
  ds_read2_b32 v[88:89], v54 offset0:0 offset1:2
  ds_read2_b32 v[90:91], v54 offset0:4 offset1:6
  v_mfma_f32_16x16x32_bf16 v[72:75], a[244:247], v[184:187], 0
  v_mfma_f32_16x16x32_bf16 v[72:75], a[248:251], v[200:203], v[72:75]
  buffer_store_dword v71, v8, s[24:27], s35 offen offset:1152 nt
  v_mfma_f32_16x16x32_bf16 v[72:75], a[252:255], v[216:219], v[72:75]
  v_cvt_pk_bf16_f32 v56, v56, v84
  v_cvt_pk_bf16_f32 v57, v57, v85
  v_mfma_f32_16x16x32_bf16 v[72:75], v[60:63], v[232:235], v[72:75]
  s_waitcnt lgkmcnt(2)
  v_cvt_pk_bf16_f32 v58, v58, v86
  v_cvt_pk_bf16_f32 v59, v59, v87
  v_mfma_f32_16x16x32_bf16 v[72:75], v[64:67], v[248:251], v[72:75]
  buffer_store_dword v56, v7, s[24:27], s36 offen offset:0 nt
  v_mfma_f32_16x16x32_bf16 v[72:75], v[76:79], a[224:227], v[72:75]
  s_waitcnt lgkmcnt(0)
  v_or3_b32 v88, v88, v89, v90
  v_or_b32 v88, v88, v91
  v_mfma_f32_16x16x32_bf16 v[104:107], v[76:79], a[228:231], 0
  v_readfirstlane_b32 s49, v88
  v_mfma_f32_16x16x32_bf16 v[104:107], v[64:67], v[252:255], v[104:107]
  buffer_store_dword v57, v7, s[24:27], s36 offen offset:384 nt
  v_mfma_f32_16x16x32_bf16 v[104:107], v[60:63], v[236:239], v[104:107]
  ds_read_b128 v[68:71], v4 offset:0
  ds_read_b128 v[80:83], v4 offset:4096
  v_mfma_f32_16x16x32_bf16 v[104:107], a[252:255], v[220:223], v[104:107]
  ds_read_b128 v[84:87], v4 offset:8192
  ds_read_b128 v[88:91], v4 offset:12288
  v_mfma_f32_16x16x32_bf16 v[104:107], a[248:251], v[204:207], v[104:107]
  buffer_store_dword v58, v7, s[24:27], s36 offen offset:768 nt
  v_mfma_f32_16x16x32_bf16 v[104:107], a[244:247], v[188:191], v[104:107]
  ds_read_b128 v[96:99], v4 offset:16384
  ds_read_b128 v[100:103], v4 offset:20480
  v_mfma_f32_16x16x32_bf16 v[92:95], a[244:247], v[192:195], 0
  v_mfma_f32_16x16x32_bf16 v[92:95], a[248:251], v[208:211], v[92:95]
  buffer_store_dword v59, v7, s[24:27], s36 offen offset:1152 nt
  v_mfma_f32_16x16x32_bf16 v[92:95], a[252:255], v[224:227], v[92:95]
  v_cvt_pk_bf16_f32 v72, v72, v104
  v_cvt_pk_bf16_f32 v73, v73, v105
  v_mfma_f32_16x16x32_bf16 v[92:95], v[60:63], v[240:243], v[92:95]
  v_cvt_pk_bf16_f32 v74, v74, v106
  v_cvt_pk_bf16_f32 v75, v75, v107
  v_mfma_f32_16x16x32_bf16 v[92:95], v[64:67], a[216:219], v[92:95]
  buffer_store_dword v72, v7, s[24:27], s33 offen offset:0 nt
  v_mfma_f32_16x16x32_bf16 v[92:95], v[76:79], a[232:235], v[92:95]
  v_mfma_f32_16x16x32_bf16 v[104:107], v[76:79], a[236:239], 0
  v_mfma_f32_16x16x32_bf16 v[104:107], v[64:67], a[220:223], v[104:107]
  buffer_store_dword v73, v7, s[24:27], s33 offen offset:384 nt
  v_mfma_f32_16x16x32_bf16 v[104:107], v[60:63], v[244:247], v[104:107]
  v_mfma_f32_16x16x32_bf16 v[104:107], a[252:255], v[228:231], v[104:107]
  v_mfma_f32_16x16x32_bf16 v[104:107], a[248:251], v[212:215], v[104:107]
  buffer_store_dword v74, v7, s[24:27], s33 offen offset:768 nt
  v_mfma_f32_16x16x32_bf16 v[104:107], a[244:247], v[196:199], v[104:107]
  s_waitcnt lgkmcnt(0)
  v_mfma_f32_16x16x32_bf16 v[56:59], v[68:71], v[184:187], 0
  v_mfma_f32_16x16x32_bf16 v[56:59], v[80:83], v[200:203], v[56:59]
  buffer_store_dword v75, v7, s[24:27], s33 offen offset:1152 nt
  v_mfma_f32_16x16x32_bf16 v[56:59], v[84:87], v[216:219], v[56:59]
  v_cvt_pk_bf16_f32 v92, v92, v104
  v_cvt_pk_bf16_f32 v93, v93, v105
  v_mfma_f32_16x16x32_bf16 v[56:59], v[88:91], v[232:235], v[56:59]
  v_cvt_pk_bf16_f32 v94, v94, v106
  v_cvt_pk_bf16_f32 v95, v95, v107
  v_mfma_f32_16x16x32_bf16 v[56:59], v[96:99], v[248:251], v[56:59]
  buffer_store_dword v92, v8, s[24:27], s33 offen offset:0 nt
  v_mfma_f32_16x16x32_bf16 v[56:59], v[100:103], a[224:227], v[56:59]
  v_mfma_f32_16x16x32_bf16 v[60:63], v[100:103], a[228:231], 0
  v_mfma_f32_16x16x32_bf16 v[60:63], v[96:99], v[252:255], v[60:63]
  buffer_store_dword v93, v8, s[24:27], s33 offen offset:384 nt
  v_mfma_f32_16x16x32_bf16 v[60:63], v[88:91], v[236:239], v[60:63]
  v_mfma_f32_16x16x32_bf16 v[60:63], v[84:87], v[220:223], v[60:63]
  v_mfma_f32_16x16x32_bf16 v[60:63], v[80:83], v[204:207], v[60:63]
  buffer_store_dword v94, v8, s[24:27], s33 offen offset:768 nt
  v_mfma_f32_16x16x32_bf16 v[60:63], v[68:71], v[188:191], v[60:63]
  buffer_store_dword v95, v8, s[24:27], s33 offen offset:1152 nt
  s_nop 6
  v_cvt_pk_bf16_f32 v56, v56, v60
  v_cvt_pk_bf16_f32 v57, v57, v61
  v_cvt_pk_bf16_f32 v58, v58, v62
  v_cvt_pk_bf16_f32 v59, v59, v63
  buffer_store_dword v56, v7, s[24:27], s34 offen offset:0 nt
  buffer_store_dword v57, v7, s[24:27], s34 offen offset:384 nt
  buffer_store_dword v58, v7, s[24:27], s34 offen offset:768 nt
  buffer_store_dword v59, v7, s[24:27], s34 offen offset:1152 nt
  s_cmp_lg_u32 s49, 0
  s_cbranch_scc1 L_safe
  s_endpgm
L_hop_1_2:
  s_cbranch_execz L_walk
L_pad4190:
L_k11:
  s_cmp_lg_u32 s59, 11
  s_cbranch_scc1 L_k12
  v_mfma_f32_16x16x32_bf16 v[104:107], a[0:3], v[92:95], 0
  v_mov_b32 v54, s12
  v_mov_b32 v55, s13
  v_mfma_f32_16x16x32_bf16 v[104:107], a[12:15], v[96:99], v[104:107]
  v_mov_b32 v74, 155712
  v_mfma_f32_16x16x32_bf16 v[104:107], a[24:27], v[136:139], v[104:107]
  v_cvt_pk_bf16_f32 v66, v132, v133
  v_cvt_pk_bf16_f32 v67, v134, v135
  v_mfma_f32_16x16x32_bf16 v[104:107], a[36:39], v[116:119], v[104:107]
  s_waitcnt lgkmcnt(0)
  ds_read_b128 v[112:115], v74
  v_mfma_f32_16x16x32_bf16 v[104:107], a[48:51], v[80:83], v[104:107]
  v_mfma_f32_16x16x32_bf16 v[104:107], a[60:63], v[84:87], v[104:107]
  v_mfma_f32_16x16x32_bf16 v[88:91], a[64:67], v[84:87], 0
  v_mfma_f32_16x16x32_bf16 v[88:91], a[52:55], v[80:83], v[88:91]
  v_mfma_f32_16x16x32_bf16 v[88:91], a[40:43], v[116:119], v[88:91]
  s_waitcnt lgkmcnt(0)
  v_mul_f32 v104, s42, v104
  v_mul_f32 v105, s42, v105
  v_mfma_f32_16x16x32_bf16 v[88:91], a[28:31], v[136:139], v[88:91]
  v_mul_f32 v106, s42, v106
  v_mul_f32 v107, s42, v107
  v_mfma_f32_16x16x32_bf16 v[88:91], a[16:19], v[96:99], v[88:91]
  v_cvt_pk_bf16_f32 v18, v104, v105
  v_cvt_pk_bf16_f32 v19, v106, v107
  v_mfma_f32_16x16x32_bf16 v[88:91], a[4:7], v[92:95], v[88:91]
  v_and_b32 v112, v112, v113
  v_and_b32 v114, v114, v115
  v_mfma_f32_16x16x32_bf16 v[108:111], a[8:11], v[92:95], 0
  v_and_b32 v112, v112, v114
  v_mfma_f32_16x16x32_bf16 v[108:111], a[20:23], v[96:99], v[108:111]
  v_readfirstlane_b32 s49, v112
  v_mfma_f32_16x16x32_bf16 v[108:111], a[32:35], v[136:139], v[108:111]
  v_mul_f32 v88, s42, v88
  v_mul_f32 v89, s42, v89
  v_mfma_f32_16x16x32_bf16 v[108:111], a[44:47], v[116:119], v[108:111]
  s_cmp_lg_u32 s49, 0
  v_mul_f32 v90, s42, v90
  v_mul_f32 v91, s42, v91
  v_mfma_f32_16x16x32_bf16 v[108:111], a[56:59], v[80:83], v[108:111]
  s_cselect_b32 s49, s44, s22
  v_cvt_pk_bf16_f32 v104, v88, v89
  v_cvt_pk_bf16_f32 v105, v90, v91
  v_mfma_f32_16x16x32_bf16 v[108:111], a[68:71], v[84:87], v[108:111]
  s_cselect_b32 s96, 4096, 0
  v_mfma_f32_16x16x32_bf16 v[112:115], a[132:135], v[84:87], 0
  buffer_store_dwordx2 v[54:55], off, s[20:23], s49 sc1
  v_mfma_f32_16x16x32_bf16 v[112:115], a[120:123], v[80:83], v[112:115]
  s_branch L_r227
L_k12:
  s_cmp_lg_u32 s45, 2
  s_cbranch_scc1 L_k12g
  v_mfma_f32_16x16x32_bf16 v[104:107], a[0:3], v[92:95], 0
  s_sub_u32 s49, s44, 2097152
  s_lshr_b32 s49, s49, 9
  s_lshr_b32 s52, s49, 6
  v_mfma_f32_16x16x32_bf16 v[104:107], a[12:15], v[96:99], v[104:107]
  s_and_b32 s53, s49, 63
  s_mul_i32 s50, s52, 15
  s_lshl_b32 s51, s57, 5
  v_mfma_f32_16x16x32_bf16 v[104:107], a[24:27], v[136:139], v[104:107]
  s_cmp_eq_u32 s53, 63
  v_cvt_pk_bf16_f32 v66, v132, v133
  v_cvt_pk_bf16_f32 v67, v134, v135
  v_mfma_f32_16x16x32_bf16 v[104:107], a[36:39], v[116:119], v[104:107]
  s_waitcnt lgkmcnt(0)
  s_cselect_b32 s53, s50, s53
  s_cselect_b32 s52, 60, s52
  v_mfma_f32_16x16x32_bf16 v[104:107], a[48:51], v[80:83], v[104:107]
  s_cselect_b32 s51, 3072, s51
  s_mul_i32 s52, s52, 1572864
  s_mul_i32 s53, s53, 3072
  v_mfma_f32_16x16x32_bf16 v[104:107], a[60:63], v[84:87], v[104:107]
  s_add_u32 s52, s52, s53
  s_add_u32 s50, s52, 787968
  s_cmp_eq_u32 s51, 3072
  v_mfma_f32_16x16x32_bf16 v[88:91], a[64:67], v[84:87], 0
  s_cselect_b32 s10, 100663296, s10
  s_sub_u32 s51, s51, s43
  s_mul_i32 s51, s51, 14
  v_mfma_f32_16x16x32_bf16 v[88:91], a[52:55], v[80:83], v[88:91]
  s_sub_u32 s50, s50, s56
  s_add_u32 s58, s50, s51
  s_mul_i32 s50, s14, 98304
  v_mfma_f32_16x16x32_bf16 v[88:91], a[40:43], v[116:119], v[88:91]
  s_add_u32 s98, s58, s50
  v_mul_f32 v104, s42, v104
  v_mul_f32 v105, s42, v105
  v_mfma_f32_16x16x32_bf16 v[88:91], a[28:31], v[136:139], v[88:91]
  s_sub_u32 s49, s98, s43
  v_mul_f32 v106, s42, v106
  v_mul_f32 v107, s42, v107
  v_mfma_f32_16x16x32_bf16 v[88:91], a[16:19], v[96:99], v[88:91]
  s_add_u32 s31, s31, s49
  v_cvt_pk_bf16_f32 v18, v104, v105
  v_cvt_pk_bf16_f32 v19, v106, v107
  v_mfma_f32_16x16x32_bf16 v[88:91], a[4:7], v[92:95], v[88:91]
  s_add_u32 s32, s32, s49
  s_lshl_b32 s50, s50, 1
  s_sub_u32 s32, s32, s50
  v_mfma_f32_16x16x32_bf16 v[108:111], a[8:11], v[92:95], 0
  s_sub_u32 s37, s37, s49
  s_sub_u32 s38, s38, s49
  s_sub_u32 s39, s39, s49
  v_mfma_f32_16x16x32_bf16 v[108:111], a[20:23], v[96:99], v[108:111]
  s_sub_u32 s40, s40, s49
  s_add_u32 s97, s97, s98
  s_mov_b32 s45, 4
  v_mfma_f32_16x16x32_bf16 v[108:111], a[32:35], v[136:139], v[108:111]
  s_lshl_b32 s96, s14, 12
  v_mul_f32 v88, s42, v88
  v_mul_f32 v89, s42, v89
  v_mfma_f32_16x16x32_bf16 v[108:111], a[44:47], v[116:119], v[108:111]
  s_mov_b64 s[100:101], -1
  v_mul_f32 v90, s42, v90
  v_mul_f32 v91, s42, v91
  v_mfma_f32_16x16x32_bf16 v[108:111], a[56:59], v[80:83], v[108:111]
  v_cvt_pk_bf16_f32 v104, v88, v89
  v_cvt_pk_bf16_f32 v105, v90, v91
  v_mfma_f32_16x16x32_bf16 v[108:111], a[68:71], v[84:87], v[108:111]
  s_branch L_r225
L_k12g:
  s_cmp_lg_u32 s59, 12
  s_cbranch_scc1 L_k13
  s_waitcnt vmcnt(30)
  v_mfma_f32_16x16x32_bf16 v[104:107], a[0:3], v[92:95], 0
  v_cmp_eq_u64 vcc, s[12:13], v[52:53]
  v_mfma_f32_16x16x32_bf16 v[104:107], a[12:15], v[96:99], v[104:107]
  v_mfma_f32_16x16x32_bf16 v[104:107], a[24:27], v[136:139], v[104:107]
  s_and_b32 s49, vcc_lo, 1
  v_cvt_pk_bf16_f32 v66, v132, v133
  v_cvt_pk_bf16_f32 v67, v134, v135
  v_mfma_f32_16x16x32_bf16 v[104:107], a[36:39], v[116:119], v[104:107]
  s_waitcnt lgkmcnt(0)
  s_lshl_b32 s49, s49, s14
  s_lshl_b32 s54, s3, 2
  v_mfma_f32_16x16x32_bf16 v[104:107], a[48:51], v[80:83], v[104:107]
  s_add_u32 s54, s54, 155728
  v_mov_b32 v54, s54
  v_mov_b32 v55, s49
  v_mfma_f32_16x16x32_bf16 v[104:107], a[60:63], v[84:87], v[104:107]
  ds_write_b32 v54, v55
  v_mfma_f32_16x16x32_bf16 v[88:91], a[64:67], v[84:87], 0
  v_mfma_f32_16x16x32_bf16 v[88:91], a[52:55], v[80:83], v[88:91]
  v_mfma_f32_16x16x32_bf16 v[88:91], a[40:43], v[116:119], v[88:91]
  v_mul_f32 v104, s42, v104
  v_mul_f32 v105, s42, v105
  v_mfma_f32_16x16x32_bf16 v[88:91], a[28:31], v[136:139], v[88:91]
  s_waitcnt lgkmcnt(0)
  v_mul_f32 v106, s42, v106
  v_mul_f32 v107, s42, v107
  v_mfma_f32_16x16x32_bf16 v[88:91], a[16:19], v[96:99], v[88:91]
  v_cvt_pk_bf16_f32 v18, v104, v105
  v_cvt_pk_bf16_f32 v19, v106, v107
  v_mfma_f32_16x16x32_bf16 v[88:91], a[4:7], v[92:95], v[88:91]
  s_branch L_r219
L_k13:
  v_mfma_f32_16x16x32_bf16 v[104:107], a[0:3], v[92:95], 0
  v_mov_b32 v54, 155728
  v_mfma_f32_16x16x32_bf16 v[104:107], a[12:15], v[96:99], v[104:107]
  ds_read_b128 v[112:115], v54
  v_mfma_f32_16x16x32_bf16 v[104:107], a[24:27], v[136:139], v[104:107]
  v_cvt_pk_bf16_f32 v66, v132, v133
  v_cvt_pk_bf16_f32 v67, v134, v135
  v_mfma_f32_16x16x32_bf16 v[104:107], a[36:39], v[116:119], v[104:107]
  s_waitcnt lgkmcnt(1)
  v_mfma_f32_16x16x32_bf16 v[104:107], a[48:51], v[80:83], v[104:107]
  v_mfma_f32_16x16x32_bf16 v[104:107], a[60:63], v[84:87], v[104:107]
  v_mfma_f32_16x16x32_bf16 v[88:91], a[64:67], v[84:87], 0
  s_waitcnt lgkmcnt(0)
  v_and_b32 v112, v112, v113
  v_and_b32 v114, v114, v115
  v_mfma_f32_16x16x32_bf16 v[88:91], a[52:55], v[80:83], v[88:91]
  v_and_b32 v112, v112, v114
  v_mfma_f32_16x16x32_bf16 v[88:91], a[40:43], v[116:119], v[88:91]
  v_mul_f32 v104, s42, v104
  v_mul_f32 v105, s42, v105
  v_mfma_f32_16x16x32_bf16 v[88:91], a[28:31], v[136:139], v[88:91]
  v_mul_f32 v106, s42, v106
  v_mul_f32 v107, s42, v107
  v_mfma_f32_16x16x32_bf16 v[88:91], a[16:19], v[96:99], v[88:91]
  v_cvt_pk_bf16_f32 v18, v104, v105
  v_cvt_pk_bf16_f32 v19, v106, v107
  v_mfma_f32_16x16x32_bf16 v[88:91], a[4:7], v[92:95], v[88:91]
  v_readfirstlane_b32 s49, v112
  v_mfma_f32_16x16x32_bf16 v[108:111], a[8:11], v[92:95], 0
  v_mfma_f32_16x16x32_bf16 v[108:111], a[20:23], v[96:99], v[108:111]
  s_lshl_b32 s96, s49, 6
  s_cmp_eq_u32 s49, 1
  s_cselect_b32 s49, s43, 0
  v_mfma_f32_16x16x32_bf16 v[108:111], a[32:35], v[136:139], v[108:111]
  s_cselect_b32 s45, 3, 0
  v_mul_f32 v88, s42, v88
  v_mul_f32 v89, s42, v89
  v_mfma_f32_16x16x32_bf16 v[108:111], a[44:47], v[116:119], v[108:111]
  s_sub_u32 s97, s97, s49
  v_mul_f32 v90, s42, v90
  v_mul_f32 v91, s42, v91
  v_mfma_f32_16x16x32_bf16 v[108:111], a[56:59], v[80:83], v[108:111]
  v_cvt_pk_bf16_f32 v104, v88, v89
  v_cvt_pk_bf16_f32 v105, v90, v91
  v_mfma_f32_16x16x32_bf16 v[108:111], a[68:71], v[84:87], v[108:111]
  s_branch L_r225
L_safe:
  s_nop 15
  s_waitcnt vmcnt(0) lgkmcnt(0)
  s_mov_b32 s10, 100663296
  v_mbcnt_lo_u32_b32 v58, -1, 0
  v_mbcnt_hi_u32_b32 v58, -1, v58
  v_lshrrev_b32 v59, 2, v58
  v_and_b32 v59, 4, v59
  v_xor_b32 v60, v59, v58
  s_cmp_eq_u32 s47, 63
  s_cselect_b32 s5, 4, 0
  v_and_b32 v60, s5, v60
  v_cmp_eq_u32 vcc, 0, v60
  s_cmp_eq_u32 s48, 63
  s_cselect_b32 s5, 0xc31044fe, 0
  v_mov_b32 v55, s5
  v_mov_b32 v54, 0xc31044fe
  v_cndmask_b32 v55, 0, v55, vcc
  v_cndmask_b32 v54, v54, 0, vcc
  v_add_u32 v0, s46, v2
  v_xor_b32 v1, 64, v0
  s_lshl_b32 s5, s48, 3
  s_add_u32 s5, s5, s3
  s_add_u32 s5, s5, 4
  s_mul_i32 s31, s5, s57
  s_add_u32 s5, s5, 4
  s_and_b32 s5, s5, 511
  s_mul_i32 s32, s5, s57
  v_lshrrev_b32 v59, 2, v59
  s_lshl_b32 s5, s47, 3
  s_add_u32 s5, s5, 4
  s_mul_i32 s5, s5, 384
  s_cmp_eq_u32 s47, 63
  s_cselect_b32 s49, 0, s5
  s_cselect_b32 s5, s5, 0
  s_cselect_b32 s6, s57, 0
  v_mul_u32_u24 v57, s6, v59
  v_sub_u32 v57, s5, v57
  s_lshl_b32 s50, s48, 3
  s_add_u32 s50, s50, 4
  s_xor_b32 s6, s4, 0
  s_lshl_b32 s6, s6, 1
  s_add_u32 s6, s6, s50
  s_and_b32 s6, s6, 511
  s_mul_i32 s6, s6, s57
  s_add_u32 s33, s6, s49
  s_xor_b32 s6, s4, 1
  s_lshl_b32 s6, s6, 1
  s_add_u32 s6, s6, s50
  s_and_b32 s6, s6, 511
  s_mul_i32 s6, s6, s57
  s_add_u32 s34, s6, s49
  s_xor_b32 s6, s4, 2
  s_lshl_b32 s6, s6, 1
  s_add_u32 s6, s6, s50
  s_and_b32 s6, s6, 511
  s_mul_i32 s6, s6, s57
  s_add_u32 s35, s6, s49
  s_xor_b32 s6, s4, 3
  s_lshl_b32 s6, s6, 1
  s_add_u32 s6, s6, s50
  s_and_b32 s6, s6, 511
  s_mul_i32 s6, s6, s57
  s_add_u32 s36, s6, s49
  s_lshl_b32 s5, s47, 3
  s_add_u32 s5, s5, 4
  v_lshrrev_b32 v59, 3, v58
  v_add_u32 v60, s5, v59
  v_and_b32 v60, 511, v60
  v_sub_u32 v60, v60, v59
  v_mul_i32_i24 v56, 0x180, v60
  v_add_u32 v6, v6, v56
  v_add_u32 v7, v7, v57
  v_add_u32 v8, v8, v57
  v_add_f32 v55, v54, v55
  s_cmp_eq_u32 s45, 3
  s_cselect_b32 s49, 15, 16
  s_cmp_eq_u32 s45, 4
  s_cselect_b32 s49, 17, s49
  s_mov_b32 s50, 0
  s_sub_u32 s56, s56, s43
  s_nop 7
L_sloop:
  s_barrier
  s_add_u32 m0, s46, 0
  s_nop 0
  buffer_load_dwordx4 v6, s[8:11], s31 offen offset:0 nt lds
  s_add_u32 m0, s46, 8064
  s_nop 0
  buffer_load_dwordx4 v6, s[8:11], s31 offen offset:128 nt lds
  s_add_u32 m0, s46, 16128
  s_nop 0
  buffer_load_dwordx4 v6, s[8:11], s31 offen offset:256 nt lds
  s_add_u32 m0, s46, 4096
  s_nop 0
  buffer_load_dwordx4 v6, s[8:11], s32 offen offset:0 nt lds
  s_add_u32 m0, s46, 12160
  s_nop 0
  buffer_load_dwordx4 v6, s[8:11], s32 offen offset:128 nt lds
  s_add_u32 m0, s46, 20224
  s_nop 0
  buffer_load_dwordx4 v6, s[8:11], s32 offen offset:256 nt lds
  s_waitcnt vmcnt(0)
  s_barrier
  ds_read_b128 a[244:247], v0 offset:0
  ds_read_b128 a[248:251], v1 offset:0
  ds_read_b128 a[252:255], v0 offset:8192
  ds_read_b128 v[76:79], v1 offset:8192
  ds_read_b128 v[80:83], v0 offset:16384
  ds_read_b128 v[84:87], v1 offset:16384
  s_waitcnt lgkmcnt(5)
  v_mfma_f32_16x16x32_bf16 v[68:71], a[0:3], a[244:247], 0
  s_waitcnt lgkmcnt(4)
  v_mfma_f32_16x16x32_bf16 v[68:71], a[12:15], a[248:251], v[68:71]
  s_waitcnt lgkmcnt(3)
  v_mfma_f32_16x16x32_bf16 v[68:71], a[24:27], a[252:255], v[68:71]
  s_waitcnt lgkmcnt(2)
  v_mfma_f32_16x16x32_bf16 v[68:71], a[36:39], v[76:79], v[68:71]
  s_waitcnt lgkmcnt(1)
  v_mfma_f32_16x16x32_bf16 v[68:71], a[48:51], v[80:83], v[68:71]
  s_waitcnt lgkmcnt(0)
  v_mfma_f32_16x16x32_bf16 v[68:71], a[60:63], v[84:87], v[68:71]
  v_mfma_f32_16x16x32_bf16 v[60:63], a[64:67], v[84:87], 0
  v_mfma_f32_16x16x32_bf16 v[60:63], a[52:55], v[80:83], v[60:63]
  v_mfma_f32_16x16x32_bf16 v[60:63], a[40:43], v[76:79], v[60:63]
  v_mfma_f32_16x16x32_bf16 v[60:63], a[28:31], a[252:255], v[60:63]
  v_mfma_f32_16x16x32_bf16 v[60:63], a[16:19], a[248:251], v[60:63]
  v_mfma_f32_16x16x32_bf16 v[60:63], a[4:7], a[244:247], v[60:63]
  v_mul_f32 v68, s42, v68
  v_mul_f32 v69, s42, v69
  v_mul_f32 v70, s42, v70
  v_mul_f32 v71, s42, v71
  v_cvt_pk_bf16_f32 v12, v68, v69
  v_cvt_pk_bf16_f32 v13, v70, v71
  v_mfma_f32_16x16x32_bf16 v[64:67], a[8:11], a[244:247], 0
  v_mfma_f32_16x16x32_bf16 v[64:67], a[20:23], a[248:251], v[64:67]
  v_mfma_f32_16x16x32_bf16 v[64:67], a[32:35], a[252:255], v[64:67]
  v_mfma_f32_16x16x32_bf16 v[64:67], a[44:47], v[76:79], v[64:67]
  v_mfma_f32_16x16x32_bf16 v[64:67], a[56:59], v[80:83], v[64:67]
  v_mfma_f32_16x16x32_bf16 v[64:67], a[68:71], v[84:87], v[64:67]
  v_mul_f32 v60, s42, v60
  v_mul_f32 v61, s42, v61
  v_mul_f32 v62, s42, v62
  v_mul_f32 v63, s42, v63
  v_cvt_pk_bf16_f32 v128, v60, v61
  v_cvt_pk_bf16_f32 v129, v62, v63
  v_mfma_f32_16x16x32_bf16 v[68:71], a[132:135], v[84:87], 0
  v_mfma_f32_16x16x32_bf16 v[68:71], a[120:123], v[80:83], v[68:71]
  v_mfma_f32_16x16x32_bf16 v[68:71], a[108:111], v[76:79], v[68:71]
  v_mfma_f32_16x16x32_bf16 v[68:71], a[96:99], a[252:255], v[68:71]
  v_mfma_f32_16x16x32_bf16 v[68:71], a[84:87], a[248:251], v[68:71]
  v_mfma_f32_16x16x32_bf16 v[68:71], a[72:75], a[244:247], v[68:71]
  v_mul_f32 v64, s42, v64
  v_mul_f32 v65, s42, v65
  v_mul_f32 v66, s42, v66
  v_mul_f32 v67, s42, v67
  v_cvt_pk_bf16_f32 v130, v64, v65
  v_cvt_pk_bf16_f32 v131, v66, v67
  v_mfma_f32_16x16x32_bf16 v[72:75], a[76:79], a[244:247], 0
  v_mfma_f32_16x16x32_bf16 v[72:75], a[88:91], a[248:251], v[72:75]
  v_mfma_f32_16x16x32_bf16 v[72:75], a[100:103], a[252:255], v[72:75]
  v_mfma_f32_16x16x32_bf16 v[72:75], a[112:115], v[76:79], v[72:75]
  v_mfma_f32_16x16x32_bf16 v[72:75], a[124:127], v[80:83], v[72:75]
  v_mfma_f32_16x16x32_bf16 v[72:75], a[136:139], v[84:87], v[72:75]
  v_cvt_pk_bf16_f32 v60, v68, v69
  v_cvt_pk_bf16_f32 v61, v70, v71
  v_mfma_f32_16x16x32_bf16 v[88:91], a[140:143], v[84:87], 0
  v_mfma_f32_16x16x32_bf16 v[88:91], a[128:131], v[80:83], v[88:91]
  v_mfma_f32_16x16x32_bf16 v[88:91], a[116:119], v[76:79], v[88:91]
  v_mfma_f32_16x16x32_bf16 v[88:91], a[104:107], a[252:255], v[88:91]
  v_mfma_f32_16x16x32_bf16 v[88:91], a[92:95], a[248:251], v[88:91]
  v_mfma_f32_16x16x32_bf16 v[88:91], a[80:83], a[244:247], v[88:91]
  v_cvt_pk_bf16_f32 v62, v72, v73
  v_cvt_pk_bf16_f32 v63, v74, v75
  v_mfma_f32_16x16x32_bf16 v[92:95], a[244:247], a[144:147], 0
  v_mfma_f32_16x16x32_bf16 v[92:95], a[248:251], a[156:159], v[92:95]
  v_mfma_f32_16x16x32_bf16 v[92:95], a[252:255], a[168:171], v[92:95]
  v_mfma_f32_16x16x32_bf16 v[92:95], v[76:79], a[180:183], v[92:95]
  v_mfma_f32_16x16x32_bf16 v[92:95], v[80:83], a[192:195], v[92:95]
  v_mfma_f32_16x16x32_bf16 v[92:95], v[84:87], a[204:207], v[92:95]
  v_cvt_pk_bf16_f32 v64, v88, v89
  v_cvt_pk_bf16_f32 v65, v90, v91
  v_mfma_f32_16x16x32_bf16 v[96:99], v[84:87], a[208:211], 0
  v_mfma_f32_16x16x32_bf16 v[96:99], v[80:83], a[196:199], v[96:99]
  v_mfma_f32_16x16x32_bf16 v[96:99], v[76:79], a[184:187], v[96:99]
  v_mfma_f32_16x16x32_bf16 v[96:99], a[252:255], a[172:175], v[96:99]
  v_mfma_f32_16x16x32_bf16 v[96:99], a[248:251], a[160:163], v[96:99]
  v_mfma_f32_16x16x32_bf16 v[96:99], a[244:247], a[148:151], v[96:99]
  v_cvt_pk_bf16_f32 v68, v92, v93
  v_cvt_pk_bf16_f32 v69, v94, v95
  v_mfma_f32_16x16x32_bf16 v[104:107], a[244:247], a[152:155], 0
  v_mfma_f32_16x16x32_bf16 v[104:107], a[248:251], a[164:167], v[104:107]
  v_mfma_f32_16x16x32_bf16 v[104:107], a[252:255], a[176:179], v[104:107]
  v_mfma_f32_16x16x32_bf16 v[104:107], v[76:79], a[188:191], v[104:107]
  v_mfma_f32_16x16x32_bf16 v[104:107], v[80:83], a[200:203], v[104:107]
  v_mfma_f32_16x16x32_bf16 v[104:107], v[84:87], a[212:215], v[104:107]
  v_cvt_pk_bf16_f32 v72, v96, v97
  v_cvt_pk_bf16_f32 v73, v98, v99
  s_nop 5
  v_cvt_pk_bf16_f32 v76, v104, v105
  v_cvt_pk_bf16_f32 v77, v106, v107
  ds_read_b128 a[244:247], v0 offset:2048
  ds_read_b128 a[248:251], v1 offset:2048
  ds_read_b128 a[252:255], v0 offset:10240
  ds_read_b128 v[88:91], v1 offset:10240
  ds_read_b128 v[92:95], v0 offset:18432
  ds_read_b128 v[96:99], v1 offset:18432
  s_waitcnt lgkmcnt(5)
  v_mfma_f32_16x16x32_bf16 v[100:103], a[0:3], a[244:247], 0
  s_waitcnt lgkmcnt(4)
  v_mfma_f32_16x16x32_bf16 v[100:103], a[12:15], a[248:251], v[100:103]
  s_waitcnt lgkmcnt(3)
  v_mfma_f32_16x16x32_bf16 v[100:103], a[24:27], a[252:255], v[100:103]
  s_waitcnt lgkmcnt(2)
  v_mfma_f32_16x16x32_bf16 v[100:103], a[36:39], v[88:91], v[100:103]
  s_waitcnt lgkmcnt(1)
  v_mfma_f32_16x16x32_bf16 v[100:103], a[48:51], v[92:95], v[100:103]
  s_waitcnt lgkmcnt(0)
  v_mfma_f32_16x16x32_bf16 v[100:103], a[60:63], v[96:99], v[100:103]
  v_mfma_f32_16x16x32_bf16 v[80:83], a[64:67], v[96:99], 0
  v_mfma_f32_16x16x32_bf16 v[80:83], a[52:55], v[92:95], v[80:83]
  v_mfma_f32_16x16x32_bf16 v[80:83], a[40:43], v[88:91], v[80:83]
  v_mfma_f32_16x16x32_bf16 v[80:83], a[28:31], a[252:255], v[80:83]
  v_mfma_f32_16x16x32_bf16 v[80:83], a[16:19], a[248:251], v[80:83]
  v_mfma_f32_16x16x32_bf16 v[80:83], a[4:7], a[244:247], v[80:83]
  v_mul_f32 v100, s42, v100
  v_mul_f32 v101, s42, v101
  v_mul_f32 v102, s42, v102
  v_mul_f32 v103, s42, v103
  v_cvt_pk_bf16_f32 v124, v100, v101
  v_cvt_pk_bf16_f32 v125, v102, v103
  v_mfma_f32_16x16x32_bf16 v[84:87], a[8:11], a[244:247], 0
  v_mfma_f32_16x16x32_bf16 v[84:87], a[20:23], a[248:251], v[84:87]
  v_mfma_f32_16x16x32_bf16 v[84:87], a[32:35], a[252:255], v[84:87]
  v_mfma_f32_16x16x32_bf16 v[84:87], a[44:47], v[88:91], v[84:87]
  v_mfma_f32_16x16x32_bf16 v[84:87], a[56:59], v[92:95], v[84:87]
  v_mfma_f32_16x16x32_bf16 v[84:87], a[68:71], v[96:99], v[84:87]
  v_mul_f32 v80, s42, v80
  v_mul_f32 v81, s42, v81
  v_mul_f32 v82, s42, v82
  v_mul_f32 v83, s42, v83
  v_cvt_pk_bf16_f32 v126, v80, v81
  v_cvt_pk_bf16_f32 v127, v82, v83
  v_mfma_f32_16x16x32_bf16 v[100:103], a[132:135], v[96:99], 0
  v_mfma_f32_16x16x32_bf16 v[100:103], a[120:123], v[92:95], v[100:103]
  v_mfma_f32_16x16x32_bf16 v[100:103], a[108:111], v[88:91], v[100:103]
  v_mfma_f32_16x16x32_bf16 v[100:103], a[96:99], a[252:255], v[100:103]
  v_mfma_f32_16x16x32_bf16 v[100:103], a[84:87], a[248:251], v[100:103]
  v_mfma_f32_16x16x32_bf16 v[100:103], a[72:75], a[244:247], v[100:103]
  v_mul_f32 v84, s42, v84
  v_mul_f32 v85, s42, v85
  v_mul_f32 v86, s42, v86
  v_mul_f32 v87, s42, v87
  v_cvt_pk_bf16_f32 v16, v84, v85
  v_cvt_pk_bf16_f32 v17, v86, v87
  v_mfma_f32_16x16x32_bf16 v[104:107], a[76:79], a[244:247], 0
  v_mfma_f32_16x16x32_bf16 v[104:107], a[88:91], a[248:251], v[104:107]
  v_mfma_f32_16x16x32_bf16 v[104:107], a[100:103], a[252:255], v[104:107]
  v_mfma_f32_16x16x32_bf16 v[104:107], a[112:115], v[88:91], v[104:107]
  v_mfma_f32_16x16x32_bf16 v[104:107], a[124:127], v[92:95], v[104:107]
  v_mfma_f32_16x16x32_bf16 v[104:107], a[136:139], v[96:99], v[104:107]
  v_cvt_pk_bf16_f32 v80, v100, v101
  v_cvt_pk_bf16_f32 v81, v102, v103
  v_mfma_f32_16x16x32_bf16 v[108:111], a[140:143], v[96:99], 0
  v_mfma_f32_16x16x32_bf16 v[108:111], a[128:131], v[92:95], v[108:111]
  v_mfma_f32_16x16x32_bf16 v[108:111], a[116:119], v[88:91], v[108:111]
  v_mfma_f32_16x16x32_bf16 v[108:111], a[104:107], a[252:255], v[108:111]
  v_mfma_f32_16x16x32_bf16 v[108:111], a[92:95], a[248:251], v[108:111]
  v_mfma_f32_16x16x32_bf16 v[108:111], a[80:83], a[244:247], v[108:111]
  v_cvt_pk_bf16_f32 v82, v104, v105
  v_cvt_pk_bf16_f32 v83, v106, v107
  v_mfma_f32_16x16x32_bf16 v[100:103], a[244:247], a[144:147], 0
  v_mfma_f32_16x16x32_bf16 v[100:103], a[248:251], a[156:159], v[100:103]
  v_mfma_f32_16x16x32_bf16 v[100:103], a[252:255], a[168:171], v[100:103]
  v_mfma_f32_16x16x32_bf16 v[100:103], v[88:91], a[180:183], v[100:103]
  v_mfma_f32_16x16x32_bf16 v[100:103], v[92:95], a[192:195], v[100:103]
  v_mfma_f32_16x16x32_bf16 v[100:103], v[96:99], a[204:207], v[100:103]
  v_cvt_pk_bf16_f32 v84, v108, v109
  v_cvt_pk_bf16_f32 v85, v110, v111
  v_mfma_f32_16x16x32_bf16 v[104:107], v[96:99], a[208:211], 0
  v_mfma_f32_16x16x32_bf16 v[104:107], v[92:95], a[196:199], v[104:107]
  v_mfma_f32_16x16x32_bf16 v[104:107], v[88:91], a[184:187], v[104:107]
  v_mfma_f32_16x16x32_bf16 v[104:107], a[252:255], a[172:175], v[104:107]
  v_mfma_f32_16x16x32_bf16 v[104:107], a[248:251], a[160:163], v[104:107]
  v_mfma_f32_16x16x32_bf16 v[104:107], a[244:247], a[148:151], v[104:107]
  v_cvt_pk_bf16_f32 v70, v100, v101
  v_cvt_pk_bf16_f32 v71, v102, v103
  v_mfma_f32_16x16x32_bf16 v[116:119], a[244:247], a[152:155], 0
  v_mfma_f32_16x16x32_bf16 v[116:119], a[248:251], a[164:167], v[116:119]
  v_mfma_f32_16x16x32_bf16 v[116:119], a[252:255], a[176:179], v[116:119]
  v_mfma_f32_16x16x32_bf16 v[116:119], v[88:91], a[188:191], v[116:119]
  v_mfma_f32_16x16x32_bf16 v[116:119], v[92:95], a[200:203], v[116:119]
  v_mfma_f32_16x16x32_bf16 v[116:119], v[96:99], a[212:215], v[116:119]
  v_cvt_pk_bf16_f32 v74, v104, v105
  v_cvt_pk_bf16_f32 v75, v106, v107
  s_nop 5
  v_cvt_pk_bf16_f32 v78, v116, v117
  v_cvt_pk_bf16_f32 v79, v118, v119
  ds_read_b128 a[244:247], v0 offset:4096
  ds_read_b128 a[248:251], v1 offset:4096
  ds_read_b128 a[252:255], v0 offset:12288
  ds_read_b128 v[100:103], v1 offset:12288
  ds_read_b128 v[108:111], v0 offset:20480
  ds_read_b128 v[112:115], v1 offset:20480
  s_waitcnt lgkmcnt(5)
  v_mfma_f32_16x16x32_bf16 v[96:99], a[0:3], a[244:247], 0
  s_waitcnt lgkmcnt(4)
  v_mfma_f32_16x16x32_bf16 v[96:99], a[12:15], a[248:251], v[96:99]
  s_waitcnt lgkmcnt(3)
  v_mfma_f32_16x16x32_bf16 v[96:99], a[24:27], a[252:255], v[96:99]
  s_waitcnt lgkmcnt(2)
  v_mfma_f32_16x16x32_bf16 v[96:99], a[36:39], v[100:103], v[96:99]
  s_waitcnt lgkmcnt(1)
  v_mfma_f32_16x16x32_bf16 v[96:99], a[48:51], v[108:111], v[96:99]
  s_waitcnt lgkmcnt(0)
  v_mfma_f32_16x16x32_bf16 v[96:99], a[60:63], v[112:115], v[96:99]
  v_mfma_f32_16x16x32_bf16 v[88:91], a[64:67], v[112:115], 0
  v_mfma_f32_16x16x32_bf16 v[88:91], a[52:55], v[108:111], v[88:91]
  v_mfma_f32_16x16x32_bf16 v[88:91], a[40:43], v[100:103], v[88:91]
  v_mfma_f32_16x16x32_bf16 v[88:91], a[28:31], a[252:255], v[88:91]
  v_mfma_f32_16x16x32_bf16 v[88:91], a[16:19], a[248:251], v[88:91]
  v_mfma_f32_16x16x32_bf16 v[88:91], a[4:7], a[244:247], v[88:91]
  v_mul_f32 v96, s42, v96
  v_mul_f32 v97, s42, v97
  v_mul_f32 v98, s42, v98
  v_mul_f32 v99, s42, v99
  v_cvt_pk_bf16_f32 v18, v96, v97
  v_cvt_pk_bf16_f32 v19, v98, v99
  v_mfma_f32_16x16x32_bf16 v[92:95], a[8:11], a[244:247], 0
  v_mfma_f32_16x16x32_bf16 v[92:95], a[20:23], a[248:251], v[92:95]
  v_mfma_f32_16x16x32_bf16 v[92:95], a[32:35], a[252:255], v[92:95]
  v_mfma_f32_16x16x32_bf16 v[92:95], a[44:47], v[100:103], v[92:95]
  v_mfma_f32_16x16x32_bf16 v[92:95], a[56:59], v[108:111], v[92:95]
  v_mfma_f32_16x16x32_bf16 v[92:95], a[68:71], v[112:115], v[92:95]
  v_mul_f32 v88, s42, v88
  v_mul_f32 v89, s42, v89
  v_mul_f32 v90, s42, v90
  v_mul_f32 v91, s42, v91
  v_cvt_pk_bf16_f32 v120, v88, v89
  v_cvt_pk_bf16_f32 v121, v90, v91
  v_mfma_f32_16x16x32_bf16 v[96:99], a[132:135], v[112:115], 0
  v_mfma_f32_16x16x32_bf16 v[96:99], a[120:123], v[108:111], v[96:99]
  v_mfma_f32_16x16x32_bf16 v[96:99], a[108:111], v[100:103], v[96:99]
  v_mfma_f32_16x16x32_bf16 v[96:99], a[96:99], a[252:255], v[96:99]
  v_mfma_f32_16x16x32_bf16 v[96:99], a[84:87], a[248:251], v[96:99]
  v_mfma_f32_16x16x32_bf16 v[96:99], a[72:75], a[244:247], v[96:99]
  v_mul_f32 v92, s42, v92
  v_mul_f32 v93, s42, v93
  v_mul_f32 v94, s42, v94
  v_mul_f32 v95, s42, v95
  v_cvt_pk_bf16_f32 v122, v92, v93
  v_cvt_pk_bf16_f32 v123, v94, v95
  v_mfma_f32_16x16x32_bf16 v[104:107], a[76:79], a[244:247], 0
  v_mfma_f32_16x16x32_bf16 v[104:107], a[88:91], a[248:251], v[104:107]
  v_mfma_f32_16x16x32_bf16 v[104:107], a[100:103], a[252:255], v[104:107]
  v_mfma_f32_16x16x32_bf16 v[104:107], a[112:115], v[100:103], v[104:107]
  v_mfma_f32_16x16x32_bf16 v[104:107], a[124:127], v[108:111], v[104:107]
  v_mfma_f32_16x16x32_bf16 v[104:107], a[136:139], v[112:115], v[104:107]
  v_cvt_pk_bf16_f32 v88, v96, v97
  v_cvt_pk_bf16_f32 v89, v98, v99
  v_mfma_f32_16x16x32_bf16 v[116:119], a[140:143], v[112:115], 0
  v_mfma_f32_16x16x32_bf16 v[116:119], a[128:131], v[108:111], v[116:119]
  v_mfma_f32_16x16x32_bf16 v[116:119], a[116:119], v[100:103], v[116:119]
  v_mfma_f32_16x16x32_bf16 v[116:119], a[104:107], a[252:255], v[116:119]
  v_mfma_f32_16x16x32_bf16 v[116:119], a[92:95], a[248:251], v[116:119]
  v_mfma_f32_16x16x32_bf16 v[116:119], a[80:83], a[244:247], v[116:119]
  v_cvt_pk_bf16_f32 v90, v104, v105
  v_cvt_pk_bf16_f32 v91, v106, v107
  v_mfma_f32_16x16x32_bf16 v[132:135], a[244:247], a[144:147], 0
  v_mfma_f32_16x16x32_bf16 v[132:135], a[248:251], a[156:159], v[132:135]
  v_mfma_f32_16x16x32_bf16 v[132:135], a[252:255], a[168:171], v[132:135]
  v_mfma_f32_16x16x32_bf16 v[132:135], v[100:103], a[180:183], v[132:135]
  v_mfma_f32_16x16x32_bf16 v[132:135], v[108:111], a[192:195], v[132:135]
  v_mfma_f32_16x16x32_bf16 v[132:135], v[112:115], a[204:207], v[132:135]
  v_cvt_pk_bf16_f32 v92, v116, v117
  v_cvt_pk_bf16_f32 v93, v118, v119
  v_mfma_f32_16x16x32_bf16 v[136:139], v[112:115], a[208:211], 0
  v_mfma_f32_16x16x32_bf16 v[136:139], v[108:111], a[196:199], v[136:139]
  v_mfma_f32_16x16x32_bf16 v[136:139], v[100:103], a[184:187], v[136:139]
  v_mfma_f32_16x16x32_bf16 v[136:139], a[252:255], a[172:175], v[136:139]
  v_mfma_f32_16x16x32_bf16 v[136:139], a[248:251], a[160:163], v[136:139]
  v_mfma_f32_16x16x32_bf16 v[136:139], a[244:247], a[148:151], v[136:139]
  v_cvt_pk_bf16_f32 v96, v132, v133
  v_cvt_pk_bf16_f32 v97, v134, v135
  v_mfma_f32_16x16x32_bf16 v[116:119], a[244:247], a[152:155], 0
  v_mfma_f32_16x16x32_bf16 v[116:119], a[248:251], a[164:167], v[116:119]
  v_mfma_f32_16x16x32_bf16 v[116:119], a[252:255], a[176:179], v[116:119]
  v_mfma_f32_16x16x32_bf16 v[116:119], v[100:103], a[188:191], v[116:119]
  v_mfma_f32_16x16x32_bf16 v[116:119], v[108:111], a[200:203], v[116:119]
  v_mfma_f32_16x16x32_bf16 v[116:119], v[112:115], a[212:215], v[116:119]
  v_cvt_pk_bf16_f32 v104, v136, v137
  v_cvt_pk_bf16_f32 v105, v138, v139
  s_nop 5
  v_cvt_pk_bf16_f32 v100, v116, v117
  v_cvt_pk_bf16_f32 v101, v118, v119
  ds_read_b128 a[244:247], v0 offset:6144
  ds_read_b128 a[248:251], v1 offset:6144
  ds_read_b128 a[252:255], v0 offset:14336
  ds_read_b128 v[132:135], v1 offset:14336
  ds_read_b128 v[136:139], v0 offset:22528
  ds_read_b128 v[140:143], v1 offset:22528
  s_waitcnt lgkmcnt(5)
  v_mfma_f32_16x16x32_bf16 v[144:147], a[0:3], a[244:247], 0
  s_waitcnt lgkmcnt(4)
  v_mfma_f32_16x16x32_bf16 v[144:147], a[12:15], a[248:251], v[144:147]
  s_waitcnt lgkmcnt(3)
  v_mfma_f32_16x16x32_bf16 v[144:147], a[24:27], a[252:255], v[144:147]
  s_waitcnt lgkmcnt(2)
  v_mfma_f32_16x16x32_bf16 v[144:147], a[36:39], v[132:135], v[144:147]
  s_waitcnt lgkmcnt(1)
  v_mfma_f32_16x16x32_bf16 v[144:147], a[48:51], v[136:139], v[144:147]
  s_waitcnt lgkmcnt(0)
  v_mfma_f32_16x16x32_bf16 v[144:147], a[60:63], v[140:143], v[144:147]
  v_mfma_f32_16x16x32_bf16 v[108:111], a[64:67], v[140:143], 0
  v_mfma_f32_16x16x32_bf16 v[108:111], a[52:55], v[136:139], v[108:111]
  v_mfma_f32_16x16x32_bf16 v[108:111], a[40:43], v[132:135], v[108:111]
  v_mfma_f32_16x16x32_bf16 v[108:111], a[28:31], a[252:255], v[108:111]
  v_mfma_f32_16x16x32_bf16 v[108:111], a[16:19], a[248:251], v[108:111]
  v_mfma_f32_16x16x32_bf16 v[108:111], a[4:7], a[244:247], v[108:111]
  v_mul_f32 v144, s42, v144
  v_mul_f32 v145, s42, v145
  v_mul_f32 v146, s42, v146
  v_mul_f32 v147, s42, v147
  v_cvt_pk_bf16_f32 v116, v144, v145
  v_cvt_pk_bf16_f32 v117, v146, v147
  v_mfma_f32_16x16x32_bf16 v[112:115], a[8:11], a[244:247], 0
  v_mfma_f32_16x16x32_bf16 v[112:115], a[20:23], a[248:251], v[112:115]
  v_mfma_f32_16x16x32_bf16 v[112:115], a[32:35], a[252:255], v[112:115]
  v_mfma_f32_16x16x32_bf16 v[112:115], a[44:47], v[132:135], v[112:115]
  v_mfma_f32_16x16x32_bf16 v[112:115], a[56:59], v[136:139], v[112:115]
  v_mfma_f32_16x16x32_bf16 v[112:115], a[68:71], v[140:143], v[112:115]
  v_mul_f32 v108, s42, v108
  v_mul_f32 v109, s42, v109
  v_mul_f32 v110, s42, v110
  v_mul_f32 v111, s42, v111
  v_cvt_pk_bf16_f32 v118, v108, v109
  v_cvt_pk_bf16_f32 v119, v110, v111
  v_mfma_f32_16x16x32_bf16 v[144:147], a[132:135], v[140:143], 0
  v_mfma_f32_16x16x32_bf16 v[144:147], a[120:123], v[136:139], v[144:147]
  v_mfma_f32_16x16x32_bf16 v[144:147], a[108:111], v[132:135], v[144:147]
  v_mfma_f32_16x16x32_bf16 v[144:147], a[96:99], a[252:255], v[144:147]
  v_mfma_f32_16x16x32_bf16 v[144:147], a[84:87], a[248:251], v[144:147]
  v_mfma_f32_16x16x32_bf16 v[144:147], a[72:75], a[244:247], v[144:147]
  v_mul_f32 v112, s42, v112
  v_mul_f32 v113, s42, v113
  v_mul_f32 v114, s42, v114
  v_mul_f32 v115, s42, v115
  v_cvt_pk_bf16_f32 v22, v112, v113
  v_cvt_pk_bf16_f32 v23, v114, v115
  v_mfma_f32_16x16x32_bf16 v[148:151], a[76:79], a[244:247], 0
  v_mfma_f32_16x16x32_bf16 v[148:151], a[88:91], a[248:251], v[148:151]
  v_mfma_f32_16x16x32_bf16 v[148:151], a[100:103], a[252:255], v[148:151]
  v_mfma_f32_16x16x32_bf16 v[148:151], a[112:115], v[132:135], v[148:151]
  v_mfma_f32_16x16x32_bf16 v[148:151], a[124:127], v[136:139], v[148:151]
  v_mfma_f32_16x16x32_bf16 v[148:151], a[136:139], v[140:143], v[148:151]
  v_cvt_pk_bf16_f32 v108, v144, v145
  v_cvt_pk_bf16_f32 v109, v146, v147
  v_mfma_f32_16x16x32_bf16 v[152:155], a[140:143], v[140:143], 0
  v_mfma_f32_16x16x32_bf16 v[152:155], a[128:131], v[136:139], v[152:155]
  v_mfma_f32_16x16x32_bf16 v[152:155], a[116:119], v[132:135], v[152:155]
  v_mfma_f32_16x16x32_bf16 v[152:155], a[104:107], a[252:255], v[152:155]
  v_mfma_f32_16x16x32_bf16 v[152:155], a[92:95], a[248:251], v[152:155]
  v_mfma_f32_16x16x32_bf16 v[152:155], a[80:83], a[244:247], v[152:155]
  v_cvt_pk_bf16_f32 v110, v148, v149
  v_cvt_pk_bf16_f32 v111, v150, v151
  v_mfma_f32_16x16x32_bf16 v[144:147], a[244:247], a[144:147], 0
  v_mfma_f32_16x16x32_bf16 v[144:147], a[248:251], a[156:159], v[144:147]
  v_mfma_f32_16x16x32_bf16 v[144:147], a[252:255], a[168:171], v[144:147]
  v_mfma_f32_16x16x32_bf16 v[144:147], v[132:135], a[180:183], v[144:147]
  v_mfma_f32_16x16x32_bf16 v[144:147], v[136:139], a[192:195], v[144:147]
  v_mfma_f32_16x16x32_bf16 v[144:147], v[140:143], a[204:207], v[144:147]
  v_cvt_pk_bf16_f32 v112, v152, v153
  v_cvt_pk_bf16_f32 v113, v154, v155
  v_mfma_f32_16x16x32_bf16 v[148:151], v[140:143], a[208:211], 0
  v_mfma_f32_16x16x32_bf16 v[148:151], v[136:139], a[196:199], v[148:151]
  v_mfma_f32_16x16x32_bf16 v[148:151], v[132:135], a[184:187], v[148:151]
  v_mfma_f32_16x16x32_bf16 v[148:151], a[252:255], a[172:175], v[148:151]
  v_mfma_f32_16x16x32_bf16 v[148:151], a[248:251], a[160:163], v[148:151]
  v_mfma_f32_16x16x32_bf16 v[148:151], a[244:247], a[148:151], v[148:151]
  v_cvt_pk_bf16_f32 v98, v144, v145
  v_cvt_pk_bf16_f32 v99, v146, v147
  v_mfma_f32_16x16x32_bf16 v[152:155], a[244:247], a[152:155], 0
  v_mfma_f32_16x16x32_bf16 v[152:155], a[248:251], a[164:167], v[152:155]
  v_mfma_f32_16x16x32_bf16 v[152:155], a[252:255], a[176:179], v[152:155]
  v_mfma_f32_16x16x32_bf16 v[152:155], v[132:135], a[188:191], v[152:155]
  v_mfma_f32_16x16x32_bf16 v[152:155], v[136:139], a[200:203], v[152:155]
  v_mfma_f32_16x16x32_bf16 v[152:155], v[140:143], a[212:215], v[152:155]
  v_cvt_pk_bf16_f32 v106, v148, v149
  v_cvt_pk_bf16_f32 v107, v150, v151
  s_nop 5
  v_cvt_pk_bf16_f32 v102, v152, v153
  v_cvt_pk_bf16_f32 v103, v154, v155
  v_mfma_f32_16x16x32_bf16 v[132:135], v[62:65], v[128:131], v[36:39]
  v_mfma_f32_16x16x32_bf16 v[132:135], v[60:63], v[12:15], v[132:135]
  v_mfma_f32_16x16x32_bf16 v[136:139], v[82:85], v[128:131], v[32:35]
  v_mfma_f32_16x16x32_bf16 v[136:139], v[80:83], v[12:15], v[136:139]
  v_mfma_f32_16x16x32_bf16 v[140:143], v[90:93], v[128:131], v[28:31]
  v_mfma_f32_16x16x32_bf16 v[140:143], v[88:91], v[12:15], v[140:143]
  v_mfma_f32_16x16x32_bf16 v[144:147], v[110:113], v[128:131], v[24:27]
  v_mfma_f32_16x16x32_bf16 v[144:147], v[108:111], v[12:15], v[144:147]
  v_add_f32 v132, v54, v132
  v_add_f32 v133, v54, v133
  v_add_f32 v134, v54, v134
  v_add_f32 v135, v54, v135
  v_add_f32 v136, v54, v136
  v_add_f32 v137, v54, v137
  v_add_f32 v138, v54, v138
  v_add_f32 v139, v54, v139
  v_add_f32 v140, v55, v140
  v_add_f32 v141, v55, v141
  v_add_f32 v142, v55, v142
  v_add_f32 v143, v55, v143
  v_add_f32 v144, v55, v144
  v_add_f32 v145, v55, v145
  v_add_f32 v146, v55, v146
  v_add_f32 v147, v55, v147
  v_max_f32 v58, v132, v133
  v_max3_f32 v58, v134, v135, v58
  v_max3_f32 v58, v136, v137, v58
  v_max3_f32 v58, v138, v139, v58
  v_max3_f32 v58, v140, v141, v58
  v_max3_f32 v58, v142, v143, v58
  v_max3_f32 v58, v144, v145, v58
  v_max3_f32 v58, v146, v147, v58
  v_mov_b32 v59, v58
  s_nop 1
  v_permlane32_swap_b32 v58, v59
  v_max_f32 v58, v58, v59
  v_mov_b32 v59, v58
  s_nop 1
  v_permlane16_swap_b32 v58, v59
  v_max_f32 v58, v58, v59
  v_sub_f32 v132, v132, v58
  v_sub_f32 v133, v133, v58
  v_sub_f32 v134, v134, v58
  v_sub_f32 v135, v135, v58
  v_sub_f32 v136, v136, v58
  v_sub_f32 v137, v137, v58
  v_sub_f32 v138, v138, v58
  v_sub_f32 v139, v139, v58
  v_sub_f32 v140, v140, v58
  v_sub_f32 v141, v141, v58
  v_sub_f32 v142, v142, v58
  v_sub_f32 v143, v143, v58
  v_sub_f32 v144, v144, v58
  v_sub_f32 v145, v145, v58
  v_sub_f32 v146, v146, v58
  v_sub_f32 v147, v147, v58
  v_exp_f32 v132, v132
  v_exp_f32 v133, v133
  v_exp_f32 v134, v134
  v_exp_f32 v135, v135
  v_cvt_pk_bf16_f32 v132, v132, v133
  v_cvt_pk_bf16_f32 v133, v134, v135
  v_exp_f32 v136, v136
  v_exp_f32 v137, v137
  v_exp_f32 v138, v138
  v_exp_f32 v139, v139
  v_cvt_pk_bf16_f32 v134, v136, v137
  v_cvt_pk_bf16_f32 v135, v138, v139
  v_exp_f32 v140, v140
  v_exp_f32 v141, v141
  v_exp_f32 v142, v142
  v_exp_f32 v143, v143
  v_cvt_pk_bf16_f32 v136, v140, v141
  v_cvt_pk_bf16_f32 v137, v142, v143
  v_exp_f32 v144, v144
  v_exp_f32 v145, v145
  v_exp_f32 v146, v146
  v_exp_f32 v147, v147
  v_cvt_pk_bf16_f32 v138, v144, v145
  v_cvt_pk_bf16_f32 v139, v146, v147
  v_mov_b64 v[128:129], 0
  s_nop 1
  v_smfmac_f32_16x16x64_bf16 v[128:131], a[240:243], v[132:139], v10
  v_mfma_f32_16x16x32_bf16 v[148:151], v[96:99], v[136:139], 0
  v_mfma_f32_16x16x32_bf16 v[148:151], v[68:71], v[132:135], v[148:151]
  v_mfma_f32_16x16x32_bf16 v[140:143], v[72:75], v[132:135], 0
  v_mfma_f32_16x16x32_bf16 v[140:143], v[104:107], v[136:139], v[140:143]
  v_mfma_f32_16x16x32_bf16 v[144:147], v[100:103], v[136:139], 0
  v_mfma_f32_16x16x32_bf16 v[144:147], v[76:79], v[132:135], v[144:147]
  v_add_f32 v128, v128, v129
  v_rcp_f32 v130, v128
  s_nop 0
  v_mul_f32 v148, v130, v148
  v_mul_f32 v149, v130, v149
  v_mul_f32 v150, v130, v150
  v_mul_f32 v151, v130, v151
  v_cvt_pk_bf16_f32 v148, v148, v149
  v_cvt_pk_bf16_f32 v149, v150, v151
  ds_write_b32 v5, v148 offset:0
  ds_write_b32 v5, v149 offset:1024
  v_mul_f32 v140, v130, v140
  v_mul_f32 v141, v130, v141
  v_mul_f32 v142, v130, v142
  v_mul_f32 v143, v130, v143
  v_cvt_pk_bf16_f32 v140, v140, v141
  v_cvt_pk_bf16_f32 v141, v142, v143
  ds_write_b32 v5, v140 offset:2048
  ds_write_b32 v5, v141 offset:3072
  v_mul_f32 v144, v130, v144
  v_mul_f32 v145, v130, v145
  v_mul_f32 v146, v130, v146
  v_mul_f32 v147, v130, v147
  v_cvt_pk_bf16_f32 v144, v144, v145
  v_cvt_pk_bf16_f32 v145, v146, v147
  ds_write_b32 v5, v144 offset:4096
  ds_write_b32 v5, v145 offset:5120
  v_mfma_f32_16x16x32_bf16 v[128:131], v[60:63], v[124:127], v[40:43]
  v_mfma_f32_16x16x32_bf16 v[128:131], v[62:65], v[14:17], v[128:131]
  v_mfma_f32_16x16x32_bf16 v[132:135], v[80:83], v[124:127], v[36:39]
  v_mfma_f32_16x16x32_bf16 v[132:135], v[82:85], v[14:17], v[132:135]
  v_mfma_f32_16x16x32_bf16 v[136:139], v[88:91], v[124:127], v[32:35]
  v_mfma_f32_16x16x32_bf16 v[136:139], v[90:93], v[14:17], v[136:139]
  v_mfma_f32_16x16x32_bf16 v[140:143], v[108:111], v[124:127], v[28:31]
  v_mfma_f32_16x16x32_bf16 v[140:143], v[110:113], v[14:17], v[140:143]
  v_add_f32 v128, v54, v128
  v_add_f32 v129, v54, v129
  v_add_f32 v130, v54, v130
  v_add_f32 v131, v54, v131
  v_add_f32 v132, v54, v132
  v_add_f32 v133, v54, v133
  v_add_f32 v134, v54, v134
  v_add_f32 v135, v54, v135
  v_add_f32 v136, v55, v136
  v_add_f32 v137, v55, v137
  v_add_f32 v138, v55, v138
  v_add_f32 v139, v55, v139
  v_add_f32 v140, v55, v140
  v_add_f32 v141, v55, v141
  v_add_f32 v142, v55, v142
  v_add_f32 v143, v55, v143
  v_max_f32 v58, v128, v129
  v_max3_f32 v58, v130, v131, v58
  v_max3_f32 v58, v132, v133, v58
  v_max3_f32 v58, v134, v135, v58
  v_max3_f32 v58, v136, v137, v58
  v_max3_f32 v58, v138, v139, v58
  v_max3_f32 v58, v140, v141, v58
  v_max3_f32 v58, v142, v143, v58
  v_mov_b32 v59, v58
  s_nop 1
  v_permlane32_swap_b32 v58, v59
  v_max_f32 v58, v58, v59
  v_mov_b32 v59, v58
  s_nop 1
  v_permlane16_swap_b32 v58, v59
  v_max_f32 v58, v58, v59
  v_sub_f32 v128, v128, v58
  v_sub_f32 v129, v129, v58
  v_sub_f32 v130, v130, v58
  v_sub_f32 v131, v131, v58
  v_sub_f32 v132, v132, v58
  v_sub_f32 v133, v133, v58
  v_sub_f32 v134, v134, v58
  v_sub_f32 v135, v135, v58
  v_sub_f32 v136, v136, v58
  v_sub_f32 v137, v137, v58
  v_sub_f32 v138, v138, v58
  v_sub_f32 v139, v139, v58
  v_sub_f32 v140, v140, v58
  v_sub_f32 v141, v141, v58
  v_sub_f32 v142, v142, v58
  v_sub_f32 v143, v143, v58
  v_exp_f32 v128, v128
  v_exp_f32 v129, v129
  v_exp_f32 v130, v130
  v_exp_f32 v131, v131
  v_cvt_pk_bf16_f32 v128, v128, v129
  v_cvt_pk_bf16_f32 v129, v130, v131
  v_exp_f32 v132, v132
  v_exp_f32 v133, v133
  v_exp_f32 v134, v134
  v_exp_f32 v135, v135
  v_cvt_pk_bf16_f32 v130, v132, v133
  v_cvt_pk_bf16_f32 v131, v134, v135
  v_exp_f32 v136, v136
  v_exp_f32 v137, v137
  v_exp_f32 v138, v138
  v_exp_f32 v139, v139
  v_cvt_pk_bf16_f32 v132, v136, v137
  v_cvt_pk_bf16_f32 v133, v138, v139
  v_exp_f32 v140, v140
  v_exp_f32 v141, v141
  v_exp_f32 v142, v142
  v_exp_f32 v143, v143
  v_cvt_pk_bf16_f32 v134, v140, v141
  v_cvt_pk_bf16_f32 v135, v142, v143
  v_mov_b64 v[124:125], 0
  s_nop 1
  v_smfmac_f32_16x16x64_bf16 v[124:127], a[240:243], v[128:135], v10
  v_mfma_f32_16x16x32_bf16 v[144:147], v[96:99], v[132:135], 0
  v_mfma_f32_16x16x32_bf16 v[144:147], v[68:71], v[128:131], v[144:147]
  v_mfma_f32_16x16x32_bf16 v[136:139], v[72:75], v[128:131], 0
  v_mfma_f32_16x16x32_bf16 v[136:139], v[104:107], v[132:135], v[136:139]
  v_mfma_f32_16x16x32_bf16 v[140:143], v[100:103], v[132:135], 0
  v_mfma_f32_16x16x32_bf16 v[140:143], v[76:79], v[128:131], v[140:143]
  v_add_f32 v124, v124, v125
  v_rcp_f32 v126, v124
  s_nop 0
  v_mul_f32 v144, v126, v144
  v_mul_f32 v145, v126, v145
  v_mul_f32 v146, v126, v146
  v_mul_f32 v147, v126, v147
  v_cvt_pk_bf16_f32 v144, v144, v145
  v_cvt_pk_bf16_f32 v145, v146, v147
  ds_write_b32 v5, v144 offset:256
  ds_write_b32 v5, v145 offset:1280
  v_mul_f32 v136, v126, v136
  v_mul_f32 v137, v126, v137
  v_mul_f32 v138, v126, v138
  v_mul_f32 v139, v126, v139
  v_cvt_pk_bf16_f32 v136, v136, v137
  v_cvt_pk_bf16_f32 v137, v138, v139
  ds_write_b32 v5, v136 offset:2304
  ds_write_b32 v5, v137 offset:3328
  v_mul_f32 v140, v126, v140
  v_mul_f32 v141, v126, v141
  v_mul_f32 v142, v126, v142
  v_mul_f32 v143, v126, v143
  v_cvt_pk_bf16_f32 v140, v140, v141
  v_cvt_pk_bf16_f32 v141, v142, v143
  ds_write_b32 v5, v140 offset:4352
  ds_write_b32 v5, v141 offset:5376
  v_mfma_f32_16x16x32_bf16 v[124:127], v[90:93], v[120:123], v[36:39]
  v_mfma_f32_16x16x32_bf16 v[124:127], v[88:91], v[18:21], v[124:127]
  v_mfma_f32_16x16x32_bf16 v[128:131], v[110:113], v[120:123], v[32:35]
  v_mfma_f32_16x16x32_bf16 v[128:131], v[108:111], v[18:21], v[128:131]
  v_mfma_f32_16x16x32_bf16 v[132:135], v[62:65], v[120:123], v[44:47]
  v_mfma_f32_16x16x32_bf16 v[132:135], v[60:63], v[18:21], v[132:135]
  v_mfma_f32_16x16x32_bf16 v[136:139], v[82:85], v[120:123], v[40:43]
  v_mfma_f32_16x16x32_bf16 v[136:139], v[80:83], v[18:21], v[136:139]
  v_add_f32 v124, v54, v124
  v_add_f32 v125, v54, v125
  v_add_f32 v126, v54, v126
  v_add_f32 v127, v54, v127
  v_add_f32 v128, v54, v128
  v_add_f32 v129, v54, v129
  v_add_f32 v130, v54, v130
  v_add_f32 v131, v54, v131
  v_add_f32 v132, v55, v132
  v_add_f32 v133, v55, v133
  v_add_f32 v134, v55, v134
  v_add_f32 v135, v55, v135
  v_add_f32 v136, v55, v136
  v_add_f32 v137, v55, v137
  v_add_f32 v138, v55, v138
  v_add_f32 v139, v55, v139
  v_max_f32 v58, v124, v125
  v_max3_f32 v58, v126, v127, v58
  v_max3_f32 v58, v128, v129, v58
  v_max3_f32 v58, v130, v131, v58
  v_max3_f32 v58, v132, v133, v58
  v_max3_f32 v58, v134, v135, v58
  v_max3_f32 v58, v136, v137, v58
  v_max3_f32 v58, v138, v139, v58
  v_mov_b32 v59, v58
  s_nop 1
  v_permlane32_swap_b32 v58, v59
  v_max_f32 v58, v58, v59
  v_mov_b32 v59, v58
  s_nop 1
  v_permlane16_swap_b32 v58, v59
  v_max_f32 v58, v58, v59
  v_sub_f32 v124, v124, v58
  v_sub_f32 v125, v125, v58
  v_sub_f32 v126, v126, v58
  v_sub_f32 v127, v127, v58
  v_sub_f32 v128, v128, v58
  v_sub_f32 v129, v129, v58
  v_sub_f32 v130, v130, v58
  v_sub_f32 v131, v131, v58
  v_sub_f32 v132, v132, v58
  v_sub_f32 v133, v133, v58
  v_sub_f32 v134, v134, v58
  v_sub_f32 v135, v135, v58
  v_sub_f32 v136, v136, v58
  v_sub_f32 v137, v137, v58
  v_sub_f32 v138, v138, v58
  v_sub_f32 v139, v139, v58
  v_exp_f32 v124, v124
  v_exp_f32 v125, v125
  v_exp_f32 v126, v126
  v_exp_f32 v127, v127
  v_cvt_pk_bf16_f32 v124, v124, v125
  v_cvt_pk_bf16_f32 v125, v126, v127
  v_exp_f32 v128, v128
  v_exp_f32 v129, v129
  v_exp_f32 v130, v130
  v_exp_f32 v131, v131
  v_cvt_pk_bf16_f32 v126, v128, v129
  v_cvt_pk_bf16_f32 v127, v130, v131
  v_exp_f32 v132, v132
  v_exp_f32 v133, v133
  v_exp_f32 v134, v134
  v_exp_f32 v135, v135
  v_cvt_pk_bf16_f32 v128, v132, v133
  v_cvt_pk_bf16_f32 v129, v134, v135
  v_exp_f32 v136, v136
  v_exp_f32 v137, v137
  v_exp_f32 v138, v138
  v_exp_f32 v139, v139
  v_cvt_pk_bf16_f32 v130, v136, v137
  v_cvt_pk_bf16_f32 v131, v138, v139
  v_mov_b64 v[120:121], 0
  s_nop 1
  v_smfmac_f32_16x16x64_bf16 v[120:123], a[240:243], v[124:131], v10
  v_mfma_f32_16x16x32_bf16 v[140:143], v[68:71], v[128:131], 0
  v_mfma_f32_16x16x32_bf16 v[140:143], v[96:99], v[124:127], v[140:143]
  v_mfma_f32_16x16x32_bf16 v[132:135], v[104:107], v[124:127], 0
  v_mfma_f32_16x16x32_bf16 v[132:135], v[72:75], v[128:131], v[132:135]
  v_mfma_f32_16x16x32_bf16 v[136:139], v[76:79], v[128:131], 0
  v_mfma_f32_16x16x32_bf16 v[136:139], v[100:103], v[124:127], v[136:139]
  v_add_f32 v120, v120, v121
  v_rcp_f32 v122, v120
  s_nop 0
  v_mul_f32 v140, v122, v140
  v_mul_f32 v141, v122, v141
  v_mul_f32 v142, v122, v142
  v_mul_f32 v143, v122, v143
  v_cvt_pk_bf16_f32 v140, v140, v141
  v_cvt_pk_bf16_f32 v141, v142, v143
  ds_write_b32 v5, v140 offset:512
  ds_write_b32 v5, v141 offset:1536
  v_mul_f32 v132, v122, v132
  v_mul_f32 v133, v122, v133
  v_mul_f32 v134, v122, v134
  v_mul_f32 v135, v122, v135
  v_cvt_pk_bf16_f32 v132, v132, v133
  v_cvt_pk_bf16_f32 v133, v134, v135
  ds_write_b32 v5, v132 offset:2560
  s_waitcnt lgkmcnt(12)
  ds_write_b32 v5, v133 offset:3584
  v_mul_f32 v136, v122, v136
  v_mul_f32 v137, v122, v137
  v_mul_f32 v138, v122, v138
  v_mul_f32 v139, v122, v139
  v_cvt_pk_bf16_f32 v136, v136, v137
  v_cvt_pk_bf16_f32 v137, v138, v139
  ds_write_b32 v5, v136 offset:4608
  ds_write_b32 v5, v137 offset:5632
  v_mfma_f32_16x16x32_bf16 v[120:123], v[88:91], v[116:119], v[40:43]
  v_mfma_f32_16x16x32_bf16 v[120:123], v[90:93], v[20:23], v[120:123]
  v_mfma_f32_16x16x32_bf16 v[124:127], v[108:111], v[116:119], v[36:39]
  v_mfma_f32_16x16x32_bf16 v[124:127], v[110:113], v[20:23], v[124:127]
  v_mfma_f32_16x16x32_bf16 v[128:131], v[60:63], v[116:119], v[48:51]
  v_mfma_f32_16x16x32_bf16 v[128:131], v[62:65], v[20:23], v[128:131]
  v_mfma_f32_16x16x32_bf16 v[88:91], v[80:83], v[116:119], v[44:47]
  v_mfma_f32_16x16x32_bf16 v[88:91], v[82:85], v[20:23], v[88:91]
  v_add_f32 v120, v54, v120
  v_add_f32 v121, v54, v121
  v_add_f32 v122, v54, v122
  v_add_f32 v123, v54, v123
  v_add_f32 v124, v54, v124
  v_add_f32 v125, v54, v125
  v_add_f32 v126, v54, v126
  v_add_f32 v127, v54, v127
  v_add_f32 v128, v55, v128
  v_add_f32 v129, v55, v129
  v_add_f32 v130, v55, v130
  v_add_f32 v131, v55, v131
  v_add_f32 v88, v55, v88
  v_add_f32 v89, v55, v89
  v_add_f32 v90, v55, v90
  v_add_f32 v91, v55, v91
  v_max_f32 v58, v120, v121
  v_max3_f32 v58, v122, v123, v58
  v_max3_f32 v58, v124, v125, v58
  v_max3_f32 v58, v126, v127, v58
  v_max3_f32 v58, v128, v129, v58
  v_max3_f32 v58, v130, v131, v58
  v_max3_f32 v58, v88, v89, v58
  v_max3_f32 v58, v90, v91, v58
  v_mov_b32 v59, v58
  s_nop 1
  v_permlane32_swap_b32 v58, v59
  v_max_f32 v58, v58, v59
  v_mov_b32 v59, v58
  s_nop 1
  v_permlane16_swap_b32 v58, v59
  v_max_f32 v58, v58, v59
  v_sub_f32 v120, v120, v58
  v_sub_f32 v121, v121, v58
  v_sub_f32 v122, v122, v58
  v_sub_f32 v123, v123, v58
  v_sub_f32 v124, v124, v58
  v_sub_f32 v125, v125, v58
  v_sub_f32 v126, v126, v58
  v_sub_f32 v127, v127, v58
  v_sub_f32 v128, v128, v58
  v_sub_f32 v129, v129, v58
  v_sub_f32 v130, v130, v58
  v_sub_f32 v131, v131, v58
  v_sub_f32 v88, v88, v58
  v_sub_f32 v89, v89, v58
  v_sub_f32 v90, v90, v58
  v_sub_f32 v91, v91, v58
  v_exp_f32 v120, v120
  v_exp_f32 v121, v121
  v_exp_f32 v122, v122
  v_exp_f32 v123, v123
  v_cvt_pk_bf16_f32 v120, v120, v121
  v_cvt_pk_bf16_f32 v121, v122, v123
  v_exp_f32 v124, v124
  v_exp_f32 v125, v125
  v_exp_f32 v126, v126
  v_exp_f32 v127, v127
  v_cvt_pk_bf16_f32 v122, v124, v125
  v_cvt_pk_bf16_f32 v123, v126, v127
  v_exp_f32 v128, v128
  v_exp_f32 v129, v129
  v_exp_f32 v130, v130
  v_exp_f32 v131, v131
  v_cvt_pk_bf16_f32 v124, v128, v129
  v_cvt_pk_bf16_f32 v125, v130, v131
  v_exp_f32 v88, v88
  v_exp_f32 v89, v89
  v_exp_f32 v90, v90
  v_exp_f32 v91, v91
  v_cvt_pk_bf16_f32 v126, v88, v89
  v_cvt_pk_bf16_f32 v127, v90, v91
  v_mov_b64 v[80:81], 0
  s_nop 1
  v_smfmac_f32_16x16x64_bf16 v[80:83], a[240:243], v[120:127], v10
  v_mfma_f32_16x16x32_bf16 v[84:87], v[68:71], v[124:127], 0
  v_mfma_f32_16x16x32_bf16 v[84:87], v[96:99], v[120:123], v[84:87]
  v_mfma_f32_16x16x32_bf16 v[60:63], v[104:107], v[120:123], 0
  v_mfma_f32_16x16x32_bf16 v[60:63], v[72:75], v[124:127], v[60:63]
  v_mfma_f32_16x16x32_bf16 v[64:67], v[76:79], v[124:127], 0
  v_mfma_f32_16x16x32_bf16 v[64:67], v[100:103], v[120:123], v[64:67]
  v_add_f32 v80, v80, v81
  v_rcp_f32 v82, v80
  s_nop 0
  v_mul_f32 v84, v82, v84
  v_mul_f32 v85, v82, v85
  v_mul_f32 v86, v82, v86
  v_mul_f32 v87, v82, v87
  v_cvt_pk_bf16_f32 v84, v84, v85
  v_cvt_pk_bf16_f32 v85, v86, v87
  s_waitcnt lgkmcnt(12)
  ds_write_b32 v5, v84 offset:768
  ds_write_b32 v5, v85 offset:1792
  v_mul_f32 v60, v82, v60
  v_mul_f32 v61, v82, v61
  v_mul_f32 v62, v82, v62
  v_mul_f32 v63, v82, v63
  v_cvt_pk_bf16_f32 v60, v60, v61
  v_cvt_pk_bf16_f32 v61, v62, v63
  ds_write_b32 v5, v60 offset:2816
  s_waitcnt lgkmcnt(12)
  ds_write_b32 v5, v61 offset:3840
  v_mul_f32 v64, v82, v64
  v_mul_f32 v65, v82, v65
  v_mul_f32 v66, v82, v66
  v_mul_f32 v67, v82, v67
  v_cvt_pk_bf16_f32 v64, v64, v65
  v_cvt_pk_bf16_f32 v65, v66, v67
  ds_write_b32 v5, v64 offset:4864
  ds_write_b32 v5, v65 offset:5888
  s_waitcnt lgkmcnt(0)
  s_barrier
  ds_read_b128 a[244:247], v3 offset:0
  ds_read_b128 a[248:251], v3 offset:4096
  ds_read_b128 a[252:255], v3 offset:8192
  ds_read_b128 v[72:75], v3 offset:12288
  ds_read_b128 v[76:79], v3 offset:16384
  ds_read_b128 v[84:87], v3 offset:20480
  s_waitcnt lgkmcnt(5)
  v_mfma_f32_16x16x32_bf16 v[68:71], a[244:247], v[184:187], 0
  s_waitcnt lgkmcnt(4)
  v_mfma_f32_16x16x32_bf16 v[68:71], a[248:251], v[200:203], v[68:71]
  s_waitcnt lgkmcnt(3)
  v_mfma_f32_16x16x32_bf16 v[68:71], a[252:255], v[216:219], v[68:71]
  s_waitcnt lgkmcnt(2)
  v_mfma_f32_16x16x32_bf16 v[68:71], v[72:75], v[232:235], v[68:71]
  s_waitcnt lgkmcnt(1)
  v_mfma_f32_16x16x32_bf16 v[68:71], v[76:79], v[248:251], v[68:71]
  s_waitcnt lgkmcnt(0)
  v_mfma_f32_16x16x32_bf16 v[68:71], v[84:87], a[224:227], v[68:71]
  v_mfma_f32_16x16x32_bf16 v[80:83], v[84:87], a[228:231], 0
  v_mfma_f32_16x16x32_bf16 v[80:83], v[76:79], v[252:255], v[80:83]
  v_mfma_f32_16x16x32_bf16 v[80:83], v[72:75], v[236:239], v[80:83]
  v_mfma_f32_16x16x32_bf16 v[80:83], a[252:255], v[220:223], v[80:83]
  v_mfma_f32_16x16x32_bf16 v[80:83], a[248:251], v[204:207], v[80:83]
  v_mfma_f32_16x16x32_bf16 v[80:83], a[244:247], v[188:191], v[80:83]
  v_mfma_f32_16x16x32_bf16 v[60:63], a[244:247], v[192:195], 0
  v_mfma_f32_16x16x32_bf16 v[60:63], a[248:251], v[208:211], v[60:63]
  v_mfma_f32_16x16x32_bf16 v[60:63], a[252:255], v[224:227], v[60:63]
  v_mfma_f32_16x16x32_bf16 v[60:63], v[72:75], v[240:243], v[60:63]
  v_mfma_f32_16x16x32_bf16 v[60:63], v[76:79], a[216:219], v[60:63]
  v_mfma_f32_16x16x32_bf16 v[60:63], v[84:87], a[232:235], v[60:63]
  v_mfma_f32_16x16x32_bf16 v[64:67], v[84:87], a[236:239], 0
  v_mfma_f32_16x16x32_bf16 v[64:67], v[76:79], a[220:223], v[64:67]
  v_mfma_f32_16x16x32_bf16 v[64:67], v[72:75], v[244:247], v[64:67]
  v_mfma_f32_16x16x32_bf16 v[64:67], a[252:255], v[228:231], v[64:67]
  v_mfma_f32_16x16x32_bf16 v[64:67], a[248:251], v[212:215], v[64:67]
  v_mfma_f32_16x16x32_bf16 v[64:67], a[244:247], v[196:199], v[64:67]
  v_cvt_pk_bf16_f32 v68, v68, v80
  v_cvt_pk_bf16_f32 v69, v69, v81
  v_cvt_pk_bf16_f32 v70, v70, v82
  v_cvt_pk_bf16_f32 v71, v71, v83
  buffer_store_dword v68, v7, s[24:27], s33 offen offset:0 nt
  buffer_store_dword v69, v7, s[24:27], s33 offen offset:384 nt
  buffer_store_dword v70, v7, s[24:27], s33 offen offset:768 nt
  buffer_store_dword v71, v7, s[24:27], s33 offen offset:1152 nt
  v_cvt_pk_bf16_f32 v60, v60, v64
  v_cvt_pk_bf16_f32 v61, v61, v65
  v_cvt_pk_bf16_f32 v62, v62, v66
  v_cvt_pk_bf16_f32 v63, v63, v67
  buffer_store_dword v60, v8, s[24:27], s33 offen offset:0 nt
  buffer_store_dword v61, v8, s[24:27], s33 offen offset:384 nt
  buffer_store_dword v62, v8, s[24:27], s33 offen offset:768 nt
  buffer_store_dword v63, v8, s[24:27], s33 offen offset:1152 nt
  ds_read_b128 a[244:247], v4 offset:0
  ds_read_b128 a[248:251], v4 offset:4096
  ds_read_b128 a[252:255], v4 offset:8192
  ds_read_b128 v[68:71], v4 offset:12288
  ds_read_b128 v[72:75], v4 offset:16384
  ds_read_b128 v[76:79], v4 offset:20480
  s_waitcnt lgkmcnt(5)
  v_mfma_f32_16x16x32_bf16 v[60:63], a[244:247], v[184:187], 0
  s_waitcnt lgkmcnt(4)
  v_mfma_f32_16x16x32_bf16 v[60:63], a[248:251], v[200:203], v[60:63]
  s_waitcnt lgkmcnt(3)
  v_mfma_f32_16x16x32_bf16 v[60:63], a[252:255], v[216:219], v[60:63]
  s_waitcnt lgkmcnt(2)
  v_mfma_f32_16x16x32_bf16 v[60:63], v[68:71], v[232:235], v[60:63]
  s_waitcnt lgkmcnt(1)
  v_mfma_f32_16x16x32_bf16 v[60:63], v[72:75], v[248:251], v[60:63]
  s_waitcnt lgkmcnt(0)
  v_mfma_f32_16x16x32_bf16 v[60:63], v[76:79], a[224:227], v[60:63]
  v_mfma_f32_16x16x32_bf16 v[64:67], v[76:79], a[228:231], 0
  v_mfma_f32_16x16x32_bf16 v[64:67], v[72:75], v[252:255], v[64:67]
  v_mfma_f32_16x16x32_bf16 v[64:67], v[68:71], v[236:239], v[64:67]
  v_mfma_f32_16x16x32_bf16 v[64:67], a[252:255], v[220:223], v[64:67]
  v_mfma_f32_16x16x32_bf16 v[64:67], a[248:251], v[204:207], v[64:67]
  v_mfma_f32_16x16x32_bf16 v[64:67], a[244:247], v[188:191], v[64:67]
  s_nop 7
  v_cvt_pk_bf16_f32 v60, v60, v64
  v_cvt_pk_bf16_f32 v61, v61, v65
  v_cvt_pk_bf16_f32 v62, v62, v66
  v_cvt_pk_bf16_f32 v63, v63, v67
  buffer_store_dword v60, v7, s[24:27], s34 offen offset:0 nt
  buffer_store_dword v61, v7, s[24:27], s34 offen offset:384 nt
  buffer_store_dword v62, v7, s[24:27], s34 offen offset:768 nt
  buffer_store_dword v63, v7, s[24:27], s34 offen offset:1152 nt
  ds_read_b128 a[244:247], v3 offset:512
  ds_read_b128 a[248:251], v3 offset:4608
  ds_read_b128 a[252:255], v3 offset:8704
  ds_read_b128 v[72:75], v3 offset:12800
  ds_read_b128 v[76:79], v3 offset:16896
  ds_read_b128 v[84:87], v3 offset:20992
  s_waitcnt lgkmcnt(5)
  v_mfma_f32_16x16x32_bf16 v[60:63], a[244:247], v[184:187], 0
  s_waitcnt lgkmcnt(4)
  v_mfma_f32_16x16x32_bf16 v[60:63], a[248:251], v[200:203], v[60:63]
  s_waitcnt lgkmcnt(3)
  v_mfma_f32_16x16x32_bf16 v[60:63], a[252:255], v[216:219], v[60:63]
  s_waitcnt lgkmcnt(2)
  v_mfma_f32_16x16x32_bf16 v[60:63], v[72:75], v[232:235], v[60:63]
  s_waitcnt lgkmcnt(1)
  v_mfma_f32_16x16x32_bf16 v[60:63], v[76:79], v[248:251], v[60:63]
  s_waitcnt lgkmcnt(0)
  v_mfma_f32_16x16x32_bf16 v[60:63], v[84:87], a[224:227], v[60:63]
  v_mfma_f32_16x16x32_bf16 v[80:83], v[84:87], a[228:231], 0
  v_mfma_f32_16x16x32_bf16 v[80:83], v[76:79], v[252:255], v[80:83]
  v_mfma_f32_16x16x32_bf16 v[80:83], v[72:75], v[236:239], v[80:83]
  v_mfma_f32_16x16x32_bf16 v[80:83], a[252:255], v[220:223], v[80:83]
  v_mfma_f32_16x16x32_bf16 v[80:83], a[248:251], v[204:207], v[80:83]
  v_mfma_f32_16x16x32_bf16 v[80:83], a[244:247], v[188:191], v[80:83]
  v_mfma_f32_16x16x32_bf16 v[64:67], a[244:247], v[192:195], 0
  v_mfma_f32_16x16x32_bf16 v[64:67], a[248:251], v[208:211], v[64:67]
  v_mfma_f32_16x16x32_bf16 v[64:67], a[252:255], v[224:227], v[64:67]
  v_mfma_f32_16x16x32_bf16 v[64:67], v[72:75], v[240:243], v[64:67]
  v_mfma_f32_16x16x32_bf16 v[64:67], v[76:79], a[216:219], v[64:67]
  v_mfma_f32_16x16x32_bf16 v[64:67], v[84:87], a[232:235], v[64:67]
  v_mfma_f32_16x16x32_bf16 v[68:71], v[84:87], a[236:239], 0
  v_mfma_f32_16x16x32_bf16 v[68:71], v[76:79], a[220:223], v[68:71]
  v_mfma_f32_16x16x32_bf16 v[68:71], v[72:75], v[244:247], v[68:71]
  v_mfma_f32_16x16x32_bf16 v[68:71], a[252:255], v[228:231], v[68:71]
  v_mfma_f32_16x16x32_bf16 v[68:71], a[248:251], v[212:215], v[68:71]
  v_mfma_f32_16x16x32_bf16 v[68:71], a[244:247], v[196:199], v[68:71]
  v_cvt_pk_bf16_f32 v60, v60, v80
  v_cvt_pk_bf16_f32 v61, v61, v81
  v_cvt_pk_bf16_f32 v62, v62, v82
  v_cvt_pk_bf16_f32 v63, v63, v83
  buffer_store_dword v60, v7, s[24:27], s35 offen offset:0 nt
  buffer_store_dword v61, v7, s[24:27], s35 offen offset:384 nt
  buffer_store_dword v62, v7, s[24:27], s35 offen offset:768 nt
  buffer_store_dword v63, v7, s[24:27], s35 offen offset:1152 nt
  v_cvt_pk_bf16_f32 v64, v64, v68
  v_cvt_pk_bf16_f32 v65, v65, v69
  v_cvt_pk_bf16_f32 v66, v66, v70
  v_cvt_pk_bf16_f32 v67, v67, v71
  buffer_store_dword v64, v8, s[24:27], s35 offen offset:0 nt
  buffer_store_dword v65, v8, s[24:27], s35 offen offset:384 nt
  buffer_store_dword v66, v8, s[24:27], s35 offen offset:768 nt
  buffer_store_dword v67, v8, s[24:27], s35 offen offset:1152 nt
  ds_read_b128 a[244:247], v4 offset:512
  ds_read_b128 a[248:251], v4 offset:4608
  ds_read_b128 a[252:255], v4 offset:8704
  ds_read_b128 v[72:75], v4 offset:12800
  ds_read_b128 v[76:79], v4 offset:16896
  ds_read_b128 v[80:83], v4 offset:20992
  s_waitcnt lgkmcnt(5)
  v_mfma_f32_16x16x32_bf16 v[60:63], a[244:247], v[184:187], 0
  s_waitcnt lgkmcnt(4)
  v_mfma_f32_16x16x32_bf16 v[60:63], a[248:251], v[200:203], v[60:63]
  s_waitcnt lgkmcnt(3)
  v_mfma_f32_16x16x32_bf16 v[60:63], a[252:255], v[216:219], v[60:63]
  s_waitcnt lgkmcnt(2)
  v_mfma_f32_16x16x32_bf16 v[60:63], v[72:75], v[232:235], v[60:63]
  s_waitcnt lgkmcnt(1)
  v_mfma_f32_16x16x32_bf16 v[60:63], v[76:79], v[248:251], v[60:63]
  s_waitcnt lgkmcnt(0)
  v_mfma_f32_16x16x32_bf16 v[60:63], v[80:83], a[224:227], v[60:63]
  v_mfma_f32_16x16x32_bf16 v[64:67], v[80:83], a[228:231], 0
  v_mfma_f32_16x16x32_bf16 v[64:67], v[76:79], v[252:255], v[64:67]
  v_mfma_f32_16x16x32_bf16 v[64:67], v[72:75], v[236:239], v[64:67]
  v_mfma_f32_16x16x32_bf16 v[64:67], a[252:255], v[220:223], v[64:67]
  v_mfma_f32_16x16x32_bf16 v[64:67], a[248:251], v[204:207], v[64:67]
  v_mfma_f32_16x16x32_bf16 v[64:67], a[244:247], v[188:191], v[64:67]
  s_nop 7
  v_cvt_pk_bf16_f32 v60, v60, v64
  v_cvt_pk_bf16_f32 v61, v61, v65
  v_cvt_pk_bf16_f32 v62, v62, v66
  v_cvt_pk_bf16_f32 v63, v63, v67
  buffer_store_dword v60, v7, s[24:27], s36 offen offset:0 nt
  buffer_store_dword v61, v7, s[24:27], s36 offen offset:384 nt
  buffer_store_dword v62, v7, s[24:27], s36 offen offset:768 nt
  buffer_store_dword v63, v7, s[24:27], s36 offen offset:1152 nt
  v_sub_u32 v6, v6, v56
  v_sub_u32 v7, v7, v57
  v_sub_u32 v8, v8, v57
  v_mov_b32 v54, 0
  v_mov_b32 v55, 0
  v_mov_b32 v56, 0
  v_mov_b32 v57, 0
  s_add_u32 s50, s50, 1
  s_cmp_eq_u32 s50, 16
  s_cselect_b32 s5, s58, s43
  s_add_u32 s56, s56, s5
  s_mul_i32 s5, s3, s57
  s_add_u32 s31, s56, s5
  s_add_u32 s32, s31, 786432
  s_xor_b32 s5, s4, 0
  s_mul_i32 s5, s5, 393216
  s_add_u32 s33, s5, s56
  s_xor_b32 s5, s4, 1
  s_mul_i32 s5, s5, 393216
  s_add_u32 s34, s5, s56
  s_xor_b32 s5, s4, 2
  s_mul_i32 s5, s5, 393216
  s_add_u32 s35, s5, s56
  s_xor_b32 s5, s4, 3
  s_mul_i32 s5, s5, 393216
  s_add_u32 s36, s5, s56
  s_cmp_lt_u32 s50, s49
  s_nop 7
  s_cbranch_scc1 L_sloop
  s_branch L_fin
.section .rodata,"a"
.p2align 6
.amdhsa_kernel standalone__window_attn_swin__vision_kernel
  .amdhsa_next_free_vgpr 512
  .amdhsa_next_free_sgpr 102
  .amdhsa_accum_offset 256
  .amdhsa_group_segment_fixed_size 0
  .amdhsa_kernarg_size 72
  .amdhsa_user_sgpr_count 2
  .amdhsa_user_sgpr_kernarg_segment_ptr 1
  .amdhsa_system_sgpr_workgroup_id_x 1
.end_amdhsa_kernel
```

```asm
; @launch grid=(256,1,1) block=(256,1,1) lds=163840
.amdgcn_target "amdgcn-amd-amdhsa--gfx950"
.text
.globl standalone__window_attn_swin__vision_kernel
.p2align 12
.p2align 8
.type standalone__window_attn_swin__vision_kernel,@function
standalone__window_attn_swin__vision_kernel:
  s_cmpk_ge_u32 s2, 256
  s_cbranch_scc1 L_end
  s_load_dwordx2 s[8:9], s[0:1], 0
  s_load_dwordx2 s[20:21], s[0:1], 24
  s_load_dwordx2 s[12:13], s[0:1], 8
  s_load_dwordx2 s[16:17], s[0:1], 16
  s_load_dwordx2 s[24:25], s[0:1], 48
  s_load_dwordx2 s[62:63], s[0:1], 64
  v_lshrrev_b32 v73, 6, v0
  s_lshr_b32 s49, s2, 3
  v_readfirstlane_b32 s3, v73
  s_getpc_b64 s[50:51]
  v_and_b32 v73, 15, v0
  v_mad_u32_u24 v73, s49, 9, v73
  v_lshlrev_b32 v73, 7, v73
  v_min_u32 v73, L_safe-standalone__window_attn_swin__vision_kernel-256, v73
  v_mov_b32 v59, s51
  v_add_co_u32 v58, vcc, s50, v73
  s_and_b32 s47, s2, 63
  s_lshr_b32 s48, s2, 6
  v_addc_co_u32 v59, vcc, 0, v59, vcc
  global_load_dword v94, v[58:59], off
  v_bfe_u32 v56, v0, 3, 4
  v_and_b32 v54, 7, v0
  v_lshrrev_b32 v66, 1, v56
  v_lshlrev_b32 v74, 2, v56
  v_and_b32 v74, 4, v74
  v_xor_b32 v66, v66, v74
  v_xor_b32 v66, v54, v66
  v_and_b32 v55, 7, v56
  s_add_u32 s48, s48, 60
  s_cmp_lt_u32 s2, 60
  s_cselect_b32 s48, s2, s48
  s_cselect_b32 s47, 63, s47
  s_lshl_b32 s5, s47, 3
  s_add_u32 s5, s5, 4
  v_add_u32 v74, s5, v55
  v_and_b32 v74, 511, v74
  v_mul_u32_u24 v74, 0x180, v74
  v_lshlrev_b32 v57, 4, v66
  v_add_u32 v6, v57, v74
  v_and_b32 v64, 63, v0
  v_lshlrev_b32 v58, 4, v64
  s_mov_b32 s57, 196608
  s_lshl_b32 s5, s48, 3
  s_add_u32 s5, s5, s3
  s_add_u32 s5, s5, 4
  s_mul_i32 s31, s5, s57
  s_add_u32 s5, s5, 4
  s_and_b32 s5, s5, 511
  s_mul_i32 s32, s5, s57
  s_lshl_b32 s46, s3, 10
  s_lshl_b32 s5, s3, 11
  s_add_u32 m0, s5, 151552
  s_mov_b32 s11, 0x20000
  s_mov_b32 s10, 100663296
  s_mov_b32 s23, s11
  s_movk_i32 s22, 1800
  s_mov_b32 s15, s11
  s_mov_b32 s14, 221184
  s_waitcnt lgkmcnt(0)
  buffer_load_dwordx4 v58, s[20:23], 0 offen lds
  buffer_load_dwordx4 v58, s[20:23], 0 offen offset:1024 lds
  s_add_u32 m0, s46, 0
  v_and_b32 v66, 2, v56
  buffer_load_dwordx4 v6, s[8:11], s31 offen offset:0 nt lds
  s_add_u32 m0, s46, 8064
  v_lshrrev_b32 v74, 1, v56
  buffer_load_dwordx4 v6, s[8:11], s31 offen offset:128 nt lds
  s_add_u32 m0, s46, 16128
  v_and_b32 v74, 4, v74
  buffer_load_dwordx4 v6, s[8:11], s31 offen offset:256 nt lds
  s_add_u32 m0, s46, 4096
  v_or_b32 v74, v66, v74
  buffer_load_dwordx4 v6, s[8:11], s32 offen offset:0 nt lds
  s_add_u32 m0, s46, 12160
  v_xor_b32 v74, v54, v74
  buffer_load_dwordx4 v6, s[8:11], s32 offen offset:128 nt lds
  s_add_u32 m0, s46, 20224
  v_lshlrev_b32 v74, 4, v74
  buffer_load_dwordx4 v6, s[8:11], s32 offen offset:256 nt lds
  v_mul_u32_u24 v56, 1152, v55
  v_add_u32 v58, v74, v56
  s_mul_i32 s44, s3, 9216
  s_mov_b32 s19, s11
  s_mov_b32 s18, 73728
  s_lshl_b32 s49, s49, 2
  s_add_u32 s49, s49, s3
  s_mul_i32 s50, s49, 2304
  v_min_u32 v92, 17, v64
  v_lshlrev_b32 v92, 7, v92
  v_lshlrev_b32 v66, 1, v66
  v_xor_b32 v66, v54, v66
  v_mul_u32_u24 v74, 0x180, v55
  v_lshl_add_u32 v71, v66, 4, v74
  s_mul_i32 s45, s3, 3072
  v_add_u32 v6, v57, v74
  s_mov_b32 s27, s11
  s_mov_b32 s26, 100663296
  v_and_b32 v54, 15, v64
  v_lshrrev_b32 v55, 4, v64
  v_lshrrev_b32 v73, 1, v54
  v_lshlrev_b32 v66, 2, v54
  v_and_b32 v66, 4, v66
  v_xor_b32 v73, v73, v66
  v_xor_b32 v73, v55, v73
  v_lshlrev_b32 v73, 4, v73
  v_lshl_add_u32 v0, v54, 7, v73
  v_xor_b32 v1, 64, v0
  v_subrev_u32 v2, s46, v0
  s_add_u32 s28, s46, 28672
  s_add_u32 s29, s46, 53248
  s_mov_b32 s30, s46
  s_and_b32 s4, s3, 1
  v_lshlrev_b32 v73, 4, v54
  v_lshl_add_u32 v66, v55, 10, v73
  s_lshl_b32 s5, s4, 8
  s_add_u32 s5, s5, 77824
  v_add_u32 v3, s5, v66
  v_xor_b32 v4, 0x100, v3
  s_mul_i32 s5, s3, 6144
  s_add_u32 s6, s5, 102400
  s_add_u32 s5, s5, 77824
  s_xor_b32 s41, s5, s6
  v_lshl_add_u32 v66, v55, 2, v73
  v_add_u32 v5, s5, v66
  v_and_b32 v65, 7, v54
  v_lshrrev_b32 v70, 3, v54
  v_and_b32 v67, 1, v55
  v_lshrrev_b32 v72, 1, v55
  v_mul_u32_u24 v73, 0x600, v67
  v_mul_u32_u24 v66, s57, v72
  v_add_u32 v73, v73, v66
  v_lshl_add_u32 v73, v54, 2, v73
  s_lshr_b32 s49, s3, 1
  s_lshl_b32 s5, s49, 6
  s_add_u32 s6, s5, 256
  v_add_u32 v53, s6, v73
  s_lshl_b32 s6, s4, 7
  s_add_u32 s5, s5, s6
  v_add_u32 v52, s5, v73
  s_lshl_b32 s5, s47, 3
  s_add_u32 s5, s5, 4
  s_mul_i32 s5, s5, 384
  s_cmp_eq_u32 s47, 63
  s_cselect_b32 s37, 0, s5
  s_cselect_b32 s5, s5, 0
  s_cselect_b32 s6, s57, 0
  v_mul_u32_u24 v66, s6, v67
  v_sub_u32 v66, s5, v66
  s_lshl_b32 s38, s48, 3
  s_add_u32 s38, s38, 4
  s_xor_b32 s6, s4, 0
  s_lshl_b32 s6, s6, 1
  s_add_u32 s6, s6, s38
  s_and_b32 s6, s6, 511
  s_mul_i32 s6, s6, s57
  s_add_u32 s33, s6, s37
  s_xor_b32 s6, s4, 1
  s_lshl_b32 s6, s6, 1
  s_add_u32 s6, s6, s38
  s_and_b32 s6, s6, 511
  s_mul_i32 s6, s6, s57
  s_add_u32 s34, s6, s37
  s_xor_b32 s6, s4, 2
  s_lshl_b32 s6, s6, 1
  s_add_u32 s6, s6, s38
  s_and_b32 s6, s6, 511
  s_mul_i32 s6, s6, s57
  s_add_u32 s35, s6, s37
  s_xor_b32 s6, s4, 3
  s_lshl_b32 s6, s6, 1
  s_add_u32 s6, s6, s38
  s_and_b32 s6, s6, 511
  s_mul_i32 s6, s6, s57
  s_add_u32 s36, s6, s37
  v_add_u32 v7, v52, v66
  v_add_u32 v8, v53, v66
  s_lshr_b32 s5, s2, 6
  s_and_b32 s6, s2, 63
  s_mul_i32 s56, s5, 15
  s_lshl_b32 s43, s57, 5
  s_cmp_eq_u32 s6, 63
  s_cselect_b32 s6, s56, s6
  s_cselect_b32 s5, 60, s5
  s_cselect_b32 s43, 3072, s43
  s_mul_i32 s5, s5, 1572864
  s_mul_i32 s6, s6, 3072
  s_add_u32 s5, s5, s6
  s_add_u32 s56, s5, 787968
  s_cmp_eq_u32 s43, 3072
  s_cselect_b32 s10, s10, 95158272
  s_mul_i32 s5, s3, s57
  s_add_u32 s31, s56, s5
  s_add_u32 s32, s31, 786432
  s_mul_i32 s6, s43, 3
  s_add_u32 s5, s5, s6
  s_xor_b32 s6, s4, 0
  s_mul_i32 s6, s6, 393216
  s_sub_u32 s37, s6, s5
  s_xor_b32 s6, s4, 1
  s_mul_i32 s6, s6, 393216
  s_sub_u32 s38, s6, s5
  s_xor_b32 s6, s4, 2
  s_mul_i32 s6, s6, 393216
  s_sub_u32 s39, s6, s5
  s_xor_b32 s6, s4, 3
  s_mul_i32 s6, s6, 393216
  s_sub_u32 s40, s6, s5
  s_mul_i32 s97, s43, 17
  s_add_u32 s97, s97, s31
  s_mov_b32 s42, 0x3e553b95
  v_lshrrev_b32 v73, 2, v54
  v_lshl_add_u32 v66, v67, 1, v70
  v_lshl_add_u32 v73, v55, 3, v73
  v_lshlrev_b32 v73, 7, v73
  v_lshl_add_u32 v73, v66, 5, v73
  v_and_b32 v75, 3, v54
  v_lshl_add_u32 v73, v75, 3, v73
  s_mul_i32 s5, s3, 3
  s_and_b32 s6, s5, 3
  s_lshl_b32 s6, s6, 5
  s_lshr_b32 s7, s5, 2
  s_lshl_b32 s7, s7, 13
  s_add_u32 s7, s7, 28672
  v_xor_b32 v66, s6, v73
  v_add_u32 v61, s7, v66
  v_add_u32 v57, 73728, v61
  s_add_u32 s5, s5, 1
  s_and_b32 s6, s5, 3
  s_lshl_b32 s6, s6, 5
  s_lshr_b32 s7, s5, 2
  s_lshl_b32 s7, s7, 13
  s_add_u32 s7, s7, 28672
  v_xor_b32 v66, s6, v73
  v_add_u32 v62, s7, v66
  v_add_u32 v60, 73728, v62
  s_add_u32 s5, s5, 1
  s_and_b32 s6, s5, 3
  s_lshl_b32 s6, s6, 5
  s_lshr_b32 s7, s5, 2
  s_lshl_b32 s7, s7, 13
  s_add_u32 s7, s7, 28672
  v_xor_b32 v66, s6, v73
  v_add_u32 v63, s7, v66
  v_add_u32 v59, 73728, v63
  v_xor_b32 v66, s49, v67
  s_lshl_b32 s5, s4, 13
  v_lshl_add_u32 v73, v72, 3, v67
  v_lshl_add_u32 v73, v73, 2, v66
  v_lshl_add_u32 v73, v73, 4, v54
  v_lshlrev_b32 v73, 2, v73
  s_add_u32 s5, s5, 126976
  v_add_u32 v68, s5, v73
  v_add_u32 v69, 128, v68
  v_add_u32 v54, 143360, v73
  v_add_u32 v55, 128, v54
  s_mov_b32 s58, 0x05040100
  s_mov_b32 s59, 0x07060302
  v_cmp_gt_u32 vcc, 2, v75
  v_mov_b32 v73, 0x3f803f80
  v_mov_b32 v66, 0x44444444
  v_cndmask_b32 v73, 0, v73, vcc
  v_cmp_eq_u32 vcc, 1, v75
  v_mov_b32 v74, 0xeeeeeeee
  v_accvgpr_write_b32 a240, v73
  v_accvgpr_write_b32 a241, v73
  v_accvgpr_write_b32 a242, v73
  v_accvgpr_write_b32 a243, v73
  v_cndmask_b32 v10, v66, v74, vcc
  v_mov_b32 v9, 1.0
  s_mov_b32 s98, s43
  s_mov_b64 s[20:21], s[62:63]
  s_mov_b32 s22, 402653184
  s_min_u32 s96, s3, 1
  s_lshl_b32 s96, s96, 7
  s_xor_b32 s96, s96, 1152
  s_mov_b64 s[62:63], -1
  v_lshlrev_b32 v11, 3, v64
  v_lshlrev_b32 v73, 2, v65
  v_add_u32 v73, 159808, v73
  v_mov_b32 v66, 0
  ds_write_b32 v73, v66
  s_lshl_b32 m0, s3, 8
  s_nop 0
  ds_write_addtid_b32 v66 offset:24576
  v_mov_b64 v[14:15], 0
  v_mov_b64 v[20:21], 0
  v_sub_u32 v73, v70, v72
  v_mul_i32_i24 v73, 15, v73
  v_lshlrev_b32 v66, 2, v67
  v_sub_u32 v74, v65, v66
  v_add3_u32 v73, v73, v74, 19
  s_mul_i32 s5, s3, 2050
  s_add_u32 s5, s5, 151552
  v_lshl_add_u32 v64, v73, 3, s5
  v_mov_b64 v[24:25], 0
  v_mov_b64 v[26:27], 0
  v_mov_b64 v[28:29], 0
  v_mov_b64 v[30:31], 0
  v_mov_b64 v[32:33], 0
  v_mov_b64 v[34:35], 0
  v_mov_b64 v[36:37], 0
  v_mov_b64 v[38:39], 0
  v_mov_b64 v[40:41], 0
  v_mov_b64 v[42:43], 0
  v_mov_b64 v[44:45], 0
  v_mov_b64 v[46:47], 0
  v_mov_b64 v[48:49], 0
  v_mov_b64 v[50:51], 0
  v_xor_b32 v73, v66, v65
  s_cmp_eq_u32 s47, 63
  s_cselect_b32 s5, 4, 0
  v_and_b32 v73, s5, v73
  v_cmp_eq_u32 vcc, 0, v73
  s_cmp_eq_u32 s48, 63
  s_cselect_b32 s5, 0xc31044fe, 0
  v_mov_b32 v93, s5
  v_mov_b32 v70, 0xc31044fe
  v_cndmask_b32 v93, 0, v93, vcc
  v_cndmask_b32 v70, v70, 0, vcc
  s_add_u32 s5, s44, 0
  s_add_u32 m0, s46, 28672
  s_nop 0
  buffer_load_dwordx4 v58, s[12:15], s5 offen offset:0 lds
  s_add_u32 m0, s46, 36736
  s_nop 0
  buffer_load_dwordx4 v58, s[12:15], s5 offen offset:128 lds
  s_add_u32 m0, s46, 44800
  s_nop 0
  buffer_load_dwordx4 v58, s[12:15], s5 offen offset:256 lds
  s_add_u32 s5, s44, 36864
  s_add_u32 m0, s46, 32768
  s_nop 0
  buffer_load_dwordx4 v58, s[12:15], s5 offen offset:0 lds
  s_add_u32 m0, s46, 40832
  s_nop 0
  buffer_load_dwordx4 v58, s[12:15], s5 offen offset:128 lds
  s_add_u32 m0, s46, 48896
  s_nop 0
  buffer_load_dwordx4 v58, s[12:15], s5 offen offset:256 lds
  s_waitcnt vmcnt(12)
  ds_read_u16_d16_hi v24, v64 offset:24
  ds_read_u16_d16_hi v25, v64 offset:16
  ds_read_u16_d16_hi v26, v64 offset:8
  ds_read_u16_d16_hi v27, v64 offset:0
  ds_read_u16_d16_hi v28, v64 offset:264
  ds_read_u16_d16_hi v29, v64 offset:256
  ds_read_u16_d16_hi v30, v64 offset:248
  ds_read_u16_d16_hi v31, v64 offset:240
  ds_read_u16_d16_hi v32, v64 offset:504
  ds_read_u16_d16_hi v33, v64 offset:496
  ds_read_u16_d16_hi v34, v64 offset:488
  ds_read_u16_d16_hi v35, v64 offset:480
  ds_read_u16_d16_hi v36, v64 offset:744
  ds_read_u16_d16_hi v37, v64 offset:736
  ds_read_u16_d16_hi v38, v64 offset:728
  ds_read_u16_d16_hi v39, v64 offset:720
  ds_read_u16_d16_hi v40, v64 offset:984
  ds_read_u16_d16_hi v41, v64 offset:976
  ds_read_u16_d16_hi v42, v64 offset:968
  ds_read_u16_d16_hi v43, v64 offset:960
  ds_read_u16_d16_hi v44, v64 offset:1224
  ds_read_u16_d16_hi v45, v64 offset:1216
  ds_read_u16_d16_hi v46, v64 offset:1208
  ds_read_u16_d16_hi v47, v64 offset:1200
  ds_read_u16_d16_hi v48, v64 offset:1464
  ds_read_u16_d16_hi v49, v64 offset:1456
  ds_read_u16_d16_hi v50, v64 offset:1448
  ds_read_u16_d16_hi v51, v64 offset:1440
  s_mov_b32 s5, 0x3fb8aa3b
  v_add_f32 v93, v70, v93
  s_waitcnt lgkmcnt(15)
  v_mul_f32 v24, s5, v24
  v_mul_f32 v25, s5, v25
  v_mul_f32 v26, s5, v26
  v_mul_f32 v27, s5, v27
  v_mul_f32 v28, s5, v28
  v_mul_f32 v29, s5, v29
  v_mul_f32 v30, s5, v30
  v_mul_f32 v31, s5, v31
  v_mul_f32 v32, s5, v32
  v_mul_f32 v33, s5, v33
  v_mul_f32 v34, s5, v34
  v_mul_f32 v35, s5, v35
  v_mul_f32 v36, s5, v36
  s_waitcnt lgkmcnt(14)
  v_mul_f32 v37, s5, v37
  s_waitcnt lgkmcnt(13)
  v_mul_f32 v38, s5, v38
  s_waitcnt lgkmcnt(12)
  v_mul_f32 v39, s5, v39
  s_waitcnt lgkmcnt(11)
  v_mul_f32 v40, s5, v40
  s_waitcnt lgkmcnt(10)
  v_mul_f32 v41, s5, v41
  s_waitcnt lgkmcnt(9)
  v_mul_f32 v42, s5, v42
  s_waitcnt lgkmcnt(8)
  v_mul_f32 v43, s5, v43
  s_waitcnt lgkmcnt(7)
  v_mul_f32 v44, s5, v44
  s_waitcnt lgkmcnt(6)
  v_mul_f32 v45, s5, v45
  s_waitcnt lgkmcnt(5)
  v_mul_f32 v46, s5, v46
  s_waitcnt lgkmcnt(4)
  v_mul_f32 v47, s5, v47
  s_waitcnt lgkmcnt(3)
  v_mul_f32 v48, s5, v48
  s_waitcnt lgkmcnt(2)
  v_mul_f32 v49, s5, v49
  s_waitcnt lgkmcnt(1)
  v_mul_f32 v50, s5, v50
  s_waitcnt lgkmcnt(0)
  v_mul_f32 v51, s5, v51
  v_add_f32 v72, v93, v48
  v_add_f32 v73, v93, v49
  v_add_f32 v74, v93, v50
  v_add_f32 v75, v93, v51
  v_add_f32 v64, v93, v44
  v_add_f32 v65, v93, v45
  v_add_f32 v66, v93, v46
  v_add_f32 v67, v93, v47
  v_add_f32 v76, v93, v40
  v_add_f32 v77, v93, v41
  v_add_f32 v78, v93, v42
  v_add_f32 v79, v93, v43
  v_add_f32 v84, v93, v32
  v_add_f32 v85, v93, v33
  v_add_f32 v86, v93, v34
  v_add_f32 v87, v93, v35
  v_add_f32 v80, v93, v28
  v_add_f32 v81, v93, v29
  v_add_f32 v82, v93, v30
  v_add_f32 v83, v93, v31
  v_add_f32 v88, v93, v24
  v_add_f32 v89, v93, v25
  v_add_f32 v90, v93, v26
  v_add_f32 v91, v93, v27
  s_add_u32 s5, s44, 73728
  s_add_u32 m0, s46, 53248
  s_nop 0
  buffer_load_dwordx4 v58, s[12:15], s5 offen offset:0 lds
  s_add_u32 m0, s46, 61312
  s_nop 0
  buffer_load_dwordx4 v58, s[12:15], s5 offen offset:128 lds
  s_add_u32 m0, s46, 69376
  s_nop 0
  buffer_load_dwordx4 v58, s[12:15], s5 offen offset:256 lds
  s_add_u32 s5, s44, 110592
  s_add_u32 m0, s46, 57344
  s_nop 0
  buffer_load_dwordx4 v58, s[12:15], s5 offen offset:0 lds
  s_add_u32 m0, s46, 65408
  s_nop 0
  buffer_load_dwordx4 v58, s[12:15], s5 offen offset:128 lds
  s_add_u32 m0, s46, 73472
  s_nop 0
  buffer_load_dwordx4 v58, s[12:15], s5 offen offset:256 lds
  s_cmp_ge_u32 s50, s14
  s_cselect_b64 s[52:53], s[16:17], s[12:13]
  s_cselect_b64 s[54:55], s[18:19], s[14:15]
  s_cselect_b32 s5, s14, 0
  s_sub_u32 s50, s50, s5
  buffer_load_dword v96, v92, s[52:55], s50 offen
  s_mov_b64 exec, 0
  s_cmp_eq_u32 s3, 0
  s_cbranch_scc1 L_hop_0_0
  s_cmp_eq_u32 s3, 1
  s_cbranch_scc1 L_hop_1_0
  s_cmp_eq_u32 s3, 2
  s_cbranch_scc1 L_hop_2_0
  s_branch L_hop_3_0
  s_nop 0
  s_nop 0
  s_nop 0
  s_nop 0
  s_nop 0
  s_nop 0
  s_nop 0
  s_nop 0
  s_nop 0
  s_nop 0
  s_nop 0
  s_nop 0
  s_nop 0
  s_nop 0
  s_nop 0
  s_nop 0
  s_nop 0
  s_nop 0
  s_nop 0
  s_nop 0
  s_nop 0
  s_nop 0
  s_nop 0
  s_nop 0
  s_nop 0
  s_nop 0
  s_nop 0
  s_nop 0
  s_nop 0
  s_nop 0
  s_nop 0
  s_nop 0
  s_nop 0
  s_nop 0
  s_nop 0
  s_nop 0
  s_nop 0
  s_nop 0
  s_nop 0
  s_nop 0
  s_nop 0
  s_nop 0
  s_nop 0
  s_nop 0
  s_nop 0
  s_nop 0
  s_nop 0
  s_nop 0
  s_nop 0
  s_nop 0
  s_nop 0
  s_nop 0
  s_nop 0
  s_nop 0
  s_nop 0
  s_nop 0
  s_nop 0
  s_nop 0
  s_nop 0
  s_nop 0
  s_nop 0
  s_nop 0
  s_nop 0
  s_nop 0
  s_nop 0
  s_nop 0
  s_nop 0
  s_nop 0
  s_nop 0
  s_nop 0
  s_nop 0
  s_nop 0
  s_nop 0
  s_nop 0
  s_nop 0
  s_nop 0
  s_nop 0
  s_nop 0
  s_nop 0
  s_nop 0
  s_nop 0
  s_nop 0
  s_nop 0
  s_nop 0
  s_nop 0
  s_nop 0
  s_nop 0
  s_nop 0
  s_nop 0
  s_nop 0
  s_nop 0
  s_nop 0
  s_nop 0
  s_nop 0
  s_nop 0
  s_nop 0
  s_nop 0
  s_nop 0
  s_nop 0
  s_nop 0
  s_nop 0
  s_nop 0
  s_nop 0
  s_nop 0
  s_nop 0
  s_nop 0
  s_nop 0
  s_nop 0
  s_nop 0
  s_nop 0
  s_nop 0
  s_nop 0
  s_nop 0
  s_nop 0
  s_nop 0
  s_nop 0
  s_nop 0
  s_nop 0
  s_nop 0
  s_nop 0
  s_nop 0
  s_nop 0
  s_nop 0
  s_nop 0
  s_nop 0
  s_nop 0
  s_nop 0
  s_nop 0
  s_nop 0
  s_nop 0
  s_nop 0
  s_nop 0
  s_nop 0
  s_nop 0
  s_nop 0
  s_nop 0
  s_nop 0
  s_nop 0
  s_nop 0
  s_nop 0
  s_nop 0
  s_nop 0
  s_nop 0
  s_nop 0
  s_nop 0
  s_nop 0
  s_nop 0
  s_nop 0
  s_nop 0
  s_nop 0
  s_nop 0
  s_nop 0
  s_nop 0
  s_nop 0
  s_nop 0
  s_nop 0
  s_nop 0
  s_nop 0
  s_nop 0
  s_nop 0
  s_nop 0
  s_nop 0
  s_nop 0
  s_nop 0
  s_nop 0
  s_nop 0
  s_nop 0
  s_nop 0
  s_nop 0
  s_nop 0
  s_nop 0
  s_nop 0
  s_nop 0
  s_nop 0
  s_nop 0
  s_nop 0
  s_nop 0
  s_nop 0
  s_nop 0
  s_nop 0
  s_nop 0
  s_nop 0
  s_nop 0
  s_nop 0
  s_nop 0
  s_nop 0
  s_nop 0
  s_nop 0
  s_nop 0
  s_nop 0
  s_nop 0
  s_nop 0
  s_nop 0
  s_nop 0
  s_nop 0
  s_nop 0
  s_nop 0
  s_nop 0
  s_nop 0
  s_nop 0
  s_nop 0
  s_nop 0
  s_nop 0
  s_nop 0
  s_nop 0
  s_nop 0
  s_nop 0
  s_nop 0
  s_nop 0
  s_nop 0
  s_nop 0
  s_nop 0
  s_nop 0
  s_nop 0
  s_nop 0
  s_nop 0
  s_nop 0
  s_nop 0
  s_nop 0
  s_nop 0
  s_nop 0
  s_nop 0
  s_nop 0
  s_nop 0
  s_nop 0
  s_nop 0
  s_nop 0
  s_nop 0
  s_nop 0
  s_nop 0
  s_nop 0
  s_nop 0
  s_nop 0
  s_nop 0
  s_nop 0
  s_nop 0
  s_nop 0
  s_nop 0
  s_nop 0
  s_nop 0
  s_nop 0
  s_nop 0
  s_nop 0
  s_nop 0
  s_nop 0
  s_nop 0
  s_nop 0
  s_nop 0
  s_nop 0
  s_nop 0
  s_nop 0
  s_nop 0
  s_nop 0
  s_nop 0
  s_nop 0
  s_nop 0
  s_nop 0
  s_nop 0
  s_nop 0
  s_nop 0
  s_nop 0
  s_nop 0
  s_nop 0
  s_nop 0
  s_nop 0
  s_nop 0
  s_nop 0
  s_nop 0
  s_nop 0
  s_nop 0
  s_nop 0
  s_nop 0
  s_nop 0
  s_nop 0
  s_nop 0
  s_nop 0
  s_nop 0
  s_nop 0
  s_nop 0
  s_nop 0
  s_nop 0
  s_nop 0
  s_nop 0
  s_nop 0
  s_nop 0
  s_nop 0
  s_nop 0
  s_nop 0
  s_nop 0
  s_nop 0
  s_nop 0
  s_nop 0
  s_nop 0
  s_nop 0
  s_nop 0
  s_nop 0
  s_nop 0
  s_nop 0
  s_nop 0
  s_nop 0
  s_nop 0
  s_nop 0
  s_nop 0
  s_nop 0
  s_nop 0
  s_nop 0
  s_nop 0
  s_nop 0
  s_nop 0
  s_nop 0
  s_nop 0
  s_nop 0
  s_nop 0
  s_nop 0
  s_nop 0
  s_nop 0
  s_nop 0
  s_nop 0
  s_nop 0
  s_nop 0
  s_nop 0
  s_nop 0
  s_nop 0
  s_nop 0
  s_nop 0
  s_nop 0
  s_nop 0
  s_nop 0
  s_nop 0
  s_nop 0
  s_nop 0
  s_nop 0
  s_nop 0
  s_nop 0
  s_nop 0
  s_nop 0
  s_nop 0
  s_nop 0
  s_nop 0
  s_nop 0
  s_nop 0
  s_nop 0
  s_nop 0
  s_nop 0
  s_nop 0
  s_nop 0
  s_nop 0
  s_nop 0
  s_nop 0
  s_nop 0
  s_nop 0
  s_nop 0
  s_nop 0
  s_nop 0
  s_nop 0
  s_nop 0
  s_nop 0
  s_nop 0
  s_nop 0
  s_nop 0
  s_nop 0
  s_nop 0
  s_nop 0
  s_nop 0
  s_nop 0
  s_nop 0
  s_nop 0
  s_nop 0
  s_nop 0
  s_nop 0
  s_nop 0
  s_nop 0
  s_nop 0
  s_nop 0
  s_nop 0
  s_nop 0
  s_nop 0
  s_nop 0
  s_nop 0
  s_nop 0
  s_nop 0
  s_nop 0
  s_nop 0
  s_nop 0
  s_nop 0
  s_nop 0
  s_nop 0
  s_nop 0
  s_nop 0
  s_nop 0
  s_nop 0
  s_nop 0
  s_nop 0
  s_nop 0
  s_nop 0
  s_nop 0
  s_nop 0
  s_nop 0
  s_nop 0
  s_nop 0
  s_nop 0
  s_nop 0
  s_nop 0
  s_nop 0
  s_nop 0
  s_nop 0
  s_nop 0
  s_nop 0
  s_nop 0
  s_nop 0
  s_nop 0
  s_nop 0
  s_nop 0
  s_nop 0
  s_nop 0
  s_nop 0
  s_nop 0
  s_nop 0
  s_nop 0
  s_nop 0
  s_nop 0
  s_nop 0
L_walk:
  s_mov_b64 exec, -1
L_walked:
  s_waitcnt vmcnt(13)
  s_barrier
  ds_read_b128 v[184:187], v0 offset:0
  ds_read_b128 v[188:191], v1 offset:0
  ds_read_b128 v[208:211], v0 offset:2048
  ds_read_b128 v[212:215], v1 offset:2048
  ds_read_b128 v[232:235], v0 offset:4096
  ds_read_b128 v[236:239], v1 offset:4096
  ds_read_b128 a[216:219], v0 offset:6144
  ds_read_b128 a[220:223], v1 offset:6144
  s_add_u32 s5, s44, 147456
  s_add_u32 m0, s46, 77824
  s_nop 0
  buffer_load_dwordx4 v58, s[12:15], s5 offen offset:0 lds
  s_add_u32 m0, s46, 85888
  s_nop 0
  buffer_load_dwordx4 v58, s[12:15], s5 offen offset:128 lds
  s_add_u32 m0, s46, 93952
  s_nop 0
  buffer_load_dwordx4 v58, s[12:15], s5 offen offset:256 lds
  s_waitcnt vmcnt(10)
  s_barrier
  ds_read_b64_tr_b16 a[0:1], v61 offset:0
  ds_read_b64_tr_b16 a[2:3], v61 offset:512
  ds_read_b64_tr_b16 a[12:13], v61 offset:4096
  ds_read_b64_tr_b16 a[14:15], v61 offset:4608
  s_waitcnt lgkmcnt(2)
  v_mfma_f32_16x16x32_bf16 v[116:119], a[0:3], v[184:187], 0
  s_add_u32 s5, s44, 184320
  s_add_u32 m0, s46, 81920
  ds_read_b64_tr_b16 a[4:5], v62 offset:0
  s_waitcnt lgkmcnt(1)
  v_mfma_f32_16x16x32_bf16 v[116:119], a[12:15], v[188:191], v[116:119]
  buffer_load_dwordx4 v58, s[12:15], s5 offen offset:0 lds
  v_mfma_f32_16x16x32_bf16 v[128:131], a[0:3], v[208:211], 0
  s_add_u32 m0, s46, 89984
  ds_read_b64_tr_b16 a[6:7], v62 offset:512
  ds_read_b64_tr_b16 a[16:17], v62 offset:4096
  v_mfma_f32_16x16x32_bf16 v[128:131], a[12:15], v[212:215], v[128:131]
  buffer_load_dwordx4 v58, s[12:15], s5 offen offset:128 lds
  v_mfma_f32_16x16x32_bf16 v[120:123], a[0:3], v[232:235], 0
  s_add_u32 m0, s46, 98048
  ds_read_b64_tr_b16 a[18:19], v62 offset:4608
  ds_read_b64_tr_b16 a[8:9], v63 offset:0
  v_mfma_f32_16x16x32_bf16 v[120:123], a[12:15], v[236:239], v[120:123]
  buffer_load_dwordx4 v58, s[12:15], s5 offen offset:256 lds
  v_mfma_f32_16x16x32_bf16 v[92:95], a[0:3], a[216:219], 0
  s_add_u32 s5, s44, 384
  s_add_u32 m0, s46, 102400
  ds_read_b64_tr_b16 a[10:11], v63 offset:512
  v_mfma_f32_16x16x32_bf16 v[92:95], a[12:15], a[220:223], v[92:95]
  s_waitcnt lgkmcnt(3)
  ds_read_b64_tr_b16 a[20:21], v63 offset:4096
  ds_read_b64_tr_b16 a[22:23], v63 offset:4608
  v_mfma_f32_16x16x32_bf16 v[136:139], a[4:7], v[184:187], 0
  buffer_load_dwordx4 v58, s[12:15], s5 offen offset:0 lds
  s_waitcnt lgkmcnt(4)
  v_mfma_f32_16x16x32_bf16 v[136:139], a[16:19], v[188:191], v[136:139]
  s_add_u32 m0, s46, 110464
  ds_read_b128 v[192:195], v0 offset:8192
  ds_read_b128 v[196:199], v1 offset:8192
  v_mfma_f32_16x16x32_bf16 v[132:135], a[4:7], v[208:211], 0
  buffer_load_dwordx4 v58, s[12:15], s5 offen offset:128 lds
  v_mfma_f32_16x16x32_bf16 v[132:135], a[16:19], v[212:215], v[132:135]
  s_add_u32 m0, s46, 118528
  ds_read_b128 v[216:219], v0 offset:10240
  ds_read_b128 v[220:223], v1 offset:10240
  v_mfma_f32_16x16x32_bf16 v[148:151], a[4:7], v[232:235], 0
  buffer_load_dwordx4 v58, s[12:15], s5 offen offset:256 lds
  v_mfma_f32_16x16x32_bf16 v[148:151], a[16:19], v[236:239], v[148:151]
  s_add_u32 s5, s44, 37248
  s_add_u32 m0, s46, 106496
  ds_read_b128 v[240:243], v0 offset:12288
  v_mfma_f32_16x16x32_bf16 v[108:111], a[4:7], a[216:219], 0
  s_waitcnt lgkmcnt(3)
  ds_read_b128 v[244:247], v1 offset:12288
  ds_read_b128 a[224:227], v0 offset:14336
  v_mfma_f32_16x16x32_bf16 v[108:111], a[16:19], a[220:223], v[108:111]
  s_waitcnt vmcnt(10)
  s_barrier
  v_mfma_f32_16x16x32_bf16 v[140:143], a[8:11], v[184:187], 0
  buffer_load_dwordx4 v58, s[12:15], s5 offen offset:0 lds
  v_mfma_f32_16x16x32_bf16 v[140:143], a[20:23], v[188:191], v[140:143]
  s_add_u32 m0, s46, 114560
  ds_read_b64_tr_b16 a[24:25], v61 offset:24576
  ds_read_b64_tr_b16 a[26:27], v61 offset:25088
  v_mfma_f32_16x16x32_bf16 v[124:127], a[8:11], v[208:211], 0
  buffer_load_dwordx4 v58, s[12:15], s5 offen offset:128 lds
  v_mfma_f32_16x16x32_bf16 v[124:127], a[20:23], v[212:215], v[124:127]
  s_add_u32 m0, s46, 122624
  ds_read_b64_tr_b16 a[36:37], v61 offset:28672
  ds_read_b64_tr_b16 a[38:39], v61 offset:29184
  v_mfma_f32_16x16x32_bf16 v[100:103], a[8:11], v[232:235], 0
  buffer_load_dwordx4 v58, s[12:15], s5 offen offset:256 lds
  v_mfma_f32_16x16x32_bf16 v[100:103], a[20:23], v[236:239], v[100:103]
  ds_read_b128 a[228:231], v1 offset:14336
  ds_read_b64_tr_b16 a[28:29], v62 offset:24576
  v_mfma_f32_16x16x32_bf16 v[112:115], a[8:11], a[216:219], 0
  ds_read_b64_tr_b16 a[30:31], v62 offset:25088
  ds_read_b64_tr_b16 a[40:41], v62 offset:28672
  v_mfma_f32_16x16x32_bf16 v[112:115], a[20:23], a[220:223], v[112:115]
  s_waitcnt lgkmcnt(6)
  ds_read_b64_tr_b16 a[42:43], v62 offset:29184
  ds_read_b64_tr_b16 a[32:33], v63 offset:24576
  v_mfma_f32_16x16x32_bf16 v[116:119], a[24:27], v[192:195], v[116:119]
  s_waitcnt lgkmcnt(6)
  ds_read_b64_tr_b16 a[34:35], v63 offset:25088
  ds_read_b64_tr_b16 a[44:45], v63 offset:28672
  v_mfma_f32_16x16x32_bf16 v[116:119], a[36:39], v[196:199], v[116:119]
  ds_read_b64_tr_b16 a[46:47], v63 offset:29184
  ds_read_b128 v[200:203], v0 offset:16384
  v_mfma_f32_16x16x32_bf16 v[128:131], a[24:27], v[216:219], v[128:131]
  ds_read_b128 v[204:207], v1 offset:16384
  ds_read_b128 v[224:227], v0 offset:18432
  v_mfma_f32_16x16x32_bf16 v[128:131], a[36:39], v[220:223], v[128:131]
  ds_read_b128 v[228:231], v1 offset:18432
  ds_read_b128 v[248:251], v0 offset:20480
  v_mfma_f32_16x16x32_bf16 v[120:123], a[24:27], v[240:243], v[120:123]
  ds_read_b128 v[252:255], v1 offset:20480
  ds_read_b128 a[232:235], v0 offset:22528
  v_mfma_f32_16x16x32_bf16 v[120:123], a[36:39], v[244:247], v[120:123]
  s_add_u32 s5, s44, 74112
  s_add_u32 m0, s46, 126976
  ds_read_b128 a[236:239], v1 offset:22528
  v_mfma_f32_16x16x32_bf16 v[92:95], a[24:27], a[224:227], v[92:95]
  s_waitcnt lgkmcnt(7)
  v_mfma_f32_16x16x32_bf16 v[92:95], a[36:39], a[228:231], v[92:95]
  v_mfma_f32_16x16x32_bf16 v[136:139], a[28:31], v[192:195], v[136:139]
  buffer_load_dwordx4 v58, s[12:15], s5 offen offset:0 lds
  v_mfma_f32_16x16x32_bf16 v[136:139], a[40:43], v[196:199], v[136:139]
  s_add_u32 m0, s46, 135040
  v_mfma_f32_16x16x32_bf16 v[132:135], a[28:31], v[216:219], v[132:135]
  buffer_load_dwordx4 v58, s[12:15], s5 offen offset:128 lds
  v_mfma_f32_16x16x32_bf16 v[132:135], a[40:43], v[220:223], v[132:135]
  s_add_u32 m0, s46, 143104
  v_mfma_f32_16x16x32_bf16 v[148:151], a[28:31], v[240:243], v[148:151]
  buffer_load_dwordx4 v58, s[12:15], s5 offen offset:256 lds
  v_mfma_f32_16x16x32_bf16 v[148:151], a[40:43], v[244:247], v[148:151]
  s_add_u32 s5, s44, 110976
  s_add_u32 m0, s46, 131072
  v_mfma_f32_16x16x32_bf16 v[108:111], a[28:31], a[224:227], v[108:111]
  v_mfma_f32_16x16x32_bf16 v[108:111], a[40:43], a[228:231], v[108:111]
  s_waitcnt vmcnt(9)
  s_barrier
  v_mfma_f32_16x16x32_bf16 v[140:143], a[32:35], v[192:195], v[140:143]
  buffer_load_dwordx4 v58, s[12:15], s5 offen offset:0 lds
  v_mfma_f32_16x16x32_bf16 v[140:143], a[44:47], v[196:199], v[140:143]
  s_add_u32 m0, s46, 139136
  ds_read_b64_tr_b16 a[48:49], v61 offset:49152
  ds_read_b64_tr_b16 a[50:51], v61 offset:49664
  v_mfma_f32_16x16x32_bf16 v[124:127], a[32:35], v[216:219], v[124:127]
  buffer_load_dwordx4 v58, s[12:15], s5 offen offset:128 lds
  v_mfma_f32_16x16x32_bf16 v[124:127], a[44:47], v[220:223], v[124:127]
  s_add_u32 m0, s46, 147200
  ds_read_b64_tr_b16 a[60:61], v61 offset:53248
  ds_read_b64_tr_b16 a[62:63], v61 offset:53760
  v_mfma_f32_16x16x32_bf16 v[100:103], a[32:35], v[240:243], v[100:103]
  buffer_load_dwordx4 v58, s[12:15], s5 offen offset:256 lds
  v_mfma_f32_16x16x32_bf16 v[100:103], a[44:47], v[244:247], v[100:103]
  ds_read_b64_tr_b16 a[52:53], v62 offset:49152
  ds_read_b64_tr_b16 a[54:55], v62 offset:49664
  v_mfma_f32_16x16x32_bf16 v[112:115], a[32:35], a[224:227], v[112:115]
  ds_read_b64_tr_b16 a[64:65], v62 offset:53248
  ds_read_b64_tr_b16 a[66:67], v62 offset:53760
  v_mfma_f32_16x16x32_bf16 v[112:115], a[44:47], a[228:231], v[112:115]
  s_waitcnt lgkmcnt(6)
  ds_read_b64_tr_b16 a[56:57], v63 offset:49152
  ds_read_b64_tr_b16 a[58:59], v63 offset:49664
  v_mfma_f32_16x16x32_bf16 v[116:119], a[48:51], v[200:203], v[116:119]
  s_waitcnt lgkmcnt(6)
  ds_read_b64_tr_b16 a[68:69], v63 offset:53248
  ds_read_b64_tr_b16 a[70:71], v63 offset:53760
  v_mfma_f32_16x16x32_bf16 v[116:119], a[60:63], v[204:207], v[116:119]
  v_mfma_f32_16x16x32_bf16 v[128:131], a[48:51], v[224:227], v[128:131]
  v_mfma_f32_16x16x32_bf16 v[128:131], a[60:63], v[228:231], v[128:131]
  v_mfma_f32_16x16x32_bf16 v[120:123], a[48:51], v[248:251], v[120:123]
  v_mul_f32 v116, s42, v116
  v_mul_f32 v117, s42, v117
  v_mfma_f32_16x16x32_bf16 v[120:123], a[60:63], v[252:255], v[120:123]
  s_add_u32 s5, s44, 147840
  s_add_u32 m0, s46, 28672
  v_mul_f32 v118, s42, v118
  v_mfma_f32_16x16x32_bf16 v[92:95], a[48:51], a[232:235], v[92:95]
  v_mul_f32 v119, s42, v119
  v_cvt_pk_bf16_f32 v12, v116, v117
  v_mfma_f32_16x16x32_bf16 v[92:95], a[60:63], a[236:239], v[92:95]
  s_waitcnt lgkmcnt(0)
  v_cvt_pk_bf16_f32 v13, v118, v119
  v_mul_f32 v128, s42, v128
  v_mfma_f32_16x16x32_bf16 v[136:139], a[52:55], v[200:203], v[136:139]
  buffer_load_dwordx4 v58, s[12:15], s5 offen offset:0 lds
  v_mfma_f32_16x16x32_bf16 v[136:139], a[64:67], v[204:207], v[136:139]
  s_add_u32 m0, s46, 36736
  v_mul_f32 v129, s42, v129
  v_mul_f32 v130, s42, v130
  v_mfma_f32_16x16x32_bf16 v[132:135], a[52:55], v[224:227], v[132:135]
  buffer_load_dwordx4 v58, s[12:15], s5 offen offset:128 lds
  v_mfma_f32_16x16x32_bf16 v[132:135], a[64:67], v[228:231], v[132:135]
  s_add_u32 m0, s46, 44800
  v_mul_f32 v131, s42, v131
  v_cvt_pk_bf16_f32 v180, v128, v129
  v_mfma_f32_16x16x32_bf16 v[148:151], a[52:55], v[248:251], v[148:151]
  buffer_load_dwordx4 v58, s[12:15], s5 offen offset:256 lds
  v_mfma_f32_16x16x32_bf16 v[148:151], a[64:67], v[252:255], v[148:151]
  s_add_u32 s5, s44, 184704
  s_add_u32 m0, s46, 32768
  v_mul_f32 v136, s42, v136
  v_mfma_f32_16x16x32_bf16 v[108:111], a[52:55], a[232:235], v[108:111]
  v_mul_f32 v137, s42, v137
  v_mul_f32 v138, s42, v138
  v_mfma_f32_16x16x32_bf16 v[108:111], a[64:67], a[236:239], v[108:111]
  s_waitcnt vmcnt(9)
  s_barrier
  v_mfma_f32_16x16x32_bf16 v[140:143], a[56:59], v[200:203], v[140:143]
  buffer_load_dwordx4 v58, s[12:15], s5 offen offset:0 lds
  v_mfma_f32_16x16x32_bf16 v[140:143], a[68:71], v[204:207], v[140:143]
  s_add_u32 m0, s46, 40832
  ds_read_b64_tr_b16 a[72:73], v57 offset:0
  ds_read_b64_tr_b16 a[74:75], v57 offset:512
  v_mfma_f32_16x16x32_bf16 v[124:127], a[56:59], v[224:227], v[124:127]
  buffer_load_dwordx4 v58, s[12:15], s5 offen offset:128 lds
  v_mfma_f32_16x16x32_bf16 v[124:127], a[68:71], v[228:231], v[124:127]
  s_add_u32 m0, s46, 48896
  ds_read_b64_tr_b16 a[84:85], v57 offset:4096
  ds_read_b64_tr_b16 a[86:87], v57 offset:4608
  v_mfma_f32_16x16x32_bf16 v[100:103], a[56:59], v[248:251], v[100:103]
  buffer_load_dwordx4 v58, s[12:15], s5 offen offset:256 lds
  v_mfma_f32_16x16x32_bf16 v[100:103], a[68:71], v[252:255], v[100:103]
  ds_read_b64_tr_b16 a[76:77], v60 offset:0
  ds_read_b64_tr_b16 a[78:79], v60 offset:512
  v_mfma_f32_16x16x32_bf16 v[112:115], a[56:59], a[232:235], v[112:115]
  ds_read_b64_tr_b16 a[88:89], v60 offset:4096
  ds_read_b64_tr_b16 a[90:91], v60 offset:4608
  v_mfma_f32_16x16x32_bf16 v[112:115], a[68:71], a[236:239], v[112:115]
  s_waitcnt lgkmcnt(6)
  ds_read_b64_tr_b16 a[80:81], v59 offset:0
  ds_read_b64_tr_b16 a[82:83], v59 offset:512
  v_mfma_f32_16x16x32_bf16 v[116:119], a[72:75], v[184:187], 0
  s_waitcnt lgkmcnt(6)
  ds_read_b64_tr_b16 a[92:93], v59 offset:4096
  ds_read_b64_tr_b16 a[94:95], v59 offset:4608
  v_mfma_f32_16x16x32_bf16 v[116:119], a[84:87], v[188:191], v[116:119]
  v_mul_f32 v139, s42, v139
  v_cvt_pk_bf16_f32 v144, v136, v137
  v_mfma_f32_16x16x32_bf16 v[156:159], a[72:75], v[208:211], 0
  v_cvt_pk_bf16_f32 v145, v138, v139
  v_mul_f32 v140, s42, v140
  v_mfma_f32_16x16x32_bf16 v[156:159], a[84:87], v[212:215], v[156:159]
  v_mul_f32 v141, s42, v141
  v_mul_f32 v142, s42, v142
  v_mfma_f32_16x16x32_bf16 v[166:169], a[72:75], v[232:235], 0
  v_mul_f32 v143, s42, v143
  v_cvt_pk_bf16_f32 v146, v140, v141
  v_mfma_f32_16x16x32_bf16 v[166:169], a[84:87], v[236:239], v[166:169]
  s_add_u32 s5, s44, 768
  s_add_u32 m0, s46, 53248
  v_cvt_pk_bf16_f32 v147, v142, v143
  v_mfma_f32_16x16x32_bf16 v[172:175], a[72:75], a[216:219], 0
  v_cvt_pk_bf16_f32 v181, v130, v131
  v_mul_f32 v132, s42, v132
  v_mfma_f32_16x16x32_bf16 v[172:175], a[84:87], a[220:223], v[172:175]
  s_waitcnt lgkmcnt(0)
  v_mul_f32 v133, s42, v133
  v_mul_f32 v134, s42, v134
  v_mfma_f32_16x16x32_bf16 v[136:139], a[76:79], v[184:187], 0
  buffer_load_dwordx4 v58, s[12:15], s5 offen offset:0 lds
  v_mfma_f32_16x16x32_bf16 v[136:139], a[88:91], v[188:191], v[136:139]
  s_add_u32 m0, s46, 61312
  v_mul_f32 v135, s42, v135
  v_cvt_pk_bf16_f32 v182, v132, v133
  v_mfma_f32_16x16x32_bf16 v[140:143], a[76:79], v[208:211], 0
  buffer_load_dwordx4 v58, s[12:15], s5 offen offset:128 lds
  v_mfma_f32_16x16x32_bf16 v[140:143], a[88:91], v[212:215], v[140:143]
  s_add_u32 m0, s46, 69376
  v_cvt_pk_bf16_f32 v183, v134, v135
  v_mul_f32 v124, s42, v124
  v_mfma_f32_16x16x32_bf16 v[160:163], a[76:79], v[232:235], 0
  buffer_load_dwordx4 v58, s[12:15], s5 offen offset:256 lds
  v_mfma_f32_16x16x32_bf16 v[160:163], a[88:91], v[236:239], v[160:163]
  s_add_u32 s5, s44, 37632
  s_add_u32 m0, s46, 57344
  v_mul_f32 v125, s42, v125
  v_mfma_f32_16x16x32_bf16 v[96:99], a[76:79], a[216:219], 0
  v_mul_f32 v126, s42, v126
  v_mul_f32 v127, s42, v127
  v_mfma_f32_16x16x32_bf16 v[96:99], a[88:91], a[220:223], v[96:99]
  s_waitcnt vmcnt(9)
  s_barrier
  v_mfma_f32_16x16x32_bf16 v[152:155], a[80:83], v[184:187], 0
  buffer_load_dwordx4 v58, s[12:15], s5 offen offset:0 lds
  v_mfma_f32_16x16x32_bf16 v[152:155], a[92:95], v[188:191], v[152:155]
  s_add_u32 m0, s46, 65408
  ds_read_b64_tr_b16 a[96:97], v57 offset:24576
  ds_read_b64_tr_b16 a[98:99], v57 offset:25088
  v_mfma_f32_16x16x32_bf16 v[176:179], a[80:83], v[208:211], 0
  buffer_load_dwordx4 v58, s[12:15], s5 offen offset:128 lds
  v_mfma_f32_16x16x32_bf16 v[176:179], a[92:95], v[212:215], v[176:179]
  s_add_u32 m0, s46, 73472
  ds_read_b64_tr_b16 a[108:109], v57 offset:28672
  ds_read_b64_tr_b16 a[110:111], v57 offset:29184
  v_mfma_f32_16x16x32_bf16 v[128:131], a[80:83], v[232:235], 0
  buffer_load_dwordx4 v58, s[12:15], s5 offen offset:256 lds
  v_mfma_f32_16x16x32_bf16 v[128:131], a[92:95], v[236:239], v[128:131]
  ds_read_b64_tr_b16 a[100:101], v60 offset:24576
  ds_read_b64_tr_b16 a[102:103], v60 offset:25088
  v_mfma_f32_16x16x32_bf16 v[104:107], a[80:83], a[216:219], 0
  ds_read_b64_tr_b16 a[112:113], v60 offset:28672
  ds_read_b64_tr_b16 a[114:115], v60 offset:29184
  v_mfma_f32_16x16x32_bf16 v[104:107], a[92:95], a[220:223], v[104:107]
  s_waitcnt lgkmcnt(6)
  ds_read_b64_tr_b16 a[104:105], v59 offset:24576
  ds_read_b64_tr_b16 a[106:107], v59 offset:25088
  v_mfma_f32_16x16x32_bf16 v[116:119], a[96:99], v[192:195], v[116:119]
  s_waitcnt lgkmcnt(6)
  ds_read_b64_tr_b16 a[116:117], v59 offset:28672
  ds_read_b64_tr_b16 a[118:119], v59 offset:29184
  v_mfma_f32_16x16x32_bf16 v[116:119], a[108:111], v[196:199], v[116:119]
  v_cvt_pk_bf16_f32 v16, v124, v125
  v_cvt_pk_bf16_f32 v17, v126, v127
  v_mfma_f32_16x16x32_bf16 v[156:159], a[96:99], v[216:219], v[156:159]
  v_mul_f32 v120, s42, v120
  v_mul_f32 v121, s42, v121
  v_mfma_f32_16x16x32_bf16 v[156:159], a[108:111], v[220:223], v[156:159]
  v_mul_f32 v122, s42, v122
  v_mul_f32 v123, s42, v123
  v_mfma_f32_16x16x32_bf16 v[166:169], a[96:99], v[240:243], v[166:169]
  v_cvt_pk_bf16_f32 v18, v120, v121
  v_cvt_pk_bf16_f32 v19, v122, v123
  v_mfma_f32_16x16x32_bf16 v[166:169], a[108:111], v[244:247], v[166:169]
  s_add_u32 s5, s44, 74496
  s_add_u32 m0, s46, 77824
  v_mul_f32 v148, s42, v148
  v_mfma_f32_16x16x32_bf16 v[172:175], a[96:99], a[224:227], v[172:175]
  v_mul_f32 v149, s42, v149
  v_mul_f32 v150, s42, v150
  v_mfma_f32_16x16x32_bf16 v[172:175], a[108:111], a[228:231], v[172:175]
  s_waitcnt lgkmcnt(0)
  v_mul_f32 v151, s42, v151
  v_cvt_pk_bf16_f32 v124, v148, v149
  v_mfma_f32_16x16x32_bf16 v[136:139], a[100:103], v[192:195], v[136:139]
  buffer_load_dwordx4 v58, s[12:15], s5 offen offset:0 lds
  v_mfma_f32_16x16x32_bf16 v[136:139], a[112:115], v[196:199], v[136:139]
  s_add_u32 m0, s46, 85888
  v_cvt_pk_bf16_f32 v125, v150, v151
  v_mul_f32 v100, s42, v100
  v_mfma_f32_16x16x32_bf16 v[140:143], a[100:103], v[216:219], v[140:143]
  buffer_load_dwordx4 v58, s[12:15], s5 offen offset:128 lds
  v_mfma_f32_16x16x32_bf16 v[140:143], a[112:115], v[220:223], v[140:143]
  s_add_u32 m0, s46, 93952
  v_mul_f32 v101, s42, v101
  v_mul_f32 v102, s42, v102
  v_mfma_f32_16x16x32_bf16 v[160:163], a[100:103], v[240:243], v[160:163]
  buffer_load_dwordx4 v58, s[12:15], s5 offen offset:256 lds
  v_mfma_f32_16x16x32_bf16 v[160:163], a[112:115], v[244:247], v[160:163]
  s_add_u32 s5, s44, 111360
  s_add_u32 m0, s46, 81920
  v_mul_f32 v103, s42, v103
  v_mfma_f32_16x16x32_bf16 v[96:99], a[100:103], a[224:227], v[96:99]
  v_add_f32 v120, v70, v36
  v_add_f32 v121, v70, v37
  v_mfma_f32_16x16x32_bf16 v[96:99], a[112:115], a[228:231], v[96:99]
  s_waitcnt vmcnt(9)
  s_barrier
  v_mfma_f32_16x16x32_bf16 v[152:155], a[104:107], v[192:195], v[152:155]
  buffer_load_dwordx4 v58, s[12:15], s5 offen offset:0 lds
  v_mfma_f32_16x16x32_bf16 v[152:155], a[116:119], v[196:199], v[152:155]
  s_add_u32 m0, s46, 89984
  ds_read_b64_tr_b16 a[120:121], v61 offset:0
  ds_read_b64_tr_b16 a[122:123], v61 offset:512
  v_mfma_f32_16x16x32_bf16 v[176:179], a[104:107], v[216:219], v[176:179]
  buffer_load_dwordx4 v58, s[12:15], s5 offen offset:128 lds
  v_mfma_f32_16x16x32_bf16 v[176:179], a[116:119], v[220:223], v[176:179]
  s_add_u32 m0, s46, 98048
  ds_read_b64_tr_b16 a[132:133], v61 offset:4096
  ds_read_b64_tr_b16 a[134:135], v61 offset:4608
  v_mfma_f32_16x16x32_bf16 v[128:131], a[104:107], v[240:243], v[128:131]
  buffer_load_dwordx4 v58, s[12:15], s5 offen offset:256 lds
  v_mfma_f32_16x16x32_bf16 v[128:131], a[116:119], v[244:247], v[128:131]
  ds_read_b64_tr_b16 a[124:125], v62 offset:0
  ds_read_b64_tr_b16 a[126:127], v62 offset:512
  v_mfma_f32_16x16x32_bf16 v[104:107], a[104:107], a[224:227], v[104:107]
  ds_read_b64_tr_b16 a[136:137], v62 offset:4096
  ds_read_b64_tr_b16 a[138:139], v62 offset:4608
  v_mfma_f32_16x16x32_bf16 v[104:107], a[116:119], a[228:231], v[104:107]
  s_waitcnt lgkmcnt(6)
  ds_read_b64_tr_b16 a[128:129], v63 offset:0
  ds_read_b64_tr_b16 a[130:131], v63 offset:512
  v_mfma_f32_16x16x32_bf16 v[116:119], a[120:123], v[200:203], v[116:119]
  s_waitcnt lgkmcnt(6)
  ds_read_b64_tr_b16 a[140:141], v63 offset:4096
  ds_read_b64_tr_b16 a[142:143], v63 offset:4608
  v_mfma_f32_16x16x32_bf16 v[116:119], a[132:135], v[204:207], v[116:119]
  v_add_f32 v122, v70, v38
  v_add_f32 v123, v70, v39
  v_mfma_f32_16x16x32_bf16 v[156:159], a[120:123], v[224:227], v[156:159]
  v_add_f32 v148, v70, v32
  v_add_f32 v149, v70, v33
  v_mfma_f32_16x16x32_bf16 v[156:159], a[132:135], v[228:231], v[156:159]
  v_add_f32 v150, v70, v34
  v_add_f32 v151, v70, v35
  v_mfma_f32_16x16x32_bf16 v[166:169], a[120:123], v[248:251], v[166:169]
  v_cvt_pk_bf16_f32 v132, v116, v117
  v_cvt_pk_bf16_f32 v133, v118, v119
  v_mfma_f32_16x16x32_bf16 v[166:169], a[132:135], v[252:255], v[166:169]
  s_add_u32 s5, s44, 148224
  s_add_u32 m0, s46, 102400
  v_add_f32 v116, v70, v40
  v_mfma_f32_16x16x32_bf16 v[172:175], a[120:123], a[232:235], v[172:175]
  v_cvt_pk_bf16_f32 v170, v156, v157
  v_cvt_pk_bf16_f32 v171, v158, v159
  v_mfma_f32_16x16x32_bf16 v[172:175], a[132:135], a[236:239], v[172:175]
  s_waitcnt lgkmcnt(0)
  v_add_f32 v117, v70, v41
  v_add_f32 v118, v70, v42
  v_mfma_f32_16x16x32_bf16 v[136:139], a[124:127], v[200:203], v[136:139]
  buffer_load_dwordx4 v58, s[12:15], s5 offen offset:0 lds
  v_mfma_f32_16x16x32_bf16 v[136:139], a[136:139], v[204:207], v[136:139]
  s_add_u32 m0, s46, 110464
  v_cvt_pk_bf16_f32 v164, v166, v167
  v_cvt_pk_bf16_f32 v165, v168, v169
  v_mfma_f32_16x16x32_bf16 v[140:143], a[124:127], v[224:227], v[140:143]
  buffer_load_dwordx4 v58, s[12:15], s5 offen offset:128 lds
  v_mfma_f32_16x16x32_bf16 v[140:143], a[136:139], v[228:231], v[140:143]
  s_add_u32 m0, s46, 118528
  v_cvt_pk_bf16_f32 v158, v172, v173
  v_cvt_pk_bf16_f32 v159, v174, v175
  v_mfma_f32_16x16x32_bf16 v[160:163], a[124:127], v[248:251], v[160:163]
  buffer_load_dwordx4 v58, s[12:15], s5 offen offset:256 lds
  v_mfma_f32_16x16x32_bf16 v[160:163], a[136:139], v[252:255], v[160:163]
  s_add_u32 s5, s44, 185088
  s_add_u32 m0, s46, 106496
  v_cvt_pk_bf16_f32 v134, v136, v137
  v_mfma_f32_16x16x32_bf16 v[96:99], a[124:127], a[232:235], v[96:99]
  v_cvt_pk_bf16_f32 v135, v138, v139
  v_cvt_pk_bf16_f32 v172, v140, v141
  v_mfma_f32_16x16x32_bf16 v[96:99], a[136:139], a[236:239], v[96:99]
  v_cvt_pk_bf16_f32 v173, v142, v143
  v_add_f32 v119, v70, v43
  v_mfma_f32_16x16x32_bf16 v[152:155], a[128:131], v[200:203], v[152:155]
  buffer_load_dwordx4 v58, s[12:15], s5 offen offset:0 lds
  v_mfma_f32_16x16x32_bf16 v[152:155], a[140:143], v[204:207], v[152:155]
  s_add_u32 m0, s46, 114560
  v_cvt_pk_bf16_f32 v166, v160, v161
  v_cvt_pk_bf16_f32 v167, v162, v163
  v_mfma_f32_16x16x32_bf16 v[176:179], a[128:131], v[224:227], v[176:179]
  buffer_load_dwordx4 v58, s[12:15], s5 offen offset:128 lds
  v_mfma_f32_16x16x32_bf16 v[176:179], a[140:143], v[228:231], v[176:179]
L_hop_0_0:
  s_cbranch_execz L_hop_0_1
  s_add_u32 m0, s46, 122624
  v_cvt_pk_bf16_f32 v160, v96, v97
  v_cvt_pk_bf16_f32 v161, v98, v99
  v_mfma_f32_16x16x32_bf16 v[128:131], a[128:131], v[248:251], v[128:131]
  buffer_load_dwordx4 v58, s[12:15], s5 offen offset:256 lds
  v_mfma_f32_16x16x32_bf16 v[128:131], a[140:143], v[252:255], v[128:131]
  v_cvt_pk_bf16_f32 v136, v152, v153
  v_cvt_pk_bf16_f32 v137, v154, v155
  v_mfma_f32_16x16x32_bf16 v[104:107], a[128:131], a[232:235], v[104:107]
  v_cvt_pk_bf16_f32 v174, v176, v177
  v_cvt_pk_bf16_f32 v175, v178, v179
  v_mfma_f32_16x16x32_bf16 v[104:107], a[140:143], a[236:239], v[104:107]
  v_cvt_pk_bf16_f32 v126, v100, v101
  v_cvt_pk_bf16_f32 v127, v102, v103
  v_mfma_f32_16x16x32_bf16 v[96:99], v[134:137], v[144:147], v[120:123]
  v_cvt_pk_bf16_f32 v168, v128, v129
  v_cvt_pk_bf16_f32 v169, v130, v131
  v_mfma_f32_16x16x32_bf16 v[96:99], v[132:135], v[12:15], v[96:99]
  v_mul_f32 v92, s42, v92
  v_mul_f32 v93, s42, v93
  v_mfma_f32_16x16x32_bf16 v[100:103], v[172:175], v[144:147], v[148:151]
  v_cvt_pk_bf16_f32 v162, v104, v105
  v_cvt_pk_bf16_f32 v163, v106, v107
  v_mfma_f32_16x16x32_bf16 v[100:103], v[170:173], v[12:15], v[100:103]
  v_mul_f32 v94, s42, v94
  v_mul_f32 v95, s42, v95
  v_mfma_f32_16x16x32_bf16 v[176:179], v[166:169], v[144:147], v[80:83]
  v_cvt_pk_bf16_f32 v128, v92, v93
  v_cvt_pk_bf16_f32 v129, v94, v95
  v_mfma_f32_16x16x32_bf16 v[176:179], v[164:167], v[12:15], v[176:179]
  v_mul_f32 v108, s42, v108
  v_mul_f32 v109, s42, v109
  v_mfma_f32_16x16x32_bf16 v[152:155], v[160:163], v[144:147], v[88:91]
  v_mul_f32 v110, s42, v110
  v_mul_f32 v111, s42, v111
  v_mfma_f32_16x16x32_bf16 v[152:155], v[158:161], v[12:15], v[152:155]
  v_cvt_pk_bf16_f32 v130, v108, v109
  v_cvt_pk_bf16_f32 v131, v110, v111
  v_mfma_f32_16x16x32_bf16 v[104:107], v[132:135], v[180:183], v[116:119]
  v_mul_f32 v112, s42, v112
  v_mul_f32 v113, s42, v113
  v_mfma_f32_16x16x32_bf16 v[104:107], v[134:137], v[14:17], v[104:107]
  v_mul_f32 v114, s42, v114
  v_mul_f32 v115, s42, v115
  v_mfma_f32_16x16x32_bf16 v[108:111], v[170:173], v[180:183], v[120:123]
  v_cvt_pk_bf16_f32 v22, v112, v113
  v_cvt_pk_bf16_f32 v23, v114, v115
  v_mfma_f32_16x16x32_bf16 v[108:111], v[172:175], v[14:17], v[108:111]
  v_exp_f32 v96, v96
  v_mfma_f32_16x16x32_bf16 v[140:143], v[164:167], v[180:183], v[84:87]
  s_add_u32 m0, s28, 0
  v_exp_f32 v97, v97
  v_mfma_f32_16x16x32_bf16 v[140:143], v[166:169], v[14:17], v[140:143]
  v_exp_f32 v98, v98
  v_mfma_f32_16x16x32_bf16 v[144:147], v[158:161], v[180:183], v[80:83]
  s_waitcnt vmcnt(6)
  s_barrier
  v_mfma_f32_16x16x32_bf16 v[144:147], v[160:163], v[14:17], v[144:147]
  buffer_load_dwordx4 v6, s[8:11], s31 offen offset:0 nt lds
  v_mfma_f32_16x16x32_bf16 v[80:83], v[166:169], v[124:127], v[120:123]
  s_add_u32 m0, s28, 8064
  ds_read_b64_tr_b16 a[144:145], v61 offset:24576
  ds_read_b64_tr_b16 a[146:147], v61 offset:25088
  v_mfma_f32_16x16x32_bf16 v[80:83], v[164:167], v[18:21], v[80:83]
  ds_read_b64_tr_b16 a[156:157], v61 offset:28672
  ds_read_b64_tr_b16 a[158:159], v61 offset:29184
  v_mfma_f32_16x16x32_bf16 v[84:87], v[160:163], v[124:127], v[148:151]
  buffer_load_dwordx4 v6, s[8:11], s31 offen offset:128 nt lds
  v_mfma_f32_16x16x32_bf16 v[84:87], v[158:161], v[18:21], v[84:87]
  s_add_u32 m0, s28, 16128
  ds_read_b64_tr_b16 a[148:149], v62 offset:24576
  ds_read_b64_tr_b16 a[150:151], v62 offset:25088
  v_mfma_f32_16x16x32_bf16 v[112:115], v[134:137], v[124:127], v[64:67]
  ds_read_b64_tr_b16 a[160:161], v62 offset:28672
  ds_read_b64_tr_b16 a[162:163], v62 offset:29184
  v_mfma_f32_16x16x32_bf16 v[112:115], v[132:135], v[18:21], v[112:115]
  buffer_load_dwordx4 v6, s[8:11], s31 offen offset:256 nt lds
  v_mfma_f32_16x16x32_bf16 v[180:183], v[172:175], v[124:127], v[76:79]
  s_add_u32 s31, s31, s43
  ds_read_b64_tr_b16 a[152:153], v63 offset:24576
  ds_read_b64_tr_b16 a[154:155], v63 offset:25088
  v_mfma_f32_16x16x32_bf16 v[180:183], v[170:173], v[18:21], v[180:183]
  ds_read_b64_tr_b16 a[164:165], v63 offset:28672
  ds_read_b64_tr_b16 a[166:167], v63 offset:29184
  v_mfma_f32_16x16x32_bf16 v[88:91], v[164:167], v[128:131], v[116:119]
  ds_read_b64_tr_b16 a[168:169], v61 offset:49152
  ds_read_b64_tr_b16 a[170:171], v61 offset:49664
  v_mfma_f32_16x16x32_bf16 v[88:91], v[166:169], v[20:23], v[88:91]
  ds_read_b64_tr_b16 a[180:181], v61 offset:53248
  ds_read_b64_tr_b16 a[182:183], v61 offset:53760
  v_mfma_f32_16x16x32_bf16 v[92:95], v[158:161], v[128:131], v[120:123]
  ds_read_b64_tr_b16 a[172:173], v62 offset:49152
  ds_read_b64_tr_b16 a[174:175], v62 offset:49664
  v_mfma_f32_16x16x32_bf16 v[92:95], v[160:163], v[20:23], v[92:95]
  ds_read_b64_tr_b16 a[184:185], v62 offset:53248
  ds_read_b64_tr_b16 a[186:187], v62 offset:53760
  v_mfma_f32_16x16x32_bf16 v[148:151], v[132:135], v[128:131], v[72:75]
  ds_read_b64_tr_b16 a[176:177], v63 offset:49152
  ds_read_b64_tr_b16 a[178:179], v63 offset:49664
  v_mfma_f32_16x16x32_bf16 v[148:151], v[134:137], v[20:23], v[148:151]
  ds_read_b64_tr_b16 a[188:189], v63 offset:53248
  ds_read_b64_tr_b16 a[190:191], v63 offset:53760
  v_mfma_f32_16x16x32_bf16 v[164:167], v[170:173], v[128:131], v[64:67]
  v_exp_f32 v99, v99
  v_mfma_f32_16x16x32_bf16 v[164:167], v[172:175], v[20:23], v[164:167]
  s_waitcnt lgkmcnt(6)
  v_exp_f32 v100, v100
  v_mfma_f32_16x16x32_bf16 v[72:75], v[184:187], a[144:147], 0
  v_exp_f32 v101, v101
  v_mfma_f32_16x16x32_bf16 v[72:75], v[188:191], a[156:159], v[72:75]
  v_exp_f32 v102, v102
  v_mfma_f32_16x16x32_bf16 v[120:123], v[184:187], a[148:151], 0
  v_exp_f32 v103, v103
  v_mfma_f32_16x16x32_bf16 v[120:123], v[188:191], a[160:163], v[120:123]
  v_exp_f32 v176, v176
  v_mfma_f32_16x16x32_bf16 v[128:131], v[184:187], a[152:155], 0
  v_exp_f32 v177, v177
  v_mfma_f32_16x16x32_bf16 v[128:131], v[188:191], a[164:167], v[128:131]
  v_exp_f32 v178, v178
  v_mfma_f32_16x16x32_bf16 v[132:135], v[208:211], a[144:147], 0
  v_exp_f32 v179, v179
  v_mfma_f32_16x16x32_bf16 v[132:135], v[212:215], a[156:159], v[132:135]
  v_exp_f32 v152, v152
  v_mfma_f32_16x16x32_bf16 v[124:127], v[208:211], a[148:151], 0
  v_exp_f32 v153, v153
  v_mfma_f32_16x16x32_bf16 v[124:127], v[212:215], a[160:163], v[124:127]
  v_exp_f32 v154, v154
  v_mfma_f32_16x16x32_bf16 v[64:67], v[208:211], a[152:155], 0
  v_exp_f32 v155, v155
  v_mfma_f32_16x16x32_bf16 v[64:67], v[212:215], a[164:167], v[64:67]
  v_cvt_pk_bf16_f32 v96, v96, v97
  v_cvt_pk_bf16_f32 v97, v98, v99
  v_mfma_f32_16x16x32_bf16 v[72:75], v[192:195], a[168:171], v[72:75]
  v_cvt_pk_bf16_f32 v98, v100, v101
  v_cvt_pk_bf16_f32 v99, v102, v103
  v_mfma_f32_16x16x32_bf16 v[72:75], v[196:199], a[180:183], v[72:75]
  v_cvt_pk_bf16_f32 v100, v176, v177
  v_cvt_pk_bf16_f32 v101, v178, v179
  v_mfma_f32_16x16x32_bf16 v[120:123], v[192:195], a[172:175], v[120:123]
  s_waitcnt lgkmcnt(0)
  v_cvt_pk_bf16_f32 v102, v152, v153
  v_cvt_pk_bf16_f32 v103, v154, v155
  v_mfma_f32_16x16x32_bf16 v[120:123], v[196:199], a[184:187], v[120:123]
  s_waitcnt vmcnt(3)
  s_barrier
  v_mfma_f32_16x16x32_bf16 v[128:131], v[192:195], a[176:179], v[128:131]
  ds_read_b64_tr_b16 a[192:193], v57 offset:0
  ds_read_b64_tr_b16 a[194:195], v57 offset:512
  v_mfma_f32_16x16x32_bf16 v[128:131], v[196:199], a[188:191], v[128:131]
  ds_read_b64_tr_b16 a[204:205], v57 offset:4096
  ds_read_b64_tr_b16 a[206:207], v57 offset:4608
  v_mfma_f32_16x16x32_bf16 v[132:135], v[216:219], a[168:171], v[132:135]
  ds_read_b64_tr_b16 a[196:197], v60 offset:0
  ds_read_b64_tr_b16 a[198:199], v60 offset:512
  v_mfma_f32_16x16x32_bf16 v[132:135], v[220:223], a[180:183], v[132:135]
  ds_read_b64_tr_b16 a[208:209], v60 offset:4096
  ds_read_b64_tr_b16 a[210:211], v60 offset:4608
  v_mfma_f32_16x16x32_bf16 v[124:127], v[216:219], a[172:175], v[124:127]
  s_add_u32 s5, s45, 0
  s_add_u32 m0, s46, 126976
  ds_read_b64_tr_b16 a[200:201], v59 offset:0
  v_mfma_f32_16x16x32_bf16 v[124:127], v[220:223], a[184:187], v[124:127]
  ds_read_b64_tr_b16 a[202:203], v59 offset:512
  ds_read_b64_tr_b16 a[212:213], v59 offset:4096
  v_mfma_f32_16x16x32_bf16 v[64:67], v[216:219], a[176:179], v[64:67]
  s_waitcnt lgkmcnt(5)
  ds_read_b64_tr_b16 a[214:215], v59 offset:4608
  v_add_u32 v0, s28, v2
  v_mfma_f32_16x16x32_bf16 v[64:67], v[220:223], a[188:191], v[64:67]
  buffer_load_dwordx4 v71, s[16:19], s5 offen offset:0 lds
  v_mfma_f32_16x16x32_bf16 v[72:75], v[200:203], a[192:195], v[72:75]
  s_add_u32 m0, s46, 135040
  v_exp_f32 v104, v104
  v_mfma_f32_16x16x32_bf16 v[72:75], v[204:207], a[204:207], v[72:75]
  s_waitcnt lgkmcnt(1)
  v_exp_f32 v105, v105
  v_mfma_f32_16x16x32_bf16 v[120:123], v[200:203], a[196:199], v[120:123]
  buffer_load_dwordx4 v71, s[16:19], s5 offen offset:128 lds
  v_mfma_f32_16x16x32_bf16 v[120:123], v[204:207], a[208:211], v[120:123]
  s_add_u32 m0, s46, 143104
  v_exp_f32 v106, v106
  v_mfma_f32_16x16x32_bf16 v[128:131], v[200:203], a[200:203], v[128:131]
  s_waitcnt lgkmcnt(0)
  v_cvt_pk_bf16_f32 v56, v72, v73
  v_cvt_pk_bf16_f32 v57, v74, v75
  v_mfma_f32_16x16x32_bf16 v[128:131], v[204:207], a[212:215], v[128:131]
  buffer_load_dwordx4 v71, s[16:19], s5 offen offset:256 lds
  v_mfma_f32_16x16x32_bf16 v[132:135], v[224:227], a[192:195], v[132:135]
  s_add_u32 s5, s45, 12288
  v_cvt_pk_bf16_f32 v116, v120, v121
  v_cvt_pk_bf16_f32 v117, v122, v123
  v_mfma_f32_16x16x32_bf16 v[132:135], v[228:231], a[204:207], v[132:135]
  s_add_u32 m0, s46, 131072
  v_exp_f32 v107, v107
  v_mfma_f32_16x16x32_bf16 v[124:127], v[224:227], a[196:199], v[124:127]
  buffer_load_dwordx4 v71, s[16:19], s5 offen offset:0 lds
  v_mfma_f32_16x16x32_bf16 v[124:127], v[228:231], a[208:211], v[124:127]
  s_add_u32 m0, s46, 139136
  v_cvt_pk_bf16_f32 v72, v128, v129
  v_cvt_pk_bf16_f32 v73, v130, v131
  v_mfma_f32_16x16x32_bf16 v[64:67], v[224:227], a[200:203], v[64:67]
  v_cvt_pk_bf16_f32 v58, v132, v133
  v_cvt_pk_bf16_f32 v59, v134, v135
  v_mfma_f32_16x16x32_bf16 v[64:67], v[228:231], a[212:215], v[64:67]
  buffer_load_dwordx4 v71, s[16:19], s5 offen offset:128 lds
  v_mfma_f32_16x16x32_bf16 v[60:63], v[232:235], a[144:147], 0
  s_add_u32 m0, s46, 147200
  v_cvt_pk_bf16_f32 v118, v124, v125
  v_cvt_pk_bf16_f32 v119, v126, v127
  v_mfma_f32_16x16x32_bf16 v[60:63], v[236:239], a[156:159], v[60:63]
  v_exp_f32 v108, v108
  v_mfma_f32_16x16x32_bf16 v[60:63], v[240:243], a[168:171], v[60:63]
  buffer_load_dwordx4 v71, s[16:19], s5 offen offset:256 lds
  v_mfma_f32_16x16x32_bf16 v[60:63], v[244:247], a[180:183], v[60:63]
  v_cvt_pk_bf16_f32 v74, v64, v65
  v_cvt_pk_bf16_f32 v75, v66, v67
  v_mfma_f32_16x16x32_bf16 v[60:63], v[248:251], a[192:195], v[60:63]
  v_exp_f32 v109, v109
  v_mfma_f32_16x16x32_bf16 v[60:63], v[252:255], a[204:207], v[60:63]
  v_exp_f32 v110, v110
  v_mfma_f32_16x16x32_bf16 v[64:67], v[232:235], a[148:151], 0
  v_exp_f32 v111, v111
  v_mfma_f32_16x16x32_bf16 v[64:67], v[236:239], a[160:163], v[64:67]
  v_exp_f32 v140, v140
  v_mfma_f32_16x16x32_bf16 v[64:67], v[240:243], a[172:175], v[64:67]
  v_cvt_pk_bf16_f32 v120, v60, v61
  v_cvt_pk_bf16_f32 v121, v62, v63
  v_mfma_f32_16x16x32_bf16 v[64:67], v[244:247], a[184:187], v[64:67]
  v_exp_f32 v141, v141
  v_mfma_f32_16x16x32_bf16 v[64:67], v[248:251], a[196:199], v[64:67]
  v_exp_f32 v142, v142
  v_mfma_f32_16x16x32_bf16 v[64:67], v[252:255], a[208:211], v[64:67]
  v_exp_f32 v143, v143
  v_mfma_f32_16x16x32_bf16 v[60:63], v[232:235], a[152:155], 0
  v_exp_f32 v144, v144
  v_mfma_f32_16x16x32_bf16 v[60:63], v[236:239], a[164:167], v[60:63]
  v_exp_f32 v145, v145
  v_mfma_f32_16x16x32_bf16 v[60:63], v[240:243], a[176:179], v[60:63]
  v_cvt_pk_bf16_f32 v76, v64, v65
  v_cvt_pk_bf16_f32 v77, v66, v67
  v_cvt_pk_bf16_f32 v104, v104, v105
  v_mfma_f32_16x16x32_bf16 v[60:63], v[244:247], a[188:191], v[60:63]
  v_exp_f32 v146, v146
  v_cvt_pk_bf16_f32 v105, v106, v107
  v_mfma_f32_16x16x32_bf16 v[60:63], v[248:251], a[200:203], v[60:63]
  v_exp_f32 v147, v147
  v_cvt_pk_bf16_f32 v106, v108, v109
  v_mfma_f32_16x16x32_bf16 v[60:63], v[252:255], a[212:215], v[60:63]
  v_cvt_pk_bf16_f32 v107, v110, v111
  v_cvt_pk_bf16_f32 v108, v140, v141
  v_cvt_pk_bf16_f32 v109, v142, v143
  v_mfma_f32_16x16x32_bf16 v[64:67], a[216:219], a[144:147], 0
  v_cvt_pk_bf16_f32 v110, v144, v145
  v_cvt_pk_bf16_f32 v111, v146, v147
  v_xor_b32 v1, 64, v0
  v_mfma_f32_16x16x32_bf16 v[64:67], a[220:223], a[156:159], v[64:67]
  s_add_u32 s5, s45, 24576
  s_add_u32 m0, s46, 0
  v_exp_f32 v80, v80
  v_mfma_f32_16x16x32_bf16 v[64:67], a[224:227], a[168:171], v[64:67]
  v_cvt_pk_bf16_f32 v160, v60, v61
  v_cvt_pk_bf16_f32 v161, v62, v63
  v_mfma_f32_16x16x32_bf16 v[64:67], a[228:231], a[180:183], v[64:67]
  v_exp_f32 v81, v81
  v_mfma_f32_16x16x32_bf16 v[64:67], a[232:235], a[192:195], v[64:67]
  buffer_load_dwordx4 v71, s[16:19], s5 offen offset:0 lds
  v_cvt_pk_bf16_f32 v80, v80, v81
  v_mfma_f32_16x16x32_bf16 v[64:67], a[236:239], a[204:207], v[64:67]
  s_add_u32 m0, s46, 8064
  v_exp_f32 v82, v82
  v_mfma_f32_16x16x32_bf16 v[124:127], a[216:219], a[148:151], 0
  v_exp_f32 v83, v83
  v_mfma_f32_16x16x32_bf16 v[124:127], a[220:223], a[160:163], v[124:127]
  buffer_load_dwordx4 v71, s[16:19], s5 offen offset:128 lds
  v_cvt_pk_bf16_f32 v81, v82, v83
  v_mfma_f32_16x16x32_bf16 v[124:127], a[224:227], a[172:175], v[124:127]
  s_add_u32 m0, s46, 16128
  v_cvt_pk_bf16_f32 v122, v64, v65
  v_cvt_pk_bf16_f32 v123, v66, v67
  v_mfma_f32_16x16x32_bf16 v[124:127], a[228:231], a[184:187], v[124:127]
  v_exp_f32 v84, v84
  v_mfma_f32_16x16x32_bf16 v[124:127], a[232:235], a[196:199], v[124:127]
  buffer_load_dwordx4 v71, s[16:19], s5 offen offset:256 lds
  v_mov_b64 v[168:169], 0
  v_mfma_f32_16x16x32_bf16 v[124:127], a[236:239], a[208:211], v[124:127]
  s_add_u32 s5, s45, 36864
  s_add_u32 m0, s46, 4096
  v_exp_f32 v85, v85
  v_mfma_f32_16x16x32_bf16 v[64:67], a[216:219], a[152:155], 0
  v_exp_f32 v86, v86
  v_cvt_pk_bf16_f32 v82, v84, v85
  v_mfma_f32_16x16x32_bf16 v[64:67], a[220:223], a[164:167], v[64:67]
  buffer_load_dwordx4 v71, s[16:19], s5 offen offset:0 lds
  v_mfma_f32_16x16x32_bf16 v[64:67], a[224:227], a[176:179], v[64:67]
  s_add_u32 m0, s46, 12160
  v_cvt_pk_bf16_f32 v78, v124, v125
  v_cvt_pk_bf16_f32 v79, v126, v127
  v_mfma_f32_16x16x32_bf16 v[64:67], a[228:231], a[188:191], v[64:67]
  v_exp_f32 v87, v87
  v_mfma_f32_16x16x32_bf16 v[64:67], a[232:235], a[200:203], v[64:67]
  buffer_load_dwordx4 v71, s[16:19], s5 offen offset:128 lds
  v_cvt_pk_bf16_f32 v83, v86, v87
  v_mfma_f32_16x16x32_bf16 v[64:67], a[236:239], a[212:215], v[64:67]
  s_add_u32 m0, s46, 20224
  v_mov_b64 v[132:133], 0
  v_exp_f32 v112, v112
  v_smfmac_f32_16x16x64_bf16 v[168:171], a[240:243], v[96:103], v10
  v_exp_f32 v113, v113
  v_mfma_f32_16x16x32_bf16 v[176:179], v[120:123], v[100:103], 0
  buffer_load_dwordx4 v71, s[16:19], s5 offen offset:256 lds
  v_cvt_pk_bf16_f32 v84, v112, v113
  v_mfma_f32_16x16x32_bf16 v[176:179], v[56:59], v[96:99], v[176:179]
  v_cvt_pk_bf16_f32 v162, v64, v65
  v_cvt_pk_bf16_f32 v163, v66, v67
  v_mfma_f32_16x16x32_bf16 v[172:175], v[116:119], v[96:99], 0
  v_exp_f32 v114, v114
  v_mfma_f32_16x16x32_bf16 v[172:175], v[76:79], v[100:103], v[172:175]
  v_exp_f32 v115, v115
  v_mfma_f32_16x16x32_bf16 v[124:127], v[160:163], v[100:103], 0
  v_exp_f32 v180, v180
  v_cvt_pk_bf16_f32 v85, v114, v115
  v_mfma_f32_16x16x32_bf16 v[124:127], v[72:75], v[96:99], v[124:127]
  v_exp_f32 v181, v181
  v_mov_b64 v[112:113], 0
  v_smfmac_f32_16x16x64_bf16 v[132:135], a[240:243], v[104:111], v10
  v_exp_f32 v182, v182
  v_cvt_pk_bf16_f32 v86, v180, v181
  v_mfma_f32_16x16x32_bf16 v[152:155], v[120:123], v[108:111], 0
  v_exp_f32 v183, v183
  v_add_f32 v168, v168, v169
  v_mfma_f32_16x16x32_bf16 v[152:155], v[56:59], v[104:107], v[152:155]
  v_cvt_pk_bf16_f32 v87, v182, v183
  v_exp_f32 v88, v88
  v_mfma_f32_16x16x32_bf16 v[140:143], v[116:119], v[104:107], 0
  v_exp_f32 v89, v89
  v_mfma_f32_16x16x32_bf16 v[140:143], v[76:79], v[108:111], v[140:143]
  v_exp_f32 v90, v90
  v_cvt_pk_bf16_f32 v88, v88, v89
  v_mfma_f32_16x16x32_bf16 v[180:183], v[160:163], v[108:111], 0
  v_exp_f32 v91, v91
  v_add_f32 v132, v132, v133
  v_mfma_f32_16x16x32_bf16 v[180:183], v[72:75], v[104:107], v[180:183]
  v_exp_f32 v92, v92
  v_cvt_pk_bf16_f32 v89, v90, v91
  v_smfmac_f32_16x16x64_bf16 v[112:115], a[240:243], v[80:87], v10
  v_exp_f32 v93, v93
  v_exp_f32 v94, v94
  v_exp_f32 v95, v95
  v_exp_f32 v148, v148
  v_exp_f32 v149, v149
  v_exp_f32 v150, v150
  v_exp_f32 v151, v151
  v_exp_f32 v164, v164
  v_exp_f32 v165, v165
  v_exp_f32 v166, v166
  v_exp_f32 v167, v167
  v_mfma_f32_16x16x32_bf16 v[136:139], v[56:59], v[84:87], 0
  s_add_u32 s5, s45, 49152
  v_cvt_pk_bf16_f32 v90, v92, v93
  v_cvt_pk_bf16_f32 v91, v94, v95
  v_cvt_pk_bf16_f32 v92, v148, v149
  v_cvt_pk_bf16_f32 v93, v150, v151
  v_cvt_pk_bf16_f32 v94, v164, v165
  v_cvt_pk_bf16_f32 v95, v166, v167
  v_mfma_f32_16x16x32_bf16 v[136:139], v[120:123], v[80:83], v[136:139]
  s_waitcnt vmcnt(6) lgkmcnt(0)
  s_barrier
  v_mfma_f32_16x16x32_bf16 v[156:159], v[76:79], v[80:83], 0
  s_add_u32 m0, s46, 102400
  ds_read_b128 v[60:63], v0 offset:0
  v_mov_b64 v[104:105], 0
  v_mfma_f32_16x16x32_bf16 v[156:159], v[116:119], v[84:87], v[156:159]
  buffer_load_dwordx4 v71, s[16:19], s5 offen offset:0 lds
  v_mfma_f32_16x16x32_bf16 v[148:151], v[72:75], v[84:87], 0
  s_add_u32 m0, s46, 110464
  ds_read_b128 a[244:247], v1 offset:0
  ds_read_b128 v[164:167], v0 offset:8192
  v_mfma_f32_16x16x32_bf16 v[148:151], v[160:163], v[80:83], v[148:151]
  ds_read_b128 v[64:67], v1 offset:8192
  ds_read_b128 v[128:131], v0 offset:16384
  v_smfmac_f32_16x16x64_bf16 v[104:107], a[240:243], v[88:95], v10
  buffer_load_dwordx4 v71, s[16:19], s5 offen offset:128 lds
  v_mfma_f32_16x16x32_bf16 v[100:103], v[56:59], v[92:95], 0
  s_add_u32 m0, s46, 118528
  ds_read_b128 v[144:147], v1 offset:16384
  ds_read2st64_b32 v[84:85], v68 offset0:0 offset1:2
  v_mfma_f32_16x16x32_bf16 v[100:103], v[120:123], v[88:91], v[100:103]
  ds_read2st64_b32 v[96:97], v69 offset0:0 offset1:2
  ds_read2st64_b32 v[86:87], v68 offset0:4 offset1:6
  v_mfma_f32_16x16x32_bf16 v[108:111], v[76:79], v[88:91], 0
  buffer_load_dwordx4 v71, s[16:19], s5 offen offset:256 lds
  v_mfma_f32_16x16x32_bf16 v[108:111], v[116:119], v[92:95], v[108:111]
  s_add_u32 s5, s45, 61440
  s_add_u32 m0, s46, 106496
  ds_read2st64_b32 v[98:99], v69 offset0:4 offset1:6
  v_mfma_f32_16x16x32_bf16 v[116:119], v[72:75], v[92:95], 0
  s_waitcnt lgkmcnt(3)
  ds_read2st64_b32 v[76:77], v54 offset0:0 offset1:2
  ds_read2st64_b32 v[80:81], v55 offset0:0 offset1:2
  v_mfma_f32_16x16x32_bf16 v[116:119], v[160:163], v[88:91], v[116:119]
  buffer_load_dwordx4 v71, s[16:19], s5 offen offset:0 lds
  v_mfma_f32_16x16x32_bf16 v[72:75], a[0:3], v[60:63], 0
  s_add_u32 m0, s46, 114560
  ds_read2st64_b32 v[78:79], v54 offset0:4 offset1:6
  ds_read2st64_b32 v[82:83], v55 offset0:4 offset1:6
  v_mfma_f32_16x16x32_bf16 v[72:75], a[12:15], a[244:247], v[72:75]
  v_rcp_f32 v170, v168
  v_mfma_f32_16x16x32_bf16 v[72:75], a[24:27], v[164:167], v[72:75]
  buffer_load_dwordx4 v71, s[16:19], s5 offen offset:128 lds
  v_mfma_f32_16x16x32_bf16 v[72:75], a[36:39], v[64:67], v[72:75]
  s_add_u32 m0, s46, 122624
  v_mul_f32 v176, v170, v176
  v_mul_f32 v177, v170, v177
  v_mfma_f32_16x16x32_bf16 v[72:75], a[48:51], v[128:131], v[72:75]
  s_waitcnt lgkmcnt(4)
  v_perm_b32 v184, v96, v84, s58
  v_perm_b32 v188, v96, v84, s59
  v_mfma_f32_16x16x32_bf16 v[72:75], a[60:63], v[144:147], v[72:75]
  buffer_load_dwordx4 v71, s[16:19], s5 offen offset:256 lds
  v_mfma_f32_16x16x32_bf16 v[88:91], a[64:67], v[144:147], 0
  s_waitcnt lgkmcnt(0)
  v_perm_b32 v185, v97, v85, s58
  v_perm_b32 v189, v97, v85, s59
  v_mfma_f32_16x16x32_bf16 v[88:91], a[52:55], v[128:131], v[88:91]
  s_add_u32 m0, s28, 4096
  v_perm_b32 v186, v98, v86, s58
  v_perm_b32 v190, v98, v86, s59
  v_mfma_f32_16x16x32_bf16 v[88:91], a[40:43], v[64:67], v[88:91]
  s_mov_b32 s5, s28
  v_mul_f32 v72, s42, v72
  v_mul_f32 v73, s42, v73
  v_mfma_f32_16x16x32_bf16 v[88:91], a[28:31], v[164:167], v[88:91]
  v_mul_f32 v74, s42, v74
  v_mul_f32 v75, s42, v75
  v_mfma_f32_16x16x32_bf16 v[88:91], a[16:19], a[244:247], v[88:91]
  buffer_load_dwordx4 v6, s[8:11], s32 offen offset:0 nt lds
  v_mfma_f32_16x16x32_bf16 v[88:91], a[4:7], v[60:63], v[88:91]
  s_add_u32 m0, s28, 12160
  v_cvt_pk_bf16_f32 v12, v72, v73
  v_cvt_pk_bf16_f32 v13, v74, v75
  v_mfma_f32_16x16x32_bf16 v[56:59], a[8:11], v[60:63], 0
  v_perm_b32 v187, v99, v87, s58
  v_perm_b32 v191, v99, v87, s59
  v_perm_b32 v192, v80, v76, s58
  v_mfma_f32_16x16x32_bf16 v[56:59], a[20:23], a[244:247], v[56:59]
  buffer_load_dwordx4 v6, s[8:11], s32 offen offset:128 nt lds
  v_perm_b32 v196, v80, v76, s59
  v_mfma_f32_16x16x32_bf16 v[56:59], a[32:35], v[164:167], v[56:59]
  s_add_u32 m0, s28, 20224
  v_mul_f32 v88, s42, v88
  v_mul_f32 v89, s42, v89
  v_mul_f32 v90, s42, v90
  v_mfma_f32_16x16x32_bf16 v[56:59], a[44:47], v[64:67], v[56:59]
  s_mov_b32 s28, s29
  v_mul_f32 v91, s42, v91
  v_cvt_pk_bf16_f32 v72, v88, v89
  v_cvt_pk_bf16_f32 v73, v90, v91
  v_mfma_f32_16x16x32_bf16 v[56:59], a[56:59], v[128:131], v[56:59]
  buffer_load_dwordx4 v6, s[8:11], s32 offen offset:256 nt lds
  v_perm_b32 v193, v81, v77, s58
  v_mfma_f32_16x16x32_bf16 v[56:59], a[68:71], v[144:147], v[56:59]
  s_add_u32 s32, s32, s43
  v_perm_b32 v197, v81, v77, s59
  v_perm_b32 v194, v82, v78, s58
  v_perm_b32 v198, v82, v78, s59
  v_mfma_f32_16x16x32_bf16 v[88:91], a[132:135], v[144:147], 0
  ds_read2st64_b32 v[84:85], v68 offset0:16 offset1:18
  v_perm_b32 v195, v83, v79, s58
  v_perm_b32 v199, v83, v79, s59
  v_mfma_f32_16x16x32_bf16 v[88:91], a[120:123], v[128:131], v[88:91]
  ds_read2st64_b32 v[96:97], v69 offset0:16 offset1:18
  ds_read2st64_b32 v[86:87], v68 offset0:20 offset1:22
  v_mul_f32 v178, v170, v178
  v_mfma_f32_16x16x32_bf16 v[88:91], a[108:111], v[64:67], v[88:91]
  v_mul_f32 v56, s42, v56
  v_mul_f32 v57, s42, v57
  v_mul_f32 v58, s42, v58
  v_mfma_f32_16x16x32_bf16 v[88:91], a[96:99], v[164:167], v[88:91]
  v_mul_f32 v59, s42, v59
  v_cvt_pk_bf16_f32 v74, v56, v57
  v_cvt_pk_bf16_f32 v75, v58, v59
  v_mfma_f32_16x16x32_bf16 v[88:91], a[84:87], a[244:247], v[88:91]
  ds_read2st64_b32 v[98:99], v69 offset0:20 offset1:22
  ds_read2st64_b32 v[76:77], v54 offset0:16 offset1:18
  v_mul_f32 v179, v170, v179
  v_mfma_f32_16x16x32_bf16 v[88:91], a[72:75], v[60:63], v[88:91]
  ds_read2st64_b32 v[80:81], v55 offset0:16 offset1:18
  ds_read2st64_b32 v[78:79], v54 offset0:20 offset1:22
  v_cvt_pk_bf16_f32 v176, v176, v177
  v_mfma_f32_16x16x32_bf16 v[56:59], a[76:79], v[60:63], 0
  ds_read2st64_b32 v[82:83], v55 offset0:20 offset1:22
  v_cvt_pk_bf16_f32 v177, v178, v179
  v_mul_f32 v172, v170, v172
  v_mfma_f32_16x16x32_bf16 v[56:59], a[88:91], a[244:247], v[56:59]
  v_mul_f32 v173, v170, v173
  v_mul_f32 v174, v170, v174
  v_mul_f32 v175, v170, v175
  v_mfma_f32_16x16x32_bf16 v[56:59], a[100:103], v[164:167], v[56:59]
  v_cvt_pk_bf16_f32 v120, v88, v89
  v_cvt_pk_bf16_f32 v121, v90, v91
  v_cvt_pk_bf16_f32 v172, v172, v173
  v_mfma_f32_16x16x32_bf16 v[56:59], a[112:115], v[64:67], v[56:59]
  s_waitcnt lgkmcnt(4)
  v_cvt_pk_bf16_f32 v173, v174, v175
  v_mul_f32 v124, v170, v124
  v_mul_f32 v125, v170, v125
  v_mfma_f32_16x16x32_bf16 v[56:59], a[124:127], v[128:131], v[56:59]
  v_mul_f32 v126, v170, v126
  v_mul_f32 v127, v170, v127
  v_cvt_pk_bf16_f32 v124, v124, v125
  v_mfma_f32_16x16x32_bf16 v[56:59], a[136:139], v[144:147], v[56:59]
  s_waitcnt lgkmcnt(0)
  v_cvt_pk_bf16_f32 v125, v126, v127
  v_max3_f32 v9, v168, v170, v9
  v_perm_b32 v200, v96, v84, s58
  v_mfma_f32_16x16x32_bf16 v[92:95], a[140:143], v[144:147], 0
  ds_write2st64_b32 v5, v176, v177 offset0:0 offset1:4
  v_mfma_f32_16x16x32_bf16 v[92:95], a[128:131], v[128:131], v[92:95]
  ds_write2st64_b32 v5, v172, v173 offset0:8 offset1:12
  v_mfma_f32_16x16x32_bf16 v[92:95], a[116:119], v[64:67], v[92:95]
  v_cvt_pk_bf16_f32 v122, v56, v57
  v_cvt_pk_bf16_f32 v123, v58, v59
  v_perm_b32 v204, v96, v84, s59
  v_mfma_f32_16x16x32_bf16 v[92:95], a[104:107], v[164:167], v[92:95]
  ds_write2st64_b32 v5, v124, v125 offset0:16 offset1:20
  v_mfma_f32_16x16x32_bf16 v[92:95], a[92:95], a[244:247], v[92:95]
  v_perm_b32 v201, v97, v85, s58
  v_perm_b32 v205, v97, v85, s59
  v_perm_b32 v202, v98, v86, s58
  v_mfma_f32_16x16x32_bf16 v[92:95], a[80:83], v[60:63], v[92:95]
  v_perm_b32 v206, v98, v86, s59
  v_perm_b32 v203, v99, v87, s58
  v_perm_b32 v207, v99, v87, s59
  v_mfma_f32_16x16x32_bf16 v[168:171], v[60:63], a[144:147], 0
  v_perm_b32 v208, v80, v76, s58
  v_perm_b32 v212, v80, v76, s59
  v_perm_b32 v209, v81, v77, s58
  v_mfma_f32_16x16x32_bf16 v[168:171], a[244:247], a[156:159], v[168:171]
  v_perm_b32 v213, v81, v77, s59
  v_perm_b32 v210, v82, v78, s58
  v_perm_b32 v214, v82, v78, s59
  v_mfma_f32_16x16x32_bf16 v[168:171], v[164:167], a[168:171], v[168:171]
  ds_read_b128 a[248:251], v0 offset:2048
  v_cvt_pk_bf16_f32 v124, v92, v93
  v_cvt_pk_bf16_f32 v125, v94, v95
  v_mfma_f32_16x16x32_bf16 v[168:171], v[64:67], a[180:183], v[168:171]
  ds_read_b128 v[172:175], v1 offset:2048
  ds_read_b128 v[88:91], v0 offset:10240
  v_perm_b32 v211, v83, v79, s58
  v_mfma_f32_16x16x32_bf16 v[168:171], v[128:131], a[192:195], v[168:171]
  s_add_u32 m0, s29, 0
  ds_read_b128 v[160:163], v1 offset:10240
  ds_read_b128 a[252:255], v0 offset:18432
  v_perm_b32 v215, v83, v79, s59
  v_mfma_f32_16x16x32_bf16 v[168:171], v[144:147], a[204:207], v[168:171]
  ds_read_b128 v[92:95], v1 offset:18432
  v_add_u32 v68, 4294840320, v68
  v_add_u32 v69, 4294840320, v69
  v_mfma_f32_16x16x32_bf16 v[176:179], v[144:147], a[208:211], 0
  s_waitcnt vmcnt(3)
  s_barrier
  v_mfma_f32_16x16x32_bf16 v[176:179], v[128:131], a[196:199], v[176:179]
  buffer_load_dwordx4 v6, s[8:11], s31 offen offset:0 nt lds
  v_add_u32 v54, 4294840320, v54
  v_mfma_f32_16x16x32_bf16 v[176:179], v[64:67], a[184:187], v[176:179]
  s_add_u32 m0, s29, 8064
  v_cvt_pk_bf16_f32 v56, v168, v169
  v_cvt_pk_bf16_f32 v57, v170, v171
  v_add_u32 v55, 4294840320, v55
  v_mfma_f32_16x16x32_bf16 v[176:179], v[164:167], a[172:175], v[176:179]
  ds_read2st64_b32 v[84:85], v68 offset0:0 offset1:2
  ds_read2st64_b32 v[96:97], v69 offset0:0 offset1:2
  v_add_f32 v112, v112, v113
  v_mfma_f32_16x16x32_bf16 v[176:179], a[244:247], a[160:163], v[176:179]
  ds_read2st64_b32 v[86:87], v68 offset0:4 offset1:6
  ds_read2st64_b32 v[98:99], v69 offset0:4 offset1:6
  v_add_f32 v104, v104, v105
  v_mfma_f32_16x16x32_bf16 v[176:179], v[60:63], a[148:151], v[176:179]
  buffer_load_dwordx4 v6, s[8:11], s31 offen offset:128 nt lds
  v_mfma_f32_16x16x32_bf16 v[168:171], v[60:63], a[152:155], 0
L_hop_1_0:
  s_cbranch_execz L_hop_1_1
  s_add_u32 m0, s29, 16128
  ds_read2st64_b32 v[76:77], v54 offset0:0 offset1:2
  ds_read2st64_b32 v[80:81], v55 offset0:0 offset1:2
  v_mfma_f32_16x16x32_bf16 v[168:171], a[244:247], a[164:167], v[168:171]
  ds_read2st64_b32 v[78:79], v54 offset0:4 offset1:6
  ds_read2st64_b32 v[82:83], v55 offset0:4 offset1:6
  v_mfma_f32_16x16x32_bf16 v[168:171], v[164:167], a[176:179], v[168:171]
  v_cvt_pk_bf16_f32 v60, v176, v177
  v_cvt_pk_bf16_f32 v61, v178, v179
  v_mfma_f32_16x16x32_bf16 v[168:171], v[64:67], a[188:191], v[168:171]
  buffer_load_dwordx4 v6, s[8:11], s31 offen offset:256 nt lds
  v_mfma_f32_16x16x32_bf16 v[168:171], v[128:131], a[200:203], v[168:171]
  s_add_u32 m0, s29, 4096
  v_rcp_f32 v134, v132
  v_mfma_f32_16x16x32_bf16 v[168:171], v[144:147], a[212:215], v[168:171]
  s_waitcnt lgkmcnt(4)
  v_perm_b32 v216, v96, v84, s58
  v_perm_b32 v220, v96, v84, s59
  v_perm_b32 v217, v97, v85, s58
  v_mfma_f32_16x16x32_bf16 v[164:167], a[0:3], a[248:251], 0
  s_waitcnt lgkmcnt(0)
  v_perm_b32 v221, v97, v85, s59
  v_perm_b32 v218, v98, v86, s58
  v_perm_b32 v222, v98, v86, s59
  v_mfma_f32_16x16x32_bf16 v[164:167], a[12:15], v[172:175], v[164:167]
  buffer_load_dwordx4 v6, s[8:11], s32 offen offset:0 nt lds
  v_perm_b32 v219, v99, v87, s58
  v_mfma_f32_16x16x32_bf16 v[164:167], a[24:27], v[88:91], v[164:167]
  s_add_u32 m0, s29, 12160
  v_cvt_pk_bf16_f32 v64, v168, v169
  v_cvt_pk_bf16_f32 v65, v170, v171
  v_perm_b32 v223, v99, v87, s59
  v_mfma_f32_16x16x32_bf16 v[164:167], a[36:39], v[160:163], v[164:167]
  s_add_u32 s31, s31, s43
  v_perm_b32 v224, v80, v76, s58
  v_perm_b32 v228, v80, v76, s59
  v_perm_b32 v225, v81, v77, s58
  v_mfma_f32_16x16x32_bf16 v[164:167], a[48:51], a[252:255], v[164:167]
  v_perm_b32 v229, v81, v77, s59
  v_perm_b32 v226, v82, v78, s58
  v_perm_b32 v230, v82, v78, s59
  v_mfma_f32_16x16x32_bf16 v[164:167], a[60:63], v[92:95], v[164:167]
  buffer_load_dwordx4 v6, s[8:11], s32 offen offset:128 nt lds
  v_perm_b32 v227, v83, v79, s58
  v_mfma_f32_16x16x32_bf16 v[168:171], a[64:67], v[92:95], 0
  s_add_u32 m0, s29, 20224
  ds_read2st64_b32 v[84:85], v68 offset0:16 offset1:18
  ds_read2st64_b32 v[96:97], v69 offset0:16 offset1:18
  v_perm_b32 v231, v83, v79, s59
  v_mfma_f32_16x16x32_bf16 v[168:171], a[52:55], a[252:255], v[168:171]
  s_mov_b32 s29, s30
  ds_read2st64_b32 v[86:87], v68 offset0:20 offset1:22
  ds_read2st64_b32 v[98:99], v69 offset0:20 offset1:22
  v_mul_f32 v152, v134, v152
  v_mfma_f32_16x16x32_bf16 v[168:171], a[40:43], v[160:163], v[168:171]
  v_mul_f32 v164, s42, v164
  v_mul_f32 v165, s42, v165
  v_mul_f32 v166, s42, v166
  v_mfma_f32_16x16x32_bf16 v[168:171], a[28:31], v[88:91], v[168:171]
  buffer_load_dwordx4 v6, s[8:11], s32 offen offset:256 nt lds
  v_mul_f32 v167, s42, v167
  v_mfma_f32_16x16x32_bf16 v[168:171], a[16:19], v[172:175], v[168:171]
  s_add_u32 s32, s32, s43
  ds_read2st64_b32 v[76:77], v54 offset0:16 offset1:18
  v_cvt_pk_bf16_f32 v128, v164, v165
  v_cvt_pk_bf16_f32 v129, v166, v167
  v_mfma_f32_16x16x32_bf16 v[168:171], a[4:7], a[248:251], v[168:171]
  ds_read2st64_b32 v[80:81], v55 offset0:16 offset1:18
  ds_read2st64_b32 v[78:79], v54 offset0:20 offset1:22
  v_mul_f32 v153, v134, v153
  v_mfma_f32_16x16x32_bf16 v[164:167], a[8:11], a[248:251], 0
  s_waitcnt lgkmcnt(3)
  ds_read2st64_b32 v[82:83], v55 offset0:20 offset1:22
  v_mul_f32 v154, v134, v154
  v_mul_f32 v155, v134, v155
  v_mfma_f32_16x16x32_bf16 v[164:167], a[20:23], v[172:175], v[164:167]
  v_cvt_pk_bf16_f32 v152, v152, v153
  v_cvt_pk_bf16_f32 v153, v154, v155
  v_mul_f32 v140, v134, v140
  v_mfma_f32_16x16x32_bf16 v[164:167], a[32:35], v[88:91], v[164:167]
  v_mul_f32 v168, s42, v168
  v_mul_f32 v169, s42, v169
  v_mul_f32 v170, s42, v170
  v_mfma_f32_16x16x32_bf16 v[164:167], a[44:47], v[160:163], v[164:167]
  v_mul_f32 v171, s42, v171
  v_cvt_pk_bf16_f32 v130, v168, v169
  v_cvt_pk_bf16_f32 v131, v170, v171
  v_mfma_f32_16x16x32_bf16 v[164:167], a[56:59], a[252:255], v[164:167]
  v_mul_f32 v141, v134, v141
  v_mul_f32 v142, v134, v142
  v_mul_f32 v143, v134, v143
  v_mfma_f32_16x16x32_bf16 v[164:167], a[68:71], v[92:95], v[164:167]
  s_waitcnt lgkmcnt(0)
  v_cvt_pk_bf16_f32 v140, v140, v141
  v_cvt_pk_bf16_f32 v141, v142, v143
  v_mul_f32 v180, v134, v180
  v_mfma_f32_16x16x32_bf16 v[168:171], a[132:135], v[92:95], 0
  v_mul_f32 v181, v134, v181
  v_mul_f32 v182, v134, v182
  v_mul_f32 v183, v134, v183
  v_mfma_f32_16x16x32_bf16 v[168:171], a[120:123], a[252:255], v[168:171]
  v_cvt_pk_bf16_f32 v180, v180, v181
  v_cvt_pk_bf16_f32 v181, v182, v183
  v_max3_f32 v9, v132, v134, v9
  v_mfma_f32_16x16x32_bf16 v[168:171], a[108:111], v[160:163], v[168:171]
  v_mul_f32 v164, s42, v164
  v_mul_f32 v165, s42, v165
  v_mul_f32 v166, s42, v166
  v_mfma_f32_16x16x32_bf16 v[168:171], a[96:99], v[88:91], v[168:171]
  v_mul_f32 v167, s42, v167
  v_cvt_pk_bf16_f32 v16, v164, v165
  v_cvt_pk_bf16_f32 v17, v166, v167
  v_mfma_f32_16x16x32_bf16 v[168:171], a[84:87], v[172:175], v[168:171]
  ds_write2st64_b32 v5, v152, v153 offset0:1 offset1:5
  v_mfma_f32_16x16x32_bf16 v[168:171], a[72:75], a[248:251], v[168:171]
  ds_write2st64_b32 v5, v140, v141 offset0:9 offset1:13
  v_mfma_f32_16x16x32_bf16 v[132:135], a[76:79], a[248:251], 0
  ds_write2st64_b32 v5, v180, v181 offset0:17 offset1:21
  v_mfma_f32_16x16x32_bf16 v[132:135], a[88:91], v[172:175], v[132:135]
  v_rcp_f32 v114, v112
  v_perm_b32 v232, v96, v84, s58
  v_mfma_f32_16x16x32_bf16 v[132:135], a[100:103], v[88:91], v[132:135]
  v_cvt_pk_bf16_f32 v144, v168, v169
  v_cvt_pk_bf16_f32 v145, v170, v171
  v_mul_f32 v136, v114, v136
  v_mfma_f32_16x16x32_bf16 v[132:135], a[112:115], v[160:163], v[132:135]
  v_mul_f32 v137, v114, v137
  v_mul_f32 v138, v114, v138
  v_mul_f32 v139, v114, v139
  v_mfma_f32_16x16x32_bf16 v[132:135], a[124:127], a[252:255], v[132:135]
  v_cvt_pk_bf16_f32 v136, v136, v137
  v_cvt_pk_bf16_f32 v137, v138, v139
  v_mul_f32 v156, v114, v156
  v_mfma_f32_16x16x32_bf16 v[132:135], a[136:139], v[92:95], v[132:135]
  v_mul_f32 v157, v114, v157
  v_mul_f32 v158, v114, v158
  v_mul_f32 v159, v114, v159
  v_mfma_f32_16x16x32_bf16 v[152:155], a[140:143], v[92:95], 0
  v_cvt_pk_bf16_f32 v156, v156, v157
  v_cvt_pk_bf16_f32 v157, v158, v159
  v_mul_f32 v148, v114, v148
  v_mfma_f32_16x16x32_bf16 v[152:155], a[128:131], a[252:255], v[152:155]
  v_mul_f32 v149, v114, v149
  v_mul_f32 v150, v114, v150
  v_mul_f32 v151, v114, v151
  v_mfma_f32_16x16x32_bf16 v[152:155], a[116:119], v[160:163], v[152:155]
  v_cvt_pk_bf16_f32 v146, v132, v133
  v_cvt_pk_bf16_f32 v147, v134, v135
  v_cvt_pk_bf16_f32 v148, v148, v149
  v_mfma_f32_16x16x32_bf16 v[152:155], a[104:107], v[88:91], v[152:155]
  v_cvt_pk_bf16_f32 v149, v150, v151
  v_max3_f32 v9, v112, v114, v9
  v_perm_b32 v236, v96, v84, s59
  v_mfma_f32_16x16x32_bf16 v[152:155], a[92:95], v[172:175], v[152:155]
  ds_write2st64_b32 v5, v136, v137 offset0:2 offset1:6
  v_mfma_f32_16x16x32_bf16 v[152:155], a[80:83], a[248:251], v[152:155]
  ds_write2st64_b32 v5, v156, v157 offset0:10 offset1:14
  v_mfma_f32_16x16x32_bf16 v[168:171], a[248:251], a[144:147], 0
  ds_write2st64_b32 v5, v148, v149 offset0:18 offset1:22
  v_mfma_f32_16x16x32_bf16 v[168:171], v[172:175], a[156:159], v[168:171]
  v_rcp_f32 v106, v104
  v_perm_b32 v233, v97, v85, s58
  v_mfma_f32_16x16x32_bf16 v[168:171], v[88:91], a[168:171], v[168:171]
  v_cvt_pk_bf16_f32 v148, v152, v153
  v_cvt_pk_bf16_f32 v149, v154, v155
  v_mfma_f32_16x16x32_bf16 v[168:171], v[160:163], a[180:183], v[168:171]
  v_mul_f32 v100, v106, v100
  v_mul_f32 v101, v106, v101
  v_mfma_f32_16x16x32_bf16 v[168:171], a[252:255], a[192:195], v[168:171]
  s_waitcnt vmcnt(6) lgkmcnt(0)
  s_barrier
  v_mfma_f32_16x16x32_bf16 v[168:171], v[92:95], a[204:207], v[168:171]
  ds_read_b128 v[156:159], v0 offset:4096
  ds_read_b128 v[112:115], v1 offset:4096
  v_mfma_f32_16x16x32_bf16 v[132:135], v[92:95], a[208:211], 0
  ds_read_b128 v[180:183], v0 offset:12288
  ds_read_b128 v[140:143], v1 offset:12288
  v_mfma_f32_16x16x32_bf16 v[132:135], a[252:255], a[196:199], v[132:135]
  ds_read_b128 v[164:167], v0 offset:20480
  ds_read_b128 v[176:179], v1 offset:20480
  v_mfma_f32_16x16x32_bf16 v[132:135], v[160:163], a[184:187], v[132:135]
  v_cvt_pk_bf16_f32 v58, v168, v169
  v_cvt_pk_bf16_f32 v59, v170, v171
  v_mfma_f32_16x16x32_bf16 v[132:135], v[88:91], a[172:175], v[132:135]
  v_mul_f32 v102, v106, v102
  v_mul_f32 v103, v106, v103
  v_mfma_f32_16x16x32_bf16 v[132:135], v[172:175], a[160:163], v[132:135]
  v_cvt_pk_bf16_f32 v100, v100, v101
  v_cvt_pk_bf16_f32 v101, v102, v103
  v_mfma_f32_16x16x32_bf16 v[132:135], a[248:251], a[148:151], v[132:135]
  v_mul_f32 v108, v106, v108
  v_mul_f32 v109, v106, v109
  v_mfma_f32_16x16x32_bf16 v[136:139], a[248:251], a[152:155], 0
  v_mul_f32 v110, v106, v110
  v_mul_f32 v111, v106, v111
  v_mfma_f32_16x16x32_bf16 v[136:139], v[172:175], a[164:167], v[136:139]
  v_cvt_pk_bf16_f32 v108, v108, v109
  v_cvt_pk_bf16_f32 v109, v110, v111
  v_mfma_f32_16x16x32_bf16 v[136:139], v[88:91], a[176:179], v[136:139]
  v_cvt_pk_bf16_f32 v62, v132, v133
  v_cvt_pk_bf16_f32 v63, v134, v135
  v_mfma_f32_16x16x32_bf16 v[136:139], v[160:163], a[188:191], v[136:139]
  v_mul_f32 v116, v106, v116
  v_mul_f32 v117, v106, v117
  v_mfma_f32_16x16x32_bf16 v[136:139], a[252:255], a[200:203], v[136:139]
  v_mul_f32 v118, v106, v118
  v_mul_f32 v119, v106, v119
  v_mfma_f32_16x16x32_bf16 v[136:139], v[92:95], a[212:215], v[136:139]
  s_waitcnt lgkmcnt(0)
  v_cvt_pk_bf16_f32 v116, v116, v117
  v_cvt_pk_bf16_f32 v117, v118, v119
  v_mfma_f32_16x16x32_bf16 v[92:95], a[0:3], v[156:159], 0
  v_max3_f32 v9, v104, v106, v9
  v_perm_b32 v237, v97, v85, s59
  v_mfma_f32_16x16x32_bf16 v[92:95], a[12:15], v[112:115], v[92:95]
  ds_write2st64_b32 v5, v100, v101 offset0:3 offset1:7
  v_mfma_f32_16x16x32_bf16 v[92:95], a[24:27], v[180:183], v[92:95]
  v_cvt_pk_bf16_f32 v66, v136, v137
  v_cvt_pk_bf16_f32 v67, v138, v139
  v_mfma_f32_16x16x32_bf16 v[92:95], a[36:39], v[140:143], v[92:95]
  ds_write2st64_b32 v5, v108, v109 offset0:11 offset1:15
  v_mfma_f32_16x16x32_bf16 v[92:95], a[48:51], v[164:167], v[92:95]
  ds_write2st64_b32 v5, v116, v117 offset0:19 offset1:23
  v_mfma_f32_16x16x32_bf16 v[92:95], a[60:63], v[176:179], v[92:95]
  v_perm_b32 v234, v98, v86, s58
  v_perm_b32 v238, v98, v86, s59
  v_mfma_f32_16x16x32_bf16 v[88:91], a[64:67], v[176:179], 0
  v_perm_b32 v235, v99, v87, s58
  v_perm_b32 v239, v99, v87, s59
  v_mfma_f32_16x16x32_bf16 v[88:91], a[52:55], v[164:167], v[88:91]
  v_perm_b32 v240, v80, v76, s58
  v_perm_b32 v244, v80, v76, s59
  v_mfma_f32_16x16x32_bf16 v[88:91], a[40:43], v[140:143], v[88:91]
  v_mul_f32 v92, s42, v92
  v_mul_f32 v93, s42, v93
  v_mfma_f32_16x16x32_bf16 v[88:91], a[28:31], v[180:183], v[88:91]
  v_mul_f32 v94, s42, v94
  v_mul_f32 v95, s42, v95
  v_mfma_f32_16x16x32_bf16 v[88:91], a[16:19], v[112:115], v[88:91]
  v_cvt_pk_bf16_f32 v18, v92, v93
  v_cvt_pk_bf16_f32 v19, v94, v95
  v_mfma_f32_16x16x32_bf16 v[88:91], a[4:7], v[156:159], v[88:91]
  v_perm_b32 v241, v81, v77, s58
  v_perm_b32 v245, v81, v77, s59
  v_mfma_f32_16x16x32_bf16 v[92:95], a[8:11], v[156:159], 0
  v_perm_b32 v242, v82, v78, s58
  v_perm_b32 v246, v82, v78, s59
  v_mfma_f32_16x16x32_bf16 v[92:95], a[20:23], v[112:115], v[92:95]
  v_perm_b32 v243, v83, v79, s58
  v_perm_b32 v247, v83, v79, s59
  v_mfma_f32_16x16x32_bf16 v[92:95], a[32:35], v[180:183], v[92:95]
  v_mul_f32 v88, s42, v88
  v_mul_f32 v89, s42, v89
  v_mfma_f32_16x16x32_bf16 v[92:95], a[44:47], v[140:143], v[92:95]
  v_mul_f32 v90, s42, v90
  v_mul_f32 v91, s42, v91
  v_mfma_f32_16x16x32_bf16 v[92:95], a[56:59], v[164:167], v[92:95]
  v_cvt_pk_bf16_f32 v100, v88, v89
  v_cvt_pk_bf16_f32 v101, v90, v91
  v_mfma_f32_16x16x32_bf16 v[92:95], a[68:71], v[176:179], v[92:95]
  v_add_u32 v68, 102400, v68
  v_add_u32 v69, 102400, v69
  v_mfma_f32_16x16x32_bf16 v[88:91], a[132:135], v[176:179], 0
  v_add_u32 v54, 102400, v54
  v_add_u32 v55, 102400, v55
  v_mfma_f32_16x16x32_bf16 v[88:91], a[120:123], v[164:167], v[88:91]
  ds_read2st64_b32 v[84:85], v68 offset0:0 offset1:2
  ds_read2st64_b32 v[96:97], v69 offset0:0 offset1:2
  v_mfma_f32_16x16x32_bf16 v[88:91], a[108:111], v[140:143], v[88:91]
  v_mul_f32 v92, s42, v92
  v_mul_f32 v93, s42, v93
  v_mfma_f32_16x16x32_bf16 v[88:91], a[96:99], v[180:183], v[88:91]
  v_mul_f32 v94, s42, v94
  v_mul_f32 v95, s42, v95
  v_mfma_f32_16x16x32_bf16 v[88:91], a[84:87], v[112:115], v[88:91]
  v_cvt_pk_bf16_f32 v102, v92, v93
  v_cvt_pk_bf16_f32 v103, v94, v95
  v_mfma_f32_16x16x32_bf16 v[88:91], a[72:75], v[156:159], v[88:91]
  ds_read2st64_b32 v[86:87], v68 offset0:4 offset1:6
  ds_read2st64_b32 v[98:99], v69 offset0:4 offset1:6
  v_mfma_f32_16x16x32_bf16 v[92:95], a[76:79], v[156:159], 0
  ds_read2st64_b32 v[76:77], v54 offset0:0 offset1:2
  ds_read2st64_b32 v[80:81], v55 offset0:0 offset1:2
  v_mfma_f32_16x16x32_bf16 v[92:95], a[88:91], v[112:115], v[92:95]
  ds_read2st64_b32 v[78:79], v54 offset0:4 offset1:6
  ds_read2st64_b32 v[82:83], v55 offset0:4 offset1:6
  v_mfma_f32_16x16x32_bf16 v[92:95], a[100:103], v[180:183], v[92:95]
  v_cvt_pk_bf16_f32 v132, v88, v89
  v_cvt_pk_bf16_f32 v133, v90, v91
  v_mfma_f32_16x16x32_bf16 v[92:95], a[112:115], v[140:143], v[92:95]
  v_xor_b32 v5, s41, v5
  v_mfma_f32_16x16x32_bf16 v[92:95], a[124:127], v[164:167], v[92:95]
  s_waitcnt lgkmcnt(4)
  v_perm_b32 v248, v96, v84, s58
  v_perm_b32 v252, v96, v84, s59
  v_mfma_f32_16x16x32_bf16 v[92:95], a[136:139], v[176:179], v[92:95]
  v_perm_b32 v249, v97, v85, s58
  v_perm_b32 v253, v97, v85, s59
  v_mfma_f32_16x16x32_bf16 v[88:91], a[140:143], v[176:179], 0
  s_waitcnt lgkmcnt(0)
  v_perm_b32 v250, v98, v86, s58
  v_perm_b32 v254, v98, v86, s59
  v_mfma_f32_16x16x32_bf16 v[88:91], a[128:131], v[164:167], v[88:91]
  v_perm_b32 v251, v99, v87, s58
  v_perm_b32 v255, v99, v87, s59
  v_mfma_f32_16x16x32_bf16 v[88:91], a[116:119], v[140:143], v[88:91]
  v_cvt_pk_bf16_f32 v134, v92, v93
  v_cvt_pk_bf16_f32 v135, v94, v95
  v_mfma_f32_16x16x32_bf16 v[88:91], a[104:107], v[180:183], v[88:91]
  s_add_u32 m0, s30, 0
  v_perm_b32 v104, v80, v76, s58
  v_perm_b32 v76, v80, v76, s59
  v_mfma_f32_16x16x32_bf16 v[88:91], a[92:95], v[112:115], v[88:91]
  v_accvgpr_write_b32 a220, v76
  v_perm_b32 v105, v81, v77, s58
  v_mfma_f32_16x16x32_bf16 v[88:91], a[80:83], v[156:159], v[88:91]
  v_perm_b32 v77, v81, v77, s59
  v_accvgpr_write_b32 a221, v77
  v_mfma_f32_16x16x32_bf16 v[84:87], v[156:159], a[144:147], 0
  buffer_load_dwordx4 v6, s[8:11], s31 offen offset:0 nt lds
  v_mfma_f32_16x16x32_bf16 v[84:87], v[112:115], a[156:159], v[84:87]
  s_add_u32 m0, s30, 8064
  v_perm_b32 v106, v82, v78, s58
  v_perm_b32 v78, v82, v78, s59
  v_mfma_f32_16x16x32_bf16 v[84:87], v[180:183], a[168:171], v[84:87]
  v_cvt_pk_bf16_f32 v136, v88, v89
  v_cvt_pk_bf16_f32 v137, v90, v91
  v_mfma_f32_16x16x32_bf16 v[84:87], v[140:143], a[180:183], v[84:87]
  ds_read_b128 a[252:255], v1 offset:22528
  ds_read_b128 v[152:155], v0 offset:22528
  v_mfma_f32_16x16x32_bf16 v[84:87], v[164:167], a[192:195], v[84:87]
  buffer_load_dwordx4 v6, s[8:11], s31 offen offset:128 nt lds
  v_mfma_f32_16x16x32_bf16 v[84:87], v[176:179], a[204:207], v[84:87]
  s_add_u32 m0, s30, 16128
  ds_read_b128 a[244:247], v1 offset:14336
  ds_read_b128 a[248:251], v0 offset:14336
  v_mfma_f32_16x16x32_bf16 v[92:95], v[176:179], a[208:211], 0
  ds_read_b128 v[172:175], v1 offset:6144
  ds_read_b128 v[168:171], v0 offset:6144
  v_mfma_f32_16x16x32_bf16 v[92:95], v[164:167], a[196:199], v[92:95]
  v_accvgpr_write_b32 a222, v78
  v_perm_b32 v107, v83, v79, s58
  v_mfma_f32_16x16x32_bf16 v[92:95], v[140:143], a[184:187], v[92:95]
  buffer_load_dwordx4 v6, s[8:11], s31 offen offset:256 nt lds
  v_mfma_f32_16x16x32_bf16 v[92:95], v[180:183], a[172:175], v[92:95]
  s_add_u32 m0, s30, 4096
  v_cvt_pk_bf16_f32 v108, v84, v85
  v_cvt_pk_bf16_f32 v109, v86, v87
  v_mfma_f32_16x16x32_bf16 v[92:95], v[112:115], a[160:163], v[92:95]
  s_add_u32 s31, s31, s43
  v_perm_b32 v79, v83, v79, s59
  v_accvgpr_write_b32 a223, v79
  v_mfma_f32_16x16x32_bf16 v[92:95], v[156:159], a[148:151], v[92:95]
  ds_read2st64_b32 v[84:85], v68 offset0:16 offset1:18
  ds_read2st64_b32 v[96:97], v69 offset0:16 offset1:18
  v_mfma_f32_16x16x32_bf16 v[88:91], v[156:159], a[152:155], 0
  buffer_load_dwordx4 v6, s[8:11], s32 offen offset:0 nt lds
  v_mfma_f32_16x16x32_bf16 v[88:91], v[112:115], a[164:167], v[88:91]
  s_add_u32 m0, s30, 12160
  ds_read2st64_b32 v[86:87], v68 offset0:20 offset1:22
  ds_read2st64_b32 v[98:99], v69 offset0:20 offset1:22
  v_mfma_f32_16x16x32_bf16 v[88:91], v[180:183], a[176:179], v[88:91]
  v_cvt_pk_bf16_f32 v112, v92, v93
  v_cvt_pk_bf16_f32 v113, v94, v95
  v_mfma_f32_16x16x32_bf16 v[88:91], v[140:143], a[188:191], v[88:91]
  s_waitcnt lgkmcnt(2)
  ds_read2st64_b32 v[76:77], v54 offset0:16 offset1:18
  ds_read2st64_b32 v[80:81], v55 offset0:16 offset1:18
  v_mfma_f32_16x16x32_bf16 v[88:91], v[164:167], a[200:203], v[88:91]
  buffer_load_dwordx4 v6, s[8:11], s32 offen offset:128 nt lds
  v_mfma_f32_16x16x32_bf16 v[88:91], v[176:179], a[212:215], v[88:91]
  s_add_u32 m0, s30, 20224
  ds_read2st64_b32 v[78:79], v54 offset0:20 offset1:22
  ds_read2st64_b32 v[82:83], v55 offset0:20 offset1:22
  v_mfma_f32_16x16x32_bf16 v[68:71], a[132:135], a[252:255], 0
  s_waitcnt lgkmcnt(4)
  v_accvgpr_write_b32 a216, v104
  v_accvgpr_write_b32 a217, v105
  v_mfma_f32_16x16x32_bf16 v[68:71], a[120:123], v[152:155], v[68:71]
  s_mov_b32 s30, s5
  v_accvgpr_write_b32 a218, v106
  v_accvgpr_write_b32 a219, v107
  v_mfma_f32_16x16x32_bf16 v[68:71], a[108:111], a[244:247], v[68:71]
  buffer_load_dwordx4 v6, s[8:11], s32 offen offset:256 nt lds
  v_mfma_f32_16x16x32_bf16 v[68:71], a[96:99], a[248:251], v[68:71]
  s_add_u32 s32, s32, s43
  v_cvt_pk_bf16_f32 v116, v88, v89
  v_cvt_pk_bf16_f32 v117, v90, v91
  v_mfma_f32_16x16x32_bf16 v[68:71], a[84:87], v[172:175], v[68:71]
  s_waitcnt lgkmcnt(0)
  v_perm_b32 v54, v96, v84, s58
  v_perm_b32 v84, v96, v84, s59
  v_mfma_f32_16x16x32_bf16 v[68:71], a[72:75], v[168:171], v[68:71]
  v_accvgpr_write_b32 a224, v54
  v_accvgpr_write_b32 a228, v84
  v_mfma_f32_16x16x32_bf16 v[88:91], a[76:79], v[168:171], 0
  v_perm_b32 v55, v97, v85, s58
  v_perm_b32 v85, v97, v85, s59
  v_mfma_f32_16x16x32_bf16 v[88:91], a[88:91], v[172:175], v[88:91]
  v_accvgpr_write_b32 a225, v55
  v_accvgpr_write_b32 a229, v85
  v_mfma_f32_16x16x32_bf16 v[88:91], a[100:103], a[248:251], v[88:91]
  v_cvt_pk_bf16_f32 v176, v68, v69
  v_cvt_pk_bf16_f32 v177, v70, v71
  v_mfma_f32_16x16x32_bf16 v[88:91], a[112:115], a[244:247], v[88:91]
  v_perm_b32 v54, v98, v86, s58
  v_perm_b32 v86, v98, v86, s59
  v_mfma_f32_16x16x32_bf16 v[88:91], a[124:127], v[152:155], v[88:91]
  v_accvgpr_write_b32 a226, v54
  v_accvgpr_write_b32 a230, v86
  v_mfma_f32_16x16x32_bf16 v[88:91], a[136:139], a[252:255], v[88:91]
  v_perm_b32 v55, v99, v87, s58
  v_perm_b32 v87, v99, v87, s59
  v_mfma_f32_16x16x32_bf16 v[68:71], a[140:143], a[252:255], 0
  v_accvgpr_write_b32 a227, v55
  v_accvgpr_write_b32 a231, v87
  v_mfma_f32_16x16x32_bf16 v[68:71], a[128:131], v[152:155], v[68:71]
  v_perm_b32 v54, v80, v76, s58
  v_perm_b32 v76, v80, v76, s59
  v_mfma_f32_16x16x32_bf16 v[68:71], a[116:119], a[244:247], v[68:71]
  v_cvt_pk_bf16_f32 v178, v88, v89
  v_cvt_pk_bf16_f32 v179, v90, v91
  v_mfma_f32_16x16x32_bf16 v[68:71], a[104:107], a[248:251], v[68:71]
  v_accvgpr_write_b32 a232, v54
  v_accvgpr_write_b32 a236, v76
  v_mfma_f32_16x16x32_bf16 v[68:71], a[92:95], v[172:175], v[68:71]
  v_perm_b32 v55, v81, v77, s58
  v_perm_b32 v77, v81, v77, s59
  v_mfma_f32_16x16x32_bf16 v[68:71], a[80:83], v[168:171], v[68:71]
  v_accvgpr_write_b32 a233, v55
  v_accvgpr_write_b32 a237, v77
  v_mfma_f32_16x16x32_bf16 v[92:95], v[122:125], v[72:75], v[36:39]
  v_perm_b32 v54, v82, v78, s58
  v_perm_b32 v78, v82, v78, s59
  v_mfma_f32_16x16x32_bf16 v[92:95], v[120:123], v[12:15], v[92:95]
  v_accvgpr_write_b32 a234, v54
  v_accvgpr_write_b32 a238, v78
  v_mfma_f32_16x16x32_bf16 v[96:99], v[146:149], v[72:75], v[32:35]
  v_perm_b32 v55, v83, v79, s58
  v_perm_b32 v79, v83, v79, s59
  v_mfma_f32_16x16x32_bf16 v[96:99], v[144:147], v[12:15], v[96:99]
  v_accvgpr_write_b32 a235, v55
  v_accvgpr_write_b32 a239, v79
  v_mfma_f32_16x16x32_bf16 v[104:107], v[134:137], v[72:75], v[28:31]
  v_cvt_pk_bf16_f32 v180, v68, v69
  v_cvt_pk_bf16_f32 v181, v70, v71
  v_mfma_f32_16x16x32_bf16 v[104:107], v[132:135], v[12:15], v[104:107]
  v_exp_f32 v92, v92
  v_mfma_f32_16x16x32_bf16 v[140:143], v[178:181], v[72:75], v[24:27]
  s_lshr_b32 s44, s2, 3
  v_exp_f32 v93, v93
  v_mfma_f32_16x16x32_bf16 v[140:143], v[176:179], v[12:15], v[140:143]
  s_lshl_b32 s44, s44, 9
  v_exp_f32 v94, v94
  v_mfma_f32_16x16x32_bf16 v[84:87], v[120:123], v[128:131], v[40:43]
  s_add_u32 s44, s44, 1048576
  v_exp_f32 v95, v95
  v_mfma_f32_16x16x32_bf16 v[84:87], v[122:125], v[14:17], v[84:87]
  s_mov_b32 s45, 0
  v_exp_f32 v96, v96
  v_mfma_f32_16x16x32_bf16 v[88:91], v[144:147], v[128:131], v[36:39]
  s_mov_b32 s59, 0
  v_exp_f32 v97, v97
  v_mfma_f32_16x16x32_bf16 v[88:91], v[146:149], v[14:17], v[88:91]
  s_mov_b32 s58, 0
  v_exp_f32 v98, v98
  v_mfma_f32_16x16x32_bf16 v[68:71], v[132:135], v[128:131], v[32:35]
  s_mov_b64 s[12:13], 0
  v_exp_f32 v99, v99
  v_mfma_f32_16x16x32_bf16 v[68:71], v[134:137], v[14:17], v[68:71]
  s_mov_b64 s[16:17], 0
  v_exp_f32 v104, v104
  v_mfma_f32_16x16x32_bf16 v[72:75], v[176:179], v[128:131], v[28:31]
  s_mov_b64 s[18:19], 0
  v_exp_f32 v105, v105
  v_mfma_f32_16x16x32_bf16 v[72:75], v[178:181], v[14:17], v[72:75]
  s_mov_b64 s[60:61], 0
  v_exp_f32 v106, v106
  v_mfma_f32_16x16x32_bf16 v[76:79], v[134:137], v[100:103], v[36:39]
  s_mov_b32 s15, 0
  v_exp_f32 v107, v107
  v_mfma_f32_16x16x32_bf16 v[76:79], v[132:135], v[18:21], v[76:79]
  s_mov_b32 s99, 0
  v_exp_f32 v140, v140
  v_mfma_f32_16x16x32_bf16 v[80:83], v[178:181], v[100:103], v[32:35]
  s_mov_b64 s[100:101], 0
  v_exp_f32 v141, v141
  v_mfma_f32_16x16x32_bf16 v[80:83], v[176:179], v[18:21], v[80:83]
  s_mov_b32 s14, 0
  v_exp_f32 v142, v142
  v_mfma_f32_16x16x32_bf16 v[160:163], v[122:125], v[100:103], v[44:47]
  v_exp_f32 v143, v143
  v_mfma_f32_16x16x32_bf16 v[160:163], v[120:123], v[18:21], v[160:163]
  v_cvt_pk_bf16_f32 v92, v92, v93
  v_cvt_pk_bf16_f32 v93, v94, v95
  v_mfma_f32_16x16x32_bf16 v[156:159], v[146:149], v[100:103], v[40:43]
  v_cvt_pk_bf16_f32 v94, v96, v97
  v_cvt_pk_bf16_f32 v95, v98, v99
  v_mfma_f32_16x16x32_bf16 v[156:159], v[144:147], v[18:21], v[156:159]
  v_cvt_pk_bf16_f32 v96, v104, v105
  v_cvt_pk_bf16_f32 v97, v106, v107
  v_mfma_f32_16x16x32_bf16 v[128:131], a[0:3], v[168:171], 0
  v_cvt_pk_bf16_f32 v98, v140, v141
  v_cvt_pk_bf16_f32 v99, v142, v143
  v_mfma_f32_16x16x32_bf16 v[128:131], a[12:15], v[172:175], v[128:131]
  v_exp_f32 v84, v84
  v_mfma_f32_16x16x32_bf16 v[128:131], a[24:27], a[248:251], v[128:131]
  v_exp_f32 v85, v85
  v_mfma_f32_16x16x32_bf16 v[128:131], a[36:39], a[244:247], v[128:131]
  v_exp_f32 v86, v86
  v_mfma_f32_16x16x32_bf16 v[128:131], a[48:51], v[152:155], v[128:131]
  v_exp_f32 v87, v87
  v_mfma_f32_16x16x32_bf16 v[128:131], a[60:63], a[252:255], v[128:131]
  v_exp_f32 v88, v88
  v_mfma_f32_16x16x32_bf16 v[100:103], a[64:67], a[252:255], 0
  v_exp_f32 v89, v89
  v_mfma_f32_16x16x32_bf16 v[100:103], a[52:55], v[152:155], v[100:103]
  v_exp_f32 v90, v90
  v_mfma_f32_16x16x32_bf16 v[100:103], a[40:43], a[244:247], v[100:103]
  v_exp_f32 v91, v91
  v_mfma_f32_16x16x32_bf16 v[100:103], a[28:31], a[248:251], v[100:103]
  v_mul_f32 v128, s42, v128
  v_mul_f32 v129, s42, v129
  v_mfma_f32_16x16x32_bf16 v[100:103], a[16:19], v[172:175], v[100:103]
  v_mul_f32 v130, s42, v130
  v_mul_f32 v131, s42, v131
  v_mfma_f32_16x16x32_bf16 v[100:103], a[4:7], v[168:171], v[100:103]
  v_cvt_pk_bf16_f32 v140, v128, v129
  v_cvt_pk_bf16_f32 v141, v130, v131
  v_mfma_f32_16x16x32_bf16 v[104:107], a[8:11], v[168:171], 0
  v_exp_f32 v68, v68
  v_mfma_f32_16x16x32_bf16 v[104:107], a[20:23], v[172:175], v[104:107]
  v_exp_f32 v69, v69
  v_mfma_f32_16x16x32_bf16 v[104:107], a[32:35], a[248:251], v[104:107]
  v_exp_f32 v70, v70
  v_mfma_f32_16x16x32_bf16 v[104:107], a[44:47], a[244:247], v[104:107]
  v_mul_f32 v100, s42, v100
  v_mul_f32 v101, s42, v101
  v_mfma_f32_16x16x32_bf16 v[104:107], a[56:59], v[152:155], v[104:107]
  v_mul_f32 v102, s42, v102
  v_mul_f32 v103, s42, v103
  v_mfma_f32_16x16x32_bf16 v[104:107], a[68:71], a[252:255], v[104:107]
  v_cvt_pk_bf16_f32 v142, v100, v101
  v_cvt_pk_bf16_f32 v143, v102, v103
  v_mfma_f32_16x16x32_bf16 v[128:131], v[168:171], a[144:147], 0
  v_exp_f32 v71, v71
  v_mfma_f32_16x16x32_bf16 v[128:131], v[172:175], a[156:159], v[128:131]
  v_exp_f32 v72, v72
  v_mfma_f32_16x16x32_bf16 v[128:131], a[248:251], a[168:171], v[128:131]
  v_mul_f32 v104, s42, v104
  v_mul_f32 v105, s42, v105
  v_mfma_f32_16x16x32_bf16 v[128:131], a[244:247], a[180:183], v[128:131]
  v_mul_f32 v106, s42, v106
  v_mul_f32 v107, s42, v107
  v_cvt_pk_bf16_f32 v22, v104, v105
  v_cvt_pk_bf16_f32 v23, v106, v107
  v_mfma_f32_16x16x32_bf16 v[128:131], v[152:155], a[192:195], v[128:131]
  s_waitcnt vmcnt(6) lgkmcnt(0)
  s_barrier
  v_mfma_f32_16x16x32_bf16 v[128:131], a[252:255], a[204:207], v[128:131]
  v_exp_f32 v73, v73
  v_mfma_f32_16x16x32_bf16 v[100:103], v[132:135], v[140:143], v[40:43]
  v_exp_f32 v74, v74
  v_mfma_f32_16x16x32_bf16 v[100:103], v[134:137], v[20:23], v[100:103]
  v_exp_f32 v75, v75
  v_mfma_f32_16x16x32_bf16 v[104:107], v[176:179], v[140:143], v[36:39]
  v_cvt_pk_bf16_f32 v84, v84, v85
  v_cvt_pk_bf16_f32 v85, v86, v87
  v_mfma_f32_16x16x32_bf16 v[104:107], v[178:181], v[20:23], v[104:107]
  v_cvt_pk_bf16_f32 v110, v128, v129
  v_cvt_pk_bf16_f32 v111, v130, v131
  v_mfma_f32_16x16x32_bf16 v[132:135], v[120:123], v[140:143], v[48:51]
  v_cvt_pk_bf16_f32 v86, v88, v89
  v_cvt_pk_bf16_f32 v87, v90, v91
  v_mfma_f32_16x16x32_bf16 v[132:135], v[122:125], v[20:23], v[132:135]
  v_cvt_pk_bf16_f32 v88, v68, v69
  v_cvt_pk_bf16_f32 v89, v70, v71
  v_mfma_f32_16x16x32_bf16 v[128:131], v[144:147], v[140:143], v[44:47]
  v_cvt_pk_bf16_f32 v90, v72, v73
  v_cvt_pk_bf16_f32 v91, v74, v75
  v_mfma_f32_16x16x32_bf16 v[128:131], v[146:149], v[20:23], v[128:131]
L_hop_2_0:
  s_cbranch_execz L_hop_2_1
  ds_read_b128 v[136:139], v3 offset:0
  ds_read_b128 v[140:143], v3 offset:4096
  v_mfma_f32_16x16x32_bf16 v[176:179], a[252:255], a[208:211], 0
  ds_read_b128 v[68:71], v3 offset:8192
  ds_read_b128 v[72:75], v3 offset:12288
  v_mfma_f32_16x16x32_bf16 v[176:179], v[152:155], a[196:199], v[176:179]
  ds_read_b128 v[120:123], v3 offset:16384
  ds_read_b128 v[124:127], v3 offset:20480
  v_mfma_f32_16x16x32_bf16 v[176:179], a[244:247], a[184:187], v[176:179]
  v_exp_f32 v76, v76
  v_mfma_f32_16x16x32_bf16 v[176:179], a[248:251], a[172:175], v[176:179]
  v_exp_f32 v77, v77
  v_mfma_f32_16x16x32_bf16 v[176:179], v[172:175], a[160:163], v[176:179]
  v_exp_f32 v78, v78
  v_mfma_f32_16x16x32_bf16 v[176:179], v[168:171], a[148:151], v[176:179]
  v_exp_f32 v79, v79
  v_mfma_f32_16x16x32_bf16 v[164:167], v[168:171], a[152:155], 0
  v_exp_f32 v80, v80
  v_mfma_f32_16x16x32_bf16 v[164:167], v[172:175], a[164:167], v[164:167]
  v_exp_f32 v81, v81
  v_mfma_f32_16x16x32_bf16 v[164:167], a[248:251], a[176:179], v[164:167]
  v_exp_f32 v82, v82
  v_mfma_f32_16x16x32_bf16 v[164:167], a[244:247], a[188:191], v[164:167]
  v_exp_f32 v83, v83
  v_mfma_f32_16x16x32_bf16 v[164:167], v[152:155], a[200:203], v[164:167]
  v_cvt_pk_bf16_f32 v114, v176, v177
  v_cvt_pk_bf16_f32 v115, v178, v179
  v_mfma_f32_16x16x32_bf16 v[164:167], a[252:255], a[212:215], v[164:167]
  v_add_u32 v0, s28, v2
  v_xor_b32 v1, 64, v0
  s_waitcnt lgkmcnt(0)
  s_nop 1
L_loop:
  v_mfma_f32_16x16x32_bf16 v[152:155], v[136:139], v[184:187], 0
  v_exp_f32 v160, v160
  v_mfma_f32_16x16x32_bf16 v[152:155], v[140:143], v[200:203], v[152:155]
  v_exp_f32 v161, v161
  v_mfma_f32_16x16x32_bf16 v[152:155], v[68:71], v[216:219], v[152:155]
  v_cvt_pk_bf16_f32 v118, v164, v165
  v_cvt_pk_bf16_f32 v119, v166, v167
  v_mfma_f32_16x16x32_bf16 v[152:155], v[72:75], v[232:235], v[152:155]
  v_exp_f32 v162, v162
  v_mfma_f32_16x16x32_bf16 v[152:155], v[120:123], v[248:251], v[152:155]
  v_exp_f32 v163, v163
  v_mfma_f32_16x16x32_bf16 v[152:155], v[124:127], a[224:227], v[152:155]
  v_exp_f32 v156, v156
  v_mfma_f32_16x16x32_bf16 v[148:151], v[124:127], a[228:231], 0
  v_exp_f32 v157, v157
  v_mfma_f32_16x16x32_bf16 v[148:151], v[120:123], v[252:255], v[148:151]
  v_exp_f32 v158, v158
  v_mfma_f32_16x16x32_bf16 v[148:151], v[72:75], v[236:239], v[148:151]
  ds_read_b128 v[164:167], v4 offset:0
  v_cvt_pk_bf16_f32 v76, v76, v77
  v_mfma_f32_16x16x32_bf16 v[148:151], v[68:71], v[220:223], v[148:151]
  ds_read_b128 v[168:171], v4 offset:4096
  v_cvt_pk_bf16_f32 v77, v78, v79
  v_mfma_f32_16x16x32_bf16 v[148:151], v[140:143], v[204:207], v[148:151]
  ds_read_b128 v[172:175], v4 offset:8192
  v_cvt_pk_bf16_f32 v78, v80, v81
  v_mfma_f32_16x16x32_bf16 v[148:151], v[136:139], v[188:191], v[148:151]
  ds_read_b128 v[176:179], v4 offset:12288
  v_cvt_pk_bf16_f32 v79, v82, v83
  v_mfma_f32_16x16x32_bf16 v[180:183], v[136:139], v[192:195], 0
  ds_read_b128 a[244:247], v4 offset:16384
  v_cvt_pk_bf16_f32 v80, v160, v161
  v_mfma_f32_16x16x32_bf16 v[180:183], v[140:143], v[208:211], v[180:183]
  ds_read_b128 v[144:147], v4 offset:20480
  v_cvt_pk_bf16_f32 v81, v162, v163
  v_mfma_f32_16x16x32_bf16 v[180:183], v[68:71], v[224:227], v[180:183]
  v_cvt_pk_bf16_f32 v152, v152, v148
  v_cvt_pk_bf16_f32 v153, v153, v149
  v_mfma_f32_16x16x32_bf16 v[180:183], v[72:75], v[240:243], v[180:183]
  v_cvt_pk_bf16_f32 v154, v154, v150
  v_cvt_pk_bf16_f32 v155, v155, v151
  v_mfma_f32_16x16x32_bf16 v[180:183], v[120:123], a[216:219], v[180:183]
  buffer_store_dword v152, v7, s[24:27], s33 offen offset:0 nt
  v_mfma_f32_16x16x32_bf16 v[180:183], v[124:127], a[232:235], v[180:183]
  v_exp_f32 v159, v159
  v_mfma_f32_16x16x32_bf16 v[160:163], v[124:127], a[236:239], 0
  v_cvt_pk_bf16_f32 v82, v156, v157
  v_cvt_pk_bf16_f32 v83, v158, v159
  v_mfma_f32_16x16x32_bf16 v[160:163], v[120:123], a[220:223], v[160:163]
  buffer_store_dword v153, v7, s[24:27], s33 offen offset:384 nt
  v_mfma_f32_16x16x32_bf16 v[160:163], v[72:75], v[244:247], v[160:163]
  ds_read_b128 v[156:159], v3 offset:512
  v_mfma_f32_16x16x32_bf16 v[160:163], v[68:71], v[228:231], v[160:163]
  ds_read_b128 a[248:251], v3 offset:4608
  v_mfma_f32_16x16x32_bf16 v[160:163], v[140:143], v[212:215], v[160:163]
  buffer_store_dword v154, v7, s[24:27], s33 offen offset:768 nt
  v_mfma_f32_16x16x32_bf16 v[160:163], v[136:139], v[196:199], v[160:163]
  s_waitcnt lgkmcnt(2)
  ds_read_b128 a[252:255], v3 offset:8704
  v_mfma_f32_16x16x32_bf16 v[124:127], v[164:167], v[184:187], 0
  ds_read_b128 v[68:71], v3 offset:12800
  v_mfma_f32_16x16x32_bf16 v[124:127], v[168:171], v[200:203], v[124:127]
  buffer_store_dword v155, v7, s[24:27], s33 offen offset:1152 nt
  v_mfma_f32_16x16x32_bf16 v[124:127], v[172:175], v[216:219], v[124:127]
  v_cvt_pk_bf16_f32 v180, v180, v160
  v_cvt_pk_bf16_f32 v181, v181, v161
  v_mfma_f32_16x16x32_bf16 v[124:127], v[176:179], v[232:235], v[124:127]
  v_cvt_pk_bf16_f32 v182, v182, v162
  v_cvt_pk_bf16_f32 v183, v183, v163
  v_mfma_f32_16x16x32_bf16 v[124:127], a[244:247], v[248:251], v[124:127]
  buffer_store_dword v180, v8, s[24:27], s33 offen offset:0 nt
  v_mfma_f32_16x16x32_bf16 v[124:127], v[144:147], a[224:227], v[124:127]
  ds_read_b128 v[72:75], v3 offset:16896
  v_mfma_f32_16x16x32_bf16 v[120:123], v[144:147], a[228:231], 0
  ds_read_b128 v[140:143], v3 offset:20992
  v_xor_b32 v3, 40960, v3
  v_mfma_f32_16x16x32_bf16 v[120:123], a[244:247], v[252:255], v[120:123]
  buffer_store_dword v181, v8, s[24:27], s33 offen offset:384 nt
  v_mfma_f32_16x16x32_bf16 v[120:123], v[176:179], v[236:239], v[120:123]
  v_exp_f32 v100, v100
  v_mfma_f32_16x16x32_bf16 v[120:123], v[172:175], v[220:223], v[120:123]
  v_exp_f32 v101, v101
  v_mfma_f32_16x16x32_bf16 v[120:123], v[168:171], v[204:207], v[120:123]
  buffer_store_dword v182, v8, s[24:27], s33 offen offset:768 nt
  v_mfma_f32_16x16x32_bf16 v[120:123], v[164:167], v[188:191], v[120:123]
  s_waitcnt lgkmcnt(0)
  v_exp_f32 v102, v102
  v_mfma_f32_16x16x32_bf16 v[136:139], v[156:159], v[184:187], 0
  v_exp_f32 v103, v103
  v_mfma_f32_16x16x32_bf16 v[136:139], a[248:251], v[200:203], v[136:139]
  buffer_store_dword v183, v8, s[24:27], s33 offen offset:1152 nt
  v_mfma_f32_16x16x32_bf16 v[136:139], a[252:255], v[216:219], v[136:139]
  v_cvt_pk_bf16_f32 v124, v124, v120
  v_cvt_pk_bf16_f32 v125, v125, v121
  v_mfma_f32_16x16x32_bf16 v[136:139], v[68:71], v[232:235], v[136:139]
  v_cvt_pk_bf16_f32 v126, v126, v122
  v_cvt_pk_bf16_f32 v127, v127, v123
  v_mfma_f32_16x16x32_bf16 v[136:139], v[72:75], v[248:251], v[136:139]
  buffer_store_dword v124, v7, s[24:27], s34 offen offset:0 nt
  v_mfma_f32_16x16x32_bf16 v[136:139], v[140:143], a[224:227], v[136:139]
  v_exp_f32 v104, v104
  v_mfma_f32_16x16x32_bf16 v[160:163], v[140:143], a[228:231], 0
  v_exp_f32 v105, v105
  v_mfma_f32_16x16x32_bf16 v[160:163], v[72:75], v[252:255], v[160:163]
  buffer_store_dword v125, v7, s[24:27], s34 offen offset:384 nt
  v_mfma_f32_16x16x32_bf16 v[160:163], v[68:71], v[236:239], v[160:163]
  ds_read_b128 v[120:123], v4 offset:512
  v_cvt_pk_bf16_f32 v100, v100, v101
  v_mfma_f32_16x16x32_bf16 v[160:163], a[252:255], v[220:223], v[160:163]
  ds_read_b128 v[144:147], v4 offset:4608
  v_cvt_pk_bf16_f32 v101, v102, v103
  v_mfma_f32_16x16x32_bf16 v[160:163], a[248:251], v[204:207], v[160:163]
  buffer_store_dword v126, v7, s[24:27], s34 offen offset:768 nt
  v_mfma_f32_16x16x32_bf16 v[160:163], v[156:159], v[188:191], v[160:163]
  ds_read_b128 v[152:155], v4 offset:8704
  v_cvt_pk_bf16_f32 v102, v104, v105
  v_mfma_f32_16x16x32_bf16 v[148:151], v[156:159], v[192:195], 0
  ds_read_b128 a[244:247], v4 offset:12800
  v_mfma_f32_16x16x32_bf16 v[148:151], a[248:251], v[208:211], v[148:151]
  buffer_store_dword v127, v7, s[24:27], s34 offen offset:1152 nt
  v_mfma_f32_16x16x32_bf16 v[148:151], a[252:255], v[224:227], v[148:151]
  v_cvt_pk_bf16_f32 v136, v136, v160
  v_cvt_pk_bf16_f32 v137, v137, v161
  v_mfma_f32_16x16x32_bf16 v[148:151], v[68:71], v[240:243], v[148:151]
  v_cvt_pk_bf16_f32 v138, v138, v162
  v_cvt_pk_bf16_f32 v139, v139, v163
  v_mfma_f32_16x16x32_bf16 v[148:151], v[72:75], a[216:219], v[148:151]
  buffer_store_dword v136, v7, s[24:27], s35 offen offset:0 nt
  v_mfma_f32_16x16x32_bf16 v[148:151], v[140:143], a[232:235], v[148:151]
  ds_read_b128 v[124:127], v4 offset:16896
  v_mfma_f32_16x16x32_bf16 v[164:167], v[140:143], a[236:239], 0
  ds_read_b128 v[160:163], v4 offset:20992
  v_xor_b32 v4, 40960, v4
  v_mfma_f32_16x16x32_bf16 v[164:167], v[72:75], a[220:223], v[164:167]
  buffer_store_dword v137, v7, s[24:27], s35 offen offset:384 nt
  v_mfma_f32_16x16x32_bf16 v[164:167], v[68:71], v[244:247], v[164:167]
  v_exp_f32 v106, v106
  v_mfma_f32_16x16x32_bf16 v[164:167], a[252:255], v[228:231], v[164:167]
  v_exp_f32 v107, v107
  v_mfma_f32_16x16x32_bf16 v[164:167], a[248:251], v[212:215], v[164:167]
  buffer_store_dword v138, v7, s[24:27], s35 offen offset:768 nt
  v_mfma_f32_16x16x32_bf16 v[164:167], v[156:159], v[196:199], v[164:167]
  s_waitcnt lgkmcnt(0)
  v_exp_f32 v132, v132
  v_mfma_f32_16x16x32_bf16 v[140:143], v[120:123], v[184:187], 0
  v_exp_f32 v133, v133
  v_mfma_f32_16x16x32_bf16 v[140:143], v[144:147], v[200:203], v[140:143]
  buffer_store_dword v139, v7, s[24:27], s35 offen offset:1152 nt
  v_mfma_f32_16x16x32_bf16 v[140:143], v[152:155], v[216:219], v[140:143]
  v_cvt_pk_bf16_f32 v148, v148, v164
  v_cvt_pk_bf16_f32 v149, v149, v165
  v_mfma_f32_16x16x32_bf16 v[140:143], a[244:247], v[232:235], v[140:143]
  v_cvt_pk_bf16_f32 v150, v150, v166
  v_cvt_pk_bf16_f32 v151, v151, v167
  v_mfma_f32_16x16x32_bf16 v[140:143], v[124:127], v[248:251], v[140:143]
  buffer_store_dword v148, v8, s[24:27], s35 offen offset:0 nt
  v_mfma_f32_16x16x32_bf16 v[140:143], v[160:163], a[224:227], v[140:143]
  v_mov_b64 v[172:173], 0
  v_cvt_pk_bf16_f32 v103, v106, v107
  v_mfma_f32_16x16x32_bf16 v[136:139], v[160:163], a[228:231], 0
  v_exp_f32 v134, v134
  v_mfma_f32_16x16x32_bf16 v[136:139], v[124:127], v[252:255], v[136:139]
  buffer_store_dword v149, v8, s[24:27], s35 offen offset:384 nt
  v_mfma_f32_16x16x32_bf16 v[136:139], a[244:247], v[236:239], v[136:139]
  v_exp_f32 v135, v135
  v_mfma_f32_16x16x32_bf16 v[136:139], v[152:155], v[220:223], v[136:139]
  v_mov_b64 v[72:73], 0
  v_cvt_pk_bf16_f32 v104, v132, v133
  v_mfma_f32_16x16x32_bf16 v[136:139], v[144:147], v[204:207], v[136:139]
  buffer_store_dword v150, v8, s[24:27], s35 offen offset:768 nt
  v_mfma_f32_16x16x32_bf16 v[136:139], v[120:123], v[188:191], v[136:139]
  v_exp_f32 v128, v128
  v_smfmac_f32_16x16x64_bf16 v[172:175], a[240:243], v[92:99], v10
  v_exp_f32 v129, v129
  v_mfma_f32_16x16x32_bf16 v[176:179], v[108:111], v[96:99], 0
  buffer_store_dword v151, v8, s[24:27], s35 offen offset:1152 nt
  v_mfma_f32_16x16x32_bf16 v[176:179], v[56:59], v[92:95], v[176:179]
  v_cvt_pk_bf16_f32 v140, v140, v136
  v_cvt_pk_bf16_f32 v141, v141, v137
  v_mfma_f32_16x16x32_bf16 v[168:171], v[60:63], v[92:95], 0
  v_cvt_pk_bf16_f32 v142, v142, v138
  v_cvt_pk_bf16_f32 v143, v143, v139
  v_mfma_f32_16x16x32_bf16 v[168:171], v[112:115], v[96:99], v[168:171]
  buffer_store_dword v140, v7, s[24:27], s36 offen offset:0 nt
  v_mfma_f32_16x16x32_bf16 v[68:71], v[116:119], v[96:99], 0
  v_mov_b64 v[124:125], 0
  v_cvt_pk_bf16_f32 v105, v134, v135
  v_mfma_f32_16x16x32_bf16 v[68:71], v[64:67], v[92:95], v[68:71]
  v_exp_f32 v130, v130
  v_smfmac_f32_16x16x64_bf16 v[72:75], a[240:243], v[84:91], v10
  buffer_store_dword v141, v7, s[24:27], s36 offen offset:384 nt
  v_mfma_f32_16x16x32_bf16 v[164:167], v[108:111], v[88:91], 0
  v_exp_f32 v131, v131
  v_mfma_f32_16x16x32_bf16 v[164:167], v[56:59], v[84:87], v[164:167]
  v_cvt_pk_bf16_f32 v106, v128, v129
  v_cvt_pk_bf16_f32 v107, v130, v131
  v_mfma_f32_16x16x32_bf16 v[144:147], v[60:63], v[84:87], 0
  buffer_store_dword v142, v7, s[24:27], s36 offen offset:768 nt
  v_mfma_f32_16x16x32_bf16 v[144:147], v[112:115], v[88:91], v[144:147]
  v_mov_b64 v[92:93], 0
  v_add_f32 v172, v172, v173
  v_mfma_f32_16x16x32_bf16 v[132:135], v[116:119], v[88:91], 0
  ds_read_b128 v[136:139], v0 offset:0
  v_add_f32 v72, v72, v73
  v_mfma_f32_16x16x32_bf16 v[132:135], v[64:67], v[84:87], v[132:135]
  buffer_store_dword v143, v7, s[24:27], s36 offen offset:1152 nt
  v_smfmac_f32_16x16x64_bf16 v[124:127], a[240:243], v[76:83], v10
  ds_read_b128 v[152:155], v1 offset:0
  v_cndmask_b32 v7, v7, v52, s[62:63]
  v_mfma_f32_16x16x32_bf16 v[128:131], v[56:59], v[80:83], 0
  ds_read_b128 v[156:159], v0 offset:8192
  v_cndmask_b32 v8, v8, v53, s[62:63]
  v_mfma_f32_16x16x32_bf16 v[128:131], v[108:111], v[76:79], v[128:131]
  s_mov_b64 s[62:63], 0
  ds_read_b128 v[160:163], v1 offset:8192
  v_mfma_f32_16x16x32_bf16 v[120:123], v[112:115], v[76:79], 0
  ds_read_b128 v[148:151], v0 offset:16384
  v_mfma_f32_16x16x32_bf16 v[120:123], v[60:63], v[80:83], v[120:123]
  ds_read_b128 v[140:143], v1 offset:16384
  v_mfma_f32_16x16x32_bf16 v[96:99], v[64:67], v[80:83], 0
  v_rcp_f32 v174, v172
  v_mfma_f32_16x16x32_bf16 v[96:99], v[116:119], v[76:79], v[96:99]
  v_mul_f32 v176, v174, v176
  v_mul_f32 v177, v174, v177
  v_smfmac_f32_16x16x64_bf16 v[92:95], a[240:243], v[100:107], v10
  v_mul_f32 v178, v174, v178
  v_mul_f32 v179, v174, v179
  v_mfma_f32_16x16x32_bf16 v[88:91], v[56:59], v[104:107], 0
  v_cvt_pk_bf16_f32 v176, v176, v177
  v_cvt_pk_bf16_f32 v177, v178, v179
  v_mfma_f32_16x16x32_bf16 v[88:91], v[108:111], v[100:103], v[88:91]
  v_mul_f32 v168, v174, v168
  v_mul_f32 v169, v174, v169
  v_mfma_f32_16x16x32_bf16 v[80:83], v[112:115], v[100:103], 0
  v_mul_f32 v170, v174, v170
  v_mul_f32 v171, v174, v171
  v_mfma_f32_16x16x32_bf16 v[80:83], v[60:63], v[104:107], v[80:83]
  v_cvt_pk_bf16_f32 v168, v168, v169
  v_cvt_pk_bf16_f32 v169, v170, v171
  v_mfma_f32_16x16x32_bf16 v[84:87], v[64:67], v[104:107], 0
  v_mul_f32 v68, v174, v68
  v_mul_f32 v69, v174, v69
  v_mfma_f32_16x16x32_bf16 v[84:87], v[116:119], v[100:103], v[84:87]
  s_waitcnt lgkmcnt(0)
  v_mul_f32 v70, v174, v70
  v_mul_f32 v71, v174, v71
  v_mfma_f32_16x16x32_bf16 v[64:67], a[0:3], v[136:139], 0
  v_cvt_pk_bf16_f32 v68, v68, v69
  v_cvt_pk_bf16_f32 v69, v70, v71
  v_mfma_f32_16x16x32_bf16 v[64:67], a[12:15], v[152:155], v[64:67]
  v_max3_f32 v9, v172, v174, v9
  v_add_f32 v124, v124, v125
  v_mfma_f32_16x16x32_bf16 v[64:67], a[24:27], v[156:159], v[64:67]
  ds_write_b32 v5, v176 offset:0
  v_mfma_f32_16x16x32_bf16 v[64:67], a[36:39], v[160:163], v[64:67]
  v_rcp_f32 v74, v72
  v_mfma_f32_16x16x32_bf16 v[64:67], a[48:51], v[148:151], v[64:67]
  s_add_u32 m0, s30, 0
  v_mul_f32 v164, v74, v164
  v_mul_f32 v165, v74, v165
  v_mfma_f32_16x16x32_bf16 v[64:67], a[60:63], v[140:143], v[64:67]
  buffer_load_dwordx4 v6, s[8:11], s31 offen offset:0 nt lds
  v_mfma_f32_16x16x32_bf16 v[60:63], a[64:67], v[140:143], 0
  v_mul_f32 v166, v74, v166
  v_mul_f32 v167, v74, v167
  v_mfma_f32_16x16x32_bf16 v[60:63], a[52:55], v[148:151], v[60:63]
  ds_write_b32 v5, v177 offset:1024
  v_mfma_f32_16x16x32_bf16 v[60:63], a[40:43], v[160:163], v[60:63]
  v_mul_f32 v64, s42, v64
  v_mul_f32 v65, s42, v65
  v_mfma_f32_16x16x32_bf16 v[60:63], a[28:31], v[156:159], v[60:63]
  v_mul_f32 v66, s42, v66
  v_mul_f32 v67, s42, v67
  v_mfma_f32_16x16x32_bf16 v[60:63], a[16:19], v[152:155], v[60:63]
  v_cvt_pk_bf16_f32 v12, v64, v65
  v_cvt_pk_bf16_f32 v13, v66, v67
  v_mfma_f32_16x16x32_bf16 v[60:63], a[4:7], v[136:139], v[60:63]
  ds_write_b32 v5, v168 offset:2048
  v_mfma_f32_16x16x32_bf16 v[56:59], a[8:11], v[136:139], 0
  v_cvt_pk_bf16_f32 v164, v164, v165
  v_cvt_pk_bf16_f32 v165, v166, v167
  v_mfma_f32_16x16x32_bf16 v[56:59], a[20:23], v[152:155], v[56:59]
  ds_write_b32 v5, v169 offset:3072
  v_mfma_f32_16x16x32_bf16 v[56:59], a[32:35], v[156:159], v[56:59]
  v_mul_f32 v60, s42, v60
  v_mul_f32 v61, s42, v61
  v_mfma_f32_16x16x32_bf16 v[56:59], a[44:47], v[160:163], v[56:59]
  v_mul_f32 v62, s42, v62
  v_mul_f32 v63, s42, v63
  v_mfma_f32_16x16x32_bf16 v[56:59], a[56:59], v[148:151], v[56:59]
  s_add_u32 m0, s30, 8064
  v_cvt_pk_bf16_f32 v76, v60, v61
  v_cvt_pk_bf16_f32 v77, v62, v63
  v_mfma_f32_16x16x32_bf16 v[56:59], a[68:71], v[140:143], v[56:59]
  buffer_load_dwordx4 v6, s[8:11], s31 offen offset:128 nt lds
  v_mfma_f32_16x16x32_bf16 v[64:67], a[132:135], v[140:143], 0
  v_mul_f32 v144, v74, v144
  v_mul_f32 v145, v74, v145
  v_mfma_f32_16x16x32_bf16 v[64:67], a[120:123], v[148:151], v[64:67]
  ds_write_b32 v5, v68 offset:4096
  v_mfma_f32_16x16x32_bf16 v[64:67], a[108:111], v[160:163], v[64:67]
  ds_write_b32 v5, v69 offset:5120
  v_mfma_f32_16x16x32_bf16 v[64:67], a[96:99], v[156:159], v[64:67]
  v_mul_f32 v56, s42, v56
  v_mul_f32 v57, s42, v57
  v_mfma_f32_16x16x32_bf16 v[64:67], a[84:87], v[152:155], v[64:67]
  v_mul_f32 v58, s42, v58
  v_mul_f32 v59, s42, v59
  v_mfma_f32_16x16x32_bf16 v[64:67], a[72:75], v[136:139], v[64:67]
  v_cvt_pk_bf16_f32 v78, v56, v57
  v_cvt_pk_bf16_f32 v79, v58, v59
  v_mfma_f32_16x16x32_bf16 v[60:63], a[76:79], v[136:139], 0
  v_mul_f32 v146, v74, v146
  v_mul_f32 v147, v74, v147
  v_mfma_f32_16x16x32_bf16 v[60:63], a[88:91], v[152:155], v[60:63]
  v_cvt_pk_bf16_f32 v144, v144, v145
  v_cvt_pk_bf16_f32 v145, v146, v147
  v_mfma_f32_16x16x32_bf16 v[60:63], a[100:103], v[156:159], v[60:63]
  v_cvt_pk_bf16_f32 v68, v64, v65
  v_cvt_pk_bf16_f32 v69, v66, v67
  v_mfma_f32_16x16x32_bf16 v[60:63], a[112:115], v[160:163], v[60:63]
  v_mul_f32 v132, v74, v132
  v_mul_f32 v133, v74, v133
  v_mfma_f32_16x16x32_bf16 v[60:63], a[124:127], v[148:151], v[60:63]
  s_add_u32 m0, s30, 16128
  v_mul_f32 v134, v74, v134
  v_mul_f32 v135, v74, v135
  v_mfma_f32_16x16x32_bf16 v[60:63], a[136:139], v[140:143], v[60:63]
  buffer_load_dwordx4 v6, s[8:11], s31 offen offset:256 nt lds
  v_mfma_f32_16x16x32_bf16 v[56:59], a[140:143], v[140:143], 0
  v_cvt_pk_bf16_f32 v132, v132, v133
  v_cvt_pk_bf16_f32 v133, v134, v135
  v_mfma_f32_16x16x32_bf16 v[56:59], a[128:131], v[148:151], v[56:59]
  v_max3_f32 v9, v72, v74, v9
  v_add_f32 v92, v92, v93
  v_mfma_f32_16x16x32_bf16 v[56:59], a[116:119], v[160:163], v[56:59]
  v_cvt_pk_bf16_f32 v70, v60, v61
  v_cvt_pk_bf16_f32 v71, v62, v63
  v_mfma_f32_16x16x32_bf16 v[56:59], a[104:107], v[156:159], v[56:59]
  ds_write_b32 v5, v164 offset:256
  v_mfma_f32_16x16x32_bf16 v[56:59], a[92:95], v[152:155], v[56:59]
  v_rcp_f32 v126, v124
  v_mfma_f32_16x16x32_bf16 v[56:59], a[80:83], v[136:139], v[56:59]
  ds_write_b32 v5, v165 offset:1280
  v_mfma_f32_16x16x32_bf16 v[60:63], v[136:139], a[144:147], 0
  v_mul_f32 v128, v126, v128
  v_mul_f32 v129, v126, v129
  v_mfma_f32_16x16x32_bf16 v[60:63], v[152:155], a[156:159], v[60:63]
  ds_write_b32 v5, v144 offset:2304
  v_mfma_f32_16x16x32_bf16 v[60:63], v[156:159], a[168:171], v[60:63]
  v_cvt_pk_bf16_f32 v72, v56, v57
  v_cvt_pk_bf16_f32 v73, v58, v59
  v_mfma_f32_16x16x32_bf16 v[60:63], v[160:163], a[180:183], v[60:63]
  ds_read_b128 a[244:247], v0 offset:2048
  v_mul_f32 v130, v126, v130
  v_mfma_f32_16x16x32_bf16 v[60:63], v[148:151], a[192:195], v[60:63]
  s_add_u32 m0, s30, 4096
  ds_read_b128 a[248:251], v1 offset:2048
  v_mul_f32 v131, v126, v131
  v_mfma_f32_16x16x32_bf16 v[60:63], v[140:143], a[204:207], v[60:63]
  buffer_load_dwordx4 v6, s[8:11], s32 offen offset:0 nt lds
  v_mfma_f32_16x16x32_bf16 v[64:67], v[140:143], a[208:211], 0
  ds_read_b128 a[252:255], v0 offset:10240
  v_cvt_pk_bf16_f32 v128, v128, v129
  v_mfma_f32_16x16x32_bf16 v[64:67], v[148:151], a[196:199], v[64:67]
  ds_read_b128 v[104:107], v1 offset:10240
  v_cvt_pk_bf16_f32 v129, v130, v131
  v_mfma_f32_16x16x32_bf16 v[64:67], v[160:163], a[184:187], v[64:67]
  v_cvt_pk_bf16_f32 v56, v60, v61
  v_cvt_pk_bf16_f32 v57, v62, v63
  v_mfma_f32_16x16x32_bf16 v[64:67], v[156:159], a[172:175], v[64:67]
  ds_write_b32 v5, v145 offset:3328
  v_mfma_f32_16x16x32_bf16 v[64:67], v[152:155], a[160:163], v[64:67]
  v_mul_f32 v120, v126, v120
  v_mul_f32 v121, v126, v121
  v_mfma_f32_16x16x32_bf16 v[64:67], v[136:139], a[148:151], v[64:67]
  ds_write_b32 v5, v132 offset:4352
  v_mfma_f32_16x16x32_bf16 v[100:103], v[136:139], a[152:155], 0
  ds_write_b32 v5, v133 offset:5376
  v_mfma_f32_16x16x32_bf16 v[100:103], v[152:155], a[164:167], v[100:103]
  v_mul_f32 v122, v126, v122
  v_mul_f32 v123, v126, v123
  v_mfma_f32_16x16x32_bf16 v[100:103], v[156:159], a[176:179], v[100:103]
  ds_read_b128 v[108:111], v0 offset:18432
  v_cvt_pk_bf16_f32 v60, v64, v65
  v_mfma_f32_16x16x32_bf16 v[100:103], v[160:163], a[188:191], v[100:103]
  s_waitcnt lgkmcnt(4)
  ds_read_b128 v[112:115], v1 offset:18432
  v_cvt_pk_bf16_f32 v61, v66, v67
  v_mfma_f32_16x16x32_bf16 v[100:103], v[148:151], a[200:203], v[100:103]
  s_add_u32 m0, s30, 12160
  v_cvt_pk_bf16_f32 v120, v120, v121
  v_cvt_pk_bf16_f32 v121, v122, v123
  v_mfma_f32_16x16x32_bf16 v[100:103], v[140:143], a[212:215], v[100:103]
  buffer_load_dwordx4 v6, s[8:11], s32 offen offset:128 nt lds
  v_mfma_f32_16x16x32_bf16 v[136:139], a[0:3], a[244:247], 0
  v_mul_f32 v96, v126, v96
  v_mul_f32 v97, v126, v97
  v_mfma_f32_16x16x32_bf16 v[136:139], a[12:15], a[248:251], v[136:139]
  v_mul_f32 v98, v126, v98
  v_mul_f32 v99, v126, v99
  v_mfma_f32_16x16x32_bf16 v[136:139], a[24:27], a[252:255], v[136:139]
  v_cvt_pk_bf16_f32 v64, v100, v101
  v_cvt_pk_bf16_f32 v65, v102, v103
  v_mfma_f32_16x16x32_bf16 v[136:139], a[36:39], v[104:107], v[136:139]
  s_waitcnt lgkmcnt(0)
  v_cvt_pk_bf16_f32 v96, v96, v97
  v_cvt_pk_bf16_f32 v97, v98, v99
  v_mfma_f32_16x16x32_bf16 v[136:139], a[48:51], v[108:111], v[136:139]
  v_max3_f32 v9, v124, v126, v9
  v_mfma_f32_16x16x32_bf16 v[136:139], a[60:63], v[112:115], v[136:139]
  ds_write_b32 v5, v128 offset:512
  v_mfma_f32_16x16x32_bf16 v[132:135], a[64:67], v[112:115], 0
  v_rcp_f32 v94, v92
  v_mfma_f32_16x16x32_bf16 v[132:135], a[52:55], v[108:111], v[132:135]
  ds_write_b32 v5, v129 offset:1536
  v_mfma_f32_16x16x32_bf16 v[132:135], a[40:43], v[104:107], v[132:135]
  v_mul_f32 v136, s42, v136
  v_mul_f32 v137, s42, v137
  v_mfma_f32_16x16x32_bf16 v[132:135], a[28:31], a[252:255], v[132:135]
  v_mul_f32 v138, s42, v138
  v_mul_f32 v139, s42, v139
  v_mfma_f32_16x16x32_bf16 v[132:135], a[16:19], a[248:251], v[132:135]
  s_add_u32 m0, s30, 20224
  v_cvt_pk_bf16_f32 v100, v136, v137
  v_cvt_pk_bf16_f32 v101, v138, v139
  v_mfma_f32_16x16x32_bf16 v[132:135], a[4:7], a[244:247], v[132:135]
  buffer_load_dwordx4 v6, s[8:11], s32 offen offset:256 nt lds
  v_mfma_f32_16x16x32_bf16 v[116:119], a[8:11], a[244:247], 0
  s_add_u32 s33, s31, s37
  v_mul_f32 v88, v94, v88
  v_mul_f32 v89, v94, v89
  v_mfma_f32_16x16x32_bf16 v[116:119], a[20:23], a[248:251], v[116:119]
  s_add_u32 s34, s31, s38
  ds_write_b32 v5, v120 offset:2560
  v_mfma_f32_16x16x32_bf16 v[116:119], a[32:35], a[252:255], v[116:119]
  s_add_u32 s35, s31, s39
  v_mul_f32 v132, s42, v132
  v_mul_f32 v133, s42, v133
  v_mfma_f32_16x16x32_bf16 v[116:119], a[44:47], v[104:107], v[116:119]
  s_add_u32 s36, s31, s40
  v_mul_f32 v134, s42, v134
  v_mul_f32 v135, s42, v135
  v_mfma_f32_16x16x32_bf16 v[116:119], a[56:59], v[108:111], v[116:119]
  s_add_u32 s31, s31, s43
  v_cvt_pk_bf16_f32 v102, v132, v133
  v_cvt_pk_bf16_f32 v103, v134, v135
  v_mfma_f32_16x16x32_bf16 v[116:119], a[68:71], v[112:115], v[116:119]
  s_add_u32 s32, s32, s43
  ds_write_b32 v5, v121 offset:3584
  v_mfma_f32_16x16x32_bf16 v[124:127], a[132:135], v[112:115], 0
  s_mov_b32 s5, s28
  v_mul_f32 v90, v94, v90
  v_mul_f32 v91, v94, v91
  v_mfma_f32_16x16x32_bf16 v[124:127], a[120:123], v[108:111], v[124:127]
  s_mov_b32 s28, s29
  ds_write_b32 v5, v96 offset:4608
  v_mfma_f32_16x16x32_bf16 v[124:127], a[108:111], v[104:107], v[124:127]
  s_mov_b32 s29, s30
  v_mul_f32 v116, s42, v116
  v_mul_f32 v117, s42, v117
  v_mfma_f32_16x16x32_bf16 v[124:127], a[96:99], a[252:255], v[124:127]
  s_mov_b32 s30, s5
  ds_write_b32 v5, v97 offset:5632
  v_mfma_f32_16x16x32_bf16 v[124:127], a[84:87], a[248:251], v[124:127]
  v_mul_f32 v118, s42, v118
  v_mul_f32 v119, s42, v119
  v_mfma_f32_16x16x32_bf16 v[124:127], a[72:75], a[244:247], v[124:127]
  v_cvt_pk_bf16_f32 v16, v116, v117
  v_cvt_pk_bf16_f32 v17, v118, v119
  v_mfma_f32_16x16x32_bf16 v[96:99], a[76:79], a[244:247], 0
  v_cvt_pk_bf16_f32 v88, v88, v89
  v_cvt_pk_bf16_f32 v89, v90, v91
  v_mfma_f32_16x16x32_bf16 v[96:99], a[88:91], a[248:251], v[96:99]
  v_mul_f32 v80, v94, v80
  v_mul_f32 v81, v94, v81
  v_mfma_f32_16x16x32_bf16 v[96:99], a[100:103], a[252:255], v[96:99]
  s_add_u32 s59, s59, 1
  v_cvt_pk_bf16_f32 v120, v124, v125
  v_cvt_pk_bf16_f32 v121, v126, v127
  v_mfma_f32_16x16x32_bf16 v[96:99], a[112:115], v[104:107], v[96:99]
  s_cmp_eq_u32 s59, 4
  v_mul_f32 v82, v94, v82
  v_mul_f32 v83, v94, v83
  v_mfma_f32_16x16x32_bf16 v[96:99], a[124:127], v[108:111], v[96:99]
  s_cselect_b32 s18, s16, s18
  v_cvt_pk_bf16_f32 v80, v80, v81
  v_cvt_pk_bf16_f32 v81, v82, v83
  v_mfma_f32_16x16x32_bf16 v[96:99], a[136:139], v[112:115], v[96:99]
  s_cselect_b32 s15, s60, s15
  v_mul_f32 v84, v94, v84
  v_mul_f32 v85, v94, v85
  v_mfma_f32_16x16x32_bf16 v[116:119], a[140:143], v[112:115], 0
  s_cmp_eq_u32 s59, 8
  v_mul_f32 v86, v94, v86
  v_mul_f32 v87, v94, v87
  v_mfma_f32_16x16x32_bf16 v[116:119], a[128:131], v[108:111], v[116:119]
  s_cselect_b32 s19, s16, s19
  v_cvt_pk_bf16_f32 v84, v84, v85
  v_cvt_pk_bf16_f32 v85, v86, v87
  v_mfma_f32_16x16x32_bf16 v[116:119], a[116:119], v[104:107], v[116:119]
  s_cselect_b32 s99, s60, s99
  v_cvt_pk_bf16_f32 v122, v96, v97
  v_cvt_pk_bf16_f32 v123, v98, v99
  v_mfma_f32_16x16x32_bf16 v[116:119], a[104:107], a[252:255], v[116:119]
  s_memrealtime s[16:17]
  v_max3_f32 v9, v92, v94, v9
  v_mfma_f32_16x16x32_bf16 v[116:119], a[92:95], a[248:251], v[116:119]
  s_memtime s[60:61]
  ds_write_b32 v5, v88 offset:768
  v_mfma_f32_16x16x32_bf16 v[116:119], a[80:83], a[244:247], v[116:119]
  v_mfma_f32_16x16x32_bf16 v[132:135], a[244:247], a[144:147], 0
  ds_write_b32 v5, v89 offset:1792
  v_mfma_f32_16x16x32_bf16 v[132:135], a[248:251], a[156:159], v[132:135]
  v_mfma_f32_16x16x32_bf16 v[132:135], a[252:255], a[168:171], v[132:135]
  v_cvt_pk_bf16_f32 v124, v116, v117
  v_cvt_pk_bf16_f32 v125, v118, v119
  v_mfma_f32_16x16x32_bf16 v[132:135], v[104:107], a[180:183], v[132:135]
  ds_read_b128 v[88:91], v0 offset:4096
  v_mfma_f32_16x16x32_bf16 v[132:135], v[108:111], a[192:195], v[132:135]
  ds_read_b128 v[92:95], v1 offset:4096
  v_mfma_f32_16x16x32_bf16 v[132:135], v[112:115], a[204:207], v[132:135]
  ds_read_b128 v[116:119], v0 offset:12288
  v_mfma_f32_16x16x32_bf16 v[128:131], v[112:115], a[208:211], 0
  ds_read_b128 v[96:99], v1 offset:12288
  v_mfma_f32_16x16x32_bf16 v[128:131], v[108:111], a[196:199], v[128:131]
  ds_read_b128 v[136:139], v0 offset:20480
  v_mfma_f32_16x16x32_bf16 v[128:131], v[104:107], a[184:187], v[128:131]
  v_cvt_pk_bf16_f32 v58, v132, v133
  v_cvt_pk_bf16_f32 v59, v134, v135
  v_mfma_f32_16x16x32_bf16 v[128:131], a[252:255], a[172:175], v[128:131]
  ds_write_b32 v5, v80 offset:2816
  v_mfma_f32_16x16x32_bf16 v[128:131], a[248:251], a[160:163], v[128:131]
  v_mfma_f32_16x16x32_bf16 v[128:131], a[244:247], a[148:151], v[128:131]
  ds_write_b32 v5, v81 offset:3840
  v_mfma_f32_16x16x32_bf16 v[132:135], a[244:247], a[152:155], 0
  v_mfma_f32_16x16x32_bf16 v[132:135], a[248:251], a[164:167], v[132:135]
  ds_write_b32 v5, v84 offset:4864
  v_mfma_f32_16x16x32_bf16 v[132:135], a[252:255], a[176:179], v[132:135]
  ds_write_b32 v5, v85 offset:5888
  v_mfma_f32_16x16x32_bf16 v[132:135], v[104:107], a[188:191], v[132:135]
  s_waitcnt lgkmcnt(4)
  v_cvt_pk_bf16_f32 v62, v128, v129
  v_cvt_pk_bf16_f32 v63, v130, v131
  v_mfma_f32_16x16x32_bf16 v[132:135], v[108:111], a[200:203], v[132:135]
  s_bitcmp1_b32 s96, s59
  ds_read_b128 v[80:83], v1 offset:20480
  v_xor_b32 v5, s41, v5
  v_mfma_f32_16x16x32_bf16 v[132:135], v[112:115], a[212:215], v[132:135]
  s_cbranch_scc1 L_k2
L_k2r:
  v_mfma_f32_16x16x32_bf16 v[104:107], a[0:3], v[88:91], 0
L_hop_3_0:
  s_cbranch_execz L_hop_3_1
L_r208:
  v_mfma_f32_16x16x32_bf16 v[104:107], a[12:15], v[92:95], v[104:107]
L_r209:
  v_mfma_f32_16x16x32_bf16 v[104:107], a[24:27], v[116:119], v[104:107]
  v_cvt_pk_bf16_f32 v66, v132, v133
  v_cvt_pk_bf16_f32 v67, v134, v135
L_r210:
  v_mfma_f32_16x16x32_bf16 v[104:107], a[36:39], v[96:99], v[104:107]
L_r211:
  v_mfma_f32_16x16x32_bf16 v[104:107], a[48:51], v[136:139], v[104:107]
  s_waitcnt lgkmcnt(0)
L_r212:
  v_mfma_f32_16x16x32_bf16 v[104:107], a[60:63], v[80:83], v[104:107]
L_r213:
  v_mfma_f32_16x16x32_bf16 v[84:87], a[64:67], v[80:83], 0
L_r214:
  v_mfma_f32_16x16x32_bf16 v[84:87], a[52:55], v[136:139], v[84:87]
L_r215:
  v_mfma_f32_16x16x32_bf16 v[84:87], a[40:43], v[96:99], v[84:87]
  v_mul_f32 v104, s42, v104
  v_mul_f32 v105, s42, v105
L_r216:
  v_mfma_f32_16x16x32_bf16 v[84:87], a[28:31], v[116:119], v[84:87]
  v_mul_f32 v106, s42, v106
  v_mul_f32 v107, s42, v107
L_r217:
  v_mfma_f32_16x16x32_bf16 v[84:87], a[16:19], v[92:95], v[84:87]
  v_cvt_pk_bf16_f32 v18, v104, v105
  v_cvt_pk_bf16_f32 v19, v106, v107
L_r218:
  v_mfma_f32_16x16x32_bf16 v[84:87], a[4:7], v[88:91], v[84:87]
L_r219:
  v_mfma_f32_16x16x32_bf16 v[108:111], a[8:11], v[88:91], 0
L_r220:
  v_mfma_f32_16x16x32_bf16 v[108:111], a[20:23], v[92:95], v[108:111]
L_r221:
  v_mfma_f32_16x16x32_bf16 v[108:111], a[32:35], v[116:119], v[108:111]
  v_mul_f32 v84, s42, v84
  v_mul_f32 v85, s42, v85
L_r222:
  v_mfma_f32_16x16x32_bf16 v[108:111], a[44:47], v[96:99], v[108:111]
  v_mul_f32 v86, s42, v86
  v_mul_f32 v87, s42, v87
L_r223:
  v_mfma_f32_16x16x32_bf16 v[108:111], a[56:59], v[136:139], v[108:111]
  v_cvt_pk_bf16_f32 v104, v84, v85
  v_cvt_pk_bf16_f32 v105, v86, v87
L_r224:
  v_mfma_f32_16x16x32_bf16 v[108:111], a[68:71], v[80:83], v[108:111]
L_r225:
  v_mfma_f32_16x16x32_bf16 v[112:115], a[132:135], v[80:83], 0
L_r226:
  v_mfma_f32_16x16x32_bf16 v[112:115], a[120:123], v[136:139], v[112:115]
L_r227:
  v_mfma_f32_16x16x32_bf16 v[112:115], a[108:111], v[96:99], v[112:115]
  v_mul_f32 v108, s42, v108
  v_mul_f32 v109, s42, v109
L_r228:
  v_mfma_f32_16x16x32_bf16 v[112:115], a[96:99], v[116:119], v[112:115]
  v_mul_f32 v110, s42, v110
  v_mul_f32 v111, s42, v111
L_r229:
  v_mfma_f32_16x16x32_bf16 v[112:115], a[84:87], v[92:95], v[112:115]
  v_cvt_pk_bf16_f32 v106, v108, v109
  v_cvt_pk_bf16_f32 v107, v110, v111
L_r230:
  v_mfma_f32_16x16x32_bf16 v[112:115], a[72:75], v[88:91], v[112:115]
L_r231:
  v_mfma_f32_16x16x32_bf16 v[84:87], a[76:79], v[88:91], 0
L_r232:
  v_mfma_f32_16x16x32_bf16 v[84:87], a[88:91], v[92:95], v[84:87]
L_r233:
  v_mfma_f32_16x16x32_bf16 v[84:87], a[100:103], v[116:119], v[84:87]
  v_cvt_pk_bf16_f32 v128, v112, v113
  v_cvt_pk_bf16_f32 v129, v114, v115
L_r234:
  v_mfma_f32_16x16x32_bf16 v[84:87], a[112:115], v[96:99], v[84:87]
L_r235:
  v_mfma_f32_16x16x32_bf16 v[84:87], a[124:127], v[136:139], v[84:87]
L_r236:
  v_mfma_f32_16x16x32_bf16 v[84:87], a[136:139], v[80:83], v[84:87]
L_r237:
  v_mfma_f32_16x16x32_bf16 v[108:111], a[140:143], v[80:83], 0
L_r238:
  v_mfma_f32_16x16x32_bf16 v[108:111], a[128:131], v[136:139], v[108:111]
L_r239:
  v_mfma_f32_16x16x32_bf16 v[108:111], a[116:119], v[96:99], v[108:111]
  v_cvt_pk_bf16_f32 v130, v84, v85
  v_cvt_pk_bf16_f32 v131, v86, v87
L_r240:
  v_mfma_f32_16x16x32_bf16 v[108:111], a[104:107], v[116:119], v[108:111]
L_r241:
  v_mfma_f32_16x16x32_bf16 v[108:111], a[92:95], v[92:95], v[108:111]
L_r242:
  v_mfma_f32_16x16x32_bf16 v[108:111], a[80:83], v[88:91], v[108:111]
L_r243:
  v_mfma_f32_16x16x32_bf16 v[84:87], v[88:91], a[144:147], 0
L_r244:
  v_mfma_f32_16x16x32_bf16 v[84:87], v[92:95], a[156:159], v[84:87]
L_r245:
  v_mfma_f32_16x16x32_bf16 v[84:87], v[116:119], a[168:171], v[84:87]
  v_cvt_pk_bf16_f32 v132, v108, v109
  v_cvt_pk_bf16_f32 v133, v110, v111
L_r246:
  v_mfma_f32_16x16x32_bf16 v[84:87], v[96:99], a[180:183], v[84:87]
  ds_read_b128 a[244:247], v1 offset:22528
L_r247:
  v_mfma_f32_16x16x32_bf16 v[84:87], v[136:139], a[192:195], v[84:87]
  ds_read_b128 a[248:251], v0 offset:22528
L_r248:
  v_mfma_f32_16x16x32_bf16 v[84:87], v[80:83], a[204:207], v[84:87]
  ds_read_b128 a[252:255], v1 offset:14336
L_r249:
  v_mfma_f32_16x16x32_bf16 v[140:143], v[80:83], a[208:211], 0
  ds_read_b128 v[144:147], v0 offset:14336
L_r250:
  v_mfma_f32_16x16x32_bf16 v[140:143], v[136:139], a[196:199], v[140:143]
  ds_read_b128 v[148:151], v1 offset:6144
L_r251:
  v_mfma_f32_16x16x32_bf16 v[140:143], v[96:99], a[184:187], v[140:143]
  v_cvt_pk_bf16_f32 v108, v84, v85
  v_cvt_pk_bf16_f32 v109, v86, v87
L_r252:
  v_mfma_f32_16x16x32_bf16 v[140:143], v[116:119], a[172:175], v[140:143]
  ds_read_b128 v[152:155], v0 offset:6144
L_r253:
  v_mfma_f32_16x16x32_bf16 v[140:143], v[92:95], a[160:163], v[140:143]
L_r254:
  v_mfma_f32_16x16x32_bf16 v[140:143], v[88:91], a[148:151], v[140:143]
L_r255:
  v_mfma_f32_16x16x32_bf16 v[156:159], v[88:91], a[152:155], 0
L_r256:
  v_mfma_f32_16x16x32_bf16 v[156:159], v[92:95], a[164:167], v[156:159]
L_r257:
  v_mfma_f32_16x16x32_bf16 v[156:159], v[116:119], a[176:179], v[156:159]
  v_cvt_pk_bf16_f32 v112, v140, v141
  v_cvt_pk_bf16_f32 v113, v142, v143
L_r258:
  v_mfma_f32_16x16x32_bf16 v[156:159], v[96:99], a[188:191], v[156:159]
L_r259:
  v_mfma_f32_16x16x32_bf16 v[156:159], v[136:139], a[200:203], v[156:159]
  buffer_load_dwordx2 v[52:53], v11, s[20:23], s44 offen sc1
  v_mfma_f32_16x16x32_bf16 v[156:159], v[80:83], a[212:215], v[156:159]
  s_waitcnt lgkmcnt(0)
  v_mfma_f32_16x16x32_bf16 v[84:87], a[132:135], a[244:247], 0
  v_mfma_f32_16x16x32_bf16 v[84:87], a[120:123], a[248:251], v[84:87]
  v_mfma_f32_16x16x32_bf16 v[84:87], a[108:111], a[252:255], v[84:87]
  v_cvt_pk_bf16_f32 v116, v156, v157
  v_cvt_pk_bf16_f32 v117, v158, v159
  v_mfma_f32_16x16x32_bf16 v[84:87], a[96:99], v[144:147], v[84:87]
  v_mfma_f32_16x16x32_bf16 v[84:87], a[84:87], v[148:151], v[84:87]
  s_waitcnt vmcnt(31)
  s_barrier
  v_mfma_f32_16x16x32_bf16 v[84:87], a[72:75], v[152:155], v[84:87]
  v_add_u32 v0, s28, v2
  v_xor_b32 v1, 64, v0
  v_mfma_f32_16x16x32_bf16 v[80:83], a[76:79], v[152:155], 0
  v_mfma_f32_16x16x32_bf16 v[80:83], a[88:91], v[148:151], v[80:83]
  v_mfma_f32_16x16x32_bf16 v[80:83], a[100:103], v[144:147], v[80:83]
  v_cvt_pk_bf16_f32 v136, v84, v85
  v_cvt_pk_bf16_f32 v137, v86, v87
  v_mfma_f32_16x16x32_bf16 v[80:83], a[112:115], a[252:255], v[80:83]
  v_mfma_f32_16x16x32_bf16 v[80:83], a[124:127], a[248:251], v[80:83]
  v_mfma_f32_16x16x32_bf16 v[80:83], a[136:139], a[244:247], v[80:83]
  v_mfma_f32_16x16x32_bf16 v[84:87], a[140:143], a[244:247], 0
  v_mfma_f32_16x16x32_bf16 v[84:87], a[128:131], a[248:251], v[84:87]
  v_mfma_f32_16x16x32_bf16 v[84:87], a[116:119], a[252:255], v[84:87]
  v_cvt_pk_bf16_f32 v138, v80, v81
  v_cvt_pk_bf16_f32 v139, v82, v83
  v_mfma_f32_16x16x32_bf16 v[84:87], a[104:107], v[144:147], v[84:87]
  v_mfma_f32_16x16x32_bf16 v[84:87], a[92:95], v[148:151], v[84:87]
  v_mfma_f32_16x16x32_bf16 v[84:87], a[80:83], v[152:155], v[84:87]
  v_mfma_f32_16x16x32_bf16 v[92:95], v[70:73], v[76:79], v[36:39]
  v_mfma_f32_16x16x32_bf16 v[92:95], v[68:71], v[12:15], v[92:95]
  v_mfma_f32_16x16x32_bf16 v[96:99], v[122:125], v[76:79], v[32:35]
  v_cvt_pk_bf16_f32 v140, v84, v85
  v_cvt_pk_bf16_f32 v141, v86, v87
  v_mfma_f32_16x16x32_bf16 v[96:99], v[120:123], v[12:15], v[96:99]
  v_mfma_f32_16x16x32_bf16 v[172:175], v[130:133], v[76:79], v[28:31]
  v_exp_f32 v92, v92
  v_mfma_f32_16x16x32_bf16 v[172:175], v[128:131], v[12:15], v[172:175]
  v_exp_f32 v93, v93
  v_mfma_f32_16x16x32_bf16 v[176:179], v[138:141], v[76:79], v[24:27]
  v_exp_f32 v94, v94
  v_mfma_f32_16x16x32_bf16 v[176:179], v[136:139], v[12:15], v[176:179]
  v_exp_f32 v95, v95
  v_mfma_f32_16x16x32_bf16 v[84:87], v[68:71], v[100:103], v[40:43]
  v_exp_f32 v96, v96
  v_mfma_f32_16x16x32_bf16 v[84:87], v[70:73], v[14:17], v[84:87]
  v_exp_f32 v97, v97
  v_mfma_f32_16x16x32_bf16 v[88:91], v[120:123], v[100:103], v[36:39]
  v_exp_f32 v98, v98
  v_mfma_f32_16x16x32_bf16 v[88:91], v[122:125], v[14:17], v[88:91]
  v_exp_f32 v99, v99
  v_mfma_f32_16x16x32_bf16 v[168:171], v[128:131], v[100:103], v[32:35]
  v_exp_f32 v172, v172
  v_mfma_f32_16x16x32_bf16 v[168:171], v[130:133], v[14:17], v[168:171]
  v_exp_f32 v173, v173
  v_mfma_f32_16x16x32_bf16 v[164:167], v[136:139], v[100:103], v[28:31]
  v_exp_f32 v174, v174
  v_mfma_f32_16x16x32_bf16 v[164:167], v[138:141], v[14:17], v[164:167]
  v_exp_f32 v175, v175
  v_mfma_f32_16x16x32_bf16 v[76:79], v[130:133], v[104:107], v[36:39]
  v_exp_f32 v176, v176
  v_mfma_f32_16x16x32_bf16 v[76:79], v[128:131], v[18:21], v[76:79]
  v_exp_f32 v177, v177
  v_mfma_f32_16x16x32_bf16 v[80:83], v[138:141], v[104:107], v[32:35]
  v_exp_f32 v178, v178
  v_mfma_f32_16x16x32_bf16 v[80:83], v[136:139], v[18:21], v[80:83]
  v_exp_f32 v179, v179
  v_mfma_f32_16x16x32_bf16 v[160:163], v[70:73], v[104:107], v[44:47]
  v_cvt_pk_bf16_f32 v92, v92, v93
  v_cvt_pk_bf16_f32 v93, v94, v95
  v_mfma_f32_16x16x32_bf16 v[160:163], v[68:71], v[18:21], v[160:163]
  v_cvt_pk_bf16_f32 v94, v96, v97
  v_cvt_pk_bf16_f32 v95, v98, v99
  v_mfma_f32_16x16x32_bf16 v[156:159], v[122:125], v[104:107], v[40:43]
  v_cvt_pk_bf16_f32 v96, v172, v173
  v_cvt_pk_bf16_f32 v97, v174, v175
  v_mfma_f32_16x16x32_bf16 v[156:159], v[120:123], v[18:21], v[156:159]
  v_cvt_pk_bf16_f32 v98, v176, v177
  v_cvt_pk_bf16_f32 v99, v178, v179
  v_mfma_f32_16x16x32_bf16 v[180:183], a[0:3], v[152:155], 0
  v_exp_f32 v84, v84
  v_mfma_f32_16x16x32_bf16 v[180:183], a[12:15], v[148:151], v[180:183]
  v_exp_f32 v85, v85
  v_mfma_f32_16x16x32_bf16 v[180:183], a[24:27], v[144:147], v[180:183]
  v_exp_f32 v86, v86
  v_mfma_f32_16x16x32_bf16 v[180:183], a[36:39], a[252:255], v[180:183]
  v_exp_f32 v87, v87
  v_mfma_f32_16x16x32_bf16 v[180:183], a[48:51], a[248:251], v[180:183]
  v_exp_f32 v88, v88
  v_mfma_f32_16x16x32_bf16 v[180:183], a[60:63], a[244:247], v[180:183]
  v_exp_f32 v89, v89
  v_mfma_f32_16x16x32_bf16 v[100:103], a[64:67], a[244:247], 0
  v_exp_f32 v90, v90
  v_mfma_f32_16x16x32_bf16 v[100:103], a[52:55], a[248:251], v[100:103]
  v_exp_f32 v91, v91
  v_mfma_f32_16x16x32_bf16 v[100:103], a[40:43], a[252:255], v[100:103]
  v_mul_f32 v180, s42, v180
  v_mul_f32 v181, s42, v181
  v_mfma_f32_16x16x32_bf16 v[100:103], a[28:31], v[144:147], v[100:103]
  v_mul_f32 v182, s42, v182
  v_mul_f32 v183, s42, v183
  v_mfma_f32_16x16x32_bf16 v[100:103], a[16:19], v[148:151], v[100:103]
  v_cvt_pk_bf16_f32 v172, v180, v181
  v_cvt_pk_bf16_f32 v173, v182, v183
  v_mfma_f32_16x16x32_bf16 v[100:103], a[4:7], v[152:155], v[100:103]
  v_exp_f32 v168, v168
  v_mfma_f32_16x16x32_bf16 v[104:107], a[8:11], v[152:155], 0
  v_exp_f32 v169, v169
  v_mfma_f32_16x16x32_bf16 v[104:107], a[20:23], v[148:151], v[104:107]
  v_exp_f32 v170, v170
  v_mfma_f32_16x16x32_bf16 v[104:107], a[32:35], v[144:147], v[104:107]
  v_mul_f32 v100, s42, v100
  v_mul_f32 v101, s42, v101
  v_mfma_f32_16x16x32_bf16 v[104:107], a[44:47], a[252:255], v[104:107]
  v_mul_f32 v102, s42, v102
  v_mul_f32 v103, s42, v103
  v_mfma_f32_16x16x32_bf16 v[104:107], a[56:59], a[248:251], v[104:107]
  v_cvt_pk_bf16_f32 v174, v100, v101
  v_cvt_pk_bf16_f32 v175, v102, v103
  v_mfma_f32_16x16x32_bf16 v[104:107], a[68:71], a[244:247], v[104:107]
  v_exp_f32 v171, v171
  v_mfma_f32_16x16x32_bf16 v[176:179], v[152:155], a[144:147], 0
  v_exp_f32 v164, v164
  v_mfma_f32_16x16x32_bf16 v[176:179], v[148:151], a[156:159], v[176:179]
  v_exp_f32 v165, v165
  v_mfma_f32_16x16x32_bf16 v[176:179], v[144:147], a[168:171], v[176:179]
  v_mul_f32 v104, s42, v104
  v_mul_f32 v105, s42, v105
  v_mfma_f32_16x16x32_bf16 v[176:179], a[252:255], a[180:183], v[176:179]
  v_mul_f32 v106, s42, v106
  v_mul_f32 v107, s42, v107
  v_mfma_f32_16x16x32_bf16 v[176:179], a[248:251], a[192:195], v[176:179]
  v_cvt_pk_bf16_f32 v22, v104, v105
  v_cvt_pk_bf16_f32 v23, v106, v107
  v_mfma_f32_16x16x32_bf16 v[176:179], a[244:247], a[204:207], v[176:179]
  v_exp_f32 v166, v166
  v_mfma_f32_16x16x32_bf16 v[100:103], v[128:131], v[172:175], v[40:43]
  v_exp_f32 v167, v167
  v_mfma_f32_16x16x32_bf16 v[100:103], v[130:133], v[20:23], v[100:103]
  v_cvt_pk_bf16_f32 v84, v84, v85
  v_cvt_pk_bf16_f32 v85, v86, v87
  v_mfma_f32_16x16x32_bf16 v[104:107], v[136:139], v[172:175], v[36:39]
  v_cvt_pk_bf16_f32 v110, v176, v177
  v_cvt_pk_bf16_f32 v111, v178, v179
  v_mfma_f32_16x16x32_bf16 v[104:107], v[138:141], v[20:23], v[104:107]
  v_cvt_pk_bf16_f32 v86, v88, v89
  v_cvt_pk_bf16_f32 v87, v90, v91
  v_mfma_f32_16x16x32_bf16 v[132:135], v[68:71], v[172:175], v[48:51]
  ds_read_b128 v[136:139], v3 offset:0
  v_cvt_pk_bf16_f32 v88, v168, v169
  v_mfma_f32_16x16x32_bf16 v[132:135], v[70:73], v[20:23], v[132:135]
  ds_read_b128 v[140:143], v3 offset:4096
  v_cvt_pk_bf16_f32 v89, v170, v171
  v_mfma_f32_16x16x32_bf16 v[128:131], v[120:123], v[172:175], v[44:47]
  ds_read_b128 v[68:71], v3 offset:8192
  v_cvt_pk_bf16_f32 v90, v164, v165
  v_mfma_f32_16x16x32_bf16 v[128:131], v[122:125], v[20:23], v[128:131]
  ds_read_b128 v[72:75], v3 offset:12288
  v_cvt_pk_bf16_f32 v91, v166, v167
  v_mfma_f32_16x16x32_bf16 v[168:171], a[244:247], a[208:211], 0
  ds_read_b128 v[120:123], v3 offset:16384
  v_mfma_f32_16x16x32_bf16 v[168:171], a[248:251], a[196:199], v[168:171]
  ds_read_b128 v[124:127], v3 offset:20480
  v_mfma_f32_16x16x32_bf16 v[168:171], a[252:255], a[184:187], v[168:171]
  v_exp_f32 v76, v76
  v_mfma_f32_16x16x32_bf16 v[168:171], v[144:147], a[172:175], v[168:171]
  v_exp_f32 v77, v77
  v_mfma_f32_16x16x32_bf16 v[168:171], v[148:151], a[160:163], v[168:171]
  v_exp_f32 v78, v78
  v_mfma_f32_16x16x32_bf16 v[168:171], v[152:155], a[148:151], v[168:171]
  v_exp_f32 v79, v79
  v_mfma_f32_16x16x32_bf16 v[164:167], v[152:155], a[152:155], 0
  v_exp_f32 v80, v80
  v_mfma_f32_16x16x32_bf16 v[164:167], v[148:151], a[164:167], v[164:167]
  v_exp_f32 v81, v81
  v_mfma_f32_16x16x32_bf16 v[164:167], v[144:147], a[176:179], v[164:167]
  v_cvt_pk_bf16_f32 v114, v168, v169
  v_cvt_pk_bf16_f32 v115, v170, v171
  v_mfma_f32_16x16x32_bf16 v[164:167], a[252:255], a[188:191], v[164:167]
  s_cmp_lt_u32 s31, s97
  v_exp_f32 v82, v82
  v_mfma_f32_16x16x32_bf16 v[164:167], a[248:251], a[200:203], v[164:167]
  s_waitcnt lgkmcnt(0)
  v_exp_f32 v83, v83
  v_mfma_f32_16x16x32_bf16 v[164:167], a[244:247], a[212:215], v[164:167]
  s_cbranch_scc1 L_loop
L_epi:
  v_mfma_f32_16x16x32_bf16 v[180:183], v[136:139], v[184:187], 0
  s_lshl_b32 s5, s3, 3
  v_mov_b64 v[144:145], 0
  v_cvt_pk_bf16_f32 v76, v76, v77
  v_mfma_f32_16x16x32_bf16 v[180:183], v[140:143], v[200:203], v[180:183]
  s_add_u32 s5, s5, 159744
  v_exp_f32 v160, v160
  v_mfma_f32_16x16x32_bf16 v[180:183], v[68:71], v[216:219], v[180:183]
  v_cvt_pk_bf16_f32 v118, v164, v165
  v_cvt_pk_bf16_f32 v119, v166, v167
  v_mfma_f32_16x16x32_bf16 v[180:183], v[72:75], v[232:235], v[180:183]
  v_mov_b64 v[148:149], 0
  v_cvt_pk_bf16_f32 v77, v78, v79
  v_mfma_f32_16x16x32_bf16 v[180:183], v[120:123], v[248:251], v[180:183]
  v_exp_f32 v161, v161
  v_mfma_f32_16x16x32_bf16 v[180:183], v[124:127], a[224:227], v[180:183]
  v_exp_f32 v162, v162
  v_smfmac_f32_16x16x64_bf16 v[144:147], a[240:243], v[92:99], v10
  v_exp_f32 v163, v163
  v_mfma_f32_16x16x32_bf16 v[152:155], v[108:111], v[96:99], 0
  v_exp_f32 v156, v156
  v_mfma_f32_16x16x32_bf16 v[152:155], v[56:59], v[92:95], v[152:155]
  v_exp_f32 v157, v157
  v_mfma_f32_16x16x32_bf16 v[164:167], v[60:63], v[92:95], 0
  v_exp_f32 v158, v158
  v_mfma_f32_16x16x32_bf16 v[164:167], v[112:115], v[96:99], v[164:167]
  v_exp_f32 v159, v159
  v_mfma_f32_16x16x32_bf16 v[168:171], v[116:119], v[96:99], 0
  v_cvt_pk_bf16_f32 v78, v80, v81
  v_cvt_pk_bf16_f32 v79, v82, v83
  v_mfma_f32_16x16x32_bf16 v[168:171], v[64:67], v[92:95], v[168:171]
  v_cvt_pk_bf16_f32 v80, v160, v161
  v_cvt_pk_bf16_f32 v81, v162, v163
  v_smfmac_f32_16x16x64_bf16 v[148:151], a[240:243], v[84:91], v10
  v_cvt_pk_bf16_f32 v82, v156, v157
  v_cvt_pk_bf16_f32 v83, v158, v159
  v_mfma_f32_16x16x32_bf16 v[92:95], v[108:111], v[88:91], 0
  v_exp_f32 v100, v100
  v_mfma_f32_16x16x32_bf16 v[92:95], v[56:59], v[84:87], v[92:95]
  v_exp_f32 v101, v101
  v_mfma_f32_16x16x32_bf16 v[96:99], v[60:63], v[84:87], 0
  v_exp_f32 v102, v102
  v_mfma_f32_16x16x32_bf16 v[96:99], v[112:115], v[88:91], v[96:99]
  v_exp_f32 v103, v103
  v_mfma_f32_16x16x32_bf16 v[156:159], v[116:119], v[88:91], 0
  v_exp_f32 v104, v104
  v_mfma_f32_16x16x32_bf16 v[156:159], v[64:67], v[84:87], v[156:159]
  v_exp_f32 v105, v105
  v_mfma_f32_16x16x32_bf16 v[172:175], v[124:127], a[228:231], 0
  v_exp_f32 v106, v106
  v_mfma_f32_16x16x32_bf16 v[172:175], v[120:123], v[252:255], v[172:175]
  v_exp_f32 v107, v107
  v_mfma_f32_16x16x32_bf16 v[172:175], v[72:75], v[236:239], v[172:175]
  ds_read_b128 a[248:251], v4 offset:0
  ds_read_b128 v[16:19], v4 offset:4096
  v_mfma_f32_16x16x32_bf16 v[172:175], v[68:71], v[220:223], v[172:175]
  ds_read_b128 v[160:163], v4 offset:8192
  ds_read_b128 v[176:179], v4 offset:12288
  v_mfma_f32_16x16x32_bf16 v[172:175], v[140:143], v[204:207], v[172:175]
  ds_read_b128 a[244:247], v4 offset:16384
  ds_read_b128 a[252:255], v4 offset:20480
  v_mfma_f32_16x16x32_bf16 v[172:175], v[136:139], v[188:191], v[172:175]
  v_exp_f32 v132, v132
  v_mfma_f32_16x16x32_bf16 v[88:91], v[136:139], v[192:195], 0
  v_exp_f32 v133, v133
  v_mfma_f32_16x16x32_bf16 v[88:91], v[140:143], v[208:211], v[88:91]
  v_exp_f32 v134, v134
  v_mfma_f32_16x16x32_bf16 v[88:91], v[68:71], v[224:227], v[88:91]
  v_cvt_pk_bf16_f32 v180, v180, v172
  v_cvt_pk_bf16_f32 v181, v181, v173
  v_mfma_f32_16x16x32_bf16 v[88:91], v[72:75], v[240:243], v[88:91]
  v_cvt_pk_bf16_f32 v182, v182, v174
  v_cvt_pk_bf16_f32 v183, v183, v175
  v_mfma_f32_16x16x32_bf16 v[88:91], v[120:123], a[216:219], v[88:91]
  buffer_store_dword v180, v7, s[24:27], s33 offen offset:0 nt
  v_mfma_f32_16x16x32_bf16 v[88:91], v[124:127], a[232:235], v[88:91]
  v_exp_f32 v135, v135
  v_mfma_f32_16x16x32_bf16 v[84:87], v[124:127], a[236:239], 0
  buffer_store_dword v181, v7, s[24:27], s33 offen offset:384 nt
  v_mfma_f32_16x16x32_bf16 v[84:87], v[120:123], a[220:223], v[84:87]
  v_exp_f32 v128, v128
  v_mfma_f32_16x16x32_bf16 v[84:87], v[72:75], v[244:247], v[84:87]
  buffer_store_dword v182, v7, s[24:27], s33 offen offset:768 nt
  v_mfma_f32_16x16x32_bf16 v[84:87], v[68:71], v[228:231], v[84:87]
  v_exp_f32 v129, v129
  v_mfma_f32_16x16x32_bf16 v[84:87], v[140:143], v[212:215], v[84:87]
  buffer_store_dword v183, v7, s[24:27], s33 offen offset:1152 nt
  v_mfma_f32_16x16x32_bf16 v[84:87], v[136:139], v[196:199], v[84:87]
  s_waitcnt lgkmcnt(0)
  v_exp_f32 v130, v130
  v_mfma_f32_16x16x32_bf16 v[140:143], a[248:251], v[184:187], 0
  v_exp_f32 v131, v131
  v_mfma_f32_16x16x32_bf16 v[140:143], v[16:19], v[200:203], v[140:143]
  v_cvt_pk_bf16_f32 v100, v100, v101
  v_cvt_pk_bf16_f32 v101, v102, v103
  v_mfma_f32_16x16x32_bf16 v[140:143], v[160:163], v[216:219], v[140:143]
  v_cvt_pk_bf16_f32 v88, v88, v84
  v_cvt_pk_bf16_f32 v89, v89, v85
  v_mfma_f32_16x16x32_bf16 v[140:143], v[176:179], v[232:235], v[140:143]
  v_cvt_pk_bf16_f32 v90, v90, v86
  v_cvt_pk_bf16_f32 v91, v91, v87
  v_mfma_f32_16x16x32_bf16 v[140:143], a[244:247], v[248:251], v[140:143]
  buffer_store_dword v88, v8, s[24:27], s33 offen offset:0 nt
  v_mfma_f32_16x16x32_bf16 v[140:143], a[252:255], a[224:227], v[140:143]
  ds_read_b128 v[172:175], v3 offset:512
  v_mov_b64 v[84:85], 0
  v_mfma_f32_16x16x32_bf16 v[136:139], a[252:255], a[228:231], 0
  buffer_store_dword v89, v8, s[24:27], s33 offen offset:384 nt
  v_mfma_f32_16x16x32_bf16 v[136:139], a[244:247], v[252:255], v[136:139]
  ds_read_b128 v[180:183], v3 offset:4608
  ds_read_b128 a[252:255], v3 offset:8704
  v_mfma_f32_16x16x32_bf16 v[136:139], v[176:179], v[236:239], v[136:139]
  buffer_store_dword v90, v8, s[24:27], s33 offen offset:768 nt
  v_mfma_f32_16x16x32_bf16 v[136:139], v[160:163], v[220:223], v[136:139]
  ds_read_b128 v[120:123], v3 offset:12800
  ds_read_b128 v[124:127], v3 offset:16896
  v_mfma_f32_16x16x32_bf16 v[136:139], v[16:19], v[204:207], v[136:139]
  buffer_store_dword v91, v8, s[24:27], s33 offen offset:1152 nt
  v_mfma_f32_16x16x32_bf16 v[136:139], a[248:251], v[188:191], v[136:139]
  s_add_u32 s33, s33, s98
  ds_read_b128 a[244:247], v3 offset:20992
  v_cvt_pk_bf16_f32 v102, v104, v105
  v_smfmac_f32_16x16x64_bf16 v[84:87], a[240:243], v[76:83], v10
  v_cvt_pk_bf16_f32 v103, v106, v107
  v_cvt_pk_bf16_f32 v104, v132, v133
  v_mfma_f32_16x16x32_bf16 v[16:19], v[56:59], v[80:83], 0
  v_cvt_pk_bf16_f32 v105, v134, v135
  v_cvt_pk_bf16_f32 v106, v128, v129
  v_mfma_f32_16x16x32_bf16 v[16:19], v[108:111], v[76:79], v[16:19]
  v_cvt_pk_bf16_f32 v140, v140, v136
  v_cvt_pk_bf16_f32 v141, v141, v137
  v_mfma_f32_16x16x32_bf16 v[68:71], v[112:115], v[76:79], 0
  v_cvt_pk_bf16_f32 v142, v142, v138
  v_cvt_pk_bf16_f32 v143, v143, v139
  v_mfma_f32_16x16x32_bf16 v[68:71], v[60:63], v[80:83], v[68:71]
  buffer_store_dword v140, v7, s[24:27], s34 offen offset:0 nt
  v_mfma_f32_16x16x32_bf16 v[72:75], v[64:67], v[80:83], 0
  s_waitcnt lgkmcnt(0)
  v_cvt_pk_bf16_f32 v107, v130, v131
  v_add_f32 v144, v144, v145
  v_mfma_f32_16x16x32_bf16 v[72:75], v[116:119], v[76:79], v[72:75]
  buffer_store_dword v141, v7, s[24:27], s34 offen offset:384 nt
  v_mfma_f32_16x16x32_bf16 v[128:131], v[172:175], v[184:187], 0
  v_rcp_f32 v146, v144
  v_mfma_f32_16x16x32_bf16 v[128:131], v[180:183], v[200:203], v[128:131]
  buffer_store_dword v142, v7, s[24:27], s34 offen offset:768 nt
  v_mfma_f32_16x16x32_bf16 v[128:131], a[252:255], v[216:219], v[128:131]
  v_mov_b64 v[76:77], 0
  v_add_f32 v148, v148, v149
  v_mfma_f32_16x16x32_bf16 v[128:131], v[120:123], v[232:235], v[128:131]
  buffer_store_dword v143, v7, s[24:27], s34 offen offset:1152 nt
  v_mul_f32 v152, v146, v152
  v_mfma_f32_16x16x32_bf16 v[128:131], v[124:127], v[248:251], v[128:131]
  s_add_u32 s34, s34, s98
  v_rcp_f32 v150, v148
  v_mul_f32 v153, v146, v153
  v_mfma_f32_16x16x32_bf16 v[128:131], a[244:247], a[224:227], v[128:131]
  v_mul_f32 v154, v146, v154
  v_mul_f32 v155, v146, v155
  v_cvt_pk_bf16_f32 v152, v152, v153
  v_mfma_f32_16x16x32_bf16 v[88:91], a[244:247], a[228:231], 0
  v_cvt_pk_bf16_f32 v153, v154, v155
  v_mul_f32 v164, v146, v164
  v_mul_f32 v165, v146, v165
  v_mfma_f32_16x16x32_bf16 v[88:91], v[124:127], v[252:255], v[88:91]
  v_mul_f32 v166, v146, v166
  v_mul_f32 v167, v146, v167
  v_cvt_pk_bf16_f32 v164, v164, v165
  v_mfma_f32_16x16x32_bf16 v[88:91], v[120:123], v[236:239], v[88:91]
  v_cvt_pk_bf16_f32 v165, v166, v167
  v_mul_f32 v168, v146, v168
  v_mul_f32 v169, v146, v169
  v_mfma_f32_16x16x32_bf16 v[88:91], a[252:255], v[220:223], v[88:91]
  v_mul_f32 v170, v146, v170
  v_mul_f32 v171, v146, v171
  v_cvt_pk_bf16_f32 v168, v168, v169
  v_mfma_f32_16x16x32_bf16 v[88:91], v[180:183], v[204:207], v[88:91]
  v_cvt_pk_bf16_f32 v169, v170, v171
  v_mul_f32 v92, v150, v92
  v_mul_f32 v93, v150, v93
  v_mfma_f32_16x16x32_bf16 v[88:91], v[172:175], v[188:191], v[88:91]
  v_mul_f32 v94, v150, v94
  v_mul_f32 v95, v150, v95
  v_cvt_pk_bf16_f32 v92, v92, v93
  v_smfmac_f32_16x16x64_bf16 v[76:79], a[240:243], v[100:107], v10
  v_cvt_pk_bf16_f32 v93, v94, v95
  v_mul_f32 v96, v150, v96
  v_mul_f32 v97, v150, v97
  v_mfma_f32_16x16x32_bf16 v[80:83], v[56:59], v[104:107], 0
  v_mul_f32 v98, v150, v98
  v_mul_f32 v99, v150, v99
  v_cvt_pk_bf16_f32 v96, v96, v97
  v_mfma_f32_16x16x32_bf16 v[80:83], v[108:111], v[100:103], v[80:83]
  v_cvt_pk_bf16_f32 v128, v128, v88
  v_cvt_pk_bf16_f32 v129, v129, v89
  v_cvt_pk_bf16_f32 v97, v98, v99
  v_mfma_f32_16x16x32_bf16 v[56:59], v[112:115], v[100:103], 0
  ds_read_b128 v[108:111], v4 offset:512
  v_cvt_pk_bf16_f32 v130, v130, v90
  v_cvt_pk_bf16_f32 v131, v131, v91
  v_mfma_f32_16x16x32_bf16 v[56:59], v[60:63], v[104:107], v[56:59]
  buffer_store_dword v128, v7, s[24:27], s35 offen offset:0 nt
  v_mul_f32 v156, v150, v156
  v_mfma_f32_16x16x32_bf16 v[88:91], v[64:67], v[104:107], 0
  ds_read_b128 v[112:115], v4 offset:4608
  ds_read_b128 v[132:135], v4 offset:8704
  v_mul_f32 v157, v150, v157
  v_mfma_f32_16x16x32_bf16 v[88:91], v[116:119], v[100:103], v[88:91]
  buffer_store_dword v129, v7, s[24:27], s35 offen offset:384 nt
  v_mul_f32 v158, v150, v158
  v_mfma_f32_16x16x32_bf16 v[104:107], v[172:175], v[192:195], 0
  ds_read_b128 v[100:103], v4 offset:12800
  ds_read_b128 v[60:63], v4 offset:16896
  v_mul_f32 v159, v150, v159
  v_mfma_f32_16x16x32_bf16 v[104:107], v[180:183], v[208:211], v[104:107]
  buffer_store_dword v130, v7, s[24:27], s35 offen offset:768 nt
  v_cvt_pk_bf16_f32 v156, v156, v157
  v_mfma_f32_16x16x32_bf16 v[104:107], a[252:255], v[224:227], v[104:107]
  ds_read_b128 v[116:119], v4 offset:20992
  v_cvt_pk_bf16_f32 v157, v158, v159
  v_max3_f32 v9, v144, v146, v9
  v_mfma_f32_16x16x32_bf16 v[104:107], v[120:123], v[240:243], v[104:107]
  buffer_store_dword v131, v7, s[24:27], s35 offen offset:1152 nt
  v_max3_f32 v9, v148, v150, v9
  v_mfma_f32_16x16x32_bf16 v[104:107], v[124:127], a[216:219], v[104:107]
  ds_write2st64_b32 v5, v152, v153 offset0:0 offset1:4
  v_mfma_f32_16x16x32_bf16 v[104:107], a[244:247], a[232:235], v[104:107]
  ds_write2st64_b32 v5, v164, v165 offset0:8 offset1:12
  v_mfma_f32_16x16x32_bf16 v[128:131], a[244:247], a[236:239], 0
  ds_write2st64_b32 v5, v168, v169 offset0:16 offset1:20
  v_mfma_f32_16x16x32_bf16 v[128:131], v[124:127], a[220:223], v[128:131]
  ds_write2st64_b32 v5, v92, v93 offset0:1 offset1:5
  v_mfma_f32_16x16x32_bf16 v[128:131], v[120:123], v[244:247], v[128:131]
  ds_write2st64_b32 v5, v96, v97 offset0:9 offset1:13
  v_mfma_f32_16x16x32_bf16 v[128:131], a[252:255], v[228:231], v[128:131]
  ds_write2st64_b32 v5, v156, v157 offset0:17 offset1:21
  v_mfma_f32_16x16x32_bf16 v[128:131], v[180:183], v[212:215], v[128:131]
  v_xor_b32 v3, 40960, v3
  v_xor_b32 v4, 40960, v4
  v_add_f32 v84, v84, v85
  v_mfma_f32_16x16x32_bf16 v[128:131], v[172:175], v[196:199], v[128:131]
  s_waitcnt lgkmcnt(6)
  v_rcp_f32 v86, v84
  v_add_f32 v76, v76, v77
  v_mfma_f32_16x16x32_bf16 v[64:67], v[108:111], v[184:187], 0
  v_rcp_f32 v78, v76
  v_max3_f32 v9, v84, v86, v9
  v_mfma_f32_16x16x32_bf16 v[64:67], v[112:115], v[200:203], v[64:67]
  v_max3_f32 v9, v76, v78, v9
  v_cmp_nge_f32 vcc, 0x53800000, v9
  v_mul_f32 v16, v86, v16
  v_mfma_f32_16x16x32_bf16 v[64:67], v[132:135], v[216:219], v[64:67]
  v_cvt_pk_bf16_f32 v104, v104, v128
  v_cvt_pk_bf16_f32 v105, v105, v129
  v_mul_f32 v17, v86, v17
  v_mfma_f32_16x16x32_bf16 v[64:67], v[100:103], v[232:235], v[64:67]
  s_waitcnt lgkmcnt(0)
  s_barrier
  v_mfma_f32_16x16x32_bf16 v[64:67], v[60:63], v[248:251], v[64:67]
  s_or_b32 s6, vcc_lo, vcc_hi
  ds_read_b128 a[244:247], v3 offset:0
  v_cvt_pk_bf16_f32 v106, v106, v130
  v_cvt_pk_bf16_f32 v107, v107, v131
  v_mfma_f32_16x16x32_bf16 v[64:67], v[116:119], a[224:227], v[64:67]
  buffer_store_dword v104, v8, s[24:27], s35 offen offset:0 nt
  v_mul_f32 v18, v86, v18
  v_mfma_f32_16x16x32_bf16 v[120:123], v[116:119], a[228:231], 0
  ds_read_b128 a[248:251], v3 offset:4096
  ds_read_b128 a[252:255], v3 offset:8192
  v_mul_f32 v19, v86, v19
  v_mfma_f32_16x16x32_bf16 v[120:123], v[60:63], v[252:255], v[120:123]
  buffer_store_dword v105, v8, s[24:27], s35 offen offset:384 nt
  v_cvt_pk_bf16_f32 v16, v16, v17
  v_mfma_f32_16x16x32_bf16 v[120:123], v[100:103], v[236:239], v[120:123]
  ds_read_b128 v[60:63], v3 offset:12288
  ds_read_b128 v[92:95], v3 offset:16384
  v_cvt_pk_bf16_f32 v17, v18, v19
  v_mfma_f32_16x16x32_bf16 v[120:123], v[132:135], v[220:223], v[120:123]
  buffer_store_dword v106, v8, s[24:27], s35 offen offset:768 nt
  v_mul_f32 v68, v86, v68
  v_mfma_f32_16x16x32_bf16 v[120:123], v[112:115], v[204:207], v[120:123]
  s_waitcnt lgkmcnt(2)
  ds_read_b128 v[100:103], v3 offset:20480
  v_mul_f32 v69, v86, v69
  v_mul_f32 v70, v86, v70
  v_mfma_f32_16x16x32_bf16 v[120:123], v[108:111], v[188:191], v[120:123]
  buffer_store_dword v107, v8, s[24:27], s35 offen offset:1152 nt
  v_mul_f32 v71, v86, v71
  v_mfma_f32_16x16x32_bf16 v[96:99], a[244:247], v[184:187], 0
  s_add_u32 s35, s35, s98
  v_cvt_pk_bf16_f32 v68, v68, v69
  v_cvt_pk_bf16_f32 v69, v70, v71
  v_mul_f32 v72, v86, v72
  v_mfma_f32_16x16x32_bf16 v[96:99], a[248:251], v[200:203], v[96:99]
  v_mul_f32 v73, v86, v73
  v_mul_f32 v74, v86, v74
  v_mul_f32 v75, v86, v75
  v_mfma_f32_16x16x32_bf16 v[96:99], a[252:255], v[216:219], v[96:99]
  s_waitcnt lgkmcnt(1)
  v_cvt_pk_bf16_f32 v64, v64, v120
  v_cvt_pk_bf16_f32 v65, v65, v121
  v_cvt_pk_bf16_f32 v72, v72, v73
  v_mfma_f32_16x16x32_bf16 v[96:99], v[60:63], v[232:235], v[96:99]
  s_waitcnt lgkmcnt(0)
  v_cvt_pk_bf16_f32 v66, v66, v122
  v_cvt_pk_bf16_f32 v67, v67, v123
  v_cvt_pk_bf16_f32 v73, v74, v75
  v_mfma_f32_16x16x32_bf16 v[96:99], v[92:95], v[248:251], v[96:99]
  buffer_store_dword v64, v7, s[24:27], s36 offen offset:0 nt
  v_mul_f32 v80, v78, v80
  v_mfma_f32_16x16x32_bf16 v[96:99], v[100:103], a[224:227], v[96:99]
  v_mul_f32 v81, v78, v81
  v_mul_f32 v82, v78, v82
  v_mul_f32 v83, v78, v83
  v_mfma_f32_16x16x32_bf16 v[124:127], v[100:103], a[228:231], 0
  buffer_store_dword v65, v7, s[24:27], s36 offen offset:384 nt
  v_cvt_pk_bf16_f32 v80, v80, v81
  v_mfma_f32_16x16x32_bf16 v[124:127], v[92:95], v[252:255], v[124:127]
L_hop_0_1:
  s_cbranch_execz L_hop_0_2
  v_cvt_pk_bf16_f32 v81, v82, v83
  v_mul_f32 v56, v78, v56
  v_mul_f32 v57, v78, v57
  v_mfma_f32_16x16x32_bf16 v[124:127], v[60:63], v[236:239], v[124:127]
  buffer_store_dword v66, v7, s[24:27], s36 offen offset:768 nt
  v_mul_f32 v58, v78, v58
  v_mfma_f32_16x16x32_bf16 v[124:127], a[252:255], v[220:223], v[124:127]
  ds_read_b128 v[84:87], v4 offset:0
  ds_read_b128 v[104:107], v4 offset:4096
  v_mul_f32 v59, v78, v59
  v_mfma_f32_16x16x32_bf16 v[124:127], a[248:251], v[204:207], v[124:127]
  buffer_store_dword v67, v7, s[24:27], s36 offen offset:1152 nt
  v_cvt_pk_bf16_f32 v56, v56, v57
  v_mfma_f32_16x16x32_bf16 v[124:127], a[244:247], v[188:191], v[124:127]
  s_add_u32 s36, s36, s98
  ds_read_b128 v[108:111], v4 offset:8192
  ds_read_b128 v[112:115], v4 offset:12288
  v_cvt_pk_bf16_f32 v57, v58, v59
  v_mfma_f32_16x16x32_bf16 v[64:67], a[244:247], v[192:195], 0
  ds_read_b128 v[116:119], v4 offset:16384
  ds_read_b128 v[120:123], v4 offset:20480
  v_mul_f32 v88, v78, v88
  v_mfma_f32_16x16x32_bf16 v[64:67], a[248:251], v[208:211], v[64:67]
  v_mul_f32 v89, v78, v89
  v_mul_f32 v90, v78, v90
  v_mul_f32 v91, v78, v91
  v_mfma_f32_16x16x32_bf16 v[64:67], a[252:255], v[224:227], v[64:67]
  v_cvt_pk_bf16_f32 v96, v96, v124
  v_cvt_pk_bf16_f32 v97, v97, v125
  v_cvt_pk_bf16_f32 v88, v88, v89
  v_mfma_f32_16x16x32_bf16 v[64:67], v[60:63], v[240:243], v[64:67]
  v_cvt_pk_bf16_f32 v98, v98, v126
  v_cvt_pk_bf16_f32 v99, v99, v127
  v_cvt_pk_bf16_f32 v89, v90, v91
  v_mfma_f32_16x16x32_bf16 v[64:67], v[92:95], a[216:219], v[64:67]
  buffer_store_dword v96, v7, s[24:27], s33 offen offset:0 nt
  v_mov_b32 v0, s5
  v_mfma_f32_16x16x32_bf16 v[64:67], v[100:103], a[232:235], v[64:67]
  v_mov_b32 v1, s6
  v_mfma_f32_16x16x32_bf16 v[124:127], v[100:103], a[236:239], 0
  buffer_store_dword v97, v7, s[24:27], s33 offen offset:384 nt
  v_mfma_f32_16x16x32_bf16 v[124:127], v[92:95], a[220:223], v[124:127]
  ds_write2st64_b32 v5, v16, v17 offset0:2 offset1:6
  v_mfma_f32_16x16x32_bf16 v[124:127], v[60:63], v[244:247], v[124:127]
  buffer_store_dword v98, v7, s[24:27], s33 offen offset:768 nt
  v_mfma_f32_16x16x32_bf16 v[124:127], a[252:255], v[228:231], v[124:127]
  ds_write2st64_b32 v5, v68, v69 offset0:10 offset1:14
  v_mfma_f32_16x16x32_bf16 v[124:127], a[248:251], v[212:215], v[124:127]
  buffer_store_dword v99, v7, s[24:27], s33 offen offset:1152 nt
  v_mfma_f32_16x16x32_bf16 v[124:127], a[244:247], v[196:199], v[124:127]
  s_waitcnt lgkmcnt(2)
  ds_write2st64_b32 v5, v72, v73 offset0:18 offset1:22
  v_mfma_f32_16x16x32_bf16 v[16:19], v[84:87], v[184:187], 0
  ds_write2st64_b32 v5, v80, v81 offset0:3 offset1:7
  v_mfma_f32_16x16x32_bf16 v[16:19], v[104:107], v[200:203], v[16:19]
  ds_write2st64_b32 v5, v56, v57 offset0:11 offset1:15
  ds_write2st64_b32 v5, v88, v89 offset0:19 offset1:23
  ds_write_b32 v0, v1
  v_mfma_f32_16x16x32_bf16 v[16:19], v[108:111], v[216:219], v[16:19]
  v_cvt_pk_bf16_f32 v64, v64, v124
  v_cvt_pk_bf16_f32 v65, v65, v125
  v_mfma_f32_16x16x32_bf16 v[16:19], v[112:115], v[232:235], v[16:19]
  s_waitcnt lgkmcnt(0)
  s_barrier
  v_mfma_f32_16x16x32_bf16 v[16:19], v[116:119], v[248:251], v[16:19]
  v_cvt_pk_bf16_f32 v66, v66, v126
  v_cvt_pk_bf16_f32 v67, v67, v127
  v_mfma_f32_16x16x32_bf16 v[16:19], v[120:123], a[224:227], v[16:19]
  buffer_store_dword v64, v8, s[24:27], s33 offen offset:0 nt
  v_mfma_f32_16x16x32_bf16 v[76:79], v[120:123], a[228:231], 0
  ds_read_b128 a[244:247], v3 offset:512
  ds_read_b128 a[248:251], v3 offset:4608
  v_mfma_f32_16x16x32_bf16 v[76:79], v[116:119], v[252:255], v[76:79]
  buffer_store_dword v65, v8, s[24:27], s33 offen offset:384 nt
  v_mfma_f32_16x16x32_bf16 v[76:79], v[112:115], v[236:239], v[76:79]
  ds_read_b128 a[252:255], v3 offset:8704
  ds_read_b128 v[56:59], v3 offset:12800
  v_mfma_f32_16x16x32_bf16 v[76:79], v[108:111], v[220:223], v[76:79]
  buffer_store_dword v66, v8, s[24:27], s33 offen offset:768 nt
  v_mfma_f32_16x16x32_bf16 v[76:79], v[104:107], v[204:207], v[76:79]
  s_waitcnt lgkmcnt(2)
  ds_read_b128 v[68:71], v3 offset:16896
  ds_read_b128 v[72:75], v3 offset:20992
  v_mfma_f32_16x16x32_bf16 v[76:79], v[84:87], v[188:191], v[76:79]
  buffer_store_dword v67, v8, s[24:27], s33 offen offset:1152 nt
  v_mfma_f32_16x16x32_bf16 v[60:63], a[244:247], v[184:187], 0
  v_mov_b32 v0, 159744
  v_mfma_f32_16x16x32_bf16 v[60:63], a[248:251], v[200:203], v[60:63]
  s_waitcnt lgkmcnt(2)
  ds_read2_b32 v[96:97], v0 offset0:0 offset1:2
  ds_read2_b32 v[98:99], v0 offset0:4 offset1:6
  v_mfma_f32_16x16x32_bf16 v[60:63], a[252:255], v[216:219], v[60:63]
  v_cvt_pk_bf16_f32 v16, v16, v76
  v_cvt_pk_bf16_f32 v17, v17, v77
  v_mfma_f32_16x16x32_bf16 v[60:63], v[56:59], v[232:235], v[60:63]
  s_waitcnt lgkmcnt(2)
  v_cvt_pk_bf16_f32 v18, v18, v78
  v_cvt_pk_bf16_f32 v19, v19, v79
  v_mfma_f32_16x16x32_bf16 v[60:63], v[68:71], v[248:251], v[60:63]
  buffer_store_dword v16, v7, s[24:27], s34 offen offset:0 nt
  v_mfma_f32_16x16x32_bf16 v[60:63], v[72:75], a[224:227], v[60:63]
  v_mfma_f32_16x16x32_bf16 v[100:103], v[72:75], a[228:231], 0
  buffer_store_dword v17, v7, s[24:27], s34 offen offset:384 nt
  v_mfma_f32_16x16x32_bf16 v[100:103], v[68:71], v[252:255], v[100:103]
  s_waitcnt lgkmcnt(0)
  v_or3_b32 v96, v96, v97, v98
  v_or_b32 v96, v96, v99
  v_mfma_f32_16x16x32_bf16 v[100:103], v[56:59], v[236:239], v[100:103]
  buffer_store_dword v18, v7, s[24:27], s34 offen offset:768 nt
  v_mfma_f32_16x16x32_bf16 v[100:103], a[252:255], v[220:223], v[100:103]
  ds_read_b128 v[64:67], v4 offset:512
  ds_read_b128 v[76:79], v4 offset:4608
  v_mfma_f32_16x16x32_bf16 v[100:103], a[248:251], v[204:207], v[100:103]
  buffer_store_dword v19, v7, s[24:27], s34 offen offset:1152 nt
  v_mfma_f32_16x16x32_bf16 v[100:103], a[244:247], v[188:191], v[100:103]
  ds_read_b128 v[80:83], v4 offset:8704
  ds_read_b128 v[84:87], v4 offset:12800
  v_mfma_f32_16x16x32_bf16 v[16:19], a[244:247], v[192:195], 0
  ds_read_b128 v[88:91], v4 offset:16896
  ds_read_b128 v[92:95], v4 offset:20992
  v_mfma_f32_16x16x32_bf16 v[16:19], a[248:251], v[208:211], v[16:19]
  v_readfirstlane_b32 s49, v96
  v_mfma_f32_16x16x32_bf16 v[16:19], a[252:255], v[224:227], v[16:19]
  v_cvt_pk_bf16_f32 v60, v60, v100
  v_cvt_pk_bf16_f32 v61, v61, v101
  v_mfma_f32_16x16x32_bf16 v[16:19], v[56:59], v[240:243], v[16:19]
  v_cvt_pk_bf16_f32 v62, v62, v102
  v_cvt_pk_bf16_f32 v63, v63, v103
  v_mfma_f32_16x16x32_bf16 v[16:19], v[68:71], a[216:219], v[16:19]
  buffer_store_dword v60, v7, s[24:27], s35 offen offset:0 nt
  v_mfma_f32_16x16x32_bf16 v[16:19], v[72:75], a[232:235], v[16:19]
  v_mfma_f32_16x16x32_bf16 v[96:99], v[72:75], a[236:239], 0
  buffer_store_dword v61, v7, s[24:27], s35 offen offset:384 nt
  v_mfma_f32_16x16x32_bf16 v[96:99], v[68:71], a[220:223], v[96:99]
  v_mfma_f32_16x16x32_bf16 v[96:99], v[56:59], v[244:247], v[96:99]
  buffer_store_dword v62, v7, s[24:27], s35 offen offset:768 nt
  v_mfma_f32_16x16x32_bf16 v[96:99], a[252:255], v[228:231], v[96:99]
  v_mfma_f32_16x16x32_bf16 v[96:99], a[248:251], v[212:215], v[96:99]
  buffer_store_dword v63, v7, s[24:27], s35 offen offset:1152 nt
  v_mfma_f32_16x16x32_bf16 v[96:99], a[244:247], v[196:199], v[96:99]
  s_waitcnt lgkmcnt(0)
  v_mfma_f32_16x16x32_bf16 v[56:59], v[64:67], v[184:187], 0
  v_mfma_f32_16x16x32_bf16 v[56:59], v[76:79], v[200:203], v[56:59]
  v_mfma_f32_16x16x32_bf16 v[56:59], v[80:83], v[216:219], v[56:59]
  v_cvt_pk_bf16_f32 v16, v16, v96
  v_cvt_pk_bf16_f32 v17, v17, v97
  v_mfma_f32_16x16x32_bf16 v[56:59], v[84:87], v[232:235], v[56:59]
  v_cvt_pk_bf16_f32 v18, v18, v98
  v_cvt_pk_bf16_f32 v19, v19, v99
  v_mfma_f32_16x16x32_bf16 v[56:59], v[88:91], v[248:251], v[56:59]
  buffer_store_dword v16, v8, s[24:27], s35 offen offset:0 nt
  v_mfma_f32_16x16x32_bf16 v[56:59], v[92:95], a[224:227], v[56:59]
  v_mfma_f32_16x16x32_bf16 v[60:63], v[92:95], a[228:231], 0
  buffer_store_dword v17, v8, s[24:27], s35 offen offset:384 nt
  v_mfma_f32_16x16x32_bf16 v[60:63], v[88:91], v[252:255], v[60:63]
  v_mfma_f32_16x16x32_bf16 v[60:63], v[84:87], v[236:239], v[60:63]
  buffer_store_dword v18, v8, s[24:27], s35 offen offset:768 nt
  v_mfma_f32_16x16x32_bf16 v[60:63], v[80:83], v[220:223], v[60:63]
  v_mfma_f32_16x16x32_bf16 v[60:63], v[76:79], v[204:207], v[60:63]
  buffer_store_dword v19, v8, s[24:27], s35 offen offset:1152 nt
  v_mfma_f32_16x16x32_bf16 v[60:63], v[64:67], v[188:191], v[60:63]
  s_nop 7
  v_cvt_pk_bf16_f32 v56, v56, v60
  v_cvt_pk_bf16_f32 v57, v57, v61
  v_cvt_pk_bf16_f32 v58, v58, v62
  v_cvt_pk_bf16_f32 v59, v59, v63
  buffer_store_dword v56, v7, s[24:27], s36 offen offset:0 nt
  buffer_store_dword v57, v7, s[24:27], s36 offen offset:384 nt
  buffer_store_dword v58, v7, s[24:27], s36 offen offset:768 nt
  buffer_store_dword v59, v7, s[24:27], s36 offen offset:1152 nt
  s_cmp_lg_u32 s49, 0
  s_cbranch_scc1 L_safe
L_fin:
L_end:
  s_endpgm
L_hop_1_1:
  s_cbranch_execz L_hop_1_2
L_pad3493:
L_k2:
  s_cmp_lg_u32 s59, 10
  s_cbranch_scc1 L_k7
  s_waitcnt vmcnt(30)
  v_mfma_f32_16x16x32_bf16 v[104:107], a[0:3], v[88:91], 0
  s_sub_u32 s49, s19, s18
  s_sub_u32 s50, s15, s99
  s_add_u32 s50, s50, 45360
  v_mfma_f32_16x16x32_bf16 v[104:107], a[12:15], v[92:95], v[104:107]
  s_mul_i32 s49, s49, s50
  s_mul_hi_u32 s49, s49, 384088
  s_add_u32 s49, s49, s19
  v_mfma_f32_16x16x32_bf16 v[104:107], a[24:27], v[116:119], v[104:107]
  s_and_b32 s50, s2, 7
  v_cvt_pk_bf16_f32 v66, v132, v133
  v_cvt_pk_bf16_f32 v67, v134, v135
  v_mfma_f32_16x16x32_bf16 v[104:107], a[36:39], v[96:99], v[104:107]
  s_sub_u32 s49, s49, 1024
  v_subrev_u32 v54, s49, v52
  v_subrev_u32 v55, s49, v53
  v_mfma_f32_16x16x32_bf16 v[104:107], a[48:51], v[136:139], v[104:107]
  s_waitcnt lgkmcnt(0)
  v_max_u32 v126, v54, v55
  v_bfe_u32 v74, v11, 3, 3
  v_mfma_f32_16x16x32_bf16 v[104:107], a[60:63], v[80:83], v[104:107]
  v_lshrrev_b32 v75, 6, v11
  v_lshl_add_u32 v54, v54, 3, v74
  v_mfma_f32_16x16x32_bf16 v[84:87], a[64:67], v[80:83], 0
  v_lshl_add_u32 v55, v55, 3, v75
  v_mfma_f32_16x16x32_bf16 v[84:87], a[52:55], v[136:139], v[84:87]
  v_readlane_b32 s12, v52, s50
  v_cmp_lt_u32 vcc, 2047, v126
  v_mfma_f32_16x16x32_bf16 v[84:87], a[40:43], v[96:99], v[84:87]
  v_mul_f32 v104, s42, v104
  v_mul_f32 v105, s42, v105
  v_mfma_f32_16x16x32_bf16 v[84:87], a[28:31], v[116:119], v[84:87]
  v_mul_f32 v106, s42, v106
  v_mul_f32 v107, s42, v107
  v_mfma_f32_16x16x32_bf16 v[84:87], a[16:19], v[92:95], v[84:87]
  v_cvt_pk_bf16_f32 v18, v104, v105
  v_cvt_pk_bf16_f32 v19, v106, v107
  v_mfma_f32_16x16x32_bf16 v[84:87], a[4:7], v[88:91], v[84:87]
  v_and_b32 v126, 56, v11
  v_mfma_f32_16x16x32_bf16 v[108:111], a[8:11], v[88:91], 0
  s_or_b32 s51, vcc_lo, vcc_hi
  v_cmp_lt_u32 vcc, v54, v55
  v_mfma_f32_16x16x32_bf16 v[108:111], a[20:23], v[92:95], v[108:111]
  s_sub_u32 s52, s12, s49
  s_sub_u32 s52, s52, 960
  s_lshr_b32 s52, s52, 7
  v_mfma_f32_16x16x32_bf16 v[108:111], a[32:35], v[116:119], v[108:111]
  s_or_b32 s51, s51, s52
  v_mul_f32 v84, s42, v84
  v_mul_f32 v85, s42, v85
  v_mfma_f32_16x16x32_bf16 v[108:111], a[44:47], v[96:99], v[108:111]
  v_mul_f32 v86, s42, v86
  v_mul_f32 v87, s42, v87
  v_mfma_f32_16x16x32_bf16 v[108:111], a[56:59], v[136:139], v[108:111]
  v_cvt_pk_bf16_f32 v104, v84, v85
  v_cvt_pk_bf16_f32 v105, v86, v87
  v_mfma_f32_16x16x32_bf16 v[108:111], a[68:71], v[80:83], v[108:111]
  v_lshrrev_b64 v[74:75], v126, vcc
  v_and_b32 v55, 0xff, v74
  v_mfma_f32_16x16x32_bf16 v[112:115], a[132:135], v[80:83], 0
  v_bcnt_u32_b32 v55, v55, 0
  v_mfma_f32_16x16x32_bf16 v[112:115], a[120:123], v[136:139], v[112:115]
  v_readlane_b32 s52, v55, s50
  v_mfma_f32_16x16x32_bf16 v[112:115], a[108:111], v[96:99], v[112:115]
  v_mul_f32 v108, s42, v108
  v_mul_f32 v109, s42, v109
  v_mfma_f32_16x16x32_bf16 v[112:115], a[96:99], v[116:119], v[112:115]
  s_sub_u32 s52, 7, s52
  v_mul_f32 v110, s42, v110
  v_mul_f32 v111, s42, v111
  v_mfma_f32_16x16x32_bf16 v[112:115], a[84:87], v[92:95], v[112:115]
  v_cvt_pk_bf16_f32 v106, v108, v109
  v_cvt_pk_bf16_f32 v107, v110, v111
  v_mfma_f32_16x16x32_bf16 v[112:115], a[72:75], v[88:91], v[112:115]
  v_cmp_eq_u32 vcc, s52, v55
  v_mfma_f32_16x16x32_bf16 v[84:87], a[76:79], v[88:91], 0
  v_mfma_f32_16x16x32_bf16 v[84:87], a[88:91], v[92:95], v[84:87]
  s_ff1_i32_b32 s52, vcc_lo
  s_and_b32 s52, s52, 7
  v_readlane_b32 s53, v54, s52
  v_mfma_f32_16x16x32_bf16 v[84:87], a[100:103], v[116:119], v[84:87]
  v_cvt_pk_bf16_f32 v128, v112, v113
  v_cvt_pk_bf16_f32 v129, v114, v115
  v_mfma_f32_16x16x32_bf16 v[84:87], a[112:115], v[96:99], v[84:87]
  s_lshr_b32 s53, s53, 3
  s_add_u32 s53, s53, s49
  s_sub_u32 s49, s53, s12
  v_mfma_f32_16x16x32_bf16 v[84:87], a[124:127], v[136:139], v[84:87]
  s_cmp_gt_i32 s49, 0
  s_cselect_b32 s45, 2, 1
  s_cselect_b32 s12, s53, s12
  v_mfma_f32_16x16x32_bf16 v[84:87], a[136:139], v[80:83], v[84:87]
  s_cselect_b32 s53, s52, s50
  s_cselect_b32 s96, 1, 6
  s_lshl_b32 s96, s96, 11
  v_mfma_f32_16x16x32_bf16 v[108:111], a[140:143], v[80:83], 0
  s_abs_i32 s49, s49
  s_cmp_lt_u32 s49, 235
  s_cselect_b32 s51, 1, s51
  v_mfma_f32_16x16x32_bf16 v[108:111], a[128:131], v[136:139], v[108:111]
  s_cmp_lt_u32 s49, 400
  s_cselect_b32 s14, 8, 0
  s_xnor_b32 s13, s12, s14
  v_mfma_f32_16x16x32_bf16 v[108:111], a[116:119], v[96:99], v[108:111]
  s_cmp_eq_u32 s51, 0
  v_cvt_pk_bf16_f32 v130, v84, v85
  v_cvt_pk_bf16_f32 v131, v86, v87
  v_mfma_f32_16x16x32_bf16 v[108:111], a[104:107], v[116:119], v[108:111]
  s_cselect_b32 s45, s45, 0
  s_cselect_b32 s96, s96, 0
  s_andn2_b32 s51, s2, 7
  v_mfma_f32_16x16x32_bf16 v[108:111], a[92:95], v[92:95], v[108:111]
  s_add_u32 s51, s51, s53
  s_lshl_b32 s51, s51, 9
  s_add_u32 s44, s51, 2097152
  v_mfma_f32_16x16x32_bf16 v[108:111], a[80:83], v[88:91], v[108:111]
  s_lshr_b32 s49, s45, 1
  s_lshl_b32 s49, s49, s52
  s_lshl_b32 s49, s49, s14
  v_mfma_f32_16x16x32_bf16 v[84:87], v[88:91], a[144:147], 0
  s_lshl_b32 s54, s3, 2
  s_add_u32 s54, s54, 159808
  v_mov_b32 v54, s54
  v_mfma_f32_16x16x32_bf16 v[84:87], v[92:95], a[156:159], v[84:87]
  v_mov_b32 v55, s49
  v_mfma_f32_16x16x32_bf16 v[84:87], v[116:119], a[168:171], v[84:87]
  v_cvt_pk_bf16_f32 v132, v108, v109
  v_cvt_pk_bf16_f32 v133, v110, v111
  v_mfma_f32_16x16x32_bf16 v[84:87], v[96:99], a[180:183], v[84:87]
  ds_read_b128 a[244:247], v1 offset:22528
  v_mfma_f32_16x16x32_bf16 v[84:87], v[136:139], a[192:195], v[84:87]
  ds_read_b128 a[248:251], v0 offset:22528
  v_mfma_f32_16x16x32_bf16 v[84:87], v[80:83], a[204:207], v[84:87]
  ds_read_b128 a[252:255], v1 offset:14336
  v_mfma_f32_16x16x32_bf16 v[140:143], v[80:83], a[208:211], 0
  ds_read_b128 v[144:147], v0 offset:14336
  v_mfma_f32_16x16x32_bf16 v[140:143], v[136:139], a[196:199], v[140:143]
  ds_read_b128 v[148:151], v1 offset:6144
  v_mfma_f32_16x16x32_bf16 v[140:143], v[96:99], a[184:187], v[140:143]
  v_cvt_pk_bf16_f32 v108, v84, v85
  v_cvt_pk_bf16_f32 v109, v86, v87
  v_mfma_f32_16x16x32_bf16 v[140:143], v[116:119], a[172:175], v[140:143]
  ds_read_b128 v[152:155], v0 offset:6144
  v_mfma_f32_16x16x32_bf16 v[140:143], v[92:95], a[160:163], v[140:143]
  ds_write_b32 v54, v55
  v_mfma_f32_16x16x32_bf16 v[140:143], v[88:91], a[148:151], v[140:143]
  v_mfma_f32_16x16x32_bf16 v[156:159], v[88:91], a[152:155], 0
  v_mfma_f32_16x16x32_bf16 v[156:159], v[92:95], a[164:167], v[156:159]
  v_mfma_f32_16x16x32_bf16 v[156:159], v[116:119], a[176:179], v[156:159]
  s_waitcnt lgkmcnt(0)
  v_cvt_pk_bf16_f32 v112, v140, v141
  v_cvt_pk_bf16_f32 v113, v142, v143
  v_mfma_f32_16x16x32_bf16 v[156:159], v[96:99], a[188:191], v[156:159]
  s_branch L_r259
L_hop_2_1:
  s_cbranch_execz L_walk
L_pad3652:
L_k7:
  s_cmp_lg_u32 s59, 7
  s_cbranch_scc1 L_kh
  v_mfma_f32_16x16x32_bf16 v[104:107], a[0:3], v[88:91], 0
  s_waitcnt lgkmcnt(0)
  s_sub_u32 s49, s16, s18
  s_sub_u32 s50, s15, s60
  v_mfma_f32_16x16x32_bf16 v[104:107], a[12:15], v[92:95], v[104:107]
  s_add_u32 s50, s50, 45360
  s_mul_i32 s49, s49, s50
  s_mul_hi_u32 s49, s49, 384088
  v_mfma_f32_16x16x32_bf16 v[104:107], a[24:27], v[116:119], v[104:107]
  s_add_u32 s49, s49, s16
  v_cvt_pk_bf16_f32 v66, v132, v133
  v_cvt_pk_bf16_f32 v67, v134, v135
  v_mfma_f32_16x16x32_bf16 v[104:107], a[36:39], v[96:99], v[104:107]
  s_and_b32 s51, s2, 7
  s_lshl_b32 s51, s51, 3
  v_and_b32 v74, 56, v11
  v_mfma_f32_16x16x32_bf16 v[104:107], a[48:51], v[136:139], v[104:107]
  v_lshl_add_u32 v54, v74, 3, s51
  s_lshl_b32 s51, s51, 3
  v_mfma_f32_16x16x32_bf16 v[104:107], a[60:63], v[80:83], v[104:107]
  v_add_u32 v55, s51, v74
  v_mov_b32 v74, s49
  v_mfma_f32_16x16x32_bf16 v[84:87], a[64:67], v[80:83], 0
  buffer_store_dword v74, v54, s[20:23], s44 offen sc1
  v_mfma_f32_16x16x32_bf16 v[84:87], a[52:55], v[136:139], v[84:87]
  v_mfma_f32_16x16x32_bf16 v[84:87], a[40:43], v[96:99], v[84:87]
  v_mul_f32 v104, s42, v104
  v_mul_f32 v105, s42, v105
  v_mfma_f32_16x16x32_bf16 v[84:87], a[28:31], v[116:119], v[84:87]
  v_mul_f32 v106, s42, v106
  v_mul_f32 v107, s42, v107
  v_mfma_f32_16x16x32_bf16 v[84:87], a[16:19], v[92:95], v[84:87]
  v_cvt_pk_bf16_f32 v18, v104, v105
  v_cvt_pk_bf16_f32 v19, v106, v107
  v_mfma_f32_16x16x32_bf16 v[84:87], a[4:7], v[88:91], v[84:87]
  buffer_store_dword v74, v55, s[20:23], s44 offen offset:4 sc1
  v_mfma_f32_16x16x32_bf16 v[108:111], a[8:11], v[88:91], 0
  s_branch L_r220
L_hop_3_1:
  s_cbranch_execz L_walk
L_pad3694:
L_kh:
  s_cmp_lt_u32 s59, 14
  s_cbranch_scc1 L_k11
  s_waitcnt lgkmcnt(0)
  v_mfma_f32_16x16x32_bf16 v[104:107], a[132:135], v[80:83], 0
  s_lshl_b32 s5, s3, 3
  v_mfma_f32_16x16x32_bf16 v[104:107], a[120:123], v[136:139], v[104:107]
  s_add_u32 s5, s5, 159744
  v_mov_b32 v54, s5
  v_mfma_f32_16x16x32_bf16 v[104:107], a[108:111], v[96:99], v[104:107]
  v_cvt_pk_bf16_f32 v66, v132, v133
  v_cvt_pk_bf16_f32 v67, v134, v135
  v_mfma_f32_16x16x32_bf16 v[104:107], a[96:99], v[116:119], v[104:107]
  ds_read_b128 a[244:247], v1 offset:22528
  v_mfma_f32_16x16x32_bf16 v[104:107], a[84:87], v[92:95], v[104:107]
  ds_read_b128 a[248:251], v0 offset:22528
  v_mfma_f32_16x16x32_bf16 v[104:107], a[72:75], v[88:91], v[104:107]
  ds_read_b128 a[252:255], v1 offset:14336
  v_mfma_f32_16x16x32_bf16 v[108:111], a[76:79], v[88:91], 0
  ds_read_b128 v[84:87], v0 offset:14336
  v_mfma_f32_16x16x32_bf16 v[108:111], a[88:91], v[92:95], v[108:111]
  ds_read_b128 v[112:115], v1 offset:6144
  v_mfma_f32_16x16x32_bf16 v[108:111], a[100:103], v[116:119], v[108:111]
  v_cvt_pk_bf16_f32 v140, v104, v105
  v_cvt_pk_bf16_f32 v141, v106, v107
  v_mfma_f32_16x16x32_bf16 v[108:111], a[112:115], v[96:99], v[108:111]
  ds_read_b128 v[148:151], v0 offset:6144
  v_cndmask_b32 v160, v32, v48, s[100:101]
  v_mfma_f32_16x16x32_bf16 v[108:111], a[124:127], v[136:139], v[108:111]
  v_cndmask_b32 v161, v33, v49, s[100:101]
  v_cndmask_b32 v162, v34, v50, s[100:101]
  v_mfma_f32_16x16x32_bf16 v[108:111], a[136:139], v[80:83], v[108:111]
  v_cndmask_b32 v163, v35, v51, s[100:101]
  v_cndmask_b32 v164, v28, v44, s[100:101]
  v_mfma_f32_16x16x32_bf16 v[128:131], a[140:143], v[80:83], 0
  v_cndmask_b32 v165, v29, v45, s[100:101]
  v_cndmask_b32 v166, v30, v46, s[100:101]
  v_mfma_f32_16x16x32_bf16 v[128:131], a[128:131], v[136:139], v[128:131]
  v_cndmask_b32 v167, v31, v47, s[100:101]
  v_cndmask_b32 v104, v24, v40, s[100:101]
  v_mfma_f32_16x16x32_bf16 v[128:131], a[116:119], v[96:99], v[128:131]
  v_cvt_pk_bf16_f32 v142, v108, v109
  v_cvt_pk_bf16_f32 v143, v110, v111
  v_mfma_f32_16x16x32_bf16 v[128:131], a[104:107], v[116:119], v[128:131]
  v_cndmask_b32 v105, v25, v41, s[100:101]
  v_cndmask_b32 v106, v26, v42, s[100:101]
  v_mfma_f32_16x16x32_bf16 v[128:131], a[92:95], v[92:95], v[128:131]
  v_cndmask_b32 v107, v27, v43, s[100:101]
  v_mfma_f32_16x16x32_bf16 v[128:131], a[80:83], v[88:91], v[128:131]
  s_waitcnt lgkmcnt(0)
  v_mfma_f32_16x16x32_bf16 v[108:111], a[132:135], a[244:247], 0
  v_mfma_f32_16x16x32_bf16 v[108:111], a[120:123], a[248:251], v[108:111]
  v_mfma_f32_16x16x32_bf16 v[108:111], a[108:111], a[252:255], v[108:111]
  v_cvt_pk_bf16_f32 v144, v128, v129
  v_cvt_pk_bf16_f32 v145, v130, v131
  v_mfma_f32_16x16x32_bf16 v[108:111], a[96:99], v[84:87], v[108:111]
  v_mfma_f32_16x16x32_bf16 v[108:111], a[84:87], v[112:115], v[108:111]
  s_waitcnt lgkmcnt(0)
  s_barrier
  v_mfma_f32_16x16x32_bf16 v[108:111], a[72:75], v[148:151], v[108:111]
  v_mfma_f32_16x16x32_bf16 v[128:131], a[76:79], v[148:151], 0
  v_mfma_f32_16x16x32_bf16 v[128:131], a[88:91], v[112:115], v[128:131]
  v_mfma_f32_16x16x32_bf16 v[128:131], a[100:103], v[84:87], v[128:131]
  v_cvt_pk_bf16_f32 v152, v108, v109
  v_cvt_pk_bf16_f32 v153, v110, v111
  v_mfma_f32_16x16x32_bf16 v[128:131], a[112:115], a[252:255], v[128:131]
  v_mfma_f32_16x16x32_bf16 v[128:131], a[124:127], a[248:251], v[128:131]
  v_mfma_f32_16x16x32_bf16 v[128:131], a[136:139], a[244:247], v[128:131]
  v_mfma_f32_16x16x32_bf16 v[108:111], a[140:143], a[244:247], 0
  v_mfma_f32_16x16x32_bf16 v[108:111], a[128:131], a[248:251], v[108:111]
  v_mfma_f32_16x16x32_bf16 v[108:111], a[116:119], a[252:255], v[108:111]
  v_cvt_pk_bf16_f32 v154, v128, v129
  v_cvt_pk_bf16_f32 v155, v130, v131
  v_mfma_f32_16x16x32_bf16 v[108:111], a[104:107], v[84:87], v[108:111]
  v_mfma_f32_16x16x32_bf16 v[108:111], a[92:95], v[112:115], v[108:111]
  v_mfma_f32_16x16x32_bf16 v[108:111], a[80:83], v[148:151], v[108:111]
  v_mfma_f32_16x16x32_bf16 v[128:131], v[70:73], v[76:79], v[36:39]
  v_mfma_f32_16x16x32_bf16 v[128:131], v[68:71], v[12:15], v[128:131]
  v_mfma_f32_16x16x32_bf16 v[132:135], v[122:125], v[76:79], v[32:35]
  v_cvt_pk_bf16_f32 v156, v108, v109
  v_cvt_pk_bf16_f32 v157, v110, v111
  v_mfma_f32_16x16x32_bf16 v[132:135], v[120:123], v[12:15], v[132:135]
  v_mfma_f32_16x16x32_bf16 v[168:171], v[142:145], v[76:79], v[164:167]
  v_exp_f32 v128, v128
  v_mfma_f32_16x16x32_bf16 v[168:171], v[140:143], v[12:15], v[168:171]
  v_exp_f32 v129, v129
  v_mfma_f32_16x16x32_bf16 v[172:175], v[154:157], v[76:79], v[104:107]
  v_exp_f32 v130, v130
  v_mfma_f32_16x16x32_bf16 v[172:175], v[152:155], v[12:15], v[172:175]
  v_exp_f32 v131, v131
  v_mfma_f32_16x16x32_bf16 v[104:107], v[68:71], v[100:103], v[40:43]
  v_exp_f32 v132, v132
  v_mfma_f32_16x16x32_bf16 v[104:107], v[70:73], v[14:17], v[104:107]
  v_exp_f32 v133, v133
  v_mfma_f32_16x16x32_bf16 v[108:111], v[120:123], v[100:103], v[36:39]
  v_exp_f32 v134, v134
  v_mfma_f32_16x16x32_bf16 v[108:111], v[122:125], v[14:17], v[108:111]
  v_exp_f32 v135, v135
  v_mfma_f32_16x16x32_bf16 v[72:75], v[140:143], v[100:103], v[160:163]
  v_exp_f32 v168, v168
  v_mfma_f32_16x16x32_bf16 v[72:75], v[142:145], v[14:17], v[72:75]
  v_exp_f32 v169, v169
  v_mfma_f32_16x16x32_bf16 v[68:71], v[152:155], v[100:103], v[164:167]
  v_exp_f32 v170, v170
  v_mfma_f32_16x16x32_bf16 v[68:71], v[154:157], v[14:17], v[68:71]
  v_exp_f32 v171, v171
  v_mfma_f32_16x16x32_bf16 v[100:103], v[88:91], a[144:147], 0
  v_exp_f32 v172, v172
  v_mfma_f32_16x16x32_bf16 v[100:103], v[92:95], a[156:159], v[100:103]
  v_exp_f32 v173, v173
  v_mfma_f32_16x16x32_bf16 v[100:103], v[116:119], a[168:171], v[100:103]
  v_exp_f32 v174, v174
  v_mfma_f32_16x16x32_bf16 v[100:103], v[96:99], a[180:183], v[100:103]
  v_exp_f32 v175, v175
  v_mfma_f32_16x16x32_bf16 v[100:103], v[136:139], a[192:195], v[100:103]
  v_cvt_pk_bf16_f32 v128, v128, v129
  v_cvt_pk_bf16_f32 v129, v130, v131
  v_mfma_f32_16x16x32_bf16 v[100:103], v[80:83], a[204:207], v[100:103]
  v_cvt_pk_bf16_f32 v130, v132, v133
  v_cvt_pk_bf16_f32 v131, v134, v135
  v_mfma_f32_16x16x32_bf16 v[124:127], v[80:83], a[208:211], 0
  v_cvt_pk_bf16_f32 v132, v168, v169
  v_cvt_pk_bf16_f32 v133, v170, v171
  v_mfma_f32_16x16x32_bf16 v[124:127], v[136:139], a[196:199], v[124:127]
  v_cvt_pk_bf16_f32 v134, v172, v173
  v_cvt_pk_bf16_f32 v135, v174, v175
  v_mfma_f32_16x16x32_bf16 v[124:127], v[96:99], a[184:187], v[124:127]
  v_cvt_pk_bf16_f32 v76, v100, v101
  v_cvt_pk_bf16_f32 v77, v102, v103
  v_mfma_f32_16x16x32_bf16 v[124:127], v[116:119], a[172:175], v[124:127]
  v_exp_f32 v104, v104
  v_mfma_f32_16x16x32_bf16 v[124:127], v[92:95], a[160:163], v[124:127]
  v_exp_f32 v105, v105
  v_mfma_f32_16x16x32_bf16 v[124:127], v[88:91], a[148:151], v[124:127]
  v_exp_f32 v106, v106
  v_mfma_f32_16x16x32_bf16 v[100:103], v[88:91], a[152:155], 0
  v_exp_f32 v107, v107
  v_mfma_f32_16x16x32_bf16 v[100:103], v[92:95], a[164:167], v[100:103]
  v_exp_f32 v108, v108
  v_mfma_f32_16x16x32_bf16 v[100:103], v[116:119], a[176:179], v[100:103]
  v_cvt_pk_bf16_f32 v120, v124, v125
  v_cvt_pk_bf16_f32 v121, v126, v127
  v_mfma_f32_16x16x32_bf16 v[100:103], v[96:99], a[188:191], v[100:103]
  v_exp_f32 v109, v109
  v_mfma_f32_16x16x32_bf16 v[100:103], v[136:139], a[200:203], v[100:103]
  v_exp_f32 v110, v110
  v_mfma_f32_16x16x32_bf16 v[100:103], v[80:83], a[212:215], v[100:103]
  v_exp_f32 v111, v111
  v_mfma_f32_16x16x32_bf16 v[136:139], v[148:151], a[144:147], 0
  v_exp_f32 v72, v72
  v_mfma_f32_16x16x32_bf16 v[136:139], v[112:115], a[156:159], v[136:139]
  v_exp_f32 v73, v73
  v_mfma_f32_16x16x32_bf16 v[136:139], v[84:87], a[168:171], v[136:139]
  v_cvt_pk_bf16_f32 v124, v100, v101
  v_cvt_pk_bf16_f32 v125, v102, v103
  v_mfma_f32_16x16x32_bf16 v[136:139], a[252:255], a[180:183], v[136:139]
  ds_read_b128 v[80:83], v3 offset:0
  v_cvt_pk_bf16_f32 v104, v104, v105
  v_mfma_f32_16x16x32_bf16 v[136:139], a[248:251], a[192:195], v[136:139]
  ds_read_b128 v[88:91], v3 offset:4096
  v_cvt_pk_bf16_f32 v105, v106, v107
  v_mfma_f32_16x16x32_bf16 v[136:139], a[244:247], a[204:207], v[136:139]
  ds_read_b128 v[92:95], v3 offset:8192
  v_cvt_pk_bf16_f32 v106, v108, v109
  v_mfma_f32_16x16x32_bf16 v[140:143], a[244:247], a[208:211], 0
  ds_read_b128 v[96:99], v3 offset:12288
  v_cvt_pk_bf16_f32 v107, v110, v111
  v_mfma_f32_16x16x32_bf16 v[140:143], a[248:251], a[196:199], v[140:143]
  ds_read_b128 v[100:103], v3 offset:16384
  v_cvt_pk_bf16_f32 v108, v72, v73
  v_mfma_f32_16x16x32_bf16 v[140:143], a[252:255], a[184:187], v[140:143]
  v_cvt_pk_bf16_f32 v78, v136, v137
  v_cvt_pk_bf16_f32 v79, v138, v139
  v_mfma_f32_16x16x32_bf16 v[140:143], v[84:87], a[172:175], v[140:143]
  ds_read_b128 v[116:119], v3 offset:20480
  v_mfma_f32_16x16x32_bf16 v[140:143], v[112:115], a[160:163], v[140:143]
  v_exp_f32 v74, v74
  v_mfma_f32_16x16x32_bf16 v[140:143], v[148:151], a[148:151], v[140:143]
  v_exp_f32 v75, v75
  v_mfma_f32_16x16x32_bf16 v[144:147], v[148:151], a[152:155], 0
  v_exp_f32 v68, v68
  v_mfma_f32_16x16x32_bf16 v[144:147], v[112:115], a[164:167], v[144:147]
  v_exp_f32 v69, v69
  v_mfma_f32_16x16x32_bf16 v[144:147], v[84:87], a[176:179], v[144:147]
  v_cvt_pk_bf16_f32 v122, v140, v141
  v_cvt_pk_bf16_f32 v123, v142, v143
  v_mfma_f32_16x16x32_bf16 v[144:147], a[252:255], a[188:191], v[144:147]
  v_mov_b64 v[136:137], 0
  v_cvt_pk_bf16_f32 v109, v74, v75
  v_mfma_f32_16x16x32_bf16 v[144:147], a[248:251], a[200:203], v[144:147]
  v_exp_f32 v70, v70
  v_mfma_f32_16x16x32_bf16 v[144:147], a[244:247], a[212:215], v[144:147]
  s_waitcnt lgkmcnt(0)
  v_exp_f32 v71, v71
  v_mfma_f32_16x16x32_bf16 v[84:87], v[80:83], v[184:187], 0
  v_cvt_pk_bf16_f32 v110, v68, v69
  v_cvt_pk_bf16_f32 v111, v70, v71
  v_mfma_f32_16x16x32_bf16 v[84:87], v[88:91], v[200:203], v[84:87]
  v_mfma_f32_16x16x32_bf16 v[84:87], v[92:95], v[216:219], v[84:87]
  v_cvt_pk_bf16_f32 v126, v144, v145
  v_cvt_pk_bf16_f32 v127, v146, v147
  v_mfma_f32_16x16x32_bf16 v[84:87], v[96:99], v[232:235], v[84:87]
  v_mov_b64 v[68:69], 0
  v_mfma_f32_16x16x32_bf16 v[84:87], v[100:103], v[248:251], v[84:87]
  v_mfma_f32_16x16x32_bf16 v[84:87], v[116:119], a[224:227], v[84:87]
  v_smfmac_f32_16x16x64_bf16 v[136:139], a[240:243], v[128:135], v10
  v_mfma_f32_16x16x32_bf16 v[144:147], v[76:79], v[132:135], 0
  v_mfma_f32_16x16x32_bf16 v[144:147], v[56:59], v[128:131], v[144:147]
  v_mfma_f32_16x16x32_bf16 v[148:151], v[60:63], v[128:131], 0
  v_mfma_f32_16x16x32_bf16 v[148:151], v[120:123], v[132:135], v[148:151]
L_hop_0_2:
  s_cbranch_execz L_walk
  v_mfma_f32_16x16x32_bf16 v[140:143], v[124:127], v[132:135], 0
  v_add_f32 v136, v136, v137
  v_mfma_f32_16x16x32_bf16 v[140:143], v[64:67], v[128:131], v[140:143]
  v_rcp_f32 v138, v136
  v_smfmac_f32_16x16x64_bf16 v[68:71], a[240:243], v[104:111], v10
  v_mul_f32 v144, v138, v144
  v_mul_f32 v145, v138, v145
  v_mfma_f32_16x16x32_bf16 v[72:75], v[76:79], v[108:111], 0
  v_mul_f32 v146, v138, v146
  v_mul_f32 v147, v138, v147
  v_mfma_f32_16x16x32_bf16 v[72:75], v[56:59], v[104:107], v[72:75]
  v_cvt_pk_bf16_f32 v144, v144, v145
  v_cvt_pk_bf16_f32 v145, v146, v147
  v_mfma_f32_16x16x32_bf16 v[76:79], v[60:63], v[104:107], 0
  v_mul_f32 v148, v138, v148
  v_mul_f32 v149, v138, v149
  v_mfma_f32_16x16x32_bf16 v[76:79], v[120:123], v[108:111], v[76:79]
  v_mul_f32 v150, v138, v150
  v_mul_f32 v151, v138, v151
  v_mfma_f32_16x16x32_bf16 v[56:59], v[124:127], v[108:111], 0
  v_cvt_pk_bf16_f32 v148, v148, v149
  v_cvt_pk_bf16_f32 v149, v150, v151
  v_mfma_f32_16x16x32_bf16 v[56:59], v[64:67], v[104:107], v[56:59]
  v_mul_f32 v140, v138, v140
  v_mul_f32 v141, v138, v141
  v_mfma_f32_16x16x32_bf16 v[60:63], v[116:119], a[228:231], 0
  v_mul_f32 v142, v138, v142
  v_mul_f32 v143, v138, v143
  v_mfma_f32_16x16x32_bf16 v[60:63], v[100:103], v[252:255], v[60:63]
  v_cvt_pk_bf16_f32 v140, v140, v141
  v_cvt_pk_bf16_f32 v141, v142, v143
  v_mfma_f32_16x16x32_bf16 v[60:63], v[96:99], v[236:239], v[60:63]
  ds_read_b128 v[104:107], v4 offset:0
  ds_read_b128 v[108:111], v4 offset:4096
  v_mfma_f32_16x16x32_bf16 v[60:63], v[92:95], v[220:223], v[60:63]
  ds_read_b128 v[120:123], v4 offset:8192
  ds_read_b128 v[124:127], v4 offset:12288
  v_mfma_f32_16x16x32_bf16 v[60:63], v[88:91], v[204:207], v[60:63]
  ds_read_b128 v[128:131], v4 offset:16384
  ds_read_b128 v[132:135], v4 offset:20480
  v_mfma_f32_16x16x32_bf16 v[60:63], v[80:83], v[188:191], v[60:63]
  v_max3_f32 v9, v136, v138, v9
  v_add_f32 v68, v68, v69
  v_mfma_f32_16x16x32_bf16 v[112:115], v[80:83], v[192:195], 0
  ds_write2st64_b32 v5, v144, v145 offset0:0 offset1:4
  v_mfma_f32_16x16x32_bf16 v[112:115], v[88:91], v[208:211], v[112:115]
  ds_write2st64_b32 v5, v148, v149 offset0:8 offset1:12
  v_mfma_f32_16x16x32_bf16 v[112:115], v[92:95], v[224:227], v[112:115]
  v_cvt_pk_bf16_f32 v84, v84, v60
  v_cvt_pk_bf16_f32 v85, v85, v61
  v_mfma_f32_16x16x32_bf16 v[112:115], v[96:99], v[240:243], v[112:115]
  v_cvt_pk_bf16_f32 v86, v86, v62
  v_cvt_pk_bf16_f32 v87, v87, v63
  v_mfma_f32_16x16x32_bf16 v[112:115], v[100:103], a[216:219], v[112:115]
  buffer_store_dword v84, v7, s[24:27], s33 offen offset:0 nt
  v_mfma_f32_16x16x32_bf16 v[112:115], v[116:119], a[232:235], v[112:115]
  ds_write2st64_b32 v5, v140, v141 offset0:16 offset1:20
  v_mfma_f32_16x16x32_bf16 v[136:139], v[116:119], a[236:239], 0
  v_rcp_f32 v70, v68
  v_mfma_f32_16x16x32_bf16 v[136:139], v[100:103], a[220:223], v[136:139]
  buffer_store_dword v85, v7, s[24:27], s33 offen offset:384 nt
  v_mfma_f32_16x16x32_bf16 v[136:139], v[96:99], v[244:247], v[136:139]
  ds_read_b128 a[244:247], v3 offset:512
  ds_read_b128 a[248:251], v3 offset:4608
  v_mfma_f32_16x16x32_bf16 v[136:139], v[92:95], v[228:231], v[136:139]
  ds_read_b128 a[252:255], v3 offset:8704
  ds_read_b128 v[60:63], v3 offset:12800
  v_mfma_f32_16x16x32_bf16 v[136:139], v[88:91], v[212:215], v[136:139]
  buffer_store_dword v86, v7, s[24:27], s33 offen offset:768 nt
  v_mfma_f32_16x16x32_bf16 v[136:139], v[80:83], v[196:199], v[136:139]
  s_waitcnt lgkmcnt(7)
  ds_read_b128 v[64:67], v3 offset:16896
  ds_read_b128 v[88:91], v3 offset:20992
  v_mfma_f32_16x16x32_bf16 v[92:95], v[104:107], v[184:187], 0
  v_mul_f32 v72, v70, v72
  v_mul_f32 v73, v70, v73
  v_mfma_f32_16x16x32_bf16 v[92:95], v[108:111], v[200:203], v[92:95]
  buffer_store_dword v87, v7, s[24:27], s33 offen offset:1152 nt
  v_mfma_f32_16x16x32_bf16 v[92:95], v[120:123], v[216:219], v[92:95]
  v_cvt_pk_bf16_f32 v112, v112, v136
  v_cvt_pk_bf16_f32 v113, v113, v137
  v_mfma_f32_16x16x32_bf16 v[92:95], v[124:127], v[232:235], v[92:95]
  v_cvt_pk_bf16_f32 v114, v114, v138
  v_cvt_pk_bf16_f32 v115, v115, v139
  v_mfma_f32_16x16x32_bf16 v[92:95], v[128:131], v[248:251], v[92:95]
  buffer_store_dword v112, v8, s[24:27], s33 offen offset:0 nt
  v_mfma_f32_16x16x32_bf16 v[92:95], v[132:135], a[224:227], v[92:95]
  v_mul_f32 v74, v70, v74
  v_mul_f32 v75, v70, v75
  v_mfma_f32_16x16x32_bf16 v[80:83], v[132:135], a[228:231], 0
  v_cvt_pk_bf16_f32 v72, v72, v73
  v_cvt_pk_bf16_f32 v73, v74, v75
  v_mfma_f32_16x16x32_bf16 v[80:83], v[128:131], v[252:255], v[80:83]
  buffer_store_dword v113, v8, s[24:27], s33 offen offset:384 nt
  v_mfma_f32_16x16x32_bf16 v[80:83], v[124:127], v[236:239], v[80:83]
  v_mul_f32 v76, v70, v76
  v_mul_f32 v77, v70, v77
  v_mfma_f32_16x16x32_bf16 v[80:83], v[120:123], v[220:223], v[80:83]
  v_mul_f32 v78, v70, v78
  v_mul_f32 v79, v70, v79
  v_mfma_f32_16x16x32_bf16 v[80:83], v[108:111], v[204:207], v[80:83]
  buffer_store_dword v114, v8, s[24:27], s33 offen offset:768 nt
  v_mfma_f32_16x16x32_bf16 v[80:83], v[104:107], v[188:191], v[80:83]
  s_waitcnt lgkmcnt(0)
  v_cvt_pk_bf16_f32 v76, v76, v77
  v_cvt_pk_bf16_f32 v77, v78, v79
  v_mfma_f32_16x16x32_bf16 v[84:87], a[244:247], v[184:187], 0
  v_mul_f32 v56, v70, v56
  v_mul_f32 v57, v70, v57
  v_mfma_f32_16x16x32_bf16 v[84:87], a[248:251], v[200:203], v[84:87]
  buffer_store_dword v115, v8, s[24:27], s33 offen offset:1152 nt
  v_mfma_f32_16x16x32_bf16 v[84:87], a[252:255], v[216:219], v[84:87]
  s_add_u32 s33, s33, s98
  v_cvt_pk_bf16_f32 v92, v92, v80
  v_cvt_pk_bf16_f32 v93, v93, v81
  v_mfma_f32_16x16x32_bf16 v[84:87], v[60:63], v[232:235], v[84:87]
  v_cvt_pk_bf16_f32 v94, v94, v82
  v_cvt_pk_bf16_f32 v95, v95, v83
  v_mfma_f32_16x16x32_bf16 v[84:87], v[64:67], v[248:251], v[84:87]
  buffer_store_dword v92, v7, s[24:27], s34 offen offset:0 nt
  v_mfma_f32_16x16x32_bf16 v[84:87], v[88:91], a[224:227], v[84:87]
  v_mul_f32 v58, v70, v58
  v_mul_f32 v59, v70, v59
  v_mfma_f32_16x16x32_bf16 v[96:99], v[88:91], a[228:231], 0
  v_cvt_pk_bf16_f32 v56, v56, v57
  v_cvt_pk_bf16_f32 v57, v58, v59
  v_mfma_f32_16x16x32_bf16 v[96:99], v[64:67], v[252:255], v[96:99]
  buffer_store_dword v93, v7, s[24:27], s34 offen offset:384 nt
  v_mfma_f32_16x16x32_bf16 v[96:99], v[60:63], v[236:239], v[96:99]
  ds_read_b128 v[80:83], v4 offset:512
  v_max3_f32 v9, v68, v70, v9
  v_mfma_f32_16x16x32_bf16 v[96:99], a[252:255], v[220:223], v[96:99]
  ds_write2st64_b32 v5, v72, v73 offset0:1 offset1:5
  v_mfma_f32_16x16x32_bf16 v[96:99], a[248:251], v[204:207], v[96:99]
  buffer_store_dword v94, v7, s[24:27], s34 offen offset:768 nt
  v_mfma_f32_16x16x32_bf16 v[96:99], a[244:247], v[188:191], v[96:99]
  ds_write2st64_b32 v5, v76, v77 offset0:9 offset1:13
  v_mfma_f32_16x16x32_bf16 v[68:71], a[244:247], v[192:195], 0
  ds_write2st64_b32 v5, v56, v57 offset0:17 offset1:21
  v_mfma_f32_16x16x32_bf16 v[68:71], a[248:251], v[208:211], v[68:71]
  buffer_store_dword v95, v7, s[24:27], s34 offen offset:1152 nt
  v_mfma_f32_16x16x32_bf16 v[68:71], a[252:255], v[224:227], v[68:71]
  s_add_u32 s34, s34, s98
  v_cvt_pk_bf16_f32 v84, v84, v96
  v_cvt_pk_bf16_f32 v85, v85, v97
  v_mfma_f32_16x16x32_bf16 v[68:71], v[60:63], v[240:243], v[68:71]
  v_cvt_pk_bf16_f32 v86, v86, v98
  v_cvt_pk_bf16_f32 v87, v87, v99
  v_mfma_f32_16x16x32_bf16 v[68:71], v[64:67], a[216:219], v[68:71]
  buffer_store_dword v84, v7, s[24:27], s35 offen offset:0 nt
  v_mfma_f32_16x16x32_bf16 v[68:71], v[88:91], a[232:235], v[68:71]
  ds_read_b128 v[72:75], v4 offset:4608
  v_cmp_nge_f32 vcc, 0x53800000, v9
  v_mfma_f32_16x16x32_bf16 v[100:103], v[88:91], a[236:239], 0
  ds_read_b128 v[92:95], v4 offset:8704
  ds_read_b128 v[96:99], v4 offset:12800
  v_mfma_f32_16x16x32_bf16 v[100:103], v[64:67], a[220:223], v[100:103]
  buffer_store_dword v85, v7, s[24:27], s35 offen offset:384 nt
  v_mfma_f32_16x16x32_bf16 v[100:103], v[60:63], v[244:247], v[100:103]
  s_or_b32 s6, vcc_lo, vcc_hi
  ds_read_b128 v[76:79], v4 offset:16896
  v_mov_b32 v55, s6
  v_mfma_f32_16x16x32_bf16 v[100:103], a[252:255], v[228:231], v[100:103]
  ds_write_b32 v54, v55
  v_mfma_f32_16x16x32_bf16 v[100:103], a[248:251], v[212:215], v[100:103]
  buffer_store_dword v86, v7, s[24:27], s35 offen offset:768 nt
  v_mfma_f32_16x16x32_bf16 v[100:103], a[244:247], v[196:199], v[100:103]
  s_waitcnt lgkmcnt(8)
  ds_read_b128 v[64:67], v4 offset:20992
  v_xor_b32 v3, 40960, v3
  v_xor_b32 v4, 40960, v4
  v_mfma_f32_16x16x32_bf16 v[56:59], v[80:83], v[184:187], 0
  s_waitcnt lgkmcnt(1)
  s_barrier
  v_mfma_f32_16x16x32_bf16 v[56:59], v[72:75], v[200:203], v[56:59]
  buffer_store_dword v87, v7, s[24:27], s35 offen offset:1152 nt
  v_mfma_f32_16x16x32_bf16 v[56:59], v[92:95], v[216:219], v[56:59]
  s_waitcnt lgkmcnt(0)
  v_cvt_pk_bf16_f32 v68, v68, v100
  v_cvt_pk_bf16_f32 v69, v69, v101
  v_mfma_f32_16x16x32_bf16 v[56:59], v[96:99], v[232:235], v[56:59]
  v_cvt_pk_bf16_f32 v70, v70, v102
  v_cvt_pk_bf16_f32 v71, v71, v103
  v_mfma_f32_16x16x32_bf16 v[56:59], v[76:79], v[248:251], v[56:59]
  buffer_store_dword v68, v8, s[24:27], s35 offen offset:0 nt
  v_mfma_f32_16x16x32_bf16 v[56:59], v[64:67], a[224:227], v[56:59]
  ds_read_b128 a[244:247], v3 offset:0
  ds_read_b128 a[248:251], v3 offset:4096
  v_mfma_f32_16x16x32_bf16 v[84:87], v[64:67], a[228:231], 0
  ds_read_b128 a[252:255], v3 offset:8192
  ds_read_b128 v[60:63], v3 offset:12288
  v_mfma_f32_16x16x32_bf16 v[84:87], v[76:79], v[252:255], v[84:87]
  buffer_store_dword v69, v8, s[24:27], s35 offen offset:384 nt
  v_mfma_f32_16x16x32_bf16 v[84:87], v[96:99], v[236:239], v[84:87]
  ds_read_b128 v[64:67], v3 offset:16384
  ds_read_b128 v[76:79], v3 offset:20480
  v_mfma_f32_16x16x32_bf16 v[84:87], v[92:95], v[220:223], v[84:87]
  v_mov_b32 v54, 159744
  v_mfma_f32_16x16x32_bf16 v[84:87], v[72:75], v[204:207], v[84:87]
  buffer_store_dword v70, v8, s[24:27], s35 offen offset:768 nt
  v_mfma_f32_16x16x32_bf16 v[84:87], v[80:83], v[188:191], v[84:87]
  s_waitcnt lgkmcnt(2)
  ds_read2_b32 v[88:89], v54 offset0:0 offset1:2
  ds_read2_b32 v[90:91], v54 offset0:4 offset1:6
  v_mfma_f32_16x16x32_bf16 v[72:75], a[244:247], v[184:187], 0
  v_mfma_f32_16x16x32_bf16 v[72:75], a[248:251], v[200:203], v[72:75]
  buffer_store_dword v71, v8, s[24:27], s35 offen offset:1152 nt
  v_mfma_f32_16x16x32_bf16 v[72:75], a[252:255], v[216:219], v[72:75]
  v_cvt_pk_bf16_f32 v56, v56, v84
  v_cvt_pk_bf16_f32 v57, v57, v85
  v_mfma_f32_16x16x32_bf16 v[72:75], v[60:63], v[232:235], v[72:75]
  s_waitcnt lgkmcnt(2)
  v_cvt_pk_bf16_f32 v58, v58, v86
  v_cvt_pk_bf16_f32 v59, v59, v87
  v_mfma_f32_16x16x32_bf16 v[72:75], v[64:67], v[248:251], v[72:75]
  buffer_store_dword v56, v7, s[24:27], s36 offen offset:0 nt
  v_mfma_f32_16x16x32_bf16 v[72:75], v[76:79], a[224:227], v[72:75]
  s_waitcnt lgkmcnt(0)
  v_or3_b32 v88, v88, v89, v90
  v_or_b32 v88, v88, v91
  v_mfma_f32_16x16x32_bf16 v[104:107], v[76:79], a[228:231], 0
  v_readfirstlane_b32 s49, v88
  v_mfma_f32_16x16x32_bf16 v[104:107], v[64:67], v[252:255], v[104:107]
  buffer_store_dword v57, v7, s[24:27], s36 offen offset:384 nt
  v_mfma_f32_16x16x32_bf16 v[104:107], v[60:63], v[236:239], v[104:107]
  ds_read_b128 v[68:71], v4 offset:0
  ds_read_b128 v[80:83], v4 offset:4096
  v_mfma_f32_16x16x32_bf16 v[104:107], a[252:255], v[220:223], v[104:107]
  ds_read_b128 v[84:87], v4 offset:8192
  ds_read_b128 v[88:91], v4 offset:12288
  v_mfma_f32_16x16x32_bf16 v[104:107], a[248:251], v[204:207], v[104:107]
  buffer_store_dword v58, v7, s[24:27], s36 offen offset:768 nt
  v_mfma_f32_16x16x32_bf16 v[104:107], a[244:247], v[188:191], v[104:107]
  ds_read_b128 v[96:99], v4 offset:16384
  ds_read_b128 v[100:103], v4 offset:20480
  v_mfma_f32_16x16x32_bf16 v[92:95], a[244:247], v[192:195], 0
  v_mfma_f32_16x16x32_bf16 v[92:95], a[248:251], v[208:211], v[92:95]
  buffer_store_dword v59, v7, s[24:27], s36 offen offset:1152 nt
  v_mfma_f32_16x16x32_bf16 v[92:95], a[252:255], v[224:227], v[92:95]
  v_cvt_pk_bf16_f32 v72, v72, v104
  v_cvt_pk_bf16_f32 v73, v73, v105
  v_mfma_f32_16x16x32_bf16 v[92:95], v[60:63], v[240:243], v[92:95]
  v_cvt_pk_bf16_f32 v74, v74, v106
  v_cvt_pk_bf16_f32 v75, v75, v107
  v_mfma_f32_16x16x32_bf16 v[92:95], v[64:67], a[216:219], v[92:95]
  buffer_store_dword v72, v7, s[24:27], s33 offen offset:0 nt
  v_mfma_f32_16x16x32_bf16 v[92:95], v[76:79], a[232:235], v[92:95]
  v_mfma_f32_16x16x32_bf16 v[104:107], v[76:79], a[236:239], 0
  v_mfma_f32_16x16x32_bf16 v[104:107], v[64:67], a[220:223], v[104:107]
  buffer_store_dword v73, v7, s[24:27], s33 offen offset:384 nt
  v_mfma_f32_16x16x32_bf16 v[104:107], v[60:63], v[244:247], v[104:107]
  v_mfma_f32_16x16x32_bf16 v[104:107], a[252:255], v[228:231], v[104:107]
  v_mfma_f32_16x16x32_bf16 v[104:107], a[248:251], v[212:215], v[104:107]
  buffer_store_dword v74, v7, s[24:27], s33 offen offset:768 nt
  v_mfma_f32_16x16x32_bf16 v[104:107], a[244:247], v[196:199], v[104:107]
  s_waitcnt lgkmcnt(0)
  v_mfma_f32_16x16x32_bf16 v[56:59], v[68:71], v[184:187], 0
  v_mfma_f32_16x16x32_bf16 v[56:59], v[80:83], v[200:203], v[56:59]
  buffer_store_dword v75, v7, s[24:27], s33 offen offset:1152 nt
  v_mfma_f32_16x16x32_bf16 v[56:59], v[84:87], v[216:219], v[56:59]
  v_cvt_pk_bf16_f32 v92, v92, v104
  v_cvt_pk_bf16_f32 v93, v93, v105
  v_mfma_f32_16x16x32_bf16 v[56:59], v[88:91], v[232:235], v[56:59]
  v_cvt_pk_bf16_f32 v94, v94, v106
  v_cvt_pk_bf16_f32 v95, v95, v107
  v_mfma_f32_16x16x32_bf16 v[56:59], v[96:99], v[248:251], v[56:59]
  buffer_store_dword v92, v8, s[24:27], s33 offen offset:0 nt
  v_mfma_f32_16x16x32_bf16 v[56:59], v[100:103], a[224:227], v[56:59]
  v_mfma_f32_16x16x32_bf16 v[60:63], v[100:103], a[228:231], 0
  v_mfma_f32_16x16x32_bf16 v[60:63], v[96:99], v[252:255], v[60:63]
  buffer_store_dword v93, v8, s[24:27], s33 offen offset:384 nt
  v_mfma_f32_16x16x32_bf16 v[60:63], v[88:91], v[236:239], v[60:63]
  v_mfma_f32_16x16x32_bf16 v[60:63], v[84:87], v[220:223], v[60:63]
  v_mfma_f32_16x16x32_bf16 v[60:63], v[80:83], v[204:207], v[60:63]
  buffer_store_dword v94, v8, s[24:27], s33 offen offset:768 nt
  v_mfma_f32_16x16x32_bf16 v[60:63], v[68:71], v[188:191], v[60:63]
  buffer_store_dword v95, v8, s[24:27], s33 offen offset:1152 nt
  s_nop 6
  v_cvt_pk_bf16_f32 v56, v56, v60
  v_cvt_pk_bf16_f32 v57, v57, v61
  v_cvt_pk_bf16_f32 v58, v58, v62
  v_cvt_pk_bf16_f32 v59, v59, v63
  buffer_store_dword v56, v7, s[24:27], s34 offen offset:0 nt
  buffer_store_dword v57, v7, s[24:27], s34 offen offset:384 nt
  buffer_store_dword v58, v7, s[24:27], s34 offen offset:768 nt
  buffer_store_dword v59, v7, s[24:27], s34 offen offset:1152 nt
  s_cmp_lg_u32 s49, 0
  s_cbranch_scc1 L_safe
  s_endpgm
L_hop_1_2:
  s_cbranch_execz L_walk
L_pad4194:
L_k11:
  s_cmp_lg_u32 s59, 11
  s_cbranch_scc1 L_k12
  v_mfma_f32_16x16x32_bf16 v[104:107], a[0:3], v[88:91], 0
  v_mov_b32 v54, s12
  v_mov_b32 v55, s13
  v_mfma_f32_16x16x32_bf16 v[104:107], a[12:15], v[92:95], v[104:107]
  v_mov_b32 v74, 159808
  v_mfma_f32_16x16x32_bf16 v[104:107], a[24:27], v[116:119], v[104:107]
  v_cvt_pk_bf16_f32 v66, v132, v133
  v_cvt_pk_bf16_f32 v67, v134, v135
  v_mfma_f32_16x16x32_bf16 v[104:107], a[36:39], v[96:99], v[104:107]
  ds_read_b128 v[112:115], v74
  v_mfma_f32_16x16x32_bf16 v[104:107], a[48:51], v[136:139], v[104:107]
  s_waitcnt lgkmcnt(1)
  v_mfma_f32_16x16x32_bf16 v[104:107], a[60:63], v[80:83], v[104:107]
  v_mfma_f32_16x16x32_bf16 v[84:87], a[64:67], v[80:83], 0
  v_mfma_f32_16x16x32_bf16 v[84:87], a[52:55], v[136:139], v[84:87]
  v_mfma_f32_16x16x32_bf16 v[84:87], a[40:43], v[96:99], v[84:87]
  s_waitcnt lgkmcnt(0)
  v_mul_f32 v104, s42, v104
  v_mul_f32 v105, s42, v105
  v_mfma_f32_16x16x32_bf16 v[84:87], a[28:31], v[116:119], v[84:87]
  v_mul_f32 v106, s42, v106
  v_mul_f32 v107, s42, v107
  v_mfma_f32_16x16x32_bf16 v[84:87], a[16:19], v[92:95], v[84:87]
  v_cvt_pk_bf16_f32 v18, v104, v105
  v_cvt_pk_bf16_f32 v19, v106, v107
  v_mfma_f32_16x16x32_bf16 v[84:87], a[4:7], v[88:91], v[84:87]
  v_and_b32 v112, v112, v113
  v_and_b32 v114, v114, v115
  v_mfma_f32_16x16x32_bf16 v[108:111], a[8:11], v[88:91], 0
  v_and_b32 v112, v112, v114
  v_mfma_f32_16x16x32_bf16 v[108:111], a[20:23], v[92:95], v[108:111]
  v_readfirstlane_b32 s49, v112
  v_mfma_f32_16x16x32_bf16 v[108:111], a[32:35], v[116:119], v[108:111]
  v_mul_f32 v84, s42, v84
  v_mul_f32 v85, s42, v85
  v_mfma_f32_16x16x32_bf16 v[108:111], a[44:47], v[96:99], v[108:111]
  s_cmp_lg_u32 s49, 0
  v_mul_f32 v86, s42, v86
  v_mul_f32 v87, s42, v87
  v_mfma_f32_16x16x32_bf16 v[108:111], a[56:59], v[136:139], v[108:111]
  s_cselect_b32 s49, s44, s22
  v_cvt_pk_bf16_f32 v104, v84, v85
  v_cvt_pk_bf16_f32 v105, v86, v87
  v_mfma_f32_16x16x32_bf16 v[108:111], a[68:71], v[80:83], v[108:111]
  s_cselect_b32 s96, 4096, 0
  v_mfma_f32_16x16x32_bf16 v[112:115], a[132:135], v[80:83], 0
  buffer_store_dwordx2 v[54:55], off, s[20:23], s49 sc1
  v_mfma_f32_16x16x32_bf16 v[112:115], a[120:123], v[136:139], v[112:115]
  s_branch L_r227
L_k12:
  s_cmp_lg_u32 s45, 2
  s_cbranch_scc1 L_k12g
  v_mfma_f32_16x16x32_bf16 v[104:107], a[0:3], v[88:91], 0
  s_sub_u32 s49, s44, 2097152
  s_lshr_b32 s49, s49, 9
  s_lshr_b32 s52, s49, 6
  v_mfma_f32_16x16x32_bf16 v[104:107], a[12:15], v[92:95], v[104:107]
  s_and_b32 s53, s49, 63
  s_mul_i32 s50, s52, 15
  s_lshl_b32 s51, s57, 5
  v_mfma_f32_16x16x32_bf16 v[104:107], a[24:27], v[116:119], v[104:107]
  s_cmp_eq_u32 s53, 63
  v_cvt_pk_bf16_f32 v66, v132, v133
  v_cvt_pk_bf16_f32 v67, v134, v135
  v_mfma_f32_16x16x32_bf16 v[104:107], a[36:39], v[96:99], v[104:107]
  s_cselect_b32 s53, s50, s53
  s_cselect_b32 s52, 60, s52
  s_cselect_b32 s51, 3072, s51
  v_mfma_f32_16x16x32_bf16 v[104:107], a[48:51], v[136:139], v[104:107]
  s_waitcnt lgkmcnt(0)
  s_mul_i32 s52, s52, 1572864
  s_mul_i32 s53, s53, 3072
  v_mfma_f32_16x16x32_bf16 v[104:107], a[60:63], v[80:83], v[104:107]
  s_add_u32 s52, s52, s53
  s_add_u32 s50, s52, 787968
  s_cmp_eq_u32 s51, 3072
  v_mfma_f32_16x16x32_bf16 v[84:87], a[64:67], v[80:83], 0
  s_cselect_b32 s10, 100663296, s10
  s_sub_u32 s51, s51, s43
  s_mul_i32 s51, s51, 14
  v_mfma_f32_16x16x32_bf16 v[84:87], a[52:55], v[136:139], v[84:87]
  s_sub_u32 s50, s50, s56
  s_add_u32 s58, s50, s51
  s_mul_i32 s50, s14, 98304
  v_mfma_f32_16x16x32_bf16 v[84:87], a[40:43], v[96:99], v[84:87]
  s_add_u32 s98, s58, s50
  v_mul_f32 v104, s42, v104
  v_mul_f32 v105, s42, v105
  v_mfma_f32_16x16x32_bf16 v[84:87], a[28:31], v[116:119], v[84:87]
  s_sub_u32 s49, s98, s43
  v_mul_f32 v106, s42, v106
  v_mul_f32 v107, s42, v107
  v_mfma_f32_16x16x32_bf16 v[84:87], a[16:19], v[92:95], v[84:87]
  s_add_u32 s31, s31, s49
  v_cvt_pk_bf16_f32 v18, v104, v105
  v_cvt_pk_bf16_f32 v19, v106, v107
  v_mfma_f32_16x16x32_bf16 v[84:87], a[4:7], v[88:91], v[84:87]
  s_add_u32 s32, s32, s49
  s_lshl_b32 s50, s50, 1
  s_sub_u32 s32, s32, s50
  v_mfma_f32_16x16x32_bf16 v[108:111], a[8:11], v[88:91], 0
  s_sub_u32 s37, s37, s49
  s_sub_u32 s38, s38, s49
  s_sub_u32 s39, s39, s49
  v_mfma_f32_16x16x32_bf16 v[108:111], a[20:23], v[92:95], v[108:111]
  s_sub_u32 s40, s40, s49
  s_add_u32 s97, s97, s98
  s_mov_b32 s45, 4
  v_mfma_f32_16x16x32_bf16 v[108:111], a[32:35], v[116:119], v[108:111]
  s_lshl_b32 s96, s14, 12
  v_mul_f32 v84, s42, v84
  v_mul_f32 v85, s42, v85
  v_mfma_f32_16x16x32_bf16 v[108:111], a[44:47], v[96:99], v[108:111]
  s_mov_b64 s[100:101], -1
  v_mul_f32 v86, s42, v86
  v_mul_f32 v87, s42, v87
  v_mfma_f32_16x16x32_bf16 v[108:111], a[56:59], v[136:139], v[108:111]
  v_cvt_pk_bf16_f32 v104, v84, v85
  v_cvt_pk_bf16_f32 v105, v86, v87
  v_mfma_f32_16x16x32_bf16 v[108:111], a[68:71], v[80:83], v[108:111]
  s_branch L_r225
L_k12g:
  s_cmp_lg_u32 s59, 12
  s_cbranch_scc1 L_k13
  s_waitcnt vmcnt(30)
  v_mfma_f32_16x16x32_bf16 v[104:107], a[0:3], v[88:91], 0
  v_cmp_eq_u64 vcc, s[12:13], v[52:53]
  v_mfma_f32_16x16x32_bf16 v[104:107], a[12:15], v[92:95], v[104:107]
  v_mfma_f32_16x16x32_bf16 v[104:107], a[24:27], v[116:119], v[104:107]
  s_and_b32 s49, vcc_lo, 1
  v_cvt_pk_bf16_f32 v66, v132, v133
  v_cvt_pk_bf16_f32 v67, v134, v135
  v_mfma_f32_16x16x32_bf16 v[104:107], a[36:39], v[96:99], v[104:107]
  s_lshl_b32 s49, s49, s14
  s_lshl_b32 s54, s3, 2
  s_add_u32 s54, s54, 159824
  v_mfma_f32_16x16x32_bf16 v[104:107], a[48:51], v[136:139], v[104:107]
  s_waitcnt lgkmcnt(0)
  v_mov_b32 v54, s54
  v_mov_b32 v55, s49
  v_mfma_f32_16x16x32_bf16 v[104:107], a[60:63], v[80:83], v[104:107]
  ds_write_b32 v54, v55
  v_mfma_f32_16x16x32_bf16 v[84:87], a[64:67], v[80:83], 0
  v_mfma_f32_16x16x32_bf16 v[84:87], a[52:55], v[136:139], v[84:87]
  v_mfma_f32_16x16x32_bf16 v[84:87], a[40:43], v[96:99], v[84:87]
  v_mul_f32 v104, s42, v104
  v_mul_f32 v105, s42, v105
  v_mfma_f32_16x16x32_bf16 v[84:87], a[28:31], v[116:119], v[84:87]
  s_waitcnt lgkmcnt(0)
  v_mul_f32 v106, s42, v106
  v_mul_f32 v107, s42, v107
  v_mfma_f32_16x16x32_bf16 v[84:87], a[16:19], v[92:95], v[84:87]
  v_cvt_pk_bf16_f32 v18, v104, v105
  v_cvt_pk_bf16_f32 v19, v106, v107
  v_mfma_f32_16x16x32_bf16 v[84:87], a[4:7], v[88:91], v[84:87]
  s_branch L_r219
L_k13:
  v_mfma_f32_16x16x32_bf16 v[104:107], a[0:3], v[88:91], 0
  v_mov_b32 v54, 159824
  v_mfma_f32_16x16x32_bf16 v[104:107], a[12:15], v[92:95], v[104:107]
  ds_read_b128 v[112:115], v54
  v_mfma_f32_16x16x32_bf16 v[104:107], a[24:27], v[116:119], v[104:107]
  v_cvt_pk_bf16_f32 v66, v132, v133
  v_cvt_pk_bf16_f32 v67, v134, v135
  v_mfma_f32_16x16x32_bf16 v[104:107], a[36:39], v[96:99], v[104:107]
  v_mfma_f32_16x16x32_bf16 v[104:107], a[48:51], v[136:139], v[104:107]
  s_waitcnt lgkmcnt(1)
  v_mfma_f32_16x16x32_bf16 v[104:107], a[60:63], v[80:83], v[104:107]
  v_mfma_f32_16x16x32_bf16 v[84:87], a[64:67], v[80:83], 0
  s_waitcnt lgkmcnt(0)
  v_and_b32 v112, v112, v113
  v_and_b32 v114, v114, v115
  v_mfma_f32_16x16x32_bf16 v[84:87], a[52:55], v[136:139], v[84:87]
  v_and_b32 v112, v112, v114
  v_mfma_f32_16x16x32_bf16 v[84:87], a[40:43], v[96:99], v[84:87]
  v_mul_f32 v104, s42, v104
  v_mul_f32 v105, s42, v105
  v_mfma_f32_16x16x32_bf16 v[84:87], a[28:31], v[116:119], v[84:87]
  v_mul_f32 v106, s42, v106
  v_mul_f32 v107, s42, v107
  v_mfma_f32_16x16x32_bf16 v[84:87], a[16:19], v[92:95], v[84:87]
  v_cvt_pk_bf16_f32 v18, v104, v105
  v_cvt_pk_bf16_f32 v19, v106, v107
  v_mfma_f32_16x16x32_bf16 v[84:87], a[4:7], v[88:91], v[84:87]
  v_readfirstlane_b32 s49, v112
  v_mfma_f32_16x16x32_bf16 v[108:111], a[8:11], v[88:91], 0
  v_mfma_f32_16x16x32_bf16 v[108:111], a[20:23], v[92:95], v[108:111]
  s_lshl_b32 s96, s49, 6
  s_cmp_eq_u32 s49, 1
  s_cselect_b32 s49, s43, 0
  v_mfma_f32_16x16x32_bf16 v[108:111], a[32:35], v[116:119], v[108:111]
  s_cselect_b32 s45, 3, 0
  v_mul_f32 v84, s42, v84
  v_mul_f32 v85, s42, v85
  v_mfma_f32_16x16x32_bf16 v[108:111], a[44:47], v[96:99], v[108:111]
  s_sub_u32 s97, s97, s49
  v_mul_f32 v86, s42, v86
  v_mul_f32 v87, s42, v87
  v_mfma_f32_16x16x32_bf16 v[108:111], a[56:59], v[136:139], v[108:111]
  v_cvt_pk_bf16_f32 v104, v84, v85
  v_cvt_pk_bf16_f32 v105, v86, v87
  v_mfma_f32_16x16x32_bf16 v[108:111], a[68:71], v[80:83], v[108:111]
  s_branch L_r225
L_safe:
  s_nop 15
  s_waitcnt vmcnt(0) lgkmcnt(0)
  s_mov_b32 s10, 100663296
  v_mbcnt_lo_u32_b32 v58, -1, 0
  v_mbcnt_hi_u32_b32 v58, -1, v58
  v_lshrrev_b32 v59, 2, v58
  v_and_b32 v59, 4, v59
  v_xor_b32 v60, v59, v58
  s_cmp_eq_u32 s47, 63
  s_cselect_b32 s5, 4, 0
  v_and_b32 v60, s5, v60
  v_cmp_eq_u32 vcc, 0, v60
  s_cmp_eq_u32 s48, 63
  s_cselect_b32 s5, 0xc31044fe, 0
  v_mov_b32 v55, s5
  v_mov_b32 v54, 0xc31044fe
  v_cndmask_b32 v55, 0, v55, vcc
  v_cndmask_b32 v54, v54, 0, vcc
  v_add_u32 v0, s46, v2
  v_xor_b32 v1, 64, v0
  s_lshl_b32 s5, s48, 3
  s_add_u32 s5, s5, s3
  s_add_u32 s5, s5, 4
  s_mul_i32 s31, s5, s57
  s_add_u32 s5, s5, 4
  s_and_b32 s5, s5, 511
  s_mul_i32 s32, s5, s57
  v_lshrrev_b32 v59, 2, v59
  s_lshl_b32 s5, s47, 3
  s_add_u32 s5, s5, 4
  s_mul_i32 s5, s5, 384
  s_cmp_eq_u32 s47, 63
  s_cselect_b32 s49, 0, s5
  s_cselect_b32 s5, s5, 0
  s_cselect_b32 s6, s57, 0
  v_mul_u32_u24 v57, s6, v59
  v_sub_u32 v57, s5, v57
  s_lshl_b32 s50, s48, 3
  s_add_u32 s50, s50, 4
  s_xor_b32 s6, s4, 0
  s_lshl_b32 s6, s6, 1
  s_add_u32 s6, s6, s50
  s_and_b32 s6, s6, 511
  s_mul_i32 s6, s6, s57
  s_add_u32 s33, s6, s49
  s_xor_b32 s6, s4, 1
  s_lshl_b32 s6, s6, 1
  s_add_u32 s6, s6, s50
  s_and_b32 s6, s6, 511
  s_mul_i32 s6, s6, s57
  s_add_u32 s34, s6, s49
  s_xor_b32 s6, s4, 2
  s_lshl_b32 s6, s6, 1
  s_add_u32 s6, s6, s50
  s_and_b32 s6, s6, 511
  s_mul_i32 s6, s6, s57
  s_add_u32 s35, s6, s49
  s_xor_b32 s6, s4, 3
  s_lshl_b32 s6, s6, 1
  s_add_u32 s6, s6, s50
  s_and_b32 s6, s6, 511
  s_mul_i32 s6, s6, s57
  s_add_u32 s36, s6, s49
  s_lshl_b32 s5, s47, 3
  s_add_u32 s5, s5, 4
  v_lshrrev_b32 v59, 3, v58
  v_add_u32 v60, s5, v59
  v_and_b32 v60, 511, v60
  v_sub_u32 v60, v60, v59
  v_mul_i32_i24 v56, 0x180, v60
  v_add_u32 v6, v6, v56
  v_add_u32 v7, v7, v57
  v_add_u32 v8, v8, v57
  v_add_f32 v55, v54, v55
  s_cmp_eq_u32 s45, 3
  s_cselect_b32 s49, 15, 16
  s_cmp_eq_u32 s45, 4
  s_cselect_b32 s49, 17, s49
  s_mov_b32 s50, 0
  s_sub_u32 s56, s56, s43
  s_nop 7
L_sloop:
  s_barrier
  s_add_u32 m0, s46, 0
  s_nop 0
  buffer_load_dwordx4 v6, s[8:11], s31 offen offset:0 nt lds
  s_add_u32 m0, s46, 8064
  s_nop 0
  buffer_load_dwordx4 v6, s[8:11], s31 offen offset:128 nt lds
  s_add_u32 m0, s46, 16128
  s_nop 0
  buffer_load_dwordx4 v6, s[8:11], s31 offen offset:256 nt lds
  s_add_u32 m0, s46, 4096
  s_nop 0
  buffer_load_dwordx4 v6, s[8:11], s32 offen offset:0 nt lds
  s_add_u32 m0, s46, 12160
  s_nop 0
  buffer_load_dwordx4 v6, s[8:11], s32 offen offset:128 nt lds
  s_add_u32 m0, s46, 20224
  s_nop 0
  buffer_load_dwordx4 v6, s[8:11], s32 offen offset:256 nt lds
  s_waitcnt vmcnt(0)
  s_barrier
  ds_read_b128 a[244:247], v0 offset:0
  ds_read_b128 a[248:251], v1 offset:0
  ds_read_b128 a[252:255], v0 offset:8192
  ds_read_b128 v[76:79], v1 offset:8192
  ds_read_b128 v[80:83], v0 offset:16384
  ds_read_b128 v[84:87], v1 offset:16384
  s_waitcnt lgkmcnt(5)
  v_mfma_f32_16x16x32_bf16 v[68:71], a[0:3], a[244:247], 0
  s_waitcnt lgkmcnt(4)
  v_mfma_f32_16x16x32_bf16 v[68:71], a[12:15], a[248:251], v[68:71]
  s_waitcnt lgkmcnt(3)
  v_mfma_f32_16x16x32_bf16 v[68:71], a[24:27], a[252:255], v[68:71]
  s_waitcnt lgkmcnt(2)
  v_mfma_f32_16x16x32_bf16 v[68:71], a[36:39], v[76:79], v[68:71]
  s_waitcnt lgkmcnt(1)
  v_mfma_f32_16x16x32_bf16 v[68:71], a[48:51], v[80:83], v[68:71]
  s_waitcnt lgkmcnt(0)
  v_mfma_f32_16x16x32_bf16 v[68:71], a[60:63], v[84:87], v[68:71]
  v_mfma_f32_16x16x32_bf16 v[60:63], a[64:67], v[84:87], 0
  v_mfma_f32_16x16x32_bf16 v[60:63], a[52:55], v[80:83], v[60:63]
  v_mfma_f32_16x16x32_bf16 v[60:63], a[40:43], v[76:79], v[60:63]
  v_mfma_f32_16x16x32_bf16 v[60:63], a[28:31], a[252:255], v[60:63]
  v_mfma_f32_16x16x32_bf16 v[60:63], a[16:19], a[248:251], v[60:63]
  v_mfma_f32_16x16x32_bf16 v[60:63], a[4:7], a[244:247], v[60:63]
  v_mul_f32 v68, s42, v68
  v_mul_f32 v69, s42, v69
  v_mul_f32 v70, s42, v70
  v_mul_f32 v71, s42, v71
  v_cvt_pk_bf16_f32 v12, v68, v69
  v_cvt_pk_bf16_f32 v13, v70, v71
  v_mfma_f32_16x16x32_bf16 v[64:67], a[8:11], a[244:247], 0
  v_mfma_f32_16x16x32_bf16 v[64:67], a[20:23], a[248:251], v[64:67]
  v_mfma_f32_16x16x32_bf16 v[64:67], a[32:35], a[252:255], v[64:67]
  v_mfma_f32_16x16x32_bf16 v[64:67], a[44:47], v[76:79], v[64:67]
  v_mfma_f32_16x16x32_bf16 v[64:67], a[56:59], v[80:83], v[64:67]
  v_mfma_f32_16x16x32_bf16 v[64:67], a[68:71], v[84:87], v[64:67]
  v_mul_f32 v60, s42, v60
  v_mul_f32 v61, s42, v61
  v_mul_f32 v62, s42, v62
  v_mul_f32 v63, s42, v63
  v_cvt_pk_bf16_f32 v128, v60, v61
  v_cvt_pk_bf16_f32 v129, v62, v63
  v_mfma_f32_16x16x32_bf16 v[68:71], a[132:135], v[84:87], 0
  v_mfma_f32_16x16x32_bf16 v[68:71], a[120:123], v[80:83], v[68:71]
  v_mfma_f32_16x16x32_bf16 v[68:71], a[108:111], v[76:79], v[68:71]
  v_mfma_f32_16x16x32_bf16 v[68:71], a[96:99], a[252:255], v[68:71]
  v_mfma_f32_16x16x32_bf16 v[68:71], a[84:87], a[248:251], v[68:71]
  v_mfma_f32_16x16x32_bf16 v[68:71], a[72:75], a[244:247], v[68:71]
  v_mul_f32 v64, s42, v64
  v_mul_f32 v65, s42, v65
  v_mul_f32 v66, s42, v66
  v_mul_f32 v67, s42, v67
  v_cvt_pk_bf16_f32 v130, v64, v65
  v_cvt_pk_bf16_f32 v131, v66, v67
  v_mfma_f32_16x16x32_bf16 v[72:75], a[76:79], a[244:247], 0
  v_mfma_f32_16x16x32_bf16 v[72:75], a[88:91], a[248:251], v[72:75]
  v_mfma_f32_16x16x32_bf16 v[72:75], a[100:103], a[252:255], v[72:75]
  v_mfma_f32_16x16x32_bf16 v[72:75], a[112:115], v[76:79], v[72:75]
  v_mfma_f32_16x16x32_bf16 v[72:75], a[124:127], v[80:83], v[72:75]
  v_mfma_f32_16x16x32_bf16 v[72:75], a[136:139], v[84:87], v[72:75]
  v_cvt_pk_bf16_f32 v60, v68, v69
  v_cvt_pk_bf16_f32 v61, v70, v71
  v_mfma_f32_16x16x32_bf16 v[88:91], a[140:143], v[84:87], 0
  v_mfma_f32_16x16x32_bf16 v[88:91], a[128:131], v[80:83], v[88:91]
  v_mfma_f32_16x16x32_bf16 v[88:91], a[116:119], v[76:79], v[88:91]
  v_mfma_f32_16x16x32_bf16 v[88:91], a[104:107], a[252:255], v[88:91]
  v_mfma_f32_16x16x32_bf16 v[88:91], a[92:95], a[248:251], v[88:91]
  v_mfma_f32_16x16x32_bf16 v[88:91], a[80:83], a[244:247], v[88:91]
  v_cvt_pk_bf16_f32 v62, v72, v73
  v_cvt_pk_bf16_f32 v63, v74, v75
  v_mfma_f32_16x16x32_bf16 v[92:95], a[244:247], a[144:147], 0
  v_mfma_f32_16x16x32_bf16 v[92:95], a[248:251], a[156:159], v[92:95]
  v_mfma_f32_16x16x32_bf16 v[92:95], a[252:255], a[168:171], v[92:95]
  v_mfma_f32_16x16x32_bf16 v[92:95], v[76:79], a[180:183], v[92:95]
  v_mfma_f32_16x16x32_bf16 v[92:95], v[80:83], a[192:195], v[92:95]
  v_mfma_f32_16x16x32_bf16 v[92:95], v[84:87], a[204:207], v[92:95]
  v_cvt_pk_bf16_f32 v64, v88, v89
  v_cvt_pk_bf16_f32 v65, v90, v91
  v_mfma_f32_16x16x32_bf16 v[96:99], v[84:87], a[208:211], 0
  v_mfma_f32_16x16x32_bf16 v[96:99], v[80:83], a[196:199], v[96:99]
  v_mfma_f32_16x16x32_bf16 v[96:99], v[76:79], a[184:187], v[96:99]
  v_mfma_f32_16x16x32_bf16 v[96:99], a[252:255], a[172:175], v[96:99]
  v_mfma_f32_16x16x32_bf16 v[96:99], a[248:251], a[160:163], v[96:99]
  v_mfma_f32_16x16x32_bf16 v[96:99], a[244:247], a[148:151], v[96:99]
  v_cvt_pk_bf16_f32 v68, v92, v93
  v_cvt_pk_bf16_f32 v69, v94, v95
  v_mfma_f32_16x16x32_bf16 v[104:107], a[244:247], a[152:155], 0
  v_mfma_f32_16x16x32_bf16 v[104:107], a[248:251], a[164:167], v[104:107]
  v_mfma_f32_16x16x32_bf16 v[104:107], a[252:255], a[176:179], v[104:107]
  v_mfma_f32_16x16x32_bf16 v[104:107], v[76:79], a[188:191], v[104:107]
  v_mfma_f32_16x16x32_bf16 v[104:107], v[80:83], a[200:203], v[104:107]
  v_mfma_f32_16x16x32_bf16 v[104:107], v[84:87], a[212:215], v[104:107]
  v_cvt_pk_bf16_f32 v72, v96, v97
  v_cvt_pk_bf16_f32 v73, v98, v99
  s_nop 5
  v_cvt_pk_bf16_f32 v76, v104, v105
  v_cvt_pk_bf16_f32 v77, v106, v107
  ds_read_b128 a[244:247], v0 offset:2048
  ds_read_b128 a[248:251], v1 offset:2048
  ds_read_b128 a[252:255], v0 offset:10240
  ds_read_b128 v[88:91], v1 offset:10240
  ds_read_b128 v[92:95], v0 offset:18432
  ds_read_b128 v[96:99], v1 offset:18432
  s_waitcnt lgkmcnt(5)
  v_mfma_f32_16x16x32_bf16 v[100:103], a[0:3], a[244:247], 0
  s_waitcnt lgkmcnt(4)
  v_mfma_f32_16x16x32_bf16 v[100:103], a[12:15], a[248:251], v[100:103]
  s_waitcnt lgkmcnt(3)
  v_mfma_f32_16x16x32_bf16 v[100:103], a[24:27], a[252:255], v[100:103]
  s_waitcnt lgkmcnt(2)
  v_mfma_f32_16x16x32_bf16 v[100:103], a[36:39], v[88:91], v[100:103]
  s_waitcnt lgkmcnt(1)
  v_mfma_f32_16x16x32_bf16 v[100:103], a[48:51], v[92:95], v[100:103]
  s_waitcnt lgkmcnt(0)
  v_mfma_f32_16x16x32_bf16 v[100:103], a[60:63], v[96:99], v[100:103]
  v_mfma_f32_16x16x32_bf16 v[80:83], a[64:67], v[96:99], 0
  v_mfma_f32_16x16x32_bf16 v[80:83], a[52:55], v[92:95], v[80:83]
  v_mfma_f32_16x16x32_bf16 v[80:83], a[40:43], v[88:91], v[80:83]
  v_mfma_f32_16x16x32_bf16 v[80:83], a[28:31], a[252:255], v[80:83]
  v_mfma_f32_16x16x32_bf16 v[80:83], a[16:19], a[248:251], v[80:83]
  v_mfma_f32_16x16x32_bf16 v[80:83], a[4:7], a[244:247], v[80:83]
  v_mul_f32 v100, s42, v100
  v_mul_f32 v101, s42, v101
  v_mul_f32 v102, s42, v102
  v_mul_f32 v103, s42, v103
  v_cvt_pk_bf16_f32 v124, v100, v101
  v_cvt_pk_bf16_f32 v125, v102, v103
  v_mfma_f32_16x16x32_bf16 v[84:87], a[8:11], a[244:247], 0
  v_mfma_f32_16x16x32_bf16 v[84:87], a[20:23], a[248:251], v[84:87]
  v_mfma_f32_16x16x32_bf16 v[84:87], a[32:35], a[252:255], v[84:87]
  v_mfma_f32_16x16x32_bf16 v[84:87], a[44:47], v[88:91], v[84:87]
  v_mfma_f32_16x16x32_bf16 v[84:87], a[56:59], v[92:95], v[84:87]
  v_mfma_f32_16x16x32_bf16 v[84:87], a[68:71], v[96:99], v[84:87]
  v_mul_f32 v80, s42, v80
  v_mul_f32 v81, s42, v81
  v_mul_f32 v82, s42, v82
  v_mul_f32 v83, s42, v83
  v_cvt_pk_bf16_f32 v126, v80, v81
  v_cvt_pk_bf16_f32 v127, v82, v83
  v_mfma_f32_16x16x32_bf16 v[100:103], a[132:135], v[96:99], 0
  v_mfma_f32_16x16x32_bf16 v[100:103], a[120:123], v[92:95], v[100:103]
  v_mfma_f32_16x16x32_bf16 v[100:103], a[108:111], v[88:91], v[100:103]
  v_mfma_f32_16x16x32_bf16 v[100:103], a[96:99], a[252:255], v[100:103]
  v_mfma_f32_16x16x32_bf16 v[100:103], a[84:87], a[248:251], v[100:103]
  v_mfma_f32_16x16x32_bf16 v[100:103], a[72:75], a[244:247], v[100:103]
  v_mul_f32 v84, s42, v84
  v_mul_f32 v85, s42, v85
  v_mul_f32 v86, s42, v86
  v_mul_f32 v87, s42, v87
  v_cvt_pk_bf16_f32 v16, v84, v85
  v_cvt_pk_bf16_f32 v17, v86, v87
  v_mfma_f32_16x16x32_bf16 v[104:107], a[76:79], a[244:247], 0
  v_mfma_f32_16x16x32_bf16 v[104:107], a[88:91], a[248:251], v[104:107]
  v_mfma_f32_16x16x32_bf16 v[104:107], a[100:103], a[252:255], v[104:107]
  v_mfma_f32_16x16x32_bf16 v[104:107], a[112:115], v[88:91], v[104:107]
  v_mfma_f32_16x16x32_bf16 v[104:107], a[124:127], v[92:95], v[104:107]
  v_mfma_f32_16x16x32_bf16 v[104:107], a[136:139], v[96:99], v[104:107]
  v_cvt_pk_bf16_f32 v80, v100, v101
  v_cvt_pk_bf16_f32 v81, v102, v103
  v_mfma_f32_16x16x32_bf16 v[108:111], a[140:143], v[96:99], 0
  v_mfma_f32_16x16x32_bf16 v[108:111], a[128:131], v[92:95], v[108:111]
  v_mfma_f32_16x16x32_bf16 v[108:111], a[116:119], v[88:91], v[108:111]
  v_mfma_f32_16x16x32_bf16 v[108:111], a[104:107], a[252:255], v[108:111]
  v_mfma_f32_16x16x32_bf16 v[108:111], a[92:95], a[248:251], v[108:111]
  v_mfma_f32_16x16x32_bf16 v[108:111], a[80:83], a[244:247], v[108:111]
  v_cvt_pk_bf16_f32 v82, v104, v105
  v_cvt_pk_bf16_f32 v83, v106, v107
  v_mfma_f32_16x16x32_bf16 v[100:103], a[244:247], a[144:147], 0
  v_mfma_f32_16x16x32_bf16 v[100:103], a[248:251], a[156:159], v[100:103]
  v_mfma_f32_16x16x32_bf16 v[100:103], a[252:255], a[168:171], v[100:103]
  v_mfma_f32_16x16x32_bf16 v[100:103], v[88:91], a[180:183], v[100:103]
  v_mfma_f32_16x16x32_bf16 v[100:103], v[92:95], a[192:195], v[100:103]
  v_mfma_f32_16x16x32_bf16 v[100:103], v[96:99], a[204:207], v[100:103]
  v_cvt_pk_bf16_f32 v84, v108, v109
  v_cvt_pk_bf16_f32 v85, v110, v111
  v_mfma_f32_16x16x32_bf16 v[104:107], v[96:99], a[208:211], 0
  v_mfma_f32_16x16x32_bf16 v[104:107], v[92:95], a[196:199], v[104:107]
  v_mfma_f32_16x16x32_bf16 v[104:107], v[88:91], a[184:187], v[104:107]
  v_mfma_f32_16x16x32_bf16 v[104:107], a[252:255], a[172:175], v[104:107]
  v_mfma_f32_16x16x32_bf16 v[104:107], a[248:251], a[160:163], v[104:107]
  v_mfma_f32_16x16x32_bf16 v[104:107], a[244:247], a[148:151], v[104:107]
  v_cvt_pk_bf16_f32 v70, v100, v101
  v_cvt_pk_bf16_f32 v71, v102, v103
  v_mfma_f32_16x16x32_bf16 v[116:119], a[244:247], a[152:155], 0
  v_mfma_f32_16x16x32_bf16 v[116:119], a[248:251], a[164:167], v[116:119]
  v_mfma_f32_16x16x32_bf16 v[116:119], a[252:255], a[176:179], v[116:119]
  v_mfma_f32_16x16x32_bf16 v[116:119], v[88:91], a[188:191], v[116:119]
  v_mfma_f32_16x16x32_bf16 v[116:119], v[92:95], a[200:203], v[116:119]
  v_mfma_f32_16x16x32_bf16 v[116:119], v[96:99], a[212:215], v[116:119]
  v_cvt_pk_bf16_f32 v74, v104, v105
  v_cvt_pk_bf16_f32 v75, v106, v107
  s_nop 5
  v_cvt_pk_bf16_f32 v78, v116, v117
  v_cvt_pk_bf16_f32 v79, v118, v119
  ds_read_b128 a[244:247], v0 offset:4096
  ds_read_b128 a[248:251], v1 offset:4096
  ds_read_b128 a[252:255], v0 offset:12288
  ds_read_b128 v[100:103], v1 offset:12288
  ds_read_b128 v[108:111], v0 offset:20480
  ds_read_b128 v[112:115], v1 offset:20480
  s_waitcnt lgkmcnt(5)
  v_mfma_f32_16x16x32_bf16 v[96:99], a[0:3], a[244:247], 0
  s_waitcnt lgkmcnt(4)
  v_mfma_f32_16x16x32_bf16 v[96:99], a[12:15], a[248:251], v[96:99]
  s_waitcnt lgkmcnt(3)
  v_mfma_f32_16x16x32_bf16 v[96:99], a[24:27], a[252:255], v[96:99]
  s_waitcnt lgkmcnt(2)
  v_mfma_f32_16x16x32_bf16 v[96:99], a[36:39], v[100:103], v[96:99]
  s_waitcnt lgkmcnt(1)
  v_mfma_f32_16x16x32_bf16 v[96:99], a[48:51], v[108:111], v[96:99]
  s_waitcnt lgkmcnt(0)
  v_mfma_f32_16x16x32_bf16 v[96:99], a[60:63], v[112:115], v[96:99]
  v_mfma_f32_16x16x32_bf16 v[88:91], a[64:67], v[112:115], 0
  v_mfma_f32_16x16x32_bf16 v[88:91], a[52:55], v[108:111], v[88:91]
  v_mfma_f32_16x16x32_bf16 v[88:91], a[40:43], v[100:103], v[88:91]
  v_mfma_f32_16x16x32_bf16 v[88:91], a[28:31], a[252:255], v[88:91]
  v_mfma_f32_16x16x32_bf16 v[88:91], a[16:19], a[248:251], v[88:91]
  v_mfma_f32_16x16x32_bf16 v[88:91], a[4:7], a[244:247], v[88:91]
  v_mul_f32 v96, s42, v96
  v_mul_f32 v97, s42, v97
  v_mul_f32 v98, s42, v98
  v_mul_f32 v99, s42, v99
  v_cvt_pk_bf16_f32 v18, v96, v97
  v_cvt_pk_bf16_f32 v19, v98, v99
  v_mfma_f32_16x16x32_bf16 v[92:95], a[8:11], a[244:247], 0
  v_mfma_f32_16x16x32_bf16 v[92:95], a[20:23], a[248:251], v[92:95]
  v_mfma_f32_16x16x32_bf16 v[92:95], a[32:35], a[252:255], v[92:95]
  v_mfma_f32_16x16x32_bf16 v[92:95], a[44:47], v[100:103], v[92:95]
  v_mfma_f32_16x16x32_bf16 v[92:95], a[56:59], v[108:111], v[92:95]
  v_mfma_f32_16x16x32_bf16 v[92:95], a[68:71], v[112:115], v[92:95]
  v_mul_f32 v88, s42, v88
  v_mul_f32 v89, s42, v89
  v_mul_f32 v90, s42, v90
  v_mul_f32 v91, s42, v91
  v_cvt_pk_bf16_f32 v120, v88, v89
  v_cvt_pk_bf16_f32 v121, v90, v91
  v_mfma_f32_16x16x32_bf16 v[96:99], a[132:135], v[112:115], 0
  v_mfma_f32_16x16x32_bf16 v[96:99], a[120:123], v[108:111], v[96:99]
  v_mfma_f32_16x16x32_bf16 v[96:99], a[108:111], v[100:103], v[96:99]
  v_mfma_f32_16x16x32_bf16 v[96:99], a[96:99], a[252:255], v[96:99]
  v_mfma_f32_16x16x32_bf16 v[96:99], a[84:87], a[248:251], v[96:99]
  v_mfma_f32_16x16x32_bf16 v[96:99], a[72:75], a[244:247], v[96:99]
  v_mul_f32 v92, s42, v92
  v_mul_f32 v93, s42, v93
  v_mul_f32 v94, s42, v94
  v_mul_f32 v95, s42, v95
  v_cvt_pk_bf16_f32 v122, v92, v93
  v_cvt_pk_bf16_f32 v123, v94, v95
  v_mfma_f32_16x16x32_bf16 v[104:107], a[76:79], a[244:247], 0
  v_mfma_f32_16x16x32_bf16 v[104:107], a[88:91], a[248:251], v[104:107]
  v_mfma_f32_16x16x32_bf16 v[104:107], a[100:103], a[252:255], v[104:107]
  v_mfma_f32_16x16x32_bf16 v[104:107], a[112:115], v[100:103], v[104:107]
  v_mfma_f32_16x16x32_bf16 v[104:107], a[124:127], v[108:111], v[104:107]
  v_mfma_f32_16x16x32_bf16 v[104:107], a[136:139], v[112:115], v[104:107]
  v_cvt_pk_bf16_f32 v88, v96, v97
  v_cvt_pk_bf16_f32 v89, v98, v99
  v_mfma_f32_16x16x32_bf16 v[116:119], a[140:143], v[112:115], 0
  v_mfma_f32_16x16x32_bf16 v[116:119], a[128:131], v[108:111], v[116:119]
  v_mfma_f32_16x16x32_bf16 v[116:119], a[116:119], v[100:103], v[116:119]
  v_mfma_f32_16x16x32_bf16 v[116:119], a[104:107], a[252:255], v[116:119]
  v_mfma_f32_16x16x32_bf16 v[116:119], a[92:95], a[248:251], v[116:119]
  v_mfma_f32_16x16x32_bf16 v[116:119], a[80:83], a[244:247], v[116:119]
  v_cvt_pk_bf16_f32 v90, v104, v105
  v_cvt_pk_bf16_f32 v91, v106, v107
  v_mfma_f32_16x16x32_bf16 v[132:135], a[244:247], a[144:147], 0
  v_mfma_f32_16x16x32_bf16 v[132:135], a[248:251], a[156:159], v[132:135]
  v_mfma_f32_16x16x32_bf16 v[132:135], a[252:255], a[168:171], v[132:135]
  v_mfma_f32_16x16x32_bf16 v[132:135], v[100:103], a[180:183], v[132:135]
  v_mfma_f32_16x16x32_bf16 v[132:135], v[108:111], a[192:195], v[132:135]
  v_mfma_f32_16x16x32_bf16 v[132:135], v[112:115], a[204:207], v[132:135]
  v_cvt_pk_bf16_f32 v92, v116, v117
  v_cvt_pk_bf16_f32 v93, v118, v119
  v_mfma_f32_16x16x32_bf16 v[136:139], v[112:115], a[208:211], 0
  v_mfma_f32_16x16x32_bf16 v[136:139], v[108:111], a[196:199], v[136:139]
  v_mfma_f32_16x16x32_bf16 v[136:139], v[100:103], a[184:187], v[136:139]
  v_mfma_f32_16x16x32_bf16 v[136:139], a[252:255], a[172:175], v[136:139]
  v_mfma_f32_16x16x32_bf16 v[136:139], a[248:251], a[160:163], v[136:139]
  v_mfma_f32_16x16x32_bf16 v[136:139], a[244:247], a[148:151], v[136:139]
  v_cvt_pk_bf16_f32 v96, v132, v133
  v_cvt_pk_bf16_f32 v97, v134, v135
  v_mfma_f32_16x16x32_bf16 v[116:119], a[244:247], a[152:155], 0
  v_mfma_f32_16x16x32_bf16 v[116:119], a[248:251], a[164:167], v[116:119]
  v_mfma_f32_16x16x32_bf16 v[116:119], a[252:255], a[176:179], v[116:119]
  v_mfma_f32_16x16x32_bf16 v[116:119], v[100:103], a[188:191], v[116:119]
  v_mfma_f32_16x16x32_bf16 v[116:119], v[108:111], a[200:203], v[116:119]
  v_mfma_f32_16x16x32_bf16 v[116:119], v[112:115], a[212:215], v[116:119]
  v_cvt_pk_bf16_f32 v104, v136, v137
  v_cvt_pk_bf16_f32 v105, v138, v139
  s_nop 5
  v_cvt_pk_bf16_f32 v100, v116, v117
  v_cvt_pk_bf16_f32 v101, v118, v119
  ds_read_b128 a[244:247], v0 offset:6144
  ds_read_b128 a[248:251], v1 offset:6144
  ds_read_b128 a[252:255], v0 offset:14336
  ds_read_b128 v[132:135], v1 offset:14336
  ds_read_b128 v[136:139], v0 offset:22528
  ds_read_b128 v[140:143], v1 offset:22528
  s_waitcnt lgkmcnt(5)
  v_mfma_f32_16x16x32_bf16 v[144:147], a[0:3], a[244:247], 0
  s_waitcnt lgkmcnt(4)
  v_mfma_f32_16x16x32_bf16 v[144:147], a[12:15], a[248:251], v[144:147]
  s_waitcnt lgkmcnt(3)
  v_mfma_f32_16x16x32_bf16 v[144:147], a[24:27], a[252:255], v[144:147]
  s_waitcnt lgkmcnt(2)
  v_mfma_f32_16x16x32_bf16 v[144:147], a[36:39], v[132:135], v[144:147]
  s_waitcnt lgkmcnt(1)
  v_mfma_f32_16x16x32_bf16 v[144:147], a[48:51], v[136:139], v[144:147]
  s_waitcnt lgkmcnt(0)
  v_mfma_f32_16x16x32_bf16 v[144:147], a[60:63], v[140:143], v[144:147]
  v_mfma_f32_16x16x32_bf16 v[108:111], a[64:67], v[140:143], 0
  v_mfma_f32_16x16x32_bf16 v[108:111], a[52:55], v[136:139], v[108:111]
  v_mfma_f32_16x16x32_bf16 v[108:111], a[40:43], v[132:135], v[108:111]
  v_mfma_f32_16x16x32_bf16 v[108:111], a[28:31], a[252:255], v[108:111]
  v_mfma_f32_16x16x32_bf16 v[108:111], a[16:19], a[248:251], v[108:111]
  v_mfma_f32_16x16x32_bf16 v[108:111], a[4:7], a[244:247], v[108:111]
  v_mul_f32 v144, s42, v144
  v_mul_f32 v145, s42, v145
  v_mul_f32 v146, s42, v146
  v_mul_f32 v147, s42, v147
  v_cvt_pk_bf16_f32 v116, v144, v145
  v_cvt_pk_bf16_f32 v117, v146, v147
  v_mfma_f32_16x16x32_bf16 v[112:115], a[8:11], a[244:247], 0
  v_mfma_f32_16x16x32_bf16 v[112:115], a[20:23], a[248:251], v[112:115]
  v_mfma_f32_16x16x32_bf16 v[112:115], a[32:35], a[252:255], v[112:115]
  v_mfma_f32_16x16x32_bf16 v[112:115], a[44:47], v[132:135], v[112:115]
  v_mfma_f32_16x16x32_bf16 v[112:115], a[56:59], v[136:139], v[112:115]
  v_mfma_f32_16x16x32_bf16 v[112:115], a[68:71], v[140:143], v[112:115]
  v_mul_f32 v108, s42, v108
  v_mul_f32 v109, s42, v109
  v_mul_f32 v110, s42, v110
  v_mul_f32 v111, s42, v111
  v_cvt_pk_bf16_f32 v118, v108, v109
  v_cvt_pk_bf16_f32 v119, v110, v111
  v_mfma_f32_16x16x32_bf16 v[144:147], a[132:135], v[140:143], 0
  v_mfma_f32_16x16x32_bf16 v[144:147], a[120:123], v[136:139], v[144:147]
  v_mfma_f32_16x16x32_bf16 v[144:147], a[108:111], v[132:135], v[144:147]
  v_mfma_f32_16x16x32_bf16 v[144:147], a[96:99], a[252:255], v[144:147]
  v_mfma_f32_16x16x32_bf16 v[144:147], a[84:87], a[248:251], v[144:147]
  v_mfma_f32_16x16x32_bf16 v[144:147], a[72:75], a[244:247], v[144:147]
  v_mul_f32 v112, s42, v112
  v_mul_f32 v113, s42, v113
  v_mul_f32 v114, s42, v114
  v_mul_f32 v115, s42, v115
  v_cvt_pk_bf16_f32 v22, v112, v113
  v_cvt_pk_bf16_f32 v23, v114, v115
  v_mfma_f32_16x16x32_bf16 v[148:151], a[76:79], a[244:247], 0
  v_mfma_f32_16x16x32_bf16 v[148:151], a[88:91], a[248:251], v[148:151]
  v_mfma_f32_16x16x32_bf16 v[148:151], a[100:103], a[252:255], v[148:151]
  v_mfma_f32_16x16x32_bf16 v[148:151], a[112:115], v[132:135], v[148:151]
  v_mfma_f32_16x16x32_bf16 v[148:151], a[124:127], v[136:139], v[148:151]
  v_mfma_f32_16x16x32_bf16 v[148:151], a[136:139], v[140:143], v[148:151]
  v_cvt_pk_bf16_f32 v108, v144, v145
  v_cvt_pk_bf16_f32 v109, v146, v147
  v_mfma_f32_16x16x32_bf16 v[152:155], a[140:143], v[140:143], 0
  v_mfma_f32_16x16x32_bf16 v[152:155], a[128:131], v[136:139], v[152:155]
  v_mfma_f32_16x16x32_bf16 v[152:155], a[116:119], v[132:135], v[152:155]
  v_mfma_f32_16x16x32_bf16 v[152:155], a[104:107], a[252:255], v[152:155]
  v_mfma_f32_16x16x32_bf16 v[152:155], a[92:95], a[248:251], v[152:155]
  v_mfma_f32_16x16x32_bf16 v[152:155], a[80:83], a[244:247], v[152:155]
  v_cvt_pk_bf16_f32 v110, v148, v149
  v_cvt_pk_bf16_f32 v111, v150, v151
  v_mfma_f32_16x16x32_bf16 v[144:147], a[244:247], a[144:147], 0
  v_mfma_f32_16x16x32_bf16 v[144:147], a[248:251], a[156:159], v[144:147]
  v_mfma_f32_16x16x32_bf16 v[144:147], a[252:255], a[168:171], v[144:147]
  v_mfma_f32_16x16x32_bf16 v[144:147], v[132:135], a[180:183], v[144:147]
  v_mfma_f32_16x16x32_bf16 v[144:147], v[136:139], a[192:195], v[144:147]
  v_mfma_f32_16x16x32_bf16 v[144:147], v[140:143], a[204:207], v[144:147]
  v_cvt_pk_bf16_f32 v112, v152, v153
  v_cvt_pk_bf16_f32 v113, v154, v155
  v_mfma_f32_16x16x32_bf16 v[148:151], v[140:143], a[208:211], 0
  v_mfma_f32_16x16x32_bf16 v[148:151], v[136:139], a[196:199], v[148:151]
  v_mfma_f32_16x16x32_bf16 v[148:151], v[132:135], a[184:187], v[148:151]
  v_mfma_f32_16x16x32_bf16 v[148:151], a[252:255], a[172:175], v[148:151]
  v_mfma_f32_16x16x32_bf16 v[148:151], a[248:251], a[160:163], v[148:151]
  v_mfma_f32_16x16x32_bf16 v[148:151], a[244:247], a[148:151], v[148:151]
  v_cvt_pk_bf16_f32 v98, v144, v145
  v_cvt_pk_bf16_f32 v99, v146, v147
  v_mfma_f32_16x16x32_bf16 v[152:155], a[244:247], a[152:155], 0
  v_mfma_f32_16x16x32_bf16 v[152:155], a[248:251], a[164:167], v[152:155]
  v_mfma_f32_16x16x32_bf16 v[152:155], a[252:255], a[176:179], v[152:155]
  v_mfma_f32_16x16x32_bf16 v[152:155], v[132:135], a[188:191], v[152:155]
  v_mfma_f32_16x16x32_bf16 v[152:155], v[136:139], a[200:203], v[152:155]
  v_mfma_f32_16x16x32_bf16 v[152:155], v[140:143], a[212:215], v[152:155]
  v_cvt_pk_bf16_f32 v106, v148, v149
  v_cvt_pk_bf16_f32 v107, v150, v151
  s_nop 5
  v_cvt_pk_bf16_f32 v102, v152, v153
  v_cvt_pk_bf16_f32 v103, v154, v155
  v_mfma_f32_16x16x32_bf16 v[132:135], v[62:65], v[128:131], v[36:39]
  v_mfma_f32_16x16x32_bf16 v[132:135], v[60:63], v[12:15], v[132:135]
  v_mfma_f32_16x16x32_bf16 v[136:139], v[82:85], v[128:131], v[32:35]
  v_mfma_f32_16x16x32_bf16 v[136:139], v[80:83], v[12:15], v[136:139]
  v_mfma_f32_16x16x32_bf16 v[140:143], v[90:93], v[128:131], v[28:31]
  v_mfma_f32_16x16x32_bf16 v[140:143], v[88:91], v[12:15], v[140:143]
  v_mfma_f32_16x16x32_bf16 v[144:147], v[110:113], v[128:131], v[24:27]
  v_mfma_f32_16x16x32_bf16 v[144:147], v[108:111], v[12:15], v[144:147]
  v_add_f32 v132, v54, v132
  v_add_f32 v133, v54, v133
  v_add_f32 v134, v54, v134
  v_add_f32 v135, v54, v135
  v_add_f32 v136, v54, v136
  v_add_f32 v137, v54, v137
  v_add_f32 v138, v54, v138
  v_add_f32 v139, v54, v139
  v_add_f32 v140, v55, v140
  v_add_f32 v141, v55, v141
  v_add_f32 v142, v55, v142
  v_add_f32 v143, v55, v143
  v_add_f32 v144, v55, v144
  v_add_f32 v145, v55, v145
  v_add_f32 v146, v55, v146
  v_add_f32 v147, v55, v147
  v_max_f32 v58, v132, v133
  v_max3_f32 v58, v134, v135, v58
  v_max3_f32 v58, v136, v137, v58
  v_max3_f32 v58, v138, v139, v58
  v_max3_f32 v58, v140, v141, v58
  v_max3_f32 v58, v142, v143, v58
  v_max3_f32 v58, v144, v145, v58
  v_max3_f32 v58, v146, v147, v58
  v_mov_b32 v59, v58
  s_nop 1
  v_permlane32_swap_b32 v58, v59
  v_max_f32 v58, v58, v59
  v_mov_b32 v59, v58
  s_nop 1
  v_permlane16_swap_b32 v58, v59
  v_max_f32 v58, v58, v59
  v_sub_f32 v132, v132, v58
  v_sub_f32 v133, v133, v58
  v_sub_f32 v134, v134, v58
  v_sub_f32 v135, v135, v58
  v_sub_f32 v136, v136, v58
  v_sub_f32 v137, v137, v58
  v_sub_f32 v138, v138, v58
  v_sub_f32 v139, v139, v58
  v_sub_f32 v140, v140, v58
  v_sub_f32 v141, v141, v58
  v_sub_f32 v142, v142, v58
  v_sub_f32 v143, v143, v58
  v_sub_f32 v144, v144, v58
  v_sub_f32 v145, v145, v58
  v_sub_f32 v146, v146, v58
  v_sub_f32 v147, v147, v58
  v_exp_f32 v132, v132
  v_exp_f32 v133, v133
  v_exp_f32 v134, v134
  v_exp_f32 v135, v135
  v_cvt_pk_bf16_f32 v132, v132, v133
  v_cvt_pk_bf16_f32 v133, v134, v135
  v_exp_f32 v136, v136
  v_exp_f32 v137, v137
  v_exp_f32 v138, v138
  v_exp_f32 v139, v139
  v_cvt_pk_bf16_f32 v134, v136, v137
  v_cvt_pk_bf16_f32 v135, v138, v139
  v_exp_f32 v140, v140
  v_exp_f32 v141, v141
  v_exp_f32 v142, v142
  v_exp_f32 v143, v143
  v_cvt_pk_bf16_f32 v136, v140, v141
  v_cvt_pk_bf16_f32 v137, v142, v143
  v_exp_f32 v144, v144
  v_exp_f32 v145, v145
  v_exp_f32 v146, v146
  v_exp_f32 v147, v147
  v_cvt_pk_bf16_f32 v138, v144, v145
  v_cvt_pk_bf16_f32 v139, v146, v147
  v_mov_b64 v[128:129], 0
  s_nop 1
  v_smfmac_f32_16x16x64_bf16 v[128:131], a[240:243], v[132:139], v10
  v_mfma_f32_16x16x32_bf16 v[148:151], v[96:99], v[136:139], 0
  v_mfma_f32_16x16x32_bf16 v[148:151], v[68:71], v[132:135], v[148:151]
  v_mfma_f32_16x16x32_bf16 v[140:143], v[72:75], v[132:135], 0
  v_mfma_f32_16x16x32_bf16 v[140:143], v[104:107], v[136:139], v[140:143]
  v_mfma_f32_16x16x32_bf16 v[144:147], v[100:103], v[136:139], 0
  v_mfma_f32_16x16x32_bf16 v[144:147], v[76:79], v[132:135], v[144:147]
  v_add_f32 v128, v128, v129
  v_rcp_f32 v130, v128
  s_nop 0
  v_mul_f32 v148, v130, v148
  v_mul_f32 v149, v130, v149
  v_mul_f32 v150, v130, v150
  v_mul_f32 v151, v130, v151
  v_cvt_pk_bf16_f32 v148, v148, v149
  v_cvt_pk_bf16_f32 v149, v150, v151
  ds_write_b32 v5, v148 offset:0
  ds_write_b32 v5, v149 offset:1024
  v_mul_f32 v140, v130, v140
  v_mul_f32 v141, v130, v141
  v_mul_f32 v142, v130, v142
  v_mul_f32 v143, v130, v143
  v_cvt_pk_bf16_f32 v140, v140, v141
  v_cvt_pk_bf16_f32 v141, v142, v143
  ds_write_b32 v5, v140 offset:2048
  ds_write_b32 v5, v141 offset:3072
  v_mul_f32 v144, v130, v144
  v_mul_f32 v145, v130, v145
  v_mul_f32 v146, v130, v146
  v_mul_f32 v147, v130, v147
  v_cvt_pk_bf16_f32 v144, v144, v145
  v_cvt_pk_bf16_f32 v145, v146, v147
  ds_write_b32 v5, v144 offset:4096
  ds_write_b32 v5, v145 offset:5120
  v_mfma_f32_16x16x32_bf16 v[128:131], v[60:63], v[124:127], v[40:43]
  v_mfma_f32_16x16x32_bf16 v[128:131], v[62:65], v[14:17], v[128:131]
  v_mfma_f32_16x16x32_bf16 v[132:135], v[80:83], v[124:127], v[36:39]
  v_mfma_f32_16x16x32_bf16 v[132:135], v[82:85], v[14:17], v[132:135]
  v_mfma_f32_16x16x32_bf16 v[136:139], v[88:91], v[124:127], v[32:35]
  v_mfma_f32_16x16x32_bf16 v[136:139], v[90:93], v[14:17], v[136:139]
  v_mfma_f32_16x16x32_bf16 v[140:143], v[108:111], v[124:127], v[28:31]
  v_mfma_f32_16x16x32_bf16 v[140:143], v[110:113], v[14:17], v[140:143]
  v_add_f32 v128, v54, v128
  v_add_f32 v129, v54, v129
  v_add_f32 v130, v54, v130
  v_add_f32 v131, v54, v131
  v_add_f32 v132, v54, v132
  v_add_f32 v133, v54, v133
  v_add_f32 v134, v54, v134
  v_add_f32 v135, v54, v135
  v_add_f32 v136, v55, v136
  v_add_f32 v137, v55, v137
  v_add_f32 v138, v55, v138
  v_add_f32 v139, v55, v139
  v_add_f32 v140, v55, v140
  v_add_f32 v141, v55, v141
  v_add_f32 v142, v55, v142
  v_add_f32 v143, v55, v143
  v_max_f32 v58, v128, v129
  v_max3_f32 v58, v130, v131, v58
  v_max3_f32 v58, v132, v133, v58
  v_max3_f32 v58, v134, v135, v58
  v_max3_f32 v58, v136, v137, v58
  v_max3_f32 v58, v138, v139, v58
  v_max3_f32 v58, v140, v141, v58
  v_max3_f32 v58, v142, v143, v58
  v_mov_b32 v59, v58
  s_nop 1
  v_permlane32_swap_b32 v58, v59
  v_max_f32 v58, v58, v59
  v_mov_b32 v59, v58
  s_nop 1
  v_permlane16_swap_b32 v58, v59
  v_max_f32 v58, v58, v59
  v_sub_f32 v128, v128, v58
  v_sub_f32 v129, v129, v58
  v_sub_f32 v130, v130, v58
  v_sub_f32 v131, v131, v58
  v_sub_f32 v132, v132, v58
  v_sub_f32 v133, v133, v58
  v_sub_f32 v134, v134, v58
  v_sub_f32 v135, v135, v58
  v_sub_f32 v136, v136, v58
  v_sub_f32 v137, v137, v58
  v_sub_f32 v138, v138, v58
  v_sub_f32 v139, v139, v58
  v_sub_f32 v140, v140, v58
  v_sub_f32 v141, v141, v58
  v_sub_f32 v142, v142, v58
  v_sub_f32 v143, v143, v58
  v_exp_f32 v128, v128
  v_exp_f32 v129, v129
  v_exp_f32 v130, v130
  v_exp_f32 v131, v131
  v_cvt_pk_bf16_f32 v128, v128, v129
  v_cvt_pk_bf16_f32 v129, v130, v131
  v_exp_f32 v132, v132
  v_exp_f32 v133, v133
  v_exp_f32 v134, v134
  v_exp_f32 v135, v135
  v_cvt_pk_bf16_f32 v130, v132, v133
  v_cvt_pk_bf16_f32 v131, v134, v135
  v_exp_f32 v136, v136
  v_exp_f32 v137, v137
  v_exp_f32 v138, v138
  v_exp_f32 v139, v139
  v_cvt_pk_bf16_f32 v132, v136, v137
  v_cvt_pk_bf16_f32 v133, v138, v139
  v_exp_f32 v140, v140
  v_exp_f32 v141, v141
  v_exp_f32 v142, v142
  v_exp_f32 v143, v143
  v_cvt_pk_bf16_f32 v134, v140, v141
  v_cvt_pk_bf16_f32 v135, v142, v143
  v_mov_b64 v[124:125], 0
  s_nop 1
  v_smfmac_f32_16x16x64_bf16 v[124:127], a[240:243], v[128:135], v10
  v_mfma_f32_16x16x32_bf16 v[144:147], v[96:99], v[132:135], 0
  v_mfma_f32_16x16x32_bf16 v[144:147], v[68:71], v[128:131], v[144:147]
  v_mfma_f32_16x16x32_bf16 v[136:139], v[72:75], v[128:131], 0
  v_mfma_f32_16x16x32_bf16 v[136:139], v[104:107], v[132:135], v[136:139]
  v_mfma_f32_16x16x32_bf16 v[140:143], v[100:103], v[132:135], 0
  v_mfma_f32_16x16x32_bf16 v[140:143], v[76:79], v[128:131], v[140:143]
  v_add_f32 v124, v124, v125
  v_rcp_f32 v126, v124
  s_nop 0
  v_mul_f32 v144, v126, v144
  v_mul_f32 v145, v126, v145
  v_mul_f32 v146, v126, v146
  v_mul_f32 v147, v126, v147
  v_cvt_pk_bf16_f32 v144, v144, v145
  v_cvt_pk_bf16_f32 v145, v146, v147
  ds_write_b32 v5, v144 offset:256
  ds_write_b32 v5, v145 offset:1280
  v_mul_f32 v136, v126, v136
  v_mul_f32 v137, v126, v137
  v_mul_f32 v138, v126, v138
  v_mul_f32 v139, v126, v139
  v_cvt_pk_bf16_f32 v136, v136, v137
  v_cvt_pk_bf16_f32 v137, v138, v139
  ds_write_b32 v5, v136 offset:2304
  ds_write_b32 v5, v137 offset:3328
  v_mul_f32 v140, v126, v140
  v_mul_f32 v141, v126, v141
  v_mul_f32 v142, v126, v142
  v_mul_f32 v143, v126, v143
  v_cvt_pk_bf16_f32 v140, v140, v141
  v_cvt_pk_bf16_f32 v141, v142, v143
  ds_write_b32 v5, v140 offset:4352
  ds_write_b32 v5, v141 offset:5376
  v_mfma_f32_16x16x32_bf16 v[124:127], v[90:93], v[120:123], v[36:39]
  v_mfma_f32_16x16x32_bf16 v[124:127], v[88:91], v[18:21], v[124:127]
  v_mfma_f32_16x16x32_bf16 v[128:131], v[110:113], v[120:123], v[32:35]
  v_mfma_f32_16x16x32_bf16 v[128:131], v[108:111], v[18:21], v[128:131]
  v_mfma_f32_16x16x32_bf16 v[132:135], v[62:65], v[120:123], v[44:47]
  v_mfma_f32_16x16x32_bf16 v[132:135], v[60:63], v[18:21], v[132:135]
  v_mfma_f32_16x16x32_bf16 v[136:139], v[82:85], v[120:123], v[40:43]
  v_mfma_f32_16x16x32_bf16 v[136:139], v[80:83], v[18:21], v[136:139]
  v_add_f32 v124, v54, v124
  v_add_f32 v125, v54, v125
  v_add_f32 v126, v54, v126
  v_add_f32 v127, v54, v127
  v_add_f32 v128, v54, v128
  v_add_f32 v129, v54, v129
  v_add_f32 v130, v54, v130
  v_add_f32 v131, v54, v131
  v_add_f32 v132, v55, v132
  v_add_f32 v133, v55, v133
  v_add_f32 v134, v55, v134
  v_add_f32 v135, v55, v135
  v_add_f32 v136, v55, v136
  v_add_f32 v137, v55, v137
  v_add_f32 v138, v55, v138
  v_add_f32 v139, v55, v139
  v_max_f32 v58, v124, v125
  v_max3_f32 v58, v126, v127, v58
  v_max3_f32 v58, v128, v129, v58
  v_max3_f32 v58, v130, v131, v58
  v_max3_f32 v58, v132, v133, v58
  v_max3_f32 v58, v134, v135, v58
  v_max3_f32 v58, v136, v137, v58
  v_max3_f32 v58, v138, v139, v58
  v_mov_b32 v59, v58
  s_nop 1
  v_permlane32_swap_b32 v58, v59
  v_max_f32 v58, v58, v59
  v_mov_b32 v59, v58
  s_nop 1
  v_permlane16_swap_b32 v58, v59
  v_max_f32 v58, v58, v59
  v_sub_f32 v124, v124, v58
  v_sub_f32 v125, v125, v58
  v_sub_f32 v126, v126, v58
  v_sub_f32 v127, v127, v58
  v_sub_f32 v128, v128, v58
  v_sub_f32 v129, v129, v58
  v_sub_f32 v130, v130, v58
  v_sub_f32 v131, v131, v58
  v_sub_f32 v132, v132, v58
  v_sub_f32 v133, v133, v58
  v_sub_f32 v134, v134, v58
  v_sub_f32 v135, v135, v58
  v_sub_f32 v136, v136, v58
  v_sub_f32 v137, v137, v58
  v_sub_f32 v138, v138, v58
  v_sub_f32 v139, v139, v58
  v_exp_f32 v124, v124
  v_exp_f32 v125, v125
  v_exp_f32 v126, v126
  v_exp_f32 v127, v127
  v_cvt_pk_bf16_f32 v124, v124, v125
  v_cvt_pk_bf16_f32 v125, v126, v127
  v_exp_f32 v128, v128
  v_exp_f32 v129, v129
  v_exp_f32 v130, v130
  v_exp_f32 v131, v131
  v_cvt_pk_bf16_f32 v126, v128, v129
  v_cvt_pk_bf16_f32 v127, v130, v131
  v_exp_f32 v132, v132
  v_exp_f32 v133, v133
  v_exp_f32 v134, v134
  v_exp_f32 v135, v135
  v_cvt_pk_bf16_f32 v128, v132, v133
  v_cvt_pk_bf16_f32 v129, v134, v135
  v_exp_f32 v136, v136
  v_exp_f32 v137, v137
  v_exp_f32 v138, v138
  v_exp_f32 v139, v139
  v_cvt_pk_bf16_f32 v130, v136, v137
  v_cvt_pk_bf16_f32 v131, v138, v139
  v_mov_b64 v[120:121], 0
  s_nop 1
  v_smfmac_f32_16x16x64_bf16 v[120:123], a[240:243], v[124:131], v10
  v_mfma_f32_16x16x32_bf16 v[140:143], v[68:71], v[128:131], 0
  v_mfma_f32_16x16x32_bf16 v[140:143], v[96:99], v[124:127], v[140:143]
  v_mfma_f32_16x16x32_bf16 v[132:135], v[104:107], v[124:127], 0
  v_mfma_f32_16x16x32_bf16 v[132:135], v[72:75], v[128:131], v[132:135]
  v_mfma_f32_16x16x32_bf16 v[136:139], v[76:79], v[128:131], 0
  v_mfma_f32_16x16x32_bf16 v[136:139], v[100:103], v[124:127], v[136:139]
  v_add_f32 v120, v120, v121
  v_rcp_f32 v122, v120
  s_nop 0
  v_mul_f32 v140, v122, v140
  v_mul_f32 v141, v122, v141
  v_mul_f32 v142, v122, v142
  v_mul_f32 v143, v122, v143
  v_cvt_pk_bf16_f32 v140, v140, v141
  v_cvt_pk_bf16_f32 v141, v142, v143
  ds_write_b32 v5, v140 offset:512
  ds_write_b32 v5, v141 offset:1536
  v_mul_f32 v132, v122, v132
  v_mul_f32 v133, v122, v133
  v_mul_f32 v134, v122, v134
  v_mul_f32 v135, v122, v135
  v_cvt_pk_bf16_f32 v132, v132, v133
  v_cvt_pk_bf16_f32 v133, v134, v135
  ds_write_b32 v5, v132 offset:2560
  s_waitcnt lgkmcnt(12)
  ds_write_b32 v5, v133 offset:3584
  v_mul_f32 v136, v122, v136
  v_mul_f32 v137, v122, v137
  v_mul_f32 v138, v122, v138
  v_mul_f32 v139, v122, v139
  v_cvt_pk_bf16_f32 v136, v136, v137
  v_cvt_pk_bf16_f32 v137, v138, v139
  ds_write_b32 v5, v136 offset:4608
  ds_write_b32 v5, v137 offset:5632
  v_mfma_f32_16x16x32_bf16 v[120:123], v[88:91], v[116:119], v[40:43]
  v_mfma_f32_16x16x32_bf16 v[120:123], v[90:93], v[20:23], v[120:123]
  v_mfma_f32_16x16x32_bf16 v[124:127], v[108:111], v[116:119], v[36:39]
  v_mfma_f32_16x16x32_bf16 v[124:127], v[110:113], v[20:23], v[124:127]
  v_mfma_f32_16x16x32_bf16 v[128:131], v[60:63], v[116:119], v[48:51]
  v_mfma_f32_16x16x32_bf16 v[128:131], v[62:65], v[20:23], v[128:131]
  v_mfma_f32_16x16x32_bf16 v[88:91], v[80:83], v[116:119], v[44:47]
  v_mfma_f32_16x16x32_bf16 v[88:91], v[82:85], v[20:23], v[88:91]
  v_add_f32 v120, v54, v120
  v_add_f32 v121, v54, v121
  v_add_f32 v122, v54, v122
  v_add_f32 v123, v54, v123
  v_add_f32 v124, v54, v124
  v_add_f32 v125, v54, v125
  v_add_f32 v126, v54, v126
  v_add_f32 v127, v54, v127
  v_add_f32 v128, v55, v128
  v_add_f32 v129, v55, v129
  v_add_f32 v130, v55, v130
  v_add_f32 v131, v55, v131
  v_add_f32 v88, v55, v88
  v_add_f32 v89, v55, v89
  v_add_f32 v90, v55, v90
  v_add_f32 v91, v55, v91
  v_max_f32 v58, v120, v121
  v_max3_f32 v58, v122, v123, v58
  v_max3_f32 v58, v124, v125, v58
  v_max3_f32 v58, v126, v127, v58
  v_max3_f32 v58, v128, v129, v58
  v_max3_f32 v58, v130, v131, v58
  v_max3_f32 v58, v88, v89, v58
  v_max3_f32 v58, v90, v91, v58
  v_mov_b32 v59, v58
  s_nop 1
  v_permlane32_swap_b32 v58, v59
  v_max_f32 v58, v58, v59
  v_mov_b32 v59, v58
  s_nop 1
  v_permlane16_swap_b32 v58, v59
  v_max_f32 v58, v58, v59
  v_sub_f32 v120, v120, v58
  v_sub_f32 v121, v121, v58
  v_sub_f32 v122, v122, v58
  v_sub_f32 v123, v123, v58
  v_sub_f32 v124, v124, v58
  v_sub_f32 v125, v125, v58
  v_sub_f32 v126, v126, v58
  v_sub_f32 v127, v127, v58
  v_sub_f32 v128, v128, v58
  v_sub_f32 v129, v129, v58
  v_sub_f32 v130, v130, v58
  v_sub_f32 v131, v131, v58
  v_sub_f32 v88, v88, v58
  v_sub_f32 v89, v89, v58
  v_sub_f32 v90, v90, v58
  v_sub_f32 v91, v91, v58
  v_exp_f32 v120, v120
  v_exp_f32 v121, v121
  v_exp_f32 v122, v122
  v_exp_f32 v123, v123
  v_cvt_pk_bf16_f32 v120, v120, v121
  v_cvt_pk_bf16_f32 v121, v122, v123
  v_exp_f32 v124, v124
  v_exp_f32 v125, v125
  v_exp_f32 v126, v126
  v_exp_f32 v127, v127
  v_cvt_pk_bf16_f32 v122, v124, v125
  v_cvt_pk_bf16_f32 v123, v126, v127
  v_exp_f32 v128, v128
  v_exp_f32 v129, v129
  v_exp_f32 v130, v130
  v_exp_f32 v131, v131
  v_cvt_pk_bf16_f32 v124, v128, v129
  v_cvt_pk_bf16_f32 v125, v130, v131
  v_exp_f32 v88, v88
  v_exp_f32 v89, v89
  v_exp_f32 v90, v90
  v_exp_f32 v91, v91
  v_cvt_pk_bf16_f32 v126, v88, v89
  v_cvt_pk_bf16_f32 v127, v90, v91
  v_mov_b64 v[80:81], 0
  s_nop 1
  v_smfmac_f32_16x16x64_bf16 v[80:83], a[240:243], v[120:127], v10
  v_mfma_f32_16x16x32_bf16 v[84:87], v[68:71], v[124:127], 0
  v_mfma_f32_16x16x32_bf16 v[84:87], v[96:99], v[120:123], v[84:87]
  v_mfma_f32_16x16x32_bf16 v[60:63], v[104:107], v[120:123], 0
  v_mfma_f32_16x16x32_bf16 v[60:63], v[72:75], v[124:127], v[60:63]
  v_mfma_f32_16x16x32_bf16 v[64:67], v[76:79], v[124:127], 0
  v_mfma_f32_16x16x32_bf16 v[64:67], v[100:103], v[120:123], v[64:67]
  v_add_f32 v80, v80, v81
  v_rcp_f32 v82, v80
  s_nop 0
  v_mul_f32 v84, v82, v84
  v_mul_f32 v85, v82, v85
  v_mul_f32 v86, v82, v86
  v_mul_f32 v87, v82, v87
  v_cvt_pk_bf16_f32 v84, v84, v85
  v_cvt_pk_bf16_f32 v85, v86, v87
  s_waitcnt lgkmcnt(12)
  ds_write_b32 v5, v84 offset:768
  ds_write_b32 v5, v85 offset:1792
  v_mul_f32 v60, v82, v60
  v_mul_f32 v61, v82, v61
  v_mul_f32 v62, v82, v62
  v_mul_f32 v63, v82, v63
  v_cvt_pk_bf16_f32 v60, v60, v61
  v_cvt_pk_bf16_f32 v61, v62, v63
  ds_write_b32 v5, v60 offset:2816
  s_waitcnt lgkmcnt(12)
  ds_write_b32 v5, v61 offset:3840
  v_mul_f32 v64, v82, v64
  v_mul_f32 v65, v82, v65
  v_mul_f32 v66, v82, v66
  v_mul_f32 v67, v82, v67
  v_cvt_pk_bf16_f32 v64, v64, v65
  v_cvt_pk_bf16_f32 v65, v66, v67
  ds_write_b32 v5, v64 offset:4864
  ds_write_b32 v5, v65 offset:5888
  s_waitcnt lgkmcnt(0)
  s_barrier
  ds_read_b128 a[244:247], v3 offset:0
  ds_read_b128 a[248:251], v3 offset:4096
  ds_read_b128 a[252:255], v3 offset:8192
  ds_read_b128 v[72:75], v3 offset:12288
  ds_read_b128 v[76:79], v3 offset:16384
  ds_read_b128 v[84:87], v3 offset:20480
  s_waitcnt lgkmcnt(5)
  v_mfma_f32_16x16x32_bf16 v[68:71], a[244:247], v[184:187], 0
  s_waitcnt lgkmcnt(4)
  v_mfma_f32_16x16x32_bf16 v[68:71], a[248:251], v[200:203], v[68:71]
  s_waitcnt lgkmcnt(3)
  v_mfma_f32_16x16x32_bf16 v[68:71], a[252:255], v[216:219], v[68:71]
  s_waitcnt lgkmcnt(2)
  v_mfma_f32_16x16x32_bf16 v[68:71], v[72:75], v[232:235], v[68:71]
  s_waitcnt lgkmcnt(1)
  v_mfma_f32_16x16x32_bf16 v[68:71], v[76:79], v[248:251], v[68:71]
  s_waitcnt lgkmcnt(0)
  v_mfma_f32_16x16x32_bf16 v[68:71], v[84:87], a[224:227], v[68:71]
  v_mfma_f32_16x16x32_bf16 v[80:83], v[84:87], a[228:231], 0
  v_mfma_f32_16x16x32_bf16 v[80:83], v[76:79], v[252:255], v[80:83]
  v_mfma_f32_16x16x32_bf16 v[80:83], v[72:75], v[236:239], v[80:83]
  v_mfma_f32_16x16x32_bf16 v[80:83], a[252:255], v[220:223], v[80:83]
  v_mfma_f32_16x16x32_bf16 v[80:83], a[248:251], v[204:207], v[80:83]
  v_mfma_f32_16x16x32_bf16 v[80:83], a[244:247], v[188:191], v[80:83]
  v_mfma_f32_16x16x32_bf16 v[60:63], a[244:247], v[192:195], 0
  v_mfma_f32_16x16x32_bf16 v[60:63], a[248:251], v[208:211], v[60:63]
  v_mfma_f32_16x16x32_bf16 v[60:63], a[252:255], v[224:227], v[60:63]
  v_mfma_f32_16x16x32_bf16 v[60:63], v[72:75], v[240:243], v[60:63]
  v_mfma_f32_16x16x32_bf16 v[60:63], v[76:79], a[216:219], v[60:63]
  v_mfma_f32_16x16x32_bf16 v[60:63], v[84:87], a[232:235], v[60:63]
  v_mfma_f32_16x16x32_bf16 v[64:67], v[84:87], a[236:239], 0
  v_mfma_f32_16x16x32_bf16 v[64:67], v[76:79], a[220:223], v[64:67]
  v_mfma_f32_16x16x32_bf16 v[64:67], v[72:75], v[244:247], v[64:67]
  v_mfma_f32_16x16x32_bf16 v[64:67], a[252:255], v[228:231], v[64:67]
  v_mfma_f32_16x16x32_bf16 v[64:67], a[248:251], v[212:215], v[64:67]
  v_mfma_f32_16x16x32_bf16 v[64:67], a[244:247], v[196:199], v[64:67]
  v_cvt_pk_bf16_f32 v68, v68, v80
  v_cvt_pk_bf16_f32 v69, v69, v81
  v_cvt_pk_bf16_f32 v70, v70, v82
  v_cvt_pk_bf16_f32 v71, v71, v83
  buffer_store_dword v68, v7, s[24:27], s33 offen offset:0 nt
  buffer_store_dword v69, v7, s[24:27], s33 offen offset:384 nt
  buffer_store_dword v70, v7, s[24:27], s33 offen offset:768 nt
  buffer_store_dword v71, v7, s[24:27], s33 offen offset:1152 nt
  v_cvt_pk_bf16_f32 v60, v60, v64
  v_cvt_pk_bf16_f32 v61, v61, v65
  v_cvt_pk_bf16_f32 v62, v62, v66
  v_cvt_pk_bf16_f32 v63, v63, v67
  buffer_store_dword v60, v8, s[24:27], s33 offen offset:0 nt
  buffer_store_dword v61, v8, s[24:27], s33 offen offset:384 nt
  buffer_store_dword v62, v8, s[24:27], s33 offen offset:768 nt
  buffer_store_dword v63, v8, s[24:27], s33 offen offset:1152 nt
  ds_read_b128 a[244:247], v4 offset:0
  ds_read_b128 a[248:251], v4 offset:4096
  ds_read_b128 a[252:255], v4 offset:8192
  ds_read_b128 v[68:71], v4 offset:12288
  ds_read_b128 v[72:75], v4 offset:16384
  ds_read_b128 v[76:79], v4 offset:20480
  s_waitcnt lgkmcnt(5)
  v_mfma_f32_16x16x32_bf16 v[60:63], a[244:247], v[184:187], 0
  s_waitcnt lgkmcnt(4)
  v_mfma_f32_16x16x32_bf16 v[60:63], a[248:251], v[200:203], v[60:63]
  s_waitcnt lgkmcnt(3)
  v_mfma_f32_16x16x32_bf16 v[60:63], a[252:255], v[216:219], v[60:63]
  s_waitcnt lgkmcnt(2)
  v_mfma_f32_16x16x32_bf16 v[60:63], v[68:71], v[232:235], v[60:63]
  s_waitcnt lgkmcnt(1)
  v_mfma_f32_16x16x32_bf16 v[60:63], v[72:75], v[248:251], v[60:63]
  s_waitcnt lgkmcnt(0)
  v_mfma_f32_16x16x32_bf16 v[60:63], v[76:79], a[224:227], v[60:63]
  v_mfma_f32_16x16x32_bf16 v[64:67], v[76:79], a[228:231], 0
  v_mfma_f32_16x16x32_bf16 v[64:67], v[72:75], v[252:255], v[64:67]
  v_mfma_f32_16x16x32_bf16 v[64:67], v[68:71], v[236:239], v[64:67]
  v_mfma_f32_16x16x32_bf16 v[64:67], a[252:255], v[220:223], v[64:67]
  v_mfma_f32_16x16x32_bf16 v[64:67], a[248:251], v[204:207], v[64:67]
  v_mfma_f32_16x16x32_bf16 v[64:67], a[244:247], v[188:191], v[64:67]
  s_nop 7
  v_cvt_pk_bf16_f32 v60, v60, v64
  v_cvt_pk_bf16_f32 v61, v61, v65
  v_cvt_pk_bf16_f32 v62, v62, v66
  v_cvt_pk_bf16_f32 v63, v63, v67
  buffer_store_dword v60, v7, s[24:27], s34 offen offset:0 nt
  buffer_store_dword v61, v7, s[24:27], s34 offen offset:384 nt
  buffer_store_dword v62, v7, s[24:27], s34 offen offset:768 nt
  buffer_store_dword v63, v7, s[24:27], s34 offen offset:1152 nt
  ds_read_b128 a[244:247], v3 offset:512
  ds_read_b128 a[248:251], v3 offset:4608
  ds_read_b128 a[252:255], v3 offset:8704
  ds_read_b128 v[72:75], v3 offset:12800
  ds_read_b128 v[76:79], v3 offset:16896
  ds_read_b128 v[84:87], v3 offset:20992
  s_waitcnt lgkmcnt(5)
  v_mfma_f32_16x16x32_bf16 v[60:63], a[244:247], v[184:187], 0
  s_waitcnt lgkmcnt(4)
  v_mfma_f32_16x16x32_bf16 v[60:63], a[248:251], v[200:203], v[60:63]
  s_waitcnt lgkmcnt(3)
  v_mfma_f32_16x16x32_bf16 v[60:63], a[252:255], v[216:219], v[60:63]
  s_waitcnt lgkmcnt(2)
  v_mfma_f32_16x16x32_bf16 v[60:63], v[72:75], v[232:235], v[60:63]
  s_waitcnt lgkmcnt(1)
  v_mfma_f32_16x16x32_bf16 v[60:63], v[76:79], v[248:251], v[60:63]
  s_waitcnt lgkmcnt(0)
  v_mfma_f32_16x16x32_bf16 v[60:63], v[84:87], a[224:227], v[60:63]
  v_mfma_f32_16x16x32_bf16 v[80:83], v[84:87], a[228:231], 0
  v_mfma_f32_16x16x32_bf16 v[80:83], v[76:79], v[252:255], v[80:83]
  v_mfma_f32_16x16x32_bf16 v[80:83], v[72:75], v[236:239], v[80:83]
  v_mfma_f32_16x16x32_bf16 v[80:83], a[252:255], v[220:223], v[80:83]
  v_mfma_f32_16x16x32_bf16 v[80:83], a[248:251], v[204:207], v[80:83]
  v_mfma_f32_16x16x32_bf16 v[80:83], a[244:247], v[188:191], v[80:83]
  v_mfma_f32_16x16x32_bf16 v[64:67], a[244:247], v[192:195], 0
  v_mfma_f32_16x16x32_bf16 v[64:67], a[248:251], v[208:211], v[64:67]
  v_mfma_f32_16x16x32_bf16 v[64:67], a[252:255], v[224:227], v[64:67]
  v_mfma_f32_16x16x32_bf16 v[64:67], v[72:75], v[240:243], v[64:67]
  v_mfma_f32_16x16x32_bf16 v[64:67], v[76:79], a[216:219], v[64:67]
  v_mfma_f32_16x16x32_bf16 v[64:67], v[84:87], a[232:235], v[64:67]
  v_mfma_f32_16x16x32_bf16 v[68:71], v[84:87], a[236:239], 0
  v_mfma_f32_16x16x32_bf16 v[68:71], v[76:79], a[220:223], v[68:71]
  v_mfma_f32_16x16x32_bf16 v[68:71], v[72:75], v[244:247], v[68:71]
  v_mfma_f32_16x16x32_bf16 v[68:71], a[252:255], v[228:231], v[68:71]
  v_mfma_f32_16x16x32_bf16 v[68:71], a[248:251], v[212:215], v[68:71]
  v_mfma_f32_16x16x32_bf16 v[68:71], a[244:247], v[196:199], v[68:71]
  v_cvt_pk_bf16_f32 v60, v60, v80
  v_cvt_pk_bf16_f32 v61, v61, v81
  v_cvt_pk_bf16_f32 v62, v62, v82
  v_cvt_pk_bf16_f32 v63, v63, v83
  buffer_store_dword v60, v7, s[24:27], s35 offen offset:0 nt
  buffer_store_dword v61, v7, s[24:27], s35 offen offset:384 nt
  buffer_store_dword v62, v7, s[24:27], s35 offen offset:768 nt
  buffer_store_dword v63, v7, s[24:27], s35 offen offset:1152 nt
  v_cvt_pk_bf16_f32 v64, v64, v68
  v_cvt_pk_bf16_f32 v65, v65, v69
  v_cvt_pk_bf16_f32 v66, v66, v70
  v_cvt_pk_bf16_f32 v67, v67, v71
  buffer_store_dword v64, v8, s[24:27], s35 offen offset:0 nt
  buffer_store_dword v65, v8, s[24:27], s35 offen offset:384 nt
  buffer_store_dword v66, v8, s[24:27], s35 offen offset:768 nt
  buffer_store_dword v67, v8, s[24:27], s35 offen offset:1152 nt
  ds_read_b128 a[244:247], v4 offset:512
  ds_read_b128 a[248:251], v4 offset:4608
  ds_read_b128 a[252:255], v4 offset:8704
  ds_read_b128 v[72:75], v4 offset:12800
  ds_read_b128 v[76:79], v4 offset:16896
  ds_read_b128 v[80:83], v4 offset:20992
  s_waitcnt lgkmcnt(5)
  v_mfma_f32_16x16x32_bf16 v[60:63], a[244:247], v[184:187], 0
  s_waitcnt lgkmcnt(4)
  v_mfma_f32_16x16x32_bf16 v[60:63], a[248:251], v[200:203], v[60:63]
  s_waitcnt lgkmcnt(3)
  v_mfma_f32_16x16x32_bf16 v[60:63], a[252:255], v[216:219], v[60:63]
  s_waitcnt lgkmcnt(2)
  v_mfma_f32_16x16x32_bf16 v[60:63], v[72:75], v[232:235], v[60:63]
  s_waitcnt lgkmcnt(1)
  v_mfma_f32_16x16x32_bf16 v[60:63], v[76:79], v[248:251], v[60:63]
  s_waitcnt lgkmcnt(0)
  v_mfma_f32_16x16x32_bf16 v[60:63], v[80:83], a[224:227], v[60:63]
  v_mfma_f32_16x16x32_bf16 v[64:67], v[80:83], a[228:231], 0
  v_mfma_f32_16x16x32_bf16 v[64:67], v[76:79], v[252:255], v[64:67]
  v_mfma_f32_16x16x32_bf16 v[64:67], v[72:75], v[236:239], v[64:67]
  v_mfma_f32_16x16x32_bf16 v[64:67], a[252:255], v[220:223], v[64:67]
  v_mfma_f32_16x16x32_bf16 v[64:67], a[248:251], v[204:207], v[64:67]
  v_mfma_f32_16x16x32_bf16 v[64:67], a[244:247], v[188:191], v[64:67]
  s_nop 7
  v_cvt_pk_bf16_f32 v60, v60, v64
  v_cvt_pk_bf16_f32 v61, v61, v65
  v_cvt_pk_bf16_f32 v62, v62, v66
  v_cvt_pk_bf16_f32 v63, v63, v67
  buffer_store_dword v60, v7, s[24:27], s36 offen offset:0 nt
  buffer_store_dword v61, v7, s[24:27], s36 offen offset:384 nt
  buffer_store_dword v62, v7, s[24:27], s36 offen offset:768 nt
  buffer_store_dword v63, v7, s[24:27], s36 offen offset:1152 nt
  v_sub_u32 v6, v6, v56
  v_sub_u32 v7, v7, v57
  v_sub_u32 v8, v8, v57
  v_mov_b32 v54, 0
  v_mov_b32 v55, 0
  v_mov_b32 v56, 0
  v_mov_b32 v57, 0
  s_add_u32 s50, s50, 1
  s_cmp_eq_u32 s50, 16
  s_cselect_b32 s5, s58, s43
  s_add_u32 s56, s56, s5
  s_mul_i32 s5, s3, s57
  s_add_u32 s31, s56, s5
  s_add_u32 s32, s31, 786432
  s_xor_b32 s5, s4, 0
  s_mul_i32 s5, s5, 393216
  s_add_u32 s33, s5, s56
  s_xor_b32 s5, s4, 1
  s_mul_i32 s5, s5, 393216
  s_add_u32 s34, s5, s56
  s_xor_b32 s5, s4, 2
  s_mul_i32 s5, s5, 393216
  s_add_u32 s35, s5, s56
  s_xor_b32 s5, s4, 3
  s_mul_i32 s5, s5, 393216
  s_add_u32 s36, s5, s56
  s_cmp_lt_u32 s50, s49
  s_nop 7
  s_cbranch_scc1 L_sloop
  s_branch L_fin
.section .rodata,"a"
.p2align 6
.amdhsa_kernel standalone__window_attn_swin__vision_kernel
  .amdhsa_next_free_vgpr 512
  .amdhsa_next_free_sgpr 102
  .amdhsa_accum_offset 256
  .amdhsa_group_segment_fixed_size 0
  .amdhsa_kernarg_size 72
  .amdhsa_user_sgpr_count 2
  .amdhsa_user_sgpr_kernarg_segment_ptr 1
  .amdhsa_system_sgpr_workgroup_id_x 1
.end_amdhsa_kernel
```

```asm
; @launch grid=(256,1,1) block=(256,1,1) lds=163840
.amdgcn_target "amdgcn-amd-amdhsa--gfx950"
.text
.globl standalone__window_attn_swin__vision_kernel
.p2align 12
.p2align 8
.type standalone__window_attn_swin__vision_kernel,@function
standalone__window_attn_swin__vision_kernel:
  s_cmpk_ge_u32 s2, 256
  s_cbranch_scc1 L_end
  s_load_dwordx2 s[8:9], s[0:1], 0
  s_load_dwordx2 s[20:21], s[0:1], 24
  s_load_dwordx2 s[12:13], s[0:1], 8
  s_load_dwordx2 s[16:17], s[0:1], 16
  s_load_dwordx2 s[24:25], s[0:1], 48
  s_load_dwordx2 s[62:63], s[0:1], 64
  v_lshrrev_b32 v75, 6, v0
  s_lshr_b32 s49, s2, 3
  v_readfirstlane_b32 s3, v75
  s_getpc_b64 s[50:51]
  v_and_b32 v75, 15, v0
  v_mad_u32_u24 v75, s49, 9, v75
  v_lshlrev_b32 v75, 7, v75
  v_min_u32 v75, L_safe-standalone__window_attn_swin__vision_kernel-256, v75
  v_mov_b32 v59, s51
  v_add_co_u32 v58, vcc, s50, v75
  s_and_b32 s47, s2, 63
  s_lshr_b32 s48, s2, 6
  v_addc_co_u32 v59, vcc, 0, v59, vcc
  global_load_dword v67, v[58:59], off
  v_bfe_u32 v56, v0, 3, 4
  v_and_b32 v54, 7, v0
  v_lshrrev_b32 v71, 1, v56
  v_lshlrev_b32 v76, 2, v56
  v_and_b32 v76, 4, v76
  v_xor_b32 v71, v71, v76
  v_xor_b32 v71, v54, v71
  v_and_b32 v55, 7, v56
  s_add_u32 s48, s48, 60
  s_cmp_lt_u32 s2, 60
  s_cselect_b32 s48, s2, s48
  s_cselect_b32 s47, 63, s47
  s_lshl_b32 s5, s47, 3
  s_add_u32 s5, s5, 4
  v_add_u32 v76, s5, v55
  v_and_b32 v76, 511, v76
  v_mul_u32_u24 v76, 0x180, v76
  v_lshlrev_b32 v58, 4, v71
  v_add_u32 v6, v58, v76
  v_and_b32 v65, 63, v0
  v_lshlrev_b32 v57, 4, v65
  s_mov_b32 s57, 196608
  s_lshl_b32 s5, s48, 3
  s_add_u32 s5, s5, s3
  s_add_u32 s5, s5, 4
  s_mul_i32 s31, s5, s57
  s_add_u32 s5, s5, 4
  s_and_b32 s5, s5, 511
  s_mul_i32 s32, s5, s57
  s_lshl_b32 s46, s3, 10
  s_lshl_b32 s5, s3, 11
  s_add_u32 m0, s5, 151552
  s_mov_b32 s11, 0x20000
  s_mov_b32 s10, 100663296
  s_mov_b32 s23, s11
  s_movk_i32 s22, 1800
  s_mov_b32 s15, s11
  s_mov_b32 s14, 221184
  s_lshl_b32 s49, s49, 2
  s_add_u32 s51, s49, s3
  s_mul_i32 s50, s51, 1728
  v_min_u32 v59, 13, v65
  v_lshlrev_b32 v59, 7, v59
  s_waitcnt lgkmcnt(0)
  buffer_load_dword v66, v59, s[12:15], s50 offen
  buffer_load_dwordx4 v57, s[20:23], 0 offen lds
  buffer_load_dwordx4 v57, s[20:23], 0 offen offset:1024 lds
  s_add_u32 m0, s46, 0
  v_and_b32 v71, 2, v56
  buffer_load_dwordx4 v6, s[8:11], s31 offen offset:0 nt lds
  s_add_u32 m0, s46, 8064
  v_lshrrev_b32 v76, 1, v56
  buffer_load_dwordx4 v6, s[8:11], s31 offen offset:128 nt lds
  s_add_u32 m0, s46, 16128
  v_and_b32 v76, 4, v76
  buffer_load_dwordx4 v6, s[8:11], s31 offen offset:256 nt lds
  s_add_u32 m0, s46, 4096
  v_or_b32 v76, v71, v76
  buffer_load_dwordx4 v6, s[8:11], s32 offen offset:0 nt lds
  s_add_u32 m0, s46, 12160
  v_xor_b32 v76, v54, v76
  buffer_load_dwordx4 v6, s[8:11], s32 offen offset:128 nt lds
  s_add_u32 m0, s46, 20224
  v_lshlrev_b32 v76, 4, v76
  buffer_load_dwordx4 v6, s[8:11], s32 offen offset:256 nt lds
  v_mul_u32_u24 v56, 1152, v55
  v_add_u32 v64, v76, v56
  s_mul_i32 s44, s3, 9216
  v_lshlrev_b32 v71, 1, v71
  v_xor_b32 v71, v54, v71
  v_mul_u32_u24 v76, 0x180, v55
  v_lshl_add_u32 v56, v71, 4, v76
  s_mul_i32 s45, s3, 3072
  s_mov_b32 s19, s11
  s_mov_b32 s18, 73728
  s_mul_i32 s51, s51, 576
  v_min_u32 v63, 512, v59
  v_add_u32 v6, v58, v76
  s_mov_b32 s27, s11
  s_mov_b32 s26, 100663296
  v_and_b32 v54, 15, v65
  v_lshrrev_b32 v55, 4, v65
  v_lshrrev_b32 v75, 1, v54
  v_lshlrev_b32 v71, 2, v54
  v_and_b32 v71, 4, v71
  v_xor_b32 v75, v75, v71
  v_xor_b32 v75, v55, v75
  v_lshlrev_b32 v75, 4, v75
  v_lshl_add_u32 v0, v54, 7, v75
  v_xor_b32 v1, 64, v0
  v_subrev_u32 v2, s46, v0
  s_add_u32 s28, s46, 28672
  s_add_u32 s29, s46, 53248
  s_mov_b32 s30, s46
  s_and_b32 s4, s3, 1
  v_lshlrev_b32 v75, 4, v54
  v_lshl_add_u32 v71, v55, 10, v75
  s_lshl_b32 s5, s4, 8
  s_add_u32 s5, s5, 77824
  v_add_u32 v3, s5, v71
  v_xor_b32 v4, 0x100, v3
  s_mul_i32 s5, s3, 6144
  s_add_u32 s6, s5, 102400
  s_add_u32 s5, s5, 77824
  s_xor_b32 s41, s5, s6
  v_lshl_add_u32 v71, v55, 2, v75
  v_add_u32 v5, s5, v71
  v_and_b32 v70, 7, v54
  v_lshrrev_b32 v73, 3, v54
  v_and_b32 v72, 1, v55
  v_lshrrev_b32 v74, 1, v55
  v_mul_u32_u24 v75, 0x600, v72
  v_mul_u32_u24 v71, s57, v74
  v_add_u32 v75, v75, v71
  v_lshl_add_u32 v75, v54, 2, v75
  s_lshr_b32 s49, s3, 1
  s_lshl_b32 s5, s49, 6
  s_add_u32 s6, s5, 256
  v_add_u32 v53, s6, v75
  s_lshl_b32 s6, s4, 7
  s_add_u32 s5, s5, s6
  v_add_u32 v52, s5, v75
  s_lshl_b32 s5, s47, 3
  s_add_u32 s5, s5, 4
  s_mul_i32 s5, s5, 384
  s_cmp_eq_u32 s47, 63
  s_cselect_b32 s37, 0, s5
  s_cselect_b32 s5, s5, 0
  s_cselect_b32 s6, s57, 0
  v_mul_u32_u24 v71, s6, v72
  v_sub_u32 v71, s5, v71
  s_lshl_b32 s38, s48, 3
  s_add_u32 s38, s38, 4
  s_xor_b32 s6, s4, 0
  s_lshl_b32 s6, s6, 1
  s_add_u32 s6, s6, s38
  s_and_b32 s6, s6, 511
  s_mul_i32 s6, s6, s57
  s_add_u32 s33, s6, s37
  s_xor_b32 s6, s4, 1
  s_lshl_b32 s6, s6, 1
  s_add_u32 s6, s6, s38
  s_and_b32 s6, s6, 511
  s_mul_i32 s6, s6, s57
  s_add_u32 s34, s6, s37
  s_xor_b32 s6, s4, 2
  s_lshl_b32 s6, s6, 1
  s_add_u32 s6, s6, s38
  s_and_b32 s6, s6, 511
  s_mul_i32 s6, s6, s57
  s_add_u32 s35, s6, s37
  s_xor_b32 s6, s4, 3
  s_lshl_b32 s6, s6, 1
  s_add_u32 s6, s6, s38
  s_and_b32 s6, s6, 511
  s_mul_i32 s6, s6, s57
  s_add_u32 s36, s6, s37
  v_add_u32 v7, v52, v71
  v_add_u32 v8, v53, v71
  s_lshr_b32 s5, s2, 6
  s_and_b32 s6, s2, 63
  s_mul_i32 s56, s5, 15
  s_lshl_b32 s43, s57, 5
  s_cmp_eq_u32 s6, 63
  s_cselect_b32 s6, s56, s6
  s_cselect_b32 s5, 60, s5
  s_cselect_b32 s43, 3072, s43
  s_mul_i32 s5, s5, 1572864
  s_mul_i32 s6, s6, 3072
  s_add_u32 s5, s5, s6
  s_add_u32 s56, s5, 787968
  s_cmp_eq_u32 s43, 3072
  s_cselect_b32 s10, s10, 95158272
  s_mul_i32 s5, s3, s57
  s_add_u32 s31, s56, s5
  s_add_u32 s32, s31, 786432
  s_mul_i32 s6, s43, 3
  s_add_u32 s5, s5, s6
  s_xor_b32 s6, s4, 0
  s_mul_i32 s6, s6, 393216
  s_sub_u32 s37, s6, s5
  s_xor_b32 s6, s4, 1
  s_mul_i32 s6, s6, 393216
  s_sub_u32 s38, s6, s5
  s_xor_b32 s6, s4, 2
  s_mul_i32 s6, s6, 393216
  s_sub_u32 s39, s6, s5
  s_xor_b32 s6, s4, 3
  s_mul_i32 s6, s6, 393216
  s_sub_u32 s40, s6, s5
  s_mov_b32 s97, 14
  s_mov_b32 s42, 0x3e553b95
  v_lshrrev_b32 v75, 2, v54
  v_lshl_add_u32 v71, v72, 1, v73
  v_lshl_add_u32 v75, v55, 3, v75
  v_lshlrev_b32 v75, 7, v75
  v_lshl_add_u32 v75, v71, 5, v75
  v_and_b32 v77, 3, v54
  v_lshl_add_u32 v75, v77, 3, v75
  s_mul_i32 s5, s3, 3
  s_and_b32 s6, s5, 3
  s_lshl_b32 s6, s6, 5
  s_lshr_b32 s7, s5, 2
  s_lshl_b32 s7, s7, 13
  s_add_u32 s7, s7, 28672
  v_xor_b32 v71, s6, v75
  v_add_u32 v60, s7, v71
  v_add_u32 v61, 73728, v60
  s_add_u32 s5, s5, 1
  s_and_b32 s6, s5, 3
  s_lshl_b32 s6, s6, 5
  s_lshr_b32 s7, s5, 2
  s_lshl_b32 s7, s7, 13
  s_add_u32 s7, s7, 28672
  v_xor_b32 v71, s6, v75
  v_add_u32 v58, s7, v71
  v_add_u32 v59, 73728, v58
  s_add_u32 s5, s5, 1
  s_and_b32 s6, s5, 3
  s_lshl_b32 s6, s6, 5
  s_lshr_b32 s7, s5, 2
  s_lshl_b32 s7, s7, 13
  s_add_u32 s7, s7, 28672
  v_xor_b32 v71, s6, v75
  v_add_u32 v62, s7, v71
  v_add_u32 v57, 73728, v62
  v_xor_b32 v71, s49, v72
  s_lshl_b32 s5, s4, 13
  v_lshl_add_u32 v75, v74, 3, v72
  v_lshl_add_u32 v75, v75, 2, v71
  v_lshl_add_u32 v75, v75, 4, v54
  v_lshlrev_b32 v75, 2, v75
  s_add_u32 s5, s5, 126976
  v_add_u32 v68, s5, v75
  v_add_u32 v69, 128, v68
  v_add_u32 v54, 143360, v75
  v_add_u32 v55, 128, v54
  s_mov_b32 s58, 0x05040100
  s_mov_b32 s59, 0x07060302
  v_cmp_gt_u32 vcc, 2, v77
  v_mov_b32 v75, 0x3f803f80
  v_mov_b32 v71, 0x44444444
  v_cndmask_b32 v75, 0, v75, vcc
  v_cmp_eq_u32 vcc, 1, v77
  v_mov_b32 v76, 0xeeeeeeee
  v_accvgpr_write_b32 a240, v75
  v_accvgpr_write_b32 a241, v75
  v_accvgpr_write_b32 a242, v75
  v_accvgpr_write_b32 a243, v75
  v_cndmask_b32 v10, v71, v76, vcc
  v_mov_b32 v9, 1.0
  s_mov_b32 s98, s43
  s_mov_b64 s[20:21], s[62:63]
  s_mov_b32 s22, 402653184
  s_min_u32 s96, s3, 1
  s_lshl_b32 s96, s96, 7
  s_xor_b32 s96, s96, 1152
  s_bitset1_b32 s96, s97
  s_mov_b64 s[62:63], -1
  v_lshlrev_b32 v11, 3, v65
  v_lshlrev_b32 v75, 2, v70
  v_add_u32 v75, 159808, v75
  v_mov_b32 v71, 0
  ds_write_b32 v75, v71
  s_lshl_b32 m0, s3, 8
  s_nop 0
  ds_write_addtid_b32 v71 offset:24576
  v_mov_b64 v[14:15], 0
  v_mov_b64 v[20:21], 0
  v_sub_u32 v75, v73, v74
  v_mul_i32_i24 v75, 15, v75
  v_lshlrev_b32 v71, 2, v72
  v_sub_u32 v76, v70, v71
  v_add3_u32 v75, v75, v76, 19
  s_mul_i32 s5, s3, 2050
  s_add_u32 s5, s5, 151552
  v_lshl_add_u32 v72, v75, 3, s5
  v_mov_b64 v[24:25], 0
  v_mov_b64 v[26:27], 0
  v_mov_b64 v[28:29], 0
  v_mov_b64 v[30:31], 0
  v_mov_b64 v[32:33], 0
  v_mov_b64 v[34:35], 0
  v_mov_b64 v[36:37], 0
  v_mov_b64 v[38:39], 0
  v_mov_b64 v[40:41], 0
  v_mov_b64 v[42:43], 0
  v_mov_b64 v[44:45], 0
  v_mov_b64 v[46:47], 0
  v_mov_b64 v[48:49], 0
  v_mov_b64 v[50:51], 0
  v_xor_b32 v75, v71, v70
  s_cmp_eq_u32 s47, 63
  s_cselect_b32 s5, 4, 0
  v_and_b32 v75, s5, v75
  v_cmp_eq_u32 vcc, 0, v75
  s_cmp_eq_u32 s48, 63
  s_cselect_b32 s5, 0xc31044fe, 0
  v_mov_b32 v70, s5
  v_mov_b32 v65, 0xc31044fe
  v_cndmask_b32 v70, 0, v70, vcc
  v_cndmask_b32 v65, v65, 0, vcc
  s_add_u32 s5, s44, 0
  s_add_u32 m0, s46, 28672
  s_nop 0
  buffer_load_dwordx4 v64, s[12:15], s5 offen offset:0 lds
  s_add_u32 m0, s46, 36736
  s_nop 0
  buffer_load_dwordx4 v64, s[12:15], s5 offen offset:128 lds
  s_add_u32 m0, s46, 44800
  s_nop 0
  buffer_load_dwordx4 v64, s[12:15], s5 offen offset:256 lds
  s_add_u32 s5, s44, 36864
  s_add_u32 m0, s46, 32768
  s_nop 0
  buffer_load_dwordx4 v64, s[12:15], s5 offen offset:0 lds
  s_add_u32 m0, s46, 40832
  s_nop 0
  buffer_load_dwordx4 v64, s[12:15], s5 offen offset:128 lds
  s_add_u32 m0, s46, 48896
  s_nop 0
  buffer_load_dwordx4 v64, s[12:15], s5 offen offset:256 lds
  s_mov_b64 exec, 0
  s_cmp_eq_u32 s3, 0
  s_cbranch_scc1 L_hop_0_0
  s_cmp_eq_u32 s3, 1
  s_cbranch_scc1 L_hop_1_0
  s_cmp_eq_u32 s3, 2
  s_cbranch_scc1 L_hop_2_0
  s_branch L_hop_3_0
L_walk:
  s_mov_b64 exec, -1
L_walked:
  s_waitcnt vmcnt(12)
  ds_read_u16_d16_hi v24, v72 offset:24
  ds_read_u16_d16_hi v25, v72 offset:16
  ds_read_u16_d16_hi v26, v72 offset:8
  ds_read_u16_d16_hi v27, v72 offset:0
  ds_read_u16_d16_hi v28, v72 offset:264
  ds_read_u16_d16_hi v29, v72 offset:256
  ds_read_u16_d16_hi v30, v72 offset:248
  ds_read_u16_d16_hi v31, v72 offset:240
  ds_read_u16_d16_hi v32, v72 offset:504
  ds_read_u16_d16_hi v33, v72 offset:496
  ds_read_u16_d16_hi v34, v72 offset:488
  ds_read_u16_d16_hi v35, v72 offset:480
  ds_read_u16_d16_hi v36, v72 offset:744
  ds_read_u16_d16_hi v37, v72 offset:736
  ds_read_u16_d16_hi v38, v72 offset:728
  ds_read_u16_d16_hi v39, v72 offset:720
  ds_read_u16_d16_hi v40, v72 offset:984
  ds_read_u16_d16_hi v41, v72 offset:976
  ds_read_u16_d16_hi v42, v72 offset:968
  ds_read_u16_d16_hi v43, v72 offset:960
  ds_read_u16_d16_hi v44, v72 offset:1224
  ds_read_u16_d16_hi v45, v72 offset:1216
  ds_read_u16_d16_hi v46, v72 offset:1208
  ds_read_u16_d16_hi v47, v72 offset:1200
  ds_read_u16_d16_hi v48, v72 offset:1464
  ds_read_u16_d16_hi v49, v72 offset:1456
  ds_read_u16_d16_hi v50, v72 offset:1448
  ds_read_u16_d16_hi v51, v72 offset:1440
  s_mov_b32 s5, 0x3fb8aa3b
  v_add_f32 v70, v65, v70
  s_waitcnt lgkmcnt(15)
  v_mul_f32 v24, s5, v24
  v_mul_f32 v25, s5, v25
  v_mul_f32 v26, s5, v26
  v_mul_f32 v27, s5, v27
  v_mul_f32 v28, s5, v28
  v_mul_f32 v29, s5, v29
  v_mul_f32 v30, s5, v30
  v_mul_f32 v31, s5, v31
  v_mul_f32 v32, s5, v32
  v_mul_f32 v33, s5, v33
  v_mul_f32 v34, s5, v34
  v_mul_f32 v35, s5, v35
  v_mul_f32 v36, s5, v36
  s_waitcnt lgkmcnt(14)
  v_mul_f32 v37, s5, v37
  s_waitcnt lgkmcnt(13)
  v_mul_f32 v38, s5, v38
  s_waitcnt lgkmcnt(12)
  v_mul_f32 v39, s5, v39
  s_waitcnt lgkmcnt(11)
  v_mul_f32 v40, s5, v40
  s_waitcnt lgkmcnt(10)
  v_mul_f32 v41, s5, v41
  s_waitcnt lgkmcnt(9)
  v_mul_f32 v42, s5, v42
  s_waitcnt lgkmcnt(8)
  v_mul_f32 v43, s5, v43
  s_waitcnt lgkmcnt(7)
  v_mul_f32 v44, s5, v44
  s_waitcnt lgkmcnt(6)
  v_mul_f32 v45, s5, v45
  s_waitcnt lgkmcnt(5)
  v_mul_f32 v46, s5, v46
  s_waitcnt lgkmcnt(4)
  v_mul_f32 v47, s5, v47
  s_waitcnt lgkmcnt(3)
  v_mul_f32 v48, s5, v48
  s_waitcnt lgkmcnt(2)
  v_mul_f32 v49, s5, v49
  s_waitcnt lgkmcnt(1)
  v_mul_f32 v50, s5, v50
  s_waitcnt lgkmcnt(0)
  v_mul_f32 v51, s5, v51
  v_add_f32 v76, v70, v48
  v_add_f32 v77, v70, v49
  v_add_f32 v78, v70, v50
  v_add_f32 v79, v70, v51
  v_add_f32 v80, v70, v44
  v_add_f32 v81, v70, v45
  v_add_f32 v82, v70, v46
  v_add_f32 v83, v70, v47
  v_add_f32 v88, v70, v40
  v_add_f32 v89, v70, v41
  v_add_f32 v90, v70, v42
  v_add_f32 v91, v70, v43
  v_add_f32 v84, v70, v32
  v_add_f32 v85, v70, v33
  v_add_f32 v86, v70, v34
  v_add_f32 v87, v70, v35
  v_add_f32 v156, v70, v28
  v_add_f32 v157, v70, v29
  v_add_f32 v158, v70, v30
  v_add_f32 v159, v70, v31
  v_add_f32 v92, v70, v24
  v_add_f32 v93, v70, v25
  v_add_f32 v94, v70, v26
  v_add_f32 v95, v70, v27
  s_add_u32 s5, s44, 73728
  s_add_u32 m0, s46, 53248
  s_nop 0
  buffer_load_dwordx4 v64, s[12:15], s5 offen offset:0 lds
  s_add_u32 m0, s46, 61312
  s_nop 0
  buffer_load_dwordx4 v64, s[12:15], s5 offen offset:128 lds
  s_add_u32 m0, s46, 69376
  s_nop 0
  buffer_load_dwordx4 v64, s[12:15], s5 offen offset:256 lds
  s_add_u32 s5, s44, 110592
  s_add_u32 m0, s46, 57344
  s_nop 0
  buffer_load_dwordx4 v64, s[12:15], s5 offen offset:0 lds
  s_add_u32 m0, s46, 65408
  s_nop 0
  buffer_load_dwordx4 v64, s[12:15], s5 offen offset:128 lds
  s_add_u32 m0, s46, 73472
  s_nop 0
  buffer_load_dwordx4 v64, s[12:15], s5 offen offset:256 lds
  s_waitcnt vmcnt(12)
  s_barrier
  ds_read_b128 v[184:187], v0 offset:0
  ds_read_b128 v[188:191], v1 offset:0
  ds_read_b128 v[208:211], v0 offset:2048
  ds_read_b128 v[212:215], v1 offset:2048
  ds_read_b128 v[232:235], v0 offset:4096
  ds_read_b128 v[236:239], v1 offset:4096
  ds_read_b128 a[216:219], v0 offset:6144
  ds_read_b128 a[220:223], v1 offset:6144
  s_add_u32 s5, s44, 147456
  s_add_u32 m0, s46, 77824
  s_nop 0
  buffer_load_dwordx4 v64, s[12:15], s5 offen offset:0 lds
  s_add_u32 m0, s46, 85888
  s_nop 0
  buffer_load_dwordx4 v64, s[12:15], s5 offen offset:128 lds
  s_add_u32 m0, s46, 93952
  s_nop 0
  buffer_load_dwordx4 v64, s[12:15], s5 offen offset:256 lds
  s_waitcnt vmcnt(9)
  s_barrier
  ds_read_b64_tr_b16 a[0:1], v60 offset:0
  ds_read_b64_tr_b16 a[2:3], v60 offset:512
  ds_read_b64_tr_b16 a[12:13], v60 offset:4096
  ds_read_b64_tr_b16 a[14:15], v60 offset:4608
  s_waitcnt lgkmcnt(2)
  v_mfma_f32_16x16x32_bf16 v[120:123], a[0:3], v[184:187], 0
  s_add_u32 s5, s44, 184320
  s_add_u32 m0, s46, 81920
  ds_read_b64_tr_b16 a[4:5], v58 offset:0
  s_waitcnt lgkmcnt(1)
  v_mfma_f32_16x16x32_bf16 v[120:123], a[12:15], v[188:191], v[120:123]
  buffer_load_dwordx4 v64, s[12:15], s5 offen offset:0 lds
  v_mfma_f32_16x16x32_bf16 v[132:135], a[0:3], v[208:211], 0
  s_add_u32 m0, s46, 89984
  ds_read_b64_tr_b16 a[6:7], v58 offset:512
  ds_read_b64_tr_b16 a[16:17], v58 offset:4096
  v_mfma_f32_16x16x32_bf16 v[132:135], a[12:15], v[212:215], v[132:135]
  buffer_load_dwordx4 v64, s[12:15], s5 offen offset:128 lds
  v_mfma_f32_16x16x32_bf16 v[128:131], a[0:3], v[232:235], 0
  s_add_u32 m0, s46, 98048
  ds_read_b64_tr_b16 a[18:19], v58 offset:4608
  ds_read_b64_tr_b16 a[8:9], v62 offset:0
  v_mfma_f32_16x16x32_bf16 v[128:131], a[12:15], v[236:239], v[128:131]
  buffer_load_dwordx4 v64, s[12:15], s5 offen offset:256 lds
  v_mfma_f32_16x16x32_bf16 v[96:99], a[0:3], a[216:219], 0
  s_add_u32 s5, s44, 384
  s_add_u32 m0, s46, 102400
  ds_read_b64_tr_b16 a[10:11], v62 offset:512
  v_mfma_f32_16x16x32_bf16 v[96:99], a[12:15], a[220:223], v[96:99]
  s_waitcnt lgkmcnt(3)
  ds_read_b64_tr_b16 a[20:21], v62 offset:4096
  ds_read_b64_tr_b16 a[22:23], v62 offset:4608
  v_mfma_f32_16x16x32_bf16 v[140:143], a[4:7], v[184:187], 0
  buffer_load_dwordx4 v64, s[12:15], s5 offen offset:0 lds
  s_waitcnt lgkmcnt(4)
  v_mfma_f32_16x16x32_bf16 v[140:143], a[16:19], v[188:191], v[140:143]
  s_add_u32 m0, s46, 110464
  ds_read_b128 v[192:195], v0 offset:8192
  ds_read_b128 v[196:199], v1 offset:8192
  v_mfma_f32_16x16x32_bf16 v[152:155], a[4:7], v[208:211], 0
  buffer_load_dwordx4 v64, s[12:15], s5 offen offset:128 lds
  v_mfma_f32_16x16x32_bf16 v[152:155], a[16:19], v[212:215], v[152:155]
  s_add_u32 m0, s46, 118528
  ds_read_b128 v[216:219], v0 offset:10240
  ds_read_b128 v[220:223], v1 offset:10240
  v_mfma_f32_16x16x32_bf16 v[180:183], a[4:7], v[232:235], 0
  buffer_load_dwordx4 v64, s[12:15], s5 offen offset:256 lds
  v_mfma_f32_16x16x32_bf16 v[180:183], a[16:19], v[236:239], v[180:183]
  s_add_u32 s5, s44, 37248
  s_add_u32 m0, s46, 106496
  ds_read_b128 v[240:243], v0 offset:12288
  v_mfma_f32_16x16x32_bf16 v[112:115], a[4:7], a[216:219], 0
  s_waitcnt lgkmcnt(3)
  ds_read_b128 v[244:247], v1 offset:12288
  ds_read_b128 a[224:227], v0 offset:14336
  v_mfma_f32_16x16x32_bf16 v[112:115], a[16:19], a[220:223], v[112:115]
  s_waitcnt vmcnt(9)
  s_barrier
  v_mfma_f32_16x16x32_bf16 v[144:147], a[8:11], v[184:187], 0
  buffer_load_dwordx4 v64, s[12:15], s5 offen offset:0 lds
  v_mfma_f32_16x16x32_bf16 v[144:147], a[20:23], v[188:191], v[144:147]
  s_add_u32 m0, s46, 114560
  ds_read_b64_tr_b16 a[24:25], v60 offset:24576
  ds_read_b64_tr_b16 a[26:27], v60 offset:25088
  v_mfma_f32_16x16x32_bf16 v[136:139], a[8:11], v[208:211], 0
  buffer_load_dwordx4 v64, s[12:15], s5 offen offset:128 lds
  v_mfma_f32_16x16x32_bf16 v[136:139], a[20:23], v[212:215], v[136:139]
  s_add_u32 m0, s46, 122624
  ds_read_b64_tr_b16 a[36:37], v60 offset:28672
  ds_read_b64_tr_b16 a[38:39], v60 offset:29184
  v_mfma_f32_16x16x32_bf16 v[104:107], a[8:11], v[232:235], 0
  buffer_load_dwordx4 v64, s[12:15], s5 offen offset:256 lds
  v_mfma_f32_16x16x32_bf16 v[104:107], a[20:23], v[236:239], v[104:107]
  ds_read_b128 a[228:231], v1 offset:14336
  ds_read_b64_tr_b16 a[28:29], v58 offset:24576
  v_mfma_f32_16x16x32_bf16 v[116:119], a[8:11], a[216:219], 0
  ds_read_b64_tr_b16 a[30:31], v58 offset:25088
  ds_read_b64_tr_b16 a[40:41], v58 offset:28672
  v_mfma_f32_16x16x32_bf16 v[116:119], a[20:23], a[220:223], v[116:119]
  s_waitcnt lgkmcnt(6)
  ds_read_b64_tr_b16 a[42:43], v58 offset:29184
  ds_read_b64_tr_b16 a[32:33], v62 offset:24576
  v_mfma_f32_16x16x32_bf16 v[120:123], a[24:27], v[192:195], v[120:123]
  s_waitcnt lgkmcnt(6)
  ds_read_b64_tr_b16 a[34:35], v62 offset:25088
  ds_read_b64_tr_b16 a[44:45], v62 offset:28672
  v_mfma_f32_16x16x32_bf16 v[120:123], a[36:39], v[196:199], v[120:123]
  ds_read_b64_tr_b16 a[46:47], v62 offset:29184
  ds_read_b128 v[200:203], v0 offset:16384
  v_mfma_f32_16x16x32_bf16 v[132:135], a[24:27], v[216:219], v[132:135]
L_hop_0_0:
  s_cbranch_execz L_hop_0_1
  ds_read_b128 v[204:207], v1 offset:16384
  ds_read_b128 v[224:227], v0 offset:18432
  v_mfma_f32_16x16x32_bf16 v[132:135], a[36:39], v[220:223], v[132:135]
  ds_read_b128 v[228:231], v1 offset:18432
  ds_read_b128 v[248:251], v0 offset:20480
  v_mfma_f32_16x16x32_bf16 v[128:131], a[24:27], v[240:243], v[128:131]
  ds_read_b128 v[252:255], v1 offset:20480
  ds_read_b128 a[232:235], v0 offset:22528
  v_mfma_f32_16x16x32_bf16 v[128:131], a[36:39], v[244:247], v[128:131]
  s_add_u32 s5, s44, 74112
  s_add_u32 m0, s46, 126976
  ds_read_b128 a[236:239], v1 offset:22528
  v_mfma_f32_16x16x32_bf16 v[96:99], a[24:27], a[224:227], v[96:99]
  s_waitcnt lgkmcnt(7)
  v_mfma_f32_16x16x32_bf16 v[96:99], a[36:39], a[228:231], v[96:99]
  v_mfma_f32_16x16x32_bf16 v[140:143], a[28:31], v[192:195], v[140:143]
  buffer_load_dwordx4 v64, s[12:15], s5 offen offset:0 lds
  v_mfma_f32_16x16x32_bf16 v[140:143], a[40:43], v[196:199], v[140:143]
  s_add_u32 m0, s46, 135040
  v_mfma_f32_16x16x32_bf16 v[152:155], a[28:31], v[216:219], v[152:155]
  buffer_load_dwordx4 v64, s[12:15], s5 offen offset:128 lds
  v_mfma_f32_16x16x32_bf16 v[152:155], a[40:43], v[220:223], v[152:155]
  s_add_u32 m0, s46, 143104
  v_mfma_f32_16x16x32_bf16 v[180:183], a[28:31], v[240:243], v[180:183]
  buffer_load_dwordx4 v64, s[12:15], s5 offen offset:256 lds
  v_mfma_f32_16x16x32_bf16 v[180:183], a[40:43], v[244:247], v[180:183]
  s_add_u32 s5, s44, 110976
  s_add_u32 m0, s46, 131072
  v_mfma_f32_16x16x32_bf16 v[112:115], a[28:31], a[224:227], v[112:115]
  v_mfma_f32_16x16x32_bf16 v[112:115], a[40:43], a[228:231], v[112:115]
  s_waitcnt vmcnt(9)
  s_barrier
  v_mfma_f32_16x16x32_bf16 v[144:147], a[32:35], v[192:195], v[144:147]
  buffer_load_dwordx4 v64, s[12:15], s5 offen offset:0 lds
  v_mfma_f32_16x16x32_bf16 v[144:147], a[44:47], v[196:199], v[144:147]
  s_add_u32 m0, s46, 139136
  ds_read_b64_tr_b16 a[48:49], v60 offset:49152
  ds_read_b64_tr_b16 a[50:51], v60 offset:49664
  v_mfma_f32_16x16x32_bf16 v[136:139], a[32:35], v[216:219], v[136:139]
  buffer_load_dwordx4 v64, s[12:15], s5 offen offset:128 lds
  v_mfma_f32_16x16x32_bf16 v[136:139], a[44:47], v[220:223], v[136:139]
  s_add_u32 m0, s46, 147200
  ds_read_b64_tr_b16 a[60:61], v60 offset:53248
  ds_read_b64_tr_b16 a[62:63], v60 offset:53760
  v_mfma_f32_16x16x32_bf16 v[104:107], a[32:35], v[240:243], v[104:107]
  buffer_load_dwordx4 v64, s[12:15], s5 offen offset:256 lds
  v_mfma_f32_16x16x32_bf16 v[104:107], a[44:47], v[244:247], v[104:107]
  ds_read_b64_tr_b16 a[52:53], v58 offset:49152
  ds_read_b64_tr_b16 a[54:55], v58 offset:49664
  v_mfma_f32_16x16x32_bf16 v[116:119], a[32:35], a[224:227], v[116:119]
  ds_read_b64_tr_b16 a[64:65], v58 offset:53248
  ds_read_b64_tr_b16 a[66:67], v58 offset:53760
  v_mfma_f32_16x16x32_bf16 v[116:119], a[44:47], a[228:231], v[116:119]
  s_waitcnt lgkmcnt(6)
  ds_read_b64_tr_b16 a[56:57], v62 offset:49152
  ds_read_b64_tr_b16 a[58:59], v62 offset:49664
  v_mfma_f32_16x16x32_bf16 v[120:123], a[48:51], v[200:203], v[120:123]
  s_waitcnt lgkmcnt(6)
  ds_read_b64_tr_b16 a[68:69], v62 offset:53248
  ds_read_b64_tr_b16 a[70:71], v62 offset:53760
  v_mfma_f32_16x16x32_bf16 v[120:123], a[60:63], v[204:207], v[120:123]
  v_mfma_f32_16x16x32_bf16 v[132:135], a[48:51], v[224:227], v[132:135]
  v_mfma_f32_16x16x32_bf16 v[132:135], a[60:63], v[228:231], v[132:135]
  v_mfma_f32_16x16x32_bf16 v[128:131], a[48:51], v[248:251], v[128:131]
  v_mul_f32 v120, s42, v120
  v_mul_f32 v121, s42, v121
  v_mfma_f32_16x16x32_bf16 v[128:131], a[60:63], v[252:255], v[128:131]
  s_add_u32 s5, s44, 147840
  s_add_u32 m0, s46, 28672
  v_mul_f32 v122, s42, v122
  v_mfma_f32_16x16x32_bf16 v[96:99], a[48:51], a[232:235], v[96:99]
  v_mul_f32 v123, s42, v123
  v_cvt_pk_bf16_f32 v12, v120, v121
  v_mfma_f32_16x16x32_bf16 v[96:99], a[60:63], a[236:239], v[96:99]
  s_waitcnt lgkmcnt(0)
  v_cvt_pk_bf16_f32 v13, v122, v123
  v_mul_f32 v132, s42, v132
  v_mfma_f32_16x16x32_bf16 v[140:143], a[52:55], v[200:203], v[140:143]
  buffer_load_dwordx4 v64, s[12:15], s5 offen offset:0 lds
  v_mfma_f32_16x16x32_bf16 v[140:143], a[64:67], v[204:207], v[140:143]
  s_add_u32 m0, s46, 36736
  v_mul_f32 v133, s42, v133
  v_mul_f32 v134, s42, v134
  v_mfma_f32_16x16x32_bf16 v[152:155], a[52:55], v[224:227], v[152:155]
  buffer_load_dwordx4 v64, s[12:15], s5 offen offset:128 lds
  v_mfma_f32_16x16x32_bf16 v[152:155], a[64:67], v[228:231], v[152:155]
  s_add_u32 m0, s46, 44800
  v_mul_f32 v135, s42, v135
  v_cvt_pk_bf16_f32 v120, v132, v133
  v_mfma_f32_16x16x32_bf16 v[180:183], a[52:55], v[248:251], v[180:183]
  buffer_load_dwordx4 v64, s[12:15], s5 offen offset:256 lds
  v_mfma_f32_16x16x32_bf16 v[180:183], a[64:67], v[252:255], v[180:183]
  s_add_u32 s5, s44, 184704
  s_add_u32 m0, s46, 32768
  v_mul_f32 v140, s42, v140
  v_mfma_f32_16x16x32_bf16 v[112:115], a[52:55], a[232:235], v[112:115]
  v_mul_f32 v141, s42, v141
  v_mul_f32 v142, s42, v142
  v_mfma_f32_16x16x32_bf16 v[112:115], a[64:67], a[236:239], v[112:115]
  s_waitcnt vmcnt(9)
  s_barrier
  v_mfma_f32_16x16x32_bf16 v[144:147], a[56:59], v[200:203], v[144:147]
  buffer_load_dwordx4 v64, s[12:15], s5 offen offset:0 lds
  v_mfma_f32_16x16x32_bf16 v[144:147], a[68:71], v[204:207], v[144:147]
  s_add_u32 m0, s46, 40832
  ds_read_b64_tr_b16 a[72:73], v61 offset:0
  ds_read_b64_tr_b16 a[74:75], v61 offset:512
  v_mfma_f32_16x16x32_bf16 v[136:139], a[56:59], v[224:227], v[136:139]
  buffer_load_dwordx4 v64, s[12:15], s5 offen offset:128 lds
  v_mfma_f32_16x16x32_bf16 v[136:139], a[68:71], v[228:231], v[136:139]
  s_add_u32 m0, s46, 48896
  ds_read_b64_tr_b16 a[84:85], v61 offset:4096
  ds_read_b64_tr_b16 a[86:87], v61 offset:4608
  v_mfma_f32_16x16x32_bf16 v[104:107], a[56:59], v[248:251], v[104:107]
  buffer_load_dwordx4 v64, s[12:15], s5 offen offset:256 lds
  v_mfma_f32_16x16x32_bf16 v[104:107], a[68:71], v[252:255], v[104:107]
  ds_read_b64_tr_b16 a[76:77], v59 offset:0
  ds_read_b64_tr_b16 a[78:79], v59 offset:512
  v_mfma_f32_16x16x32_bf16 v[116:119], a[56:59], a[232:235], v[116:119]
  ds_read_b64_tr_b16 a[88:89], v59 offset:4096
  ds_read_b64_tr_b16 a[90:91], v59 offset:4608
  v_mfma_f32_16x16x32_bf16 v[116:119], a[68:71], a[236:239], v[116:119]
  s_waitcnt lgkmcnt(6)
  ds_read_b64_tr_b16 a[80:81], v57 offset:0
  ds_read_b64_tr_b16 a[82:83], v57 offset:512
  v_mfma_f32_16x16x32_bf16 v[166:169], a[72:75], v[184:187], 0
  s_waitcnt lgkmcnt(6)
  ds_read_b64_tr_b16 a[92:93], v57 offset:4096
  ds_read_b64_tr_b16 a[94:95], v57 offset:4608
  v_mfma_f32_16x16x32_bf16 v[166:169], a[84:87], v[188:191], v[166:169]
  v_mul_f32 v143, s42, v143
  v_cvt_pk_bf16_f32 v124, v140, v141
  v_mfma_f32_16x16x32_bf16 v[148:151], a[72:75], v[208:211], 0
  v_cvt_pk_bf16_f32 v125, v142, v143
  v_mul_f32 v144, s42, v144
  v_mfma_f32_16x16x32_bf16 v[148:151], a[84:87], v[212:215], v[148:151]
  v_mul_f32 v145, s42, v145
  v_mul_f32 v146, s42, v146
  v_mfma_f32_16x16x32_bf16 v[72:75], a[72:75], v[232:235], 0
  v_mul_f32 v147, s42, v147
  v_cvt_pk_bf16_f32 v126, v144, v145
  v_mfma_f32_16x16x32_bf16 v[72:75], a[84:87], v[236:239], v[72:75]
  s_add_u32 s5, s44, 768
  s_add_u32 m0, s46, 53248
  v_cvt_pk_bf16_f32 v127, v146, v147
  v_mfma_f32_16x16x32_bf16 v[172:175], a[72:75], a[216:219], 0
  v_cvt_pk_bf16_f32 v121, v134, v135
  v_mul_f32 v152, s42, v152
  v_mfma_f32_16x16x32_bf16 v[172:175], a[84:87], a[220:223], v[172:175]
  s_waitcnt lgkmcnt(0)
  v_mul_f32 v153, s42, v153
  v_mul_f32 v154, s42, v154
  v_mfma_f32_16x16x32_bf16 v[140:143], a[76:79], v[184:187], 0
  buffer_load_dwordx4 v64, s[12:15], s5 offen offset:0 lds
  v_mfma_f32_16x16x32_bf16 v[140:143], a[88:91], v[188:191], v[140:143]
  s_add_u32 m0, s46, 61312
  v_mul_f32 v155, s42, v155
  v_cvt_pk_bf16_f32 v122, v152, v153
  v_mfma_f32_16x16x32_bf16 v[100:103], a[76:79], v[208:211], 0
  buffer_load_dwordx4 v64, s[12:15], s5 offen offset:128 lds
  v_mfma_f32_16x16x32_bf16 v[100:103], a[88:91], v[212:215], v[100:103]
  s_add_u32 m0, s46, 69376
  v_cvt_pk_bf16_f32 v123, v154, v155
  v_mul_f32 v136, s42, v136
  v_mfma_f32_16x16x32_bf16 v[108:111], a[76:79], v[232:235], 0
  buffer_load_dwordx4 v64, s[12:15], s5 offen offset:256 lds
  v_mfma_f32_16x16x32_bf16 v[108:111], a[88:91], v[236:239], v[108:111]
  s_add_u32 s5, s44, 37632
  s_add_u32 m0, s46, 57344
  v_mul_f32 v137, s42, v137
  v_mfma_f32_16x16x32_bf16 v[152:155], a[76:79], a[216:219], 0
  v_mul_f32 v138, s42, v138
  v_mul_f32 v139, s42, v139
  v_mfma_f32_16x16x32_bf16 v[152:155], a[88:91], a[220:223], v[152:155]
  s_waitcnt vmcnt(9)
  s_barrier
  v_mfma_f32_16x16x32_bf16 v[162:165], a[80:83], v[184:187], 0
  buffer_load_dwordx4 v64, s[12:15], s5 offen offset:0 lds
  v_mfma_f32_16x16x32_bf16 v[162:165], a[92:95], v[188:191], v[162:165]
  s_add_u32 m0, s46, 65408
  ds_read_b64_tr_b16 a[96:97], v61 offset:24576
  ds_read_b64_tr_b16 a[98:99], v61 offset:25088
  v_mfma_f32_16x16x32_bf16 v[144:147], a[80:83], v[208:211], 0
  buffer_load_dwordx4 v64, s[12:15], s5 offen offset:128 lds
  v_mfma_f32_16x16x32_bf16 v[144:147], a[92:95], v[212:215], v[144:147]
  s_add_u32 m0, s46, 73472
  ds_read_b64_tr_b16 a[108:109], v61 offset:28672
  ds_read_b64_tr_b16 a[110:111], v61 offset:29184
  v_mfma_f32_16x16x32_bf16 v[176:179], a[80:83], v[232:235], 0
  buffer_load_dwordx4 v64, s[12:15], s5 offen offset:256 lds
  v_mfma_f32_16x16x32_bf16 v[176:179], a[92:95], v[236:239], v[176:179]
  ds_read_b64_tr_b16 a[100:101], v59 offset:24576
  ds_read_b64_tr_b16 a[102:103], v59 offset:25088
  v_mfma_f32_16x16x32_bf16 v[132:135], a[80:83], a[216:219], 0
  ds_read_b64_tr_b16 a[112:113], v59 offset:28672
  ds_read_b64_tr_b16 a[114:115], v59 offset:29184
  v_mfma_f32_16x16x32_bf16 v[132:135], a[92:95], a[220:223], v[132:135]
  s_waitcnt lgkmcnt(6)
  ds_read_b64_tr_b16 a[104:105], v57 offset:24576
  ds_read_b64_tr_b16 a[106:107], v57 offset:25088
  v_mfma_f32_16x16x32_bf16 v[166:169], a[96:99], v[192:195], v[166:169]
  s_waitcnt lgkmcnt(6)
  ds_read_b64_tr_b16 a[116:117], v57 offset:28672
  ds_read_b64_tr_b16 a[118:119], v57 offset:29184
  v_mfma_f32_16x16x32_bf16 v[166:169], a[108:111], v[196:199], v[166:169]
  v_cvt_pk_bf16_f32 v16, v136, v137
  v_cvt_pk_bf16_f32 v17, v138, v139
  v_mfma_f32_16x16x32_bf16 v[148:151], a[96:99], v[216:219], v[148:151]
  v_mul_f32 v128, s42, v128
  v_mul_f32 v129, s42, v129
  v_mfma_f32_16x16x32_bf16 v[148:151], a[108:111], v[220:223], v[148:151]
  v_mul_f32 v130, s42, v130
  v_mul_f32 v131, s42, v131
  v_mfma_f32_16x16x32_bf16 v[72:75], a[96:99], v[240:243], v[72:75]
  v_cvt_pk_bf16_f32 v18, v128, v129
  v_cvt_pk_bf16_f32 v19, v130, v131
  v_mfma_f32_16x16x32_bf16 v[72:75], a[108:111], v[244:247], v[72:75]
  s_add_u32 s5, s44, 74496
  s_add_u32 m0, s46, 77824
  v_mul_f32 v180, s42, v180
  v_mfma_f32_16x16x32_bf16 v[172:175], a[96:99], a[224:227], v[172:175]
  v_mul_f32 v181, s42, v181
  v_mul_f32 v182, s42, v182
  v_mfma_f32_16x16x32_bf16 v[172:175], a[108:111], a[228:231], v[172:175]
  s_waitcnt lgkmcnt(0)
  v_mul_f32 v183, s42, v183
  v_cvt_pk_bf16_f32 v160, v180, v181
  v_mfma_f32_16x16x32_bf16 v[140:143], a[100:103], v[192:195], v[140:143]
  buffer_load_dwordx4 v64, s[12:15], s5 offen offset:0 lds
  v_mfma_f32_16x16x32_bf16 v[140:143], a[112:115], v[196:199], v[140:143]
  s_add_u32 m0, s46, 85888
  v_cvt_pk_bf16_f32 v161, v182, v183
  v_mul_f32 v104, s42, v104
  v_mfma_f32_16x16x32_bf16 v[100:103], a[100:103], v[216:219], v[100:103]
  buffer_load_dwordx4 v64, s[12:15], s5 offen offset:128 lds
  v_mfma_f32_16x16x32_bf16 v[100:103], a[112:115], v[220:223], v[100:103]
  s_add_u32 m0, s46, 93952
  v_mul_f32 v105, s42, v105
  v_mul_f32 v106, s42, v106
  v_mfma_f32_16x16x32_bf16 v[108:111], a[100:103], v[240:243], v[108:111]
  buffer_load_dwordx4 v64, s[12:15], s5 offen offset:256 lds
  v_mfma_f32_16x16x32_bf16 v[108:111], a[112:115], v[244:247], v[108:111]
  s_add_u32 s5, s44, 111360
  s_add_u32 m0, s46, 81920
  v_mul_f32 v107, s42, v107
  v_mfma_f32_16x16x32_bf16 v[152:155], a[100:103], a[224:227], v[152:155]
  v_add_f32 v128, v65, v36
  v_add_f32 v129, v65, v37
  v_mfma_f32_16x16x32_bf16 v[152:155], a[112:115], a[228:231], v[152:155]
  s_waitcnt vmcnt(9)
  s_barrier
  v_mfma_f32_16x16x32_bf16 v[162:165], a[104:107], v[192:195], v[162:165]
  buffer_load_dwordx4 v64, s[12:15], s5 offen offset:0 lds
  v_mfma_f32_16x16x32_bf16 v[162:165], a[116:119], v[196:199], v[162:165]
  s_add_u32 m0, s46, 89984
  ds_read_b64_tr_b16 a[120:121], v60 offset:0
  ds_read_b64_tr_b16 a[122:123], v60 offset:512
  v_mfma_f32_16x16x32_bf16 v[144:147], a[104:107], v[216:219], v[144:147]
  buffer_load_dwordx4 v64, s[12:15], s5 offen offset:128 lds
  v_mfma_f32_16x16x32_bf16 v[144:147], a[116:119], v[220:223], v[144:147]
  s_add_u32 m0, s46, 98048
  ds_read_b64_tr_b16 a[132:133], v60 offset:4096
  ds_read_b64_tr_b16 a[134:135], v60 offset:4608
  v_mfma_f32_16x16x32_bf16 v[176:179], a[104:107], v[240:243], v[176:179]
  buffer_load_dwordx4 v64, s[12:15], s5 offen offset:256 lds
  v_mfma_f32_16x16x32_bf16 v[176:179], a[116:119], v[244:247], v[176:179]
  ds_read_b64_tr_b16 a[124:125], v58 offset:0
  ds_read_b64_tr_b16 a[126:127], v58 offset:512
  v_mfma_f32_16x16x32_bf16 v[132:135], a[104:107], a[224:227], v[132:135]
  ds_read_b64_tr_b16 a[136:137], v58 offset:4096
  ds_read_b64_tr_b16 a[138:139], v58 offset:4608
  v_mfma_f32_16x16x32_bf16 v[132:135], a[116:119], a[228:231], v[132:135]
  s_waitcnt lgkmcnt(6)
  ds_read_b64_tr_b16 a[128:129], v62 offset:0
  ds_read_b64_tr_b16 a[130:131], v62 offset:512
  v_mfma_f32_16x16x32_bf16 v[166:169], a[120:123], v[200:203], v[166:169]
  s_waitcnt lgkmcnt(6)
  ds_read_b64_tr_b16 a[140:141], v62 offset:4096
  ds_read_b64_tr_b16 a[142:143], v62 offset:4608
  v_mfma_f32_16x16x32_bf16 v[166:169], a[132:135], v[204:207], v[166:169]
  v_add_f32 v130, v65, v38
  v_add_f32 v131, v65, v39
  v_mfma_f32_16x16x32_bf16 v[148:151], a[120:123], v[224:227], v[148:151]
  v_add_f32 v180, v65, v32
  v_add_f32 v181, v65, v33
  v_mfma_f32_16x16x32_bf16 v[148:151], a[132:135], v[228:231], v[148:151]
  v_add_f32 v182, v65, v34
  v_add_f32 v183, v65, v35
  v_mfma_f32_16x16x32_bf16 v[72:75], a[120:123], v[248:251], v[72:75]
  v_cvt_pk_bf16_f32 v170, v166, v167
  v_cvt_pk_bf16_f32 v171, v168, v169
  v_mfma_f32_16x16x32_bf16 v[72:75], a[132:135], v[252:255], v[72:75]
  s_add_u32 s5, s44, 148224
  s_add_u32 m0, s46, 102400
  v_add_f32 v166, v65, v40
  v_mfma_f32_16x16x32_bf16 v[172:175], a[120:123], a[232:235], v[172:175]
  v_cvt_pk_bf16_f32 v70, v148, v149
  v_cvt_pk_bf16_f32 v71, v150, v151
  v_mfma_f32_16x16x32_bf16 v[172:175], a[132:135], a[236:239], v[172:175]
  s_waitcnt lgkmcnt(0)
  v_add_f32 v167, v65, v41
  v_add_f32 v168, v65, v42
  v_mfma_f32_16x16x32_bf16 v[140:143], a[124:127], v[200:203], v[140:143]
  buffer_load_dwordx4 v64, s[12:15], s5 offen offset:0 lds
  v_mfma_f32_16x16x32_bf16 v[140:143], a[136:139], v[204:207], v[140:143]
  s_add_u32 m0, s46, 110464
  v_cvt_pk_bf16_f32 v138, v72, v73
  v_cvt_pk_bf16_f32 v139, v74, v75
  v_mfma_f32_16x16x32_bf16 v[100:103], a[124:127], v[224:227], v[100:103]
  buffer_load_dwordx4 v64, s[12:15], s5 offen offset:128 lds
  v_mfma_f32_16x16x32_bf16 v[100:103], a[136:139], v[228:231], v[100:103]
  s_add_u32 m0, s46, 118528
  v_cvt_pk_bf16_f32 v148, v172, v173
  v_cvt_pk_bf16_f32 v149, v174, v175
  v_mfma_f32_16x16x32_bf16 v[108:111], a[124:127], v[248:251], v[108:111]
  buffer_load_dwordx4 v64, s[12:15], s5 offen offset:256 lds
  v_mfma_f32_16x16x32_bf16 v[108:111], a[136:139], v[252:255], v[108:111]
  s_add_u32 s5, s44, 185088
  s_add_u32 m0, s46, 106496
  v_cvt_pk_bf16_f32 v172, v140, v141
  v_mfma_f32_16x16x32_bf16 v[152:155], a[124:127], a[232:235], v[152:155]
  v_cvt_pk_bf16_f32 v173, v142, v143
  v_cvt_pk_bf16_f32 v72, v100, v101
  v_mfma_f32_16x16x32_bf16 v[152:155], a[136:139], a[236:239], v[152:155]
  v_cvt_pk_bf16_f32 v73, v102, v103
  v_add_f32 v169, v65, v43
  v_mfma_f32_16x16x32_bf16 v[162:165], a[128:131], v[200:203], v[162:165]
  buffer_load_dwordx4 v64, s[12:15], s5 offen offset:0 lds
  v_mfma_f32_16x16x32_bf16 v[162:165], a[140:143], v[204:207], v[162:165]
  s_add_u32 m0, s46, 114560
  v_cvt_pk_bf16_f32 v140, v108, v109
  v_cvt_pk_bf16_f32 v141, v110, v111
  v_mfma_f32_16x16x32_bf16 v[144:147], a[128:131], v[224:227], v[144:147]
  buffer_load_dwordx4 v64, s[12:15], s5 offen offset:128 lds
  v_mfma_f32_16x16x32_bf16 v[144:147], a[140:143], v[228:231], v[144:147]
  s_add_u32 m0, s46, 122624
  v_cvt_pk_bf16_f32 v150, v152, v153
  v_cvt_pk_bf16_f32 v151, v154, v155
  v_mfma_f32_16x16x32_bf16 v[176:179], a[128:131], v[248:251], v[176:179]
  buffer_load_dwordx4 v64, s[12:15], s5 offen offset:256 lds
  v_mfma_f32_16x16x32_bf16 v[176:179], a[140:143], v[252:255], v[176:179]
  v_cvt_pk_bf16_f32 v174, v162, v163
  v_cvt_pk_bf16_f32 v175, v164, v165
  v_mfma_f32_16x16x32_bf16 v[132:135], a[128:131], a[232:235], v[132:135]
  v_cvt_pk_bf16_f32 v74, v144, v145
  v_cvt_pk_bf16_f32 v75, v146, v147
  v_mfma_f32_16x16x32_bf16 v[132:135], a[140:143], a[236:239], v[132:135]
  v_cvt_pk_bf16_f32 v162, v104, v105
  v_cvt_pk_bf16_f32 v163, v106, v107
  v_mfma_f32_16x16x32_bf16 v[100:103], v[172:175], v[124:127], v[128:131]
  v_cvt_pk_bf16_f32 v142, v176, v177
  v_cvt_pk_bf16_f32 v143, v178, v179
  v_mfma_f32_16x16x32_bf16 v[100:103], v[170:173], v[12:15], v[100:103]
  v_mul_f32 v96, s42, v96
  v_mul_f32 v97, s42, v97
  v_mfma_f32_16x16x32_bf16 v[104:107], v[72:75], v[124:127], v[180:183]
  v_cvt_pk_bf16_f32 v152, v132, v133
  v_cvt_pk_bf16_f32 v153, v134, v135
  v_mfma_f32_16x16x32_bf16 v[104:107], v[70:73], v[12:15], v[104:107]
  v_mul_f32 v98, s42, v98
  v_mul_f32 v99, s42, v99
  v_mfma_f32_16x16x32_bf16 v[64:67], v[140:143], v[124:127], v[156:159]
  v_cvt_pk_bf16_f32 v134, v96, v97
  v_cvt_pk_bf16_f32 v135, v98, v99
  v_mfma_f32_16x16x32_bf16 v[64:67], v[138:141], v[12:15], v[64:67]
  v_mul_f32 v112, s42, v112
  v_mul_f32 v113, s42, v113
  v_mfma_f32_16x16x32_bf16 v[176:179], v[150:153], v[124:127], v[92:95]
  v_mul_f32 v114, s42, v114
  v_mul_f32 v115, s42, v115
  v_mfma_f32_16x16x32_bf16 v[176:179], v[148:151], v[12:15], v[176:179]
  v_cvt_pk_bf16_f32 v136, v112, v113
  v_cvt_pk_bf16_f32 v137, v114, v115
  v_mfma_f32_16x16x32_bf16 v[108:111], v[170:173], v[120:123], v[166:169]
  v_mul_f32 v116, s42, v116
  v_mul_f32 v117, s42, v117
  v_mfma_f32_16x16x32_bf16 v[108:111], v[172:175], v[14:17], v[108:111]
  v_mul_f32 v118, s42, v118
  v_mul_f32 v119, s42, v119
  v_mfma_f32_16x16x32_bf16 v[112:115], v[70:73], v[120:123], v[128:131]
  v_cvt_pk_bf16_f32 v22, v116, v117
  v_cvt_pk_bf16_f32 v23, v118, v119
  v_mfma_f32_16x16x32_bf16 v[112:115], v[72:75], v[14:17], v[112:115]
  v_exp_f32 v100, v100
  v_mfma_f32_16x16x32_bf16 v[124:127], v[138:141], v[120:123], v[84:87]
  v_exp_f32 v101, v101
  v_mfma_f32_16x16x32_bf16 v[124:127], v[140:143], v[14:17], v[124:127]
  v_exp_f32 v102, v102
  v_mfma_f32_16x16x32_bf16 v[116:119], v[148:151], v[120:123], v[156:159]
  v_exp_f32 v103, v103
  v_mfma_f32_16x16x32_bf16 v[116:119], v[150:153], v[14:17], v[116:119]
  v_exp_f32 v104, v104
  v_mfma_f32_16x16x32_bf16 v[92:95], v[140:143], v[160:163], v[128:131]
  v_exp_f32 v105, v105
  v_mfma_f32_16x16x32_bf16 v[92:95], v[138:141], v[18:21], v[92:95]
  buffer_load_dword v132, v63, s[16:19], s51 offen
  v_mfma_f32_16x16x32_bf16 v[96:99], v[150:153], v[160:163], v[180:183]
  s_add_u32 m0, s28, 0
  v_exp_f32 v106, v106
  v_mfma_f32_16x16x32_bf16 v[96:99], v[148:151], v[18:21], v[96:99]
  v_exp_f32 v107, v107
  v_mfma_f32_16x16x32_bf16 v[180:183], v[172:175], v[160:163], v[80:83]
  s_waitcnt vmcnt(7)
  s_barrier
  v_mfma_f32_16x16x32_bf16 v[180:183], v[170:173], v[18:21], v[180:183]
  buffer_load_dwordx4 v6, s[8:11], s31 offen offset:0 nt lds
  v_mfma_f32_16x16x32_bf16 v[144:147], v[72:75], v[160:163], v[88:91]
  s_add_u32 m0, s28, 8064
  ds_read_b64_tr_b16 a[144:145], v60 offset:24576
  ds_read_b64_tr_b16 a[146:147], v60 offset:25088
  v_mfma_f32_16x16x32_bf16 v[144:147], v[70:73], v[18:21], v[144:147]
  ds_read_b64_tr_b16 a[156:157], v60 offset:28672
  ds_read_b64_tr_b16 a[158:159], v60 offset:29184
  v_mfma_f32_16x16x32_bf16 v[84:87], v[138:141], v[134:137], v[166:169]
  buffer_load_dwordx4 v6, s[8:11], s31 offen offset:128 nt lds
  v_mfma_f32_16x16x32_bf16 v[84:87], v[140:143], v[20:23], v[84:87]
  s_add_u32 m0, s28, 16128
  ds_read_b64_tr_b16 a[148:149], v58 offset:24576
  ds_read_b64_tr_b16 a[150:151], v58 offset:25088
  v_mfma_f32_16x16x32_bf16 v[88:91], v[148:151], v[134:137], v[128:131]
  ds_read_b64_tr_b16 a[160:161], v58 offset:28672
  ds_read_b64_tr_b16 a[162:163], v58 offset:29184
  v_mfma_f32_16x16x32_bf16 v[88:91], v[150:153], v[20:23], v[88:91]
  buffer_load_dwordx4 v6, s[8:11], s31 offen offset:256 nt lds
  v_mfma_f32_16x16x32_bf16 v[164:167], v[170:173], v[134:137], v[76:79]
  s_add_u32 s31, s31, s43
  ds_read_b64_tr_b16 a[152:153], v62 offset:24576
  ds_read_b64_tr_b16 a[154:155], v62 offset:25088
  v_mfma_f32_16x16x32_bf16 v[164:167], v[172:175], v[20:23], v[164:167]
  ds_read_b64_tr_b16 a[164:165], v62 offset:28672
  ds_read_b64_tr_b16 a[166:167], v62 offset:29184
  v_mfma_f32_16x16x32_bf16 v[140:143], v[70:73], v[134:137], v[80:83]
  ds_read_b64_tr_b16 a[168:169], v60 offset:49152
  ds_read_b64_tr_b16 a[170:171], v60 offset:49664
  v_mfma_f32_16x16x32_bf16 v[140:143], v[72:75], v[20:23], v[140:143]
  s_waitcnt lgkmcnt(6)
  ds_read_b64_tr_b16 a[180:181], v60 offset:53248
  ds_read_b64_tr_b16 a[182:183], v60 offset:53760
  v_mfma_f32_16x16x32_bf16 v[120:123], v[184:187], a[144:147], 0
  ds_read_b64_tr_b16 a[172:173], v58 offset:49152
  ds_read_b64_tr_b16 a[174:175], v58 offset:49664
  v_mfma_f32_16x16x32_bf16 v[120:123], v[188:191], a[156:159], v[120:123]
  ds_read_b64_tr_b16 a[184:185], v58 offset:53248
  ds_read_b64_tr_b16 a[186:187], v58 offset:53760
  v_mfma_f32_16x16x32_bf16 v[76:79], v[184:187], a[148:151], 0
  ds_read_b64_tr_b16 a[176:177], v62 offset:49152
  ds_read_b64_tr_b16 a[178:179], v62 offset:49664
  v_mfma_f32_16x16x32_bf16 v[76:79], v[188:191], a[160:163], v[76:79]
  s_waitcnt lgkmcnt(8)
  ds_read_b64_tr_b16 a[188:189], v62 offset:53248
  ds_read_b64_tr_b16 a[190:191], v62 offset:53760
  v_mfma_f32_16x16x32_bf16 v[148:151], v[184:187], a[152:155], 0
  v_exp_f32 v64, v64
  v_mfma_f32_16x16x32_bf16 v[148:151], v[188:191], a[164:167], v[148:151]
  v_exp_f32 v65, v65
  v_mfma_f32_16x16x32_bf16 v[128:131], v[208:211], a[144:147], 0
  v_exp_f32 v66, v66
  v_mfma_f32_16x16x32_bf16 v[128:131], v[212:215], a[156:159], v[128:131]
  v_exp_f32 v67, v67
  v_mfma_f32_16x16x32_bf16 v[136:139], v[208:211], a[148:151], 0
  v_exp_f32 v176, v176
  v_mfma_f32_16x16x32_bf16 v[136:139], v[212:215], a[160:163], v[136:139]
  v_exp_f32 v177, v177
  v_mfma_f32_16x16x32_bf16 v[72:75], v[208:211], a[152:155], 0
  v_exp_f32 v178, v178
  v_mfma_f32_16x16x32_bf16 v[72:75], v[212:215], a[164:167], v[72:75]
  v_exp_f32 v179, v179
  v_mfma_f32_16x16x32_bf16 v[120:123], v[192:195], a[168:171], v[120:123]
  s_waitcnt lgkmcnt(0)
  v_cvt_pk_bf16_f32 v100, v100, v101
  v_cvt_pk_bf16_f32 v101, v102, v103
  v_mfma_f32_16x16x32_bf16 v[120:123], v[196:199], a[180:183], v[120:123]
  v_cvt_pk_bf16_f32 v102, v104, v105
  v_cvt_pk_bf16_f32 v103, v106, v107
  v_mfma_f32_16x16x32_bf16 v[76:79], v[192:195], a[172:175], v[76:79]
  v_cvt_pk_bf16_f32 v104, v64, v65
  v_cvt_pk_bf16_f32 v105, v66, v67
  v_mfma_f32_16x16x32_bf16 v[76:79], v[196:199], a[184:187], v[76:79]
  v_cvt_pk_bf16_f32 v106, v176, v177
  v_cvt_pk_bf16_f32 v107, v178, v179
  v_mfma_f32_16x16x32_bf16 v[148:151], v[192:195], a[176:179], v[148:151]
  v_exp_f32 v108, v108
  v_mfma_f32_16x16x32_bf16 v[148:151], v[196:199], a[188:191], v[148:151]
  s_waitcnt vmcnt(4)
  s_barrier
  v_mfma_f32_16x16x32_bf16 v[128:131], v[216:219], a[168:171], v[128:131]
  ds_read_b64_tr_b16 a[192:193], v61 offset:0
  ds_read_b64_tr_b16 a[194:195], v61 offset:512
  v_mfma_f32_16x16x32_bf16 v[128:131], v[220:223], a[180:183], v[128:131]
  ds_read_b64_tr_b16 a[204:205], v61 offset:4096
  ds_read_b64_tr_b16 a[206:207], v61 offset:4608
  v_mfma_f32_16x16x32_bf16 v[136:139], v[216:219], a[172:175], v[136:139]
  ds_read_b64_tr_b16 a[196:197], v59 offset:0
  ds_read_b64_tr_b16 a[198:199], v59 offset:512
  v_mfma_f32_16x16x32_bf16 v[136:139], v[220:223], a[184:187], v[136:139]
  s_waitcnt lgkmcnt(4)
  ds_read_b64_tr_b16 a[208:209], v59 offset:4096
  ds_read_b64_tr_b16 a[210:211], v59 offset:4608
  v_mfma_f32_16x16x32_bf16 v[72:75], v[216:219], a[176:179], v[72:75]
  s_add_u32 s5, s45, 0
  ds_read_b64_tr_b16 a[200:201], v57 offset:0
  ds_read_b64_tr_b16 a[202:203], v57 offset:512
  v_mfma_f32_16x16x32_bf16 v[72:75], v[220:223], a[188:191], v[72:75]
  s_add_u32 m0, s46, 126976
  ds_read_b64_tr_b16 a[212:213], v57 offset:4096
  ds_read_b64_tr_b16 a[214:215], v57 offset:4608
  v_mfma_f32_16x16x32_bf16 v[120:123], v[200:203], a[192:195], v[120:123]
  s_waitcnt lgkmcnt(8)
  v_exp_f32 v109, v109
  v_mfma_f32_16x16x32_bf16 v[120:123], v[204:207], a[204:207], v[120:123]
  buffer_load_dwordx4 v56, s[16:19], s5 offen offset:0 lds
  s_waitcnt lgkmcnt(6)
  v_mfma_f32_16x16x32_bf16 v[76:79], v[200:203], a[196:199], v[76:79]
  s_add_u32 m0, s46, 135040
  v_exp_f32 v110, v110
  s_waitcnt lgkmcnt(4)
  v_mfma_f32_16x16x32_bf16 v[76:79], v[204:207], a[208:211], v[76:79]
  s_waitcnt lgkmcnt(2)
  v_exp_f32 v111, v111
  v_mfma_f32_16x16x32_bf16 v[148:151], v[200:203], a[200:203], v[148:151]
  buffer_load_dwordx4 v56, s[16:19], s5 offen offset:128 lds
  s_waitcnt lgkmcnt(0)
  v_mfma_f32_16x16x32_bf16 v[148:151], v[204:207], a[212:215], v[148:151]
  s_add_u32 m0, s46, 143104
  v_cvt_pk_bf16_f32 v160, v120, v121
  v_cvt_pk_bf16_f32 v161, v122, v123
  v_mfma_f32_16x16x32_bf16 v[128:131], v[224:227], a[192:195], v[128:131]
  v_cvt_pk_bf16_f32 v80, v76, v77
  v_cvt_pk_bf16_f32 v81, v78, v79
  v_mfma_f32_16x16x32_bf16 v[128:131], v[228:231], a[204:207], v[128:131]
  buffer_load_dwordx4 v56, s[16:19], s5 offen offset:256 lds
  v_mfma_f32_16x16x32_bf16 v[136:139], v[224:227], a[196:199], v[136:139]
  s_add_u32 s5, s45, 12288
  v_cvt_pk_bf16_f32 v120, v148, v149
  v_cvt_pk_bf16_f32 v121, v150, v151
  v_mfma_f32_16x16x32_bf16 v[136:139], v[228:231], a[208:211], v[136:139]
  s_add_u32 m0, s46, 131072
  v_exp_f32 v112, v112
  v_mfma_f32_16x16x32_bf16 v[72:75], v[224:227], a[200:203], v[72:75]
  buffer_load_dwordx4 v56, s[16:19], s5 offen offset:0 lds
  v_mfma_f32_16x16x32_bf16 v[72:75], v[228:231], a[212:215], v[72:75]
  s_add_u32 m0, s46, 139136
  v_cvt_pk_bf16_f32 v162, v128, v129
  v_cvt_pk_bf16_f32 v163, v130, v131
  v_mfma_f32_16x16x32_bf16 v[60:63], v[232:235], a[144:147], 0
  v_cvt_pk_bf16_f32 v82, v136, v137
  v_cvt_pk_bf16_f32 v83, v138, v139
  v_mfma_f32_16x16x32_bf16 v[60:63], v[236:239], a[156:159], v[60:63]
  buffer_load_dwordx4 v56, s[16:19], s5 offen offset:128 lds
  v_mfma_f32_16x16x32_bf16 v[60:63], v[240:243], a[168:171], v[60:63]
  s_add_u32 m0, s46, 147200
  v_cvt_pk_bf16_f32 v122, v72, v73
  v_cvt_pk_bf16_f32 v123, v74, v75
  v_mfma_f32_16x16x32_bf16 v[60:63], v[244:247], a[180:183], v[60:63]
  v_exp_f32 v113, v113
  v_mfma_f32_16x16x32_bf16 v[60:63], v[248:251], a[192:195], v[60:63]
  buffer_load_dwordx4 v56, s[16:19], s5 offen offset:256 lds
  v_mfma_f32_16x16x32_bf16 v[60:63], v[252:255], a[204:207], v[60:63]
  v_exp_f32 v114, v114
  v_mfma_f32_16x16x32_bf16 v[72:75], v[232:235], a[148:151], 0
  v_exp_f32 v115, v115
  v_mfma_f32_16x16x32_bf16 v[72:75], v[236:239], a[160:163], v[72:75]
  v_exp_f32 v124, v124
  v_mfma_f32_16x16x32_bf16 v[72:75], v[240:243], a[172:175], v[72:75]
  v_cvt_pk_bf16_f32 v70, v60, v61
  v_cvt_pk_bf16_f32 v71, v62, v63
  v_mfma_f32_16x16x32_bf16 v[72:75], v[244:247], a[184:187], v[72:75]
  v_exp_f32 v125, v125
  v_mfma_f32_16x16x32_bf16 v[72:75], v[248:251], a[196:199], v[72:75]
  v_exp_f32 v126, v126
  v_mfma_f32_16x16x32_bf16 v[72:75], v[252:255], a[208:211], v[72:75]
  v_exp_f32 v127, v127
  v_mfma_f32_16x16x32_bf16 v[60:63], v[232:235], a[152:155], 0
L_hop_1_0:
  s_cbranch_execz L_hop_1_1
  v_exp_f32 v116, v116
  v_mfma_f32_16x16x32_bf16 v[60:63], v[236:239], a[164:167], v[60:63]
  v_exp_f32 v117, v117
  v_mfma_f32_16x16x32_bf16 v[60:63], v[240:243], a[176:179], v[60:63]
  v_cvt_pk_bf16_f32 v76, v72, v73
  v_cvt_pk_bf16_f32 v77, v74, v75
  v_cvt_pk_bf16_f32 v108, v108, v109
  v_mfma_f32_16x16x32_bf16 v[60:63], v[244:247], a[188:191], v[60:63]
  v_exp_f32 v118, v118
  v_cvt_pk_bf16_f32 v109, v110, v111
  v_mfma_f32_16x16x32_bf16 v[60:63], v[248:251], a[200:203], v[60:63]
  v_exp_f32 v119, v119
  v_cvt_pk_bf16_f32 v110, v112, v113
  v_mfma_f32_16x16x32_bf16 v[60:63], v[252:255], a[212:215], v[60:63]
  v_cvt_pk_bf16_f32 v111, v114, v115
  v_cvt_pk_bf16_f32 v112, v124, v125
  v_cvt_pk_bf16_f32 v113, v126, v127
  v_mfma_f32_16x16x32_bf16 v[128:131], a[216:219], a[144:147], 0
  v_cvt_pk_bf16_f32 v114, v116, v117
  v_cvt_pk_bf16_f32 v115, v118, v119
  v_add_u32 v0, s28, v2
  v_mfma_f32_16x16x32_bf16 v[128:131], a[220:223], a[156:159], v[128:131]
  s_add_u32 s5, s45, 24576
  s_add_u32 m0, s46, 0
  v_exp_f32 v92, v92
  v_mfma_f32_16x16x32_bf16 v[128:131], a[224:227], a[168:171], v[128:131]
  v_cvt_pk_bf16_f32 v172, v60, v61
  v_cvt_pk_bf16_f32 v173, v62, v63
  v_xor_b32 v1, 64, v0
  v_mfma_f32_16x16x32_bf16 v[128:131], a[228:231], a[180:183], v[128:131]
  v_exp_f32 v93, v93
  v_mfma_f32_16x16x32_bf16 v[128:131], a[232:235], a[192:195], v[128:131]
  buffer_load_dwordx4 v56, s[16:19], s5 offen offset:0 lds
  v_cvt_pk_bf16_f32 v92, v92, v93
  v_mfma_f32_16x16x32_bf16 v[128:131], a[236:239], a[204:207], v[128:131]
  s_add_u32 m0, s46, 8064
  v_exp_f32 v94, v94
  v_mfma_f32_16x16x32_bf16 v[124:127], a[216:219], a[148:151], 0
  v_exp_f32 v95, v95
  v_mfma_f32_16x16x32_bf16 v[124:127], a[220:223], a[160:163], v[124:127]
  buffer_load_dwordx4 v56, s[16:19], s5 offen offset:128 lds
  v_cvt_pk_bf16_f32 v93, v94, v95
  v_mfma_f32_16x16x32_bf16 v[124:127], a[224:227], a[172:175], v[124:127]
  s_add_u32 m0, s46, 16128
  v_cvt_pk_bf16_f32 v72, v128, v129
  v_cvt_pk_bf16_f32 v73, v130, v131
  v_mfma_f32_16x16x32_bf16 v[124:127], a[228:231], a[184:187], v[124:127]
  v_exp_f32 v96, v96
  v_mfma_f32_16x16x32_bf16 v[124:127], a[232:235], a[196:199], v[124:127]
  buffer_load_dwordx4 v56, s[16:19], s5 offen offset:256 lds
  v_mov_b64 v[156:157], 0
  v_mfma_f32_16x16x32_bf16 v[124:127], a[236:239], a[208:211], v[124:127]
  s_add_u32 s5, s45, 36864
  s_add_u32 m0, s46, 4096
  v_exp_f32 v97, v97
  v_mfma_f32_16x16x32_bf16 v[128:131], a[216:219], a[152:155], 0
  v_exp_f32 v98, v98
  v_cvt_pk_bf16_f32 v94, v96, v97
  v_mfma_f32_16x16x32_bf16 v[128:131], a[220:223], a[164:167], v[128:131]
  buffer_load_dwordx4 v56, s[16:19], s5 offen offset:0 lds
  v_mfma_f32_16x16x32_bf16 v[128:131], a[224:227], a[176:179], v[128:131]
  s_add_u32 m0, s46, 12160
  v_cvt_pk_bf16_f32 v78, v124, v125
  v_cvt_pk_bf16_f32 v79, v126, v127
  v_mfma_f32_16x16x32_bf16 v[128:131], a[228:231], a[188:191], v[128:131]
  v_exp_f32 v99, v99
  v_mfma_f32_16x16x32_bf16 v[128:131], a[232:235], a[200:203], v[128:131]
  buffer_load_dwordx4 v56, s[16:19], s5 offen offset:128 lds
  v_cvt_pk_bf16_f32 v95, v98, v99
  v_mfma_f32_16x16x32_bf16 v[128:131], a[236:239], a[212:215], v[128:131]
  s_add_u32 m0, s46, 20224
  v_mov_b64 v[136:137], 0
  v_exp_f32 v180, v180
  v_smfmac_f32_16x16x64_bf16 v[156:159], a[240:243], v[100:107], v10
  v_exp_f32 v181, v181
  v_mfma_f32_16x16x32_bf16 v[176:179], v[70:73], v[104:107], 0
  buffer_load_dwordx4 v56, s[16:19], s5 offen offset:256 lds
  v_cvt_pk_bf16_f32 v96, v180, v181
  v_mfma_f32_16x16x32_bf16 v[176:179], v[160:163], v[100:103], v[176:179]
  v_cvt_pk_bf16_f32 v174, v128, v129
  v_cvt_pk_bf16_f32 v175, v130, v131
  v_mfma_f32_16x16x32_bf16 v[124:127], v[80:83], v[100:103], 0
  v_exp_f32 v182, v182
  v_mfma_f32_16x16x32_bf16 v[124:127], v[76:79], v[104:107], v[124:127]
  v_exp_f32 v183, v183
  v_mfma_f32_16x16x32_bf16 v[128:131], v[172:175], v[104:107], 0
  v_exp_f32 v144, v144
  v_cvt_pk_bf16_f32 v97, v182, v183
  v_mfma_f32_16x16x32_bf16 v[128:131], v[120:123], v[100:103], v[128:131]
  v_exp_f32 v145, v145
  v_mov_b64 v[148:149], 0
  v_smfmac_f32_16x16x64_bf16 v[136:139], a[240:243], v[108:115], v10
  v_exp_f32 v146, v146
  v_cvt_pk_bf16_f32 v98, v144, v145
  v_mfma_f32_16x16x32_bf16 v[180:183], v[70:73], v[112:115], 0
  v_exp_f32 v147, v147
  v_add_f32 v156, v156, v157
  v_mfma_f32_16x16x32_bf16 v[180:183], v[160:163], v[108:111], v[180:183]
  v_cvt_pk_bf16_f32 v99, v146, v147
  v_exp_f32 v84, v84
  v_mfma_f32_16x16x32_bf16 v[152:155], v[80:83], v[108:111], 0
  v_exp_f32 v85, v85
  v_mfma_f32_16x16x32_bf16 v[152:155], v[76:79], v[112:115], v[152:155]
  v_exp_f32 v86, v86
  v_cvt_pk_bf16_f32 v84, v84, v85
  v_mfma_f32_16x16x32_bf16 v[104:107], v[172:175], v[112:115], 0
  v_exp_f32 v87, v87
  v_add_f32 v136, v136, v137
  v_mfma_f32_16x16x32_bf16 v[104:107], v[120:123], v[108:111], v[104:107]
  v_exp_f32 v88, v88
  v_cvt_pk_bf16_f32 v85, v86, v87
  v_smfmac_f32_16x16x64_bf16 v[148:151], a[240:243], v[92:99], v10
  v_exp_f32 v89, v89
  v_exp_f32 v90, v90
  v_exp_f32 v91, v91
  v_exp_f32 v164, v164
  v_exp_f32 v165, v165
  v_exp_f32 v166, v166
  v_exp_f32 v167, v167
  v_exp_f32 v140, v140
  v_exp_f32 v141, v141
  v_exp_f32 v142, v142
  v_exp_f32 v143, v143
  v_mfma_f32_16x16x32_bf16 v[116:119], v[160:163], v[96:99], 0
  s_add_u32 s5, s45, 49152
  v_cvt_pk_bf16_f32 v86, v88, v89
  v_cvt_pk_bf16_f32 v87, v90, v91
  v_cvt_pk_bf16_f32 v88, v164, v165
  v_cvt_pk_bf16_f32 v89, v166, v167
  v_cvt_pk_bf16_f32 v90, v140, v141
  v_cvt_pk_bf16_f32 v91, v142, v143
  v_mfma_f32_16x16x32_bf16 v[116:119], v[70:73], v[92:95], v[116:119]
  s_waitcnt vmcnt(6) lgkmcnt(0)
  s_barrier
  v_mfma_f32_16x16x32_bf16 v[164:167], v[76:79], v[92:95], 0
  s_add_u32 m0, s46, 102400
  ds_read_b128 a[244:247], v0 offset:0
  v_mov_b64 v[100:101], 0
  v_mfma_f32_16x16x32_bf16 v[164:167], v[80:83], v[96:99], v[164:167]
  buffer_load_dwordx4 v56, s[16:19], s5 offen offset:0 lds
  v_mfma_f32_16x16x32_bf16 v[140:143], v[120:123], v[96:99], 0
  s_add_u32 m0, s46, 110464
  ds_read_b128 v[60:63], v1 offset:0
  ds_read_b128 v[64:67], v0 offset:8192
  v_mfma_f32_16x16x32_bf16 v[140:143], v[172:175], v[92:95], v[140:143]
  ds_read_b128 v[132:135], v1 offset:8192
  ds_read_b128 v[168:171], v0 offset:16384
  v_smfmac_f32_16x16x64_bf16 v[100:103], a[240:243], v[84:91], v10
  buffer_load_dwordx4 v56, s[16:19], s5 offen offset:128 lds
  v_mfma_f32_16x16x32_bf16 v[108:111], v[160:163], v[88:91], 0
  s_add_u32 m0, s46, 118528
  ds_read_b128 v[144:147], v1 offset:16384
  ds_read2st64_b32 v[92:93], v68 offset0:0 offset1:2
  v_mfma_f32_16x16x32_bf16 v[108:111], v[70:73], v[84:87], v[108:111]
  ds_read2st64_b32 v[96:97], v69 offset0:0 offset1:2
  ds_read2st64_b32 v[94:95], v68 offset0:4 offset1:6
  v_mfma_f32_16x16x32_bf16 v[112:115], v[76:79], v[84:87], 0
  buffer_load_dwordx4 v56, s[16:19], s5 offen offset:256 lds
  v_mfma_f32_16x16x32_bf16 v[112:115], v[80:83], v[88:91], v[112:115]
  s_add_u32 s5, s45, 61440
  s_add_u32 m0, s46, 106496
  ds_read2st64_b32 v[98:99], v69 offset0:4 offset1:6
  v_mfma_f32_16x16x32_bf16 v[80:83], v[120:123], v[88:91], 0
  s_waitcnt lgkmcnt(3)
  ds_read2st64_b32 v[160:161], v54 offset0:0 offset1:2
  ds_read2st64_b32 v[76:77], v55 offset0:0 offset1:2
  v_mfma_f32_16x16x32_bf16 v[80:83], v[172:175], v[84:87], v[80:83]
  buffer_load_dwordx4 v56, s[16:19], s5 offen offset:0 lds
  v_mfma_f32_16x16x32_bf16 v[88:91], a[0:3], a[244:247], 0
  s_add_u32 m0, s46, 114560
  ds_read2st64_b32 v[162:163], v54 offset0:4 offset1:6
  ds_read2st64_b32 v[78:79], v55 offset0:4 offset1:6
  v_mfma_f32_16x16x32_bf16 v[88:91], a[12:15], v[60:63], v[88:91]
  v_rcp_f32 v158, v156
  v_mfma_f32_16x16x32_bf16 v[88:91], a[24:27], v[64:67], v[88:91]
  buffer_load_dwordx4 v56, s[16:19], s5 offen offset:128 lds
  v_mfma_f32_16x16x32_bf16 v[88:91], a[36:39], v[132:135], v[88:91]
  s_add_u32 m0, s46, 122624
  v_mul_f32 v176, v158, v176
  v_mul_f32 v177, v158, v177
  v_mfma_f32_16x16x32_bf16 v[88:91], a[48:51], v[168:171], v[88:91]
  s_waitcnt lgkmcnt(4)
  v_perm_b32 v184, v96, v92, s58
  v_perm_b32 v188, v96, v92, s59
  v_mfma_f32_16x16x32_bf16 v[88:91], a[60:63], v[144:147], v[88:91]
  buffer_load_dwordx4 v56, s[16:19], s5 offen offset:256 lds
  v_mfma_f32_16x16x32_bf16 v[84:87], a[64:67], v[144:147], 0
  s_waitcnt lgkmcnt(0)
  v_perm_b32 v185, v97, v93, s58
  v_perm_b32 v189, v97, v93, s59
  v_mfma_f32_16x16x32_bf16 v[84:87], a[52:55], v[168:171], v[84:87]
  s_add_u32 m0, s28, 4096
  v_perm_b32 v186, v98, v94, s58
  v_perm_b32 v190, v98, v94, s59
  v_mfma_f32_16x16x32_bf16 v[84:87], a[40:43], v[132:135], v[84:87]
  s_mov_b32 s5, s28
  v_mul_f32 v88, s42, v88
  v_mul_f32 v89, s42, v89
  v_mfma_f32_16x16x32_bf16 v[84:87], a[28:31], v[64:67], v[84:87]
  v_mul_f32 v90, s42, v90
  v_mul_f32 v91, s42, v91
  v_mfma_f32_16x16x32_bf16 v[84:87], a[16:19], v[60:63], v[84:87]
  buffer_load_dwordx4 v6, s[8:11], s32 offen offset:0 nt lds
  v_mfma_f32_16x16x32_bf16 v[84:87], a[4:7], a[244:247], v[84:87]
  s_add_u32 m0, s28, 12160
  v_cvt_pk_bf16_f32 v12, v88, v89
  v_cvt_pk_bf16_f32 v13, v90, v91
  v_mfma_f32_16x16x32_bf16 v[56:59], a[8:11], a[244:247], 0
  v_perm_b32 v187, v99, v95, s58
  v_perm_b32 v191, v99, v95, s59
  v_perm_b32 v192, v76, v160, s58
  v_mfma_f32_16x16x32_bf16 v[56:59], a[20:23], v[60:63], v[56:59]
  buffer_load_dwordx4 v6, s[8:11], s32 offen offset:128 nt lds
  v_perm_b32 v196, v76, v160, s59
  v_mfma_f32_16x16x32_bf16 v[56:59], a[32:35], v[64:67], v[56:59]
  s_add_u32 m0, s28, 20224
  v_mul_f32 v84, s42, v84
  v_mul_f32 v85, s42, v85
  v_mul_f32 v86, s42, v86
  v_mfma_f32_16x16x32_bf16 v[56:59], a[44:47], v[132:135], v[56:59]
  s_mov_b32 s28, s29
  v_mul_f32 v87, s42, v87
  v_cvt_pk_bf16_f32 v72, v84, v85
  v_cvt_pk_bf16_f32 v73, v86, v87
  v_mfma_f32_16x16x32_bf16 v[56:59], a[56:59], v[168:171], v[56:59]
  buffer_load_dwordx4 v6, s[8:11], s32 offen offset:256 nt lds
  v_perm_b32 v193, v77, v161, s58
  v_mfma_f32_16x16x32_bf16 v[56:59], a[68:71], v[144:147], v[56:59]
  s_add_u32 s32, s32, s43
  v_perm_b32 v197, v77, v161, s59
  v_perm_b32 v194, v78, v162, s58
  v_perm_b32 v198, v78, v162, s59
  v_mfma_f32_16x16x32_bf16 v[84:87], a[132:135], v[144:147], 0
  ds_read2st64_b32 v[92:93], v68 offset0:16 offset1:18
  v_perm_b32 v195, v79, v163, s58
  v_perm_b32 v199, v79, v163, s59
  v_mfma_f32_16x16x32_bf16 v[84:87], a[120:123], v[168:171], v[84:87]
  ds_read2st64_b32 v[96:97], v69 offset0:16 offset1:18
  ds_read2st64_b32 v[94:95], v68 offset0:20 offset1:22
  v_mul_f32 v178, v158, v178
  v_mfma_f32_16x16x32_bf16 v[84:87], a[108:111], v[132:135], v[84:87]
  v_mul_f32 v56, s42, v56
  v_mul_f32 v57, s42, v57
  v_mul_f32 v58, s42, v58
  v_mfma_f32_16x16x32_bf16 v[84:87], a[96:99], v[64:67], v[84:87]
  v_mul_f32 v59, s42, v59
  v_cvt_pk_bf16_f32 v74, v56, v57
  v_cvt_pk_bf16_f32 v75, v58, v59
  v_mfma_f32_16x16x32_bf16 v[84:87], a[84:87], v[60:63], v[84:87]
  ds_read2st64_b32 v[98:99], v69 offset0:20 offset1:22
  ds_read2st64_b32 v[160:161], v54 offset0:16 offset1:18
  v_mul_f32 v179, v158, v179
  v_mfma_f32_16x16x32_bf16 v[84:87], a[72:75], a[244:247], v[84:87]
  ds_read2st64_b32 v[76:77], v55 offset0:16 offset1:18
  ds_read2st64_b32 v[162:163], v54 offset0:20 offset1:22
  v_cvt_pk_bf16_f32 v176, v176, v177
  v_mfma_f32_16x16x32_bf16 v[56:59], a[76:79], a[244:247], 0
  ds_read2st64_b32 v[78:79], v55 offset0:20 offset1:22
  v_cvt_pk_bf16_f32 v177, v178, v179
  v_mul_f32 v124, v158, v124
  v_mfma_f32_16x16x32_bf16 v[56:59], a[88:91], v[60:63], v[56:59]
  v_mul_f32 v125, v158, v125
  v_mul_f32 v126, v158, v126
  v_mul_f32 v127, v158, v127
  v_mfma_f32_16x16x32_bf16 v[56:59], a[100:103], v[64:67], v[56:59]
  v_cvt_pk_bf16_f32 v120, v84, v85
  v_cvt_pk_bf16_f32 v121, v86, v87
  v_cvt_pk_bf16_f32 v124, v124, v125
  v_mfma_f32_16x16x32_bf16 v[56:59], a[112:115], v[132:135], v[56:59]
  s_waitcnt lgkmcnt(4)
  v_cvt_pk_bf16_f32 v125, v126, v127
  v_mul_f32 v128, v158, v128
  v_mul_f32 v129, v158, v129
  v_mfma_f32_16x16x32_bf16 v[56:59], a[124:127], v[168:171], v[56:59]
  v_mul_f32 v130, v158, v130
  v_mul_f32 v131, v158, v131
  v_cvt_pk_bf16_f32 v128, v128, v129
  v_mfma_f32_16x16x32_bf16 v[56:59], a[136:139], v[144:147], v[56:59]
  s_waitcnt lgkmcnt(0)
  v_cvt_pk_bf16_f32 v129, v130, v131
  v_max3_f32 v9, v156, v158, v9
  v_perm_b32 v200, v96, v92, s58
  v_mfma_f32_16x16x32_bf16 v[88:91], a[140:143], v[144:147], 0
  ds_write2st64_b32 v5, v176, v177 offset0:0 offset1:4
  v_mfma_f32_16x16x32_bf16 v[88:91], a[128:131], v[168:171], v[88:91]
  ds_write2st64_b32 v5, v124, v125 offset0:8 offset1:12
  v_mfma_f32_16x16x32_bf16 v[88:91], a[116:119], v[132:135], v[88:91]
  v_cvt_pk_bf16_f32 v122, v56, v57
  v_cvt_pk_bf16_f32 v123, v58, v59
  v_perm_b32 v204, v96, v92, s59
  v_mfma_f32_16x16x32_bf16 v[88:91], a[104:107], v[64:67], v[88:91]
  ds_write2st64_b32 v5, v128, v129 offset0:16 offset1:20
  v_mfma_f32_16x16x32_bf16 v[88:91], a[92:95], v[60:63], v[88:91]
  v_perm_b32 v201, v97, v93, s58
  v_perm_b32 v205, v97, v93, s59
  v_perm_b32 v202, v98, v94, s58
  v_mfma_f32_16x16x32_bf16 v[88:91], a[80:83], a[244:247], v[88:91]
  v_perm_b32 v206, v98, v94, s59
  v_perm_b32 v203, v99, v95, s58
  v_perm_b32 v207, v99, v95, s59
  v_mfma_f32_16x16x32_bf16 v[176:179], a[244:247], a[144:147], 0
  v_perm_b32 v208, v76, v160, s58
  v_perm_b32 v212, v76, v160, s59
  v_perm_b32 v209, v77, v161, s58
  v_mfma_f32_16x16x32_bf16 v[176:179], v[60:63], a[156:159], v[176:179]
  v_perm_b32 v213, v77, v161, s59
  v_perm_b32 v210, v78, v162, s58
  v_perm_b32 v214, v78, v162, s59
  v_mfma_f32_16x16x32_bf16 v[176:179], v[64:67], a[168:171], v[176:179]
  ds_read_b128 v[84:87], v0 offset:2048
  v_cvt_pk_bf16_f32 v124, v88, v89
  v_cvt_pk_bf16_f32 v125, v90, v91
  v_mfma_f32_16x16x32_bf16 v[176:179], v[132:135], a[180:183], v[176:179]
  ds_read_b128 a[252:255], v1 offset:2048
  ds_read_b128 a[248:251], v0 offset:10240
  v_perm_b32 v211, v79, v163, s58
  v_mfma_f32_16x16x32_bf16 v[176:179], v[168:171], a[192:195], v[176:179]
  s_add_u32 m0, s29, 0
  ds_read_b128 v[88:91], v1 offset:10240
  ds_read_b128 v[126:129], v0 offset:18432
  v_perm_b32 v215, v79, v163, s59
  v_mfma_f32_16x16x32_bf16 v[176:179], v[144:147], a[204:207], v[176:179]
  ds_read_b128 v[172:175], v1 offset:18432
  v_add_u32 v68, 4294840320, v68
  v_add_u32 v69, 4294840320, v69
  v_mfma_f32_16x16x32_bf16 v[156:159], v[144:147], a[208:211], 0
  s_waitcnt vmcnt(3)
  s_barrier
  v_mfma_f32_16x16x32_bf16 v[156:159], v[168:171], a[196:199], v[156:159]
  buffer_load_dwordx4 v6, s[8:11], s31 offen offset:0 nt lds
  v_add_u32 v54, 4294840320, v54
  v_mfma_f32_16x16x32_bf16 v[156:159], v[132:135], a[184:187], v[156:159]
  s_add_u32 m0, s29, 8064
  v_cvt_pk_bf16_f32 v56, v176, v177
  v_cvt_pk_bf16_f32 v57, v178, v179
  v_add_u32 v55, 4294840320, v55
  v_mfma_f32_16x16x32_bf16 v[156:159], v[64:67], a[172:175], v[156:159]
  ds_read2st64_b32 v[92:93], v68 offset0:0 offset1:2
  ds_read2st64_b32 v[96:97], v69 offset0:0 offset1:2
  v_add_f32 v148, v148, v149
  v_mfma_f32_16x16x32_bf16 v[156:159], v[60:63], a[160:163], v[156:159]
  ds_read2st64_b32 v[94:95], v68 offset0:4 offset1:6
  ds_read2st64_b32 v[98:99], v69 offset0:4 offset1:6
  v_add_f32 v100, v100, v101
  v_mfma_f32_16x16x32_bf16 v[156:159], a[244:247], a[148:151], v[156:159]
  buffer_load_dwordx4 v6, s[8:11], s31 offen offset:128 nt lds
  v_mfma_f32_16x16x32_bf16 v[176:179], a[244:247], a[152:155], 0
  s_add_u32 m0, s29, 16128
  ds_read2st64_b32 v[160:161], v54 offset0:0 offset1:2
  ds_read2st64_b32 v[76:77], v55 offset0:0 offset1:2
  v_mfma_f32_16x16x32_bf16 v[176:179], v[60:63], a[164:167], v[176:179]
  ds_read2st64_b32 v[162:163], v54 offset0:4 offset1:6
  ds_read2st64_b32 v[78:79], v55 offset0:4 offset1:6
  v_mfma_f32_16x16x32_bf16 v[176:179], v[64:67], a[176:179], v[176:179]
  v_cvt_pk_bf16_f32 v60, v156, v157
  v_cvt_pk_bf16_f32 v61, v158, v159
  v_mfma_f32_16x16x32_bf16 v[176:179], v[132:135], a[188:191], v[176:179]
  buffer_load_dwordx4 v6, s[8:11], s31 offen offset:256 nt lds
  v_mfma_f32_16x16x32_bf16 v[176:179], v[168:171], a[200:203], v[176:179]
  s_add_u32 m0, s29, 4096
  v_rcp_f32 v138, v136
  v_mfma_f32_16x16x32_bf16 v[176:179], v[144:147], a[212:215], v[176:179]
  s_waitcnt lgkmcnt(4)
  v_perm_b32 v216, v96, v92, s58
  v_perm_b32 v220, v96, v92, s59
  v_perm_b32 v217, v97, v93, s58
  v_mfma_f32_16x16x32_bf16 v[144:147], a[0:3], v[84:87], 0
  s_waitcnt lgkmcnt(0)
  v_perm_b32 v221, v97, v93, s59
  v_perm_b32 v218, v98, v94, s58
  v_perm_b32 v222, v98, v94, s59
  v_mfma_f32_16x16x32_bf16 v[144:147], a[12:15], a[252:255], v[144:147]
  buffer_load_dwordx4 v6, s[8:11], s32 offen offset:0 nt lds
  v_perm_b32 v219, v99, v95, s58
  v_mfma_f32_16x16x32_bf16 v[144:147], a[24:27], a[248:251], v[144:147]
  s_add_u32 m0, s29, 12160
  v_cvt_pk_bf16_f32 v64, v176, v177
  v_cvt_pk_bf16_f32 v65, v178, v179
  v_perm_b32 v223, v99, v95, s59
  v_mfma_f32_16x16x32_bf16 v[144:147], a[36:39], v[88:91], v[144:147]
  s_add_u32 s31, s31, s43
  v_perm_b32 v224, v76, v160, s58
  v_perm_b32 v228, v76, v160, s59
  v_perm_b32 v225, v77, v161, s58
  v_mfma_f32_16x16x32_bf16 v[144:147], a[48:51], v[126:129], v[144:147]
  v_perm_b32 v229, v77, v161, s59
  v_perm_b32 v226, v78, v162, s58
  v_perm_b32 v230, v78, v162, s59
  v_mfma_f32_16x16x32_bf16 v[144:147], a[60:63], v[172:175], v[144:147]
  buffer_load_dwordx4 v6, s[8:11], s32 offen offset:128 nt lds
  v_perm_b32 v227, v79, v163, s58
  v_mfma_f32_16x16x32_bf16 v[168:171], a[64:67], v[172:175], 0
  s_add_u32 m0, s29, 20224
  ds_read2st64_b32 v[92:93], v68 offset0:16 offset1:18
  ds_read2st64_b32 v[96:97], v69 offset0:16 offset1:18
  v_perm_b32 v231, v79, v163, s59
  v_mfma_f32_16x16x32_bf16 v[168:171], a[52:55], v[126:129], v[168:171]
  s_mov_b32 s29, s30
  ds_read2st64_b32 v[94:95], v68 offset0:20 offset1:22
  ds_read2st64_b32 v[98:99], v69 offset0:20 offset1:22
  v_mul_f32 v180, v138, v180
  v_mfma_f32_16x16x32_bf16 v[168:171], a[40:43], v[88:91], v[168:171]
  v_mul_f32 v144, s42, v144
  v_mul_f32 v145, s42, v145
  v_mul_f32 v146, s42, v146
  v_mfma_f32_16x16x32_bf16 v[168:171], a[28:31], a[248:251], v[168:171]
  buffer_load_dwordx4 v6, s[8:11], s32 offen offset:256 nt lds
  v_mul_f32 v147, s42, v147
  v_mfma_f32_16x16x32_bf16 v[168:171], a[16:19], a[252:255], v[168:171]
  s_add_u32 s32, s32, s43
  ds_read2st64_b32 v[160:161], v54 offset0:16 offset1:18
  v_cvt_pk_bf16_f32 v156, v144, v145
  v_cvt_pk_bf16_f32 v157, v146, v147
  v_mfma_f32_16x16x32_bf16 v[168:171], a[4:7], v[84:87], v[168:171]
  ds_read2st64_b32 v[76:77], v55 offset0:16 offset1:18
  ds_read2st64_b32 v[162:163], v54 offset0:20 offset1:22
  v_mul_f32 v181, v138, v181
  v_mfma_f32_16x16x32_bf16 v[132:135], a[8:11], v[84:87], 0
  s_waitcnt lgkmcnt(3)
  ds_read2st64_b32 v[78:79], v55 offset0:20 offset1:22
  v_mul_f32 v182, v138, v182
  v_mul_f32 v183, v138, v183
  v_mfma_f32_16x16x32_bf16 v[132:135], a[20:23], a[252:255], v[132:135]
  v_cvt_pk_bf16_f32 v180, v180, v181
  v_cvt_pk_bf16_f32 v181, v182, v183
  v_mul_f32 v152, v138, v152
  v_mfma_f32_16x16x32_bf16 v[132:135], a[32:35], a[248:251], v[132:135]
  v_mul_f32 v168, s42, v168
  v_mul_f32 v169, s42, v169
  v_mul_f32 v170, s42, v170
  v_mfma_f32_16x16x32_bf16 v[132:135], a[44:47], v[88:91], v[132:135]
  v_mul_f32 v171, s42, v171
  v_cvt_pk_bf16_f32 v158, v168, v169
  v_cvt_pk_bf16_f32 v159, v170, v171
  v_mfma_f32_16x16x32_bf16 v[132:135], a[56:59], v[126:129], v[132:135]
  v_mul_f32 v153, v138, v153
  v_mul_f32 v154, v138, v154
  v_mul_f32 v155, v138, v155
  v_mfma_f32_16x16x32_bf16 v[132:135], a[68:71], v[172:175], v[132:135]
  s_waitcnt lgkmcnt(0)
  v_cvt_pk_bf16_f32 v152, v152, v153
  v_cvt_pk_bf16_f32 v153, v154, v155
  v_mul_f32 v104, v138, v104
  v_mfma_f32_16x16x32_bf16 v[168:171], a[132:135], v[172:175], 0
  v_mul_f32 v105, v138, v105
  v_mul_f32 v106, v138, v106
  v_mul_f32 v107, v138, v107
  v_mfma_f32_16x16x32_bf16 v[168:171], a[120:123], v[126:129], v[168:171]
  v_cvt_pk_bf16_f32 v104, v104, v105
  v_cvt_pk_bf16_f32 v105, v106, v107
  v_max3_f32 v9, v136, v138, v9
  v_mfma_f32_16x16x32_bf16 v[168:171], a[108:111], v[88:91], v[168:171]
  v_mul_f32 v132, s42, v132
  v_mul_f32 v133, s42, v133
  v_mul_f32 v134, s42, v134
  v_mfma_f32_16x16x32_bf16 v[168:171], a[96:99], a[248:251], v[168:171]
  v_mul_f32 v135, s42, v135
  v_cvt_pk_bf16_f32 v16, v132, v133
  v_cvt_pk_bf16_f32 v17, v134, v135
  v_mfma_f32_16x16x32_bf16 v[168:171], a[84:87], a[252:255], v[168:171]
  ds_write2st64_b32 v5, v180, v181 offset0:1 offset1:5
  v_mfma_f32_16x16x32_bf16 v[168:171], a[72:75], v[84:87], v[168:171]
  ds_write2st64_b32 v5, v152, v153 offset0:9 offset1:13
  v_mfma_f32_16x16x32_bf16 v[132:135], a[76:79], v[84:87], 0
  ds_write2st64_b32 v5, v104, v105 offset0:17 offset1:21
  v_mfma_f32_16x16x32_bf16 v[132:135], a[88:91], a[252:255], v[132:135]
  v_rcp_f32 v150, v148
  v_perm_b32 v232, v96, v92, s58
  v_mfma_f32_16x16x32_bf16 v[132:135], a[100:103], a[248:251], v[132:135]
  v_cvt_pk_bf16_f32 v144, v168, v169
  v_cvt_pk_bf16_f32 v145, v170, v171
  v_mul_f32 v116, v150, v116
  v_mfma_f32_16x16x32_bf16 v[132:135], a[112:115], v[88:91], v[132:135]
  v_mul_f32 v117, v150, v117
  v_mul_f32 v118, v150, v118
  v_mul_f32 v119, v150, v119
  v_mfma_f32_16x16x32_bf16 v[132:135], a[124:127], v[126:129], v[132:135]
  v_cvt_pk_bf16_f32 v116, v116, v117
  v_cvt_pk_bf16_f32 v117, v118, v119
  v_mul_f32 v164, v150, v164
  v_mfma_f32_16x16x32_bf16 v[132:135], a[136:139], v[172:175], v[132:135]
  v_mul_f32 v165, v150, v165
  v_mul_f32 v166, v150, v166
  v_mul_f32 v167, v150, v167
  v_mfma_f32_16x16x32_bf16 v[152:155], a[140:143], v[172:175], 0
  v_cvt_pk_bf16_f32 v164, v164, v165
  v_cvt_pk_bf16_f32 v165, v166, v167
  v_mul_f32 v140, v150, v140
  v_mfma_f32_16x16x32_bf16 v[152:155], a[128:131], v[126:129], v[152:155]
  v_mul_f32 v141, v150, v141
  v_mul_f32 v142, v150, v142
  v_mul_f32 v143, v150, v143
  v_mfma_f32_16x16x32_bf16 v[152:155], a[116:119], v[88:91], v[152:155]
  v_cvt_pk_bf16_f32 v146, v132, v133
  v_cvt_pk_bf16_f32 v147, v134, v135
  v_cvt_pk_bf16_f32 v140, v140, v141
  v_mfma_f32_16x16x32_bf16 v[152:155], a[104:107], a[248:251], v[152:155]
  v_cvt_pk_bf16_f32 v141, v142, v143
  v_max3_f32 v9, v148, v150, v9
  v_perm_b32 v236, v96, v92, s59
  v_mfma_f32_16x16x32_bf16 v[152:155], a[92:95], a[252:255], v[152:155]
  ds_write2st64_b32 v5, v116, v117 offset0:2 offset1:6
  v_mfma_f32_16x16x32_bf16 v[152:155], a[80:83], v[84:87], v[152:155]
  ds_write2st64_b32 v5, v164, v165 offset0:10 offset1:14
  v_mfma_f32_16x16x32_bf16 v[168:171], v[84:87], a[144:147], 0
  ds_write2st64_b32 v5, v140, v141 offset0:18 offset1:22
  v_mfma_f32_16x16x32_bf16 v[168:171], a[252:255], a[156:159], v[168:171]
  v_rcp_f32 v102, v100
  v_perm_b32 v233, v97, v93, s58
  v_mfma_f32_16x16x32_bf16 v[168:171], a[248:251], a[168:171], v[168:171]
  v_cvt_pk_bf16_f32 v148, v152, v153
  v_cvt_pk_bf16_f32 v149, v154, v155
  v_mfma_f32_16x16x32_bf16 v[168:171], v[88:91], a[180:183], v[168:171]
  v_mul_f32 v108, v102, v108
  v_mul_f32 v109, v102, v109
  v_mfma_f32_16x16x32_bf16 v[168:171], v[126:129], a[192:195], v[168:171]
  s_waitcnt vmcnt(6) lgkmcnt(0)
  s_barrier
  v_mfma_f32_16x16x32_bf16 v[168:171], v[172:175], a[204:207], v[168:171]
  ds_read_b128 v[140:143], v0 offset:4096
  ds_read_b128 v[176:179], v1 offset:4096
  v_mfma_f32_16x16x32_bf16 v[132:135], v[172:175], a[208:211], 0
  ds_read_b128 v[116:119], v0 offset:12288
  ds_read_b128 v[164:167], v1 offset:12288
  v_mfma_f32_16x16x32_bf16 v[132:135], v[126:129], a[196:199], v[132:135]
  ds_read_b128 v[180:183], v0 offset:20480
  ds_read_b128 v[104:107], v1 offset:20480
  v_mfma_f32_16x16x32_bf16 v[132:135], v[88:91], a[184:187], v[132:135]
  v_cvt_pk_bf16_f32 v58, v168, v169
  v_cvt_pk_bf16_f32 v59, v170, v171
  v_mfma_f32_16x16x32_bf16 v[132:135], a[248:251], a[172:175], v[132:135]
  v_mul_f32 v110, v102, v110
  v_mul_f32 v111, v102, v111
  v_mfma_f32_16x16x32_bf16 v[132:135], a[252:255], a[160:163], v[132:135]
  v_cvt_pk_bf16_f32 v108, v108, v109
  v_cvt_pk_bf16_f32 v109, v110, v111
  v_mfma_f32_16x16x32_bf16 v[132:135], v[84:87], a[148:151], v[132:135]
  v_mul_f32 v112, v102, v112
  v_mul_f32 v113, v102, v113
  v_mfma_f32_16x16x32_bf16 v[136:139], v[84:87], a[152:155], 0
  v_mul_f32 v114, v102, v114
  v_mul_f32 v115, v102, v115
  v_mfma_f32_16x16x32_bf16 v[136:139], a[252:255], a[164:167], v[136:139]
  v_cvt_pk_bf16_f32 v112, v112, v113
  v_cvt_pk_bf16_f32 v113, v114, v115
  v_mfma_f32_16x16x32_bf16 v[136:139], a[248:251], a[176:179], v[136:139]
  v_cvt_pk_bf16_f32 v62, v132, v133
  v_cvt_pk_bf16_f32 v63, v134, v135
  v_mfma_f32_16x16x32_bf16 v[136:139], v[88:91], a[188:191], v[136:139]
  v_mul_f32 v80, v102, v80
  v_mul_f32 v81, v102, v81
  v_mfma_f32_16x16x32_bf16 v[136:139], v[126:129], a[200:203], v[136:139]
  v_mul_f32 v82, v102, v82
  v_mul_f32 v83, v102, v83
  v_mfma_f32_16x16x32_bf16 v[136:139], v[172:175], a[212:215], v[136:139]
  s_waitcnt lgkmcnt(0)
  v_cvt_pk_bf16_f32 v80, v80, v81
  v_cvt_pk_bf16_f32 v81, v82, v83
  v_mfma_f32_16x16x32_bf16 v[88:91], a[0:3], v[140:143], 0
  v_max3_f32 v9, v100, v102, v9
  v_perm_b32 v237, v97, v93, s59
  v_mfma_f32_16x16x32_bf16 v[88:91], a[12:15], v[176:179], v[88:91]
  ds_write2st64_b32 v5, v108, v109 offset0:3 offset1:7
  v_mfma_f32_16x16x32_bf16 v[88:91], a[24:27], v[116:119], v[88:91]
  v_cvt_pk_bf16_f32 v66, v136, v137
  v_cvt_pk_bf16_f32 v67, v138, v139
  v_mfma_f32_16x16x32_bf16 v[88:91], a[36:39], v[164:167], v[88:91]
  ds_write2st64_b32 v5, v112, v113 offset0:11 offset1:15
  v_mfma_f32_16x16x32_bf16 v[88:91], a[48:51], v[180:183], v[88:91]
  ds_write2st64_b32 v5, v80, v81 offset0:19 offset1:23
  v_mfma_f32_16x16x32_bf16 v[88:91], a[60:63], v[104:107], v[88:91]
  v_perm_b32 v234, v98, v94, s58
  v_perm_b32 v238, v98, v94, s59
  v_mfma_f32_16x16x32_bf16 v[84:87], a[64:67], v[104:107], 0
  v_perm_b32 v235, v99, v95, s58
  v_perm_b32 v239, v99, v95, s59
  v_mfma_f32_16x16x32_bf16 v[84:87], a[52:55], v[180:183], v[84:87]
  v_perm_b32 v240, v76, v160, s58
  v_perm_b32 v244, v76, v160, s59
  v_mfma_f32_16x16x32_bf16 v[84:87], a[40:43], v[164:167], v[84:87]
  v_mul_f32 v88, s42, v88
  v_mul_f32 v89, s42, v89
  v_mfma_f32_16x16x32_bf16 v[84:87], a[28:31], v[116:119], v[84:87]
  v_mul_f32 v90, s42, v90
  v_mul_f32 v91, s42, v91
  v_mfma_f32_16x16x32_bf16 v[84:87], a[16:19], v[176:179], v[84:87]
L_hop_2_0:
  s_cbranch_execz L_hop_2_1
  v_cvt_pk_bf16_f32 v18, v88, v89
  v_cvt_pk_bf16_f32 v19, v90, v91
  v_mfma_f32_16x16x32_bf16 v[84:87], a[4:7], v[140:143], v[84:87]
  v_perm_b32 v241, v77, v161, s58
  v_perm_b32 v245, v77, v161, s59
  v_mfma_f32_16x16x32_bf16 v[88:91], a[8:11], v[140:143], 0
  v_perm_b32 v242, v78, v162, s58
  v_perm_b32 v246, v78, v162, s59
  v_mfma_f32_16x16x32_bf16 v[88:91], a[20:23], v[176:179], v[88:91]
  v_perm_b32 v243, v79, v163, s58
  v_perm_b32 v247, v79, v163, s59
  v_mfma_f32_16x16x32_bf16 v[88:91], a[32:35], v[116:119], v[88:91]
  v_mul_f32 v84, s42, v84
  v_mul_f32 v85, s42, v85
  v_mfma_f32_16x16x32_bf16 v[88:91], a[44:47], v[164:167], v[88:91]
  v_mul_f32 v86, s42, v86
  v_mul_f32 v87, s42, v87
  v_mfma_f32_16x16x32_bf16 v[88:91], a[56:59], v[180:183], v[88:91]
  v_cvt_pk_bf16_f32 v100, v84, v85
  v_cvt_pk_bf16_f32 v101, v86, v87
  v_mfma_f32_16x16x32_bf16 v[88:91], a[68:71], v[104:107], v[88:91]
  v_add_u32 v68, 102400, v68
  v_add_u32 v69, 102400, v69
  v_mfma_f32_16x16x32_bf16 v[80:83], a[132:135], v[104:107], 0
  v_add_u32 v54, 102400, v54
  v_add_u32 v55, 102400, v55
  v_mfma_f32_16x16x32_bf16 v[80:83], a[120:123], v[180:183], v[80:83]
  ds_read2st64_b32 v[92:93], v68 offset0:0 offset1:2
  ds_read2st64_b32 v[96:97], v69 offset0:0 offset1:2
  v_mfma_f32_16x16x32_bf16 v[80:83], a[108:111], v[164:167], v[80:83]
  v_mul_f32 v88, s42, v88
  v_mul_f32 v89, s42, v89
  v_mfma_f32_16x16x32_bf16 v[80:83], a[96:99], v[116:119], v[80:83]
  v_mul_f32 v90, s42, v90
  v_mul_f32 v91, s42, v91
  v_mfma_f32_16x16x32_bf16 v[80:83], a[84:87], v[176:179], v[80:83]
  v_cvt_pk_bf16_f32 v102, v88, v89
  v_cvt_pk_bf16_f32 v103, v90, v91
  v_mfma_f32_16x16x32_bf16 v[80:83], a[72:75], v[140:143], v[80:83]
  ds_read2st64_b32 v[94:95], v68 offset0:4 offset1:6
  ds_read2st64_b32 v[98:99], v69 offset0:4 offset1:6
  v_mfma_f32_16x16x32_bf16 v[84:87], a[76:79], v[140:143], 0
  ds_read2st64_b32 v[160:161], v54 offset0:0 offset1:2
  ds_read2st64_b32 v[76:77], v55 offset0:0 offset1:2
  v_mfma_f32_16x16x32_bf16 v[84:87], a[88:91], v[176:179], v[84:87]
  ds_read2st64_b32 v[162:163], v54 offset0:4 offset1:6
  ds_read2st64_b32 v[78:79], v55 offset0:4 offset1:6
  v_mfma_f32_16x16x32_bf16 v[84:87], a[100:103], v[116:119], v[84:87]
  v_cvt_pk_bf16_f32 v132, v80, v81
  v_cvt_pk_bf16_f32 v133, v82, v83
  v_mfma_f32_16x16x32_bf16 v[84:87], a[112:115], v[164:167], v[84:87]
  v_xor_b32 v5, s41, v5
  v_mfma_f32_16x16x32_bf16 v[84:87], a[124:127], v[180:183], v[84:87]
  s_waitcnt lgkmcnt(4)
  v_perm_b32 v248, v96, v92, s58
  v_perm_b32 v252, v96, v92, s59
  v_mfma_f32_16x16x32_bf16 v[84:87], a[136:139], v[104:107], v[84:87]
  v_perm_b32 v249, v97, v93, s58
  v_perm_b32 v253, v97, v93, s59
  v_mfma_f32_16x16x32_bf16 v[88:91], a[140:143], v[104:107], 0
  s_waitcnt lgkmcnt(0)
  v_perm_b32 v250, v98, v94, s58
  v_perm_b32 v254, v98, v94, s59
  v_mfma_f32_16x16x32_bf16 v[88:91], a[128:131], v[180:183], v[88:91]
  v_perm_b32 v251, v99, v95, s58
  v_perm_b32 v255, v99, v95, s59
  v_mfma_f32_16x16x32_bf16 v[88:91], a[116:119], v[164:167], v[88:91]
  v_cvt_pk_bf16_f32 v134, v84, v85
  v_cvt_pk_bf16_f32 v135, v86, v87
  v_mfma_f32_16x16x32_bf16 v[88:91], a[104:107], v[116:119], v[88:91]
  s_add_u32 m0, s30, 0
  v_perm_b32 v80, v76, v160, s58
  v_perm_b32 v160, v76, v160, s59
  v_mfma_f32_16x16x32_bf16 v[88:91], a[92:95], v[176:179], v[88:91]
  v_accvgpr_write_b32 a220, v160
  v_perm_b32 v81, v77, v161, s58
  v_mfma_f32_16x16x32_bf16 v[88:91], a[80:83], v[140:143], v[88:91]
  v_perm_b32 v161, v77, v161, s59
  v_accvgpr_write_b32 a221, v161
  v_mfma_f32_16x16x32_bf16 v[84:87], v[140:143], a[144:147], 0
  buffer_load_dwordx4 v6, s[8:11], s31 offen offset:0 nt lds
  v_mfma_f32_16x16x32_bf16 v[84:87], v[176:179], a[156:159], v[84:87]
  s_add_u32 m0, s30, 8064
  v_perm_b32 v82, v78, v162, s58
  v_perm_b32 v162, v78, v162, s59
  v_mfma_f32_16x16x32_bf16 v[84:87], v[116:119], a[168:171], v[84:87]
  v_cvt_pk_bf16_f32 v136, v88, v89
  v_cvt_pk_bf16_f32 v137, v90, v91
  v_mfma_f32_16x16x32_bf16 v[84:87], v[164:167], a[180:183], v[84:87]
  ds_read_b128 a[244:247], v1 offset:22528
  ds_read_b128 a[248:251], v0 offset:22528
  v_mfma_f32_16x16x32_bf16 v[84:87], v[180:183], a[192:195], v[84:87]
  buffer_load_dwordx4 v6, s[8:11], s31 offen offset:128 nt lds
  v_mfma_f32_16x16x32_bf16 v[84:87], v[104:107], a[204:207], v[84:87]
  s_add_u32 m0, s30, 16128
  ds_read_b128 v[168:171], v1 offset:14336
  ds_read_b128 v[172:175], v0 offset:14336
  v_mfma_f32_16x16x32_bf16 v[88:91], v[104:107], a[208:211], 0
  ds_read_b128 a[252:255], v1 offset:6144
  ds_read_b128 v[150:153], v0 offset:6144
  v_mfma_f32_16x16x32_bf16 v[88:91], v[180:183], a[196:199], v[88:91]
  v_accvgpr_write_b32 a222, v162
  v_perm_b32 v83, v79, v163, s58
  v_mfma_f32_16x16x32_bf16 v[88:91], v[164:167], a[184:187], v[88:91]
  buffer_load_dwordx4 v6, s[8:11], s31 offen offset:256 nt lds
  v_mfma_f32_16x16x32_bf16 v[88:91], v[116:119], a[172:175], v[88:91]
  s_add_u32 m0, s30, 4096
  v_cvt_pk_bf16_f32 v108, v84, v85
  v_cvt_pk_bf16_f32 v109, v86, v87
  v_mfma_f32_16x16x32_bf16 v[88:91], v[176:179], a[160:163], v[88:91]
  s_add_u32 s31, s31, s43
  v_perm_b32 v163, v79, v163, s59
  v_accvgpr_write_b32 a223, v163
  v_mfma_f32_16x16x32_bf16 v[88:91], v[140:143], a[148:151], v[88:91]
  ds_read2st64_b32 v[92:93], v68 offset0:16 offset1:18
  ds_read2st64_b32 v[96:97], v69 offset0:16 offset1:18
  v_mfma_f32_16x16x32_bf16 v[84:87], v[140:143], a[152:155], 0
  buffer_load_dwordx4 v6, s[8:11], s32 offen offset:0 nt lds
  v_mfma_f32_16x16x32_bf16 v[84:87], v[176:179], a[164:167], v[84:87]
  s_add_u32 m0, s30, 12160
  ds_read2st64_b32 v[94:95], v68 offset0:20 offset1:22
  ds_read2st64_b32 v[98:99], v69 offset0:20 offset1:22
  v_mfma_f32_16x16x32_bf16 v[84:87], v[116:119], a[176:179], v[84:87]
  v_cvt_pk_bf16_f32 v112, v88, v89
  v_cvt_pk_bf16_f32 v113, v90, v91
  v_mfma_f32_16x16x32_bf16 v[84:87], v[164:167], a[188:191], v[84:87]
  s_waitcnt lgkmcnt(2)
  ds_read2st64_b32 v[160:161], v54 offset0:16 offset1:18
  ds_read2st64_b32 v[76:77], v55 offset0:16 offset1:18
  v_mfma_f32_16x16x32_bf16 v[84:87], v[180:183], a[200:203], v[84:87]
  buffer_load_dwordx4 v6, s[8:11], s32 offen offset:128 nt lds
  v_mfma_f32_16x16x32_bf16 v[84:87], v[104:107], a[212:215], v[84:87]
  s_add_u32 m0, s30, 20224
  ds_read2st64_b32 v[162:163], v54 offset0:20 offset1:22
  ds_read2st64_b32 v[78:79], v55 offset0:20 offset1:22
  v_mfma_f32_16x16x32_bf16 v[68:71], a[132:135], a[244:247], 0
  s_waitcnt lgkmcnt(4)
  v_accvgpr_write_b32 a216, v80
  v_accvgpr_write_b32 a217, v81
  v_mfma_f32_16x16x32_bf16 v[68:71], a[120:123], a[248:251], v[68:71]
  s_mov_b32 s30, s5
  v_accvgpr_write_b32 a218, v82
  v_accvgpr_write_b32 a219, v83
  v_mfma_f32_16x16x32_bf16 v[68:71], a[108:111], v[168:171], v[68:71]
  buffer_load_dwordx4 v6, s[8:11], s32 offen offset:256 nt lds
  v_mfma_f32_16x16x32_bf16 v[68:71], a[96:99], v[172:175], v[68:71]
  s_add_u32 s32, s32, s43
  v_cvt_pk_bf16_f32 v116, v84, v85
  v_cvt_pk_bf16_f32 v117, v86, v87
  v_mfma_f32_16x16x32_bf16 v[68:71], a[84:87], a[252:255], v[68:71]
  s_waitcnt lgkmcnt(0)
  v_perm_b32 v54, v96, v92, s58
  v_perm_b32 v92, v96, v92, s59
  v_mfma_f32_16x16x32_bf16 v[68:71], a[72:75], v[150:153], v[68:71]
  v_accvgpr_write_b32 a224, v54
  v_accvgpr_write_b32 a228, v92
  v_mfma_f32_16x16x32_bf16 v[84:87], a[76:79], v[150:153], 0
  v_perm_b32 v55, v97, v93, s58
  v_perm_b32 v93, v97, v93, s59
  v_mfma_f32_16x16x32_bf16 v[84:87], a[88:91], a[252:255], v[84:87]
  v_accvgpr_write_b32 a225, v55
  v_accvgpr_write_b32 a229, v93
  v_mfma_f32_16x16x32_bf16 v[84:87], a[100:103], v[172:175], v[84:87]
  v_cvt_pk_bf16_f32 v176, v68, v69
  v_cvt_pk_bf16_f32 v177, v70, v71
  v_mfma_f32_16x16x32_bf16 v[84:87], a[112:115], v[168:171], v[84:87]
  v_perm_b32 v54, v98, v94, s58
  v_perm_b32 v94, v98, v94, s59
  v_mfma_f32_16x16x32_bf16 v[84:87], a[124:127], a[248:251], v[84:87]
  v_accvgpr_write_b32 a226, v54
  v_accvgpr_write_b32 a230, v94
  v_mfma_f32_16x16x32_bf16 v[84:87], a[136:139], a[244:247], v[84:87]
  v_perm_b32 v55, v99, v95, s58
  v_perm_b32 v95, v99, v95, s59
  v_mfma_f32_16x16x32_bf16 v[68:71], a[140:143], a[244:247], 0
  v_accvgpr_write_b32 a227, v55
  v_accvgpr_write_b32 a231, v95
  v_mfma_f32_16x16x32_bf16 v[68:71], a[128:131], a[248:251], v[68:71]
  v_perm_b32 v54, v76, v160, s58
  v_perm_b32 v160, v76, v160, s59
  v_mfma_f32_16x16x32_bf16 v[68:71], a[116:119], v[168:171], v[68:71]
  v_cvt_pk_bf16_f32 v178, v84, v85
  v_cvt_pk_bf16_f32 v179, v86, v87
  v_mfma_f32_16x16x32_bf16 v[68:71], a[104:107], v[172:175], v[68:71]
  v_accvgpr_write_b32 a232, v54
  v_accvgpr_write_b32 a236, v160
  v_mfma_f32_16x16x32_bf16 v[68:71], a[92:95], a[252:255], v[68:71]
  v_perm_b32 v55, v77, v161, s58
  v_perm_b32 v161, v77, v161, s59
  v_mfma_f32_16x16x32_bf16 v[68:71], a[80:83], v[150:153], v[68:71]
  v_accvgpr_write_b32 a233, v55
  v_accvgpr_write_b32 a237, v161
  v_mfma_f32_16x16x32_bf16 v[92:95], v[122:125], v[72:75], v[36:39]
  v_perm_b32 v54, v78, v162, s58
  v_perm_b32 v162, v78, v162, s59
  v_mfma_f32_16x16x32_bf16 v[92:95], v[120:123], v[12:15], v[92:95]
  v_accvgpr_write_b32 a234, v54
  v_accvgpr_write_b32 a238, v162
  v_mfma_f32_16x16x32_bf16 v[96:99], v[146:149], v[72:75], v[32:35]
  v_perm_b32 v55, v79, v163, s58
  v_perm_b32 v163, v79, v163, s59
  v_mfma_f32_16x16x32_bf16 v[96:99], v[144:147], v[12:15], v[96:99]
  v_accvgpr_write_b32 a235, v55
  v_accvgpr_write_b32 a239, v163
  v_mfma_f32_16x16x32_bf16 v[104:107], v[134:137], v[72:75], v[28:31]
  v_cvt_pk_bf16_f32 v180, v68, v69
  v_cvt_pk_bf16_f32 v181, v70, v71
  v_mfma_f32_16x16x32_bf16 v[104:107], v[132:135], v[12:15], v[104:107]
  v_exp_f32 v92, v92
  v_mfma_f32_16x16x32_bf16 v[140:143], v[178:181], v[72:75], v[24:27]
  s_lshr_b32 s44, s2, 3
  v_exp_f32 v93, v93
  v_mfma_f32_16x16x32_bf16 v[140:143], v[176:179], v[12:15], v[140:143]
  s_lshl_b32 s44, s44, 9
  v_exp_f32 v94, v94
  v_mfma_f32_16x16x32_bf16 v[84:87], v[120:123], v[156:159], v[40:43]
  s_add_u32 s44, s44, 1048576
  v_exp_f32 v95, v95
  v_mfma_f32_16x16x32_bf16 v[84:87], v[122:125], v[14:17], v[84:87]
  s_mov_b32 s45, 0
  v_exp_f32 v96, v96
  v_mfma_f32_16x16x32_bf16 v[88:91], v[144:147], v[156:159], v[36:39]
  s_mov_b32 s59, 0
  v_exp_f32 v97, v97
  v_mfma_f32_16x16x32_bf16 v[88:91], v[146:149], v[14:17], v[88:91]
  s_mov_b32 s58, 0
  v_exp_f32 v98, v98
  v_mfma_f32_16x16x32_bf16 v[68:71], v[132:135], v[156:159], v[32:35]
  s_mov_b64 s[12:13], 0
  v_exp_f32 v99, v99
  v_mfma_f32_16x16x32_bf16 v[68:71], v[134:137], v[14:17], v[68:71]
  s_mov_b64 s[16:17], 0
  v_exp_f32 v104, v104
  v_mfma_f32_16x16x32_bf16 v[72:75], v[176:179], v[156:159], v[28:31]
  s_mov_b64 s[18:19], 0
  v_exp_f32 v105, v105
  v_mfma_f32_16x16x32_bf16 v[72:75], v[178:181], v[14:17], v[72:75]
  s_mov_b64 s[60:61], 0
  v_exp_f32 v106, v106
  v_mfma_f32_16x16x32_bf16 v[76:79], v[134:137], v[100:103], v[36:39]
  s_mov_b32 s15, 0
  v_exp_f32 v107, v107
  v_mfma_f32_16x16x32_bf16 v[76:79], v[132:135], v[18:21], v[76:79]
  s_mov_b32 s99, 0
  v_exp_f32 v140, v140
  v_mfma_f32_16x16x32_bf16 v[80:83], v[178:181], v[100:103], v[32:35]
  s_mov_b64 s[100:101], 0
  v_exp_f32 v141, v141
  v_mfma_f32_16x16x32_bf16 v[80:83], v[176:179], v[18:21], v[80:83]
  s_mov_b32 s14, 0
  v_exp_f32 v142, v142
  v_mfma_f32_16x16x32_bf16 v[160:163], v[122:125], v[100:103], v[44:47]
  v_exp_f32 v143, v143
  v_mfma_f32_16x16x32_bf16 v[160:163], v[120:123], v[18:21], v[160:163]
  v_cvt_pk_bf16_f32 v92, v92, v93
  v_cvt_pk_bf16_f32 v93, v94, v95
  v_mfma_f32_16x16x32_bf16 v[156:159], v[146:149], v[100:103], v[40:43]
  v_cvt_pk_bf16_f32 v94, v96, v97
  v_cvt_pk_bf16_f32 v95, v98, v99
  v_mfma_f32_16x16x32_bf16 v[156:159], v[144:147], v[18:21], v[156:159]
  v_cvt_pk_bf16_f32 v96, v104, v105
  v_cvt_pk_bf16_f32 v97, v106, v107
  v_mfma_f32_16x16x32_bf16 v[128:131], a[0:3], v[150:153], 0
  v_cvt_pk_bf16_f32 v98, v140, v141
  v_cvt_pk_bf16_f32 v99, v142, v143
  v_mfma_f32_16x16x32_bf16 v[128:131], a[12:15], a[252:255], v[128:131]
  v_exp_f32 v84, v84
  v_mfma_f32_16x16x32_bf16 v[128:131], a[24:27], v[172:175], v[128:131]
  v_exp_f32 v85, v85
  v_mfma_f32_16x16x32_bf16 v[128:131], a[36:39], v[168:171], v[128:131]
  v_exp_f32 v86, v86
  v_mfma_f32_16x16x32_bf16 v[128:131], a[48:51], a[248:251], v[128:131]
  v_exp_f32 v87, v87
  v_mfma_f32_16x16x32_bf16 v[128:131], a[60:63], a[244:247], v[128:131]
  v_exp_f32 v88, v88
  v_mfma_f32_16x16x32_bf16 v[100:103], a[64:67], a[244:247], 0
  v_exp_f32 v89, v89
  v_mfma_f32_16x16x32_bf16 v[100:103], a[52:55], a[248:251], v[100:103]
  v_exp_f32 v90, v90
  v_mfma_f32_16x16x32_bf16 v[100:103], a[40:43], v[168:171], v[100:103]
  v_exp_f32 v91, v91
  v_mfma_f32_16x16x32_bf16 v[100:103], a[28:31], v[172:175], v[100:103]
  v_mul_f32 v128, s42, v128
  v_mul_f32 v129, s42, v129
  v_mfma_f32_16x16x32_bf16 v[100:103], a[16:19], a[252:255], v[100:103]
  v_mul_f32 v130, s42, v130
  v_mul_f32 v131, s42, v131
  v_mfma_f32_16x16x32_bf16 v[100:103], a[4:7], v[150:153], v[100:103]
  v_cvt_pk_bf16_f32 v140, v128, v129
  v_cvt_pk_bf16_f32 v141, v130, v131
  v_mfma_f32_16x16x32_bf16 v[104:107], a[8:11], v[150:153], 0
  v_exp_f32 v68, v68
  v_mfma_f32_16x16x32_bf16 v[104:107], a[20:23], a[252:255], v[104:107]
  v_exp_f32 v69, v69
  v_mfma_f32_16x16x32_bf16 v[104:107], a[32:35], v[172:175], v[104:107]
  v_exp_f32 v70, v70
  v_mfma_f32_16x16x32_bf16 v[104:107], a[44:47], v[168:171], v[104:107]
  v_mul_f32 v100, s42, v100
  v_mul_f32 v101, s42, v101
  v_mfma_f32_16x16x32_bf16 v[104:107], a[56:59], a[248:251], v[104:107]
  v_mul_f32 v102, s42, v102
  v_mul_f32 v103, s42, v103
  v_mfma_f32_16x16x32_bf16 v[104:107], a[68:71], a[244:247], v[104:107]
  v_cvt_pk_bf16_f32 v142, v100, v101
  v_cvt_pk_bf16_f32 v143, v102, v103
  v_mfma_f32_16x16x32_bf16 v[128:131], v[150:153], a[144:147], 0
  v_exp_f32 v71, v71
  v_mfma_f32_16x16x32_bf16 v[128:131], a[252:255], a[156:159], v[128:131]
  v_exp_f32 v72, v72
  v_mfma_f32_16x16x32_bf16 v[128:131], v[172:175], a[168:171], v[128:131]
  v_mul_f32 v104, s42, v104
  v_mul_f32 v105, s42, v105
  v_mfma_f32_16x16x32_bf16 v[128:131], v[168:171], a[180:183], v[128:131]
  v_mul_f32 v106, s42, v106
  v_mul_f32 v107, s42, v107
  v_cvt_pk_bf16_f32 v22, v104, v105
  v_cvt_pk_bf16_f32 v23, v106, v107
  v_mfma_f32_16x16x32_bf16 v[128:131], a[248:251], a[192:195], v[128:131]
  s_waitcnt vmcnt(6) lgkmcnt(0)
  s_barrier
  v_mfma_f32_16x16x32_bf16 v[128:131], a[244:247], a[204:207], v[128:131]
  v_exp_f32 v73, v73
  v_mfma_f32_16x16x32_bf16 v[100:103], v[132:135], v[140:143], v[40:43]
  v_exp_f32 v74, v74
  v_mfma_f32_16x16x32_bf16 v[100:103], v[134:137], v[20:23], v[100:103]
  v_exp_f32 v75, v75
  v_mfma_f32_16x16x32_bf16 v[104:107], v[176:179], v[140:143], v[36:39]
  v_cvt_pk_bf16_f32 v84, v84, v85
  v_cvt_pk_bf16_f32 v85, v86, v87
  v_mfma_f32_16x16x32_bf16 v[104:107], v[178:181], v[20:23], v[104:107]
  v_cvt_pk_bf16_f32 v110, v128, v129
  v_cvt_pk_bf16_f32 v111, v130, v131
  v_mfma_f32_16x16x32_bf16 v[132:135], v[120:123], v[140:143], v[48:51]
  v_cvt_pk_bf16_f32 v86, v88, v89
  v_cvt_pk_bf16_f32 v87, v90, v91
  v_mfma_f32_16x16x32_bf16 v[132:135], v[122:125], v[20:23], v[132:135]
  v_cvt_pk_bf16_f32 v88, v68, v69
  v_cvt_pk_bf16_f32 v89, v70, v71
  v_mfma_f32_16x16x32_bf16 v[128:131], v[144:147], v[140:143], v[44:47]
  v_cvt_pk_bf16_f32 v90, v72, v73
  v_cvt_pk_bf16_f32 v91, v74, v75
  v_mfma_f32_16x16x32_bf16 v[128:131], v[146:149], v[20:23], v[128:131]
  ds_read_b128 v[136:139], v3 offset:0
  ds_read_b128 v[140:143], v3 offset:4096
  v_mfma_f32_16x16x32_bf16 v[176:179], a[244:247], a[208:211], 0
  ds_read_b128 v[68:71], v3 offset:8192
  ds_read_b128 v[72:75], v3 offset:12288
  v_mfma_f32_16x16x32_bf16 v[176:179], a[248:251], a[196:199], v[176:179]
  ds_read_b128 v[120:123], v3 offset:16384
  ds_read_b128 v[124:127], v3 offset:20480
  v_mfma_f32_16x16x32_bf16 v[176:179], v[168:171], a[184:187], v[176:179]
  v_exp_f32 v76, v76
  v_mfma_f32_16x16x32_bf16 v[176:179], v[172:175], a[172:175], v[176:179]
  v_exp_f32 v77, v77
  v_mfma_f32_16x16x32_bf16 v[176:179], a[252:255], a[160:163], v[176:179]
  v_exp_f32 v78, v78
  v_mfma_f32_16x16x32_bf16 v[176:179], v[150:153], a[148:151], v[176:179]
  v_exp_f32 v79, v79
  v_mfma_f32_16x16x32_bf16 v[164:167], v[150:153], a[152:155], 0
  v_exp_f32 v80, v80
  v_mfma_f32_16x16x32_bf16 v[164:167], a[252:255], a[164:167], v[164:167]
  v_exp_f32 v81, v81
  v_mfma_f32_16x16x32_bf16 v[164:167], v[172:175], a[176:179], v[164:167]
  v_exp_f32 v82, v82
  v_mfma_f32_16x16x32_bf16 v[164:167], v[168:171], a[188:191], v[164:167]
  v_exp_f32 v83, v83
  v_mfma_f32_16x16x32_bf16 v[164:167], a[248:251], a[200:203], v[164:167]
  v_cvt_pk_bf16_f32 v114, v176, v177
  v_cvt_pk_bf16_f32 v115, v178, v179
  v_mfma_f32_16x16x32_bf16 v[164:167], a[244:247], a[212:215], v[164:167]
  v_add_u32 v0, s28, v2
  v_xor_b32 v1, 64, v0
  s_waitcnt lgkmcnt(0)
  s_branch L_mid
  s_nop 0
  s_nop 0
  s_nop 0
  s_nop 0
  s_nop 0
  s_nop 0
  s_nop 0
  s_nop 0
  s_nop 0
  s_nop 0
  s_nop 0
  s_nop 0
  s_nop 0
  s_nop 0
  s_nop 0
  s_nop 0
  s_nop 0
  s_nop 0
  s_nop 0
  s_nop 0
  s_nop 0
  s_nop 0
  s_nop 0
  s_nop 0
  s_nop 0
  s_nop 0
  s_nop 0
  s_nop 0
  s_nop 0
  s_nop 0
  s_nop 0
  s_nop 0
  s_nop 0
  s_nop 0
  s_nop 0
  s_nop 0
  s_nop 0
  s_nop 0
  s_nop 0
  s_nop 0
  s_nop 0
  s_nop 0
  s_nop 0
  s_nop 0
  s_nop 0
  s_nop 0
  s_nop 0
  s_nop 0
  s_nop 0
  s_nop 0
  s_nop 0
  s_nop 0
  s_nop 0
  s_nop 0
  s_nop 0
  s_nop 0
  s_nop 0
  s_nop 0
  s_nop 0
  s_nop 0
  s_nop 0
  s_nop 0
  s_nop 0
  s_nop 0
  s_nop 0
  s_nop 0
  s_nop 0
  s_nop 0
  s_nop 0
  s_nop 0
  s_nop 0
  s_nop 0
  s_nop 0
  s_nop 0
  s_nop 0
  s_nop 0
  s_nop 0
  s_nop 0
  s_nop 0
  s_nop 0
  s_nop 0
  s_nop 0
  s_nop 0
  s_nop 0
  s_nop 0
  s_nop 0
  s_nop 0
  s_nop 0
  s_nop 0
  s_nop 0
  s_nop 0
  s_nop 0
  s_nop 0
  s_nop 0
  s_nop 0
  s_nop 0
  s_nop 0
  s_nop 0
  s_nop 0
  s_nop 0
  s_nop 0
  s_nop 0
  s_nop 0
  s_nop 0
  s_nop 0
  s_nop 0
  s_nop 0
  s_nop 0
  s_nop 0
  s_nop 0
  s_nop 0
  s_nop 0
  s_nop 0
  s_nop 0
  s_nop 0
  s_nop 0
  s_nop 0
  s_nop 0
  s_nop 0
  s_nop 0
  s_nop 0
  s_nop 0
  s_nop 0
  s_nop 0
  s_nop 0
  s_nop 0
  s_nop 0
  s_nop 0
  s_nop 0
  s_nop 0
  s_nop 0
  s_nop 0
  s_nop 0
  s_nop 0
  s_nop 0
  s_nop 0
  s_nop 0
  s_nop 0
  s_nop 0
  s_nop 0
  s_nop 0
  s_nop 0
  s_nop 0
  s_nop 0
  s_nop 0
  s_nop 0
  s_nop 0
  s_nop 0
  s_nop 0
  s_nop 0
  s_nop 0
  s_nop 0
  s_nop 0
  s_nop 0
  s_nop 0
  s_nop 0
  s_nop 0
  s_nop 0
  s_nop 0
  s_nop 0
  s_nop 0
  s_nop 0
  s_nop 0
  s_nop 0
  s_nop 0
  s_nop 0
  s_nop 0
  s_nop 0
  s_nop 0
  s_nop 0
  s_nop 0
  s_nop 0
  s_nop 0
  s_nop 0
  s_nop 0
  s_nop 0
  s_nop 0
  s_nop 0
  s_nop 0
  s_nop 0
  s_nop 0
  s_nop 0
  s_nop 0
  s_nop 0
  s_nop 0
  s_nop 0
  s_nop 0
  s_nop 0
  s_nop 0
  s_nop 0
  s_nop 0
  s_nop 0
  s_nop 0
  s_nop 0
  s_nop 0
  s_nop 0
  s_nop 0
  s_nop 0
  s_nop 0
  s_nop 0
  s_nop 0
  s_nop 0
  s_nop 0
  s_nop 0
  s_nop 0
  s_nop 0
  s_nop 0
  s_nop 0
  s_nop 0
  s_nop 0
  s_nop 0
  s_nop 0
  s_nop 0
  s_nop 0
  s_nop 0
  s_nop 0
  s_nop 0
  s_nop 0
  s_nop 0
  s_nop 0
  s_nop 0
  s_nop 0
  s_nop 0
  s_nop 0
  s_nop 0
  s_nop 0
  s_nop 0
  s_nop 0
  s_nop 0
  s_nop 0
  s_nop 0
  s_nop 0
  s_nop 0
  s_nop 0
  s_nop 0
  s_nop 0
  s_nop 0
  s_nop 0
  s_nop 0
  s_nop 0
  s_nop 0
  s_nop 0
  s_nop 0
  s_nop 0
  s_nop 0
  s_nop 0
  s_nop 0
  s_nop 0
  s_nop 0
  s_nop 0
  s_nop 0
  s_nop 0
  s_nop 0
  s_nop 0
  s_nop 0
  s_nop 0
  s_nop 0
  s_nop 0
  s_nop 0
  s_nop 0
  s_nop 0
  s_nop 0
  s_nop 0
  s_nop 0
  s_nop 0
  s_nop 0
  s_nop 0
  s_nop 0
  s_nop 0
  s_nop 0
  s_nop 0
  s_nop 0
  s_nop 0
  s_nop 0
  s_nop 0
  s_nop 0
  s_nop 0
  s_nop 0
  s_nop 0
  s_nop 0
  s_nop 0
  s_nop 0
  s_nop 0
  s_nop 0
  s_nop 0
  s_nop 0
  s_nop 0
  s_nop 0
  s_nop 0
  s_nop 0
  s_nop 0
  s_nop 0
  s_nop 0
  s_nop 0
  s_nop 0
  s_nop 0
  s_nop 0
  s_nop 0
  s_nop 0
  s_nop 0
  s_nop 0
  s_nop 0
  s_nop 0
  s_nop 0
  s_nop 0
  s_nop 0
  s_nop 0
  s_nop 0
  s_nop 0
  s_nop 0
  s_nop 0
  s_nop 0
  s_nop 0
  s_nop 0
  s_nop 0
  s_nop 0
  s_nop 0
  s_nop 0
  s_nop 0
  s_nop 0
  s_nop 0
  s_nop 0
  s_nop 0
  s_nop 0
  s_nop 0
  s_nop 0
  s_nop 0
  s_nop 0
  s_nop 0
  s_nop 0
  s_nop 0
  s_nop 0
  s_nop 0
  s_nop 0
  s_nop 0
  s_nop 0
  s_nop 0
  s_nop 0
  s_nop 0
  s_nop 0
  s_nop 0
  s_nop 0
  s_nop 0
  s_nop 0
  s_nop 0
  s_nop 0
  s_nop 0
  s_nop 0
  s_nop 0
  s_nop 0
  s_nop 0
  s_nop 0
  s_nop 0
  s_nop 0
  s_nop 0
  s_nop 0
  s_nop 0
  s_nop 0
  s_nop 0
  s_nop 0
  s_nop 0
  s_nop 0
  s_nop 0
  s_nop 0
  s_nop 0
  s_nop 0
  s_nop 0
  s_nop 0
  s_nop 0
  s_nop 0
  s_nop 0
  s_nop 0
  s_nop 0
  s_nop 0
  s_nop 0
  s_nop 0
  s_nop 0
  s_nop 0
  s_nop 0
  s_nop 0
  s_nop 0
  s_nop 0
  s_nop 0
  s_nop 0
  s_nop 0
  s_nop 0
  s_nop 0
  s_nop 0
  s_nop 0
  s_nop 0
  s_nop 0
  s_nop 0
  s_nop 0
  s_nop 0
  s_nop 0
  s_nop 0
  s_nop 0
  s_nop 0
  s_nop 0
  s_nop 0
  s_nop 0
  s_nop 0
  s_nop 0
  s_nop 0
  s_nop 0
  s_nop 0
  s_nop 0
  s_nop 0
  s_nop 0
  s_nop 0
  s_nop 0
  s_nop 0
  s_nop 0
  s_nop 0
  s_nop 0
  s_nop 0
  s_nop 0
  s_nop 0
  s_nop 0
  s_nop 0
  s_nop 0
  s_nop 0
  s_nop 0
  s_nop 0
  s_nop 0
  s_nop 0
  s_nop 0
  s_nop 0
  s_nop 0
  s_nop 0
  s_nop 0
  s_nop 0
  s_nop 0
  s_nop 0
  s_nop 0
  s_nop 0
  s_nop 0
  s_nop 0
  s_nop 0
  s_nop 0
  s_nop 0
  s_nop 0
  s_nop 0
  s_nop 0
  s_nop 0
  s_nop 0
  s_nop 0
  s_nop 0
  s_nop 0
  s_nop 0
  s_nop 0
  s_nop 0
  s_nop 0
  s_nop 0
  s_nop 0
  s_nop 0
  s_nop 0
  s_nop 0
  s_nop 0
  s_nop 0
  s_nop 0
  s_nop 0
  s_nop 0
  s_nop 0
  s_nop 0
  s_nop 0
  s_nop 0
  s_nop 0
  s_nop 0
  s_nop 0
  s_nop 0
  s_nop 0
  s_nop 0
  s_nop 0
  s_nop 0
  s_nop 0
  s_nop 0
  s_nop 0
  s_nop 0
  s_nop 0
  s_nop 0
  s_nop 0
  s_nop 0
  s_nop 0
  s_nop 0
  s_nop 0
  s_nop 0
  s_nop 0
  s_nop 0
  s_nop 0
  s_nop 0
  s_nop 0
  s_nop 0
  s_nop 0
  s_nop 0
  s_nop 0
  s_nop 0
  s_nop 0
  s_nop 0
  s_nop 0
  s_nop 0
  s_nop 0
  s_nop 0
  s_nop 0
  s_nop 0
  s_nop 0
  s_nop 0
  s_nop 0
  s_nop 0
  s_nop 0
  s_nop 0
  s_nop 0
  s_nop 0
  s_nop 0
  s_nop 0
  s_nop 0
  s_nop 0
  s_nop 0
  s_nop 0
  s_nop 0
  s_nop 0
  s_nop 0
  s_nop 0
  s_nop 0
  s_nop 0
  s_nop 0
  s_nop 0
  s_nop 0
  s_nop 0
  s_nop 0
  s_nop 0
  s_nop 0
  s_nop 0
  s_nop 0
  s_nop 0
  s_nop 0
  s_nop 0
  s_nop 0
  s_nop 0
  s_nop 0
  s_nop 0
  s_nop 0
  s_nop 0
  s_nop 0
  s_nop 0
  s_nop 0
  s_nop 0
  s_nop 0
  s_nop 0
  s_nop 0
  s_nop 0
  s_nop 0
  s_nop 0
  s_nop 0
  s_nop 0
  s_nop 0
  s_nop 0
  s_nop 0
  s_nop 0
  s_nop 0
  s_nop 0
  s_nop 0
  s_nop 0
  s_nop 0
  s_nop 0
  s_nop 0
  s_nop 0
  s_nop 0
  s_nop 0
  s_nop 0
  s_nop 0
  s_nop 0
  s_nop 0
  s_nop 0
  s_nop 0
  s_nop 0
  s_nop 0
  s_nop 0
  s_nop 0
  s_nop 0
  s_nop 0
  s_nop 0
  s_nop 0
  s_nop 0
  s_nop 0
  s_nop 0
  s_nop 0
  s_nop 0
  s_nop 0
  s_nop 0
  s_nop 0
  s_nop 0
  s_nop 0
  s_nop 0
  s_nop 0
  s_nop 0
  s_nop 0
  s_nop 0
  s_nop 0
  s_nop 0
  s_nop 0
  s_nop 0
  s_nop 0
  s_nop 0
  s_nop 0
  s_nop 0
  s_nop 0
  s_nop 0
  s_nop 0
  s_nop 0
  s_nop 0
  s_nop 0
  s_nop 0
  s_nop 0
  s_nop 0
  s_nop 0
  s_nop 0
  s_nop 0
  s_nop 0
  s_nop 0
  s_nop 0
  s_nop 0
  s_nop 0
  s_nop 0
  s_nop 0
  s_nop 0
  s_nop 0
  s_nop 0
  s_nop 0
  s_nop 0
  s_nop 0
  s_nop 0
  s_nop 0
  s_nop 0
  s_nop 0
  s_nop 0
  s_nop 0
  s_nop 0
  s_nop 0
  s_nop 0
  s_nop 0
  s_nop 0
  s_nop 0
  s_nop 0
  s_nop 0
  s_nop 0
  s_nop 0
  s_nop 0
  s_nop 0
  s_nop 0
  s_nop 0
  s_nop 0
  s_nop 0
  s_nop 0
  s_nop 0
  s_nop 0
  s_nop 0
  s_nop 0
  s_nop 0
  s_nop 0
  s_nop 0
  s_nop 0
  s_nop 0
  s_nop 0
  s_nop 0
  s_nop 0
  s_nop 0
  s_nop 0
  s_nop 0
  s_nop 0
  s_nop 0
  s_nop 0
  s_nop 0
  s_nop 0
  s_nop 0
  s_nop 0
  s_nop 0
  s_nop 0
  s_nop 0
  s_nop 0
  s_nop 0
  s_nop 0
  s_nop 0
  s_nop 0
  s_nop 0
  s_nop 0
  s_nop 0
  s_nop 0
  s_nop 0
  s_nop 0
  s_nop 0
  s_nop 0
  s_nop 0
  s_nop 0
  s_nop 0
  s_nop 0
  s_nop 0
  s_nop 0
  s_nop 0
  s_nop 0
  s_nop 0
  s_nop 0
  s_nop 0
  s_nop 0
  s_nop 0
  s_nop 0
  s_nop 0
  s_nop 0
  s_nop 0
  s_nop 0
  s_nop 0
  s_nop 0
  s_nop 0
  s_nop 0
  s_nop 0
  s_nop 0
  s_nop 0
  s_nop 0
  s_nop 0
  s_nop 0
  s_nop 0
  s_nop 0
  s_nop 0
  s_nop 0
  s_nop 0
  s_nop 0
  s_nop 0
  s_nop 0
  s_nop 0
  s_nop 0
  s_nop 0
  s_nop 0
  s_nop 0
  s_nop 0
  s_nop 0
  s_nop 0
  s_nop 0
  s_nop 0
  s_nop 0
  s_nop 0
  s_nop 0
  s_nop 0
  s_nop 0
  s_nop 0
  s_nop 0
  s_nop 0
  s_nop 0
  s_nop 0
  s_nop 0
  s_nop 0
  s_nop 0
  s_nop 0
  s_nop 0
  s_nop 0
  s_nop 0
  s_nop 0
  s_nop 0
  s_nop 0
  s_nop 0
  s_nop 0
  s_nop 0
  s_nop 0
  s_nop 0
  s_nop 0
  s_nop 0
  s_nop 0
  s_nop 0
  s_nop 0
  s_nop 0
  s_nop 0
  s_nop 0
  s_nop 0
  s_nop 0
  s_nop 0
  s_nop 0
  s_nop 0
  s_nop 0
  s_nop 0
  s_nop 0
  s_nop 0
  s_nop 0
  s_nop 0
  s_nop 0
  s_nop 0
  s_nop 0
  s_nop 0
  s_nop 0
  s_nop 0
  s_nop 0
  s_nop 0
  s_nop 0
  s_nop 0
  s_nop 0
  s_nop 0
  s_nop 0
  s_nop 0
  s_nop 0
  s_nop 0
  s_nop 0
  s_nop 0
  s_nop 0
  s_nop 0
  s_nop 0
  s_nop 0
  s_nop 0
  s_nop 0
  s_nop 0
  s_nop 0
  s_nop 0
  s_nop 0
  s_nop 0
  s_nop 0
  s_nop 0
  s_nop 0
  s_nop 0
  s_nop 0
  s_nop 0
  s_nop 0
  s_nop 0
  s_nop 0
  s_nop 0
  s_nop 0
  s_nop 0
  s_nop 0
  s_nop 0
  s_nop 0
  s_nop 0
  s_nop 0
  s_nop 0
  s_nop 0
  s_nop 0
  s_nop 0
  s_nop 0
  s_nop 0
  s_nop 0
  s_nop 0
  s_nop 0
  s_nop 0
  s_nop 0
  s_nop 0
  s_nop 0
  s_nop 0
  s_nop 0
  s_nop 0
  s_nop 0
  s_nop 0
  s_nop 0
  s_nop 0
  s_nop 0
  s_nop 0
  s_nop 0
  s_nop 0
  s_nop 0
  s_nop 0
  s_nop 0
  s_nop 0
  s_nop 0
  s_nop 0
  s_nop 0
  s_nop 0
  s_nop 0
  s_nop 0
  s_nop 0
  s_nop 0
  s_nop 0
  s_nop 0
  s_nop 0
  s_nop 0
  s_nop 0
  s_nop 0
  s_nop 0
  s_nop 0
  s_nop 0
  s_nop 0
  s_nop 0
  s_nop 0
  s_nop 0
  s_nop 0
  s_nop 0
  s_nop 0
  s_nop 0
  s_nop 0
  s_nop 0
  s_nop 0
  s_nop 0
  s_nop 0
  s_nop 0
  s_nop 0
  s_nop 0
  s_nop 0
  s_nop 0
  s_nop 0
  s_nop 0
  s_nop 0
  s_nop 0
  s_nop 0
L_hop_3_0:
  s_cbranch_execz L_hop_3_1
L_pad2119:
L_loop:
  v_mfma_f32_16x16x32_bf16 v[104:107], a[0:3], v[88:91], 0
L_r208:
  v_mfma_f32_16x16x32_bf16 v[104:107], a[12:15], v[92:95], v[104:107]
L_r209:
  v_mfma_f32_16x16x32_bf16 v[104:107], a[24:27], v[116:119], v[104:107]
  v_cvt_pk_bf16_f32 v66, v132, v133
  v_cvt_pk_bf16_f32 v67, v134, v135
L_r210:
  v_mfma_f32_16x16x32_bf16 v[104:107], a[36:39], v[96:99], v[104:107]
L_r211:
  v_mfma_f32_16x16x32_bf16 v[104:107], a[48:51], v[136:139], v[104:107]
  s_waitcnt lgkmcnt(0)
L_r212:
  v_mfma_f32_16x16x32_bf16 v[104:107], a[60:63], v[80:83], v[104:107]
L_r213:
  v_mfma_f32_16x16x32_bf16 v[84:87], a[64:67], v[80:83], 0
L_r214:
  v_mfma_f32_16x16x32_bf16 v[84:87], a[52:55], v[136:139], v[84:87]
L_r215:
  v_mfma_f32_16x16x32_bf16 v[84:87], a[40:43], v[96:99], v[84:87]
  v_mul_f32 v104, s42, v104
  v_mul_f32 v105, s42, v105
L_r216:
  v_mfma_f32_16x16x32_bf16 v[84:87], a[28:31], v[116:119], v[84:87]
  v_mul_f32 v106, s42, v106
  v_mul_f32 v107, s42, v107
L_r217:
  v_mfma_f32_16x16x32_bf16 v[84:87], a[16:19], v[92:95], v[84:87]
  v_cvt_pk_bf16_f32 v18, v104, v105
  v_cvt_pk_bf16_f32 v19, v106, v107
L_r218:
  v_mfma_f32_16x16x32_bf16 v[84:87], a[4:7], v[88:91], v[84:87]
L_r219:
  v_mfma_f32_16x16x32_bf16 v[108:111], a[8:11], v[88:91], 0
L_r220:
  v_mfma_f32_16x16x32_bf16 v[108:111], a[20:23], v[92:95], v[108:111]
L_r221:
  v_mfma_f32_16x16x32_bf16 v[108:111], a[32:35], v[116:119], v[108:111]
  v_mul_f32 v84, s42, v84
  v_mul_f32 v85, s42, v85
L_r222:
  v_mfma_f32_16x16x32_bf16 v[108:111], a[44:47], v[96:99], v[108:111]
  v_mul_f32 v86, s42, v86
  v_mul_f32 v87, s42, v87
L_r223:
  v_mfma_f32_16x16x32_bf16 v[108:111], a[56:59], v[136:139], v[108:111]
  v_cvt_pk_bf16_f32 v104, v84, v85
  v_cvt_pk_bf16_f32 v105, v86, v87
L_r224:
  v_mfma_f32_16x16x32_bf16 v[108:111], a[68:71], v[80:83], v[108:111]
L_r225:
  v_mfma_f32_16x16x32_bf16 v[112:115], a[132:135], v[80:83], 0
L_r226:
  v_mfma_f32_16x16x32_bf16 v[112:115], a[120:123], v[136:139], v[112:115]
L_r227:
  v_mfma_f32_16x16x32_bf16 v[112:115], a[108:111], v[96:99], v[112:115]
  v_mul_f32 v108, s42, v108
  v_mul_f32 v109, s42, v109
L_r228:
  v_mfma_f32_16x16x32_bf16 v[112:115], a[96:99], v[116:119], v[112:115]
  v_mul_f32 v110, s42, v110
  v_mul_f32 v111, s42, v111
L_r229:
  v_mfma_f32_16x16x32_bf16 v[112:115], a[84:87], v[92:95], v[112:115]
  v_cvt_pk_bf16_f32 v106, v108, v109
  v_cvt_pk_bf16_f32 v107, v110, v111
L_r230:
  v_mfma_f32_16x16x32_bf16 v[112:115], a[72:75], v[88:91], v[112:115]
L_r231:
  v_mfma_f32_16x16x32_bf16 v[84:87], a[76:79], v[88:91], 0
L_r232:
  v_mfma_f32_16x16x32_bf16 v[84:87], a[88:91], v[92:95], v[84:87]
L_r233:
  v_mfma_f32_16x16x32_bf16 v[84:87], a[100:103], v[116:119], v[84:87]
  v_cvt_pk_bf16_f32 v128, v112, v113
  v_cvt_pk_bf16_f32 v129, v114, v115
L_r234:
  v_mfma_f32_16x16x32_bf16 v[84:87], a[112:115], v[96:99], v[84:87]
L_r235:
  v_mfma_f32_16x16x32_bf16 v[84:87], a[124:127], v[136:139], v[84:87]
L_r236:
  v_mfma_f32_16x16x32_bf16 v[84:87], a[136:139], v[80:83], v[84:87]
L_r237:
  v_mfma_f32_16x16x32_bf16 v[108:111], a[140:143], v[80:83], 0
L_r238:
  v_mfma_f32_16x16x32_bf16 v[108:111], a[128:131], v[136:139], v[108:111]
L_r239:
  v_mfma_f32_16x16x32_bf16 v[108:111], a[116:119], v[96:99], v[108:111]
  v_cvt_pk_bf16_f32 v130, v84, v85
  v_cvt_pk_bf16_f32 v131, v86, v87
L_r240:
  v_mfma_f32_16x16x32_bf16 v[108:111], a[104:107], v[116:119], v[108:111]
L_r241:
  v_mfma_f32_16x16x32_bf16 v[108:111], a[92:95], v[92:95], v[108:111]
L_r242:
  v_mfma_f32_16x16x32_bf16 v[108:111], a[80:83], v[88:91], v[108:111]
L_r243:
  v_mfma_f32_16x16x32_bf16 v[84:87], v[88:91], a[144:147], 0
L_r244:
  v_mfma_f32_16x16x32_bf16 v[84:87], v[92:95], a[156:159], v[84:87]
L_r245:
  v_mfma_f32_16x16x32_bf16 v[84:87], v[116:119], a[168:171], v[84:87]
  v_cvt_pk_bf16_f32 v132, v108, v109
  v_cvt_pk_bf16_f32 v133, v110, v111
L_r246:
  v_mfma_f32_16x16x32_bf16 v[84:87], v[96:99], a[180:183], v[84:87]
  ds_read_b128 a[244:247], v1 offset:22528
L_r247:
  v_mfma_f32_16x16x32_bf16 v[84:87], v[136:139], a[192:195], v[84:87]
  ds_read_b128 a[248:251], v0 offset:22528
L_r248:
  v_mfma_f32_16x16x32_bf16 v[84:87], v[80:83], a[204:207], v[84:87]
  ds_read_b128 a[252:255], v1 offset:14336
L_r249:
  v_mfma_f32_16x16x32_bf16 v[140:143], v[80:83], a[208:211], 0
  ds_read_b128 v[144:147], v0 offset:14336
L_r250:
  v_mfma_f32_16x16x32_bf16 v[140:143], v[136:139], a[196:199], v[140:143]
  ds_read_b128 v[148:151], v1 offset:6144
L_r251:
  v_mfma_f32_16x16x32_bf16 v[140:143], v[96:99], a[184:187], v[140:143]
  v_cvt_pk_bf16_f32 v108, v84, v85
  v_cvt_pk_bf16_f32 v109, v86, v87
L_r252:
  v_mfma_f32_16x16x32_bf16 v[140:143], v[116:119], a[172:175], v[140:143]
  ds_read_b128 v[152:155], v0 offset:6144
L_r253:
  v_mfma_f32_16x16x32_bf16 v[140:143], v[92:95], a[160:163], v[140:143]
L_r254:
  v_mfma_f32_16x16x32_bf16 v[140:143], v[88:91], a[148:151], v[140:143]
L_r255:
  v_mfma_f32_16x16x32_bf16 v[156:159], v[88:91], a[152:155], 0
L_r256:
  v_mfma_f32_16x16x32_bf16 v[156:159], v[92:95], a[164:167], v[156:159]
L_r257:
  v_mfma_f32_16x16x32_bf16 v[156:159], v[116:119], a[176:179], v[156:159]
  v_cvt_pk_bf16_f32 v112, v140, v141
  v_cvt_pk_bf16_f32 v113, v142, v143
L_r258:
  v_mfma_f32_16x16x32_bf16 v[156:159], v[96:99], a[188:191], v[156:159]
L_r259:
  v_mfma_f32_16x16x32_bf16 v[156:159], v[136:139], a[200:203], v[156:159]
  buffer_load_dwordx2 v[52:53], v11, s[20:23], s44 offen sc1
  v_mfma_f32_16x16x32_bf16 v[156:159], v[80:83], a[212:215], v[156:159]
  s_waitcnt lgkmcnt(0)
  v_mfma_f32_16x16x32_bf16 v[84:87], a[132:135], a[244:247], 0
  v_mfma_f32_16x16x32_bf16 v[84:87], a[120:123], a[248:251], v[84:87]
  v_mfma_f32_16x16x32_bf16 v[84:87], a[108:111], a[252:255], v[84:87]
  v_cvt_pk_bf16_f32 v116, v156, v157
  v_cvt_pk_bf16_f32 v117, v158, v159
  v_mfma_f32_16x16x32_bf16 v[84:87], a[96:99], v[144:147], v[84:87]
  v_mfma_f32_16x16x32_bf16 v[84:87], a[84:87], v[148:151], v[84:87]
  s_waitcnt vmcnt(31)
  s_barrier
  v_mfma_f32_16x16x32_bf16 v[84:87], a[72:75], v[152:155], v[84:87]
  v_add_u32 v0, s28, v2
  v_xor_b32 v1, 64, v0
  v_mfma_f32_16x16x32_bf16 v[80:83], a[76:79], v[152:155], 0
  v_mfma_f32_16x16x32_bf16 v[80:83], a[88:91], v[148:151], v[80:83]
  v_mfma_f32_16x16x32_bf16 v[80:83], a[100:103], v[144:147], v[80:83]
  v_cvt_pk_bf16_f32 v136, v84, v85
  v_cvt_pk_bf16_f32 v137, v86, v87
  v_mfma_f32_16x16x32_bf16 v[80:83], a[112:115], a[252:255], v[80:83]
  v_mfma_f32_16x16x32_bf16 v[80:83], a[124:127], a[248:251], v[80:83]
  v_mfma_f32_16x16x32_bf16 v[80:83], a[136:139], a[244:247], v[80:83]
  v_mfma_f32_16x16x32_bf16 v[84:87], a[140:143], a[244:247], 0
  v_mfma_f32_16x16x32_bf16 v[84:87], a[128:131], a[248:251], v[84:87]
  v_mfma_f32_16x16x32_bf16 v[84:87], a[116:119], a[252:255], v[84:87]
  v_cvt_pk_bf16_f32 v138, v80, v81
  v_cvt_pk_bf16_f32 v139, v82, v83
  v_mfma_f32_16x16x32_bf16 v[84:87], a[104:107], v[144:147], v[84:87]
  v_mfma_f32_16x16x32_bf16 v[84:87], a[92:95], v[148:151], v[84:87]
  v_mfma_f32_16x16x32_bf16 v[84:87], a[80:83], v[152:155], v[84:87]
  v_mfma_f32_16x16x32_bf16 v[92:95], v[70:73], v[76:79], v[36:39]
  v_mfma_f32_16x16x32_bf16 v[92:95], v[68:71], v[12:15], v[92:95]
  v_mfma_f32_16x16x32_bf16 v[96:99], v[122:125], v[76:79], v[32:35]
  v_cvt_pk_bf16_f32 v140, v84, v85
  v_cvt_pk_bf16_f32 v141, v86, v87
  v_mfma_f32_16x16x32_bf16 v[96:99], v[120:123], v[12:15], v[96:99]
  v_mfma_f32_16x16x32_bf16 v[172:175], v[130:133], v[76:79], v[28:31]
  v_exp_f32 v92, v92
  v_mfma_f32_16x16x32_bf16 v[172:175], v[128:131], v[12:15], v[172:175]
  v_exp_f32 v93, v93
  v_mfma_f32_16x16x32_bf16 v[176:179], v[138:141], v[76:79], v[24:27]
  v_exp_f32 v94, v94
  v_mfma_f32_16x16x32_bf16 v[176:179], v[136:139], v[12:15], v[176:179]
  v_exp_f32 v95, v95
  v_mfma_f32_16x16x32_bf16 v[84:87], v[68:71], v[100:103], v[40:43]
  v_exp_f32 v96, v96
  v_mfma_f32_16x16x32_bf16 v[84:87], v[70:73], v[14:17], v[84:87]
  v_exp_f32 v97, v97
  v_mfma_f32_16x16x32_bf16 v[88:91], v[120:123], v[100:103], v[36:39]
  v_exp_f32 v98, v98
  v_mfma_f32_16x16x32_bf16 v[88:91], v[122:125], v[14:17], v[88:91]
  v_exp_f32 v99, v99
  v_mfma_f32_16x16x32_bf16 v[168:171], v[128:131], v[100:103], v[32:35]
  v_exp_f32 v172, v172
  v_mfma_f32_16x16x32_bf16 v[168:171], v[130:133], v[14:17], v[168:171]
  v_exp_f32 v173, v173
  v_mfma_f32_16x16x32_bf16 v[164:167], v[136:139], v[100:103], v[28:31]
  v_exp_f32 v174, v174
  v_mfma_f32_16x16x32_bf16 v[164:167], v[138:141], v[14:17], v[164:167]
  v_exp_f32 v175, v175
  v_mfma_f32_16x16x32_bf16 v[76:79], v[130:133], v[104:107], v[36:39]
  v_exp_f32 v176, v176
  v_mfma_f32_16x16x32_bf16 v[76:79], v[128:131], v[18:21], v[76:79]
  v_exp_f32 v177, v177
  v_mfma_f32_16x16x32_bf16 v[80:83], v[138:141], v[104:107], v[32:35]
  v_exp_f32 v178, v178
  v_mfma_f32_16x16x32_bf16 v[80:83], v[136:139], v[18:21], v[80:83]
  v_exp_f32 v179, v179
  v_mfma_f32_16x16x32_bf16 v[160:163], v[70:73], v[104:107], v[44:47]
  v_cvt_pk_bf16_f32 v92, v92, v93
  v_cvt_pk_bf16_f32 v93, v94, v95
  v_mfma_f32_16x16x32_bf16 v[160:163], v[68:71], v[18:21], v[160:163]
  v_cvt_pk_bf16_f32 v94, v96, v97
  v_cvt_pk_bf16_f32 v95, v98, v99
  v_mfma_f32_16x16x32_bf16 v[156:159], v[122:125], v[104:107], v[40:43]
  v_cvt_pk_bf16_f32 v96, v172, v173
  v_cvt_pk_bf16_f32 v97, v174, v175
  v_mfma_f32_16x16x32_bf16 v[156:159], v[120:123], v[18:21], v[156:159]
  v_cvt_pk_bf16_f32 v98, v176, v177
  v_cvt_pk_bf16_f32 v99, v178, v179
  v_mfma_f32_16x16x32_bf16 v[180:183], a[0:3], v[152:155], 0
  v_exp_f32 v84, v84
  v_mfma_f32_16x16x32_bf16 v[180:183], a[12:15], v[148:151], v[180:183]
  v_exp_f32 v85, v85
  v_mfma_f32_16x16x32_bf16 v[180:183], a[24:27], v[144:147], v[180:183]
  v_exp_f32 v86, v86
  v_mfma_f32_16x16x32_bf16 v[180:183], a[36:39], a[252:255], v[180:183]
  v_exp_f32 v87, v87
  v_mfma_f32_16x16x32_bf16 v[180:183], a[48:51], a[248:251], v[180:183]
  v_exp_f32 v88, v88
  v_mfma_f32_16x16x32_bf16 v[180:183], a[60:63], a[244:247], v[180:183]
  v_exp_f32 v89, v89
  v_mfma_f32_16x16x32_bf16 v[100:103], a[64:67], a[244:247], 0
  v_exp_f32 v90, v90
  v_mfma_f32_16x16x32_bf16 v[100:103], a[52:55], a[248:251], v[100:103]
  v_exp_f32 v91, v91
  v_mfma_f32_16x16x32_bf16 v[100:103], a[40:43], a[252:255], v[100:103]
  v_mul_f32 v180, s42, v180
  v_mul_f32 v181, s42, v181
  v_mfma_f32_16x16x32_bf16 v[100:103], a[28:31], v[144:147], v[100:103]
  v_mul_f32 v182, s42, v182
  v_mul_f32 v183, s42, v183
  v_mfma_f32_16x16x32_bf16 v[100:103], a[16:19], v[148:151], v[100:103]
  v_cvt_pk_bf16_f32 v172, v180, v181
  v_cvt_pk_bf16_f32 v173, v182, v183
  v_mfma_f32_16x16x32_bf16 v[100:103], a[4:7], v[152:155], v[100:103]
  v_exp_f32 v168, v168
  v_mfma_f32_16x16x32_bf16 v[104:107], a[8:11], v[152:155], 0
  v_exp_f32 v169, v169
  v_mfma_f32_16x16x32_bf16 v[104:107], a[20:23], v[148:151], v[104:107]
  v_exp_f32 v170, v170
  v_mfma_f32_16x16x32_bf16 v[104:107], a[32:35], v[144:147], v[104:107]
  v_mul_f32 v100, s42, v100
  v_mul_f32 v101, s42, v101
  v_mfma_f32_16x16x32_bf16 v[104:107], a[44:47], a[252:255], v[104:107]
  v_mul_f32 v102, s42, v102
  v_mul_f32 v103, s42, v103
  v_mfma_f32_16x16x32_bf16 v[104:107], a[56:59], a[248:251], v[104:107]
  v_cvt_pk_bf16_f32 v174, v100, v101
  v_cvt_pk_bf16_f32 v175, v102, v103
  v_mfma_f32_16x16x32_bf16 v[104:107], a[68:71], a[244:247], v[104:107]
  v_exp_f32 v171, v171
  v_mfma_f32_16x16x32_bf16 v[176:179], v[152:155], a[144:147], 0
  v_exp_f32 v164, v164
  v_mfma_f32_16x16x32_bf16 v[176:179], v[148:151], a[156:159], v[176:179]
  v_exp_f32 v165, v165
  v_mfma_f32_16x16x32_bf16 v[176:179], v[144:147], a[168:171], v[176:179]
  v_mul_f32 v104, s42, v104
  v_mul_f32 v105, s42, v105
  v_mfma_f32_16x16x32_bf16 v[176:179], a[252:255], a[180:183], v[176:179]
  v_mul_f32 v106, s42, v106
  v_mul_f32 v107, s42, v107
  v_mfma_f32_16x16x32_bf16 v[176:179], a[248:251], a[192:195], v[176:179]
  v_cvt_pk_bf16_f32 v22, v104, v105
  v_cvt_pk_bf16_f32 v23, v106, v107
  v_mfma_f32_16x16x32_bf16 v[176:179], a[244:247], a[204:207], v[176:179]
  v_exp_f32 v166, v166
  v_mfma_f32_16x16x32_bf16 v[100:103], v[128:131], v[172:175], v[40:43]
  v_exp_f32 v167, v167
  v_mfma_f32_16x16x32_bf16 v[100:103], v[130:133], v[20:23], v[100:103]
  v_cvt_pk_bf16_f32 v84, v84, v85
  v_cvt_pk_bf16_f32 v85, v86, v87
  v_mfma_f32_16x16x32_bf16 v[104:107], v[136:139], v[172:175], v[36:39]
  v_cvt_pk_bf16_f32 v110, v176, v177
  v_cvt_pk_bf16_f32 v111, v178, v179
  v_mfma_f32_16x16x32_bf16 v[104:107], v[138:141], v[20:23], v[104:107]
  v_cvt_pk_bf16_f32 v86, v88, v89
  v_cvt_pk_bf16_f32 v87, v90, v91
  v_mfma_f32_16x16x32_bf16 v[132:135], v[68:71], v[172:175], v[48:51]
  ds_read_b128 v[136:139], v3 offset:0
  v_cvt_pk_bf16_f32 v88, v168, v169
  v_mfma_f32_16x16x32_bf16 v[132:135], v[70:73], v[20:23], v[132:135]
  ds_read_b128 v[140:143], v3 offset:4096
  v_cvt_pk_bf16_f32 v89, v170, v171
  v_mfma_f32_16x16x32_bf16 v[128:131], v[120:123], v[172:175], v[44:47]
  ds_read_b128 v[68:71], v3 offset:8192
  v_cvt_pk_bf16_f32 v90, v164, v165
  v_mfma_f32_16x16x32_bf16 v[128:131], v[122:125], v[20:23], v[128:131]
  ds_read_b128 v[72:75], v3 offset:12288
  v_cvt_pk_bf16_f32 v91, v166, v167
  v_mfma_f32_16x16x32_bf16 v[168:171], a[244:247], a[208:211], 0
  ds_read_b128 v[120:123], v3 offset:16384
  v_mfma_f32_16x16x32_bf16 v[168:171], a[248:251], a[196:199], v[168:171]
  ds_read_b128 v[124:127], v3 offset:20480
  v_mfma_f32_16x16x32_bf16 v[168:171], a[252:255], a[184:187], v[168:171]
  v_exp_f32 v76, v76
  v_mfma_f32_16x16x32_bf16 v[168:171], v[144:147], a[172:175], v[168:171]
  v_exp_f32 v77, v77
  v_mfma_f32_16x16x32_bf16 v[168:171], v[148:151], a[160:163], v[168:171]
  v_exp_f32 v78, v78
  v_mfma_f32_16x16x32_bf16 v[168:171], v[152:155], a[148:151], v[168:171]
  v_exp_f32 v79, v79
  v_mfma_f32_16x16x32_bf16 v[164:167], v[152:155], a[152:155], 0
  v_exp_f32 v80, v80
  v_mfma_f32_16x16x32_bf16 v[164:167], v[148:151], a[164:167], v[164:167]
  v_exp_f32 v81, v81
  v_mfma_f32_16x16x32_bf16 v[164:167], v[144:147], a[176:179], v[164:167]
  v_cvt_pk_bf16_f32 v114, v168, v169
  v_cvt_pk_bf16_f32 v115, v170, v171
  v_mfma_f32_16x16x32_bf16 v[164:167], a[252:255], a[188:191], v[164:167]
  v_exp_f32 v82, v82
  v_mfma_f32_16x16x32_bf16 v[164:167], a[248:251], a[200:203], v[164:167]
  s_waitcnt lgkmcnt(0)
  v_exp_f32 v83, v83
  v_mfma_f32_16x16x32_bf16 v[164:167], a[244:247], a[212:215], v[164:167]
L_hop_0_1:
  s_cbranch_execz L_hop_0_2
L_mid:
  v_mfma_f32_16x16x32_bf16 v[152:155], v[136:139], v[184:187], 0
  v_exp_f32 v160, v160
  v_mfma_f32_16x16x32_bf16 v[152:155], v[140:143], v[200:203], v[152:155]
  v_exp_f32 v161, v161
  v_mfma_f32_16x16x32_bf16 v[152:155], v[68:71], v[216:219], v[152:155]
  v_cvt_pk_bf16_f32 v118, v164, v165
  v_cvt_pk_bf16_f32 v119, v166, v167
  v_mfma_f32_16x16x32_bf16 v[152:155], v[72:75], v[232:235], v[152:155]
  v_exp_f32 v162, v162
  v_mfma_f32_16x16x32_bf16 v[152:155], v[120:123], v[248:251], v[152:155]
  v_exp_f32 v163, v163
  v_mfma_f32_16x16x32_bf16 v[152:155], v[124:127], a[224:227], v[152:155]
  v_exp_f32 v156, v156
  v_mfma_f32_16x16x32_bf16 v[148:151], v[124:127], a[228:231], 0
  v_exp_f32 v157, v157
  v_mfma_f32_16x16x32_bf16 v[148:151], v[120:123], v[252:255], v[148:151]
  v_exp_f32 v158, v158
  v_mfma_f32_16x16x32_bf16 v[148:151], v[72:75], v[236:239], v[148:151]
  ds_read_b128 v[164:167], v4 offset:0
  v_cvt_pk_bf16_f32 v76, v76, v77
  v_mfma_f32_16x16x32_bf16 v[148:151], v[68:71], v[220:223], v[148:151]
  ds_read_b128 v[168:171], v4 offset:4096
  v_cvt_pk_bf16_f32 v77, v78, v79
  v_mfma_f32_16x16x32_bf16 v[148:151], v[140:143], v[204:207], v[148:151]
  ds_read_b128 v[172:175], v4 offset:8192
  v_cvt_pk_bf16_f32 v78, v80, v81
  v_mfma_f32_16x16x32_bf16 v[148:151], v[136:139], v[188:191], v[148:151]
  ds_read_b128 v[176:179], v4 offset:12288
  v_cvt_pk_bf16_f32 v79, v82, v83
  v_mfma_f32_16x16x32_bf16 v[180:183], v[136:139], v[192:195], 0
  ds_read_b128 a[244:247], v4 offset:16384
  v_cvt_pk_bf16_f32 v80, v160, v161
  v_mfma_f32_16x16x32_bf16 v[180:183], v[140:143], v[208:211], v[180:183]
  ds_read_b128 v[144:147], v4 offset:20480
  v_cvt_pk_bf16_f32 v81, v162, v163
  v_mfma_f32_16x16x32_bf16 v[180:183], v[68:71], v[224:227], v[180:183]
  v_cvt_pk_bf16_f32 v152, v152, v148
  v_cvt_pk_bf16_f32 v153, v153, v149
  v_mfma_f32_16x16x32_bf16 v[180:183], v[72:75], v[240:243], v[180:183]
  v_cvt_pk_bf16_f32 v154, v154, v150
  v_cvt_pk_bf16_f32 v155, v155, v151
  v_mfma_f32_16x16x32_bf16 v[180:183], v[120:123], a[216:219], v[180:183]
  buffer_store_dword v152, v7, s[24:27], s33 offen offset:0 nt
  v_mfma_f32_16x16x32_bf16 v[180:183], v[124:127], a[232:235], v[180:183]
  v_exp_f32 v159, v159
  v_mfma_f32_16x16x32_bf16 v[160:163], v[124:127], a[236:239], 0
  v_cvt_pk_bf16_f32 v82, v156, v157
  v_cvt_pk_bf16_f32 v83, v158, v159
  v_mfma_f32_16x16x32_bf16 v[160:163], v[120:123], a[220:223], v[160:163]
  buffer_store_dword v153, v7, s[24:27], s33 offen offset:384 nt
  v_mfma_f32_16x16x32_bf16 v[160:163], v[72:75], v[244:247], v[160:163]
  ds_read_b128 v[156:159], v3 offset:512
  v_mfma_f32_16x16x32_bf16 v[160:163], v[68:71], v[228:231], v[160:163]
  ds_read_b128 a[248:251], v3 offset:4608
  v_mfma_f32_16x16x32_bf16 v[160:163], v[140:143], v[212:215], v[160:163]
  buffer_store_dword v154, v7, s[24:27], s33 offen offset:768 nt
  v_mfma_f32_16x16x32_bf16 v[160:163], v[136:139], v[196:199], v[160:163]
  s_waitcnt lgkmcnt(2)
  ds_read_b128 a[252:255], v3 offset:8704
  v_mfma_f32_16x16x32_bf16 v[124:127], v[164:167], v[184:187], 0
  ds_read_b128 v[68:71], v3 offset:12800
  v_mfma_f32_16x16x32_bf16 v[124:127], v[168:171], v[200:203], v[124:127]
  buffer_store_dword v155, v7, s[24:27], s33 offen offset:1152 nt
  v_mfma_f32_16x16x32_bf16 v[124:127], v[172:175], v[216:219], v[124:127]
  v_cvt_pk_bf16_f32 v180, v180, v160
  v_cvt_pk_bf16_f32 v181, v181, v161
  v_mfma_f32_16x16x32_bf16 v[124:127], v[176:179], v[232:235], v[124:127]
  v_cvt_pk_bf16_f32 v182, v182, v162
  v_cvt_pk_bf16_f32 v183, v183, v163
  v_mfma_f32_16x16x32_bf16 v[124:127], a[244:247], v[248:251], v[124:127]
  buffer_store_dword v180, v8, s[24:27], s33 offen offset:0 nt
  v_mfma_f32_16x16x32_bf16 v[124:127], v[144:147], a[224:227], v[124:127]
  ds_read_b128 v[72:75], v3 offset:16896
  v_mfma_f32_16x16x32_bf16 v[120:123], v[144:147], a[228:231], 0
  ds_read_b128 v[140:143], v3 offset:20992
  v_xor_b32 v3, 40960, v3
  v_mfma_f32_16x16x32_bf16 v[120:123], a[244:247], v[252:255], v[120:123]
  buffer_store_dword v181, v8, s[24:27], s33 offen offset:384 nt
  v_mfma_f32_16x16x32_bf16 v[120:123], v[176:179], v[236:239], v[120:123]
  v_exp_f32 v100, v100
  v_mfma_f32_16x16x32_bf16 v[120:123], v[172:175], v[220:223], v[120:123]
  v_exp_f32 v101, v101
  v_mfma_f32_16x16x32_bf16 v[120:123], v[168:171], v[204:207], v[120:123]
  buffer_store_dword v182, v8, s[24:27], s33 offen offset:768 nt
  v_mfma_f32_16x16x32_bf16 v[120:123], v[164:167], v[188:191], v[120:123]
  s_waitcnt lgkmcnt(0)
  v_exp_f32 v102, v102
  v_mfma_f32_16x16x32_bf16 v[136:139], v[156:159], v[184:187], 0
  v_exp_f32 v103, v103
  v_mfma_f32_16x16x32_bf16 v[136:139], a[248:251], v[200:203], v[136:139]
  buffer_store_dword v183, v8, s[24:27], s33 offen offset:1152 nt
  v_mfma_f32_16x16x32_bf16 v[136:139], a[252:255], v[216:219], v[136:139]
  v_cvt_pk_bf16_f32 v124, v124, v120
  v_cvt_pk_bf16_f32 v125, v125, v121
  v_mfma_f32_16x16x32_bf16 v[136:139], v[68:71], v[232:235], v[136:139]
  v_cvt_pk_bf16_f32 v126, v126, v122
  v_cvt_pk_bf16_f32 v127, v127, v123
  v_mfma_f32_16x16x32_bf16 v[136:139], v[72:75], v[248:251], v[136:139]
  buffer_store_dword v124, v7, s[24:27], s34 offen offset:0 nt
  v_mfma_f32_16x16x32_bf16 v[136:139], v[140:143], a[224:227], v[136:139]
  v_exp_f32 v104, v104
  v_mfma_f32_16x16x32_bf16 v[160:163], v[140:143], a[228:231], 0
  v_exp_f32 v105, v105
  v_mfma_f32_16x16x32_bf16 v[160:163], v[72:75], v[252:255], v[160:163]
  buffer_store_dword v125, v7, s[24:27], s34 offen offset:384 nt
  v_mfma_f32_16x16x32_bf16 v[160:163], v[68:71], v[236:239], v[160:163]
  ds_read_b128 v[120:123], v4 offset:512
  v_cvt_pk_bf16_f32 v100, v100, v101
  v_mfma_f32_16x16x32_bf16 v[160:163], a[252:255], v[220:223], v[160:163]
  ds_read_b128 v[144:147], v4 offset:4608
  v_cvt_pk_bf16_f32 v101, v102, v103
  v_mfma_f32_16x16x32_bf16 v[160:163], a[248:251], v[204:207], v[160:163]
  buffer_store_dword v126, v7, s[24:27], s34 offen offset:768 nt
  v_mfma_f32_16x16x32_bf16 v[160:163], v[156:159], v[188:191], v[160:163]
  ds_read_b128 v[152:155], v4 offset:8704
  v_cvt_pk_bf16_f32 v102, v104, v105
  v_mfma_f32_16x16x32_bf16 v[148:151], v[156:159], v[192:195], 0
  ds_read_b128 a[244:247], v4 offset:12800
  v_mfma_f32_16x16x32_bf16 v[148:151], a[248:251], v[208:211], v[148:151]
  buffer_store_dword v127, v7, s[24:27], s34 offen offset:1152 nt
  v_mfma_f32_16x16x32_bf16 v[148:151], a[252:255], v[224:227], v[148:151]
  v_cvt_pk_bf16_f32 v136, v136, v160
  v_cvt_pk_bf16_f32 v137, v137, v161
  v_mfma_f32_16x16x32_bf16 v[148:151], v[68:71], v[240:243], v[148:151]
  v_cvt_pk_bf16_f32 v138, v138, v162
  v_cvt_pk_bf16_f32 v139, v139, v163
  v_mfma_f32_16x16x32_bf16 v[148:151], v[72:75], a[216:219], v[148:151]
  buffer_store_dword v136, v7, s[24:27], s35 offen offset:0 nt
  v_mfma_f32_16x16x32_bf16 v[148:151], v[140:143], a[232:235], v[148:151]
  ds_read_b128 v[124:127], v4 offset:16896
  v_mfma_f32_16x16x32_bf16 v[164:167], v[140:143], a[236:239], 0
  ds_read_b128 v[160:163], v4 offset:20992
  v_xor_b32 v4, 40960, v4
  v_mfma_f32_16x16x32_bf16 v[164:167], v[72:75], a[220:223], v[164:167]
  buffer_store_dword v137, v7, s[24:27], s35 offen offset:384 nt
  v_mfma_f32_16x16x32_bf16 v[164:167], v[68:71], v[244:247], v[164:167]
  v_exp_f32 v106, v106
  v_mfma_f32_16x16x32_bf16 v[164:167], a[252:255], v[228:231], v[164:167]
  v_exp_f32 v107, v107
  v_mfma_f32_16x16x32_bf16 v[164:167], a[248:251], v[212:215], v[164:167]
  buffer_store_dword v138, v7, s[24:27], s35 offen offset:768 nt
  v_mfma_f32_16x16x32_bf16 v[164:167], v[156:159], v[196:199], v[164:167]
  s_waitcnt lgkmcnt(0)
  v_exp_f32 v132, v132
  v_mfma_f32_16x16x32_bf16 v[140:143], v[120:123], v[184:187], 0
  v_exp_f32 v133, v133
  v_mfma_f32_16x16x32_bf16 v[140:143], v[144:147], v[200:203], v[140:143]
  buffer_store_dword v139, v7, s[24:27], s35 offen offset:1152 nt
  v_mfma_f32_16x16x32_bf16 v[140:143], v[152:155], v[216:219], v[140:143]
  v_cvt_pk_bf16_f32 v148, v148, v164
  v_cvt_pk_bf16_f32 v149, v149, v165
  v_mfma_f32_16x16x32_bf16 v[140:143], a[244:247], v[232:235], v[140:143]
  v_cvt_pk_bf16_f32 v150, v150, v166
  v_cvt_pk_bf16_f32 v151, v151, v167
  v_mfma_f32_16x16x32_bf16 v[140:143], v[124:127], v[248:251], v[140:143]
  buffer_store_dword v148, v8, s[24:27], s35 offen offset:0 nt
  v_mfma_f32_16x16x32_bf16 v[140:143], v[160:163], a[224:227], v[140:143]
  v_mov_b64 v[172:173], 0
  v_cvt_pk_bf16_f32 v103, v106, v107
  v_mfma_f32_16x16x32_bf16 v[136:139], v[160:163], a[228:231], 0
  v_exp_f32 v134, v134
  v_mfma_f32_16x16x32_bf16 v[136:139], v[124:127], v[252:255], v[136:139]
  buffer_store_dword v149, v8, s[24:27], s35 offen offset:384 nt
  v_mfma_f32_16x16x32_bf16 v[136:139], a[244:247], v[236:239], v[136:139]
  v_exp_f32 v135, v135
  v_mfma_f32_16x16x32_bf16 v[136:139], v[152:155], v[220:223], v[136:139]
  v_mov_b64 v[72:73], 0
  v_cvt_pk_bf16_f32 v104, v132, v133
  v_mfma_f32_16x16x32_bf16 v[136:139], v[144:147], v[204:207], v[136:139]
  buffer_store_dword v150, v8, s[24:27], s35 offen offset:768 nt
  v_mfma_f32_16x16x32_bf16 v[136:139], v[120:123], v[188:191], v[136:139]
  v_exp_f32 v128, v128
  v_smfmac_f32_16x16x64_bf16 v[172:175], a[240:243], v[92:99], v10
  v_exp_f32 v129, v129
  v_mfma_f32_16x16x32_bf16 v[176:179], v[108:111], v[96:99], 0
  buffer_store_dword v151, v8, s[24:27], s35 offen offset:1152 nt
  v_mfma_f32_16x16x32_bf16 v[176:179], v[56:59], v[92:95], v[176:179]
  v_cvt_pk_bf16_f32 v140, v140, v136
  v_cvt_pk_bf16_f32 v141, v141, v137
  v_mfma_f32_16x16x32_bf16 v[168:171], v[60:63], v[92:95], 0
  v_cvt_pk_bf16_f32 v142, v142, v138
  v_cvt_pk_bf16_f32 v143, v143, v139
  v_mfma_f32_16x16x32_bf16 v[168:171], v[112:115], v[96:99], v[168:171]
  buffer_store_dword v140, v7, s[24:27], s36 offen offset:0 nt
  v_mfma_f32_16x16x32_bf16 v[68:71], v[116:119], v[96:99], 0
  v_mov_b64 v[124:125], 0
  v_cvt_pk_bf16_f32 v105, v134, v135
  v_mfma_f32_16x16x32_bf16 v[68:71], v[64:67], v[92:95], v[68:71]
  v_exp_f32 v130, v130
  v_smfmac_f32_16x16x64_bf16 v[72:75], a[240:243], v[84:91], v10
  buffer_store_dword v141, v7, s[24:27], s36 offen offset:384 nt
  v_mfma_f32_16x16x32_bf16 v[164:167], v[108:111], v[88:91], 0
  v_exp_f32 v131, v131
  v_mfma_f32_16x16x32_bf16 v[164:167], v[56:59], v[84:87], v[164:167]
  v_cvt_pk_bf16_f32 v106, v128, v129
  v_cvt_pk_bf16_f32 v107, v130, v131
  v_mfma_f32_16x16x32_bf16 v[144:147], v[60:63], v[84:87], 0
  buffer_store_dword v142, v7, s[24:27], s36 offen offset:768 nt
  v_mfma_f32_16x16x32_bf16 v[144:147], v[112:115], v[88:91], v[144:147]
  v_mov_b64 v[92:93], 0
  v_add_f32 v172, v172, v173
  v_mfma_f32_16x16x32_bf16 v[132:135], v[116:119], v[88:91], 0
  ds_read_b128 v[136:139], v0 offset:0
  v_add_f32 v72, v72, v73
  v_mfma_f32_16x16x32_bf16 v[132:135], v[64:67], v[84:87], v[132:135]
  buffer_store_dword v143, v7, s[24:27], s36 offen offset:1152 nt
  v_smfmac_f32_16x16x64_bf16 v[124:127], a[240:243], v[76:83], v10
  ds_read_b128 v[152:155], v1 offset:0
  v_cndmask_b32 v7, v7, v52, s[62:63]
  v_mfma_f32_16x16x32_bf16 v[128:131], v[56:59], v[80:83], 0
  ds_read_b128 v[156:159], v0 offset:8192
  v_cndmask_b32 v8, v8, v53, s[62:63]
  v_mfma_f32_16x16x32_bf16 v[128:131], v[108:111], v[76:79], v[128:131]
  s_mov_b64 s[62:63], 0
  ds_read_b128 v[160:163], v1 offset:8192
  v_mfma_f32_16x16x32_bf16 v[120:123], v[112:115], v[76:79], 0
  ds_read_b128 v[148:151], v0 offset:16384
  v_mfma_f32_16x16x32_bf16 v[120:123], v[60:63], v[80:83], v[120:123]
  ds_read_b128 v[140:143], v1 offset:16384
  v_mfma_f32_16x16x32_bf16 v[96:99], v[64:67], v[80:83], 0
  v_rcp_f32 v174, v172
  v_mfma_f32_16x16x32_bf16 v[96:99], v[116:119], v[76:79], v[96:99]
  v_mul_f32 v176, v174, v176
  v_mul_f32 v177, v174, v177
  v_smfmac_f32_16x16x64_bf16 v[92:95], a[240:243], v[100:107], v10
  v_mul_f32 v178, v174, v178
  v_mul_f32 v179, v174, v179
  v_mfma_f32_16x16x32_bf16 v[88:91], v[56:59], v[104:107], 0
  v_cvt_pk_bf16_f32 v176, v176, v177
  v_cvt_pk_bf16_f32 v177, v178, v179
  v_mfma_f32_16x16x32_bf16 v[88:91], v[108:111], v[100:103], v[88:91]
  v_mul_f32 v168, v174, v168
  v_mul_f32 v169, v174, v169
  v_mfma_f32_16x16x32_bf16 v[80:83], v[112:115], v[100:103], 0
  v_mul_f32 v170, v174, v170
  v_mul_f32 v171, v174, v171
  v_mfma_f32_16x16x32_bf16 v[80:83], v[60:63], v[104:107], v[80:83]
  v_cvt_pk_bf16_f32 v168, v168, v169
  v_cvt_pk_bf16_f32 v169, v170, v171
  v_mfma_f32_16x16x32_bf16 v[84:87], v[64:67], v[104:107], 0
  v_mul_f32 v68, v174, v68
  v_mul_f32 v69, v174, v69
  v_mfma_f32_16x16x32_bf16 v[84:87], v[116:119], v[100:103], v[84:87]
  s_waitcnt lgkmcnt(0)
  v_mul_f32 v70, v174, v70
  v_mul_f32 v71, v174, v71
  v_mfma_f32_16x16x32_bf16 v[64:67], a[0:3], v[136:139], 0
  v_cvt_pk_bf16_f32 v68, v68, v69
  v_cvt_pk_bf16_f32 v69, v70, v71
  v_mfma_f32_16x16x32_bf16 v[64:67], a[12:15], v[152:155], v[64:67]
  v_max3_f32 v9, v172, v174, v9
  v_add_f32 v124, v124, v125
  v_mfma_f32_16x16x32_bf16 v[64:67], a[24:27], v[156:159], v[64:67]
  ds_write_b32 v5, v176 offset:0
  v_mfma_f32_16x16x32_bf16 v[64:67], a[36:39], v[160:163], v[64:67]
  v_rcp_f32 v74, v72
  v_mfma_f32_16x16x32_bf16 v[64:67], a[48:51], v[148:151], v[64:67]
  s_add_u32 m0, s30, 0
  v_mul_f32 v164, v74, v164
  v_mul_f32 v165, v74, v165
  v_mfma_f32_16x16x32_bf16 v[64:67], a[60:63], v[140:143], v[64:67]
  buffer_load_dwordx4 v6, s[8:11], s31 offen offset:0 nt lds
  v_mfma_f32_16x16x32_bf16 v[60:63], a[64:67], v[140:143], 0
  v_mul_f32 v166, v74, v166
  v_mul_f32 v167, v74, v167
  v_mfma_f32_16x16x32_bf16 v[60:63], a[52:55], v[148:151], v[60:63]
  ds_write_b32 v5, v177 offset:1024
  v_mfma_f32_16x16x32_bf16 v[60:63], a[40:43], v[160:163], v[60:63]
  v_mul_f32 v64, s42, v64
  v_mul_f32 v65, s42, v65
  v_mfma_f32_16x16x32_bf16 v[60:63], a[28:31], v[156:159], v[60:63]
  v_mul_f32 v66, s42, v66
  v_mul_f32 v67, s42, v67
  v_mfma_f32_16x16x32_bf16 v[60:63], a[16:19], v[152:155], v[60:63]
  v_cvt_pk_bf16_f32 v12, v64, v65
  v_cvt_pk_bf16_f32 v13, v66, v67
  v_mfma_f32_16x16x32_bf16 v[60:63], a[4:7], v[136:139], v[60:63]
  ds_write_b32 v5, v168 offset:2048
  v_mfma_f32_16x16x32_bf16 v[56:59], a[8:11], v[136:139], 0
  v_cvt_pk_bf16_f32 v164, v164, v165
  v_cvt_pk_bf16_f32 v165, v166, v167
  v_mfma_f32_16x16x32_bf16 v[56:59], a[20:23], v[152:155], v[56:59]
  ds_write_b32 v5, v169 offset:3072
  v_mfma_f32_16x16x32_bf16 v[56:59], a[32:35], v[156:159], v[56:59]
  v_mul_f32 v60, s42, v60
  v_mul_f32 v61, s42, v61
  v_mfma_f32_16x16x32_bf16 v[56:59], a[44:47], v[160:163], v[56:59]
  v_mul_f32 v62, s42, v62
  v_mul_f32 v63, s42, v63
  v_mfma_f32_16x16x32_bf16 v[56:59], a[56:59], v[148:151], v[56:59]
  s_add_u32 m0, s30, 8064
  v_cvt_pk_bf16_f32 v76, v60, v61
  v_cvt_pk_bf16_f32 v77, v62, v63
  v_mfma_f32_16x16x32_bf16 v[56:59], a[68:71], v[140:143], v[56:59]
  buffer_load_dwordx4 v6, s[8:11], s31 offen offset:128 nt lds
  v_mfma_f32_16x16x32_bf16 v[64:67], a[132:135], v[140:143], 0
  v_mul_f32 v144, v74, v144
  v_mul_f32 v145, v74, v145
  v_mfma_f32_16x16x32_bf16 v[64:67], a[120:123], v[148:151], v[64:67]
  ds_write_b32 v5, v68 offset:4096
  v_mfma_f32_16x16x32_bf16 v[64:67], a[108:111], v[160:163], v[64:67]
  ds_write_b32 v5, v69 offset:5120
  v_mfma_f32_16x16x32_bf16 v[64:67], a[96:99], v[156:159], v[64:67]
  v_mul_f32 v56, s42, v56
  v_mul_f32 v57, s42, v57
  v_mfma_f32_16x16x32_bf16 v[64:67], a[84:87], v[152:155], v[64:67]
  v_mul_f32 v58, s42, v58
  v_mul_f32 v59, s42, v59
  v_mfma_f32_16x16x32_bf16 v[64:67], a[72:75], v[136:139], v[64:67]
  v_cvt_pk_bf16_f32 v78, v56, v57
  v_cvt_pk_bf16_f32 v79, v58, v59
  v_mfma_f32_16x16x32_bf16 v[60:63], a[76:79], v[136:139], 0
  v_mul_f32 v146, v74, v146
  v_mul_f32 v147, v74, v147
  v_mfma_f32_16x16x32_bf16 v[60:63], a[88:91], v[152:155], v[60:63]
  v_cvt_pk_bf16_f32 v144, v144, v145
  v_cvt_pk_bf16_f32 v145, v146, v147
  v_mfma_f32_16x16x32_bf16 v[60:63], a[100:103], v[156:159], v[60:63]
  v_cvt_pk_bf16_f32 v68, v64, v65
  v_cvt_pk_bf16_f32 v69, v66, v67
  v_mfma_f32_16x16x32_bf16 v[60:63], a[112:115], v[160:163], v[60:63]
  v_mul_f32 v132, v74, v132
  v_mul_f32 v133, v74, v133
  v_mfma_f32_16x16x32_bf16 v[60:63], a[124:127], v[148:151], v[60:63]
  s_add_u32 m0, s30, 16128
  v_mul_f32 v134, v74, v134
  v_mul_f32 v135, v74, v135
  v_mfma_f32_16x16x32_bf16 v[60:63], a[136:139], v[140:143], v[60:63]
  buffer_load_dwordx4 v6, s[8:11], s31 offen offset:256 nt lds
  v_mfma_f32_16x16x32_bf16 v[56:59], a[140:143], v[140:143], 0
  v_cvt_pk_bf16_f32 v132, v132, v133
  v_cvt_pk_bf16_f32 v133, v134, v135
  v_mfma_f32_16x16x32_bf16 v[56:59], a[128:131], v[148:151], v[56:59]
  v_max3_f32 v9, v72, v74, v9
  v_add_f32 v92, v92, v93
  v_mfma_f32_16x16x32_bf16 v[56:59], a[116:119], v[160:163], v[56:59]
  v_cvt_pk_bf16_f32 v70, v60, v61
  v_cvt_pk_bf16_f32 v71, v62, v63
  v_mfma_f32_16x16x32_bf16 v[56:59], a[104:107], v[156:159], v[56:59]
  ds_write_b32 v5, v164 offset:256
  v_mfma_f32_16x16x32_bf16 v[56:59], a[92:95], v[152:155], v[56:59]
  v_rcp_f32 v126, v124
  v_mfma_f32_16x16x32_bf16 v[56:59], a[80:83], v[136:139], v[56:59]
  ds_write_b32 v5, v165 offset:1280
  v_mfma_f32_16x16x32_bf16 v[60:63], v[136:139], a[144:147], 0
  v_mul_f32 v128, v126, v128
  v_mul_f32 v129, v126, v129
  v_mfma_f32_16x16x32_bf16 v[60:63], v[152:155], a[156:159], v[60:63]
  ds_write_b32 v5, v144 offset:2304
  v_mfma_f32_16x16x32_bf16 v[60:63], v[156:159], a[168:171], v[60:63]
  v_cvt_pk_bf16_f32 v72, v56, v57
  v_cvt_pk_bf16_f32 v73, v58, v59
  v_mfma_f32_16x16x32_bf16 v[60:63], v[160:163], a[180:183], v[60:63]
  ds_read_b128 a[244:247], v0 offset:2048
  v_mul_f32 v130, v126, v130
  v_mfma_f32_16x16x32_bf16 v[60:63], v[148:151], a[192:195], v[60:63]
  s_add_u32 m0, s30, 4096
  ds_read_b128 a[248:251], v1 offset:2048
  v_mul_f32 v131, v126, v131
  v_mfma_f32_16x16x32_bf16 v[60:63], v[140:143], a[204:207], v[60:63]
  buffer_load_dwordx4 v6, s[8:11], s32 offen offset:0 nt lds
  v_mfma_f32_16x16x32_bf16 v[64:67], v[140:143], a[208:211], 0
  ds_read_b128 a[252:255], v0 offset:10240
  v_cvt_pk_bf16_f32 v128, v128, v129
  v_mfma_f32_16x16x32_bf16 v[64:67], v[148:151], a[196:199], v[64:67]
  ds_read_b128 v[104:107], v1 offset:10240
  v_cvt_pk_bf16_f32 v129, v130, v131
  v_mfma_f32_16x16x32_bf16 v[64:67], v[160:163], a[184:187], v[64:67]
  v_cvt_pk_bf16_f32 v56, v60, v61
  v_cvt_pk_bf16_f32 v57, v62, v63
  v_mfma_f32_16x16x32_bf16 v[64:67], v[156:159], a[172:175], v[64:67]
  ds_write_b32 v5, v145 offset:3328
  v_mfma_f32_16x16x32_bf16 v[64:67], v[152:155], a[160:163], v[64:67]
  v_mul_f32 v120, v126, v120
  v_mul_f32 v121, v126, v121
  v_mfma_f32_16x16x32_bf16 v[64:67], v[136:139], a[148:151], v[64:67]
  ds_write_b32 v5, v132 offset:4352
  v_mfma_f32_16x16x32_bf16 v[100:103], v[136:139], a[152:155], 0
  ds_write_b32 v5, v133 offset:5376
  v_mfma_f32_16x16x32_bf16 v[100:103], v[152:155], a[164:167], v[100:103]
  v_mul_f32 v122, v126, v122
  v_mul_f32 v123, v126, v123
  v_mfma_f32_16x16x32_bf16 v[100:103], v[156:159], a[176:179], v[100:103]
  ds_read_b128 v[108:111], v0 offset:18432
  v_cvt_pk_bf16_f32 v60, v64, v65
  v_mfma_f32_16x16x32_bf16 v[100:103], v[160:163], a[188:191], v[100:103]
  s_waitcnt lgkmcnt(4)
  ds_read_b128 v[112:115], v1 offset:18432
  v_cvt_pk_bf16_f32 v61, v66, v67
  v_mfma_f32_16x16x32_bf16 v[100:103], v[148:151], a[200:203], v[100:103]
  s_add_u32 m0, s30, 12160
  v_cvt_pk_bf16_f32 v120, v120, v121
  v_cvt_pk_bf16_f32 v121, v122, v123
  v_mfma_f32_16x16x32_bf16 v[100:103], v[140:143], a[212:215], v[100:103]
  buffer_load_dwordx4 v6, s[8:11], s32 offen offset:128 nt lds
  v_mfma_f32_16x16x32_bf16 v[136:139], a[0:3], a[244:247], 0
  v_mul_f32 v96, v126, v96
  v_mul_f32 v97, v126, v97
  v_mfma_f32_16x16x32_bf16 v[136:139], a[12:15], a[248:251], v[136:139]
  v_mul_f32 v98, v126, v98
  v_mul_f32 v99, v126, v99
  v_mfma_f32_16x16x32_bf16 v[136:139], a[24:27], a[252:255], v[136:139]
  v_cvt_pk_bf16_f32 v64, v100, v101
  v_cvt_pk_bf16_f32 v65, v102, v103
  v_mfma_f32_16x16x32_bf16 v[136:139], a[36:39], v[104:107], v[136:139]
  s_waitcnt lgkmcnt(0)
  v_cvt_pk_bf16_f32 v96, v96, v97
  v_cvt_pk_bf16_f32 v97, v98, v99
  v_mfma_f32_16x16x32_bf16 v[136:139], a[48:51], v[108:111], v[136:139]
  v_max3_f32 v9, v124, v126, v9
  v_mfma_f32_16x16x32_bf16 v[136:139], a[60:63], v[112:115], v[136:139]
  ds_write_b32 v5, v128 offset:512
  v_mfma_f32_16x16x32_bf16 v[132:135], a[64:67], v[112:115], 0
  v_rcp_f32 v94, v92
  v_mfma_f32_16x16x32_bf16 v[132:135], a[52:55], v[108:111], v[132:135]
  ds_write_b32 v5, v129 offset:1536
  v_mfma_f32_16x16x32_bf16 v[132:135], a[40:43], v[104:107], v[132:135]
  v_mul_f32 v136, s42, v136
  v_mul_f32 v137, s42, v137
  v_mfma_f32_16x16x32_bf16 v[132:135], a[28:31], a[252:255], v[132:135]
  v_mul_f32 v138, s42, v138
  v_mul_f32 v139, s42, v139
  v_mfma_f32_16x16x32_bf16 v[132:135], a[16:19], a[248:251], v[132:135]
  s_add_u32 m0, s30, 20224
  v_cvt_pk_bf16_f32 v100, v136, v137
  v_cvt_pk_bf16_f32 v101, v138, v139
  v_mfma_f32_16x16x32_bf16 v[132:135], a[4:7], a[244:247], v[132:135]
  buffer_load_dwordx4 v6, s[8:11], s32 offen offset:256 nt lds
  v_mfma_f32_16x16x32_bf16 v[116:119], a[8:11], a[244:247], 0
  s_add_u32 s33, s31, s37
  v_mul_f32 v88, v94, v88
  v_mul_f32 v89, v94, v89
  v_mfma_f32_16x16x32_bf16 v[116:119], a[20:23], a[248:251], v[116:119]
  s_add_u32 s34, s31, s38
  ds_write_b32 v5, v120 offset:2560
  v_mfma_f32_16x16x32_bf16 v[116:119], a[32:35], a[252:255], v[116:119]
  s_add_u32 s35, s31, s39
  v_mul_f32 v132, s42, v132
  v_mul_f32 v133, s42, v133
  v_mfma_f32_16x16x32_bf16 v[116:119], a[44:47], v[104:107], v[116:119]
  s_add_u32 s36, s31, s40
  v_mul_f32 v134, s42, v134
  v_mul_f32 v135, s42, v135
  v_mfma_f32_16x16x32_bf16 v[116:119], a[56:59], v[108:111], v[116:119]
  s_add_u32 s31, s31, s43
  v_cvt_pk_bf16_f32 v102, v132, v133
  v_cvt_pk_bf16_f32 v103, v134, v135
  v_mfma_f32_16x16x32_bf16 v[116:119], a[68:71], v[112:115], v[116:119]
  s_add_u32 s32, s32, s43
  ds_write_b32 v5, v121 offset:3584
  v_mfma_f32_16x16x32_bf16 v[124:127], a[132:135], v[112:115], 0
  s_mov_b32 s5, s28
  v_mul_f32 v90, v94, v90
  v_mul_f32 v91, v94, v91
  v_mfma_f32_16x16x32_bf16 v[124:127], a[120:123], v[108:111], v[124:127]
  s_mov_b32 s28, s29
  ds_write_b32 v5, v96 offset:4608
  v_mfma_f32_16x16x32_bf16 v[124:127], a[108:111], v[104:107], v[124:127]
  s_mov_b32 s29, s30
  v_mul_f32 v116, s42, v116
  v_mul_f32 v117, s42, v117
  v_mfma_f32_16x16x32_bf16 v[124:127], a[96:99], a[252:255], v[124:127]
  s_mov_b32 s30, s5
  ds_write_b32 v5, v97 offset:5632
  v_mfma_f32_16x16x32_bf16 v[124:127], a[84:87], a[248:251], v[124:127]
  v_mul_f32 v118, s42, v118
  v_mul_f32 v119, s42, v119
  v_mfma_f32_16x16x32_bf16 v[124:127], a[72:75], a[244:247], v[124:127]
  v_cvt_pk_bf16_f32 v16, v116, v117
  v_cvt_pk_bf16_f32 v17, v118, v119
  v_mfma_f32_16x16x32_bf16 v[96:99], a[76:79], a[244:247], 0
  v_cvt_pk_bf16_f32 v88, v88, v89
  v_cvt_pk_bf16_f32 v89, v90, v91
  v_mfma_f32_16x16x32_bf16 v[96:99], a[88:91], a[248:251], v[96:99]
  v_mul_f32 v80, v94, v80
  v_mul_f32 v81, v94, v81
  v_mfma_f32_16x16x32_bf16 v[96:99], a[100:103], a[252:255], v[96:99]
  s_add_u32 s59, s59, 1
  v_cvt_pk_bf16_f32 v120, v124, v125
  v_cvt_pk_bf16_f32 v121, v126, v127
  v_mfma_f32_16x16x32_bf16 v[96:99], a[112:115], v[104:107], v[96:99]
  s_cmp_eq_u32 s59, 4
  v_mul_f32 v82, v94, v82
  v_mul_f32 v83, v94, v83
  v_mfma_f32_16x16x32_bf16 v[96:99], a[124:127], v[108:111], v[96:99]
  s_cselect_b32 s18, s16, s18
  v_cvt_pk_bf16_f32 v80, v80, v81
  v_cvt_pk_bf16_f32 v81, v82, v83
  v_mfma_f32_16x16x32_bf16 v[96:99], a[136:139], v[112:115], v[96:99]
  s_cselect_b32 s15, s60, s15
  v_mul_f32 v84, v94, v84
  v_mul_f32 v85, v94, v85
  v_mfma_f32_16x16x32_bf16 v[116:119], a[140:143], v[112:115], 0
  s_cmp_eq_u32 s59, 8
  v_mul_f32 v86, v94, v86
  v_mul_f32 v87, v94, v87
  v_mfma_f32_16x16x32_bf16 v[116:119], a[128:131], v[108:111], v[116:119]
  s_cselect_b32 s19, s16, s19
  v_cvt_pk_bf16_f32 v84, v84, v85
  v_cvt_pk_bf16_f32 v85, v86, v87
  v_mfma_f32_16x16x32_bf16 v[116:119], a[116:119], v[104:107], v[116:119]
  s_cselect_b32 s99, s60, s99
  v_cvt_pk_bf16_f32 v122, v96, v97
  v_cvt_pk_bf16_f32 v123, v98, v99
  v_mfma_f32_16x16x32_bf16 v[116:119], a[104:107], a[252:255], v[116:119]
  s_memrealtime s[16:17]
  v_max3_f32 v9, v92, v94, v9
  v_mfma_f32_16x16x32_bf16 v[116:119], a[92:95], a[248:251], v[116:119]
  s_memtime s[60:61]
  ds_write_b32 v5, v88 offset:768
  v_mfma_f32_16x16x32_bf16 v[116:119], a[80:83], a[244:247], v[116:119]
  v_mfma_f32_16x16x32_bf16 v[132:135], a[244:247], a[144:147], 0
  ds_write_b32 v5, v89 offset:1792
  v_mfma_f32_16x16x32_bf16 v[132:135], a[248:251], a[156:159], v[132:135]
  v_mfma_f32_16x16x32_bf16 v[132:135], a[252:255], a[168:171], v[132:135]
  v_cvt_pk_bf16_f32 v124, v116, v117
  v_cvt_pk_bf16_f32 v125, v118, v119
  v_mfma_f32_16x16x32_bf16 v[132:135], v[104:107], a[180:183], v[132:135]
  ds_read_b128 v[88:91], v0 offset:4096
  v_mfma_f32_16x16x32_bf16 v[132:135], v[108:111], a[192:195], v[132:135]
  ds_read_b128 v[92:95], v1 offset:4096
  v_mfma_f32_16x16x32_bf16 v[132:135], v[112:115], a[204:207], v[132:135]
  ds_read_b128 v[116:119], v0 offset:12288
  v_mfma_f32_16x16x32_bf16 v[128:131], v[112:115], a[208:211], 0
  ds_read_b128 v[96:99], v1 offset:12288
  v_mfma_f32_16x16x32_bf16 v[128:131], v[108:111], a[196:199], v[128:131]
  ds_read_b128 v[136:139], v0 offset:20480
  v_mfma_f32_16x16x32_bf16 v[128:131], v[104:107], a[184:187], v[128:131]
  v_cvt_pk_bf16_f32 v58, v132, v133
  v_cvt_pk_bf16_f32 v59, v134, v135
  v_mfma_f32_16x16x32_bf16 v[128:131], a[252:255], a[172:175], v[128:131]
  ds_write_b32 v5, v80 offset:2816
  v_mfma_f32_16x16x32_bf16 v[128:131], a[248:251], a[160:163], v[128:131]
  v_mfma_f32_16x16x32_bf16 v[128:131], a[244:247], a[148:151], v[128:131]
  ds_write_b32 v5, v81 offset:3840
  v_mfma_f32_16x16x32_bf16 v[132:135], a[244:247], a[152:155], 0
  v_mfma_f32_16x16x32_bf16 v[132:135], a[248:251], a[164:167], v[132:135]
  ds_write_b32 v5, v84 offset:4864
  v_mfma_f32_16x16x32_bf16 v[132:135], a[252:255], a[176:179], v[132:135]
  ds_write_b32 v5, v85 offset:5888
  v_mfma_f32_16x16x32_bf16 v[132:135], v[104:107], a[188:191], v[132:135]
  s_waitcnt lgkmcnt(4)
  v_cvt_pk_bf16_f32 v62, v128, v129
  v_cvt_pk_bf16_f32 v63, v130, v131
  v_mfma_f32_16x16x32_bf16 v[132:135], v[108:111], a[200:203], v[132:135]
  s_bitcmp1_b32 s96, s59
  ds_read_b128 v[80:83], v1 offset:20480
  v_xor_b32 v5, s41, v5
  v_mfma_f32_16x16x32_bf16 v[132:135], v[112:115], a[212:215], v[132:135]
  s_cbranch_scc0 L_loop
L_epi:
  s_cmp_lg_u32 s59, s97
  s_cbranch_scc1 L_k2
L_full:
  v_mfma_f32_16x16x32_bf16 v[104:107], a[76:79], v[88:91], 0
  s_lshl_b32 s5, s3, 3
  v_mfma_f32_16x16x32_bf16 v[104:107], a[88:91], v[92:95], v[104:107]
  s_add_u32 s5, s5, 159744
  v_mov_b32 v11, s5
  v_mfma_f32_16x16x32_bf16 v[104:107], a[100:103], v[116:119], v[104:107]
  v_cvt_pk_bf16_f32 v66, v132, v133
  v_cvt_pk_bf16_f32 v67, v134, v135
  v_mfma_f32_16x16x32_bf16 v[104:107], a[112:115], v[96:99], v[104:107]
  ds_read_b128 a[248:251], v1 offset:22528
  v_mfma_f32_16x16x32_bf16 v[104:107], a[124:127], v[136:139], v[104:107]
  ds_read_b128 a[244:247], v0 offset:22528
  s_waitcnt lgkmcnt(2)
  v_mfma_f32_16x16x32_bf16 v[104:107], a[136:139], v[80:83], v[104:107]
  ds_read_b128 a[252:255], v1 offset:14336
  v_mfma_f32_16x16x32_bf16 v[108:111], a[132:135], v[80:83], 0
  ds_read_b128 v[84:87], v0 offset:14336
  v_mfma_f32_16x16x32_bf16 v[108:111], a[120:123], v[136:139], v[108:111]
  ds_read_b128 v[180:183], v1 offset:6144
  v_mfma_f32_16x16x32_bf16 v[108:111], a[108:111], v[96:99], v[108:111]
  v_cvt_pk_bf16_f32 v150, v104, v105
  v_cvt_pk_bf16_f32 v151, v106, v107
  v_mfma_f32_16x16x32_bf16 v[108:111], a[96:99], v[116:119], v[108:111]
  ds_read_b128 v[164:167], v0 offset:6144
  v_mfma_f32_16x16x32_bf16 v[108:111], a[84:87], v[92:95], v[108:111]
  v_mfma_f32_16x16x32_bf16 v[108:111], a[72:75], v[88:91], v[108:111]
  v_mfma_f32_16x16x32_bf16 v[128:131], a[140:143], v[80:83], 0
  v_mfma_f32_16x16x32_bf16 v[128:131], a[128:131], v[136:139], v[128:131]
  v_mfma_f32_16x16x32_bf16 v[128:131], a[116:119], v[96:99], v[128:131]
  v_cvt_pk_bf16_f32 v148, v108, v109
  v_cvt_pk_bf16_f32 v149, v110, v111
  v_mfma_f32_16x16x32_bf16 v[128:131], a[104:107], v[116:119], v[128:131]
L_hop_1_1:
  s_cbranch_execz L_hop_1_2
  v_mfma_f32_16x16x32_bf16 v[128:131], a[92:95], v[92:95], v[128:131]
  v_mfma_f32_16x16x32_bf16 v[128:131], a[80:83], v[88:91], v[128:131]
  s_waitcnt lgkmcnt(0)
  v_mfma_f32_16x16x32_bf16 v[104:107], a[132:135], a[248:251], 0
  v_mfma_f32_16x16x32_bf16 v[104:107], a[120:123], a[244:247], v[104:107]
  v_mfma_f32_16x16x32_bf16 v[104:107], a[108:111], a[252:255], v[104:107]
  v_cvt_pk_bf16_f32 v152, v128, v129
  v_cvt_pk_bf16_f32 v153, v130, v131
  v_mfma_f32_16x16x32_bf16 v[104:107], a[96:99], v[84:87], v[104:107]
  v_mfma_f32_16x16x32_bf16 v[104:107], a[84:87], v[180:183], v[104:107]
  s_waitcnt lgkmcnt(0)
  s_barrier
  v_mfma_f32_16x16x32_bf16 v[104:107], a[72:75], v[164:167], v[104:107]
  v_mfma_f32_16x16x32_bf16 v[108:111], a[76:79], v[164:167], 0
  v_mfma_f32_16x16x32_bf16 v[108:111], a[88:91], v[180:183], v[108:111]
  v_mfma_f32_16x16x32_bf16 v[108:111], a[100:103], v[84:87], v[108:111]
  v_cvt_pk_bf16_f32 v154, v104, v105
  v_cvt_pk_bf16_f32 v155, v106, v107
  v_mfma_f32_16x16x32_bf16 v[108:111], a[112:115], a[252:255], v[108:111]
  v_mfma_f32_16x16x32_bf16 v[108:111], a[124:127], a[244:247], v[108:111]
  v_mfma_f32_16x16x32_bf16 v[108:111], a[136:139], a[248:251], v[108:111]
  v_mfma_f32_16x16x32_bf16 v[104:107], a[140:143], a[248:251], 0
  v_mfma_f32_16x16x32_bf16 v[104:107], a[128:131], a[244:247], v[104:107]
  v_mfma_f32_16x16x32_bf16 v[104:107], a[116:119], a[252:255], v[104:107]
  v_cvt_pk_bf16_f32 v156, v108, v109
  v_cvt_pk_bf16_f32 v157, v110, v111
  v_mfma_f32_16x16x32_bf16 v[104:107], a[104:107], v[84:87], v[104:107]
  v_mfma_f32_16x16x32_bf16 v[104:107], a[92:95], v[180:183], v[104:107]
  v_mfma_f32_16x16x32_bf16 v[104:107], a[80:83], v[164:167], v[104:107]
  v_mfma_f32_16x16x32_bf16 v[128:131], v[70:73], v[76:79], v[36:39]
  v_mfma_f32_16x16x32_bf16 v[128:131], v[68:71], v[12:15], v[128:131]
  v_mfma_f32_16x16x32_bf16 v[132:135], v[122:125], v[76:79], v[32:35]
  v_cvt_pk_bf16_f32 v158, v104, v105
  v_cvt_pk_bf16_f32 v159, v106, v107
  v_mfma_f32_16x16x32_bf16 v[132:135], v[120:123], v[12:15], v[132:135]
  v_mfma_f32_16x16x32_bf16 v[140:143], v[150:153], v[76:79], v[28:31]
  v_exp_f32 v128, v128
  v_mfma_f32_16x16x32_bf16 v[140:143], v[148:151], v[12:15], v[140:143]
  v_exp_f32 v129, v129
  v_mfma_f32_16x16x32_bf16 v[144:147], v[156:159], v[76:79], v[24:27]
  v_exp_f32 v130, v130
  v_mfma_f32_16x16x32_bf16 v[144:147], v[154:157], v[12:15], v[144:147]
  v_exp_f32 v131, v131
  v_mfma_f32_16x16x32_bf16 v[104:107], v[68:71], v[100:103], v[40:43]
  v_exp_f32 v132, v132
  v_mfma_f32_16x16x32_bf16 v[104:107], v[70:73], v[14:17], v[104:107]
  v_exp_f32 v133, v133
  v_mfma_f32_16x16x32_bf16 v[108:111], v[120:123], v[100:103], v[36:39]
  v_exp_f32 v134, v134
  v_mfma_f32_16x16x32_bf16 v[108:111], v[122:125], v[14:17], v[108:111]
  v_exp_f32 v135, v135
  v_mfma_f32_16x16x32_bf16 v[74:77], v[148:151], v[100:103], v[32:35]
  v_exp_f32 v140, v140
  v_mfma_f32_16x16x32_bf16 v[74:77], v[150:153], v[14:17], v[74:77]
  v_exp_f32 v141, v141
  v_mfma_f32_16x16x32_bf16 v[176:179], v[154:157], v[100:103], v[28:31]
  v_exp_f32 v142, v142
  v_mfma_f32_16x16x32_bf16 v[176:179], v[156:159], v[14:17], v[176:179]
  v_exp_f32 v143, v143
  v_mfma_f32_16x16x32_bf16 v[100:103], a[0:3], v[88:91], 0
  v_exp_f32 v144, v144
  v_mfma_f32_16x16x32_bf16 v[100:103], a[12:15], v[92:95], v[100:103]
  v_exp_f32 v145, v145
  v_mfma_f32_16x16x32_bf16 v[100:103], a[24:27], v[116:119], v[100:103]
  v_exp_f32 v146, v146
  v_mfma_f32_16x16x32_bf16 v[100:103], a[36:39], v[96:99], v[100:103]
  v_exp_f32 v147, v147
  v_mfma_f32_16x16x32_bf16 v[100:103], a[48:51], v[136:139], v[100:103]
  v_cvt_pk_bf16_f32 v128, v128, v129
  v_cvt_pk_bf16_f32 v129, v130, v131
  v_mfma_f32_16x16x32_bf16 v[100:103], a[60:63], v[80:83], v[100:103]
  v_cvt_pk_bf16_f32 v130, v132, v133
  v_cvt_pk_bf16_f32 v131, v134, v135
  v_mfma_f32_16x16x32_bf16 v[172:175], a[64:67], v[80:83], 0
  v_cvt_pk_bf16_f32 v132, v140, v141
  v_cvt_pk_bf16_f32 v133, v142, v143
  v_mfma_f32_16x16x32_bf16 v[172:175], a[52:55], v[136:139], v[172:175]
  v_cvt_pk_bf16_f32 v134, v144, v145
  v_cvt_pk_bf16_f32 v135, v146, v147
  v_mfma_f32_16x16x32_bf16 v[172:175], a[40:43], v[96:99], v[172:175]
  v_mul_f32 v100, s42, v100
  v_mul_f32 v101, s42, v101
  v_mfma_f32_16x16x32_bf16 v[172:175], a[28:31], v[116:119], v[172:175]
  v_mul_f32 v102, s42, v102
  v_mul_f32 v103, s42, v103
  v_mfma_f32_16x16x32_bf16 v[172:175], a[16:19], v[92:95], v[172:175]
  v_cvt_pk_bf16_f32 v18, v100, v101
  v_cvt_pk_bf16_f32 v19, v102, v103
  v_mfma_f32_16x16x32_bf16 v[172:175], a[4:7], v[88:91], v[172:175]
  v_exp_f32 v104, v104
  v_mfma_f32_16x16x32_bf16 v[140:143], a[8:11], v[88:91], 0
  v_exp_f32 v105, v105
  v_mfma_f32_16x16x32_bf16 v[140:143], a[20:23], v[92:95], v[140:143]
  v_exp_f32 v106, v106
  v_mfma_f32_16x16x32_bf16 v[140:143], a[32:35], v[116:119], v[140:143]
  v_mul_f32 v172, s42, v172
  v_mul_f32 v173, s42, v173
  v_mfma_f32_16x16x32_bf16 v[140:143], a[44:47], v[96:99], v[140:143]
  v_mul_f32 v174, s42, v174
  v_mul_f32 v175, s42, v175
  v_mfma_f32_16x16x32_bf16 v[140:143], a[56:59], v[136:139], v[140:143]
  v_cvt_pk_bf16_f32 v168, v172, v173
  v_cvt_pk_bf16_f32 v169, v174, v175
  v_mfma_f32_16x16x32_bf16 v[140:143], a[68:71], v[80:83], v[140:143]
  v_exp_f32 v107, v107
  v_mfma_f32_16x16x32_bf16 v[144:147], a[0:3], v[164:167], 0
  v_exp_f32 v108, v108
  v_mfma_f32_16x16x32_bf16 v[144:147], a[12:15], v[180:183], v[144:147]
  v_exp_f32 v109, v109
  v_mfma_f32_16x16x32_bf16 v[144:147], a[24:27], v[84:87], v[144:147]
  v_mul_f32 v140, s42, v140
  v_mul_f32 v141, s42, v141
  v_mfma_f32_16x16x32_bf16 v[144:147], a[36:39], a[252:255], v[144:147]
  v_mul_f32 v142, s42, v142
  v_mul_f32 v143, s42, v143
  v_mfma_f32_16x16x32_bf16 v[144:147], a[48:51], a[244:247], v[144:147]
  v_cvt_pk_bf16_f32 v170, v140, v141
  v_cvt_pk_bf16_f32 v171, v142, v143
  v_mfma_f32_16x16x32_bf16 v[144:147], a[60:63], a[248:251], v[144:147]
  v_exp_f32 v110, v110
  v_mfma_f32_16x16x32_bf16 v[172:175], a[64:67], a[248:251], 0
  v_exp_f32 v111, v111
  v_mfma_f32_16x16x32_bf16 v[172:175], a[52:55], a[244:247], v[172:175]
  v_exp_f32 v74, v74
  v_mfma_f32_16x16x32_bf16 v[172:175], a[40:43], a[252:255], v[172:175]
  v_mul_f32 v144, s42, v144
  v_mul_f32 v145, s42, v145
  v_mfma_f32_16x16x32_bf16 v[172:175], a[28:31], v[84:87], v[172:175]
  v_mul_f32 v146, s42, v146
  v_mul_f32 v147, s42, v147
  v_mfma_f32_16x16x32_bf16 v[172:175], a[16:19], v[180:183], v[172:175]
  v_cvt_pk_bf16_f32 v112, v144, v145
  v_cvt_pk_bf16_f32 v113, v146, v147
  v_mfma_f32_16x16x32_bf16 v[172:175], a[4:7], v[164:167], v[172:175]
  v_exp_f32 v75, v75
  v_mfma_f32_16x16x32_bf16 v[100:103], a[8:11], v[164:167], 0
  v_exp_f32 v76, v76
  v_mfma_f32_16x16x32_bf16 v[100:103], a[20:23], v[180:183], v[100:103]
  v_exp_f32 v77, v77
  v_mfma_f32_16x16x32_bf16 v[100:103], a[32:35], v[84:87], v[100:103]
  v_mul_f32 v172, s42, v172
  v_mul_f32 v173, s42, v173
  v_mfma_f32_16x16x32_bf16 v[100:103], a[44:47], a[252:255], v[100:103]
  v_mul_f32 v174, s42, v174
  v_mul_f32 v175, s42, v175
  v_mfma_f32_16x16x32_bf16 v[100:103], a[56:59], a[244:247], v[100:103]
  v_cvt_pk_bf16_f32 v114, v172, v173
  v_cvt_pk_bf16_f32 v115, v174, v175
  v_mfma_f32_16x16x32_bf16 v[100:103], a[68:71], a[248:251], v[100:103]
  v_exp_f32 v176, v176
  v_mfma_f32_16x16x32_bf16 v[140:143], v[150:153], v[168:171], v[36:39]
  v_exp_f32 v177, v177
  v_mfma_f32_16x16x32_bf16 v[140:143], v[148:151], v[18:21], v[140:143]
  v_exp_f32 v178, v178
  v_mfma_f32_16x16x32_bf16 v[144:147], v[156:159], v[168:171], v[32:35]
  v_mul_f32 v100, s42, v100
  v_mul_f32 v101, s42, v101
  v_mfma_f32_16x16x32_bf16 v[144:147], v[154:157], v[18:21], v[144:147]
  v_mul_f32 v102, s42, v102
  v_mul_f32 v103, s42, v103
  v_mfma_f32_16x16x32_bf16 v[172:175], v[70:73], v[168:171], v[44:47]
  v_cvt_pk_bf16_f32 v22, v100, v101
  v_cvt_pk_bf16_f32 v23, v102, v103
  v_mfma_f32_16x16x32_bf16 v[172:175], v[68:71], v[18:21], v[172:175]
  v_exp_f32 v179, v179
  v_mfma_f32_16x16x32_bf16 v[160:163], v[122:125], v[168:171], v[40:43]
  v_cvt_pk_bf16_f32 v104, v104, v105
  v_cvt_pk_bf16_f32 v105, v106, v107
  v_mfma_f32_16x16x32_bf16 v[160:163], v[120:123], v[18:21], v[160:163]
  v_cvt_pk_bf16_f32 v106, v108, v109
  v_cvt_pk_bf16_f32 v107, v110, v111
  v_mfma_f32_16x16x32_bf16 v[168:171], v[88:91], a[144:147], 0
  v_cvt_pk_bf16_f32 v108, v74, v75
  v_cvt_pk_bf16_f32 v109, v76, v77
  v_mfma_f32_16x16x32_bf16 v[168:171], v[92:95], a[156:159], v[168:171]
  v_cvt_pk_bf16_f32 v110, v176, v177
  v_cvt_pk_bf16_f32 v111, v178, v179
  v_mfma_f32_16x16x32_bf16 v[168:171], v[116:119], a[168:171], v[168:171]
  v_exp_f32 v140, v140
  v_mfma_f32_16x16x32_bf16 v[168:171], v[96:99], a[180:183], v[168:171]
  v_exp_f32 v141, v141
  v_mfma_f32_16x16x32_bf16 v[168:171], v[136:139], a[192:195], v[168:171]
  v_exp_f32 v142, v142
  v_mfma_f32_16x16x32_bf16 v[168:171], v[80:83], a[204:207], v[168:171]
  v_exp_f32 v143, v143
  v_mfma_f32_16x16x32_bf16 v[76:79], v[80:83], a[208:211], 0
  v_exp_f32 v144, v144
  v_mfma_f32_16x16x32_bf16 v[76:79], v[136:139], a[196:199], v[76:79]
  v_exp_f32 v145, v145
  v_mfma_f32_16x16x32_bf16 v[76:79], v[96:99], a[184:187], v[76:79]
  v_cvt_pk_bf16_f32 v100, v168, v169
  v_cvt_pk_bf16_f32 v101, v170, v171
  v_mfma_f32_16x16x32_bf16 v[76:79], v[116:119], a[172:175], v[76:79]
  v_exp_f32 v146, v146
  v_mfma_f32_16x16x32_bf16 v[76:79], v[92:95], a[160:163], v[76:79]
  v_exp_f32 v147, v147
  v_mfma_f32_16x16x32_bf16 v[76:79], v[88:91], a[148:151], v[76:79]
  v_exp_f32 v172, v172
  v_mfma_f32_16x16x32_bf16 v[168:171], v[88:91], a[152:155], 0
  v_exp_f32 v173, v173
  v_mfma_f32_16x16x32_bf16 v[168:171], v[92:95], a[164:167], v[168:171]
  v_exp_f32 v174, v174
  v_mfma_f32_16x16x32_bf16 v[168:171], v[116:119], a[176:179], v[168:171]
  v_cvt_pk_bf16_f32 v88, v76, v77
  v_cvt_pk_bf16_f32 v89, v78, v79
  v_mfma_f32_16x16x32_bf16 v[168:171], v[96:99], a[188:191], v[168:171]
  v_exp_f32 v175, v175
  v_mfma_f32_16x16x32_bf16 v[168:171], v[136:139], a[200:203], v[168:171]
  v_exp_f32 v160, v160
  v_mfma_f32_16x16x32_bf16 v[168:171], v[80:83], a[212:215], v[168:171]
  v_exp_f32 v161, v161
  v_mfma_f32_16x16x32_bf16 v[76:79], v[148:151], v[112:115], v[40:43]
  v_exp_f32 v162, v162
  v_mfma_f32_16x16x32_bf16 v[76:79], v[150:153], v[20:23], v[76:79]
  v_exp_f32 v163, v163
  v_mfma_f32_16x16x32_bf16 v[80:83], v[154:157], v[112:115], v[36:39]
  v_cvt_pk_bf16_f32 v92, v168, v169
  v_cvt_pk_bf16_f32 v93, v170, v171
  v_mfma_f32_16x16x32_bf16 v[80:83], v[156:159], v[20:23], v[80:83]
  v_cvt_pk_bf16_f32 v140, v140, v141
  v_cvt_pk_bf16_f32 v141, v142, v143
  v_mfma_f32_16x16x32_bf16 v[148:151], v[68:71], v[112:115], v[48:51]
  v_cvt_pk_bf16_f32 v142, v144, v145
  v_cvt_pk_bf16_f32 v143, v146, v147
  v_mfma_f32_16x16x32_bf16 v[148:151], v[70:73], v[20:23], v[148:151]
  v_cvt_pk_bf16_f32 v144, v172, v173
  v_cvt_pk_bf16_f32 v145, v174, v175
  v_mfma_f32_16x16x32_bf16 v[152:155], v[120:123], v[112:115], v[44:47]
  v_cvt_pk_bf16_f32 v146, v160, v161
  v_cvt_pk_bf16_f32 v147, v162, v163
  v_mfma_f32_16x16x32_bf16 v[152:155], v[122:125], v[20:23], v[152:155]
  v_exp_f32 v76, v76
  v_mfma_f32_16x16x32_bf16 v[136:139], v[164:167], a[144:147], 0
  v_exp_f32 v77, v77
  v_mfma_f32_16x16x32_bf16 v[136:139], v[180:183], a[156:159], v[136:139]
  v_exp_f32 v78, v78
  v_mfma_f32_16x16x32_bf16 v[136:139], v[84:87], a[168:171], v[136:139]
  ds_read_b128 v[68:71], v3 offset:0
  v_cvt_pk_bf16_f32 v76, v76, v77
  v_mfma_f32_16x16x32_bf16 v[136:139], a[252:255], a[180:183], v[136:139]
  ds_read_b128 v[72:75], v3 offset:4096
  v_mfma_f32_16x16x32_bf16 v[136:139], a[244:247], a[192:195], v[136:139]
  ds_read_b128 v[96:99], v3 offset:8192
  v_mfma_f32_16x16x32_bf16 v[136:139], a[248:251], a[204:207], v[136:139]
  ds_read_b128 v[116:119], v3 offset:12288
  v_mfma_f32_16x16x32_bf16 v[156:159], a[248:251], a[208:211], 0
  ds_read_b128 v[120:123], v3 offset:16384
  v_mfma_f32_16x16x32_bf16 v[156:159], a[244:247], a[196:199], v[156:159]
  ds_read_b128 v[124:127], v3 offset:20480
  v_mfma_f32_16x16x32_bf16 v[156:159], a[252:255], a[184:187], v[156:159]
  v_cvt_pk_bf16_f32 v102, v136, v137
  v_cvt_pk_bf16_f32 v103, v138, v139
  v_mfma_f32_16x16x32_bf16 v[156:159], v[84:87], a[172:175], v[156:159]
  v_exp_f32 v79, v79
  v_mfma_f32_16x16x32_bf16 v[156:159], v[180:183], a[160:163], v[156:159]
  v_exp_f32 v80, v80
  v_mfma_f32_16x16x32_bf16 v[156:159], v[164:167], a[148:151], v[156:159]
  v_exp_f32 v81, v81
  v_mfma_f32_16x16x32_bf16 v[160:163], v[164:167], a[152:155], 0
  v_exp_f32 v82, v82
  v_mfma_f32_16x16x32_bf16 v[160:163], v[180:183], a[164:167], v[160:163]
  v_exp_f32 v83, v83
  v_mfma_f32_16x16x32_bf16 v[160:163], v[84:87], a[176:179], v[160:163]
  v_cvt_pk_bf16_f32 v90, v156, v157
  v_cvt_pk_bf16_f32 v91, v158, v159
  v_mfma_f32_16x16x32_bf16 v[160:163], a[252:255], a[188:191], v[160:163]
  v_mov_b64 v[172:173], 0
  v_cvt_pk_bf16_f32 v77, v78, v79
  v_mfma_f32_16x16x32_bf16 v[160:163], a[244:247], a[200:203], v[160:163]
  v_exp_f32 v148, v148
  v_mfma_f32_16x16x32_bf16 v[160:163], a[248:251], a[212:215], v[160:163]
  s_waitcnt lgkmcnt(0)
  v_exp_f32 v149, v149
  v_mfma_f32_16x16x32_bf16 v[136:139], v[68:71], v[184:187], 0
  v_exp_f32 v150, v150
  v_mfma_f32_16x16x32_bf16 v[136:139], v[72:75], v[200:203], v[136:139]
  v_exp_f32 v151, v151
  v_mfma_f32_16x16x32_bf16 v[136:139], v[96:99], v[216:219], v[136:139]
  v_cvt_pk_bf16_f32 v94, v160, v161
  v_cvt_pk_bf16_f32 v95, v162, v163
  v_mfma_f32_16x16x32_bf16 v[136:139], v[116:119], v[232:235], v[136:139]
  v_mov_b64 v[156:157], 0
  v_cvt_pk_bf16_f32 v78, v80, v81
  v_mfma_f32_16x16x32_bf16 v[136:139], v[120:123], v[248:251], v[136:139]
  v_exp_f32 v152, v152
  v_mfma_f32_16x16x32_bf16 v[136:139], v[124:127], a[224:227], v[136:139]
  v_exp_f32 v153, v153
  v_smfmac_f32_16x16x64_bf16 v[172:175], a[240:243], v[128:135], v10
  v_exp_f32 v154, v154
  v_mfma_f32_16x16x32_bf16 v[160:163], v[100:103], v[132:135], 0
  v_exp_f32 v155, v155
  v_mfma_f32_16x16x32_bf16 v[160:163], v[56:59], v[128:131], v[160:163]
  v_cvt_pk_bf16_f32 v79, v82, v83
  v_cvt_pk_bf16_f32 v80, v148, v149
  v_mfma_f32_16x16x32_bf16 v[168:171], v[60:63], v[128:131], 0
  v_cvt_pk_bf16_f32 v81, v150, v151
  v_cvt_pk_bf16_f32 v82, v152, v153
  v_mfma_f32_16x16x32_bf16 v[168:171], v[88:91], v[132:135], v[168:171]
  v_cvt_pk_bf16_f32 v83, v154, v155
  v_mfma_f32_16x16x32_bf16 v[164:167], v[92:95], v[132:135], 0
  v_add_f32 v172, v172, v173
  v_rcp_f32 v174, v172
  v_mfma_f32_16x16x32_bf16 v[164:167], v[64:67], v[128:131], v[164:167]
  v_max3_f32 v9, v172, v174, v9
  v_mul_f32 v160, v174, v160
  v_mul_f32 v161, v174, v161
  v_smfmac_f32_16x16x64_bf16 v[156:159], a[240:243], v[104:111], v10
  v_mul_f32 v162, v174, v162
  v_mul_f32 v163, v174, v163
  v_cvt_pk_bf16_f32 v160, v160, v161
  v_mfma_f32_16x16x32_bf16 v[132:135], v[100:103], v[108:111], 0
  v_cvt_pk_bf16_f32 v161, v162, v163
  v_mul_f32 v168, v174, v168
  v_mul_f32 v169, v174, v169
  v_mfma_f32_16x16x32_bf16 v[132:135], v[56:59], v[104:107], v[132:135]
  v_mul_f32 v170, v174, v170
  v_mul_f32 v171, v174, v171
  v_cvt_pk_bf16_f32 v168, v168, v169
  v_mfma_f32_16x16x32_bf16 v[112:115], v[60:63], v[104:107], 0
  v_cvt_pk_bf16_f32 v169, v170, v171
  v_mul_f32 v164, v174, v164
  v_mul_f32 v165, v174, v165
  v_mfma_f32_16x16x32_bf16 v[112:115], v[88:91], v[108:111], v[112:115]
  v_mul_f32 v166, v174, v166
  v_mul_f32 v167, v174, v167
  v_cvt_pk_bf16_f32 v164, v164, v165
  v_mfma_f32_16x16x32_bf16 v[84:87], v[92:95], v[108:111], 0
  v_add_f32 v156, v156, v157
  v_rcp_f32 v158, v156
  v_mfma_f32_16x16x32_bf16 v[84:87], v[64:67], v[104:107], v[84:87]
  v_cvt_pk_bf16_f32 v165, v166, v167
  v_max3_f32 v9, v156, v158, v9
  v_mul_f32 v132, v158, v132
  v_mfma_f32_16x16x32_bf16 v[104:107], v[124:127], a[228:231], 0
  v_mul_f32 v133, v158, v133
  v_mul_f32 v134, v158, v134
  v_mul_f32 v135, v158, v135
  v_mfma_f32_16x16x32_bf16 v[104:107], v[120:123], v[252:255], v[104:107]
  v_cvt_pk_bf16_f32 v132, v132, v133
  v_cvt_pk_bf16_f32 v133, v134, v135
  v_mul_f32 v112, v158, v112
  v_mfma_f32_16x16x32_bf16 v[104:107], v[116:119], v[236:239], v[104:107]
  v_mov_b64 v[172:173], 0
  v_mul_f32 v113, v158, v113
  v_mul_f32 v114, v158, v114
  v_mfma_f32_16x16x32_bf16 v[104:107], v[96:99], v[220:223], v[104:107]
  v_mul_f32 v115, v158, v115
  v_cvt_pk_bf16_f32 v112, v112, v113
  v_cvt_pk_bf16_f32 v113, v114, v115
  v_mfma_f32_16x16x32_bf16 v[104:107], v[72:75], v[204:207], v[104:107]
  v_mul_f32 v84, v158, v84
  v_mul_f32 v85, v158, v85
  v_mul_f32 v86, v158, v86
  v_mfma_f32_16x16x32_bf16 v[104:107], v[68:71], v[188:191], v[104:107]
  v_mul_f32 v87, v158, v87
  v_cvt_pk_bf16_f32 v84, v84, v85
  v_cvt_pk_bf16_f32 v85, v86, v87
  v_mfma_f32_16x16x32_bf16 v[152:155], v[68:71], v[192:195], 0
  ds_write2st64_b32 v5, v160, v161 offset0:0 offset1:4
  v_mfma_f32_16x16x32_bf16 v[152:155], v[72:75], v[208:211], v[152:155]
  ds_write2st64_b32 v5, v168, v169 offset0:8 offset1:12
  v_mfma_f32_16x16x32_bf16 v[152:155], v[96:99], v[224:227], v[152:155]
  v_cvt_pk_bf16_f32 v136, v136, v104
  v_cvt_pk_bf16_f32 v137, v137, v105
  v_mfma_f32_16x16x32_bf16 v[152:155], v[116:119], v[240:243], v[152:155]
  ds_read_b128 a[248:251], v4 offset:0
  v_cvt_pk_bf16_f32 v138, v138, v106
  v_cvt_pk_bf16_f32 v139, v139, v107
  v_mfma_f32_16x16x32_bf16 v[152:155], v[120:123], a[216:219], v[152:155]
  buffer_store_dword v136, v7, s[24:27], s33 offen offset:0 nt
  v_mfma_f32_16x16x32_bf16 v[152:155], v[124:127], a[232:235], v[152:155]
  ds_read_b128 v[148:151], v4 offset:4096
  ds_read_b128 v[156:159], v4 offset:8192
  v_smfmac_f32_16x16x64_bf16 v[172:175], a[240:243], v[140:147], v10
  ds_read_b128 v[160:163], v4 offset:12288
  ds_read_b128 v[168:171], v4 offset:16384
  v_mfma_f32_16x16x32_bf16 v[108:111], v[56:59], v[144:147], 0
  buffer_store_dword v137, v7, s[24:27], s33 offen offset:384 nt
  v_mfma_f32_16x16x32_bf16 v[108:111], v[100:103], v[140:143], v[108:111]
  ds_read_b128 v[176:179], v4 offset:20480
  v_mfma_f32_16x16x32_bf16 v[128:131], v[88:91], v[140:143], 0
  ds_write2st64_b32 v5, v164, v165 offset0:16 offset1:20
  v_mfma_f32_16x16x32_bf16 v[128:131], v[60:63], v[144:147], v[128:131]
  buffer_store_dword v138, v7, s[24:27], s33 offen offset:768 nt
  v_mfma_f32_16x16x32_bf16 v[104:107], v[64:67], v[144:147], 0
  v_add_f32 v172, v172, v173
  v_rcp_f32 v174, v172
  v_mfma_f32_16x16x32_bf16 v[104:107], v[92:95], v[140:143], v[104:107]
  v_max3_f32 v9, v172, v174, v9
  v_mul_f32 v108, v174, v108
  v_mul_f32 v109, v174, v109
  v_mfma_f32_16x16x32_bf16 v[140:143], v[124:127], a[236:239], 0
  buffer_store_dword v139, v7, s[24:27], s33 offen offset:1152 nt
  v_mul_f32 v110, v174, v110
  v_mfma_f32_16x16x32_bf16 v[140:143], v[120:123], a[220:223], v[140:143]
  v_mul_f32 v111, v174, v111
  v_cvt_pk_bf16_f32 v108, v108, v109
  v_cvt_pk_bf16_f32 v109, v110, v111
  v_mfma_f32_16x16x32_bf16 v[140:143], v[116:119], v[244:247], v[140:143]
  v_mov_b64 v[124:125], 0
  v_mul_f32 v128, v174, v128
  v_mul_f32 v129, v174, v129
  v_mfma_f32_16x16x32_bf16 v[140:143], v[96:99], v[228:231], v[140:143]
  v_mul_f32 v130, v174, v130
  v_mul_f32 v131, v174, v131
  v_cvt_pk_bf16_f32 v128, v128, v129
  v_mfma_f32_16x16x32_bf16 v[140:143], v[72:75], v[212:215], v[140:143]
  v_cvt_pk_bf16_f32 v129, v130, v131
  v_mul_f32 v104, v174, v104
  v_mul_f32 v105, v174, v105
  v_mfma_f32_16x16x32_bf16 v[140:143], v[68:71], v[196:199], v[140:143]
  s_waitcnt lgkmcnt(1)
  v_mul_f32 v106, v174, v106
  v_mul_f32 v107, v174, v107
  v_cvt_pk_bf16_f32 v104, v104, v105
  v_mfma_f32_16x16x32_bf16 v[96:99], a[248:251], v[184:187], 0
  v_cvt_pk_bf16_f32 v105, v106, v107
  v_mfma_f32_16x16x32_bf16 v[96:99], v[148:151], v[200:203], v[96:99]
  ds_write2st64_b32 v5, v132, v133 offset0:1 offset1:5
  v_mfma_f32_16x16x32_bf16 v[96:99], v[156:159], v[216:219], v[96:99]
  v_cvt_pk_bf16_f32 v152, v152, v140
  v_cvt_pk_bf16_f32 v153, v153, v141
  v_mfma_f32_16x16x32_bf16 v[96:99], v[160:163], v[232:235], v[96:99]
  ds_read_b128 a[244:247], v3 offset:512
  v_cvt_pk_bf16_f32 v154, v154, v142
  v_cvt_pk_bf16_f32 v155, v155, v143
  v_mfma_f32_16x16x32_bf16 v[96:99], v[168:171], v[248:251], v[96:99]
  buffer_store_dword v152, v8, s[24:27], s33 offen offset:0 nt
  v_mfma_f32_16x16x32_bf16 v[96:99], v[176:179], a[224:227], v[96:99]
  ds_read_b128 a[252:255], v3 offset:4608
  ds_read_b128 v[68:71], v3 offset:8704
  v_smfmac_f32_16x16x64_bf16 v[124:127], a[240:243], v[76:83], v10
  ds_read_b128 v[72:75], v3 offset:12800
  ds_read_b128 v[116:119], v3 offset:16896
  v_mfma_f32_16x16x32_bf16 v[132:135], v[56:59], v[80:83], 0
  buffer_store_dword v153, v8, s[24:27], s33 offen offset:384 nt
  v_mfma_f32_16x16x32_bf16 v[132:135], v[100:103], v[76:79], v[132:135]
  ds_read_b128 v[120:123], v3 offset:20992
  v_xor_b32 v3, 40960, v3
  v_mfma_f32_16x16x32_bf16 v[136:139], v[88:91], v[76:79], 0
  ds_write2st64_b32 v5, v112, v113 offset0:9 offset1:13
  v_mfma_f32_16x16x32_bf16 v[136:139], v[60:63], v[80:83], v[136:139]
  buffer_store_dword v154, v8, s[24:27], s33 offen offset:768 nt
  v_mfma_f32_16x16x32_bf16 v[56:59], v[64:67], v[80:83], 0
  v_add_f32 v124, v124, v125
  v_rcp_f32 v126, v124
  v_mfma_f32_16x16x32_bf16 v[56:59], v[92:95], v[76:79], v[56:59]
  v_max3_f32 v9, v124, v126, v9
  v_mul_f32 v132, v126, v132
  v_mul_f32 v133, v126, v133
  v_mfma_f32_16x16x32_bf16 v[60:63], v[176:179], a[228:231], 0
  buffer_store_dword v155, v8, s[24:27], s33 offen offset:1152 nt
  v_mul_f32 v134, v126, v134
  v_mfma_f32_16x16x32_bf16 v[60:63], v[168:171], v[252:255], v[60:63]
  s_add_u32 s33, s33, s98
  v_mul_f32 v135, v126, v135
  v_cvt_pk_bf16_f32 v132, v132, v133
  v_cvt_pk_bf16_f32 v133, v134, v135
  v_mfma_f32_16x16x32_bf16 v[60:63], v[160:163], v[236:239], v[60:63]
  v_mul_f32 v136, v126, v136
  v_mul_f32 v137, v126, v137
  v_mul_f32 v138, v126, v138
  v_mfma_f32_16x16x32_bf16 v[60:63], v[156:159], v[220:223], v[60:63]
  v_mul_f32 v139, v126, v139
  v_cvt_pk_bf16_f32 v136, v136, v137
  v_cvt_pk_bf16_f32 v137, v138, v139
  v_mfma_f32_16x16x32_bf16 v[60:63], v[148:151], v[204:207], v[60:63]
  v_mul_f32 v56, v126, v56
  v_mul_f32 v57, v126, v57
  v_mul_f32 v58, v126, v58
  v_mfma_f32_16x16x32_bf16 v[60:63], a[248:251], v[188:191], v[60:63]
  s_waitcnt lgkmcnt(1)
  v_mul_f32 v59, v126, v59
  v_cvt_pk_bf16_f32 v56, v56, v57
  v_cvt_pk_bf16_f32 v57, v58, v59
  v_mfma_f32_16x16x32_bf16 v[76:79], a[244:247], v[184:187], 0
  v_cmp_nge_f32 vcc, 0x53800000, v9
  v_mfma_f32_16x16x32_bf16 v[76:79], a[252:255], v[200:203], v[76:79]
  ds_write2st64_b32 v5, v84, v85 offset0:17 offset1:21
  v_mfma_f32_16x16x32_bf16 v[76:79], v[68:71], v[216:219], v[76:79]
  s_or_b32 s6, vcc_lo, vcc_hi
  v_cvt_pk_bf16_f32 v96, v96, v60
  v_cvt_pk_bf16_f32 v97, v97, v61
  v_mov_b32 v54, s6
  v_mfma_f32_16x16x32_bf16 v[76:79], v[72:75], v[232:235], v[76:79]
  v_cvt_pk_bf16_f32 v98, v98, v62
  v_cvt_pk_bf16_f32 v99, v99, v63
  v_mfma_f32_16x16x32_bf16 v[76:79], v[116:119], v[248:251], v[76:79]
  buffer_store_dword v96, v7, s[24:27], s34 offen offset:0 nt
  v_mfma_f32_16x16x32_bf16 v[76:79], v[120:123], a[224:227], v[76:79]
  ds_write2st64_b32 v5, v108, v109 offset0:2 offset1:6
  v_mfma_f32_16x16x32_bf16 v[80:83], v[120:123], a[228:231], 0
  ds_write2st64_b32 v5, v128, v129 offset0:10 offset1:14
  v_mfma_f32_16x16x32_bf16 v[80:83], v[116:119], v[252:255], v[80:83]
  buffer_store_dword v97, v7, s[24:27], s34 offen offset:384 nt
  v_mfma_f32_16x16x32_bf16 v[80:83], v[72:75], v[236:239], v[80:83]
  ds_read_b128 a[248:251], v4 offset:512
  ds_read_b128 v[60:63], v4 offset:4608
  v_mfma_f32_16x16x32_bf16 v[80:83], v[68:71], v[220:223], v[80:83]
  ds_write2st64_b32 v5, v104, v105 offset0:18 offset1:22
  v_mfma_f32_16x16x32_bf16 v[80:83], a[252:255], v[204:207], v[80:83]
  buffer_store_dword v98, v7, s[24:27], s34 offen offset:768 nt
  v_mfma_f32_16x16x32_bf16 v[80:83], a[244:247], v[188:191], v[80:83]
  ds_write2st64_b32 v5, v132, v133 offset0:3 offset1:7
  v_mfma_f32_16x16x32_bf16 v[64:67], a[244:247], v[192:195], 0
  ds_write2st64_b32 v5, v136, v137 offset0:11 offset1:15
  v_mfma_f32_16x16x32_bf16 v[64:67], a[252:255], v[208:211], v[64:67]
  buffer_store_dword v99, v7, s[24:27], s34 offen offset:1152 nt
  v_mfma_f32_16x16x32_bf16 v[64:67], v[68:71], v[224:227], v[64:67]
  s_add_u32 s34, s34, s98
  ds_read_b128 v[84:87], v4 offset:8704
  v_cvt_pk_bf16_f32 v76, v76, v80
  v_cvt_pk_bf16_f32 v77, v77, v81
  v_mfma_f32_16x16x32_bf16 v[64:67], v[72:75], v[240:243], v[64:67]
  ds_read_b128 v[92:95], v4 offset:12800
  v_cvt_pk_bf16_f32 v78, v78, v82
  v_cvt_pk_bf16_f32 v79, v79, v83
  v_mfma_f32_16x16x32_bf16 v[64:67], v[116:119], a[216:219], v[64:67]
  buffer_store_dword v76, v7, s[24:27], s35 offen offset:0 nt
  v_mfma_f32_16x16x32_bf16 v[64:67], v[120:123], a[232:235], v[64:67]
  ds_write2st64_b32 v5, v56, v57 offset0:19 offset1:23
  v_mfma_f32_16x16x32_bf16 v[96:99], v[120:123], a[236:239], 0
  ds_read_b128 v[88:91], v4 offset:16896
  ds_write_b32 v11, v54
  v_mfma_f32_16x16x32_bf16 v[96:99], v[116:119], a[220:223], v[96:99]
  buffer_store_dword v77, v7, s[24:27], s35 offen offset:384 nt
  v_mov_b32 v11, 159744
  v_mfma_f32_16x16x32_bf16 v[96:99], v[72:75], v[244:247], v[96:99]
  ds_read_b128 v[100:103], v4 offset:20992
  v_xor_b32 v4, 40960, v4
  v_mfma_f32_16x16x32_bf16 v[96:99], v[68:71], v[228:231], v[96:99]
  v_mfma_f32_16x16x32_bf16 v[96:99], a[252:255], v[212:215], v[96:99]
  buffer_store_dword v78, v7, s[24:27], s35 offen offset:768 nt
  v_mfma_f32_16x16x32_bf16 v[96:99], a[244:247], v[196:199], v[96:99]
  s_waitcnt lgkmcnt(9)
  v_mfma_f32_16x16x32_bf16 v[80:83], a[248:251], v[184:187], 0
  s_waitcnt lgkmcnt(1)
  s_barrier
  v_mfma_f32_16x16x32_bf16 v[80:83], v[60:63], v[200:203], v[80:83]
  buffer_store_dword v79, v7, s[24:27], s35 offen offset:1152 nt
  v_mfma_f32_16x16x32_bf16 v[80:83], v[84:87], v[216:219], v[80:83]
  s_waitcnt lgkmcnt(0)
  v_cvt_pk_bf16_f32 v64, v64, v96
  v_cvt_pk_bf16_f32 v65, v65, v97
  v_mfma_f32_16x16x32_bf16 v[80:83], v[92:95], v[232:235], v[80:83]
  v_cvt_pk_bf16_f32 v66, v66, v98
  v_cvt_pk_bf16_f32 v67, v67, v99
  v_mfma_f32_16x16x32_bf16 v[80:83], v[88:91], v[248:251], v[80:83]
  buffer_store_dword v64, v8, s[24:27], s35 offen offset:0 nt
  v_mfma_f32_16x16x32_bf16 v[80:83], v[100:103], a[224:227], v[80:83]
  ds_read_b128 a[252:255], v3 offset:0
  ds_read_b128 v[56:59], v3 offset:4096
  v_mfma_f32_16x16x32_bf16 v[76:79], v[100:103], a[228:231], 0
  ds_read_b128 v[68:71], v3 offset:8192
  ds_read_b128 v[72:75], v3 offset:12288
  v_mfma_f32_16x16x32_bf16 v[76:79], v[88:91], v[252:255], v[76:79]
  buffer_store_dword v65, v8, s[24:27], s35 offen offset:384 nt
  v_mfma_f32_16x16x32_bf16 v[76:79], v[92:95], v[236:239], v[76:79]
  ds_read_b128 a[244:247], v3 offset:16384
  ds_read_b128 v[88:91], v3 offset:20480
  v_mfma_f32_16x16x32_bf16 v[76:79], v[84:87], v[220:223], v[76:79]
  ds_read2_b32 v[92:93], v11 offset0:0 offset1:2
  ds_read2_b32 v[94:95], v11 offset0:4 offset1:6
  v_mfma_f32_16x16x32_bf16 v[76:79], v[60:63], v[204:207], v[76:79]
  buffer_store_dword v66, v8, s[24:27], s35 offen offset:768 nt
  v_mfma_f32_16x16x32_bf16 v[76:79], a[248:251], v[188:191], v[76:79]
  s_waitcnt lgkmcnt(4)
  v_mfma_f32_16x16x32_bf16 v[60:63], a[252:255], v[184:187], 0
  buffer_store_dword v67, v8, s[24:27], s35 offen offset:1152 nt
  v_mfma_f32_16x16x32_bf16 v[60:63], v[56:59], v[200:203], v[60:63]
  s_add_u32 s35, s35, s98
  v_mfma_f32_16x16x32_bf16 v[60:63], v[68:71], v[216:219], v[60:63]
  s_waitcnt lgkmcnt(0)
  v_cvt_pk_bf16_f32 v80, v80, v76
  v_cvt_pk_bf16_f32 v81, v81, v77
  v_mfma_f32_16x16x32_bf16 v[60:63], v[72:75], v[232:235], v[60:63]
  v_cvt_pk_bf16_f32 v82, v82, v78
  v_cvt_pk_bf16_f32 v83, v83, v79
  v_mfma_f32_16x16x32_bf16 v[60:63], a[244:247], v[248:251], v[60:63]
  buffer_store_dword v80, v7, s[24:27], s36 offen offset:0 nt
  v_mfma_f32_16x16x32_bf16 v[60:63], v[88:91], a[224:227], v[60:63]
  v_or3_b32 v92, v92, v93, v94
  v_or_b32 v92, v92, v95
  v_mfma_f32_16x16x32_bf16 v[64:67], v[88:91], a[228:231], 0
  buffer_store_dword v81, v7, s[24:27], s36 offen offset:384 nt
  v_mfma_f32_16x16x32_bf16 v[64:67], a[244:247], v[252:255], v[64:67]
  v_readfirstlane_b32 s49, v92
  v_mfma_f32_16x16x32_bf16 v[64:67], v[72:75], v[236:239], v[64:67]
  buffer_store_dword v82, v7, s[24:27], s36 offen offset:768 nt
  v_mfma_f32_16x16x32_bf16 v[64:67], v[68:71], v[220:223], v[64:67]
  ds_read_b128 v[76:79], v4 offset:0
  ds_read_b128 v[84:87], v4 offset:4096
  v_mfma_f32_16x16x32_bf16 v[64:67], v[56:59], v[204:207], v[64:67]
  buffer_store_dword v83, v7, s[24:27], s36 offen offset:1152 nt
  v_mfma_f32_16x16x32_bf16 v[64:67], a[252:255], v[188:191], v[64:67]
  s_add_u32 s36, s36, s98
  ds_read_b128 v[92:95], v4 offset:8192
  ds_read_b128 v[96:99], v4 offset:12288
  v_mfma_f32_16x16x32_bf16 v[80:83], a[252:255], v[192:195], 0
L_hop_2_1:
  s_cbranch_execz L_hop_2_2
  ds_read_b128 v[100:103], v4 offset:16384
  ds_read_b128 v[104:107], v4 offset:20480
  v_mfma_f32_16x16x32_bf16 v[80:83], v[56:59], v[208:211], v[80:83]
  v_mfma_f32_16x16x32_bf16 v[80:83], v[68:71], v[224:227], v[80:83]
  v_cvt_pk_bf16_f32 v60, v60, v64
  v_cvt_pk_bf16_f32 v61, v61, v65
  v_mfma_f32_16x16x32_bf16 v[80:83], v[72:75], v[240:243], v[80:83]
  v_cvt_pk_bf16_f32 v62, v62, v66
  v_cvt_pk_bf16_f32 v63, v63, v67
  v_mfma_f32_16x16x32_bf16 v[80:83], a[244:247], a[216:219], v[80:83]
  buffer_store_dword v60, v7, s[24:27], s33 offen offset:0 nt
  v_mfma_f32_16x16x32_bf16 v[80:83], v[88:91], a[232:235], v[80:83]
  v_mfma_f32_16x16x32_bf16 v[108:111], v[88:91], a[236:239], 0
  buffer_store_dword v61, v7, s[24:27], s33 offen offset:384 nt
  v_mfma_f32_16x16x32_bf16 v[108:111], a[244:247], a[220:223], v[108:111]
  v_mfma_f32_16x16x32_bf16 v[108:111], v[72:75], v[244:247], v[108:111]
  buffer_store_dword v62, v7, s[24:27], s33 offen offset:768 nt
  v_mfma_f32_16x16x32_bf16 v[108:111], v[68:71], v[228:231], v[108:111]
  ds_read_b128 a[244:247], v3 offset:512
  ds_read_b128 a[248:251], v3 offset:4608
  v_mfma_f32_16x16x32_bf16 v[108:111], v[56:59], v[212:215], v[108:111]
  buffer_store_dword v63, v7, s[24:27], s33 offen offset:1152 nt
  v_mfma_f32_16x16x32_bf16 v[108:111], a[252:255], v[196:199], v[108:111]
  s_waitcnt lgkmcnt(2)
  ds_read_b128 v[56:59], v3 offset:8704
  ds_read_b128 v[60:63], v3 offset:12800
  v_mfma_f32_16x16x32_bf16 v[88:91], v[76:79], v[184:187], 0
  ds_read_b128 a[252:255], v3 offset:16896
  ds_read_b128 v[64:67], v3 offset:20992
  v_mfma_f32_16x16x32_bf16 v[88:91], v[84:87], v[200:203], v[88:91]
  v_mfma_f32_16x16x32_bf16 v[88:91], v[92:95], v[216:219], v[88:91]
  v_cvt_pk_bf16_f32 v80, v80, v108
  v_cvt_pk_bf16_f32 v81, v81, v109
  v_mfma_f32_16x16x32_bf16 v[88:91], v[96:99], v[232:235], v[88:91]
  v_cvt_pk_bf16_f32 v82, v82, v110
  v_cvt_pk_bf16_f32 v83, v83, v111
  v_mfma_f32_16x16x32_bf16 v[88:91], v[100:103], v[248:251], v[88:91]
  buffer_store_dword v80, v8, s[24:27], s33 offen offset:0 nt
  v_mfma_f32_16x16x32_bf16 v[88:91], v[104:107], a[224:227], v[88:91]
  v_mfma_f32_16x16x32_bf16 v[68:71], v[104:107], a[228:231], 0
  buffer_store_dword v81, v8, s[24:27], s33 offen offset:384 nt
  v_mfma_f32_16x16x32_bf16 v[68:71], v[100:103], v[252:255], v[68:71]
  v_mfma_f32_16x16x32_bf16 v[68:71], v[96:99], v[236:239], v[68:71]
  buffer_store_dword v82, v8, s[24:27], s33 offen offset:768 nt
  v_mfma_f32_16x16x32_bf16 v[68:71], v[92:95], v[220:223], v[68:71]
  v_mfma_f32_16x16x32_bf16 v[68:71], v[84:87], v[204:207], v[68:71]
  buffer_store_dword v83, v8, s[24:27], s33 offen offset:1152 nt
  v_mfma_f32_16x16x32_bf16 v[68:71], v[76:79], v[188:191], v[68:71]
  s_waitcnt lgkmcnt(0)
  v_mfma_f32_16x16x32_bf16 v[84:87], a[244:247], v[184:187], 0
  v_mfma_f32_16x16x32_bf16 v[84:87], a[248:251], v[200:203], v[84:87]
  v_mfma_f32_16x16x32_bf16 v[84:87], v[56:59], v[216:219], v[84:87]
  v_cvt_pk_bf16_f32 v88, v88, v68
  v_cvt_pk_bf16_f32 v89, v89, v69
  v_mfma_f32_16x16x32_bf16 v[84:87], v[60:63], v[232:235], v[84:87]
  v_cvt_pk_bf16_f32 v90, v90, v70
  v_cvt_pk_bf16_f32 v91, v91, v71
  v_mfma_f32_16x16x32_bf16 v[84:87], a[252:255], v[248:251], v[84:87]
  buffer_store_dword v88, v7, s[24:27], s34 offen offset:0 nt
  v_mfma_f32_16x16x32_bf16 v[84:87], v[64:67], a[224:227], v[84:87]
  v_mfma_f32_16x16x32_bf16 v[100:103], v[64:67], a[228:231], 0
  buffer_store_dword v89, v7, s[24:27], s34 offen offset:384 nt
  v_mfma_f32_16x16x32_bf16 v[100:103], a[252:255], v[252:255], v[100:103]
  v_mfma_f32_16x16x32_bf16 v[100:103], v[60:63], v[236:239], v[100:103]
  buffer_store_dword v90, v7, s[24:27], s34 offen offset:768 nt
  v_mfma_f32_16x16x32_bf16 v[100:103], v[56:59], v[220:223], v[100:103]
  ds_read_b128 v[68:71], v4 offset:512
  ds_read_b128 v[72:75], v4 offset:4608
  v_mfma_f32_16x16x32_bf16 v[100:103], a[248:251], v[204:207], v[100:103]
  buffer_store_dword v91, v7, s[24:27], s34 offen offset:1152 nt
  v_mfma_f32_16x16x32_bf16 v[100:103], a[244:247], v[188:191], v[100:103]
  ds_read_b128 v[76:79], v4 offset:8704
  ds_read_b128 v[92:95], v4 offset:12800
  v_mfma_f32_16x16x32_bf16 v[80:83], a[244:247], v[192:195], 0
  ds_read_b128 v[88:91], v4 offset:16896
  ds_read_b128 v[96:99], v4 offset:20992
  v_mfma_f32_16x16x32_bf16 v[80:83], a[248:251], v[208:211], v[80:83]
  v_mfma_f32_16x16x32_bf16 v[80:83], v[56:59], v[224:227], v[80:83]
  v_cvt_pk_bf16_f32 v84, v84, v100
  v_cvt_pk_bf16_f32 v85, v85, v101
  v_mfma_f32_16x16x32_bf16 v[80:83], v[60:63], v[240:243], v[80:83]
  v_cvt_pk_bf16_f32 v86, v86, v102
  v_cvt_pk_bf16_f32 v87, v87, v103
  v_mfma_f32_16x16x32_bf16 v[80:83], a[252:255], a[216:219], v[80:83]
  buffer_store_dword v84, v7, s[24:27], s35 offen offset:0 nt
  v_mfma_f32_16x16x32_bf16 v[80:83], v[64:67], a[232:235], v[80:83]
  v_mfma_f32_16x16x32_bf16 v[100:103], v[64:67], a[236:239], 0
  buffer_store_dword v85, v7, s[24:27], s35 offen offset:384 nt
  v_mfma_f32_16x16x32_bf16 v[100:103], a[252:255], a[220:223], v[100:103]
  v_mfma_f32_16x16x32_bf16 v[100:103], v[60:63], v[244:247], v[100:103]
  buffer_store_dword v86, v7, s[24:27], s35 offen offset:768 nt
  v_mfma_f32_16x16x32_bf16 v[100:103], v[56:59], v[228:231], v[100:103]
  v_mfma_f32_16x16x32_bf16 v[100:103], a[248:251], v[212:215], v[100:103]
  buffer_store_dword v87, v7, s[24:27], s35 offen offset:1152 nt
  v_mfma_f32_16x16x32_bf16 v[100:103], a[244:247], v[196:199], v[100:103]
  s_waitcnt lgkmcnt(0)
  v_mfma_f32_16x16x32_bf16 v[56:59], v[68:71], v[184:187], 0
  v_mfma_f32_16x16x32_bf16 v[56:59], v[72:75], v[200:203], v[56:59]
  v_mfma_f32_16x16x32_bf16 v[56:59], v[76:79], v[216:219], v[56:59]
  v_cvt_pk_bf16_f32 v80, v80, v100
  v_cvt_pk_bf16_f32 v81, v81, v101
  v_mfma_f32_16x16x32_bf16 v[56:59], v[92:95], v[232:235], v[56:59]
  v_cvt_pk_bf16_f32 v82, v82, v102
  v_cvt_pk_bf16_f32 v83, v83, v103
  v_mfma_f32_16x16x32_bf16 v[56:59], v[88:91], v[248:251], v[56:59]
  buffer_store_dword v80, v8, s[24:27], s35 offen offset:0 nt
  v_mfma_f32_16x16x32_bf16 v[56:59], v[96:99], a[224:227], v[56:59]
  v_mfma_f32_16x16x32_bf16 v[60:63], v[96:99], a[228:231], 0
  buffer_store_dword v81, v8, s[24:27], s35 offen offset:384 nt
  v_mfma_f32_16x16x32_bf16 v[60:63], v[88:91], v[252:255], v[60:63]
  v_mfma_f32_16x16x32_bf16 v[60:63], v[92:95], v[236:239], v[60:63]
  buffer_store_dword v82, v8, s[24:27], s35 offen offset:768 nt
  v_mfma_f32_16x16x32_bf16 v[60:63], v[76:79], v[220:223], v[60:63]
  v_mfma_f32_16x16x32_bf16 v[60:63], v[72:75], v[204:207], v[60:63]
  buffer_store_dword v83, v8, s[24:27], s35 offen offset:1152 nt
  v_mfma_f32_16x16x32_bf16 v[60:63], v[68:71], v[188:191], v[60:63]
  s_nop 7
  v_cvt_pk_bf16_f32 v56, v56, v60
  v_cvt_pk_bf16_f32 v57, v57, v61
  v_cvt_pk_bf16_f32 v58, v58, v62
  v_cvt_pk_bf16_f32 v59, v59, v63
  buffer_store_dword v56, v7, s[24:27], s36 offen offset:0 nt
  buffer_store_dword v57, v7, s[24:27], s36 offen offset:384 nt
  buffer_store_dword v58, v7, s[24:27], s36 offen offset:768 nt
  buffer_store_dword v59, v7, s[24:27], s36 offen offset:1152 nt
  s_cmp_lg_u32 s49, 0
  s_cbranch_scc1 L_safe
L_fin:
L_end:
  s_endpgm
L_hop_3_1:
  s_cbranch_execz L_walk
L_pad3765:
L_k7:
  s_cmp_lg_u32 s59, 7
  s_cbranch_scc1 L_kh
  v_mfma_f32_16x16x32_bf16 v[104:107], a[0:3], v[88:91], 0
  s_waitcnt lgkmcnt(0)
  s_sub_u32 s49, s16, s18
  s_sub_u32 s50, s15, s60
  v_mfma_f32_16x16x32_bf16 v[104:107], a[12:15], v[92:95], v[104:107]
  s_add_u32 s50, s50, 45360
  s_mul_i32 s49, s49, s50
  s_mul_hi_u32 s49, s49, 384088
  v_mfma_f32_16x16x32_bf16 v[104:107], a[24:27], v[116:119], v[104:107]
  s_add_u32 s49, s49, s16
  v_cvt_pk_bf16_f32 v66, v132, v133
  v_cvt_pk_bf16_f32 v67, v134, v135
  v_mfma_f32_16x16x32_bf16 v[104:107], a[36:39], v[96:99], v[104:107]
  s_and_b32 s51, s2, 7
  s_lshl_b32 s51, s51, 3
  v_and_b32 v74, 56, v11
  v_mfma_f32_16x16x32_bf16 v[104:107], a[48:51], v[136:139], v[104:107]
  v_lshl_add_u32 v54, v74, 3, s51
  s_lshl_b32 s51, s51, 3
  v_mfma_f32_16x16x32_bf16 v[104:107], a[60:63], v[80:83], v[104:107]
  v_add_u32 v55, s51, v74
  v_mov_b32 v74, s49
  v_mfma_f32_16x16x32_bf16 v[84:87], a[64:67], v[80:83], 0
  buffer_store_dword v74, v54, s[20:23], s44 offen sc1
  v_mfma_f32_16x16x32_bf16 v[84:87], a[52:55], v[136:139], v[84:87]
  v_mfma_f32_16x16x32_bf16 v[84:87], a[40:43], v[96:99], v[84:87]
  v_mul_f32 v104, s42, v104
  v_mul_f32 v105, s42, v105
  v_mfma_f32_16x16x32_bf16 v[84:87], a[28:31], v[116:119], v[84:87]
  v_mul_f32 v106, s42, v106
  v_mul_f32 v107, s42, v107
  v_mfma_f32_16x16x32_bf16 v[84:87], a[16:19], v[92:95], v[84:87]
  v_cvt_pk_bf16_f32 v18, v104, v105
  v_cvt_pk_bf16_f32 v19, v106, v107
  v_mfma_f32_16x16x32_bf16 v[84:87], a[4:7], v[88:91], v[84:87]
  buffer_store_dword v74, v55, s[20:23], s44 offen offset:4 sc1
  v_mfma_f32_16x16x32_bf16 v[108:111], a[8:11], v[88:91], 0
  s_branch L_r220
L_k2:
  s_cmp_lg_u32 s59, 10
  s_cbranch_scc1 L_k7
  s_waitcnt vmcnt(30)
  v_mfma_f32_16x16x32_bf16 v[104:107], a[0:3], v[88:91], 0
  s_sub_u32 s49, s19, s18
  s_sub_u32 s50, s15, s99
  s_add_u32 s50, s50, 45360
  v_mfma_f32_16x16x32_bf16 v[104:107], a[12:15], v[92:95], v[104:107]
  s_mul_i32 s49, s49, s50
  s_mul_hi_u32 s49, s49, 384088
  s_add_u32 s49, s49, s19
  v_mfma_f32_16x16x32_bf16 v[104:107], a[24:27], v[116:119], v[104:107]
  s_and_b32 s50, s2, 7
  v_cvt_pk_bf16_f32 v66, v132, v133
  v_cvt_pk_bf16_f32 v67, v134, v135
  v_mfma_f32_16x16x32_bf16 v[104:107], a[36:39], v[96:99], v[104:107]
  s_sub_u32 s49, s49, 1024
  v_subrev_u32 v54, s49, v52
  v_subrev_u32 v55, s49, v53
  v_mfma_f32_16x16x32_bf16 v[104:107], a[48:51], v[136:139], v[104:107]
  s_waitcnt lgkmcnt(0)
  v_max_u32 v126, v54, v55
  v_bfe_u32 v74, v11, 3, 3
  v_mfma_f32_16x16x32_bf16 v[104:107], a[60:63], v[80:83], v[104:107]
  v_lshrrev_b32 v75, 6, v11
  v_lshl_add_u32 v54, v54, 3, v74
  v_mfma_f32_16x16x32_bf16 v[84:87], a[64:67], v[80:83], 0
  v_lshl_add_u32 v55, v55, 3, v75
  v_mfma_f32_16x16x32_bf16 v[84:87], a[52:55], v[136:139], v[84:87]
  v_readlane_b32 s12, v52, s50
  v_cmp_lt_u32 vcc, 2047, v126
  v_mfma_f32_16x16x32_bf16 v[84:87], a[40:43], v[96:99], v[84:87]
  v_mul_f32 v104, s42, v104
  v_mul_f32 v105, s42, v105
  v_mfma_f32_16x16x32_bf16 v[84:87], a[28:31], v[116:119], v[84:87]
  v_mul_f32 v106, s42, v106
  v_mul_f32 v107, s42, v107
  v_mfma_f32_16x16x32_bf16 v[84:87], a[16:19], v[92:95], v[84:87]
  v_cvt_pk_bf16_f32 v18, v104, v105
  v_cvt_pk_bf16_f32 v19, v106, v107
  v_mfma_f32_16x16x32_bf16 v[84:87], a[4:7], v[88:91], v[84:87]
  v_and_b32 v126, 56, v11
  v_mfma_f32_16x16x32_bf16 v[108:111], a[8:11], v[88:91], 0
  s_or_b32 s51, vcc_lo, vcc_hi
  v_cmp_lt_u32 vcc, v54, v55
  v_mfma_f32_16x16x32_bf16 v[108:111], a[20:23], v[92:95], v[108:111]
  s_sub_u32 s52, s12, s49
  s_sub_u32 s52, s52, 960
  s_lshr_b32 s52, s52, 7
  v_mfma_f32_16x16x32_bf16 v[108:111], a[32:35], v[116:119], v[108:111]
  s_or_b32 s51, s51, s52
  v_mul_f32 v84, s42, v84
  v_mul_f32 v85, s42, v85
  v_mfma_f32_16x16x32_bf16 v[108:111], a[44:47], v[96:99], v[108:111]
  v_mul_f32 v86, s42, v86
  v_mul_f32 v87, s42, v87
  v_mfma_f32_16x16x32_bf16 v[108:111], a[56:59], v[136:139], v[108:111]
  v_cvt_pk_bf16_f32 v104, v84, v85
  v_cvt_pk_bf16_f32 v105, v86, v87
  v_mfma_f32_16x16x32_bf16 v[108:111], a[68:71], v[80:83], v[108:111]
  v_lshrrev_b64 v[74:75], v126, vcc
  v_and_b32 v55, 0xff, v74
  v_mfma_f32_16x16x32_bf16 v[112:115], a[132:135], v[80:83], 0
  v_bcnt_u32_b32 v55, v55, 0
  v_mfma_f32_16x16x32_bf16 v[112:115], a[120:123], v[136:139], v[112:115]
  v_readlane_b32 s52, v55, s50
  v_mfma_f32_16x16x32_bf16 v[112:115], a[108:111], v[96:99], v[112:115]
  v_mul_f32 v108, s42, v108
  v_mul_f32 v109, s42, v109
  v_mfma_f32_16x16x32_bf16 v[112:115], a[96:99], v[116:119], v[112:115]
  s_sub_u32 s52, 7, s52
  v_mul_f32 v110, s42, v110
  v_mul_f32 v111, s42, v111
  v_mfma_f32_16x16x32_bf16 v[112:115], a[84:87], v[92:95], v[112:115]
  v_cvt_pk_bf16_f32 v106, v108, v109
  v_cvt_pk_bf16_f32 v107, v110, v111
  v_mfma_f32_16x16x32_bf16 v[112:115], a[72:75], v[88:91], v[112:115]
  v_cmp_eq_u32 vcc, s52, v55
  v_mfma_f32_16x16x32_bf16 v[84:87], a[76:79], v[88:91], 0
  v_mfma_f32_16x16x32_bf16 v[84:87], a[88:91], v[92:95], v[84:87]
  s_ff1_i32_b32 s52, vcc_lo
  s_and_b32 s52, s52, 7
  v_readlane_b32 s53, v54, s52
  v_mfma_f32_16x16x32_bf16 v[84:87], a[100:103], v[116:119], v[84:87]
  v_cvt_pk_bf16_f32 v128, v112, v113
  v_cvt_pk_bf16_f32 v129, v114, v115
  v_mfma_f32_16x16x32_bf16 v[84:87], a[112:115], v[96:99], v[84:87]
  s_lshr_b32 s53, s53, 3
  s_add_u32 s53, s53, s49
  s_sub_u32 s49, s53, s12
  v_mfma_f32_16x16x32_bf16 v[84:87], a[124:127], v[136:139], v[84:87]
  s_cmp_gt_i32 s49, 0
  s_cselect_b32 s45, 2, 1
  s_cselect_b32 s12, s53, s12
  v_mfma_f32_16x16x32_bf16 v[84:87], a[136:139], v[80:83], v[84:87]
  s_cselect_b32 s53, s52, s50
  s_cselect_b32 s96, 1, 6
  s_lshl_b32 s96, s96, 11
  v_mfma_f32_16x16x32_bf16 v[108:111], a[140:143], v[80:83], 0
  s_abs_i32 s49, s49
  s_cmp_lt_u32 s49, 235
  s_cselect_b32 s51, 1, s51
  v_mfma_f32_16x16x32_bf16 v[108:111], a[128:131], v[136:139], v[108:111]
  s_cmp_lt_u32 s49, 400
  s_cselect_b32 s14, 8, 0
  s_xnor_b32 s13, s12, s14
  v_mfma_f32_16x16x32_bf16 v[108:111], a[116:119], v[96:99], v[108:111]
  s_cmp_eq_u32 s51, 0
  v_cvt_pk_bf16_f32 v130, v84, v85
  v_cvt_pk_bf16_f32 v131, v86, v87
  v_mfma_f32_16x16x32_bf16 v[108:111], a[104:107], v[116:119], v[108:111]
  s_cselect_b32 s45, s45, 0
  s_cselect_b32 s96, s96, 0
  s_bitset1_b32 s96, 14
  v_mfma_f32_16x16x32_bf16 v[108:111], a[92:95], v[92:95], v[108:111]
  s_andn2_b32 s51, s2, 7
  s_add_u32 s51, s51, s53
  s_lshl_b32 s51, s51, 9
  v_mfma_f32_16x16x32_bf16 v[108:111], a[80:83], v[88:91], v[108:111]
  s_add_u32 s44, s51, 2097152
  s_lshr_b32 s49, s45, 1
  s_lshl_b32 s49, s49, s52
  v_mfma_f32_16x16x32_bf16 v[84:87], v[88:91], a[144:147], 0
  s_lshl_b32 s49, s49, s14
  s_lshl_b32 s54, s3, 2
  s_add_u32 s54, s54, 159808
  v_mfma_f32_16x16x32_bf16 v[84:87], v[92:95], a[156:159], v[84:87]
  v_mov_b32 v54, s54
  v_mov_b32 v55, s49
  v_mfma_f32_16x16x32_bf16 v[84:87], v[116:119], a[168:171], v[84:87]
  v_cvt_pk_bf16_f32 v132, v108, v109
  v_cvt_pk_bf16_f32 v133, v110, v111
  v_mfma_f32_16x16x32_bf16 v[84:87], v[96:99], a[180:183], v[84:87]
  ds_read_b128 a[244:247], v1 offset:22528
  v_mfma_f32_16x16x32_bf16 v[84:87], v[136:139], a[192:195], v[84:87]
  ds_read_b128 a[248:251], v0 offset:22528
  v_mfma_f32_16x16x32_bf16 v[84:87], v[80:83], a[204:207], v[84:87]
  ds_read_b128 a[252:255], v1 offset:14336
  v_mfma_f32_16x16x32_bf16 v[140:143], v[80:83], a[208:211], 0
  ds_read_b128 v[144:147], v0 offset:14336
  v_mfma_f32_16x16x32_bf16 v[140:143], v[136:139], a[196:199], v[140:143]
  ds_read_b128 v[148:151], v1 offset:6144
  v_mfma_f32_16x16x32_bf16 v[140:143], v[96:99], a[184:187], v[140:143]
  v_cvt_pk_bf16_f32 v108, v84, v85
  v_cvt_pk_bf16_f32 v109, v86, v87
  v_mfma_f32_16x16x32_bf16 v[140:143], v[116:119], a[172:175], v[140:143]
  ds_read_b128 v[152:155], v0 offset:6144
  v_mfma_f32_16x16x32_bf16 v[140:143], v[92:95], a[160:163], v[140:143]
  ds_write_b32 v54, v55
  v_mfma_f32_16x16x32_bf16 v[140:143], v[88:91], a[148:151], v[140:143]
  v_mfma_f32_16x16x32_bf16 v[156:159], v[88:91], a[152:155], 0
  v_mfma_f32_16x16x32_bf16 v[156:159], v[92:95], a[164:167], v[156:159]
  v_mfma_f32_16x16x32_bf16 v[156:159], v[116:119], a[176:179], v[156:159]
  s_waitcnt lgkmcnt(0)
  v_cvt_pk_bf16_f32 v112, v140, v141
  v_cvt_pk_bf16_f32 v113, v142, v143
  v_mfma_f32_16x16x32_bf16 v[156:159], v[96:99], a[188:191], v[156:159]
  s_branch L_r259
L_hop_0_2:
  s_cbranch_execz L_walk
L_pad3966:
L_kh:
  s_cmp_lt_u32 s59, 14
  s_cbranch_scc1 L_k11
  v_mfma_f32_16x16x32_bf16 v[104:107], a[76:79], v[88:91], 0
  s_lshl_b32 s5, s3, 3
  v_mfma_f32_16x16x32_bf16 v[104:107], a[88:91], v[92:95], v[104:107]
  s_add_u32 s5, s5, 159744
  v_mov_b32 v11, s5
  v_mfma_f32_16x16x32_bf16 v[104:107], a[100:103], v[116:119], v[104:107]
  v_cvt_pk_bf16_f32 v66, v132, v133
  v_cvt_pk_bf16_f32 v67, v134, v135
  v_mfma_f32_16x16x32_bf16 v[104:107], a[112:115], v[96:99], v[104:107]
  ds_read_b128 a[244:247], v1 offset:22528
  v_mfma_f32_16x16x32_bf16 v[104:107], a[124:127], v[136:139], v[104:107]
  ds_read_b128 a[248:251], v0 offset:22528
  s_waitcnt lgkmcnt(2)
  v_mfma_f32_16x16x32_bf16 v[104:107], a[136:139], v[80:83], v[104:107]
  ds_read_b128 a[252:255], v1 offset:14336
  v_mfma_f32_16x16x32_bf16 v[108:111], a[132:135], v[80:83], 0
  ds_read_b128 v[84:87], v0 offset:14336
  v_mfma_f32_16x16x32_bf16 v[108:111], a[120:123], v[136:139], v[108:111]
  ds_read_b128 v[112:115], v1 offset:6144
  v_mfma_f32_16x16x32_bf16 v[108:111], a[108:111], v[96:99], v[108:111]
  v_cvt_pk_bf16_f32 v142, v104, v105
  v_cvt_pk_bf16_f32 v143, v106, v107
  v_mfma_f32_16x16x32_bf16 v[108:111], a[96:99], v[116:119], v[108:111]
  ds_read_b128 v[148:151], v0 offset:6144
  v_cndmask_b32 v160, v32, v48, s[100:101]
  v_mfma_f32_16x16x32_bf16 v[108:111], a[84:87], v[92:95], v[108:111]
  v_cndmask_b32 v161, v33, v49, s[100:101]
  v_cndmask_b32 v162, v34, v50, s[100:101]
  v_mfma_f32_16x16x32_bf16 v[108:111], a[72:75], v[88:91], v[108:111]
  v_cndmask_b32 v163, v35, v51, s[100:101]
  v_cndmask_b32 v164, v28, v44, s[100:101]
  v_mfma_f32_16x16x32_bf16 v[128:131], a[140:143], v[80:83], 0
  v_cndmask_b32 v165, v29, v45, s[100:101]
  v_cndmask_b32 v166, v30, v46, s[100:101]
  v_mfma_f32_16x16x32_bf16 v[128:131], a[128:131], v[136:139], v[128:131]
  v_cndmask_b32 v167, v31, v47, s[100:101]
  v_cndmask_b32 v104, v24, v40, s[100:101]
  v_mfma_f32_16x16x32_bf16 v[128:131], a[116:119], v[96:99], v[128:131]
  v_cvt_pk_bf16_f32 v140, v108, v109
  v_cvt_pk_bf16_f32 v141, v110, v111
  v_mfma_f32_16x16x32_bf16 v[128:131], a[104:107], v[116:119], v[128:131]
  v_cndmask_b32 v105, v25, v41, s[100:101]
  v_cndmask_b32 v106, v26, v42, s[100:101]
  v_mfma_f32_16x16x32_bf16 v[128:131], a[92:95], v[92:95], v[128:131]
  v_cndmask_b32 v107, v27, v43, s[100:101]
  v_mfma_f32_16x16x32_bf16 v[128:131], a[80:83], v[88:91], v[128:131]
  s_waitcnt lgkmcnt(0)
  v_mfma_f32_16x16x32_bf16 v[108:111], a[132:135], a[244:247], 0
  v_mfma_f32_16x16x32_bf16 v[108:111], a[120:123], a[248:251], v[108:111]
  v_mfma_f32_16x16x32_bf16 v[108:111], a[108:111], a[252:255], v[108:111]
  v_cvt_pk_bf16_f32 v144, v128, v129
  v_cvt_pk_bf16_f32 v145, v130, v131
  v_mfma_f32_16x16x32_bf16 v[108:111], a[96:99], v[84:87], v[108:111]
  v_mfma_f32_16x16x32_bf16 v[108:111], a[84:87], v[112:115], v[108:111]
  s_waitcnt lgkmcnt(0)
  s_barrier
  v_mfma_f32_16x16x32_bf16 v[108:111], a[72:75], v[148:151], v[108:111]
  v_mfma_f32_16x16x32_bf16 v[128:131], a[76:79], v[148:151], 0
  v_mfma_f32_16x16x32_bf16 v[128:131], a[88:91], v[112:115], v[128:131]
  v_mfma_f32_16x16x32_bf16 v[128:131], a[100:103], v[84:87], v[128:131]
  v_cvt_pk_bf16_f32 v152, v108, v109
  v_cvt_pk_bf16_f32 v153, v110, v111
  v_mfma_f32_16x16x32_bf16 v[128:131], a[112:115], a[252:255], v[128:131]
  v_mfma_f32_16x16x32_bf16 v[128:131], a[124:127], a[248:251], v[128:131]
  v_mfma_f32_16x16x32_bf16 v[128:131], a[136:139], a[244:247], v[128:131]
  v_mfma_f32_16x16x32_bf16 v[108:111], a[140:143], a[244:247], 0
  v_mfma_f32_16x16x32_bf16 v[108:111], a[128:131], a[248:251], v[108:111]
  v_mfma_f32_16x16x32_bf16 v[108:111], a[116:119], a[252:255], v[108:111]
  v_cvt_pk_bf16_f32 v154, v128, v129
  v_cvt_pk_bf16_f32 v155, v130, v131
  v_mfma_f32_16x16x32_bf16 v[108:111], a[104:107], v[84:87], v[108:111]
  v_mfma_f32_16x16x32_bf16 v[108:111], a[92:95], v[112:115], v[108:111]
  v_mfma_f32_16x16x32_bf16 v[108:111], a[80:83], v[148:151], v[108:111]
  v_mfma_f32_16x16x32_bf16 v[128:131], v[70:73], v[76:79], v[36:39]
  v_mfma_f32_16x16x32_bf16 v[128:131], v[68:71], v[12:15], v[128:131]
  v_mfma_f32_16x16x32_bf16 v[132:135], v[122:125], v[76:79], v[32:35]
  v_cvt_pk_bf16_f32 v156, v108, v109
  v_cvt_pk_bf16_f32 v157, v110, v111
  v_mfma_f32_16x16x32_bf16 v[132:135], v[120:123], v[12:15], v[132:135]
  v_mfma_f32_16x16x32_bf16 v[168:171], v[142:145], v[76:79], v[164:167]
  v_exp_f32 v128, v128
  v_mfma_f32_16x16x32_bf16 v[168:171], v[140:143], v[12:15], v[168:171]
  v_exp_f32 v129, v129
  v_mfma_f32_16x16x32_bf16 v[172:175], v[154:157], v[76:79], v[104:107]
  v_exp_f32 v130, v130
  v_mfma_f32_16x16x32_bf16 v[172:175], v[152:155], v[12:15], v[172:175]
  v_exp_f32 v131, v131
  v_mfma_f32_16x16x32_bf16 v[104:107], v[68:71], v[100:103], v[40:43]
  v_exp_f32 v132, v132
  v_mfma_f32_16x16x32_bf16 v[104:107], v[70:73], v[14:17], v[104:107]
  v_exp_f32 v133, v133
  v_mfma_f32_16x16x32_bf16 v[108:111], v[120:123], v[100:103], v[36:39]
  v_exp_f32 v134, v134
  v_mfma_f32_16x16x32_bf16 v[108:111], v[122:125], v[14:17], v[108:111]
  v_exp_f32 v135, v135
  v_mfma_f32_16x16x32_bf16 v[72:75], v[140:143], v[100:103], v[160:163]
  v_exp_f32 v168, v168
  v_mfma_f32_16x16x32_bf16 v[72:75], v[142:145], v[14:17], v[72:75]
  v_exp_f32 v169, v169
  v_mfma_f32_16x16x32_bf16 v[68:71], v[152:155], v[100:103], v[164:167]
  v_exp_f32 v170, v170
  v_mfma_f32_16x16x32_bf16 v[68:71], v[154:157], v[14:17], v[68:71]
  v_exp_f32 v171, v171
  v_mfma_f32_16x16x32_bf16 v[76:79], v[88:91], a[144:147], 0
  v_exp_f32 v172, v172
  v_mfma_f32_16x16x32_bf16 v[76:79], v[92:95], a[156:159], v[76:79]
  v_exp_f32 v173, v173
  v_mfma_f32_16x16x32_bf16 v[76:79], v[116:119], a[168:171], v[76:79]
  v_exp_f32 v174, v174
  v_mfma_f32_16x16x32_bf16 v[76:79], v[96:99], a[180:183], v[76:79]
  v_exp_f32 v175, v175
  v_mfma_f32_16x16x32_bf16 v[76:79], v[136:139], a[192:195], v[76:79]
  v_cvt_pk_bf16_f32 v128, v128, v129
  v_cvt_pk_bf16_f32 v129, v130, v131
  v_mfma_f32_16x16x32_bf16 v[76:79], v[80:83], a[204:207], v[76:79]
  v_cvt_pk_bf16_f32 v130, v132, v133
  v_cvt_pk_bf16_f32 v131, v134, v135
  v_mfma_f32_16x16x32_bf16 v[100:103], v[80:83], a[208:211], 0
  v_cvt_pk_bf16_f32 v132, v168, v169
  v_cvt_pk_bf16_f32 v133, v170, v171
  v_mfma_f32_16x16x32_bf16 v[100:103], v[136:139], a[196:199], v[100:103]
  v_cvt_pk_bf16_f32 v134, v172, v173
  v_cvt_pk_bf16_f32 v135, v174, v175
  v_mfma_f32_16x16x32_bf16 v[100:103], v[96:99], a[184:187], v[100:103]
  v_cvt_pk_bf16_f32 v140, v76, v77
  v_cvt_pk_bf16_f32 v141, v78, v79
  v_mfma_f32_16x16x32_bf16 v[100:103], v[116:119], a[172:175], v[100:103]
  v_exp_f32 v104, v104
  v_mfma_f32_16x16x32_bf16 v[100:103], v[92:95], a[160:163], v[100:103]
  v_exp_f32 v105, v105
  v_mfma_f32_16x16x32_bf16 v[100:103], v[88:91], a[148:151], v[100:103]
  v_exp_f32 v106, v106
  v_mfma_f32_16x16x32_bf16 v[120:123], v[88:91], a[152:155], 0
  v_exp_f32 v107, v107
  v_mfma_f32_16x16x32_bf16 v[120:123], v[92:95], a[164:167], v[120:123]
  v_exp_f32 v108, v108
  v_mfma_f32_16x16x32_bf16 v[120:123], v[116:119], a[176:179], v[120:123]
  v_cvt_pk_bf16_f32 v144, v100, v101
  v_cvt_pk_bf16_f32 v145, v102, v103
  v_mfma_f32_16x16x32_bf16 v[120:123], v[96:99], a[188:191], v[120:123]
  v_exp_f32 v109, v109
  v_mfma_f32_16x16x32_bf16 v[120:123], v[136:139], a[200:203], v[120:123]
  v_exp_f32 v110, v110
  v_mfma_f32_16x16x32_bf16 v[120:123], v[80:83], a[212:215], v[120:123]
  v_exp_f32 v111, v111
  v_mfma_f32_16x16x32_bf16 v[76:79], v[148:151], a[144:147], 0
  v_exp_f32 v72, v72
  v_mfma_f32_16x16x32_bf16 v[76:79], v[112:115], a[156:159], v[76:79]
  v_exp_f32 v73, v73
  v_mfma_f32_16x16x32_bf16 v[76:79], v[84:87], a[168:171], v[76:79]
  v_cvt_pk_bf16_f32 v136, v120, v121
  v_cvt_pk_bf16_f32 v137, v122, v123
  v_mfma_f32_16x16x32_bf16 v[76:79], a[252:255], a[180:183], v[76:79]
  ds_read_b128 v[88:91], v3 offset:0
  v_cvt_pk_bf16_f32 v104, v104, v105
  v_mfma_f32_16x16x32_bf16 v[76:79], a[248:251], a[192:195], v[76:79]
  ds_read_b128 v[92:95], v3 offset:4096
  v_cvt_pk_bf16_f32 v105, v106, v107
  v_mfma_f32_16x16x32_bf16 v[76:79], a[244:247], a[204:207], v[76:79]
  ds_read_b128 v[100:103], v3 offset:8192
  v_cvt_pk_bf16_f32 v106, v108, v109
  v_mfma_f32_16x16x32_bf16 v[80:83], a[244:247], a[208:211], 0
  ds_read_b128 v[116:119], v3 offset:12288
  v_cvt_pk_bf16_f32 v107, v110, v111
  v_mfma_f32_16x16x32_bf16 v[80:83], a[248:251], a[196:199], v[80:83]
  ds_read_b128 v[120:123], v3 offset:16384
  v_cvt_pk_bf16_f32 v108, v72, v73
  v_mfma_f32_16x16x32_bf16 v[80:83], a[252:255], a[184:187], v[80:83]
  v_cvt_pk_bf16_f32 v142, v76, v77
  v_cvt_pk_bf16_f32 v143, v78, v79
  v_mfma_f32_16x16x32_bf16 v[80:83], v[84:87], a[172:175], v[80:83]
  ds_read_b128 v[124:127], v3 offset:20480
  v_mfma_f32_16x16x32_bf16 v[80:83], v[112:115], a[160:163], v[80:83]
  v_exp_f32 v74, v74
  v_mfma_f32_16x16x32_bf16 v[80:83], v[148:151], a[148:151], v[80:83]
  v_exp_f32 v75, v75
  v_mfma_f32_16x16x32_bf16 v[76:79], v[148:151], a[152:155], 0
  v_exp_f32 v68, v68
  v_mfma_f32_16x16x32_bf16 v[76:79], v[112:115], a[164:167], v[76:79]
  v_exp_f32 v69, v69
  v_mfma_f32_16x16x32_bf16 v[76:79], v[84:87], a[176:179], v[76:79]
  v_cvt_pk_bf16_f32 v146, v80, v81
  v_cvt_pk_bf16_f32 v147, v82, v83
  v_mfma_f32_16x16x32_bf16 v[76:79], a[252:255], a[188:191], v[76:79]
  v_mov_b64 v[148:149], 0
  v_cvt_pk_bf16_f32 v109, v74, v75
  v_mfma_f32_16x16x32_bf16 v[76:79], a[248:251], a[200:203], v[76:79]
  v_exp_f32 v70, v70
  v_mfma_f32_16x16x32_bf16 v[76:79], a[244:247], a[212:215], v[76:79]
  s_waitcnt lgkmcnt(0)
  v_exp_f32 v71, v71
  v_mfma_f32_16x16x32_bf16 v[112:115], v[88:91], v[184:187], 0
  v_cvt_pk_bf16_f32 v110, v68, v69
  v_cvt_pk_bf16_f32 v111, v70, v71
  v_mfma_f32_16x16x32_bf16 v[112:115], v[92:95], v[200:203], v[112:115]
  v_mfma_f32_16x16x32_bf16 v[112:115], v[100:103], v[216:219], v[112:115]
  v_cvt_pk_bf16_f32 v138, v76, v77
  v_cvt_pk_bf16_f32 v139, v78, v79
  v_mfma_f32_16x16x32_bf16 v[112:115], v[116:119], v[232:235], v[112:115]
  v_mov_b64 v[96:97], 0
  v_mfma_f32_16x16x32_bf16 v[112:115], v[120:123], v[248:251], v[112:115]
  v_mfma_f32_16x16x32_bf16 v[112:115], v[124:127], a[224:227], v[112:115]
  v_smfmac_f32_16x16x64_bf16 v[148:151], a[240:243], v[128:135], v10
  v_mfma_f32_16x16x32_bf16 v[76:79], v[140:143], v[132:135], 0
  v_mfma_f32_16x16x32_bf16 v[76:79], v[56:59], v[128:131], v[76:79]
  v_mfma_f32_16x16x32_bf16 v[80:83], v[60:63], v[128:131], 0
  v_mfma_f32_16x16x32_bf16 v[80:83], v[144:147], v[132:135], v[80:83]
  v_mfma_f32_16x16x32_bf16 v[68:71], v[136:139], v[132:135], 0
  v_add_f32 v148, v148, v149
  v_mfma_f32_16x16x32_bf16 v[68:71], v[64:67], v[128:131], v[68:71]
  v_rcp_f32 v150, v148
  v_smfmac_f32_16x16x64_bf16 v[96:99], a[240:243], v[104:111], v10
  v_max3_f32 v9, v148, v150, v9
  v_mul_f32 v76, v150, v76
  v_mfma_f32_16x16x32_bf16 v[72:75], v[140:143], v[108:111], 0
  v_mul_f32 v77, v150, v77
  v_mul_f32 v78, v150, v78
  v_mfma_f32_16x16x32_bf16 v[72:75], v[56:59], v[104:107], v[72:75]
  v_mul_f32 v79, v150, v79
  v_cvt_pk_bf16_f32 v76, v76, v77
  v_mfma_f32_16x16x32_bf16 v[84:87], v[60:63], v[104:107], 0
  v_cvt_pk_bf16_f32 v77, v78, v79
  v_mul_f32 v80, v150, v80
  v_mfma_f32_16x16x32_bf16 v[84:87], v[144:147], v[108:111], v[84:87]
  v_mul_f32 v81, v150, v81
  v_mul_f32 v82, v150, v82
  v_mfma_f32_16x16x32_bf16 v[56:59], v[136:139], v[108:111], 0
  v_add_f32 v96, v96, v97
  v_mul_f32 v83, v150, v83
  v_mfma_f32_16x16x32_bf16 v[56:59], v[64:67], v[104:107], v[56:59]
  v_rcp_f32 v98, v96
  v_mfma_f32_16x16x32_bf16 v[60:63], v[124:127], a[228:231], 0
  v_cvt_pk_bf16_f32 v80, v80, v81
  v_cvt_pk_bf16_f32 v81, v82, v83
  v_mfma_f32_16x16x32_bf16 v[60:63], v[120:123], v[252:255], v[60:63]
  v_mul_f32 v68, v150, v68
  v_mul_f32 v69, v150, v69
  v_mfma_f32_16x16x32_bf16 v[60:63], v[116:119], v[236:239], v[60:63]
  ds_read_b128 v[104:107], v4 offset:0
  ds_read_b128 v[108:111], v4 offset:4096
  v_mfma_f32_16x16x32_bf16 v[60:63], v[100:103], v[220:223], v[60:63]
  ds_read_b128 v[132:135], v4 offset:8192
  ds_read_b128 v[136:139], v4 offset:12288
  v_mfma_f32_16x16x32_bf16 v[60:63], v[92:95], v[204:207], v[60:63]
  ds_read_b128 v[140:143], v4 offset:16384
  ds_read_b128 v[144:147], v4 offset:20480
  v_mfma_f32_16x16x32_bf16 v[60:63], v[88:91], v[188:191], v[60:63]
  v_mul_f32 v70, v150, v70
  v_mul_f32 v71, v150, v71
  v_mfma_f32_16x16x32_bf16 v[128:131], v[88:91], v[192:195], 0
  v_cvt_pk_bf16_f32 v68, v68, v69
  v_cvt_pk_bf16_f32 v69, v70, v71
  v_mfma_f32_16x16x32_bf16 v[128:131], v[92:95], v[208:211], v[128:131]
  v_max3_f32 v9, v96, v98, v9
  v_mul_f32 v72, v98, v72
  v_mfma_f32_16x16x32_bf16 v[128:131], v[100:103], v[224:227], v[128:131]
L_hop_1_2:
  s_cbranch_execz L_walk
  v_cvt_pk_bf16_f32 v112, v112, v60
  v_cvt_pk_bf16_f32 v113, v113, v61
  v_mfma_f32_16x16x32_bf16 v[128:131], v[116:119], v[240:243], v[128:131]
  v_cvt_pk_bf16_f32 v114, v114, v62
  v_cvt_pk_bf16_f32 v115, v115, v63
  v_mfma_f32_16x16x32_bf16 v[128:131], v[120:123], a[216:219], v[128:131]
  buffer_store_dword v112, v7, s[24:27], s33 offen offset:0 nt
  v_mfma_f32_16x16x32_bf16 v[128:131], v[124:127], a[232:235], v[128:131]
  v_mul_f32 v73, v98, v73
  v_mul_f32 v74, v98, v74
  v_mfma_f32_16x16x32_bf16 v[148:151], v[124:127], a[236:239], 0
  v_mul_f32 v75, v98, v75
  v_cvt_pk_bf16_f32 v72, v72, v73
  v_mfma_f32_16x16x32_bf16 v[148:151], v[120:123], a[220:223], v[148:151]
  buffer_store_dword v113, v7, s[24:27], s33 offen offset:384 nt
  v_mfma_f32_16x16x32_bf16 v[148:151], v[116:119], v[244:247], v[148:151]
  ds_read_b128 a[244:247], v3 offset:512
  ds_read_b128 a[248:251], v3 offset:4608
  v_mfma_f32_16x16x32_bf16 v[148:151], v[100:103], v[228:231], v[148:151]
  ds_read_b128 a[252:255], v3 offset:8704
  ds_read_b128 v[60:63], v3 offset:12800
  v_mfma_f32_16x16x32_bf16 v[148:151], v[92:95], v[212:215], v[148:151]
  buffer_store_dword v114, v7, s[24:27], s33 offen offset:768 nt
  v_mfma_f32_16x16x32_bf16 v[148:151], v[88:91], v[196:199], v[148:151]
  s_waitcnt lgkmcnt(4)
  ds_read_b128 v[64:67], v3 offset:16896
  ds_read_b128 v[92:95], v3 offset:20992
  v_mfma_f32_16x16x32_bf16 v[88:91], v[104:107], v[184:187], 0
  v_cvt_pk_bf16_f32 v73, v74, v75
  v_mul_f32 v84, v98, v84
  v_mfma_f32_16x16x32_bf16 v[88:91], v[108:111], v[200:203], v[88:91]
  buffer_store_dword v115, v7, s[24:27], s33 offen offset:1152 nt
  v_mfma_f32_16x16x32_bf16 v[88:91], v[132:135], v[216:219], v[88:91]
  v_cvt_pk_bf16_f32 v128, v128, v148
  v_cvt_pk_bf16_f32 v129, v129, v149
  v_mfma_f32_16x16x32_bf16 v[88:91], v[136:139], v[232:235], v[88:91]
  v_cvt_pk_bf16_f32 v130, v130, v150
  v_cvt_pk_bf16_f32 v131, v131, v151
  v_mfma_f32_16x16x32_bf16 v[88:91], v[140:143], v[248:251], v[88:91]
  buffer_store_dword v128, v8, s[24:27], s33 offen offset:0 nt
  v_mfma_f32_16x16x32_bf16 v[88:91], v[144:147], a[224:227], v[88:91]
  v_mul_f32 v85, v98, v85
  v_mul_f32 v86, v98, v86
  v_mfma_f32_16x16x32_bf16 v[112:115], v[144:147], a[228:231], 0
  v_mul_f32 v87, v98, v87
  v_cvt_pk_bf16_f32 v84, v84, v85
  v_mfma_f32_16x16x32_bf16 v[112:115], v[140:143], v[252:255], v[112:115]
  buffer_store_dword v129, v8, s[24:27], s33 offen offset:384 nt
  v_mfma_f32_16x16x32_bf16 v[112:115], v[136:139], v[236:239], v[112:115]
  v_cvt_pk_bf16_f32 v85, v86, v87
  v_mul_f32 v56, v98, v56
  v_mfma_f32_16x16x32_bf16 v[112:115], v[132:135], v[220:223], v[112:115]
  v_mul_f32 v57, v98, v57
  v_mul_f32 v58, v98, v58
  v_mfma_f32_16x16x32_bf16 v[112:115], v[108:111], v[204:207], v[112:115]
  buffer_store_dword v130, v8, s[24:27], s33 offen offset:768 nt
  v_mfma_f32_16x16x32_bf16 v[112:115], v[104:107], v[188:191], v[112:115]
  s_waitcnt lgkmcnt(0)
  v_mul_f32 v59, v98, v59
  v_cvt_pk_bf16_f32 v56, v56, v57
  v_mfma_f32_16x16x32_bf16 v[100:103], a[244:247], v[184:187], 0
  v_cvt_pk_bf16_f32 v57, v58, v59
  v_cmp_nge_f32 vcc, 0x53800000, v9
  v_mfma_f32_16x16x32_bf16 v[100:103], a[248:251], v[200:203], v[100:103]
  buffer_store_dword v131, v8, s[24:27], s33 offen offset:1152 nt
  v_mfma_f32_16x16x32_bf16 v[100:103], a[252:255], v[216:219], v[100:103]
  s_add_u32 s33, s33, s98
  v_cvt_pk_bf16_f32 v88, v88, v112
  v_cvt_pk_bf16_f32 v89, v89, v113
  v_mfma_f32_16x16x32_bf16 v[100:103], v[60:63], v[232:235], v[100:103]
  s_or_b32 s6, vcc_lo, vcc_hi
  v_cvt_pk_bf16_f32 v90, v90, v114
  v_cvt_pk_bf16_f32 v91, v91, v115
  v_mfma_f32_16x16x32_bf16 v[100:103], v[64:67], v[248:251], v[100:103]
  buffer_store_dword v88, v7, s[24:27], s34 offen offset:0 nt
  v_mfma_f32_16x16x32_bf16 v[100:103], v[92:95], a[224:227], v[100:103]
  ds_write2st64_b32 v5, v76, v77 offset0:0 offset1:4
  v_mfma_f32_16x16x32_bf16 v[96:99], v[92:95], a[228:231], 0
  ds_write2st64_b32 v5, v80, v81 offset0:8 offset1:12
  v_mfma_f32_16x16x32_bf16 v[96:99], v[64:67], v[252:255], v[96:99]
  buffer_store_dword v89, v7, s[24:27], s34 offen offset:384 nt
  v_mfma_f32_16x16x32_bf16 v[96:99], v[60:63], v[236:239], v[96:99]
  ds_read_b128 v[76:79], v4 offset:512
  ds_read_b128 v[80:83], v4 offset:4608
  v_mfma_f32_16x16x32_bf16 v[96:99], a[252:255], v[220:223], v[96:99]
  ds_write2st64_b32 v5, v68, v69 offset0:16 offset1:20
  v_mfma_f32_16x16x32_bf16 v[96:99], a[248:251], v[204:207], v[96:99]
  buffer_store_dword v90, v7, s[24:27], s34 offen offset:768 nt
  v_mfma_f32_16x16x32_bf16 v[96:99], a[244:247], v[188:191], v[96:99]
  ds_write2st64_b32 v5, v72, v73 offset0:1 offset1:5
  v_mfma_f32_16x16x32_bf16 v[68:71], a[244:247], v[192:195], 0
  ds_write2st64_b32 v5, v84, v85 offset0:9 offset1:13
  v_mfma_f32_16x16x32_bf16 v[68:71], a[248:251], v[208:211], v[68:71]
  buffer_store_dword v91, v7, s[24:27], s34 offen offset:1152 nt
  v_mfma_f32_16x16x32_bf16 v[68:71], a[252:255], v[224:227], v[68:71]
  s_add_u32 s34, s34, s98
  v_cvt_pk_bf16_f32 v100, v100, v96
  v_cvt_pk_bf16_f32 v101, v101, v97
  v_mfma_f32_16x16x32_bf16 v[68:71], v[60:63], v[240:243], v[68:71]
  v_cvt_pk_bf16_f32 v102, v102, v98
  v_cvt_pk_bf16_f32 v103, v103, v99
  v_mfma_f32_16x16x32_bf16 v[68:71], v[64:67], a[216:219], v[68:71]
  buffer_store_dword v100, v7, s[24:27], s35 offen offset:0 nt
  v_mfma_f32_16x16x32_bf16 v[68:71], v[92:95], a[232:235], v[68:71]
  ds_write2st64_b32 v5, v56, v57 offset0:17 offset1:21
  v_mfma_f32_16x16x32_bf16 v[96:99], v[92:95], a[236:239], 0
  ds_read_b128 v[84:87], v4 offset:8704
  v_mov_b32 v54, s6
  v_mfma_f32_16x16x32_bf16 v[96:99], v[64:67], a[220:223], v[96:99]
  buffer_store_dword v101, v7, s[24:27], s35 offen offset:384 nt
  v_mfma_f32_16x16x32_bf16 v[96:99], v[60:63], v[244:247], v[96:99]
  ds_read_b128 v[88:91], v4 offset:12800
  ds_read_b128 v[72:75], v4 offset:16896
  v_mfma_f32_16x16x32_bf16 v[96:99], a[252:255], v[228:231], v[96:99]
  ds_write_b32 v11, v54
  v_mfma_f32_16x16x32_bf16 v[96:99], a[248:251], v[212:215], v[96:99]
  buffer_store_dword v102, v7, s[24:27], s35 offen offset:768 nt
  v_mfma_f32_16x16x32_bf16 v[96:99], a[244:247], v[196:199], v[96:99]
  s_waitcnt lgkmcnt(8)
  ds_read_b128 v[64:67], v4 offset:20992
  v_xor_b32 v3, 40960, v3
  v_xor_b32 v4, 40960, v4
  v_mfma_f32_16x16x32_bf16 v[60:63], v[76:79], v[184:187], 0
  s_waitcnt lgkmcnt(1)
  s_barrier
  v_mfma_f32_16x16x32_bf16 v[60:63], v[80:83], v[200:203], v[60:63]
  buffer_store_dword v103, v7, s[24:27], s35 offen offset:1152 nt
  v_mfma_f32_16x16x32_bf16 v[60:63], v[84:87], v[216:219], v[60:63]
  v_cvt_pk_bf16_f32 v68, v68, v96
  v_cvt_pk_bf16_f32 v69, v69, v97
  v_mfma_f32_16x16x32_bf16 v[60:63], v[88:91], v[232:235], v[60:63]
  s_waitcnt lgkmcnt(0)
  v_cvt_pk_bf16_f32 v70, v70, v98
  v_cvt_pk_bf16_f32 v71, v71, v99
  v_mfma_f32_16x16x32_bf16 v[60:63], v[72:75], v[248:251], v[60:63]
  buffer_store_dword v68, v8, s[24:27], s35 offen offset:0 nt
  v_mfma_f32_16x16x32_bf16 v[60:63], v[64:67], a[224:227], v[60:63]
  ds_read_b128 a[244:247], v3 offset:0
  ds_read_b128 a[248:251], v3 offset:4096
  v_mfma_f32_16x16x32_bf16 v[92:95], v[64:67], a[228:231], 0
  ds_read_b128 a[252:255], v3 offset:8192
  ds_read_b128 v[56:59], v3 offset:12288
  v_mfma_f32_16x16x32_bf16 v[92:95], v[72:75], v[252:255], v[92:95]
  buffer_store_dword v69, v8, s[24:27], s35 offen offset:384 nt
  v_mfma_f32_16x16x32_bf16 v[92:95], v[88:91], v[236:239], v[92:95]
  ds_read_b128 v[64:67], v3 offset:16384
  ds_read_b128 v[72:75], v3 offset:20480
  v_mfma_f32_16x16x32_bf16 v[92:95], v[84:87], v[220:223], v[92:95]
  v_mov_b32 v11, 159744
  v_mfma_f32_16x16x32_bf16 v[92:95], v[80:83], v[204:207], v[92:95]
  buffer_store_dword v70, v8, s[24:27], s35 offen offset:768 nt
  v_mfma_f32_16x16x32_bf16 v[92:95], v[76:79], v[188:191], v[92:95]
  s_waitcnt lgkmcnt(2)
  ds_read2_b32 v[80:81], v11 offset0:0 offset1:2
  ds_read2_b32 v[82:83], v11 offset0:4 offset1:6
  v_mfma_f32_16x16x32_bf16 v[76:79], a[244:247], v[184:187], 0
  buffer_store_dword v71, v8, s[24:27], s35 offen offset:1152 nt
  v_mfma_f32_16x16x32_bf16 v[76:79], a[248:251], v[200:203], v[76:79]
  v_mfma_f32_16x16x32_bf16 v[76:79], a[252:255], v[216:219], v[76:79]
  v_cvt_pk_bf16_f32 v60, v60, v92
  v_cvt_pk_bf16_f32 v61, v61, v93
  v_mfma_f32_16x16x32_bf16 v[76:79], v[56:59], v[232:235], v[76:79]
  s_waitcnt lgkmcnt(2)
  v_cvt_pk_bf16_f32 v62, v62, v94
  v_cvt_pk_bf16_f32 v63, v63, v95
  v_mfma_f32_16x16x32_bf16 v[76:79], v[64:67], v[248:251], v[76:79]
  buffer_store_dword v60, v7, s[24:27], s36 offen offset:0 nt
  v_mfma_f32_16x16x32_bf16 v[76:79], v[72:75], a[224:227], v[76:79]
  s_waitcnt lgkmcnt(0)
  v_or3_b32 v80, v80, v81, v82
  v_or_b32 v80, v80, v83
  v_mfma_f32_16x16x32_bf16 v[100:103], v[72:75], a[228:231], 0
  buffer_store_dword v61, v7, s[24:27], s36 offen offset:384 nt
  v_mfma_f32_16x16x32_bf16 v[100:103], v[64:67], v[252:255], v[100:103]
  v_readfirstlane_b32 s49, v80
  v_mfma_f32_16x16x32_bf16 v[100:103], v[56:59], v[236:239], v[100:103]
  buffer_store_dword v62, v7, s[24:27], s36 offen offset:768 nt
  v_mfma_f32_16x16x32_bf16 v[100:103], a[252:255], v[220:223], v[100:103]
  ds_read_b128 v[68:71], v4 offset:0
  ds_read_b128 v[80:83], v4 offset:4096
  v_mfma_f32_16x16x32_bf16 v[100:103], a[248:251], v[204:207], v[100:103]
  buffer_store_dword v63, v7, s[24:27], s36 offen offset:1152 nt
  v_mfma_f32_16x16x32_bf16 v[100:103], a[244:247], v[188:191], v[100:103]
  ds_read_b128 v[84:87], v4 offset:8192
  ds_read_b128 v[88:91], v4 offset:12288
  v_mfma_f32_16x16x32_bf16 v[60:63], a[244:247], v[192:195], 0
  ds_read_b128 v[92:95], v4 offset:16384
  ds_read_b128 v[96:99], v4 offset:20480
  v_mfma_f32_16x16x32_bf16 v[60:63], a[248:251], v[208:211], v[60:63]
  v_mfma_f32_16x16x32_bf16 v[60:63], a[252:255], v[224:227], v[60:63]
  v_cvt_pk_bf16_f32 v76, v76, v100
  v_cvt_pk_bf16_f32 v77, v77, v101
  v_mfma_f32_16x16x32_bf16 v[60:63], v[56:59], v[240:243], v[60:63]
  v_cvt_pk_bf16_f32 v78, v78, v102
  v_cvt_pk_bf16_f32 v79, v79, v103
  v_mfma_f32_16x16x32_bf16 v[60:63], v[64:67], a[216:219], v[60:63]
  buffer_store_dword v76, v7, s[24:27], s33 offen offset:0 nt
  v_mfma_f32_16x16x32_bf16 v[60:63], v[72:75], a[232:235], v[60:63]
  v_mfma_f32_16x16x32_bf16 v[100:103], v[72:75], a[236:239], 0
  buffer_store_dword v77, v7, s[24:27], s33 offen offset:384 nt
  v_mfma_f32_16x16x32_bf16 v[100:103], v[64:67], a[220:223], v[100:103]
  v_mfma_f32_16x16x32_bf16 v[100:103], v[56:59], v[244:247], v[100:103]
  buffer_store_dword v78, v7, s[24:27], s33 offen offset:768 nt
  v_mfma_f32_16x16x32_bf16 v[100:103], a[252:255], v[228:231], v[100:103]
  v_mfma_f32_16x16x32_bf16 v[100:103], a[248:251], v[212:215], v[100:103]
  buffer_store_dword v79, v7, s[24:27], s33 offen offset:1152 nt
  v_mfma_f32_16x16x32_bf16 v[100:103], a[244:247], v[196:199], v[100:103]
  s_waitcnt lgkmcnt(0)
  v_mfma_f32_16x16x32_bf16 v[56:59], v[68:71], v[184:187], 0
  v_mfma_f32_16x16x32_bf16 v[56:59], v[80:83], v[200:203], v[56:59]
  v_mfma_f32_16x16x32_bf16 v[56:59], v[84:87], v[216:219], v[56:59]
  v_cvt_pk_bf16_f32 v60, v60, v100
  v_cvt_pk_bf16_f32 v61, v61, v101
  v_mfma_f32_16x16x32_bf16 v[56:59], v[88:91], v[232:235], v[56:59]
  v_cvt_pk_bf16_f32 v62, v62, v102
  v_cvt_pk_bf16_f32 v63, v63, v103
  v_mfma_f32_16x16x32_bf16 v[56:59], v[92:95], v[248:251], v[56:59]
  buffer_store_dword v60, v8, s[24:27], s33 offen offset:0 nt
  v_mfma_f32_16x16x32_bf16 v[56:59], v[96:99], a[224:227], v[56:59]
  v_mfma_f32_16x16x32_bf16 v[64:67], v[96:99], a[228:231], 0
  buffer_store_dword v61, v8, s[24:27], s33 offen offset:384 nt
  v_mfma_f32_16x16x32_bf16 v[64:67], v[92:95], v[252:255], v[64:67]
  v_mfma_f32_16x16x32_bf16 v[64:67], v[88:91], v[236:239], v[64:67]
  buffer_store_dword v62, v8, s[24:27], s33 offen offset:768 nt
  v_mfma_f32_16x16x32_bf16 v[64:67], v[84:87], v[220:223], v[64:67]
  v_mfma_f32_16x16x32_bf16 v[64:67], v[80:83], v[204:207], v[64:67]
  buffer_store_dword v63, v8, s[24:27], s33 offen offset:1152 nt
  v_mfma_f32_16x16x32_bf16 v[64:67], v[68:71], v[188:191], v[64:67]
  s_nop 7
  v_cvt_pk_bf16_f32 v56, v56, v64
  v_cvt_pk_bf16_f32 v57, v57, v65
  v_cvt_pk_bf16_f32 v58, v58, v66
  v_cvt_pk_bf16_f32 v59, v59, v67
  buffer_store_dword v56, v7, s[24:27], s34 offen offset:0 nt
  buffer_store_dword v57, v7, s[24:27], s34 offen offset:384 nt
  buffer_store_dword v58, v7, s[24:27], s34 offen offset:768 nt
  buffer_store_dword v59, v7, s[24:27], s34 offen offset:1152 nt
  s_cmp_lg_u32 s49, 0
  s_cbranch_scc1 L_safe
  s_endpgm
L_hop_2_2:
  s_cbranch_execz L_walk
L_pad4466:
L_k11:
  s_cmp_lg_u32 s59, 11
  s_cbranch_scc1 L_k12
  v_mfma_f32_16x16x32_bf16 v[104:107], a[0:3], v[88:91], 0
  v_mov_b32 v54, s12
  v_mov_b32 v55, s13
  v_mfma_f32_16x16x32_bf16 v[104:107], a[12:15], v[92:95], v[104:107]
  v_mov_b32 v74, 159808
  v_mfma_f32_16x16x32_bf16 v[104:107], a[24:27], v[116:119], v[104:107]
  v_cvt_pk_bf16_f32 v66, v132, v133
  v_cvt_pk_bf16_f32 v67, v134, v135
  v_mfma_f32_16x16x32_bf16 v[104:107], a[36:39], v[96:99], v[104:107]
  ds_read_b128 v[112:115], v74
  v_mfma_f32_16x16x32_bf16 v[104:107], a[48:51], v[136:139], v[104:107]
  s_waitcnt lgkmcnt(1)
  v_mfma_f32_16x16x32_bf16 v[104:107], a[60:63], v[80:83], v[104:107]
  v_mfma_f32_16x16x32_bf16 v[84:87], a[64:67], v[80:83], 0
  v_mfma_f32_16x16x32_bf16 v[84:87], a[52:55], v[136:139], v[84:87]
  v_mfma_f32_16x16x32_bf16 v[84:87], a[40:43], v[96:99], v[84:87]
  s_waitcnt lgkmcnt(0)
  v_mul_f32 v104, s42, v104
  v_mul_f32 v105, s42, v105
  v_mfma_f32_16x16x32_bf16 v[84:87], a[28:31], v[116:119], v[84:87]
  v_mul_f32 v106, s42, v106
  v_mul_f32 v107, s42, v107
  v_mfma_f32_16x16x32_bf16 v[84:87], a[16:19], v[92:95], v[84:87]
  v_cvt_pk_bf16_f32 v18, v104, v105
  v_cvt_pk_bf16_f32 v19, v106, v107
  v_mfma_f32_16x16x32_bf16 v[84:87], a[4:7], v[88:91], v[84:87]
  v_and_b32 v112, v112, v113
  v_and_b32 v114, v114, v115
  v_mfma_f32_16x16x32_bf16 v[108:111], a[8:11], v[88:91], 0
  v_and_b32 v112, v112, v114
  v_mfma_f32_16x16x32_bf16 v[108:111], a[20:23], v[92:95], v[108:111]
  v_readfirstlane_b32 s49, v112
  v_mfma_f32_16x16x32_bf16 v[108:111], a[32:35], v[116:119], v[108:111]
  v_mul_f32 v84, s42, v84
  v_mul_f32 v85, s42, v85
  v_mfma_f32_16x16x32_bf16 v[108:111], a[44:47], v[96:99], v[108:111]
  s_cmp_lg_u32 s49, 0
  v_mul_f32 v86, s42, v86
  v_mul_f32 v87, s42, v87
  v_mfma_f32_16x16x32_bf16 v[108:111], a[56:59], v[136:139], v[108:111]
  s_cselect_b32 s49, s44, s22
  v_cvt_pk_bf16_f32 v104, v84, v85
  v_cvt_pk_bf16_f32 v105, v86, v87
  v_mfma_f32_16x16x32_bf16 v[108:111], a[68:71], v[80:83], v[108:111]
  s_cselect_b32 s96, 4096, s96
  v_mfma_f32_16x16x32_bf16 v[112:115], a[132:135], v[80:83], 0
  buffer_store_dwordx2 v[54:55], off, s[20:23], s49 sc1
  v_mfma_f32_16x16x32_bf16 v[112:115], a[120:123], v[136:139], v[112:115]
  s_branch L_r227
L_k12:
  s_cmp_lg_u32 s45, 2
  s_cbranch_scc1 L_k12g
  v_mfma_f32_16x16x32_bf16 v[104:107], a[0:3], v[88:91], 0
  s_sub_u32 s49, s44, 2097152
  s_lshr_b32 s49, s49, 9
  s_lshr_b32 s52, s49, 6
  v_mfma_f32_16x16x32_bf16 v[104:107], a[12:15], v[92:95], v[104:107]
  s_and_b32 s53, s49, 63
  s_mul_i32 s50, s52, 15
  s_lshl_b32 s51, s57, 5
  v_mfma_f32_16x16x32_bf16 v[104:107], a[24:27], v[116:119], v[104:107]
  s_cmp_eq_u32 s53, 63
  v_cvt_pk_bf16_f32 v66, v132, v133
  v_cvt_pk_bf16_f32 v67, v134, v135
  v_mfma_f32_16x16x32_bf16 v[104:107], a[36:39], v[96:99], v[104:107]
  s_cselect_b32 s53, s50, s53
  s_cselect_b32 s52, 60, s52
  s_cselect_b32 s51, 3072, s51
  v_mfma_f32_16x16x32_bf16 v[104:107], a[48:51], v[136:139], v[104:107]
  s_waitcnt lgkmcnt(0)
  s_mul_i32 s52, s52, 1572864
  s_mul_i32 s53, s53, 3072
  v_mfma_f32_16x16x32_bf16 v[104:107], a[60:63], v[80:83], v[104:107]
  s_add_u32 s52, s52, s53
  s_add_u32 s50, s52, 787968
  s_cmp_eq_u32 s51, 3072
  v_mfma_f32_16x16x32_bf16 v[84:87], a[64:67], v[80:83], 0
  s_cselect_b32 s10, 100663296, s10
  s_sub_u32 s51, s51, s43
  s_mul_i32 s51, s51, 14
  v_mfma_f32_16x16x32_bf16 v[84:87], a[52:55], v[136:139], v[84:87]
  s_sub_u32 s50, s50, s56
  s_add_u32 s58, s50, s51
  s_mul_i32 s50, s14, 98304
  v_mfma_f32_16x16x32_bf16 v[84:87], a[40:43], v[96:99], v[84:87]
  s_add_u32 s98, s58, s50
  v_mul_f32 v104, s42, v104
  v_mul_f32 v105, s42, v105
  v_mfma_f32_16x16x32_bf16 v[84:87], a[28:31], v[116:119], v[84:87]
  s_sub_u32 s49, s98, s43
  v_mul_f32 v106, s42, v106
  v_mul_f32 v107, s42, v107
  v_mfma_f32_16x16x32_bf16 v[84:87], a[16:19], v[92:95], v[84:87]
  s_add_u32 s31, s31, s49
  v_cvt_pk_bf16_f32 v18, v104, v105
  v_cvt_pk_bf16_f32 v19, v106, v107
  v_mfma_f32_16x16x32_bf16 v[84:87], a[4:7], v[88:91], v[84:87]
  s_add_u32 s32, s32, s49
  s_lshl_b32 s50, s50, 1
  s_sub_u32 s32, s32, s50
  v_mfma_f32_16x16x32_bf16 v[108:111], a[8:11], v[88:91], 0
  s_sub_u32 s37, s37, s49
  s_sub_u32 s38, s38, s49
  s_sub_u32 s39, s39, s49
  v_mfma_f32_16x16x32_bf16 v[108:111], a[20:23], v[92:95], v[108:111]
  s_sub_u32 s40, s40, s49
  s_lshl_b32 s49, s14, 2
  s_add_u32 s97, s49, 15
  v_mfma_f32_16x16x32_bf16 v[108:111], a[32:35], v[116:119], v[108:111]
  s_mov_b32 s45, 4
  v_mul_f32 v84, s42, v84
  v_mul_f32 v85, s42, v85
  v_mfma_f32_16x16x32_bf16 v[108:111], a[44:47], v[96:99], v[108:111]
  s_mov_b32 s96, 32768
  v_mul_f32 v86, s42, v86
  v_mul_f32 v87, s42, v87
  v_mfma_f32_16x16x32_bf16 v[108:111], a[56:59], v[136:139], v[108:111]
  s_mov_b64 s[100:101], -1
  v_cvt_pk_bf16_f32 v104, v84, v85
  v_cvt_pk_bf16_f32 v105, v86, v87
  v_mfma_f32_16x16x32_bf16 v[108:111], a[68:71], v[80:83], v[108:111]
  s_branch L_r225
L_k12g:
  s_cmp_lg_u32 s59, 12
  s_cbranch_scc1 L_k13
  s_waitcnt vmcnt(30)
  v_mfma_f32_16x16x32_bf16 v[104:107], a[0:3], v[88:91], 0
  v_cmp_eq_u64 vcc, s[12:13], v[52:53]
  v_mfma_f32_16x16x32_bf16 v[104:107], a[12:15], v[92:95], v[104:107]
  v_mfma_f32_16x16x32_bf16 v[104:107], a[24:27], v[116:119], v[104:107]
  s_and_b32 s49, vcc_lo, 1
  v_cvt_pk_bf16_f32 v66, v132, v133
  v_cvt_pk_bf16_f32 v67, v134, v135
  v_mfma_f32_16x16x32_bf16 v[104:107], a[36:39], v[96:99], v[104:107]
  s_lshl_b32 s49, s49, s14
  s_lshl_b32 s54, s3, 2
  s_add_u32 s54, s54, 159824
  v_mfma_f32_16x16x32_bf16 v[104:107], a[48:51], v[136:139], v[104:107]
  s_waitcnt lgkmcnt(0)
  v_mov_b32 v54, s54
  v_mov_b32 v55, s49
  v_mfma_f32_16x16x32_bf16 v[104:107], a[60:63], v[80:83], v[104:107]
  ds_write_b32 v54, v55
  v_mfma_f32_16x16x32_bf16 v[84:87], a[64:67], v[80:83], 0
  v_mfma_f32_16x16x32_bf16 v[84:87], a[52:55], v[136:139], v[84:87]
  v_mfma_f32_16x16x32_bf16 v[84:87], a[40:43], v[96:99], v[84:87]
  v_mul_f32 v104, s42, v104
  v_mul_f32 v105, s42, v105
  v_mfma_f32_16x16x32_bf16 v[84:87], a[28:31], v[116:119], v[84:87]
  s_waitcnt lgkmcnt(0)
  v_mul_f32 v106, s42, v106
  v_mul_f32 v107, s42, v107
  v_mfma_f32_16x16x32_bf16 v[84:87], a[16:19], v[92:95], v[84:87]
  v_cvt_pk_bf16_f32 v18, v104, v105
  v_cvt_pk_bf16_f32 v19, v106, v107
  v_mfma_f32_16x16x32_bf16 v[84:87], a[4:7], v[88:91], v[84:87]
  s_branch L_r219
L_k13:
  v_mov_b32 v54, 159824
  ds_read_b128 v[84:87], v54
  s_waitcnt lgkmcnt(0)
  v_and_b32 v84, v84, v85
  v_and_b32 v86, v86, v87
  v_and_b32 v84, v84, v86
  s_nop 0
  v_readfirstlane_b32 s49, v84
  s_nop 3
  s_lshr_b32 s50, s49, 3
  s_add_u32 s97, s97, s50
  s_cmp_eq_u32 s49, 1
  s_cselect_b32 s45, 3, 0
  s_cbranch_scc1 L_full
  s_branch L_loop
L_safe:
  s_nop 15
  s_waitcnt vmcnt(0) lgkmcnt(0)
  s_mov_b32 s10, 100663296
  v_mbcnt_lo_u32_b32 v58, -1, 0
  v_mbcnt_hi_u32_b32 v58, -1, v58
  v_lshrrev_b32 v59, 2, v58
  v_and_b32 v59, 4, v59
  v_xor_b32 v60, v59, v58
  s_cmp_eq_u32 s47, 63
  s_cselect_b32 s5, 4, 0
  v_and_b32 v60, s5, v60
  v_cmp_eq_u32 vcc, 0, v60
  s_cmp_eq_u32 s48, 63
  s_cselect_b32 s5, 0xc31044fe, 0
  v_mov_b32 v55, s5
  v_mov_b32 v54, 0xc31044fe
  v_cndmask_b32 v55, 0, v55, vcc
  v_cndmask_b32 v54, v54, 0, vcc
  v_add_u32 v0, s46, v2
  v_xor_b32 v1, 64, v0
  s_lshl_b32 s5, s48, 3
  s_add_u32 s5, s5, s3
  s_add_u32 s5, s5, 4
  s_mul_i32 s31, s5, s57
  s_add_u32 s5, s5, 4
  s_and_b32 s5, s5, 511
  s_mul_i32 s32, s5, s57
  v_lshrrev_b32 v59, 2, v59
  s_lshl_b32 s5, s47, 3
  s_add_u32 s5, s5, 4
  s_mul_i32 s5, s5, 384
  s_cmp_eq_u32 s47, 63
  s_cselect_b32 s49, 0, s5
  s_cselect_b32 s5, s5, 0
  s_cselect_b32 s6, s57, 0
  v_mul_u32_u24 v57, s6, v59
  v_sub_u32 v57, s5, v57
  s_lshl_b32 s50, s48, 3
  s_add_u32 s50, s50, 4
  s_xor_b32 s6, s4, 0
  s_lshl_b32 s6, s6, 1
  s_add_u32 s6, s6, s50
  s_and_b32 s6, s6, 511
  s_mul_i32 s6, s6, s57
  s_add_u32 s33, s6, s49
  s_xor_b32 s6, s4, 1
  s_lshl_b32 s6, s6, 1
  s_add_u32 s6, s6, s50
  s_and_b32 s6, s6, 511
  s_mul_i32 s6, s6, s57
  s_add_u32 s34, s6, s49
  s_xor_b32 s6, s4, 2
  s_lshl_b32 s6, s6, 1
  s_add_u32 s6, s6, s50
  s_and_b32 s6, s6, 511
  s_mul_i32 s6, s6, s57
  s_add_u32 s35, s6, s49
  s_xor_b32 s6, s4, 3
  s_lshl_b32 s6, s6, 1
  s_add_u32 s6, s6, s50
  s_and_b32 s6, s6, 511
  s_mul_i32 s6, s6, s57
  s_add_u32 s36, s6, s49
  s_lshl_b32 s5, s47, 3
  s_add_u32 s5, s5, 4
  v_lshrrev_b32 v59, 3, v58
  v_add_u32 v60, s5, v59
  v_and_b32 v60, 511, v60
  v_sub_u32 v60, v60, v59
  v_mul_i32_i24 v56, 0x180, v60
  v_add_u32 v6, v6, v56
  v_add_u32 v7, v7, v57
  v_add_u32 v8, v8, v57
  v_add_f32 v55, v54, v55
  s_cmp_eq_u32 s45, 3
  s_cselect_b32 s49, 15, 16
  s_cmp_eq_u32 s45, 4
  s_cselect_b32 s49, 17, s49
  s_mov_b32 s50, 0
  s_sub_u32 s56, s56, s43
  s_nop 7
L_sloop:
  s_barrier
  s_add_u32 m0, s46, 0
  s_nop 0
  buffer_load_dwordx4 v6, s[8:11], s31 offen offset:0 nt lds
  s_add_u32 m0, s46, 8064
  s_nop 0
  buffer_load_dwordx4 v6, s[8:11], s31 offen offset:128 nt lds
  s_add_u32 m0, s46, 16128
  s_nop 0
  buffer_load_dwordx4 v6, s[8:11], s31 offen offset:256 nt lds
  s_add_u32 m0, s46, 4096
  s_nop 0
  buffer_load_dwordx4 v6, s[8:11], s32 offen offset:0 nt lds
  s_add_u32 m0, s46, 12160
  s_nop 0
  buffer_load_dwordx4 v6, s[8:11], s32 offen offset:128 nt lds
  s_add_u32 m0, s46, 20224
  s_nop 0
  buffer_load_dwordx4 v6, s[8:11], s32 offen offset:256 nt lds
  s_waitcnt vmcnt(0)
  s_barrier
  ds_read_b128 a[244:247], v0 offset:0
  ds_read_b128 a[248:251], v1 offset:0
  ds_read_b128 a[252:255], v0 offset:8192
  ds_read_b128 v[76:79], v1 offset:8192
  ds_read_b128 v[80:83], v0 offset:16384
  ds_read_b128 v[84:87], v1 offset:16384
  s_waitcnt lgkmcnt(5)
  v_mfma_f32_16x16x32_bf16 v[68:71], a[0:3], a[244:247], 0
  s_waitcnt lgkmcnt(4)
  v_mfma_f32_16x16x32_bf16 v[68:71], a[12:15], a[248:251], v[68:71]
  s_waitcnt lgkmcnt(3)
  v_mfma_f32_16x16x32_bf16 v[68:71], a[24:27], a[252:255], v[68:71]
  s_waitcnt lgkmcnt(2)
  v_mfma_f32_16x16x32_bf16 v[68:71], a[36:39], v[76:79], v[68:71]
  s_waitcnt lgkmcnt(1)
  v_mfma_f32_16x16x32_bf16 v[68:71], a[48:51], v[80:83], v[68:71]
  s_waitcnt lgkmcnt(0)
  v_mfma_f32_16x16x32_bf16 v[68:71], a[60:63], v[84:87], v[68:71]
  v_mfma_f32_16x16x32_bf16 v[60:63], a[64:67], v[84:87], 0
  v_mfma_f32_16x16x32_bf16 v[60:63], a[52:55], v[80:83], v[60:63]
  v_mfma_f32_16x16x32_bf16 v[60:63], a[40:43], v[76:79], v[60:63]
  v_mfma_f32_16x16x32_bf16 v[60:63], a[28:31], a[252:255], v[60:63]
  v_mfma_f32_16x16x32_bf16 v[60:63], a[16:19], a[248:251], v[60:63]
  v_mfma_f32_16x16x32_bf16 v[60:63], a[4:7], a[244:247], v[60:63]
  v_mul_f32 v68, s42, v68
  v_mul_f32 v69, s42, v69
  v_mul_f32 v70, s42, v70
  v_mul_f32 v71, s42, v71
  v_cvt_pk_bf16_f32 v12, v68, v69
  v_cvt_pk_bf16_f32 v13, v70, v71
  v_mfma_f32_16x16x32_bf16 v[64:67], a[8:11], a[244:247], 0
  v_mfma_f32_16x16x32_bf16 v[64:67], a[20:23], a[248:251], v[64:67]
  v_mfma_f32_16x16x32_bf16 v[64:67], a[32:35], a[252:255], v[64:67]
  v_mfma_f32_16x16x32_bf16 v[64:67], a[44:47], v[76:79], v[64:67]
  v_mfma_f32_16x16x32_bf16 v[64:67], a[56:59], v[80:83], v[64:67]
  v_mfma_f32_16x16x32_bf16 v[64:67], a[68:71], v[84:87], v[64:67]
  v_mul_f32 v60, s42, v60
  v_mul_f32 v61, s42, v61
  v_mul_f32 v62, s42, v62
  v_mul_f32 v63, s42, v63
  v_cvt_pk_bf16_f32 v128, v60, v61
  v_cvt_pk_bf16_f32 v129, v62, v63
  v_mfma_f32_16x16x32_bf16 v[68:71], a[132:135], v[84:87], 0
  v_mfma_f32_16x16x32_bf16 v[68:71], a[120:123], v[80:83], v[68:71]
  v_mfma_f32_16x16x32_bf16 v[68:71], a[108:111], v[76:79], v[68:71]
  v_mfma_f32_16x16x32_bf16 v[68:71], a[96:99], a[252:255], v[68:71]
  v_mfma_f32_16x16x32_bf16 v[68:71], a[84:87], a[248:251], v[68:71]
  v_mfma_f32_16x16x32_bf16 v[68:71], a[72:75], a[244:247], v[68:71]
  v_mul_f32 v64, s42, v64
  v_mul_f32 v65, s42, v65
  v_mul_f32 v66, s42, v66
  v_mul_f32 v67, s42, v67
  v_cvt_pk_bf16_f32 v130, v64, v65
  v_cvt_pk_bf16_f32 v131, v66, v67
  v_mfma_f32_16x16x32_bf16 v[72:75], a[76:79], a[244:247], 0
  v_mfma_f32_16x16x32_bf16 v[72:75], a[88:91], a[248:251], v[72:75]
  v_mfma_f32_16x16x32_bf16 v[72:75], a[100:103], a[252:255], v[72:75]
  v_mfma_f32_16x16x32_bf16 v[72:75], a[112:115], v[76:79], v[72:75]
  v_mfma_f32_16x16x32_bf16 v[72:75], a[124:127], v[80:83], v[72:75]
  v_mfma_f32_16x16x32_bf16 v[72:75], a[136:139], v[84:87], v[72:75]
  v_cvt_pk_bf16_f32 v60, v68, v69
  v_cvt_pk_bf16_f32 v61, v70, v71
  v_mfma_f32_16x16x32_bf16 v[88:91], a[140:143], v[84:87], 0
  v_mfma_f32_16x16x32_bf16 v[88:91], a[128:131], v[80:83], v[88:91]
  v_mfma_f32_16x16x32_bf16 v[88:91], a[116:119], v[76:79], v[88:91]
  v_mfma_f32_16x16x32_bf16 v[88:91], a[104:107], a[252:255], v[88:91]
  v_mfma_f32_16x16x32_bf16 v[88:91], a[92:95], a[248:251], v[88:91]
  v_mfma_f32_16x16x32_bf16 v[88:91], a[80:83], a[244:247], v[88:91]
  v_cvt_pk_bf16_f32 v62, v72, v73
  v_cvt_pk_bf16_f32 v63, v74, v75
  v_mfma_f32_16x16x32_bf16 v[92:95], a[244:247], a[144:147], 0
  v_mfma_f32_16x16x32_bf16 v[92:95], a[248:251], a[156:159], v[92:95]
  v_mfma_f32_16x16x32_bf16 v[92:95], a[252:255], a[168:171], v[92:95]
  v_mfma_f32_16x16x32_bf16 v[92:95], v[76:79], a[180:183], v[92:95]
  v_mfma_f32_16x16x32_bf16 v[92:95], v[80:83], a[192:195], v[92:95]
  v_mfma_f32_16x16x32_bf16 v[92:95], v[84:87], a[204:207], v[92:95]
  v_cvt_pk_bf16_f32 v64, v88, v89
  v_cvt_pk_bf16_f32 v65, v90, v91
  v_mfma_f32_16x16x32_bf16 v[96:99], v[84:87], a[208:211], 0
  v_mfma_f32_16x16x32_bf16 v[96:99], v[80:83], a[196:199], v[96:99]
  v_mfma_f32_16x16x32_bf16 v[96:99], v[76:79], a[184:187], v[96:99]
  v_mfma_f32_16x16x32_bf16 v[96:99], a[252:255], a[172:175], v[96:99]
  v_mfma_f32_16x16x32_bf16 v[96:99], a[248:251], a[160:163], v[96:99]
  v_mfma_f32_16x16x32_bf16 v[96:99], a[244:247], a[148:151], v[96:99]
  v_cvt_pk_bf16_f32 v68, v92, v93
  v_cvt_pk_bf16_f32 v69, v94, v95
  v_mfma_f32_16x16x32_bf16 v[104:107], a[244:247], a[152:155], 0
  v_mfma_f32_16x16x32_bf16 v[104:107], a[248:251], a[164:167], v[104:107]
  v_mfma_f32_16x16x32_bf16 v[104:107], a[252:255], a[176:179], v[104:107]
  v_mfma_f32_16x16x32_bf16 v[104:107], v[76:79], a[188:191], v[104:107]
  v_mfma_f32_16x16x32_bf16 v[104:107], v[80:83], a[200:203], v[104:107]
  v_mfma_f32_16x16x32_bf16 v[104:107], v[84:87], a[212:215], v[104:107]
  v_cvt_pk_bf16_f32 v72, v96, v97
  v_cvt_pk_bf16_f32 v73, v98, v99
  s_nop 5
  v_cvt_pk_bf16_f32 v76, v104, v105
  v_cvt_pk_bf16_f32 v77, v106, v107
  ds_read_b128 a[244:247], v0 offset:2048
  ds_read_b128 a[248:251], v1 offset:2048
  ds_read_b128 a[252:255], v0 offset:10240
  ds_read_b128 v[88:91], v1 offset:10240
  ds_read_b128 v[92:95], v0 offset:18432
  ds_read_b128 v[96:99], v1 offset:18432
  s_waitcnt lgkmcnt(5)
  v_mfma_f32_16x16x32_bf16 v[100:103], a[0:3], a[244:247], 0
  s_waitcnt lgkmcnt(4)
  v_mfma_f32_16x16x32_bf16 v[100:103], a[12:15], a[248:251], v[100:103]
  s_waitcnt lgkmcnt(3)
  v_mfma_f32_16x16x32_bf16 v[100:103], a[24:27], a[252:255], v[100:103]
  s_waitcnt lgkmcnt(2)
  v_mfma_f32_16x16x32_bf16 v[100:103], a[36:39], v[88:91], v[100:103]
  s_waitcnt lgkmcnt(1)
  v_mfma_f32_16x16x32_bf16 v[100:103], a[48:51], v[92:95], v[100:103]
  s_waitcnt lgkmcnt(0)
  v_mfma_f32_16x16x32_bf16 v[100:103], a[60:63], v[96:99], v[100:103]
  v_mfma_f32_16x16x32_bf16 v[80:83], a[64:67], v[96:99], 0
  v_mfma_f32_16x16x32_bf16 v[80:83], a[52:55], v[92:95], v[80:83]
  v_mfma_f32_16x16x32_bf16 v[80:83], a[40:43], v[88:91], v[80:83]
  v_mfma_f32_16x16x32_bf16 v[80:83], a[28:31], a[252:255], v[80:83]
  v_mfma_f32_16x16x32_bf16 v[80:83], a[16:19], a[248:251], v[80:83]
  v_mfma_f32_16x16x32_bf16 v[80:83], a[4:7], a[244:247], v[80:83]
  v_mul_f32 v100, s42, v100
  v_mul_f32 v101, s42, v101
  v_mul_f32 v102, s42, v102
  v_mul_f32 v103, s42, v103
  v_cvt_pk_bf16_f32 v124, v100, v101
  v_cvt_pk_bf16_f32 v125, v102, v103
  v_mfma_f32_16x16x32_bf16 v[84:87], a[8:11], a[244:247], 0
  v_mfma_f32_16x16x32_bf16 v[84:87], a[20:23], a[248:251], v[84:87]
  v_mfma_f32_16x16x32_bf16 v[84:87], a[32:35], a[252:255], v[84:87]
  v_mfma_f32_16x16x32_bf16 v[84:87], a[44:47], v[88:91], v[84:87]
  v_mfma_f32_16x16x32_bf16 v[84:87], a[56:59], v[92:95], v[84:87]
  v_mfma_f32_16x16x32_bf16 v[84:87], a[68:71], v[96:99], v[84:87]
  v_mul_f32 v80, s42, v80
  v_mul_f32 v81, s42, v81
  v_mul_f32 v82, s42, v82
  v_mul_f32 v83, s42, v83
  v_cvt_pk_bf16_f32 v126, v80, v81
  v_cvt_pk_bf16_f32 v127, v82, v83
  v_mfma_f32_16x16x32_bf16 v[100:103], a[132:135], v[96:99], 0
  v_mfma_f32_16x16x32_bf16 v[100:103], a[120:123], v[92:95], v[100:103]
  v_mfma_f32_16x16x32_bf16 v[100:103], a[108:111], v[88:91], v[100:103]
  v_mfma_f32_16x16x32_bf16 v[100:103], a[96:99], a[252:255], v[100:103]
  v_mfma_f32_16x16x32_bf16 v[100:103], a[84:87], a[248:251], v[100:103]
  v_mfma_f32_16x16x32_bf16 v[100:103], a[72:75], a[244:247], v[100:103]
  v_mul_f32 v84, s42, v84
  v_mul_f32 v85, s42, v85
  v_mul_f32 v86, s42, v86
  v_mul_f32 v87, s42, v87
  v_cvt_pk_bf16_f32 v16, v84, v85
  v_cvt_pk_bf16_f32 v17, v86, v87
  v_mfma_f32_16x16x32_bf16 v[104:107], a[76:79], a[244:247], 0
  v_mfma_f32_16x16x32_bf16 v[104:107], a[88:91], a[248:251], v[104:107]
  v_mfma_f32_16x16x32_bf16 v[104:107], a[100:103], a[252:255], v[104:107]
  v_mfma_f32_16x16x32_bf16 v[104:107], a[112:115], v[88:91], v[104:107]
  v_mfma_f32_16x16x32_bf16 v[104:107], a[124:127], v[92:95], v[104:107]
  v_mfma_f32_16x16x32_bf16 v[104:107], a[136:139], v[96:99], v[104:107]
  v_cvt_pk_bf16_f32 v80, v100, v101
  v_cvt_pk_bf16_f32 v81, v102, v103
  v_mfma_f32_16x16x32_bf16 v[108:111], a[140:143], v[96:99], 0
  v_mfma_f32_16x16x32_bf16 v[108:111], a[128:131], v[92:95], v[108:111]
  v_mfma_f32_16x16x32_bf16 v[108:111], a[116:119], v[88:91], v[108:111]
  v_mfma_f32_16x16x32_bf16 v[108:111], a[104:107], a[252:255], v[108:111]
  v_mfma_f32_16x16x32_bf16 v[108:111], a[92:95], a[248:251], v[108:111]
  v_mfma_f32_16x16x32_bf16 v[108:111], a[80:83], a[244:247], v[108:111]
  v_cvt_pk_bf16_f32 v82, v104, v105
  v_cvt_pk_bf16_f32 v83, v106, v107
  v_mfma_f32_16x16x32_bf16 v[100:103], a[244:247], a[144:147], 0
  v_mfma_f32_16x16x32_bf16 v[100:103], a[248:251], a[156:159], v[100:103]
  v_mfma_f32_16x16x32_bf16 v[100:103], a[252:255], a[168:171], v[100:103]
  v_mfma_f32_16x16x32_bf16 v[100:103], v[88:91], a[180:183], v[100:103]
  v_mfma_f32_16x16x32_bf16 v[100:103], v[92:95], a[192:195], v[100:103]
  v_mfma_f32_16x16x32_bf16 v[100:103], v[96:99], a[204:207], v[100:103]
  v_cvt_pk_bf16_f32 v84, v108, v109
  v_cvt_pk_bf16_f32 v85, v110, v111
  v_mfma_f32_16x16x32_bf16 v[104:107], v[96:99], a[208:211], 0
  v_mfma_f32_16x16x32_bf16 v[104:107], v[92:95], a[196:199], v[104:107]
  v_mfma_f32_16x16x32_bf16 v[104:107], v[88:91], a[184:187], v[104:107]
  v_mfma_f32_16x16x32_bf16 v[104:107], a[252:255], a[172:175], v[104:107]
  v_mfma_f32_16x16x32_bf16 v[104:107], a[248:251], a[160:163], v[104:107]
  v_mfma_f32_16x16x32_bf16 v[104:107], a[244:247], a[148:151], v[104:107]
  v_cvt_pk_bf16_f32 v70, v100, v101
  v_cvt_pk_bf16_f32 v71, v102, v103
  v_mfma_f32_16x16x32_bf16 v[116:119], a[244:247], a[152:155], 0
  v_mfma_f32_16x16x32_bf16 v[116:119], a[248:251], a[164:167], v[116:119]
  v_mfma_f32_16x16x32_bf16 v[116:119], a[252:255], a[176:179], v[116:119]
  v_mfma_f32_16x16x32_bf16 v[116:119], v[88:91], a[188:191], v[116:119]
  v_mfma_f32_16x16x32_bf16 v[116:119], v[92:95], a[200:203], v[116:119]
  v_mfma_f32_16x16x32_bf16 v[116:119], v[96:99], a[212:215], v[116:119]
  v_cvt_pk_bf16_f32 v74, v104, v105
  v_cvt_pk_bf16_f32 v75, v106, v107
  s_nop 5
  v_cvt_pk_bf16_f32 v78, v116, v117
  v_cvt_pk_bf16_f32 v79, v118, v119
  ds_read_b128 a[244:247], v0 offset:4096
  ds_read_b128 a[248:251], v1 offset:4096
  ds_read_b128 a[252:255], v0 offset:12288
  ds_read_b128 v[100:103], v1 offset:12288
  ds_read_b128 v[108:111], v0 offset:20480
  ds_read_b128 v[112:115], v1 offset:20480
  s_waitcnt lgkmcnt(5)
  v_mfma_f32_16x16x32_bf16 v[96:99], a[0:3], a[244:247], 0
  s_waitcnt lgkmcnt(4)
  v_mfma_f32_16x16x32_bf16 v[96:99], a[12:15], a[248:251], v[96:99]
  s_waitcnt lgkmcnt(3)
  v_mfma_f32_16x16x32_bf16 v[96:99], a[24:27], a[252:255], v[96:99]
  s_waitcnt lgkmcnt(2)
  v_mfma_f32_16x16x32_bf16 v[96:99], a[36:39], v[100:103], v[96:99]
  s_waitcnt lgkmcnt(1)
  v_mfma_f32_16x16x32_bf16 v[96:99], a[48:51], v[108:111], v[96:99]
  s_waitcnt lgkmcnt(0)
  v_mfma_f32_16x16x32_bf16 v[96:99], a[60:63], v[112:115], v[96:99]
  v_mfma_f32_16x16x32_bf16 v[88:91], a[64:67], v[112:115], 0
  v_mfma_f32_16x16x32_bf16 v[88:91], a[52:55], v[108:111], v[88:91]
  v_mfma_f32_16x16x32_bf16 v[88:91], a[40:43], v[100:103], v[88:91]
  v_mfma_f32_16x16x32_bf16 v[88:91], a[28:31], a[252:255], v[88:91]
  v_mfma_f32_16x16x32_bf16 v[88:91], a[16:19], a[248:251], v[88:91]
  v_mfma_f32_16x16x32_bf16 v[88:91], a[4:7], a[244:247], v[88:91]
  v_mul_f32 v96, s42, v96
  v_mul_f32 v97, s42, v97
  v_mul_f32 v98, s42, v98
  v_mul_f32 v99, s42, v99
  v_cvt_pk_bf16_f32 v18, v96, v97
  v_cvt_pk_bf16_f32 v19, v98, v99
  v_mfma_f32_16x16x32_bf16 v[92:95], a[8:11], a[244:247], 0
  v_mfma_f32_16x16x32_bf16 v[92:95], a[20:23], a[248:251], v[92:95]
  v_mfma_f32_16x16x32_bf16 v[92:95], a[32:35], a[252:255], v[92:95]
  v_mfma_f32_16x16x32_bf16 v[92:95], a[44:47], v[100:103], v[92:95]
  v_mfma_f32_16x16x32_bf16 v[92:95], a[56:59], v[108:111], v[92:95]
  v_mfma_f32_16x16x32_bf16 v[92:95], a[68:71], v[112:115], v[92:95]
  v_mul_f32 v88, s42, v88
  v_mul_f32 v89, s42, v89
  v_mul_f32 v90, s42, v90
  v_mul_f32 v91, s42, v91
  v_cvt_pk_bf16_f32 v120, v88, v89
  v_cvt_pk_bf16_f32 v121, v90, v91
  v_mfma_f32_16x16x32_bf16 v[96:99], a[132:135], v[112:115], 0
  v_mfma_f32_16x16x32_bf16 v[96:99], a[120:123], v[108:111], v[96:99]
  v_mfma_f32_16x16x32_bf16 v[96:99], a[108:111], v[100:103], v[96:99]
  v_mfma_f32_16x16x32_bf16 v[96:99], a[96:99], a[252:255], v[96:99]
  v_mfma_f32_16x16x32_bf16 v[96:99], a[84:87], a[248:251], v[96:99]
  v_mfma_f32_16x16x32_bf16 v[96:99], a[72:75], a[244:247], v[96:99]
  v_mul_f32 v92, s42, v92
  v_mul_f32 v93, s42, v93
  v_mul_f32 v94, s42, v94
  v_mul_f32 v95, s42, v95
  v_cvt_pk_bf16_f32 v122, v92, v93
  v_cvt_pk_bf16_f32 v123, v94, v95
  v_mfma_f32_16x16x32_bf16 v[104:107], a[76:79], a[244:247], 0
  v_mfma_f32_16x16x32_bf16 v[104:107], a[88:91], a[248:251], v[104:107]
  v_mfma_f32_16x16x32_bf16 v[104:107], a[100:103], a[252:255], v[104:107]
  v_mfma_f32_16x16x32_bf16 v[104:107], a[112:115], v[100:103], v[104:107]
  v_mfma_f32_16x16x32_bf16 v[104:107], a[124:127], v[108:111], v[104:107]
  v_mfma_f32_16x16x32_bf16 v[104:107], a[136:139], v[112:115], v[104:107]
  v_cvt_pk_bf16_f32 v88, v96, v97
  v_cvt_pk_bf16_f32 v89, v98, v99
  v_mfma_f32_16x16x32_bf16 v[116:119], a[140:143], v[112:115], 0
  v_mfma_f32_16x16x32_bf16 v[116:119], a[128:131], v[108:111], v[116:119]
  v_mfma_f32_16x16x32_bf16 v[116:119], a[116:119], v[100:103], v[116:119]
  v_mfma_f32_16x16x32_bf16 v[116:119], a[104:107], a[252:255], v[116:119]
  v_mfma_f32_16x16x32_bf16 v[116:119], a[92:95], a[248:251], v[116:119]
  v_mfma_f32_16x16x32_bf16 v[116:119], a[80:83], a[244:247], v[116:119]
  v_cvt_pk_bf16_f32 v90, v104, v105
  v_cvt_pk_bf16_f32 v91, v106, v107
  v_mfma_f32_16x16x32_bf16 v[132:135], a[244:247], a[144:147], 0
  v_mfma_f32_16x16x32_bf16 v[132:135], a[248:251], a[156:159], v[132:135]
  v_mfma_f32_16x16x32_bf16 v[132:135], a[252:255], a[168:171], v[132:135]
  v_mfma_f32_16x16x32_bf16 v[132:135], v[100:103], a[180:183], v[132:135]
  v_mfma_f32_16x16x32_bf16 v[132:135], v[108:111], a[192:195], v[132:135]
  v_mfma_f32_16x16x32_bf16 v[132:135], v[112:115], a[204:207], v[132:135]
  v_cvt_pk_bf16_f32 v92, v116, v117
  v_cvt_pk_bf16_f32 v93, v118, v119
  v_mfma_f32_16x16x32_bf16 v[136:139], v[112:115], a[208:211], 0
  v_mfma_f32_16x16x32_bf16 v[136:139], v[108:111], a[196:199], v[136:139]
  v_mfma_f32_16x16x32_bf16 v[136:139], v[100:103], a[184:187], v[136:139]
  v_mfma_f32_16x16x32_bf16 v[136:139], a[252:255], a[172:175], v[136:139]
  v_mfma_f32_16x16x32_bf16 v[136:139], a[248:251], a[160:163], v[136:139]
  v_mfma_f32_16x16x32_bf16 v[136:139], a[244:247], a[148:151], v[136:139]
  v_cvt_pk_bf16_f32 v96, v132, v133
  v_cvt_pk_bf16_f32 v97, v134, v135
  v_mfma_f32_16x16x32_bf16 v[116:119], a[244:247], a[152:155], 0
  v_mfma_f32_16x16x32_bf16 v[116:119], a[248:251], a[164:167], v[116:119]
  v_mfma_f32_16x16x32_bf16 v[116:119], a[252:255], a[176:179], v[116:119]
  v_mfma_f32_16x16x32_bf16 v[116:119], v[100:103], a[188:191], v[116:119]
  v_mfma_f32_16x16x32_bf16 v[116:119], v[108:111], a[200:203], v[116:119]
  v_mfma_f32_16x16x32_bf16 v[116:119], v[112:115], a[212:215], v[116:119]
  v_cvt_pk_bf16_f32 v104, v136, v137
  v_cvt_pk_bf16_f32 v105, v138, v139
  s_nop 5
  v_cvt_pk_bf16_f32 v100, v116, v117
  v_cvt_pk_bf16_f32 v101, v118, v119
  ds_read_b128 a[244:247], v0 offset:6144
  ds_read_b128 a[248:251], v1 offset:6144
  ds_read_b128 a[252:255], v0 offset:14336
  ds_read_b128 v[132:135], v1 offset:14336
  ds_read_b128 v[136:139], v0 offset:22528
  ds_read_b128 v[140:143], v1 offset:22528
  s_waitcnt lgkmcnt(5)
  v_mfma_f32_16x16x32_bf16 v[144:147], a[0:3], a[244:247], 0
  s_waitcnt lgkmcnt(4)
  v_mfma_f32_16x16x32_bf16 v[144:147], a[12:15], a[248:251], v[144:147]
  s_waitcnt lgkmcnt(3)
  v_mfma_f32_16x16x32_bf16 v[144:147], a[24:27], a[252:255], v[144:147]
  s_waitcnt lgkmcnt(2)
  v_mfma_f32_16x16x32_bf16 v[144:147], a[36:39], v[132:135], v[144:147]
  s_waitcnt lgkmcnt(1)
  v_mfma_f32_16x16x32_bf16 v[144:147], a[48:51], v[136:139], v[144:147]
  s_waitcnt lgkmcnt(0)
  v_mfma_f32_16x16x32_bf16 v[144:147], a[60:63], v[140:143], v[144:147]
  v_mfma_f32_16x16x32_bf16 v[108:111], a[64:67], v[140:143], 0
  v_mfma_f32_16x16x32_bf16 v[108:111], a[52:55], v[136:139], v[108:111]
  v_mfma_f32_16x16x32_bf16 v[108:111], a[40:43], v[132:135], v[108:111]
  v_mfma_f32_16x16x32_bf16 v[108:111], a[28:31], a[252:255], v[108:111]
  v_mfma_f32_16x16x32_bf16 v[108:111], a[16:19], a[248:251], v[108:111]
  v_mfma_f32_16x16x32_bf16 v[108:111], a[4:7], a[244:247], v[108:111]
  v_mul_f32 v144, s42, v144
  v_mul_f32 v145, s42, v145
  v_mul_f32 v146, s42, v146
  v_mul_f32 v147, s42, v147
  v_cvt_pk_bf16_f32 v116, v144, v145
  v_cvt_pk_bf16_f32 v117, v146, v147
  v_mfma_f32_16x16x32_bf16 v[112:115], a[8:11], a[244:247], 0
  v_mfma_f32_16x16x32_bf16 v[112:115], a[20:23], a[248:251], v[112:115]
  v_mfma_f32_16x16x32_bf16 v[112:115], a[32:35], a[252:255], v[112:115]
  v_mfma_f32_16x16x32_bf16 v[112:115], a[44:47], v[132:135], v[112:115]
  v_mfma_f32_16x16x32_bf16 v[112:115], a[56:59], v[136:139], v[112:115]
  v_mfma_f32_16x16x32_bf16 v[112:115], a[68:71], v[140:143], v[112:115]
  v_mul_f32 v108, s42, v108
  v_mul_f32 v109, s42, v109
  v_mul_f32 v110, s42, v110
  v_mul_f32 v111, s42, v111
  v_cvt_pk_bf16_f32 v118, v108, v109
  v_cvt_pk_bf16_f32 v119, v110, v111
  v_mfma_f32_16x16x32_bf16 v[144:147], a[132:135], v[140:143], 0
  v_mfma_f32_16x16x32_bf16 v[144:147], a[120:123], v[136:139], v[144:147]
  v_mfma_f32_16x16x32_bf16 v[144:147], a[108:111], v[132:135], v[144:147]
  v_mfma_f32_16x16x32_bf16 v[144:147], a[96:99], a[252:255], v[144:147]
  v_mfma_f32_16x16x32_bf16 v[144:147], a[84:87], a[248:251], v[144:147]
  v_mfma_f32_16x16x32_bf16 v[144:147], a[72:75], a[244:247], v[144:147]
  v_mul_f32 v112, s42, v112
  v_mul_f32 v113, s42, v113
  v_mul_f32 v114, s42, v114
  v_mul_f32 v115, s42, v115
  v_cvt_pk_bf16_f32 v22, v112, v113
  v_cvt_pk_bf16_f32 v23, v114, v115
  v_mfma_f32_16x16x32_bf16 v[148:151], a[76:79], a[244:247], 0
  v_mfma_f32_16x16x32_bf16 v[148:151], a[88:91], a[248:251], v[148:151]
  v_mfma_f32_16x16x32_bf16 v[148:151], a[100:103], a[252:255], v[148:151]
  v_mfma_f32_16x16x32_bf16 v[148:151], a[112:115], v[132:135], v[148:151]
  v_mfma_f32_16x16x32_bf16 v[148:151], a[124:127], v[136:139], v[148:151]
  v_mfma_f32_16x16x32_bf16 v[148:151], a[136:139], v[140:143], v[148:151]
  v_cvt_pk_bf16_f32 v108, v144, v145
  v_cvt_pk_bf16_f32 v109, v146, v147
  v_mfma_f32_16x16x32_bf16 v[152:155], a[140:143], v[140:143], 0
  v_mfma_f32_16x16x32_bf16 v[152:155], a[128:131], v[136:139], v[152:155]
  v_mfma_f32_16x16x32_bf16 v[152:155], a[116:119], v[132:135], v[152:155]
  v_mfma_f32_16x16x32_bf16 v[152:155], a[104:107], a[252:255], v[152:155]
  v_mfma_f32_16x16x32_bf16 v[152:155], a[92:95], a[248:251], v[152:155]
  v_mfma_f32_16x16x32_bf16 v[152:155], a[80:83], a[244:247], v[152:155]
  v_cvt_pk_bf16_f32 v110, v148, v149
  v_cvt_pk_bf16_f32 v111, v150, v151
  v_mfma_f32_16x16x32_bf16 v[144:147], a[244:247], a[144:147], 0
  v_mfma_f32_16x16x32_bf16 v[144:147], a[248:251], a[156:159], v[144:147]
  v_mfma_f32_16x16x32_bf16 v[144:147], a[252:255], a[168:171], v[144:147]
  v_mfma_f32_16x16x32_bf16 v[144:147], v[132:135], a[180:183], v[144:147]
  v_mfma_f32_16x16x32_bf16 v[144:147], v[136:139], a[192:195], v[144:147]
  v_mfma_f32_16x16x32_bf16 v[144:147], v[140:143], a[204:207], v[144:147]
  v_cvt_pk_bf16_f32 v112, v152, v153
  v_cvt_pk_bf16_f32 v113, v154, v155
  v_mfma_f32_16x16x32_bf16 v[148:151], v[140:143], a[208:211], 0
  v_mfma_f32_16x16x32_bf16 v[148:151], v[136:139], a[196:199], v[148:151]
  v_mfma_f32_16x16x32_bf16 v[148:151], v[132:135], a[184:187], v[148:151]
  v_mfma_f32_16x16x32_bf16 v[148:151], a[252:255], a[172:175], v[148:151]
  v_mfma_f32_16x16x32_bf16 v[148:151], a[248:251], a[160:163], v[148:151]
  v_mfma_f32_16x16x32_bf16 v[148:151], a[244:247], a[148:151], v[148:151]
  v_cvt_pk_bf16_f32 v98, v144, v145
  v_cvt_pk_bf16_f32 v99, v146, v147
  v_mfma_f32_16x16x32_bf16 v[152:155], a[244:247], a[152:155], 0
  v_mfma_f32_16x16x32_bf16 v[152:155], a[248:251], a[164:167], v[152:155]
  v_mfma_f32_16x16x32_bf16 v[152:155], a[252:255], a[176:179], v[152:155]
  v_mfma_f32_16x16x32_bf16 v[152:155], v[132:135], a[188:191], v[152:155]
  v_mfma_f32_16x16x32_bf16 v[152:155], v[136:139], a[200:203], v[152:155]
  v_mfma_f32_16x16x32_bf16 v[152:155], v[140:143], a[212:215], v[152:155]
  v_cvt_pk_bf16_f32 v106, v148, v149
  v_cvt_pk_bf16_f32 v107, v150, v151
  s_nop 5
  v_cvt_pk_bf16_f32 v102, v152, v153
  v_cvt_pk_bf16_f32 v103, v154, v155
  v_mfma_f32_16x16x32_bf16 v[132:135], v[62:65], v[128:131], v[36:39]
  v_mfma_f32_16x16x32_bf16 v[132:135], v[60:63], v[12:15], v[132:135]
  v_mfma_f32_16x16x32_bf16 v[136:139], v[82:85], v[128:131], v[32:35]
  v_mfma_f32_16x16x32_bf16 v[136:139], v[80:83], v[12:15], v[136:139]
  v_mfma_f32_16x16x32_bf16 v[140:143], v[90:93], v[128:131], v[28:31]
  v_mfma_f32_16x16x32_bf16 v[140:143], v[88:91], v[12:15], v[140:143]
  v_mfma_f32_16x16x32_bf16 v[144:147], v[110:113], v[128:131], v[24:27]
  v_mfma_f32_16x16x32_bf16 v[144:147], v[108:111], v[12:15], v[144:147]
  v_add_f32 v132, v54, v132
  v_add_f32 v133, v54, v133
  v_add_f32 v134, v54, v134
  v_add_f32 v135, v54, v135
  v_add_f32 v136, v54, v136
  v_add_f32 v137, v54, v137
  v_add_f32 v138, v54, v138
  v_add_f32 v139, v54, v139
  v_add_f32 v140, v55, v140
  v_add_f32 v141, v55, v141
  v_add_f32 v142, v55, v142
  v_add_f32 v143, v55, v143
  v_add_f32 v144, v55, v144
  v_add_f32 v145, v55, v145
  v_add_f32 v146, v55, v146
  v_add_f32 v147, v55, v147
  v_max_f32 v58, v132, v133
  v_max3_f32 v58, v134, v135, v58
  v_max3_f32 v58, v136, v137, v58
  v_max3_f32 v58, v138, v139, v58
  v_max3_f32 v58, v140, v141, v58
  v_max3_f32 v58, v142, v143, v58
  v_max3_f32 v58, v144, v145, v58
  v_max3_f32 v58, v146, v147, v58
  v_mov_b32 v59, v58
  s_nop 1
  v_permlane32_swap_b32 v58, v59
  v_max_f32 v58, v58, v59
  v_mov_b32 v59, v58
  s_nop 1
  v_permlane16_swap_b32 v58, v59
  v_max_f32 v58, v58, v59
  v_sub_f32 v132, v132, v58
  v_sub_f32 v133, v133, v58
  v_sub_f32 v134, v134, v58
  v_sub_f32 v135, v135, v58
  v_sub_f32 v136, v136, v58
  v_sub_f32 v137, v137, v58
  v_sub_f32 v138, v138, v58
  v_sub_f32 v139, v139, v58
  v_sub_f32 v140, v140, v58
  v_sub_f32 v141, v141, v58
  v_sub_f32 v142, v142, v58
  v_sub_f32 v143, v143, v58
  v_sub_f32 v144, v144, v58
  v_sub_f32 v145, v145, v58
  v_sub_f32 v146, v146, v58
  v_sub_f32 v147, v147, v58
  v_exp_f32 v132, v132
  v_exp_f32 v133, v133
  v_exp_f32 v134, v134
  v_exp_f32 v135, v135
  v_cvt_pk_bf16_f32 v132, v132, v133
  v_cvt_pk_bf16_f32 v133, v134, v135
  v_exp_f32 v136, v136
  v_exp_f32 v137, v137
  v_exp_f32 v138, v138
  v_exp_f32 v139, v139
  v_cvt_pk_bf16_f32 v134, v136, v137
  v_cvt_pk_bf16_f32 v135, v138, v139
  v_exp_f32 v140, v140
  v_exp_f32 v141, v141
  v_exp_f32 v142, v142
  v_exp_f32 v143, v143
  v_cvt_pk_bf16_f32 v136, v140, v141
  v_cvt_pk_bf16_f32 v137, v142, v143
  v_exp_f32 v144, v144
  v_exp_f32 v145, v145
  v_exp_f32 v146, v146
  v_exp_f32 v147, v147
  v_cvt_pk_bf16_f32 v138, v144, v145
  v_cvt_pk_bf16_f32 v139, v146, v147
  v_mov_b64 v[128:129], 0
  s_nop 1
  v_smfmac_f32_16x16x64_bf16 v[128:131], a[240:243], v[132:139], v10
  v_mfma_f32_16x16x32_bf16 v[148:151], v[96:99], v[136:139], 0
  v_mfma_f32_16x16x32_bf16 v[148:151], v[68:71], v[132:135], v[148:151]
  v_mfma_f32_16x16x32_bf16 v[140:143], v[72:75], v[132:135], 0
  v_mfma_f32_16x16x32_bf16 v[140:143], v[104:107], v[136:139], v[140:143]
  v_mfma_f32_16x16x32_bf16 v[144:147], v[100:103], v[136:139], 0
  v_mfma_f32_16x16x32_bf16 v[144:147], v[76:79], v[132:135], v[144:147]
  v_add_f32 v128, v128, v129
  v_rcp_f32 v130, v128
  s_nop 0
  v_mul_f32 v148, v130, v148
  v_mul_f32 v149, v130, v149
  v_mul_f32 v150, v130, v150
  v_mul_f32 v151, v130, v151
  v_cvt_pk_bf16_f32 v148, v148, v149
  v_cvt_pk_bf16_f32 v149, v150, v151
  ds_write_b32 v5, v148 offset:0
  ds_write_b32 v5, v149 offset:1024
  v_mul_f32 v140, v130, v140
  v_mul_f32 v141, v130, v141
  v_mul_f32 v142, v130, v142
  v_mul_f32 v143, v130, v143
  v_cvt_pk_bf16_f32 v140, v140, v141
  v_cvt_pk_bf16_f32 v141, v142, v143
  ds_write_b32 v5, v140 offset:2048
  ds_write_b32 v5, v141 offset:3072
  v_mul_f32 v144, v130, v144
  v_mul_f32 v145, v130, v145
  v_mul_f32 v146, v130, v146
  v_mul_f32 v147, v130, v147
  v_cvt_pk_bf16_f32 v144, v144, v145
  v_cvt_pk_bf16_f32 v145, v146, v147
  ds_write_b32 v5, v144 offset:4096
  ds_write_b32 v5, v145 offset:5120
  v_mfma_f32_16x16x32_bf16 v[128:131], v[60:63], v[124:127], v[40:43]
  v_mfma_f32_16x16x32_bf16 v[128:131], v[62:65], v[14:17], v[128:131]
  v_mfma_f32_16x16x32_bf16 v[132:135], v[80:83], v[124:127], v[36:39]
  v_mfma_f32_16x16x32_bf16 v[132:135], v[82:85], v[14:17], v[132:135]
  v_mfma_f32_16x16x32_bf16 v[136:139], v[88:91], v[124:127], v[32:35]
  v_mfma_f32_16x16x32_bf16 v[136:139], v[90:93], v[14:17], v[136:139]
  v_mfma_f32_16x16x32_bf16 v[140:143], v[108:111], v[124:127], v[28:31]
  v_mfma_f32_16x16x32_bf16 v[140:143], v[110:113], v[14:17], v[140:143]
  v_add_f32 v128, v54, v128
  v_add_f32 v129, v54, v129
  v_add_f32 v130, v54, v130
  v_add_f32 v131, v54, v131
  v_add_f32 v132, v54, v132
  v_add_f32 v133, v54, v133
  v_add_f32 v134, v54, v134
  v_add_f32 v135, v54, v135
  v_add_f32 v136, v55, v136
  v_add_f32 v137, v55, v137
  v_add_f32 v138, v55, v138
  v_add_f32 v139, v55, v139
  v_add_f32 v140, v55, v140
  v_add_f32 v141, v55, v141
  v_add_f32 v142, v55, v142
  v_add_f32 v143, v55, v143
  v_max_f32 v58, v128, v129
  v_max3_f32 v58, v130, v131, v58
  v_max3_f32 v58, v132, v133, v58
  v_max3_f32 v58, v134, v135, v58
  v_max3_f32 v58, v136, v137, v58
  v_max3_f32 v58, v138, v139, v58
  v_max3_f32 v58, v140, v141, v58
  v_max3_f32 v58, v142, v143, v58
  v_mov_b32 v59, v58
  s_nop 1
  v_permlane32_swap_b32 v58, v59
  v_max_f32 v58, v58, v59
  v_mov_b32 v59, v58
  s_nop 1
  v_permlane16_swap_b32 v58, v59
  v_max_f32 v58, v58, v59
  v_sub_f32 v128, v128, v58
  v_sub_f32 v129, v129, v58
  v_sub_f32 v130, v130, v58
  v_sub_f32 v131, v131, v58
  v_sub_f32 v132, v132, v58
  v_sub_f32 v133, v133, v58
  v_sub_f32 v134, v134, v58
  v_sub_f32 v135, v135, v58
  v_sub_f32 v136, v136, v58
  v_sub_f32 v137, v137, v58
  v_sub_f32 v138, v138, v58
  v_sub_f32 v139, v139, v58
  v_sub_f32 v140, v140, v58
  v_sub_f32 v141, v141, v58
  v_sub_f32 v142, v142, v58
  v_sub_f32 v143, v143, v58
  v_exp_f32 v128, v128
  v_exp_f32 v129, v129
  v_exp_f32 v130, v130
  v_exp_f32 v131, v131
  v_cvt_pk_bf16_f32 v128, v128, v129
  v_cvt_pk_bf16_f32 v129, v130, v131
  v_exp_f32 v132, v132
  v_exp_f32 v133, v133
  v_exp_f32 v134, v134
  v_exp_f32 v135, v135
  v_cvt_pk_bf16_f32 v130, v132, v133
  v_cvt_pk_bf16_f32 v131, v134, v135
  v_exp_f32 v136, v136
  v_exp_f32 v137, v137
  v_exp_f32 v138, v138
  v_exp_f32 v139, v139
  v_cvt_pk_bf16_f32 v132, v136, v137
  v_cvt_pk_bf16_f32 v133, v138, v139
  v_exp_f32 v140, v140
  v_exp_f32 v141, v141
  v_exp_f32 v142, v142
  v_exp_f32 v143, v143
  v_cvt_pk_bf16_f32 v134, v140, v141
  v_cvt_pk_bf16_f32 v135, v142, v143
  v_mov_b64 v[124:125], 0
  s_nop 1
  v_smfmac_f32_16x16x64_bf16 v[124:127], a[240:243], v[128:135], v10
  v_mfma_f32_16x16x32_bf16 v[144:147], v[96:99], v[132:135], 0
  v_mfma_f32_16x16x32_bf16 v[144:147], v[68:71], v[128:131], v[144:147]
  v_mfma_f32_16x16x32_bf16 v[136:139], v[72:75], v[128:131], 0
  v_mfma_f32_16x16x32_bf16 v[136:139], v[104:107], v[132:135], v[136:139]
  v_mfma_f32_16x16x32_bf16 v[140:143], v[100:103], v[132:135], 0
  v_mfma_f32_16x16x32_bf16 v[140:143], v[76:79], v[128:131], v[140:143]
  v_add_f32 v124, v124, v125
  v_rcp_f32 v126, v124
  s_nop 0
  v_mul_f32 v144, v126, v144
  v_mul_f32 v145, v126, v145
  v_mul_f32 v146, v126, v146
  v_mul_f32 v147, v126, v147
  v_cvt_pk_bf16_f32 v144, v144, v145
  v_cvt_pk_bf16_f32 v145, v146, v147
  ds_write_b32 v5, v144 offset:256
  ds_write_b32 v5, v145 offset:1280
  v_mul_f32 v136, v126, v136
  v_mul_f32 v137, v126, v137
  v_mul_f32 v138, v126, v138
  v_mul_f32 v139, v126, v139
  v_cvt_pk_bf16_f32 v136, v136, v137
  v_cvt_pk_bf16_f32 v137, v138, v139
  ds_write_b32 v5, v136 offset:2304
  ds_write_b32 v5, v137 offset:3328
  v_mul_f32 v140, v126, v140
  v_mul_f32 v141, v126, v141
  v_mul_f32 v142, v126, v142
  v_mul_f32 v143, v126, v143
  v_cvt_pk_bf16_f32 v140, v140, v141
  v_cvt_pk_bf16_f32 v141, v142, v143
  ds_write_b32 v5, v140 offset:4352
  ds_write_b32 v5, v141 offset:5376
  v_mfma_f32_16x16x32_bf16 v[124:127], v[90:93], v[120:123], v[36:39]
  v_mfma_f32_16x16x32_bf16 v[124:127], v[88:91], v[18:21], v[124:127]
  v_mfma_f32_16x16x32_bf16 v[128:131], v[110:113], v[120:123], v[32:35]
  v_mfma_f32_16x16x32_bf16 v[128:131], v[108:111], v[18:21], v[128:131]
  v_mfma_f32_16x16x32_bf16 v[132:135], v[62:65], v[120:123], v[44:47]
  v_mfma_f32_16x16x32_bf16 v[132:135], v[60:63], v[18:21], v[132:135]
  v_mfma_f32_16x16x32_bf16 v[136:139], v[82:85], v[120:123], v[40:43]
  v_mfma_f32_16x16x32_bf16 v[136:139], v[80:83], v[18:21], v[136:139]
  v_add_f32 v124, v54, v124
  v_add_f32 v125, v54, v125
  v_add_f32 v126, v54, v126
  v_add_f32 v127, v54, v127
  v_add_f32 v128, v54, v128
  v_add_f32 v129, v54, v129
  v_add_f32 v130, v54, v130
  v_add_f32 v131, v54, v131
  v_add_f32 v132, v55, v132
  v_add_f32 v133, v55, v133
  v_add_f32 v134, v55, v134
  v_add_f32 v135, v55, v135
  v_add_f32 v136, v55, v136
  v_add_f32 v137, v55, v137
  v_add_f32 v138, v55, v138
  v_add_f32 v139, v55, v139
  v_max_f32 v58, v124, v125
  v_max3_f32 v58, v126, v127, v58
  v_max3_f32 v58, v128, v129, v58
  v_max3_f32 v58, v130, v131, v58
  v_max3_f32 v58, v132, v133, v58
  v_max3_f32 v58, v134, v135, v58
  v_max3_f32 v58, v136, v137, v58
  v_max3_f32 v58, v138, v139, v58
  v_mov_b32 v59, v58
  s_nop 1
  v_permlane32_swap_b32 v58, v59
  v_max_f32 v58, v58, v59
  v_mov_b32 v59, v58
  s_nop 1
  v_permlane16_swap_b32 v58, v59
  v_max_f32 v58, v58, v59
  v_sub_f32 v124, v124, v58
  v_sub_f32 v125, v125, v58
  v_sub_f32 v126, v126, v58
  v_sub_f32 v127, v127, v58
  v_sub_f32 v128, v128, v58
  v_sub_f32 v129, v129, v58
  v_sub_f32 v130, v130, v58
  v_sub_f32 v131, v131, v58
  v_sub_f32 v132, v132, v58
  v_sub_f32 v133, v133, v58
  v_sub_f32 v134, v134, v58
  v_sub_f32 v135, v135, v58
  v_sub_f32 v136, v136, v58
  v_sub_f32 v137, v137, v58
  v_sub_f32 v138, v138, v58
  v_sub_f32 v139, v139, v58
  v_exp_f32 v124, v124
  v_exp_f32 v125, v125
  v_exp_f32 v126, v126
  v_exp_f32 v127, v127
  v_cvt_pk_bf16_f32 v124, v124, v125
  v_cvt_pk_bf16_f32 v125, v126, v127
  v_exp_f32 v128, v128
  v_exp_f32 v129, v129
  v_exp_f32 v130, v130
  v_exp_f32 v131, v131
  v_cvt_pk_bf16_f32 v126, v128, v129
  v_cvt_pk_bf16_f32 v127, v130, v131
  v_exp_f32 v132, v132
  v_exp_f32 v133, v133
  v_exp_f32 v134, v134
  v_exp_f32 v135, v135
  v_cvt_pk_bf16_f32 v128, v132, v133
  v_cvt_pk_bf16_f32 v129, v134, v135
  v_exp_f32 v136, v136
  v_exp_f32 v137, v137
  v_exp_f32 v138, v138
  v_exp_f32 v139, v139
  v_cvt_pk_bf16_f32 v130, v136, v137
  v_cvt_pk_bf16_f32 v131, v138, v139
  v_mov_b64 v[120:121], 0
  s_nop 1
  v_smfmac_f32_16x16x64_bf16 v[120:123], a[240:243], v[124:131], v10
  v_mfma_f32_16x16x32_bf16 v[140:143], v[68:71], v[128:131], 0
  v_mfma_f32_16x16x32_bf16 v[140:143], v[96:99], v[124:127], v[140:143]
  v_mfma_f32_16x16x32_bf16 v[132:135], v[104:107], v[124:127], 0
  v_mfma_f32_16x16x32_bf16 v[132:135], v[72:75], v[128:131], v[132:135]
  v_mfma_f32_16x16x32_bf16 v[136:139], v[76:79], v[128:131], 0
  v_mfma_f32_16x16x32_bf16 v[136:139], v[100:103], v[124:127], v[136:139]
  v_add_f32 v120, v120, v121
  v_rcp_f32 v122, v120
  s_nop 0
  v_mul_f32 v140, v122, v140
  v_mul_f32 v141, v122, v141
  v_mul_f32 v142, v122, v142
  v_mul_f32 v143, v122, v143
  v_cvt_pk_bf16_f32 v140, v140, v141
  v_cvt_pk_bf16_f32 v141, v142, v143
  ds_write_b32 v5, v140 offset:512
  ds_write_b32 v5, v141 offset:1536
  v_mul_f32 v132, v122, v132
  v_mul_f32 v133, v122, v133
  v_mul_f32 v134, v122, v134
  v_mul_f32 v135, v122, v135
  v_cvt_pk_bf16_f32 v132, v132, v133
  v_cvt_pk_bf16_f32 v133, v134, v135
  ds_write_b32 v5, v132 offset:2560
  s_waitcnt lgkmcnt(12)
  ds_write_b32 v5, v133 offset:3584
  v_mul_f32 v136, v122, v136
  v_mul_f32 v137, v122, v137
  v_mul_f32 v138, v122, v138
  v_mul_f32 v139, v122, v139
  v_cvt_pk_bf16_f32 v136, v136, v137
  v_cvt_pk_bf16_f32 v137, v138, v139
  ds_write_b32 v5, v136 offset:4608
  ds_write_b32 v5, v137 offset:5632
  v_mfma_f32_16x16x32_bf16 v[120:123], v[88:91], v[116:119], v[40:43]
  v_mfma_f32_16x16x32_bf16 v[120:123], v[90:93], v[20:23], v[120:123]
  v_mfma_f32_16x16x32_bf16 v[124:127], v[108:111], v[116:119], v[36:39]
  v_mfma_f32_16x16x32_bf16 v[124:127], v[110:113], v[20:23], v[124:127]
  v_mfma_f32_16x16x32_bf16 v[128:131], v[60:63], v[116:119], v[48:51]
  v_mfma_f32_16x16x32_bf16 v[128:131], v[62:65], v[20:23], v[128:131]
  v_mfma_f32_16x16x32_bf16 v[88:91], v[80:83], v[116:119], v[44:47]
  v_mfma_f32_16x16x32_bf16 v[88:91], v[82:85], v[20:23], v[88:91]
  v_add_f32 v120, v54, v120
  v_add_f32 v121, v54, v121
  v_add_f32 v122, v54, v122
  v_add_f32 v123, v54, v123
  v_add_f32 v124, v54, v124
  v_add_f32 v125, v54, v125
  v_add_f32 v126, v54, v126
  v_add_f32 v127, v54, v127
  v_add_f32 v128, v55, v128
  v_add_f32 v129, v55, v129
  v_add_f32 v130, v55, v130
  v_add_f32 v131, v55, v131
  v_add_f32 v88, v55, v88
  v_add_f32 v89, v55, v89
  v_add_f32 v90, v55, v90
  v_add_f32 v91, v55, v91
  v_max_f32 v58, v120, v121
  v_max3_f32 v58, v122, v123, v58
  v_max3_f32 v58, v124, v125, v58
  v_max3_f32 v58, v126, v127, v58
  v_max3_f32 v58, v128, v129, v58
  v_max3_f32 v58, v130, v131, v58
  v_max3_f32 v58, v88, v89, v58
  v_max3_f32 v58, v90, v91, v58
  v_mov_b32 v59, v58
  s_nop 1
  v_permlane32_swap_b32 v58, v59
  v_max_f32 v58, v58, v59
  v_mov_b32 v59, v58
  s_nop 1
  v_permlane16_swap_b32 v58, v59
  v_max_f32 v58, v58, v59
  v_sub_f32 v120, v120, v58
  v_sub_f32 v121, v121, v58
  v_sub_f32 v122, v122, v58
  v_sub_f32 v123, v123, v58
  v_sub_f32 v124, v124, v58
  v_sub_f32 v125, v125, v58
  v_sub_f32 v126, v126, v58
  v_sub_f32 v127, v127, v58
  v_sub_f32 v128, v128, v58
  v_sub_f32 v129, v129, v58
  v_sub_f32 v130, v130, v58
  v_sub_f32 v131, v131, v58
  v_sub_f32 v88, v88, v58
  v_sub_f32 v89, v89, v58
  v_sub_f32 v90, v90, v58
  v_sub_f32 v91, v91, v58
  v_exp_f32 v120, v120
  v_exp_f32 v121, v121
  v_exp_f32 v122, v122
  v_exp_f32 v123, v123
  v_cvt_pk_bf16_f32 v120, v120, v121
  v_cvt_pk_bf16_f32 v121, v122, v123
  v_exp_f32 v124, v124
  v_exp_f32 v125, v125
  v_exp_f32 v126, v126
  v_exp_f32 v127, v127
  v_cvt_pk_bf16_f32 v122, v124, v125
  v_cvt_pk_bf16_f32 v123, v126, v127
  v_exp_f32 v128, v128
  v_exp_f32 v129, v129
  v_exp_f32 v130, v130
  v_exp_f32 v131, v131
  v_cvt_pk_bf16_f32 v124, v128, v129
  v_cvt_pk_bf16_f32 v125, v130, v131
  v_exp_f32 v88, v88
  v_exp_f32 v89, v89
  v_exp_f32 v90, v90
  v_exp_f32 v91, v91
  v_cvt_pk_bf16_f32 v126, v88, v89
  v_cvt_pk_bf16_f32 v127, v90, v91
  v_mov_b64 v[80:81], 0
  s_nop 1
  v_smfmac_f32_16x16x64_bf16 v[80:83], a[240:243], v[120:127], v10
  v_mfma_f32_16x16x32_bf16 v[84:87], v[68:71], v[124:127], 0
  v_mfma_f32_16x16x32_bf16 v[84:87], v[96:99], v[120:123], v[84:87]
  v_mfma_f32_16x16x32_bf16 v[60:63], v[104:107], v[120:123], 0
  v_mfma_f32_16x16x32_bf16 v[60:63], v[72:75], v[124:127], v[60:63]
  v_mfma_f32_16x16x32_bf16 v[64:67], v[76:79], v[124:127], 0
  v_mfma_f32_16x16x32_bf16 v[64:67], v[100:103], v[120:123], v[64:67]
  v_add_f32 v80, v80, v81
  v_rcp_f32 v82, v80
  s_nop 0
  v_mul_f32 v84, v82, v84
  v_mul_f32 v85, v82, v85
  v_mul_f32 v86, v82, v86
  v_mul_f32 v87, v82, v87
  v_cvt_pk_bf16_f32 v84, v84, v85
  v_cvt_pk_bf16_f32 v85, v86, v87
  s_waitcnt lgkmcnt(12)
  ds_write_b32 v5, v84 offset:768
  ds_write_b32 v5, v85 offset:1792
  v_mul_f32 v60, v82, v60
  v_mul_f32 v61, v82, v61
  v_mul_f32 v62, v82, v62
  v_mul_f32 v63, v82, v63
  v_cvt_pk_bf16_f32 v60, v60, v61
  v_cvt_pk_bf16_f32 v61, v62, v63
  ds_write_b32 v5, v60 offset:2816
  s_waitcnt lgkmcnt(12)
  ds_write_b32 v5, v61 offset:3840
  v_mul_f32 v64, v82, v64
  v_mul_f32 v65, v82, v65
  v_mul_f32 v66, v82, v66
  v_mul_f32 v67, v82, v67
  v_cvt_pk_bf16_f32 v64, v64, v65
  v_cvt_pk_bf16_f32 v65, v66, v67
  ds_write_b32 v5, v64 offset:4864
  ds_write_b32 v5, v65 offset:5888
  s_waitcnt lgkmcnt(0)
  s_barrier
  ds_read_b128 a[244:247], v3 offset:0
  ds_read_b128 a[248:251], v3 offset:4096
  ds_read_b128 a[252:255], v3 offset:8192
  ds_read_b128 v[72:75], v3 offset:12288
  ds_read_b128 v[76:79], v3 offset:16384
  ds_read_b128 v[84:87], v3 offset:20480
  s_waitcnt lgkmcnt(5)
  v_mfma_f32_16x16x32_bf16 v[68:71], a[244:247], v[184:187], 0
  s_waitcnt lgkmcnt(4)
  v_mfma_f32_16x16x32_bf16 v[68:71], a[248:251], v[200:203], v[68:71]
  s_waitcnt lgkmcnt(3)
  v_mfma_f32_16x16x32_bf16 v[68:71], a[252:255], v[216:219], v[68:71]
  s_waitcnt lgkmcnt(2)
  v_mfma_f32_16x16x32_bf16 v[68:71], v[72:75], v[232:235], v[68:71]
  s_waitcnt lgkmcnt(1)
  v_mfma_f32_16x16x32_bf16 v[68:71], v[76:79], v[248:251], v[68:71]
  s_waitcnt lgkmcnt(0)
  v_mfma_f32_16x16x32_bf16 v[68:71], v[84:87], a[224:227], v[68:71]
  v_mfma_f32_16x16x32_bf16 v[80:83], v[84:87], a[228:231], 0
  v_mfma_f32_16x16x32_bf16 v[80:83], v[76:79], v[252:255], v[80:83]
  v_mfma_f32_16x16x32_bf16 v[80:83], v[72:75], v[236:239], v[80:83]
  v_mfma_f32_16x16x32_bf16 v[80:83], a[252:255], v[220:223], v[80:83]
  v_mfma_f32_16x16x32_bf16 v[80:83], a[248:251], v[204:207], v[80:83]
  v_mfma_f32_16x16x32_bf16 v[80:83], a[244:247], v[188:191], v[80:83]
  v_mfma_f32_16x16x32_bf16 v[60:63], a[244:247], v[192:195], 0
  v_mfma_f32_16x16x32_bf16 v[60:63], a[248:251], v[208:211], v[60:63]
  v_mfma_f32_16x16x32_bf16 v[60:63], a[252:255], v[224:227], v[60:63]
  v_mfma_f32_16x16x32_bf16 v[60:63], v[72:75], v[240:243], v[60:63]
  v_mfma_f32_16x16x32_bf16 v[60:63], v[76:79], a[216:219], v[60:63]
  v_mfma_f32_16x16x32_bf16 v[60:63], v[84:87], a[232:235], v[60:63]
  v_mfma_f32_16x16x32_bf16 v[64:67], v[84:87], a[236:239], 0
  v_mfma_f32_16x16x32_bf16 v[64:67], v[76:79], a[220:223], v[64:67]
  v_mfma_f32_16x16x32_bf16 v[64:67], v[72:75], v[244:247], v[64:67]
  v_mfma_f32_16x16x32_bf16 v[64:67], a[252:255], v[228:231], v[64:67]
  v_mfma_f32_16x16x32_bf16 v[64:67], a[248:251], v[212:215], v[64:67]
  v_mfma_f32_16x16x32_bf16 v[64:67], a[244:247], v[196:199], v[64:67]
  v_cvt_pk_bf16_f32 v68, v68, v80
  v_cvt_pk_bf16_f32 v69, v69, v81
  v_cvt_pk_bf16_f32 v70, v70, v82
  v_cvt_pk_bf16_f32 v71, v71, v83
  buffer_store_dword v68, v7, s[24:27], s33 offen offset:0 nt
  buffer_store_dword v69, v7, s[24:27], s33 offen offset:384 nt
  buffer_store_dword v70, v7, s[24:27], s33 offen offset:768 nt
  buffer_store_dword v71, v7, s[24:27], s33 offen offset:1152 nt
  v_cvt_pk_bf16_f32 v60, v60, v64
  v_cvt_pk_bf16_f32 v61, v61, v65
  v_cvt_pk_bf16_f32 v62, v62, v66
  v_cvt_pk_bf16_f32 v63, v63, v67
  buffer_store_dword v60, v8, s[24:27], s33 offen offset:0 nt
  buffer_store_dword v61, v8, s[24:27], s33 offen offset:384 nt
  buffer_store_dword v62, v8, s[24:27], s33 offen offset:768 nt
  buffer_store_dword v63, v8, s[24:27], s33 offen offset:1152 nt
  ds_read_b128 a[244:247], v4 offset:0
  ds_read_b128 a[248:251], v4 offset:4096
  ds_read_b128 a[252:255], v4 offset:8192
  ds_read_b128 v[68:71], v4 offset:12288
  ds_read_b128 v[72:75], v4 offset:16384
  ds_read_b128 v[76:79], v4 offset:20480
  s_waitcnt lgkmcnt(5)
  v_mfma_f32_16x16x32_bf16 v[60:63], a[244:247], v[184:187], 0
  s_waitcnt lgkmcnt(4)
  v_mfma_f32_16x16x32_bf16 v[60:63], a[248:251], v[200:203], v[60:63]
  s_waitcnt lgkmcnt(3)
  v_mfma_f32_16x16x32_bf16 v[60:63], a[252:255], v[216:219], v[60:63]
  s_waitcnt lgkmcnt(2)
  v_mfma_f32_16x16x32_bf16 v[60:63], v[68:71], v[232:235], v[60:63]
  s_waitcnt lgkmcnt(1)
  v_mfma_f32_16x16x32_bf16 v[60:63], v[72:75], v[248:251], v[60:63]
  s_waitcnt lgkmcnt(0)
  v_mfma_f32_16x16x32_bf16 v[60:63], v[76:79], a[224:227], v[60:63]
  v_mfma_f32_16x16x32_bf16 v[64:67], v[76:79], a[228:231], 0
  v_mfma_f32_16x16x32_bf16 v[64:67], v[72:75], v[252:255], v[64:67]
  v_mfma_f32_16x16x32_bf16 v[64:67], v[68:71], v[236:239], v[64:67]
  v_mfma_f32_16x16x32_bf16 v[64:67], a[252:255], v[220:223], v[64:67]
  v_mfma_f32_16x16x32_bf16 v[64:67], a[248:251], v[204:207], v[64:67]
  v_mfma_f32_16x16x32_bf16 v[64:67], a[244:247], v[188:191], v[64:67]
  s_nop 7
  v_cvt_pk_bf16_f32 v60, v60, v64
  v_cvt_pk_bf16_f32 v61, v61, v65
  v_cvt_pk_bf16_f32 v62, v62, v66
  v_cvt_pk_bf16_f32 v63, v63, v67
  buffer_store_dword v60, v7, s[24:27], s34 offen offset:0 nt
  buffer_store_dword v61, v7, s[24:27], s34 offen offset:384 nt
  buffer_store_dword v62, v7, s[24:27], s34 offen offset:768 nt
  buffer_store_dword v63, v7, s[24:27], s34 offen offset:1152 nt
  ds_read_b128 a[244:247], v3 offset:512
  ds_read_b128 a[248:251], v3 offset:4608
  ds_read_b128 a[252:255], v3 offset:8704
  ds_read_b128 v[72:75], v3 offset:12800
  ds_read_b128 v[76:79], v3 offset:16896
  ds_read_b128 v[84:87], v3 offset:20992
  s_waitcnt lgkmcnt(5)
  v_mfma_f32_16x16x32_bf16 v[60:63], a[244:247], v[184:187], 0
  s_waitcnt lgkmcnt(4)
  v_mfma_f32_16x16x32_bf16 v[60:63], a[248:251], v[200:203], v[60:63]
  s_waitcnt lgkmcnt(3)
  v_mfma_f32_16x16x32_bf16 v[60:63], a[252:255], v[216:219], v[60:63]
  s_waitcnt lgkmcnt(2)
  v_mfma_f32_16x16x32_bf16 v[60:63], v[72:75], v[232:235], v[60:63]
  s_waitcnt lgkmcnt(1)
  v_mfma_f32_16x16x32_bf16 v[60:63], v[76:79], v[248:251], v[60:63]
  s_waitcnt lgkmcnt(0)
  v_mfma_f32_16x16x32_bf16 v[60:63], v[84:87], a[224:227], v[60:63]
  v_mfma_f32_16x16x32_bf16 v[80:83], v[84:87], a[228:231], 0
  v_mfma_f32_16x16x32_bf16 v[80:83], v[76:79], v[252:255], v[80:83]
  v_mfma_f32_16x16x32_bf16 v[80:83], v[72:75], v[236:239], v[80:83]
  v_mfma_f32_16x16x32_bf16 v[80:83], a[252:255], v[220:223], v[80:83]
  v_mfma_f32_16x16x32_bf16 v[80:83], a[248:251], v[204:207], v[80:83]
  v_mfma_f32_16x16x32_bf16 v[80:83], a[244:247], v[188:191], v[80:83]
  v_mfma_f32_16x16x32_bf16 v[64:67], a[244:247], v[192:195], 0
  v_mfma_f32_16x16x32_bf16 v[64:67], a[248:251], v[208:211], v[64:67]
  v_mfma_f32_16x16x32_bf16 v[64:67], a[252:255], v[224:227], v[64:67]
  v_mfma_f32_16x16x32_bf16 v[64:67], v[72:75], v[240:243], v[64:67]
  v_mfma_f32_16x16x32_bf16 v[64:67], v[76:79], a[216:219], v[64:67]
  v_mfma_f32_16x16x32_bf16 v[64:67], v[84:87], a[232:235], v[64:67]
  v_mfma_f32_16x16x32_bf16 v[68:71], v[84:87], a[236:239], 0
  v_mfma_f32_16x16x32_bf16 v[68:71], v[76:79], a[220:223], v[68:71]
  v_mfma_f32_16x16x32_bf16 v[68:71], v[72:75], v[244:247], v[68:71]
  v_mfma_f32_16x16x32_bf16 v[68:71], a[252:255], v[228:231], v[68:71]
  v_mfma_f32_16x16x32_bf16 v[68:71], a[248:251], v[212:215], v[68:71]
  v_mfma_f32_16x16x32_bf16 v[68:71], a[244:247], v[196:199], v[68:71]
  v_cvt_pk_bf16_f32 v60, v60, v80
  v_cvt_pk_bf16_f32 v61, v61, v81
  v_cvt_pk_bf16_f32 v62, v62, v82
  v_cvt_pk_bf16_f32 v63, v63, v83
  buffer_store_dword v60, v7, s[24:27], s35 offen offset:0 nt
  buffer_store_dword v61, v7, s[24:27], s35 offen offset:384 nt
  buffer_store_dword v62, v7, s[24:27], s35 offen offset:768 nt
  buffer_store_dword v63, v7, s[24:27], s35 offen offset:1152 nt
  v_cvt_pk_bf16_f32 v64, v64, v68
  v_cvt_pk_bf16_f32 v65, v65, v69
  v_cvt_pk_bf16_f32 v66, v66, v70
  v_cvt_pk_bf16_f32 v67, v67, v71
  buffer_store_dword v64, v8, s[24:27], s35 offen offset:0 nt
  buffer_store_dword v65, v8, s[24:27], s35 offen offset:384 nt
  buffer_store_dword v66, v8, s[24:27], s35 offen offset:768 nt
  buffer_store_dword v67, v8, s[24:27], s35 offen offset:1152 nt
  ds_read_b128 a[244:247], v4 offset:512
  ds_read_b128 a[248:251], v4 offset:4608
  ds_read_b128 a[252:255], v4 offset:8704
  ds_read_b128 v[72:75], v4 offset:12800
  ds_read_b128 v[76:79], v4 offset:16896
  ds_read_b128 v[80:83], v4 offset:20992
  s_waitcnt lgkmcnt(5)
  v_mfma_f32_16x16x32_bf16 v[60:63], a[244:247], v[184:187], 0
  s_waitcnt lgkmcnt(4)
  v_mfma_f32_16x16x32_bf16 v[60:63], a[248:251], v[200:203], v[60:63]
  s_waitcnt lgkmcnt(3)
  v_mfma_f32_16x16x32_bf16 v[60:63], a[252:255], v[216:219], v[60:63]
  s_waitcnt lgkmcnt(2)
  v_mfma_f32_16x16x32_bf16 v[60:63], v[72:75], v[232:235], v[60:63]
  s_waitcnt lgkmcnt(1)
  v_mfma_f32_16x16x32_bf16 v[60:63], v[76:79], v[248:251], v[60:63]
  s_waitcnt lgkmcnt(0)
  v_mfma_f32_16x16x32_bf16 v[60:63], v[80:83], a[224:227], v[60:63]
  v_mfma_f32_16x16x32_bf16 v[64:67], v[80:83], a[228:231], 0
  v_mfma_f32_16x16x32_bf16 v[64:67], v[76:79], v[252:255], v[64:67]
  v_mfma_f32_16x16x32_bf16 v[64:67], v[72:75], v[236:239], v[64:67]
  v_mfma_f32_16x16x32_bf16 v[64:67], a[252:255], v[220:223], v[64:67]
  v_mfma_f32_16x16x32_bf16 v[64:67], a[248:251], v[204:207], v[64:67]
  v_mfma_f32_16x16x32_bf16 v[64:67], a[244:247], v[188:191], v[64:67]
  s_nop 7
  v_cvt_pk_bf16_f32 v60, v60, v64
  v_cvt_pk_bf16_f32 v61, v61, v65
  v_cvt_pk_bf16_f32 v62, v62, v66
  v_cvt_pk_bf16_f32 v63, v63, v67
  buffer_store_dword v60, v7, s[24:27], s36 offen offset:0 nt
  buffer_store_dword v61, v7, s[24:27], s36 offen offset:384 nt
  buffer_store_dword v62, v7, s[24:27], s36 offen offset:768 nt
  buffer_store_dword v63, v7, s[24:27], s36 offen offset:1152 nt
  v_sub_u32 v6, v6, v56
  v_sub_u32 v7, v7, v57
  v_sub_u32 v8, v8, v57
  v_mov_b32 v54, 0
  v_mov_b32 v55, 0
  v_mov_b32 v56, 0
  v_mov_b32 v57, 0
  s_add_u32 s50, s50, 1
  s_cmp_eq_u32 s50, 16
  s_cselect_b32 s5, s58, s43
  s_add_u32 s56, s56, s5
  s_mul_i32 s5, s3, s57
  s_add_u32 s31, s56, s5
  s_add_u32 s32, s31, 786432
  s_xor_b32 s5, s4, 0
  s_mul_i32 s5, s5, 393216
  s_add_u32 s33, s5, s56
  s_xor_b32 s5, s4, 1
  s_mul_i32 s5, s5, 393216
  s_add_u32 s34, s5, s56
  s_xor_b32 s5, s4, 2
  s_mul_i32 s5, s5, 393216
  s_add_u32 s35, s5, s56
  s_xor_b32 s5, s4, 3
  s_mul_i32 s5, s5, 393216
  s_add_u32 s36, s5, s56
  s_cmp_lt_u32 s50, s49
  s_nop 7
  s_cbranch_scc1 L_sloop
  s_branch L_fin
.section .rodata,"a"
.p2align 6
.amdhsa_kernel standalone__window_attn_swin__vision_kernel
  .amdhsa_next_free_vgpr 512
  .amdhsa_next_free_sgpr 102
  .amdhsa_accum_offset 256
  .amdhsa_group_segment_fixed_size 0
  .amdhsa_kernarg_size 72
  .amdhsa_user_sgpr_count 2
  .amdhsa_user_sgpr_kernarg_segment_ptr 1
  .amdhsa_system_sgpr_workgroup_id_x 1
.end_amdhsa_kernel
```

```asm
; @launch grid=(256,1,1) block=(256,1,1) lds=163840
.amdgcn_target "amdgcn-amd-amdhsa--gfx950"
.text
.globl standalone__window_attn_swin__vision_kernel
.p2align 12
.p2align 8
.type standalone__window_attn_swin__vision_kernel,@function
standalone__window_attn_swin__vision_kernel:
  s_cmpk_ge_u32 s2, 256
  s_cbranch_scc1 L_end
  s_load_dwordx2 s[8:9], s[0:1], 0
  s_load_dwordx2 s[20:21], s[0:1], 24
  s_load_dwordx2 s[12:13], s[0:1], 8
  s_load_dwordx2 s[16:17], s[0:1], 16
  s_load_dwordx2 s[24:25], s[0:1], 48
  s_load_dwordx2 s[62:63], s[0:1], 64
  v_lshrrev_b32 v75, 6, v0
  s_lshr_b32 s49, s2, 3
  v_readfirstlane_b32 s3, v75
  s_getpc_b64 s[50:51]
  v_and_b32 v75, 15, v0
  v_mad_u32_u24 v75, s49, 9, v75
  v_lshlrev_b32 v75, 7, v75
  v_min_u32 v75, L_safe-standalone__window_attn_swin__vision_kernel-256, v75
  v_mov_b32 v59, s51
  v_add_co_u32 v58, vcc, s50, v75
  s_and_b32 s47, s2, 63
  s_lshr_b32 s48, s2, 6
  v_addc_co_u32 v59, vcc, 0, v59, vcc
  global_load_dword v67, v[58:59], off
  v_bfe_u32 v56, v0, 3, 4
  v_and_b32 v54, 7, v0
  v_lshrrev_b32 v64, 1, v56
  v_lshlrev_b32 v76, 2, v56
  v_and_b32 v76, 4, v76
  v_xor_b32 v64, v64, v76
  v_xor_b32 v64, v54, v64
  v_and_b32 v55, 7, v56
  s_add_u32 s48, s48, 60
  s_cmp_lt_u32 s2, 60
  s_cselect_b32 s48, s2, s48
  s_cselect_b32 s47, 63, s47
  s_lshl_b32 s5, s47, 3
  s_add_u32 s5, s5, 4
  v_add_u32 v76, s5, v55
  v_and_b32 v76, 511, v76
  v_mul_u32_u24 v76, 0x180, v76
  v_lshlrev_b32 v58, 4, v64
  v_add_u32 v6, v58, v76
  v_and_b32 v65, 63, v0
  v_lshlrev_b32 v57, 4, v65
  s_mov_b32 s57, 196608
  s_lshl_b32 s5, s48, 3
  s_add_u32 s5, s5, s3
  s_add_u32 s5, s5, 4
  s_mul_i32 s31, s5, s57
  s_add_u32 s5, s5, 4
  s_and_b32 s5, s5, 511
  s_mul_i32 s32, s5, s57
  s_lshl_b32 s46, s3, 10
  s_lshl_b32 s5, s3, 11
  s_add_u32 m0, s5, 151552
  s_mov_b32 s11, 0x20000
  s_mov_b32 s10, 100663296
  s_mov_b32 s23, s11
  s_movk_i32 s22, 1800
  s_mov_b32 s15, s11
  s_mov_b32 s14, 221184
  s_lshl_b32 s49, s49, 2
  s_add_u32 s51, s49, s3
  s_mul_i32 s50, s51, 1728
  v_min_u32 v59, 13, v65
  v_lshlrev_b32 v59, 7, v59
  s_waitcnt lgkmcnt(0)
  buffer_load_dword v66, v59, s[12:15], s50 offen
  buffer_load_dwordx4 v57, s[20:23], 0 offen lds
  buffer_load_dwordx4 v57, s[20:23], 0 offen offset:1024 lds
  s_add_u32 m0, s46, 0
  v_and_b32 v64, 2, v56
  buffer_load_dwordx4 v6, s[8:11], s31 offen offset:0 nt lds
  s_add_u32 m0, s46, 8064
  v_lshrrev_b32 v76, 1, v56
  buffer_load_dwordx4 v6, s[8:11], s31 offen offset:128 nt lds
  s_add_u32 m0, s46, 16128
  v_and_b32 v76, 4, v76
  buffer_load_dwordx4 v6, s[8:11], s31 offen offset:256 nt lds
  s_add_u32 m0, s46, 4096
  v_or_b32 v76, v64, v76
  buffer_load_dwordx4 v6, s[8:11], s32 offen offset:0 nt lds
  s_add_u32 m0, s46, 12160
  v_xor_b32 v76, v54, v76
  buffer_load_dwordx4 v6, s[8:11], s32 offen offset:128 nt lds
  s_add_u32 m0, s46, 20224
  v_lshlrev_b32 v76, 4, v76
  buffer_load_dwordx4 v6, s[8:11], s32 offen offset:256 nt lds
  v_mul_u32_u24 v56, 1152, v55
  v_add_u32 v61, v76, v56
  s_mul_i32 s44, s3, 9216
  v_lshlrev_b32 v64, 1, v64
  v_xor_b32 v64, v54, v64
  v_mul_u32_u24 v76, 0x180, v55
  v_lshl_add_u32 v56, v64, 4, v76
  s_mul_i32 s45, s3, 3072
  s_mov_b32 s19, s11
  s_mov_b32 s18, 73728
  s_mul_i32 s51, s51, 576
  v_min_u32 v57, 512, v59
  v_add_u32 v6, v58, v76
  s_mov_b32 s27, s11
  s_mov_b32 s26, 100663296
  v_and_b32 v54, 15, v65
  v_lshrrev_b32 v55, 4, v65
  v_lshrrev_b32 v75, 1, v54
  v_lshlrev_b32 v64, 2, v54
  v_and_b32 v64, 4, v64
  v_xor_b32 v75, v75, v64
  v_xor_b32 v75, v55, v75
  v_lshlrev_b32 v75, 4, v75
  v_lshl_add_u32 v0, v54, 7, v75
  v_xor_b32 v1, 64, v0
  v_subrev_u32 v2, s46, v0
  s_add_u32 s28, s46, 28672
  s_add_u32 s29, s46, 53248
  s_mov_b32 s30, s46
  s_and_b32 s4, s3, 1
  v_lshlrev_b32 v75, 4, v54
  v_lshl_add_u32 v64, v55, 10, v75
  s_lshl_b32 s5, s4, 8
  s_add_u32 s5, s5, 77824
  v_add_u32 v3, s5, v64
  v_xor_b32 v4, 0x100, v3
  s_mul_i32 s5, s3, 6144
  s_add_u32 s6, s5, 102400
  s_add_u32 s5, s5, 77824
  s_xor_b32 s41, s5, s6
  v_lshl_add_u32 v64, v55, 2, v75
  v_add_u32 v5, s5, v64
  v_and_b32 v70, 7, v54
  v_lshrrev_b32 v73, 3, v54
  v_and_b32 v72, 1, v55
  v_lshrrev_b32 v74, 1, v55
  v_mul_u32_u24 v75, 0x600, v72
  v_mul_u32_u24 v64, s57, v74
  v_add_u32 v75, v75, v64
  v_lshl_add_u32 v75, v54, 2, v75
  s_lshr_b32 s49, s3, 1
  s_lshl_b32 s5, s49, 6
  s_add_u32 s6, s5, 256
  v_add_u32 v53, s6, v75
  s_lshl_b32 s6, s4, 7
  s_add_u32 s5, s5, s6
  v_add_u32 v52, s5, v75
  s_lshl_b32 s5, s47, 3
  s_add_u32 s5, s5, 4
  s_mul_i32 s5, s5, 384
  s_cmp_eq_u32 s47, 63
  s_cselect_b32 s37, 0, s5
  s_cselect_b32 s5, s5, 0
  s_cselect_b32 s6, s57, 0
  v_mul_u32_u24 v64, s6, v72
  v_sub_u32 v64, s5, v64
  s_lshl_b32 s38, s48, 3
  s_add_u32 s38, s38, 4
  s_xor_b32 s6, s4, 0
  s_lshl_b32 s6, s6, 1
  s_add_u32 s6, s6, s38
  s_and_b32 s6, s6, 511
  s_mul_i32 s6, s6, s57
  s_add_u32 s33, s6, s37
  s_xor_b32 s6, s4, 1
  s_lshl_b32 s6, s6, 1
  s_add_u32 s6, s6, s38
  s_and_b32 s6, s6, 511
  s_mul_i32 s6, s6, s57
  s_add_u32 s34, s6, s37
  s_xor_b32 s6, s4, 2
  s_lshl_b32 s6, s6, 1
  s_add_u32 s6, s6, s38
  s_and_b32 s6, s6, 511
  s_mul_i32 s6, s6, s57
  s_add_u32 s35, s6, s37
  s_xor_b32 s6, s4, 3
  s_lshl_b32 s6, s6, 1
  s_add_u32 s6, s6, s38
  s_and_b32 s6, s6, 511
  s_mul_i32 s6, s6, s57
  s_add_u32 s36, s6, s37
  v_add_u32 v7, v52, v64
  v_add_u32 v8, v53, v64
  s_lshr_b32 s5, s2, 6
  s_and_b32 s6, s2, 63
  s_mul_i32 s56, s5, 15
  s_lshl_b32 s43, s57, 5
  s_cmp_eq_u32 s6, 63
  s_cselect_b32 s6, s56, s6
  s_cselect_b32 s5, 60, s5
  s_cselect_b32 s43, 3072, s43
  s_mul_i32 s5, s5, 1572864
  s_mul_i32 s6, s6, 3072
  s_add_u32 s5, s5, s6
  s_add_u32 s56, s5, 787968
  s_cmp_eq_u32 s43, 3072
  s_cselect_b32 s10, s10, 95158272
  s_mul_i32 s5, s3, s57
  s_add_u32 s31, s56, s5
  s_add_u32 s32, s31, 786432
  s_mul_i32 s6, s43, 3
  s_add_u32 s5, s5, s6
  s_xor_b32 s6, s4, 0
  s_mul_i32 s6, s6, 393216
  s_sub_u32 s37, s6, s5
  s_xor_b32 s6, s4, 1
  s_mul_i32 s6, s6, 393216
  s_sub_u32 s38, s6, s5
  s_xor_b32 s6, s4, 2
  s_mul_i32 s6, s6, 393216
  s_sub_u32 s39, s6, s5
  s_xor_b32 s6, s4, 3
  s_mul_i32 s6, s6, 393216
  s_sub_u32 s40, s6, s5
  s_mov_b32 s97, 14
  s_mov_b32 s42, 0x3e553b95
  v_lshrrev_b32 v75, 2, v54
  v_lshl_add_u32 v64, v72, 1, v73
  v_lshl_add_u32 v75, v55, 3, v75
  v_lshlrev_b32 v75, 7, v75
  v_lshl_add_u32 v75, v64, 5, v75
  v_and_b32 v77, 3, v54
  v_lshl_add_u32 v75, v77, 3, v75
  s_mul_i32 s5, s3, 3
  s_and_b32 s6, s5, 3
  s_lshl_b32 s6, s6, 5
  s_lshr_b32 s7, s5, 2
  s_lshl_b32 s7, s7, 13
  s_add_u32 s7, s7, 28672
  v_xor_b32 v64, s6, v75
  v_add_u32 v62, s7, v64
  v_add_u32 v58, 73728, v62
  s_add_u32 s5, s5, 1
  s_and_b32 s6, s5, 3
  s_lshl_b32 s6, s6, 5
  s_lshr_b32 s7, s5, 2
  s_lshl_b32 s7, s7, 13
  s_add_u32 s7, s7, 28672
  v_xor_b32 v64, s6, v75
  v_add_u32 v63, s7, v64
  v_add_u32 v59, 73728, v63
  s_add_u32 s5, s5, 1
  s_and_b32 s6, s5, 3
  s_lshl_b32 s6, s6, 5
  s_lshr_b32 s7, s5, 2
  s_lshl_b32 s7, s7, 13
  s_add_u32 s7, s7, 28672
  v_xor_b32 v64, s6, v75
  v_add_u32 v71, s7, v64
  v_add_u32 v60, 73728, v71
  v_xor_b32 v64, s49, v72
  s_lshl_b32 s5, s4, 13
  v_lshl_add_u32 v75, v74, 3, v72
  v_lshl_add_u32 v75, v75, 2, v64
  v_lshl_add_u32 v75, v75, 4, v54
  v_lshlrev_b32 v75, 2, v75
  s_add_u32 s5, s5, 126976
  v_add_u32 v68, s5, v75
  v_add_u32 v69, 128, v68
  v_add_u32 v54, 143360, v75
  v_add_u32 v55, 128, v54
  s_mov_b32 s58, 0x05040100
  s_mov_b32 s59, 0x07060302
  v_cmp_gt_u32 vcc, 2, v77
  v_mov_b32 v75, 0x3f803f80
  v_mov_b32 v64, 0x44444444
  v_cndmask_b32 v75, 0, v75, vcc
  v_cmp_eq_u32 vcc, 1, v77
  v_mov_b32 v76, 0xeeeeeeee
  v_accvgpr_write_b32 a240, v75
  v_accvgpr_write_b32 a241, v75
  v_accvgpr_write_b32 a242, v75
  v_accvgpr_write_b32 a243, v75
  v_cndmask_b32 v10, v64, v76, vcc
  v_mov_b32 v9, 1.0
  s_mov_b32 s98, s43
  s_mov_b64 s[20:21], s[62:63]
  s_mov_b32 s22, 402653184
  s_min_u32 s96, s3, 1
  s_lshl_b32 s96, s96, 7
  s_xor_b32 s96, s96, 1152
  s_bitset1_b32 s96, s97
  s_mov_b64 s[62:63], -1
  v_lshlrev_b32 v11, 3, v65
  v_lshlrev_b32 v75, 2, v70
  v_add_u32 v75, 159808, v75
  v_mov_b32 v64, 0
  ds_write_b32 v75, v64
  s_lshl_b32 m0, s3, 8
  s_nop 0
  ds_write_addtid_b32 v64 offset:24576
  v_mov_b64 v[14:15], 0
  v_mov_b64 v[20:21], 0
  v_sub_u32 v75, v73, v74
  v_mul_i32_i24 v75, 15, v75
  v_lshlrev_b32 v64, 2, v72
  v_sub_u32 v76, v70, v64
  v_add3_u32 v75, v75, v76, 19
  s_mul_i32 s5, s3, 2050
  s_add_u32 s5, s5, 151552
  v_lshl_add_u32 v72, v75, 3, s5
  v_mov_b64 v[24:25], 0
  v_mov_b64 v[26:27], 0
  v_mov_b64 v[28:29], 0
  v_mov_b64 v[30:31], 0
  v_mov_b64 v[32:33], 0
  v_mov_b64 v[34:35], 0
  v_mov_b64 v[36:37], 0
  v_mov_b64 v[38:39], 0
  v_mov_b64 v[40:41], 0
  v_mov_b64 v[42:43], 0
  v_mov_b64 v[44:45], 0
  v_mov_b64 v[46:47], 0
  v_mov_b64 v[48:49], 0
  v_mov_b64 v[50:51], 0
  v_xor_b32 v75, v64, v70
  s_cmp_eq_u32 s47, 63
  s_cselect_b32 s5, 4, 0
  v_and_b32 v75, s5, v75
  v_cmp_eq_u32 vcc, 0, v75
  s_cmp_eq_u32 s48, 63
  s_cselect_b32 s5, 0xc31044fe, 0
  v_mov_b32 v64, s5
  v_mov_b32 v70, 0xc31044fe
  v_cndmask_b32 v64, 0, v64, vcc
  v_cndmask_b32 v70, v70, 0, vcc
  s_add_u32 s5, s44, 0
  s_add_u32 m0, s46, 28672
  s_nop 0
  buffer_load_dwordx4 v61, s[12:15], s5 offen offset:0 lds
  s_add_u32 m0, s46, 36736
  s_nop 0
  buffer_load_dwordx4 v61, s[12:15], s5 offen offset:128 lds
  s_add_u32 m0, s46, 44800
  s_nop 0
  buffer_load_dwordx4 v61, s[12:15], s5 offen offset:256 lds
  s_add_u32 s5, s44, 36864
  s_add_u32 m0, s46, 32768
  s_nop 0
  buffer_load_dwordx4 v61, s[12:15], s5 offen offset:0 lds
  s_add_u32 m0, s46, 40832
  s_nop 0
  buffer_load_dwordx4 v61, s[12:15], s5 offen offset:128 lds
  s_add_u32 m0, s46, 48896
  s_nop 0
  buffer_load_dwordx4 v61, s[12:15], s5 offen offset:256 lds
  s_mov_b64 exec, 0
  s_cmp_eq_u32 s3, 0
  s_cbranch_scc1 L_hop_0_0
  s_cmp_eq_u32 s3, 1
  s_cbranch_scc1 L_hop_1_0
  s_cmp_eq_u32 s3, 2
  s_cbranch_scc1 L_hop_2_0
  s_branch L_hop_3_0
L_walk:
  s_mov_b64 exec, -1
L_walked:
  s_waitcnt vmcnt(12)
  ds_read_u16_d16_hi v24, v72 offset:24
  ds_read_u16_d16_hi v25, v72 offset:16
  ds_read_u16_d16_hi v26, v72 offset:8
  ds_read_u16_d16_hi v27, v72 offset:0
  ds_read_u16_d16_hi v28, v72 offset:264
  ds_read_u16_d16_hi v29, v72 offset:256
  ds_read_u16_d16_hi v30, v72 offset:248
  ds_read_u16_d16_hi v31, v72 offset:240
  ds_read_u16_d16_hi v32, v72 offset:504
  ds_read_u16_d16_hi v33, v72 offset:496
  ds_read_u16_d16_hi v34, v72 offset:488
  ds_read_u16_d16_hi v35, v72 offset:480
  ds_read_u16_d16_hi v36, v72 offset:744
  ds_read_u16_d16_hi v37, v72 offset:736
  ds_read_u16_d16_hi v38, v72 offset:728
  ds_read_u16_d16_hi v39, v72 offset:720
  ds_read_u16_d16_hi v40, v72 offset:984
  ds_read_u16_d16_hi v41, v72 offset:976
  ds_read_u16_d16_hi v42, v72 offset:968
  ds_read_u16_d16_hi v43, v72 offset:960
  ds_read_u16_d16_hi v44, v72 offset:1224
  ds_read_u16_d16_hi v45, v72 offset:1216
  ds_read_u16_d16_hi v46, v72 offset:1208
  ds_read_u16_d16_hi v47, v72 offset:1200
  ds_read_u16_d16_hi v48, v72 offset:1464
  ds_read_u16_d16_hi v49, v72 offset:1456
  ds_read_u16_d16_hi v50, v72 offset:1448
  ds_read_u16_d16_hi v51, v72 offset:1440
  s_mov_b32 s5, 0x3fb8aa3b
  v_add_f32 v64, v70, v64
  s_waitcnt lgkmcnt(15)
  v_mul_f32 v24, s5, v24
  v_mul_f32 v25, s5, v25
  v_mul_f32 v26, s5, v26
  v_mul_f32 v27, s5, v27
  v_mul_f32 v28, s5, v28
  v_mul_f32 v29, s5, v29
  v_mul_f32 v30, s5, v30
  v_mul_f32 v31, s5, v31
  v_mul_f32 v32, s5, v32
  v_mul_f32 v33, s5, v33
  v_mul_f32 v34, s5, v34
  v_mul_f32 v35, s5, v35
  v_mul_f32 v36, s5, v36
  s_waitcnt lgkmcnt(14)
  v_mul_f32 v37, s5, v37
  s_waitcnt lgkmcnt(13)
  v_mul_f32 v38, s5, v38
  s_waitcnt lgkmcnt(12)
  v_mul_f32 v39, s5, v39
  s_waitcnt lgkmcnt(11)
  v_mul_f32 v40, s5, v40
  s_waitcnt lgkmcnt(10)
  v_mul_f32 v41, s5, v41
  s_waitcnt lgkmcnt(9)
  v_mul_f32 v42, s5, v42
  s_waitcnt lgkmcnt(8)
  v_mul_f32 v43, s5, v43
  s_waitcnt lgkmcnt(7)
  v_mul_f32 v44, s5, v44
  s_waitcnt lgkmcnt(6)
  v_mul_f32 v45, s5, v45
  s_waitcnt lgkmcnt(5)
  v_mul_f32 v46, s5, v46
  s_waitcnt lgkmcnt(4)
  v_mul_f32 v47, s5, v47
  s_waitcnt lgkmcnt(3)
  v_mul_f32 v48, s5, v48
  s_waitcnt lgkmcnt(2)
  v_mul_f32 v49, s5, v49
  s_waitcnt lgkmcnt(1)
  v_mul_f32 v50, s5, v50
  s_waitcnt lgkmcnt(0)
  v_mul_f32 v51, s5, v51
  v_add_f32 v76, v64, v48
  v_add_f32 v77, v64, v49
  v_add_f32 v78, v64, v50
  v_add_f32 v79, v64, v51
  v_add_f32 v72, v64, v44
  v_add_f32 v73, v64, v45
  v_add_f32 v74, v64, v46
  v_add_f32 v75, v64, v47
  v_add_f32 v80, v64, v40
  v_add_f32 v81, v64, v41
  v_add_f32 v82, v64, v42
  v_add_f32 v83, v64, v43
  v_add_f32 v84, v64, v32
  v_add_f32 v85, v64, v33
  v_add_f32 v86, v64, v34
  v_add_f32 v87, v64, v35
  v_add_f32 v88, v64, v28
  v_add_f32 v89, v64, v29
  v_add_f32 v90, v64, v30
  v_add_f32 v91, v64, v31
  v_add_f32 v92, v64, v24
  v_add_f32 v93, v64, v25
  v_add_f32 v94, v64, v26
  v_add_f32 v95, v64, v27
  s_add_u32 s5, s44, 73728
  s_add_u32 m0, s46, 53248
  s_nop 0
  buffer_load_dwordx4 v61, s[12:15], s5 offen offset:0 lds
  s_add_u32 m0, s46, 61312
  s_nop 0
  buffer_load_dwordx4 v61, s[12:15], s5 offen offset:128 lds
  s_add_u32 m0, s46, 69376
  s_nop 0
  buffer_load_dwordx4 v61, s[12:15], s5 offen offset:256 lds
  s_add_u32 s5, s44, 110592
  s_add_u32 m0, s46, 57344
  s_nop 0
  buffer_load_dwordx4 v61, s[12:15], s5 offen offset:0 lds
  s_add_u32 m0, s46, 65408
  s_nop 0
  buffer_load_dwordx4 v61, s[12:15], s5 offen offset:128 lds
  s_add_u32 m0, s46, 73472
  s_nop 0
  buffer_load_dwordx4 v61, s[12:15], s5 offen offset:256 lds
  s_waitcnt vmcnt(12)
  s_barrier
  ds_read_b128 v[184:187], v0 offset:0
  ds_read_b128 v[188:191], v1 offset:0
  ds_read_b128 v[208:211], v0 offset:2048
  ds_read_b128 v[212:215], v1 offset:2048
  ds_read_b128 v[232:235], v0 offset:4096
  ds_read_b128 v[236:239], v1 offset:4096
  ds_read_b128 a[216:219], v0 offset:6144
  ds_read_b128 a[220:223], v1 offset:6144
  s_add_u32 s5, s44, 147456
  s_add_u32 m0, s46, 77824
  s_nop 0
  buffer_load_dwordx4 v61, s[12:15], s5 offen offset:0 lds
  s_add_u32 m0, s46, 85888
  s_nop 0
  buffer_load_dwordx4 v61, s[12:15], s5 offen offset:128 lds
  s_add_u32 m0, s46, 93952
  s_nop 0
  buffer_load_dwordx4 v61, s[12:15], s5 offen offset:256 lds
  s_waitcnt vmcnt(9)
  s_barrier
  ds_read_b64_tr_b16 a[0:1], v62 offset:0
  ds_read_b64_tr_b16 a[2:3], v62 offset:512
  ds_read_b64_tr_b16 a[12:13], v62 offset:4096
  ds_read_b64_tr_b16 a[14:15], v62 offset:4608
  s_waitcnt lgkmcnt(2)
  v_mfma_f32_16x16x32_bf16 v[120:123], a[0:3], v[184:187], 0
  s_add_u32 s5, s44, 184320
  s_add_u32 m0, s46, 81920
  ds_read_b64_tr_b16 a[4:5], v63 offset:0
  s_waitcnt lgkmcnt(1)
  v_mfma_f32_16x16x32_bf16 v[120:123], a[12:15], v[188:191], v[120:123]
  buffer_load_dwordx4 v61, s[12:15], s5 offen offset:0 lds
  v_mfma_f32_16x16x32_bf16 v[132:135], a[0:3], v[208:211], 0
  s_add_u32 m0, s46, 89984
  ds_read_b64_tr_b16 a[6:7], v63 offset:512
  ds_read_b64_tr_b16 a[16:17], v63 offset:4096
  v_mfma_f32_16x16x32_bf16 v[132:135], a[12:15], v[212:215], v[132:135]
  buffer_load_dwordx4 v61, s[12:15], s5 offen offset:128 lds
  v_mfma_f32_16x16x32_bf16 v[148:151], a[0:3], v[232:235], 0
  s_add_u32 m0, s46, 98048
  ds_read_b64_tr_b16 a[18:19], v63 offset:4608
  ds_read_b64_tr_b16 a[8:9], v71 offset:0
  v_mfma_f32_16x16x32_bf16 v[148:151], a[12:15], v[236:239], v[148:151]
  buffer_load_dwordx4 v61, s[12:15], s5 offen offset:256 lds
  v_mfma_f32_16x16x32_bf16 v[96:99], a[0:3], a[216:219], 0
  s_add_u32 s5, s44, 384
  s_add_u32 m0, s46, 102400
  ds_read_b64_tr_b16 a[10:11], v71 offset:512
  v_mfma_f32_16x16x32_bf16 v[96:99], a[12:15], a[220:223], v[96:99]
  s_waitcnt lgkmcnt(3)
  ds_read_b64_tr_b16 a[20:21], v71 offset:4096
  ds_read_b64_tr_b16 a[22:23], v71 offset:4608
  v_mfma_f32_16x16x32_bf16 v[140:143], a[4:7], v[184:187], 0
  buffer_load_dwordx4 v61, s[12:15], s5 offen offset:0 lds
  s_waitcnt lgkmcnt(4)
  v_mfma_f32_16x16x32_bf16 v[140:143], a[16:19], v[188:191], v[140:143]
  s_add_u32 m0, s46, 110464
  ds_read_b128 v[192:195], v0 offset:8192
  ds_read_b128 v[196:199], v1 offset:8192
  v_mfma_f32_16x16x32_bf16 v[136:139], a[4:7], v[208:211], 0
  buffer_load_dwordx4 v61, s[12:15], s5 offen offset:128 lds
  v_mfma_f32_16x16x32_bf16 v[136:139], a[16:19], v[212:215], v[136:139]
  s_add_u32 m0, s46, 118528
  ds_read_b128 v[216:219], v0 offset:10240
  ds_read_b128 v[220:223], v1 offset:10240
  v_mfma_f32_16x16x32_bf16 v[164:167], a[4:7], v[232:235], 0
  buffer_load_dwordx4 v61, s[12:15], s5 offen offset:256 lds
  v_mfma_f32_16x16x32_bf16 v[164:167], a[16:19], v[236:239], v[164:167]
  s_add_u32 s5, s44, 37248
  s_add_u32 m0, s46, 106496
  ds_read_b128 v[240:243], v0 offset:12288
  v_mfma_f32_16x16x32_bf16 v[112:115], a[4:7], a[216:219], 0
  s_waitcnt lgkmcnt(3)
  ds_read_b128 v[244:247], v1 offset:12288
  ds_read_b128 a[224:227], v0 offset:14336
  v_mfma_f32_16x16x32_bf16 v[112:115], a[16:19], a[220:223], v[112:115]
  s_waitcnt vmcnt(9)
  s_barrier
  v_mfma_f32_16x16x32_bf16 v[144:147], a[8:11], v[184:187], 0
  buffer_load_dwordx4 v61, s[12:15], s5 offen offset:0 lds
  v_mfma_f32_16x16x32_bf16 v[144:147], a[20:23], v[188:191], v[144:147]
  s_add_u32 m0, s46, 114560
  ds_read_b64_tr_b16 a[24:25], v62 offset:24576
  ds_read_b64_tr_b16 a[26:27], v62 offset:25088
  v_mfma_f32_16x16x32_bf16 v[128:131], a[8:11], v[208:211], 0
  buffer_load_dwordx4 v61, s[12:15], s5 offen offset:128 lds
  v_mfma_f32_16x16x32_bf16 v[128:131], a[20:23], v[212:215], v[128:131]
  s_add_u32 m0, s46, 122624
  ds_read_b64_tr_b16 a[36:37], v62 offset:28672
  ds_read_b64_tr_b16 a[38:39], v62 offset:29184
  v_mfma_f32_16x16x32_bf16 v[104:107], a[8:11], v[232:235], 0
  buffer_load_dwordx4 v61, s[12:15], s5 offen offset:256 lds
  v_mfma_f32_16x16x32_bf16 v[104:107], a[20:23], v[236:239], v[104:107]
  ds_read_b128 a[228:231], v1 offset:14336
  ds_read_b64_tr_b16 a[28:29], v63 offset:24576
  v_mfma_f32_16x16x32_bf16 v[116:119], a[8:11], a[216:219], 0
  ds_read_b64_tr_b16 a[30:31], v63 offset:25088
  ds_read_b64_tr_b16 a[40:41], v63 offset:28672
  v_mfma_f32_16x16x32_bf16 v[116:119], a[20:23], a[220:223], v[116:119]
  s_waitcnt lgkmcnt(6)
  ds_read_b64_tr_b16 a[42:43], v63 offset:29184
  ds_read_b64_tr_b16 a[32:33], v71 offset:24576
  v_mfma_f32_16x16x32_bf16 v[120:123], a[24:27], v[192:195], v[120:123]
  s_waitcnt lgkmcnt(6)
  ds_read_b64_tr_b16 a[34:35], v71 offset:25088
  ds_read_b64_tr_b16 a[44:45], v71 offset:28672
  v_mfma_f32_16x16x32_bf16 v[120:123], a[36:39], v[196:199], v[120:123]
  ds_read_b64_tr_b16 a[46:47], v71 offset:29184
  ds_read_b128 v[200:203], v0 offset:16384
  v_mfma_f32_16x16x32_bf16 v[132:135], a[24:27], v[216:219], v[132:135]
L_hop_0_0:
  s_cbranch_execz L_hop_0_1
  ds_read_b128 v[204:207], v1 offset:16384
  ds_read_b128 v[224:227], v0 offset:18432
  v_mfma_f32_16x16x32_bf16 v[132:135], a[36:39], v[220:223], v[132:135]
  ds_read_b128 v[228:231], v1 offset:18432
  ds_read_b128 v[248:251], v0 offset:20480
  v_mfma_f32_16x16x32_bf16 v[148:151], a[24:27], v[240:243], v[148:151]
  ds_read_b128 v[252:255], v1 offset:20480
  ds_read_b128 a[232:235], v0 offset:22528
  v_mfma_f32_16x16x32_bf16 v[148:151], a[36:39], v[244:247], v[148:151]
  s_add_u32 s5, s44, 74112
  s_add_u32 m0, s46, 126976
  ds_read_b128 a[236:239], v1 offset:22528
  v_mfma_f32_16x16x32_bf16 v[96:99], a[24:27], a[224:227], v[96:99]
  s_waitcnt lgkmcnt(7)
  v_mfma_f32_16x16x32_bf16 v[96:99], a[36:39], a[228:231], v[96:99]
  v_mfma_f32_16x16x32_bf16 v[140:143], a[28:31], v[192:195], v[140:143]
  buffer_load_dwordx4 v61, s[12:15], s5 offen offset:0 lds
  v_mfma_f32_16x16x32_bf16 v[140:143], a[40:43], v[196:199], v[140:143]
  s_add_u32 m0, s46, 135040
  v_mfma_f32_16x16x32_bf16 v[136:139], a[28:31], v[216:219], v[136:139]
  buffer_load_dwordx4 v61, s[12:15], s5 offen offset:128 lds
  v_mfma_f32_16x16x32_bf16 v[136:139], a[40:43], v[220:223], v[136:139]
  s_add_u32 m0, s46, 143104
  v_mfma_f32_16x16x32_bf16 v[164:167], a[28:31], v[240:243], v[164:167]
  buffer_load_dwordx4 v61, s[12:15], s5 offen offset:256 lds
  v_mfma_f32_16x16x32_bf16 v[164:167], a[40:43], v[244:247], v[164:167]
  s_add_u32 s5, s44, 110976
  s_add_u32 m0, s46, 131072
  v_mfma_f32_16x16x32_bf16 v[112:115], a[28:31], a[224:227], v[112:115]
  v_mfma_f32_16x16x32_bf16 v[112:115], a[40:43], a[228:231], v[112:115]
  s_waitcnt vmcnt(9)
  s_barrier
  v_mfma_f32_16x16x32_bf16 v[144:147], a[32:35], v[192:195], v[144:147]
  buffer_load_dwordx4 v61, s[12:15], s5 offen offset:0 lds
  v_mfma_f32_16x16x32_bf16 v[144:147], a[44:47], v[196:199], v[144:147]
  s_add_u32 m0, s46, 139136
  ds_read_b64_tr_b16 a[48:49], v62 offset:49152
  ds_read_b64_tr_b16 a[50:51], v62 offset:49664
  v_mfma_f32_16x16x32_bf16 v[128:131], a[32:35], v[216:219], v[128:131]
  buffer_load_dwordx4 v61, s[12:15], s5 offen offset:128 lds
  v_mfma_f32_16x16x32_bf16 v[128:131], a[44:47], v[220:223], v[128:131]
  s_add_u32 m0, s46, 147200
  ds_read_b64_tr_b16 a[60:61], v62 offset:53248
  ds_read_b64_tr_b16 a[62:63], v62 offset:53760
  v_mfma_f32_16x16x32_bf16 v[104:107], a[32:35], v[240:243], v[104:107]
  buffer_load_dwordx4 v61, s[12:15], s5 offen offset:256 lds
  v_mfma_f32_16x16x32_bf16 v[104:107], a[44:47], v[244:247], v[104:107]
  ds_read_b64_tr_b16 a[52:53], v63 offset:49152
  ds_read_b64_tr_b16 a[54:55], v63 offset:49664
  v_mfma_f32_16x16x32_bf16 v[116:119], a[32:35], a[224:227], v[116:119]
  ds_read_b64_tr_b16 a[64:65], v63 offset:53248
  ds_read_b64_tr_b16 a[66:67], v63 offset:53760
  v_mfma_f32_16x16x32_bf16 v[116:119], a[44:47], a[228:231], v[116:119]
  s_waitcnt lgkmcnt(6)
  ds_read_b64_tr_b16 a[56:57], v71 offset:49152
  ds_read_b64_tr_b16 a[58:59], v71 offset:49664
  v_mfma_f32_16x16x32_bf16 v[120:123], a[48:51], v[200:203], v[120:123]
  s_waitcnt lgkmcnt(6)
  ds_read_b64_tr_b16 a[68:69], v71 offset:53248
  ds_read_b64_tr_b16 a[70:71], v71 offset:53760
  v_mfma_f32_16x16x32_bf16 v[120:123], a[60:63], v[204:207], v[120:123]
  v_mfma_f32_16x16x32_bf16 v[132:135], a[48:51], v[224:227], v[132:135]
  v_mfma_f32_16x16x32_bf16 v[132:135], a[60:63], v[228:231], v[132:135]
  v_mfma_f32_16x16x32_bf16 v[148:151], a[48:51], v[248:251], v[148:151]
  v_mul_f32 v120, s42, v120
  v_mul_f32 v121, s42, v121
  v_mfma_f32_16x16x32_bf16 v[148:151], a[60:63], v[252:255], v[148:151]
  s_add_u32 s5, s44, 147840
  s_add_u32 m0, s46, 28672
  v_mul_f32 v122, s42, v122
  v_mfma_f32_16x16x32_bf16 v[96:99], a[48:51], a[232:235], v[96:99]
  v_mul_f32 v123, s42, v123
  v_cvt_pk_bf16_f32 v12, v120, v121
  v_mfma_f32_16x16x32_bf16 v[96:99], a[60:63], a[236:239], v[96:99]
  s_waitcnt lgkmcnt(0)
  v_cvt_pk_bf16_f32 v13, v122, v123
  v_mul_f32 v132, s42, v132
  v_mfma_f32_16x16x32_bf16 v[140:143], a[52:55], v[200:203], v[140:143]
  buffer_load_dwordx4 v61, s[12:15], s5 offen offset:0 lds
  v_mfma_f32_16x16x32_bf16 v[140:143], a[64:67], v[204:207], v[140:143]
  s_add_u32 m0, s46, 36736
  v_mul_f32 v133, s42, v133
  v_mul_f32 v134, s42, v134
  v_mfma_f32_16x16x32_bf16 v[136:139], a[52:55], v[224:227], v[136:139]
  buffer_load_dwordx4 v61, s[12:15], s5 offen offset:128 lds
  v_mfma_f32_16x16x32_bf16 v[136:139], a[64:67], v[228:231], v[136:139]
  s_add_u32 m0, s46, 44800
  v_mul_f32 v135, s42, v135
  v_cvt_pk_bf16_f32 v64, v132, v133
  v_mfma_f32_16x16x32_bf16 v[164:167], a[52:55], v[248:251], v[164:167]
  buffer_load_dwordx4 v61, s[12:15], s5 offen offset:256 lds
  v_mfma_f32_16x16x32_bf16 v[164:167], a[64:67], v[252:255], v[164:167]
  s_add_u32 s5, s44, 184704
  s_add_u32 m0, s46, 32768
  v_mul_f32 v140, s42, v140
  v_mfma_f32_16x16x32_bf16 v[112:115], a[52:55], a[232:235], v[112:115]
  v_mul_f32 v141, s42, v141
  v_mul_f32 v142, s42, v142
  v_mfma_f32_16x16x32_bf16 v[112:115], a[64:67], a[236:239], v[112:115]
  s_waitcnt vmcnt(9)
  s_barrier
  v_mfma_f32_16x16x32_bf16 v[144:147], a[56:59], v[200:203], v[144:147]
  buffer_load_dwordx4 v61, s[12:15], s5 offen offset:0 lds
  v_mfma_f32_16x16x32_bf16 v[144:147], a[68:71], v[204:207], v[144:147]
  s_add_u32 m0, s46, 40832
  ds_read_b64_tr_b16 a[72:73], v58 offset:0
  ds_read_b64_tr_b16 a[74:75], v58 offset:512
  v_mfma_f32_16x16x32_bf16 v[128:131], a[56:59], v[224:227], v[128:131]
  buffer_load_dwordx4 v61, s[12:15], s5 offen offset:128 lds
  v_mfma_f32_16x16x32_bf16 v[128:131], a[68:71], v[228:231], v[128:131]
  s_add_u32 m0, s46, 48896
  ds_read_b64_tr_b16 a[84:85], v58 offset:4096
  ds_read_b64_tr_b16 a[86:87], v58 offset:4608
  v_mfma_f32_16x16x32_bf16 v[104:107], a[56:59], v[248:251], v[104:107]
  buffer_load_dwordx4 v61, s[12:15], s5 offen offset:256 lds
  v_mfma_f32_16x16x32_bf16 v[104:107], a[68:71], v[252:255], v[104:107]
  ds_read_b64_tr_b16 a[76:77], v59 offset:0
  ds_read_b64_tr_b16 a[78:79], v59 offset:512
  v_mfma_f32_16x16x32_bf16 v[116:119], a[56:59], a[232:235], v[116:119]
  ds_read_b64_tr_b16 a[88:89], v59 offset:4096
  ds_read_b64_tr_b16 a[90:91], v59 offset:4608
  v_mfma_f32_16x16x32_bf16 v[116:119], a[68:71], a[236:239], v[116:119]
  s_waitcnt lgkmcnt(6)
  ds_read_b64_tr_b16 a[80:81], v60 offset:0
  ds_read_b64_tr_b16 a[82:83], v60 offset:512
  v_mfma_f32_16x16x32_bf16 v[172:175], a[72:75], v[184:187], 0
  s_waitcnt lgkmcnt(6)
  ds_read_b64_tr_b16 a[92:93], v60 offset:4096
  ds_read_b64_tr_b16 a[94:95], v60 offset:4608
  v_mfma_f32_16x16x32_bf16 v[172:175], a[84:87], v[188:191], v[172:175]
  v_mul_f32 v143, s42, v143
  v_cvt_pk_bf16_f32 v124, v140, v141
  v_mfma_f32_16x16x32_bf16 v[152:155], a[72:75], v[208:211], 0
  v_cvt_pk_bf16_f32 v125, v142, v143
  v_mul_f32 v144, s42, v144
  v_mfma_f32_16x16x32_bf16 v[152:155], a[84:87], v[212:215], v[152:155]
  v_mul_f32 v145, s42, v145
  v_mul_f32 v146, s42, v146
  v_mfma_f32_16x16x32_bf16 v[156:159], a[72:75], v[232:235], 0
  v_mul_f32 v147, s42, v147
  v_cvt_pk_bf16_f32 v126, v144, v145
  v_mfma_f32_16x16x32_bf16 v[156:159], a[84:87], v[236:239], v[156:159]
  s_add_u32 s5, s44, 768
  s_add_u32 m0, s46, 53248
  v_cvt_pk_bf16_f32 v127, v146, v147
  v_mfma_f32_16x16x32_bf16 v[140:143], a[72:75], a[216:219], 0
  v_cvt_pk_bf16_f32 v65, v134, v135
  v_mul_f32 v136, s42, v136
  v_mfma_f32_16x16x32_bf16 v[140:143], a[84:87], a[220:223], v[140:143]
  s_waitcnt lgkmcnt(0)
  v_mul_f32 v137, s42, v137
  v_mul_f32 v138, s42, v138
  v_mfma_f32_16x16x32_bf16 v[160:163], a[76:79], v[184:187], 0
  buffer_load_dwordx4 v61, s[12:15], s5 offen offset:0 lds
  v_mfma_f32_16x16x32_bf16 v[160:163], a[88:91], v[188:191], v[160:163]
  s_add_u32 m0, s46, 61312
  v_mul_f32 v139, s42, v139
  v_cvt_pk_bf16_f32 v66, v136, v137
  v_mfma_f32_16x16x32_bf16 v[100:103], a[76:79], v[208:211], 0
  buffer_load_dwordx4 v61, s[12:15], s5 offen offset:128 lds
  v_mfma_f32_16x16x32_bf16 v[100:103], a[88:91], v[212:215], v[100:103]
  s_add_u32 m0, s46, 69376
  v_cvt_pk_bf16_f32 v67, v138, v139
  v_mul_f32 v128, s42, v128
  v_mfma_f32_16x16x32_bf16 v[168:171], a[76:79], v[232:235], 0
  buffer_load_dwordx4 v61, s[12:15], s5 offen offset:256 lds
  v_mfma_f32_16x16x32_bf16 v[168:171], a[88:91], v[236:239], v[168:171]
  s_add_u32 s5, s44, 37632
  s_add_u32 m0, s46, 57344
  v_mul_f32 v129, s42, v129
  v_mfma_f32_16x16x32_bf16 v[180:183], a[76:79], a[216:219], 0
  v_mul_f32 v130, s42, v130
  v_mul_f32 v131, s42, v131
  v_mfma_f32_16x16x32_bf16 v[180:183], a[88:91], a[220:223], v[180:183]
  s_waitcnt vmcnt(9)
  s_barrier
  v_mfma_f32_16x16x32_bf16 v[176:179], a[80:83], v[184:187], 0
  buffer_load_dwordx4 v61, s[12:15], s5 offen offset:0 lds
  v_mfma_f32_16x16x32_bf16 v[176:179], a[92:95], v[188:191], v[176:179]
  s_add_u32 m0, s46, 65408
  ds_read_b64_tr_b16 a[96:97], v58 offset:24576
  ds_read_b64_tr_b16 a[98:99], v58 offset:25088
  v_mfma_f32_16x16x32_bf16 v[108:111], a[80:83], v[208:211], 0
  buffer_load_dwordx4 v61, s[12:15], s5 offen offset:128 lds
  v_mfma_f32_16x16x32_bf16 v[108:111], a[92:95], v[212:215], v[108:111]
  s_add_u32 m0, s46, 73472
  ds_read_b64_tr_b16 a[108:109], v58 offset:28672
  ds_read_b64_tr_b16 a[110:111], v58 offset:29184
  v_mfma_f32_16x16x32_bf16 v[120:123], a[80:83], v[232:235], 0
  buffer_load_dwordx4 v61, s[12:15], s5 offen offset:256 lds
  v_mfma_f32_16x16x32_bf16 v[120:123], a[92:95], v[236:239], v[120:123]
  ds_read_b64_tr_b16 a[100:101], v59 offset:24576
  ds_read_b64_tr_b16 a[102:103], v59 offset:25088
  v_mfma_f32_16x16x32_bf16 v[132:135], a[80:83], a[216:219], 0
  ds_read_b64_tr_b16 a[112:113], v59 offset:28672
  ds_read_b64_tr_b16 a[114:115], v59 offset:29184
  v_mfma_f32_16x16x32_bf16 v[132:135], a[92:95], a[220:223], v[132:135]
  s_waitcnt lgkmcnt(6)
  ds_read_b64_tr_b16 a[104:105], v60 offset:24576
  ds_read_b64_tr_b16 a[106:107], v60 offset:25088
  v_mfma_f32_16x16x32_bf16 v[172:175], a[96:99], v[192:195], v[172:175]
  s_waitcnt lgkmcnt(6)
  ds_read_b64_tr_b16 a[116:117], v60 offset:28672
  ds_read_b64_tr_b16 a[118:119], v60 offset:29184
  v_mfma_f32_16x16x32_bf16 v[172:175], a[108:111], v[196:199], v[172:175]
  v_cvt_pk_bf16_f32 v16, v128, v129
  v_cvt_pk_bf16_f32 v17, v130, v131
  v_mfma_f32_16x16x32_bf16 v[152:155], a[96:99], v[216:219], v[152:155]
  v_mul_f32 v148, s42, v148
  v_mul_f32 v149, s42, v149
  v_mfma_f32_16x16x32_bf16 v[152:155], a[108:111], v[220:223], v[152:155]
  v_mul_f32 v150, s42, v150
  v_mul_f32 v151, s42, v151
  v_mfma_f32_16x16x32_bf16 v[156:159], a[96:99], v[240:243], v[156:159]
  v_cvt_pk_bf16_f32 v18, v148, v149
  v_cvt_pk_bf16_f32 v19, v150, v151
  v_mfma_f32_16x16x32_bf16 v[156:159], a[108:111], v[244:247], v[156:159]
  s_add_u32 s5, s44, 74496
  s_add_u32 m0, s46, 77824
  v_mul_f32 v164, s42, v164
  v_mfma_f32_16x16x32_bf16 v[140:143], a[96:99], a[224:227], v[140:143]
  v_mul_f32 v165, s42, v165
  v_mul_f32 v166, s42, v166
  v_mfma_f32_16x16x32_bf16 v[140:143], a[108:111], a[228:231], v[140:143]
  s_waitcnt lgkmcnt(0)
  v_mul_f32 v167, s42, v167
  v_cvt_pk_bf16_f32 v128, v164, v165
  v_mfma_f32_16x16x32_bf16 v[160:163], a[100:103], v[192:195], v[160:163]
  buffer_load_dwordx4 v61, s[12:15], s5 offen offset:0 lds
  v_mfma_f32_16x16x32_bf16 v[160:163], a[112:115], v[196:199], v[160:163]
  s_add_u32 m0, s46, 85888
  v_cvt_pk_bf16_f32 v129, v166, v167
  v_mul_f32 v104, s42, v104
  v_mfma_f32_16x16x32_bf16 v[100:103], a[100:103], v[216:219], v[100:103]
  buffer_load_dwordx4 v61, s[12:15], s5 offen offset:128 lds
  v_mfma_f32_16x16x32_bf16 v[100:103], a[112:115], v[220:223], v[100:103]
  s_add_u32 m0, s46, 93952
  v_mul_f32 v105, s42, v105
  v_mul_f32 v106, s42, v106
  v_mfma_f32_16x16x32_bf16 v[168:171], a[100:103], v[240:243], v[168:171]
  buffer_load_dwordx4 v61, s[12:15], s5 offen offset:256 lds
  v_mfma_f32_16x16x32_bf16 v[168:171], a[112:115], v[244:247], v[168:171]
  s_add_u32 s5, s44, 111360
  s_add_u32 m0, s46, 81920
  v_mul_f32 v107, s42, v107
  v_mfma_f32_16x16x32_bf16 v[180:183], a[100:103], a[224:227], v[180:183]
  v_add_f32 v148, v70, v36
  v_add_f32 v149, v70, v37
  v_mfma_f32_16x16x32_bf16 v[180:183], a[112:115], a[228:231], v[180:183]
  s_waitcnt vmcnt(9)
  s_barrier
  v_mfma_f32_16x16x32_bf16 v[176:179], a[104:107], v[192:195], v[176:179]
  buffer_load_dwordx4 v61, s[12:15], s5 offen offset:0 lds
  v_mfma_f32_16x16x32_bf16 v[176:179], a[116:119], v[196:199], v[176:179]
  s_add_u32 m0, s46, 89984
  ds_read_b64_tr_b16 a[120:121], v62 offset:0
  ds_read_b64_tr_b16 a[122:123], v62 offset:512
  v_mfma_f32_16x16x32_bf16 v[108:111], a[104:107], v[216:219], v[108:111]
  buffer_load_dwordx4 v61, s[12:15], s5 offen offset:128 lds
  v_mfma_f32_16x16x32_bf16 v[108:111], a[116:119], v[220:223], v[108:111]
  s_add_u32 m0, s46, 98048
  ds_read_b64_tr_b16 a[132:133], v62 offset:4096
  ds_read_b64_tr_b16 a[134:135], v62 offset:4608
  v_mfma_f32_16x16x32_bf16 v[120:123], a[104:107], v[240:243], v[120:123]
  buffer_load_dwordx4 v61, s[12:15], s5 offen offset:256 lds
  v_mfma_f32_16x16x32_bf16 v[120:123], a[116:119], v[244:247], v[120:123]
  ds_read_b64_tr_b16 a[124:125], v63 offset:0
  ds_read_b64_tr_b16 a[126:127], v63 offset:512
  v_mfma_f32_16x16x32_bf16 v[132:135], a[104:107], a[224:227], v[132:135]
  ds_read_b64_tr_b16 a[136:137], v63 offset:4096
  ds_read_b64_tr_b16 a[138:139], v63 offset:4608
  v_mfma_f32_16x16x32_bf16 v[132:135], a[116:119], a[228:231], v[132:135]
  s_waitcnt lgkmcnt(6)
  ds_read_b64_tr_b16 a[128:129], v71 offset:0
  ds_read_b64_tr_b16 a[130:131], v71 offset:512
  v_mfma_f32_16x16x32_bf16 v[172:175], a[120:123], v[200:203], v[172:175]
  s_waitcnt lgkmcnt(6)
  ds_read_b64_tr_b16 a[140:141], v71 offset:4096
  ds_read_b64_tr_b16 a[142:143], v71 offset:4608
  v_mfma_f32_16x16x32_bf16 v[172:175], a[132:135], v[204:207], v[172:175]
  v_add_f32 v150, v70, v38
  v_add_f32 v151, v70, v39
  v_mfma_f32_16x16x32_bf16 v[152:155], a[120:123], v[224:227], v[152:155]
  v_add_f32 v144, v70, v32
  v_add_f32 v145, v70, v33
  v_mfma_f32_16x16x32_bf16 v[152:155], a[132:135], v[228:231], v[152:155]
  v_add_f32 v146, v70, v34
  v_add_f32 v147, v70, v35
  v_mfma_f32_16x16x32_bf16 v[156:159], a[120:123], v[248:251], v[156:159]
  v_cvt_pk_bf16_f32 v138, v172, v173
  v_cvt_pk_bf16_f32 v139, v174, v175
  v_mfma_f32_16x16x32_bf16 v[156:159], a[132:135], v[252:255], v[156:159]
  s_add_u32 s5, s44, 148224
  s_add_u32 m0, s46, 102400
  v_add_f32 v172, v70, v40
  v_mfma_f32_16x16x32_bf16 v[140:143], a[120:123], a[232:235], v[140:143]
  v_cvt_pk_bf16_f32 v164, v152, v153
  v_cvt_pk_bf16_f32 v165, v154, v155
  v_mfma_f32_16x16x32_bf16 v[140:143], a[132:135], a[236:239], v[140:143]
  s_waitcnt lgkmcnt(0)
  v_add_f32 v173, v70, v41
  v_add_f32 v174, v70, v42
  v_mfma_f32_16x16x32_bf16 v[160:163], a[124:127], v[200:203], v[160:163]
  buffer_load_dwordx4 v61, s[12:15], s5 offen offset:0 lds
  v_mfma_f32_16x16x32_bf16 v[160:163], a[136:139], v[204:207], v[160:163]
  s_add_u32 m0, s46, 110464
  v_cvt_pk_bf16_f32 v152, v156, v157
  v_cvt_pk_bf16_f32 v153, v158, v159
  v_mfma_f32_16x16x32_bf16 v[100:103], a[124:127], v[224:227], v[100:103]
  buffer_load_dwordx4 v61, s[12:15], s5 offen offset:128 lds
  v_mfma_f32_16x16x32_bf16 v[100:103], a[136:139], v[228:231], v[100:103]
  s_add_u32 m0, s46, 118528
  v_cvt_pk_bf16_f32 v158, v140, v141
  v_cvt_pk_bf16_f32 v159, v142, v143
  v_mfma_f32_16x16x32_bf16 v[168:171], a[124:127], v[248:251], v[168:171]
  buffer_load_dwordx4 v61, s[12:15], s5 offen offset:256 lds
  v_mfma_f32_16x16x32_bf16 v[168:171], a[136:139], v[252:255], v[168:171]
  s_add_u32 s5, s44, 185088
  s_add_u32 m0, s46, 106496
  v_cvt_pk_bf16_f32 v140, v160, v161
  v_mfma_f32_16x16x32_bf16 v[180:183], a[124:127], a[232:235], v[180:183]
  v_cvt_pk_bf16_f32 v141, v162, v163
  v_cvt_pk_bf16_f32 v166, v100, v101
  v_mfma_f32_16x16x32_bf16 v[180:183], a[136:139], a[236:239], v[180:183]
  v_cvt_pk_bf16_f32 v167, v102, v103
  v_add_f32 v175, v70, v43
  v_mfma_f32_16x16x32_bf16 v[176:179], a[128:131], v[200:203], v[176:179]
  buffer_load_dwordx4 v61, s[12:15], s5 offen offset:0 lds
  v_mfma_f32_16x16x32_bf16 v[176:179], a[140:143], v[204:207], v[176:179]
  s_add_u32 m0, s46, 114560
  v_cvt_pk_bf16_f32 v154, v168, v169
  v_cvt_pk_bf16_f32 v155, v170, v171
  v_mfma_f32_16x16x32_bf16 v[108:111], a[128:131], v[224:227], v[108:111]
  buffer_load_dwordx4 v61, s[12:15], s5 offen offset:128 lds
  v_mfma_f32_16x16x32_bf16 v[108:111], a[140:143], v[228:231], v[108:111]
  s_add_u32 m0, s46, 122624
  v_cvt_pk_bf16_f32 v160, v180, v181
  v_cvt_pk_bf16_f32 v161, v182, v183
  v_mfma_f32_16x16x32_bf16 v[120:123], a[128:131], v[248:251], v[120:123]
  buffer_load_dwordx4 v61, s[12:15], s5 offen offset:256 lds
  v_mfma_f32_16x16x32_bf16 v[120:123], a[140:143], v[252:255], v[120:123]
  v_cvt_pk_bf16_f32 v142, v176, v177
  v_cvt_pk_bf16_f32 v143, v178, v179
  v_mfma_f32_16x16x32_bf16 v[132:135], a[128:131], a[232:235], v[132:135]
  v_cvt_pk_bf16_f32 v168, v108, v109
  v_cvt_pk_bf16_f32 v169, v110, v111
  v_mfma_f32_16x16x32_bf16 v[132:135], a[140:143], a[236:239], v[132:135]
  v_cvt_pk_bf16_f32 v130, v104, v105
  v_cvt_pk_bf16_f32 v131, v106, v107
  v_mfma_f32_16x16x32_bf16 v[100:103], v[140:143], v[124:127], v[148:151]
  v_cvt_pk_bf16_f32 v156, v120, v121
  v_cvt_pk_bf16_f32 v157, v122, v123
  v_mfma_f32_16x16x32_bf16 v[100:103], v[138:141], v[12:15], v[100:103]
  v_mul_f32 v96, s42, v96
  v_mul_f32 v97, s42, v97
  v_mfma_f32_16x16x32_bf16 v[104:107], v[166:169], v[124:127], v[144:147]
  v_cvt_pk_bf16_f32 v162, v132, v133
  v_cvt_pk_bf16_f32 v163, v134, v135
  v_mfma_f32_16x16x32_bf16 v[104:107], v[164:167], v[12:15], v[104:107]
  v_mul_f32 v98, s42, v98
  v_mul_f32 v99, s42, v99
  v_mfma_f32_16x16x32_bf16 v[180:183], v[154:157], v[124:127], v[88:91]
  v_cvt_pk_bf16_f32 v120, v96, v97
  v_cvt_pk_bf16_f32 v121, v98, v99
  v_mfma_f32_16x16x32_bf16 v[180:183], v[152:155], v[12:15], v[180:183]
  v_mul_f32 v112, s42, v112
  v_mul_f32 v113, s42, v113
  v_mfma_f32_16x16x32_bf16 v[176:179], v[160:163], v[124:127], v[92:95]
  v_mul_f32 v114, s42, v114
  v_mul_f32 v115, s42, v115
  v_mfma_f32_16x16x32_bf16 v[176:179], v[158:161], v[12:15], v[176:179]
  v_cvt_pk_bf16_f32 v122, v112, v113
  v_cvt_pk_bf16_f32 v123, v114, v115
  v_mfma_f32_16x16x32_bf16 v[108:111], v[138:141], v[64:67], v[172:175]
  v_mul_f32 v116, s42, v116
  v_mul_f32 v117, s42, v117
  v_mfma_f32_16x16x32_bf16 v[108:111], v[140:143], v[14:17], v[108:111]
  v_mul_f32 v118, s42, v118
  v_mul_f32 v119, s42, v119
  v_mfma_f32_16x16x32_bf16 v[112:115], v[164:167], v[64:67], v[148:151]
  v_cvt_pk_bf16_f32 v22, v116, v117
  v_cvt_pk_bf16_f32 v23, v118, v119
  v_mfma_f32_16x16x32_bf16 v[112:115], v[166:169], v[14:17], v[112:115]
  v_exp_f32 v100, v100
  v_mfma_f32_16x16x32_bf16 v[124:127], v[152:155], v[64:67], v[84:87]
  v_exp_f32 v101, v101
  v_mfma_f32_16x16x32_bf16 v[124:127], v[154:157], v[14:17], v[124:127]
  v_exp_f32 v102, v102
  v_mfma_f32_16x16x32_bf16 v[132:135], v[158:161], v[64:67], v[88:91]
  v_exp_f32 v103, v103
  v_mfma_f32_16x16x32_bf16 v[132:135], v[160:163], v[14:17], v[132:135]
  v_exp_f32 v104, v104
  v_mfma_f32_16x16x32_bf16 v[92:95], v[154:157], v[128:131], v[148:151]
  v_exp_f32 v105, v105
  v_mfma_f32_16x16x32_bf16 v[92:95], v[152:155], v[18:21], v[92:95]
  buffer_load_dword v65, v57, s[16:19], s51 offen
  v_mfma_f32_16x16x32_bf16 v[96:99], v[160:163], v[128:131], v[144:147]
  s_add_u32 m0, s28, 0
  v_exp_f32 v106, v106
  v_mfma_f32_16x16x32_bf16 v[96:99], v[158:161], v[18:21], v[96:99]
  v_exp_f32 v107, v107
  v_mfma_f32_16x16x32_bf16 v[116:119], v[140:143], v[128:131], v[72:75]
  s_waitcnt vmcnt(7)
  s_barrier
  v_mfma_f32_16x16x32_bf16 v[116:119], v[138:141], v[18:21], v[116:119]
  buffer_load_dwordx4 v6, s[8:11], s31 offen offset:0 nt lds
  v_mfma_f32_16x16x32_bf16 v[144:147], v[166:169], v[128:131], v[80:83]
  s_add_u32 m0, s28, 8064
  ds_read_b64_tr_b16 a[144:145], v62 offset:24576
  ds_read_b64_tr_b16 a[146:147], v62 offset:25088
  v_mfma_f32_16x16x32_bf16 v[144:147], v[164:167], v[18:21], v[144:147]
  ds_read_b64_tr_b16 a[156:157], v62 offset:28672
  ds_read_b64_tr_b16 a[158:159], v62 offset:29184
  v_mfma_f32_16x16x32_bf16 v[84:87], v[152:155], v[120:123], v[172:175]
  buffer_load_dwordx4 v6, s[8:11], s31 offen offset:128 nt lds
  v_mfma_f32_16x16x32_bf16 v[84:87], v[154:157], v[20:23], v[84:87]
  s_add_u32 m0, s28, 16128
  ds_read_b64_tr_b16 a[148:149], v63 offset:24576
  ds_read_b64_tr_b16 a[150:151], v63 offset:25088
  v_mfma_f32_16x16x32_bf16 v[88:91], v[158:161], v[120:123], v[148:151]
  ds_read_b64_tr_b16 a[160:161], v63 offset:28672
  ds_read_b64_tr_b16 a[162:163], v63 offset:29184
  v_mfma_f32_16x16x32_bf16 v[88:91], v[160:163], v[20:23], v[88:91]
  buffer_load_dwordx4 v6, s[8:11], s31 offen offset:256 nt lds
  v_mfma_f32_16x16x32_bf16 v[172:175], v[138:141], v[120:123], v[76:79]
  s_add_u32 s31, s31, s43
  ds_read_b64_tr_b16 a[152:153], v71 offset:24576
  ds_read_b64_tr_b16 a[154:155], v71 offset:25088
  v_mfma_f32_16x16x32_bf16 v[172:175], v[140:143], v[20:23], v[172:175]
  ds_read_b64_tr_b16 a[164:165], v71 offset:28672
  ds_read_b64_tr_b16 a[166:167], v71 offset:29184
  v_mfma_f32_16x16x32_bf16 v[76:79], v[164:167], v[120:123], v[72:75]
  ds_read_b64_tr_b16 a[168:169], v62 offset:49152
  ds_read_b64_tr_b16 a[170:171], v62 offset:49664
  v_mfma_f32_16x16x32_bf16 v[76:79], v[166:169], v[20:23], v[76:79]
  s_waitcnt lgkmcnt(6)
  ds_read_b64_tr_b16 a[180:181], v62 offset:53248
  ds_read_b64_tr_b16 a[182:183], v62 offset:53760
  v_mfma_f32_16x16x32_bf16 v[136:139], v[184:187], a[144:147], 0
  ds_read_b64_tr_b16 a[172:173], v63 offset:49152
  ds_read_b64_tr_b16 a[174:175], v63 offset:49664
  v_mfma_f32_16x16x32_bf16 v[136:139], v[188:191], a[156:159], v[136:139]
  ds_read_b64_tr_b16 a[184:185], v63 offset:53248
  ds_read_b64_tr_b16 a[186:187], v63 offset:53760
  v_mfma_f32_16x16x32_bf16 v[148:151], v[184:187], a[148:151], 0
  ds_read_b64_tr_b16 a[176:177], v71 offset:49152
  ds_read_b64_tr_b16 a[178:179], v71 offset:49664
  v_mfma_f32_16x16x32_bf16 v[148:151], v[188:191], a[160:163], v[148:151]
  s_waitcnt lgkmcnt(8)
  ds_read_b64_tr_b16 a[188:189], v71 offset:53248
  ds_read_b64_tr_b16 a[190:191], v71 offset:53760
  v_mfma_f32_16x16x32_bf16 v[152:155], v[184:187], a[152:155], 0
  v_exp_f32 v180, v180
  v_mfma_f32_16x16x32_bf16 v[152:155], v[188:191], a[164:167], v[152:155]
  v_exp_f32 v181, v181
  v_mfma_f32_16x16x32_bf16 v[72:75], v[208:211], a[144:147], 0
  v_exp_f32 v182, v182
  v_mfma_f32_16x16x32_bf16 v[72:75], v[212:215], a[156:159], v[72:75]
  v_exp_f32 v183, v183
  v_mfma_f32_16x16x32_bf16 v[140:143], v[208:211], a[148:151], 0
  v_exp_f32 v176, v176
  v_mfma_f32_16x16x32_bf16 v[140:143], v[212:215], a[160:163], v[140:143]
  v_exp_f32 v177, v177
  v_mfma_f32_16x16x32_bf16 v[128:131], v[208:211], a[152:155], 0
  v_exp_f32 v178, v178
  v_mfma_f32_16x16x32_bf16 v[128:131], v[212:215], a[164:167], v[128:131]
  v_exp_f32 v179, v179
  v_mfma_f32_16x16x32_bf16 v[136:139], v[192:195], a[168:171], v[136:139]
  s_waitcnt lgkmcnt(0)
  v_cvt_pk_bf16_f32 v100, v100, v101
  v_cvt_pk_bf16_f32 v101, v102, v103
  v_mfma_f32_16x16x32_bf16 v[136:139], v[196:199], a[180:183], v[136:139]
  v_cvt_pk_bf16_f32 v102, v104, v105
  v_cvt_pk_bf16_f32 v103, v106, v107
  v_mfma_f32_16x16x32_bf16 v[148:151], v[192:195], a[172:175], v[148:151]
  v_cvt_pk_bf16_f32 v104, v180, v181
  v_cvt_pk_bf16_f32 v105, v182, v183
  v_mfma_f32_16x16x32_bf16 v[148:151], v[196:199], a[184:187], v[148:151]
  v_cvt_pk_bf16_f32 v106, v176, v177
  v_cvt_pk_bf16_f32 v107, v178, v179
  v_mfma_f32_16x16x32_bf16 v[152:155], v[192:195], a[176:179], v[152:155]
  v_exp_f32 v108, v108
  v_mfma_f32_16x16x32_bf16 v[152:155], v[196:199], a[188:191], v[152:155]
  s_waitcnt vmcnt(4)
  s_barrier
  v_mfma_f32_16x16x32_bf16 v[72:75], v[216:219], a[168:171], v[72:75]
  ds_read_b64_tr_b16 a[192:193], v58 offset:0
  ds_read_b64_tr_b16 a[194:195], v58 offset:512
  v_mfma_f32_16x16x32_bf16 v[72:75], v[220:223], a[180:183], v[72:75]
  ds_read_b64_tr_b16 a[204:205], v58 offset:4096
  ds_read_b64_tr_b16 a[206:207], v58 offset:4608
  v_mfma_f32_16x16x32_bf16 v[140:143], v[216:219], a[172:175], v[140:143]
  ds_read_b64_tr_b16 a[196:197], v59 offset:0
  ds_read_b64_tr_b16 a[198:199], v59 offset:512
  v_mfma_f32_16x16x32_bf16 v[140:143], v[220:223], a[184:187], v[140:143]
  s_waitcnt lgkmcnt(4)
  ds_read_b64_tr_b16 a[208:209], v59 offset:4096
  ds_read_b64_tr_b16 a[210:211], v59 offset:4608
  v_mfma_f32_16x16x32_bf16 v[128:131], v[216:219], a[176:179], v[128:131]
  s_add_u32 s5, s45, 0
  ds_read_b64_tr_b16 a[200:201], v60 offset:0
  ds_read_b64_tr_b16 a[202:203], v60 offset:512
  v_mfma_f32_16x16x32_bf16 v[128:131], v[220:223], a[188:191], v[128:131]
  s_add_u32 m0, s46, 126976
  ds_read_b64_tr_b16 a[212:213], v60 offset:4096
  ds_read_b64_tr_b16 a[214:215], v60 offset:4608
  v_mfma_f32_16x16x32_bf16 v[136:139], v[200:203], a[192:195], v[136:139]
  s_waitcnt lgkmcnt(8)
  v_exp_f32 v109, v109
  v_mfma_f32_16x16x32_bf16 v[136:139], v[204:207], a[204:207], v[136:139]
  buffer_load_dwordx4 v56, s[16:19], s5 offen offset:0 lds
  s_waitcnt lgkmcnt(6)
  v_mfma_f32_16x16x32_bf16 v[148:151], v[200:203], a[196:199], v[148:151]
  s_add_u32 m0, s46, 135040
  v_exp_f32 v110, v110
  s_waitcnt lgkmcnt(4)
  v_mfma_f32_16x16x32_bf16 v[148:151], v[204:207], a[208:211], v[148:151]
  s_waitcnt lgkmcnt(2)
  v_exp_f32 v111, v111
  v_mfma_f32_16x16x32_bf16 v[152:155], v[200:203], a[200:203], v[152:155]
  buffer_load_dwordx4 v56, s[16:19], s5 offen offset:128 lds
  s_waitcnt lgkmcnt(0)
  v_mfma_f32_16x16x32_bf16 v[152:155], v[204:207], a[212:215], v[152:155]
  s_add_u32 m0, s46, 143104
  v_cvt_pk_bf16_f32 v80, v136, v137
  v_cvt_pk_bf16_f32 v81, v138, v139
  v_mfma_f32_16x16x32_bf16 v[72:75], v[224:227], a[192:195], v[72:75]
  v_cvt_pk_bf16_f32 v164, v148, v149
  v_cvt_pk_bf16_f32 v165, v150, v151
  v_mfma_f32_16x16x32_bf16 v[72:75], v[228:231], a[204:207], v[72:75]
  buffer_load_dwordx4 v56, s[16:19], s5 offen offset:256 lds
  v_mfma_f32_16x16x32_bf16 v[140:143], v[224:227], a[196:199], v[140:143]
  s_add_u32 s5, s45, 12288
  v_cvt_pk_bf16_f32 v120, v152, v153
  v_cvt_pk_bf16_f32 v121, v154, v155
  v_mfma_f32_16x16x32_bf16 v[140:143], v[228:231], a[208:211], v[140:143]
  s_add_u32 m0, s46, 131072
  v_exp_f32 v112, v112
  v_mfma_f32_16x16x32_bf16 v[128:131], v[224:227], a[200:203], v[128:131]
  buffer_load_dwordx4 v56, s[16:19], s5 offen offset:0 lds
  v_mfma_f32_16x16x32_bf16 v[128:131], v[228:231], a[212:215], v[128:131]
  s_add_u32 m0, s46, 139136
  v_cvt_pk_bf16_f32 v82, v72, v73
  v_cvt_pk_bf16_f32 v83, v74, v75
  v_mfma_f32_16x16x32_bf16 v[60:63], v[232:235], a[144:147], 0
  v_cvt_pk_bf16_f32 v166, v140, v141
  v_cvt_pk_bf16_f32 v167, v142, v143
  v_mfma_f32_16x16x32_bf16 v[60:63], v[236:239], a[156:159], v[60:63]
  buffer_load_dwordx4 v56, s[16:19], s5 offen offset:128 lds
  v_mfma_f32_16x16x32_bf16 v[60:63], v[240:243], a[168:171], v[60:63]
  s_add_u32 m0, s46, 147200
  v_cvt_pk_bf16_f32 v122, v128, v129
  v_cvt_pk_bf16_f32 v123, v130, v131
  v_mfma_f32_16x16x32_bf16 v[60:63], v[244:247], a[180:183], v[60:63]
  v_exp_f32 v113, v113
  v_mfma_f32_16x16x32_bf16 v[60:63], v[248:251], a[192:195], v[60:63]
  buffer_load_dwordx4 v56, s[16:19], s5 offen offset:256 lds
  v_mfma_f32_16x16x32_bf16 v[60:63], v[252:255], a[204:207], v[60:63]
  v_exp_f32 v114, v114
  v_mfma_f32_16x16x32_bf16 v[128:131], v[232:235], a[148:151], 0
  v_exp_f32 v115, v115
  v_mfma_f32_16x16x32_bf16 v[128:131], v[236:239], a[160:163], v[128:131]
  v_exp_f32 v124, v124
  v_mfma_f32_16x16x32_bf16 v[128:131], v[240:243], a[172:175], v[128:131]
  v_cvt_pk_bf16_f32 v72, v60, v61
  v_cvt_pk_bf16_f32 v73, v62, v63
  v_mfma_f32_16x16x32_bf16 v[128:131], v[244:247], a[184:187], v[128:131]
  v_exp_f32 v125, v125
  v_mfma_f32_16x16x32_bf16 v[128:131], v[248:251], a[196:199], v[128:131]
  v_exp_f32 v126, v126
  v_mfma_f32_16x16x32_bf16 v[128:131], v[252:255], a[208:211], v[128:131]
  v_exp_f32 v127, v127
  v_mfma_f32_16x16x32_bf16 v[60:63], v[232:235], a[152:155], 0
L_hop_1_0:
  s_cbranch_execz L_hop_1_1
  v_exp_f32 v132, v132
  v_mfma_f32_16x16x32_bf16 v[60:63], v[236:239], a[164:167], v[60:63]
  v_exp_f32 v133, v133
  v_mfma_f32_16x16x32_bf16 v[60:63], v[240:243], a[176:179], v[60:63]
  v_cvt_pk_bf16_f32 v180, v128, v129
  v_cvt_pk_bf16_f32 v181, v130, v131
  v_cvt_pk_bf16_f32 v108, v108, v109
  v_mfma_f32_16x16x32_bf16 v[60:63], v[244:247], a[188:191], v[60:63]
  v_exp_f32 v134, v134
  v_cvt_pk_bf16_f32 v109, v110, v111
  v_mfma_f32_16x16x32_bf16 v[60:63], v[248:251], a[200:203], v[60:63]
  v_exp_f32 v135, v135
  v_cvt_pk_bf16_f32 v110, v112, v113
  v_mfma_f32_16x16x32_bf16 v[60:63], v[252:255], a[212:215], v[60:63]
  v_cvt_pk_bf16_f32 v111, v114, v115
  v_cvt_pk_bf16_f32 v112, v124, v125
  v_cvt_pk_bf16_f32 v113, v126, v127
  v_mfma_f32_16x16x32_bf16 v[128:131], a[216:219], a[144:147], 0
  v_cvt_pk_bf16_f32 v114, v132, v133
  v_cvt_pk_bf16_f32 v115, v134, v135
  v_add_u32 v0, s28, v2
  v_mfma_f32_16x16x32_bf16 v[128:131], a[220:223], a[156:159], v[128:131]
  s_add_u32 s5, s45, 24576
  s_add_u32 m0, s46, 0
  v_exp_f32 v92, v92
  v_mfma_f32_16x16x32_bf16 v[128:131], a[224:227], a[168:171], v[128:131]
  v_cvt_pk_bf16_f32 v168, v60, v61
  v_cvt_pk_bf16_f32 v169, v62, v63
  v_xor_b32 v1, 64, v0
  v_mfma_f32_16x16x32_bf16 v[128:131], a[228:231], a[180:183], v[128:131]
  v_exp_f32 v93, v93
  v_mfma_f32_16x16x32_bf16 v[128:131], a[232:235], a[192:195], v[128:131]
  buffer_load_dwordx4 v56, s[16:19], s5 offen offset:0 lds
  v_cvt_pk_bf16_f32 v92, v92, v93
  v_mfma_f32_16x16x32_bf16 v[128:131], a[236:239], a[204:207], v[128:131]
  s_add_u32 m0, s46, 8064
  v_exp_f32 v94, v94
  v_mfma_f32_16x16x32_bf16 v[124:127], a[216:219], a[148:151], 0
  v_exp_f32 v95, v95
  v_mfma_f32_16x16x32_bf16 v[124:127], a[220:223], a[160:163], v[124:127]
  buffer_load_dwordx4 v56, s[16:19], s5 offen offset:128 lds
  v_cvt_pk_bf16_f32 v93, v94, v95
  v_mfma_f32_16x16x32_bf16 v[124:127], a[224:227], a[172:175], v[124:127]
  s_add_u32 m0, s46, 16128
  v_cvt_pk_bf16_f32 v74, v128, v129
  v_cvt_pk_bf16_f32 v75, v130, v131
  v_mfma_f32_16x16x32_bf16 v[124:127], a[228:231], a[184:187], v[124:127]
  v_exp_f32 v96, v96
  v_mfma_f32_16x16x32_bf16 v[124:127], a[232:235], a[196:199], v[124:127]
  buffer_load_dwordx4 v56, s[16:19], s5 offen offset:256 lds
  v_mov_b64 v[160:161], 0
  v_mfma_f32_16x16x32_bf16 v[124:127], a[236:239], a[208:211], v[124:127]
  s_add_u32 s5, s45, 36864
  s_add_u32 m0, s46, 4096
  v_exp_f32 v97, v97
  v_mfma_f32_16x16x32_bf16 v[128:131], a[216:219], a[152:155], 0
  v_exp_f32 v98, v98
  v_cvt_pk_bf16_f32 v94, v96, v97
  v_mfma_f32_16x16x32_bf16 v[128:131], a[220:223], a[164:167], v[128:131]
  buffer_load_dwordx4 v56, s[16:19], s5 offen offset:0 lds
  v_mfma_f32_16x16x32_bf16 v[128:131], a[224:227], a[176:179], v[128:131]
  s_add_u32 m0, s46, 12160
  v_cvt_pk_bf16_f32 v182, v124, v125
  v_cvt_pk_bf16_f32 v183, v126, v127
  v_mfma_f32_16x16x32_bf16 v[128:131], a[228:231], a[188:191], v[128:131]
  v_exp_f32 v99, v99
  v_mfma_f32_16x16x32_bf16 v[128:131], a[232:235], a[200:203], v[128:131]
  buffer_load_dwordx4 v56, s[16:19], s5 offen offset:128 lds
  v_cvt_pk_bf16_f32 v95, v98, v99
  v_mfma_f32_16x16x32_bf16 v[128:131], a[236:239], a[212:215], v[128:131]
  s_add_u32 m0, s46, 20224
  v_mov_b64 v[132:133], 0
  v_exp_f32 v116, v116
  v_smfmac_f32_16x16x64_bf16 v[160:163], a[240:243], v[100:107], v10
  v_exp_f32 v117, v117
  v_mfma_f32_16x16x32_bf16 v[176:179], v[72:75], v[104:107], 0
  buffer_load_dwordx4 v56, s[16:19], s5 offen offset:256 lds
  v_cvt_pk_bf16_f32 v96, v116, v117
  v_mfma_f32_16x16x32_bf16 v[176:179], v[80:83], v[100:103], v[176:179]
  v_cvt_pk_bf16_f32 v170, v128, v129
  v_cvt_pk_bf16_f32 v171, v130, v131
  v_mfma_f32_16x16x32_bf16 v[124:127], v[164:167], v[100:103], 0
  v_exp_f32 v118, v118
  v_mfma_f32_16x16x32_bf16 v[124:127], v[180:183], v[104:107], v[124:127]
  v_exp_f32 v119, v119
  v_mfma_f32_16x16x32_bf16 v[128:131], v[168:171], v[104:107], 0
  v_exp_f32 v144, v144
  v_cvt_pk_bf16_f32 v97, v118, v119
  v_mfma_f32_16x16x32_bf16 v[128:131], v[120:123], v[100:103], v[128:131]
  v_exp_f32 v145, v145
  v_mov_b64 v[156:157], 0
  v_smfmac_f32_16x16x64_bf16 v[132:135], a[240:243], v[108:115], v10
  v_exp_f32 v146, v146
  v_cvt_pk_bf16_f32 v98, v144, v145
  v_mfma_f32_16x16x32_bf16 v[152:155], v[72:75], v[112:115], 0
  v_exp_f32 v147, v147
  v_add_f32 v160, v160, v161
  v_mfma_f32_16x16x32_bf16 v[152:155], v[80:83], v[108:111], v[152:155]
  v_cvt_pk_bf16_f32 v99, v146, v147
  v_exp_f32 v84, v84
  v_mfma_f32_16x16x32_bf16 v[140:143], v[164:167], v[108:111], 0
  v_exp_f32 v85, v85
  v_mfma_f32_16x16x32_bf16 v[140:143], v[180:183], v[112:115], v[140:143]
  v_exp_f32 v86, v86
  v_cvt_pk_bf16_f32 v84, v84, v85
  v_mfma_f32_16x16x32_bf16 v[136:139], v[168:171], v[112:115], 0
  v_exp_f32 v87, v87
  v_add_f32 v132, v132, v133
  v_mfma_f32_16x16x32_bf16 v[136:139], v[120:123], v[108:111], v[136:139]
  v_exp_f32 v88, v88
  v_cvt_pk_bf16_f32 v85, v86, v87
  v_smfmac_f32_16x16x64_bf16 v[156:159], a[240:243], v[92:99], v10
  v_exp_f32 v89, v89
  v_exp_f32 v90, v90
  v_exp_f32 v91, v91
  v_exp_f32 v172, v172
  v_exp_f32 v173, v173
  v_exp_f32 v174, v174
  v_exp_f32 v175, v175
  v_exp_f32 v76, v76
  v_exp_f32 v77, v77
  v_exp_f32 v78, v78
  v_exp_f32 v79, v79
  v_mfma_f32_16x16x32_bf16 v[148:151], v[80:83], v[96:99], 0
  s_add_u32 s5, s45, 49152
  v_cvt_pk_bf16_f32 v86, v88, v89
  v_cvt_pk_bf16_f32 v87, v90, v91
  v_cvt_pk_bf16_f32 v88, v172, v173
  v_cvt_pk_bf16_f32 v89, v174, v175
  v_cvt_pk_bf16_f32 v90, v76, v77
  v_cvt_pk_bf16_f32 v91, v78, v79
  v_mfma_f32_16x16x32_bf16 v[148:151], v[72:75], v[92:95], v[148:151]
  s_waitcnt vmcnt(6) lgkmcnt(0)
  s_barrier
  v_mfma_f32_16x16x32_bf16 v[144:147], v[180:183], v[92:95], 0
  s_add_u32 m0, s46, 102400
  ds_read_b128 v[60:63], v0 offset:0
  v_mov_b64 v[100:101], 0
  v_mfma_f32_16x16x32_bf16 v[144:147], v[164:167], v[96:99], v[144:147]
  buffer_load_dwordx4 v56, s[16:19], s5 offen offset:0 lds
  v_mfma_f32_16x16x32_bf16 v[116:119], v[120:123], v[96:99], 0
  s_add_u32 m0, s46, 110464
  ds_read_b128 a[252:255], v1 offset:0
  ds_read_b128 v[64:67], v0 offset:8192
  v_mfma_f32_16x16x32_bf16 v[116:119], v[168:171], v[92:95], v[116:119]
  ds_read_b128 v[172:175], v1 offset:8192
  ds_read_b128 a[248:251], v0 offset:16384
  v_smfmac_f32_16x16x64_bf16 v[100:103], a[240:243], v[84:91], v10
  buffer_load_dwordx4 v56, s[16:19], s5 offen offset:128 lds
  v_mfma_f32_16x16x32_bf16 v[108:111], v[80:83], v[88:91], 0
  s_add_u32 m0, s46, 118528
  ds_read_b128 v[112:115], v1 offset:16384
  ds_read2st64_b32 v[92:93], v68 offset0:0 offset1:2
  v_mfma_f32_16x16x32_bf16 v[108:111], v[72:75], v[84:87], v[108:111]
  ds_read2st64_b32 v[96:97], v69 offset0:0 offset1:2
  ds_read2st64_b32 v[94:95], v68 offset0:4 offset1:6
  v_mfma_f32_16x16x32_bf16 v[104:107], v[180:183], v[84:87], 0
  buffer_load_dwordx4 v56, s[16:19], s5 offen offset:256 lds
  v_mfma_f32_16x16x32_bf16 v[104:107], v[164:167], v[88:91], v[104:107]
  s_add_u32 s5, s45, 61440
  s_add_u32 m0, s46, 106496
  ds_read2st64_b32 v[98:99], v69 offset0:4 offset1:6
  v_mfma_f32_16x16x32_bf16 v[180:183], v[120:123], v[88:91], 0
  s_waitcnt lgkmcnt(3)
  ds_read2st64_b32 v[76:77], v54 offset0:0 offset1:2
  ds_read2st64_b32 v[80:81], v55 offset0:0 offset1:2
  v_mfma_f32_16x16x32_bf16 v[180:183], v[168:171], v[84:87], v[180:183]
  buffer_load_dwordx4 v56, s[16:19], s5 offen offset:0 lds
  v_mfma_f32_16x16x32_bf16 v[72:75], a[0:3], v[60:63], 0
  s_add_u32 m0, s46, 114560
  ds_read2st64_b32 v[78:79], v54 offset0:4 offset1:6
  ds_read2st64_b32 v[82:83], v55 offset0:4 offset1:6
  v_mfma_f32_16x16x32_bf16 v[72:75], a[12:15], a[252:255], v[72:75]
  v_rcp_f32 v162, v160
  v_mfma_f32_16x16x32_bf16 v[72:75], a[24:27], v[64:67], v[72:75]
  buffer_load_dwordx4 v56, s[16:19], s5 offen offset:128 lds
  v_mfma_f32_16x16x32_bf16 v[72:75], a[36:39], v[172:175], v[72:75]
  s_add_u32 m0, s46, 122624
  v_mul_f32 v176, v162, v176
  v_mul_f32 v177, v162, v177
  v_mfma_f32_16x16x32_bf16 v[72:75], a[48:51], a[248:251], v[72:75]
  s_waitcnt lgkmcnt(4)
  v_perm_b32 v184, v96, v92, s58
  v_perm_b32 v188, v96, v92, s59
  v_mfma_f32_16x16x32_bf16 v[72:75], a[60:63], v[112:115], v[72:75]
  buffer_load_dwordx4 v56, s[16:19], s5 offen offset:256 lds
  v_mfma_f32_16x16x32_bf16 v[84:87], a[64:67], v[112:115], 0
  s_waitcnt lgkmcnt(0)
  v_perm_b32 v185, v97, v93, s58
  v_perm_b32 v189, v97, v93, s59
  v_mfma_f32_16x16x32_bf16 v[84:87], a[52:55], a[248:251], v[84:87]
  s_add_u32 m0, s28, 4096
  v_perm_b32 v186, v98, v94, s58
  v_perm_b32 v190, v98, v94, s59
  v_mfma_f32_16x16x32_bf16 v[84:87], a[40:43], v[172:175], v[84:87]
  s_mov_b32 s5, s28
  v_mul_f32 v72, s42, v72
  v_mul_f32 v73, s42, v73
  v_mfma_f32_16x16x32_bf16 v[84:87], a[28:31], v[64:67], v[84:87]
  v_mul_f32 v74, s42, v74
  v_mul_f32 v75, s42, v75
  v_mfma_f32_16x16x32_bf16 v[84:87], a[16:19], a[252:255], v[84:87]
  buffer_load_dwordx4 v6, s[8:11], s32 offen offset:0 nt lds
  v_mfma_f32_16x16x32_bf16 v[84:87], a[4:7], v[60:63], v[84:87]
  s_add_u32 m0, s28, 12160
  v_cvt_pk_bf16_f32 v12, v72, v73
  v_cvt_pk_bf16_f32 v13, v74, v75
  v_mfma_f32_16x16x32_bf16 v[56:59], a[8:11], v[60:63], 0
  v_perm_b32 v187, v99, v95, s58
  v_perm_b32 v191, v99, v95, s59
  v_perm_b32 v192, v80, v76, s58
  v_mfma_f32_16x16x32_bf16 v[56:59], a[20:23], a[252:255], v[56:59]
  buffer_load_dwordx4 v6, s[8:11], s32 offen offset:128 nt lds
  v_perm_b32 v196, v80, v76, s59
  v_mfma_f32_16x16x32_bf16 v[56:59], a[32:35], v[64:67], v[56:59]
  s_add_u32 m0, s28, 20224
  v_mul_f32 v84, s42, v84
  v_mul_f32 v85, s42, v85
  v_mul_f32 v86, s42, v86
  v_mfma_f32_16x16x32_bf16 v[56:59], a[44:47], v[172:175], v[56:59]
  s_mov_b32 s28, s29
  v_mul_f32 v87, s42, v87
  v_cvt_pk_bf16_f32 v72, v84, v85
  v_cvt_pk_bf16_f32 v73, v86, v87
  v_mfma_f32_16x16x32_bf16 v[56:59], a[56:59], a[248:251], v[56:59]
  buffer_load_dwordx4 v6, s[8:11], s32 offen offset:256 nt lds
  v_perm_b32 v193, v81, v77, s58
  v_mfma_f32_16x16x32_bf16 v[56:59], a[68:71], v[112:115], v[56:59]
  s_add_u32 s32, s32, s43
  v_perm_b32 v197, v81, v77, s59
  v_perm_b32 v194, v82, v78, s58
  v_perm_b32 v198, v82, v78, s59
  v_mfma_f32_16x16x32_bf16 v[84:87], a[132:135], v[112:115], 0
  ds_read2st64_b32 v[92:93], v68 offset0:16 offset1:18
  v_perm_b32 v195, v83, v79, s58
  v_perm_b32 v199, v83, v79, s59
  v_mfma_f32_16x16x32_bf16 v[84:87], a[120:123], a[248:251], v[84:87]
  ds_read2st64_b32 v[96:97], v69 offset0:16 offset1:18
  ds_read2st64_b32 v[94:95], v68 offset0:20 offset1:22
  v_mul_f32 v178, v162, v178
  v_mfma_f32_16x16x32_bf16 v[84:87], a[108:111], v[172:175], v[84:87]
  v_mul_f32 v56, s42, v56
  v_mul_f32 v57, s42, v57
  v_mul_f32 v58, s42, v58
  v_mfma_f32_16x16x32_bf16 v[84:87], a[96:99], v[64:67], v[84:87]
  v_mul_f32 v59, s42, v59
  v_cvt_pk_bf16_f32 v74, v56, v57
  v_cvt_pk_bf16_f32 v75, v58, v59
  v_mfma_f32_16x16x32_bf16 v[84:87], a[84:87], a[252:255], v[84:87]
  ds_read2st64_b32 v[98:99], v69 offset0:20 offset1:22
  ds_read2st64_b32 v[76:77], v54 offset0:16 offset1:18
  v_mul_f32 v179, v162, v179
  v_mfma_f32_16x16x32_bf16 v[84:87], a[72:75], v[60:63], v[84:87]
  ds_read2st64_b32 v[80:81], v55 offset0:16 offset1:18
  ds_read2st64_b32 v[78:79], v54 offset0:20 offset1:22
  v_cvt_pk_bf16_f32 v176, v176, v177
  v_mfma_f32_16x16x32_bf16 v[56:59], a[76:79], v[60:63], 0
  ds_read2st64_b32 v[82:83], v55 offset0:20 offset1:22
  v_cvt_pk_bf16_f32 v177, v178, v179
  v_mul_f32 v124, v162, v124
  v_mfma_f32_16x16x32_bf16 v[56:59], a[88:91], a[252:255], v[56:59]
  v_mul_f32 v125, v162, v125
  v_mul_f32 v126, v162, v126
  v_mul_f32 v127, v162, v127
  v_mfma_f32_16x16x32_bf16 v[56:59], a[100:103], v[64:67], v[56:59]
  v_cvt_pk_bf16_f32 v120, v84, v85
  v_cvt_pk_bf16_f32 v121, v86, v87
  v_cvt_pk_bf16_f32 v124, v124, v125
  v_mfma_f32_16x16x32_bf16 v[56:59], a[112:115], v[172:175], v[56:59]
  s_waitcnt lgkmcnt(4)
  v_cvt_pk_bf16_f32 v125, v126, v127
  v_mul_f32 v128, v162, v128
  v_mul_f32 v129, v162, v129
  v_mfma_f32_16x16x32_bf16 v[56:59], a[124:127], a[248:251], v[56:59]
  v_mul_f32 v130, v162, v130
  v_mul_f32 v131, v162, v131
  v_cvt_pk_bf16_f32 v128, v128, v129
  v_mfma_f32_16x16x32_bf16 v[56:59], a[136:139], v[112:115], v[56:59]
  s_waitcnt lgkmcnt(0)
  v_cvt_pk_bf16_f32 v129, v130, v131
  v_max3_f32 v9, v160, v162, v9
  v_perm_b32 v200, v96, v92, s58
  v_mfma_f32_16x16x32_bf16 v[88:91], a[140:143], v[112:115], 0
  ds_write2st64_b32 v5, v176, v177 offset0:0 offset1:4
  v_mfma_f32_16x16x32_bf16 v[88:91], a[128:131], a[248:251], v[88:91]
  ds_write2st64_b32 v5, v124, v125 offset0:8 offset1:12
  v_mfma_f32_16x16x32_bf16 v[88:91], a[116:119], v[172:175], v[88:91]
  v_cvt_pk_bf16_f32 v122, v56, v57
  v_cvt_pk_bf16_f32 v123, v58, v59
  v_perm_b32 v204, v96, v92, s59
  v_mfma_f32_16x16x32_bf16 v[88:91], a[104:107], v[64:67], v[88:91]
  ds_write2st64_b32 v5, v128, v129 offset0:16 offset1:20
  v_mfma_f32_16x16x32_bf16 v[88:91], a[92:95], a[252:255], v[88:91]
  v_perm_b32 v201, v97, v93, s58
  v_perm_b32 v205, v97, v93, s59
  v_perm_b32 v202, v98, v94, s58
  v_mfma_f32_16x16x32_bf16 v[88:91], a[80:83], v[60:63], v[88:91]
  v_perm_b32 v206, v98, v94, s59
  v_perm_b32 v203, v99, v95, s58
  v_perm_b32 v207, v99, v95, s59
  v_mfma_f32_16x16x32_bf16 v[164:167], v[60:63], a[144:147], 0
  v_perm_b32 v208, v80, v76, s58
  v_perm_b32 v212, v80, v76, s59
  v_perm_b32 v209, v81, v77, s58
  v_mfma_f32_16x16x32_bf16 v[164:167], a[252:255], a[156:159], v[164:167]
  v_perm_b32 v213, v81, v77, s59
  v_perm_b32 v210, v82, v78, s58
  v_perm_b32 v214, v82, v78, s59
  v_mfma_f32_16x16x32_bf16 v[164:167], v[64:67], a[168:171], v[164:167]
  ds_read_b128 v[160:163], v0 offset:2048
  v_cvt_pk_bf16_f32 v124, v88, v89
  v_cvt_pk_bf16_f32 v125, v90, v91
  v_mfma_f32_16x16x32_bf16 v[164:167], v[172:175], a[180:183], v[164:167]
  ds_read_b128 v[176:179], v1 offset:2048
  ds_read_b128 v[168:171], v0 offset:10240
  v_perm_b32 v211, v83, v79, s58
  v_mfma_f32_16x16x32_bf16 v[164:167], a[248:251], a[192:195], v[164:167]
  s_add_u32 m0, s29, 0
  ds_read_b128 a[244:247], v1 offset:10240
  ds_read_b128 v[88:91], v0 offset:18432
  v_perm_b32 v215, v83, v79, s59
  v_mfma_f32_16x16x32_bf16 v[164:167], v[112:115], a[204:207], v[164:167]
  ds_read_b128 v[84:87], v1 offset:18432
  v_add_u32 v68, 4294840320, v68
  v_add_u32 v69, 4294840320, v69
  v_mfma_f32_16x16x32_bf16 v[128:131], v[112:115], a[208:211], 0
  s_waitcnt vmcnt(3)
  s_barrier
  v_mfma_f32_16x16x32_bf16 v[128:131], a[248:251], a[196:199], v[128:131]
  buffer_load_dwordx4 v6, s[8:11], s31 offen offset:0 nt lds
  v_add_u32 v54, 4294840320, v54
  v_mfma_f32_16x16x32_bf16 v[128:131], v[172:175], a[184:187], v[128:131]
  s_add_u32 m0, s29, 8064
  v_cvt_pk_bf16_f32 v56, v164, v165
  v_cvt_pk_bf16_f32 v57, v166, v167
  v_add_u32 v55, 4294840320, v55
  v_mfma_f32_16x16x32_bf16 v[128:131], v[64:67], a[172:175], v[128:131]
  ds_read2st64_b32 v[92:93], v68 offset0:0 offset1:2
  ds_read2st64_b32 v[96:97], v69 offset0:0 offset1:2
  v_add_f32 v156, v156, v157
  v_mfma_f32_16x16x32_bf16 v[128:131], a[252:255], a[160:163], v[128:131]
  ds_read2st64_b32 v[94:95], v68 offset0:4 offset1:6
  ds_read2st64_b32 v[98:99], v69 offset0:4 offset1:6
  v_add_f32 v100, v100, v101
  v_mfma_f32_16x16x32_bf16 v[128:131], v[60:63], a[148:151], v[128:131]
  buffer_load_dwordx4 v6, s[8:11], s31 offen offset:128 nt lds
  v_mfma_f32_16x16x32_bf16 v[164:167], v[60:63], a[152:155], 0
  s_add_u32 m0, s29, 16128
  ds_read2st64_b32 v[76:77], v54 offset0:0 offset1:2
  ds_read2st64_b32 v[80:81], v55 offset0:0 offset1:2
  v_mfma_f32_16x16x32_bf16 v[164:167], a[252:255], a[164:167], v[164:167]
  ds_read2st64_b32 v[78:79], v54 offset0:4 offset1:6
  ds_read2st64_b32 v[82:83], v55 offset0:4 offset1:6
  v_mfma_f32_16x16x32_bf16 v[164:167], v[64:67], a[176:179], v[164:167]
  v_cvt_pk_bf16_f32 v60, v128, v129
  v_cvt_pk_bf16_f32 v61, v130, v131
  v_mfma_f32_16x16x32_bf16 v[164:167], v[172:175], a[188:191], v[164:167]
  buffer_load_dwordx4 v6, s[8:11], s31 offen offset:256 nt lds
  v_mfma_f32_16x16x32_bf16 v[164:167], a[248:251], a[200:203], v[164:167]
  s_add_u32 m0, s29, 4096
  v_rcp_f32 v134, v132
  v_mfma_f32_16x16x32_bf16 v[164:167], v[112:115], a[212:215], v[164:167]
  s_waitcnt lgkmcnt(4)
  v_perm_b32 v216, v96, v92, s58
  v_perm_b32 v220, v96, v92, s59
  v_perm_b32 v217, v97, v93, s58
  v_mfma_f32_16x16x32_bf16 v[172:175], a[0:3], v[160:163], 0
  s_waitcnt lgkmcnt(0)
  v_perm_b32 v221, v97, v93, s59
  v_perm_b32 v218, v98, v94, s58
  v_perm_b32 v222, v98, v94, s59
  v_mfma_f32_16x16x32_bf16 v[172:175], a[12:15], v[176:179], v[172:175]
  buffer_load_dwordx4 v6, s[8:11], s32 offen offset:0 nt lds
  v_perm_b32 v219, v99, v95, s58
  v_mfma_f32_16x16x32_bf16 v[172:175], a[24:27], v[168:171], v[172:175]
  s_add_u32 m0, s29, 12160
  v_cvt_pk_bf16_f32 v64, v164, v165
  v_cvt_pk_bf16_f32 v65, v166, v167
  v_perm_b32 v223, v99, v95, s59
  v_mfma_f32_16x16x32_bf16 v[172:175], a[36:39], a[244:247], v[172:175]
  s_add_u32 s31, s31, s43
  v_perm_b32 v224, v80, v76, s58
  v_perm_b32 v228, v80, v76, s59
  v_perm_b32 v225, v81, v77, s58
  v_mfma_f32_16x16x32_bf16 v[172:175], a[48:51], v[88:91], v[172:175]
  v_perm_b32 v229, v81, v77, s59
  v_perm_b32 v226, v82, v78, s58
  v_perm_b32 v230, v82, v78, s59
  v_mfma_f32_16x16x32_bf16 v[172:175], a[60:63], v[84:87], v[172:175]
  buffer_load_dwordx4 v6, s[8:11], s32 offen offset:128 nt lds
  v_perm_b32 v227, v83, v79, s58
  v_mfma_f32_16x16x32_bf16 v[164:167], a[64:67], v[84:87], 0
  s_add_u32 m0, s29, 20224
  ds_read2st64_b32 v[92:93], v68 offset0:16 offset1:18
  ds_read2st64_b32 v[96:97], v69 offset0:16 offset1:18
  v_perm_b32 v231, v83, v79, s59
  v_mfma_f32_16x16x32_bf16 v[164:167], a[52:55], v[88:91], v[164:167]
  s_mov_b32 s29, s30
  ds_read2st64_b32 v[94:95], v68 offset0:20 offset1:22
  ds_read2st64_b32 v[98:99], v69 offset0:20 offset1:22
  v_mul_f32 v152, v134, v152
  v_mfma_f32_16x16x32_bf16 v[164:167], a[40:43], a[244:247], v[164:167]
  v_mul_f32 v172, s42, v172
  v_mul_f32 v173, s42, v173
  v_mul_f32 v174, s42, v174
  v_mfma_f32_16x16x32_bf16 v[164:167], a[28:31], v[168:171], v[164:167]
  buffer_load_dwordx4 v6, s[8:11], s32 offen offset:256 nt lds
  v_mul_f32 v175, s42, v175
  v_mfma_f32_16x16x32_bf16 v[164:167], a[16:19], v[176:179], v[164:167]
  s_add_u32 s32, s32, s43
  ds_read2st64_b32 v[76:77], v54 offset0:16 offset1:18
  v_cvt_pk_bf16_f32 v128, v172, v173
  v_cvt_pk_bf16_f32 v129, v174, v175
  v_mfma_f32_16x16x32_bf16 v[164:167], a[4:7], v[160:163], v[164:167]
  ds_read2st64_b32 v[80:81], v55 offset0:16 offset1:18
  ds_read2st64_b32 v[78:79], v54 offset0:20 offset1:22
  v_mul_f32 v153, v134, v153
  v_mfma_f32_16x16x32_bf16 v[172:175], a[8:11], v[160:163], 0
  s_waitcnt lgkmcnt(3)
  ds_read2st64_b32 v[82:83], v55 offset0:20 offset1:22
  v_mul_f32 v154, v134, v154
  v_mul_f32 v155, v134, v155
  v_mfma_f32_16x16x32_bf16 v[172:175], a[20:23], v[176:179], v[172:175]
  v_cvt_pk_bf16_f32 v152, v152, v153
  v_cvt_pk_bf16_f32 v153, v154, v155
  v_mul_f32 v140, v134, v140
  v_mfma_f32_16x16x32_bf16 v[172:175], a[32:35], v[168:171], v[172:175]
  v_mul_f32 v164, s42, v164
  v_mul_f32 v165, s42, v165
  v_mul_f32 v166, s42, v166
  v_mfma_f32_16x16x32_bf16 v[172:175], a[44:47], a[244:247], v[172:175]
  v_mul_f32 v167, s42, v167
  v_cvt_pk_bf16_f32 v130, v164, v165
  v_cvt_pk_bf16_f32 v131, v166, v167
  v_mfma_f32_16x16x32_bf16 v[172:175], a[56:59], v[88:91], v[172:175]
  v_mul_f32 v141, v134, v141
  v_mul_f32 v142, v134, v142
  v_mul_f32 v143, v134, v143
  v_mfma_f32_16x16x32_bf16 v[172:175], a[68:71], v[84:87], v[172:175]
  s_waitcnt lgkmcnt(0)
  v_cvt_pk_bf16_f32 v140, v140, v141
  v_cvt_pk_bf16_f32 v141, v142, v143
  v_mul_f32 v136, v134, v136
  v_mfma_f32_16x16x32_bf16 v[164:167], a[132:135], v[84:87], 0
  v_mul_f32 v137, v134, v137
  v_mul_f32 v138, v134, v138
  v_mul_f32 v139, v134, v139
  v_mfma_f32_16x16x32_bf16 v[164:167], a[120:123], v[88:91], v[164:167]
  v_cvt_pk_bf16_f32 v136, v136, v137
  v_cvt_pk_bf16_f32 v137, v138, v139
  v_max3_f32 v9, v132, v134, v9
  v_mfma_f32_16x16x32_bf16 v[164:167], a[108:111], a[244:247], v[164:167]
  v_mul_f32 v172, s42, v172
  v_mul_f32 v173, s42, v173
  v_mul_f32 v174, s42, v174
  v_mfma_f32_16x16x32_bf16 v[164:167], a[96:99], v[168:171], v[164:167]
  v_mul_f32 v175, s42, v175
  v_cvt_pk_bf16_f32 v16, v172, v173
  v_cvt_pk_bf16_f32 v17, v174, v175
  v_mfma_f32_16x16x32_bf16 v[164:167], a[84:87], v[176:179], v[164:167]
  ds_write2st64_b32 v5, v152, v153 offset0:1 offset1:5
  v_mfma_f32_16x16x32_bf16 v[164:167], a[72:75], v[160:163], v[164:167]
  ds_write2st64_b32 v5, v140, v141 offset0:9 offset1:13
  v_mfma_f32_16x16x32_bf16 v[132:135], a[76:79], v[160:163], 0
  ds_write2st64_b32 v5, v136, v137 offset0:17 offset1:21
  v_mfma_f32_16x16x32_bf16 v[132:135], a[88:91], v[176:179], v[132:135]
  v_rcp_f32 v158, v156
  v_perm_b32 v232, v96, v92, s58
  v_mfma_f32_16x16x32_bf16 v[132:135], a[100:103], v[168:171], v[132:135]
  v_cvt_pk_bf16_f32 v136, v164, v165
  v_cvt_pk_bf16_f32 v137, v166, v167
  v_mul_f32 v148, v158, v148
  v_mfma_f32_16x16x32_bf16 v[132:135], a[112:115], a[244:247], v[132:135]
  v_mul_f32 v149, v158, v149
  v_mul_f32 v150, v158, v150
  v_mul_f32 v151, v158, v151
  v_mfma_f32_16x16x32_bf16 v[132:135], a[124:127], v[88:91], v[132:135]
  v_cvt_pk_bf16_f32 v148, v148, v149
  v_cvt_pk_bf16_f32 v149, v150, v151
  v_mul_f32 v144, v158, v144
  v_mfma_f32_16x16x32_bf16 v[132:135], a[136:139], v[84:87], v[132:135]
  v_mul_f32 v145, v158, v145
  v_mul_f32 v146, v158, v146
  v_mul_f32 v147, v158, v147
  v_mfma_f32_16x16x32_bf16 v[152:155], a[140:143], v[84:87], 0
  v_cvt_pk_bf16_f32 v144, v144, v145
  v_cvt_pk_bf16_f32 v145, v146, v147
  v_mul_f32 v116, v158, v116
  v_mfma_f32_16x16x32_bf16 v[152:155], a[128:131], v[88:91], v[152:155]
  v_mul_f32 v117, v158, v117
  v_mul_f32 v118, v158, v118
  v_mul_f32 v119, v158, v119
  v_mfma_f32_16x16x32_bf16 v[152:155], a[116:119], a[244:247], v[152:155]
  v_cvt_pk_bf16_f32 v138, v132, v133
  v_cvt_pk_bf16_f32 v139, v134, v135
  v_cvt_pk_bf16_f32 v116, v116, v117
  v_mfma_f32_16x16x32_bf16 v[152:155], a[104:107], v[168:171], v[152:155]
  v_cvt_pk_bf16_f32 v117, v118, v119
  v_max3_f32 v9, v156, v158, v9
  v_perm_b32 v236, v96, v92, s59
  v_mfma_f32_16x16x32_bf16 v[152:155], a[92:95], v[176:179], v[152:155]
  ds_write2st64_b32 v5, v148, v149 offset0:2 offset1:6
  v_mfma_f32_16x16x32_bf16 v[152:155], a[80:83], v[160:163], v[152:155]
  ds_write2st64_b32 v5, v144, v145 offset0:10 offset1:14
  v_mfma_f32_16x16x32_bf16 v[164:167], v[160:163], a[144:147], 0
  ds_write2st64_b32 v5, v116, v117 offset0:18 offset1:22
  v_mfma_f32_16x16x32_bf16 v[164:167], v[176:179], a[156:159], v[164:167]
  v_rcp_f32 v102, v100
  v_perm_b32 v233, v97, v93, s58
  v_mfma_f32_16x16x32_bf16 v[164:167], v[168:171], a[168:171], v[164:167]
  v_cvt_pk_bf16_f32 v140, v152, v153
  v_cvt_pk_bf16_f32 v141, v154, v155
  v_mfma_f32_16x16x32_bf16 v[164:167], a[244:247], a[180:183], v[164:167]
  v_mul_f32 v108, v102, v108
  v_mul_f32 v109, v102, v109
  v_mfma_f32_16x16x32_bf16 v[164:167], v[88:91], a[192:195], v[164:167]
  s_waitcnt vmcnt(6) lgkmcnt(0)
  s_barrier
  v_mfma_f32_16x16x32_bf16 v[164:167], v[84:87], a[204:207], v[164:167]
  ds_read_b128 v[156:159], v0 offset:4096
  ds_read_b128 v[116:119], v1 offset:4096
  v_mfma_f32_16x16x32_bf16 v[144:147], v[84:87], a[208:211], 0
  ds_read_b128 v[132:135], v0 offset:12288
  ds_read_b128 v[152:155], v1 offset:12288
  v_mfma_f32_16x16x32_bf16 v[144:147], v[88:91], a[196:199], v[144:147]
  ds_read_b128 a[252:255], v0 offset:20480
  ds_read_b128 v[172:175], v1 offset:20480
  v_mfma_f32_16x16x32_bf16 v[144:147], a[244:247], a[184:187], v[144:147]
  v_cvt_pk_bf16_f32 v58, v164, v165
  v_cvt_pk_bf16_f32 v59, v166, v167
  v_mfma_f32_16x16x32_bf16 v[144:147], v[168:171], a[172:175], v[144:147]
  v_mul_f32 v110, v102, v110
  v_mul_f32 v111, v102, v111
  v_mfma_f32_16x16x32_bf16 v[144:147], v[176:179], a[160:163], v[144:147]
  v_cvt_pk_bf16_f32 v108, v108, v109
  v_cvt_pk_bf16_f32 v109, v110, v111
  v_mfma_f32_16x16x32_bf16 v[144:147], v[160:163], a[148:151], v[144:147]
  v_mul_f32 v104, v102, v104
  v_mul_f32 v105, v102, v105
  v_mfma_f32_16x16x32_bf16 v[148:151], v[160:163], a[152:155], 0
  v_mul_f32 v106, v102, v106
  v_mul_f32 v107, v102, v107
  v_mfma_f32_16x16x32_bf16 v[148:151], v[176:179], a[164:167], v[148:151]
  v_cvt_pk_bf16_f32 v104, v104, v105
  v_cvt_pk_bf16_f32 v105, v106, v107
  v_mfma_f32_16x16x32_bf16 v[148:151], v[168:171], a[176:179], v[148:151]
  v_cvt_pk_bf16_f32 v62, v144, v145
  v_cvt_pk_bf16_f32 v63, v146, v147
  v_mfma_f32_16x16x32_bf16 v[148:151], a[244:247], a[188:191], v[148:151]
  v_mul_f32 v180, v102, v180
  v_mul_f32 v181, v102, v181
  v_mfma_f32_16x16x32_bf16 v[148:151], v[88:91], a[200:203], v[148:151]
  v_mul_f32 v182, v102, v182
  v_mul_f32 v183, v102, v183
  v_mfma_f32_16x16x32_bf16 v[148:151], v[84:87], a[212:215], v[148:151]
  s_waitcnt lgkmcnt(0)
  v_cvt_pk_bf16_f32 v180, v180, v181
  v_cvt_pk_bf16_f32 v181, v182, v183
  v_mfma_f32_16x16x32_bf16 v[88:91], a[0:3], v[156:159], 0
  v_max3_f32 v9, v100, v102, v9
  v_perm_b32 v237, v97, v93, s59
  v_mfma_f32_16x16x32_bf16 v[88:91], a[12:15], v[116:119], v[88:91]
  ds_write2st64_b32 v5, v108, v109 offset0:3 offset1:7
  v_mfma_f32_16x16x32_bf16 v[88:91], a[24:27], v[132:135], v[88:91]
  v_cvt_pk_bf16_f32 v66, v148, v149
  v_cvt_pk_bf16_f32 v67, v150, v151
  v_mfma_f32_16x16x32_bf16 v[88:91], a[36:39], v[152:155], v[88:91]
  ds_write2st64_b32 v5, v104, v105 offset0:11 offset1:15
  v_mfma_f32_16x16x32_bf16 v[88:91], a[48:51], a[252:255], v[88:91]
  ds_write2st64_b32 v5, v180, v181 offset0:19 offset1:23
  v_mfma_f32_16x16x32_bf16 v[88:91], a[60:63], v[172:175], v[88:91]
  v_perm_b32 v234, v98, v94, s58
  v_perm_b32 v238, v98, v94, s59
  v_mfma_f32_16x16x32_bf16 v[84:87], a[64:67], v[172:175], 0
  v_perm_b32 v235, v99, v95, s58
  v_perm_b32 v239, v99, v95, s59
  v_mfma_f32_16x16x32_bf16 v[84:87], a[52:55], a[252:255], v[84:87]
  v_perm_b32 v240, v80, v76, s58
  v_perm_b32 v244, v80, v76, s59
  v_mfma_f32_16x16x32_bf16 v[84:87], a[40:43], v[152:155], v[84:87]
  v_mul_f32 v88, s42, v88
  v_mul_f32 v89, s42, v89
  v_mfma_f32_16x16x32_bf16 v[84:87], a[28:31], v[132:135], v[84:87]
  v_mul_f32 v90, s42, v90
  v_mul_f32 v91, s42, v91
  v_mfma_f32_16x16x32_bf16 v[84:87], a[16:19], v[116:119], v[84:87]
L_hop_2_0:
  s_cbranch_execz L_hop_2_1
  v_cvt_pk_bf16_f32 v18, v88, v89
  v_cvt_pk_bf16_f32 v19, v90, v91
  v_mfma_f32_16x16x32_bf16 v[84:87], a[4:7], v[156:159], v[84:87]
  v_perm_b32 v241, v81, v77, s58
  v_perm_b32 v245, v81, v77, s59
  v_mfma_f32_16x16x32_bf16 v[88:91], a[8:11], v[156:159], 0
  v_perm_b32 v242, v82, v78, s58
  v_perm_b32 v246, v82, v78, s59
  v_mfma_f32_16x16x32_bf16 v[88:91], a[20:23], v[116:119], v[88:91]
  v_perm_b32 v243, v83, v79, s58
  v_perm_b32 v247, v83, v79, s59
  v_mfma_f32_16x16x32_bf16 v[88:91], a[32:35], v[132:135], v[88:91]
  v_mul_f32 v84, s42, v84
  v_mul_f32 v85, s42, v85
  v_mfma_f32_16x16x32_bf16 v[88:91], a[44:47], v[152:155], v[88:91]
  v_mul_f32 v86, s42, v86
  v_mul_f32 v87, s42, v87
  v_mfma_f32_16x16x32_bf16 v[88:91], a[56:59], a[252:255], v[88:91]
  v_cvt_pk_bf16_f32 v100, v84, v85
  v_cvt_pk_bf16_f32 v101, v86, v87
  v_mfma_f32_16x16x32_bf16 v[88:91], a[68:71], v[172:175], v[88:91]
  v_add_u32 v68, 102400, v68
  v_add_u32 v69, 102400, v69
  v_mfma_f32_16x16x32_bf16 v[104:107], a[132:135], v[172:175], 0
  v_add_u32 v54, 102400, v54
  v_add_u32 v55, 102400, v55
  v_mfma_f32_16x16x32_bf16 v[104:107], a[120:123], a[252:255], v[104:107]
  ds_read2st64_b32 v[92:93], v68 offset0:0 offset1:2
  ds_read2st64_b32 v[96:97], v69 offset0:0 offset1:2
  v_mfma_f32_16x16x32_bf16 v[104:107], a[108:111], v[152:155], v[104:107]
  v_mul_f32 v88, s42, v88
  v_mul_f32 v89, s42, v89
  v_mfma_f32_16x16x32_bf16 v[104:107], a[96:99], v[132:135], v[104:107]
  v_mul_f32 v90, s42, v90
  v_mul_f32 v91, s42, v91
  v_mfma_f32_16x16x32_bf16 v[104:107], a[84:87], v[116:119], v[104:107]
  v_cvt_pk_bf16_f32 v102, v88, v89
  v_cvt_pk_bf16_f32 v103, v90, v91
  v_mfma_f32_16x16x32_bf16 v[104:107], a[72:75], v[156:159], v[104:107]
  ds_read2st64_b32 v[94:95], v68 offset0:4 offset1:6
  ds_read2st64_b32 v[98:99], v69 offset0:4 offset1:6
  v_mfma_f32_16x16x32_bf16 v[84:87], a[76:79], v[156:159], 0
  ds_read2st64_b32 v[76:77], v54 offset0:0 offset1:2
  ds_read2st64_b32 v[80:81], v55 offset0:0 offset1:2
  v_mfma_f32_16x16x32_bf16 v[84:87], a[88:91], v[116:119], v[84:87]
  ds_read2st64_b32 v[78:79], v54 offset0:4 offset1:6
  ds_read2st64_b32 v[82:83], v55 offset0:4 offset1:6
  v_mfma_f32_16x16x32_bf16 v[84:87], a[100:103], v[132:135], v[84:87]
  v_cvt_pk_bf16_f32 v144, v104, v105
  v_cvt_pk_bf16_f32 v145, v106, v107
  v_mfma_f32_16x16x32_bf16 v[84:87], a[112:115], v[152:155], v[84:87]
  v_xor_b32 v5, s41, v5
  v_mfma_f32_16x16x32_bf16 v[84:87], a[124:127], a[252:255], v[84:87]
  s_waitcnt lgkmcnt(4)
  v_perm_b32 v248, v96, v92, s58
  v_perm_b32 v252, v96, v92, s59
  v_mfma_f32_16x16x32_bf16 v[84:87], a[136:139], v[172:175], v[84:87]
  v_perm_b32 v249, v97, v93, s58
  v_perm_b32 v253, v97, v93, s59
  v_mfma_f32_16x16x32_bf16 v[88:91], a[140:143], v[172:175], 0
  s_waitcnt lgkmcnt(0)
  v_perm_b32 v250, v98, v94, s58
  v_perm_b32 v254, v98, v94, s59
  v_mfma_f32_16x16x32_bf16 v[88:91], a[128:131], a[252:255], v[88:91]
  v_perm_b32 v251, v99, v95, s58
  v_perm_b32 v255, v99, v95, s59
  v_mfma_f32_16x16x32_bf16 v[88:91], a[116:119], v[152:155], v[88:91]
  v_cvt_pk_bf16_f32 v146, v84, v85
  v_cvt_pk_bf16_f32 v147, v86, v87
  v_mfma_f32_16x16x32_bf16 v[88:91], a[104:107], v[132:135], v[88:91]
  s_add_u32 m0, s30, 0
  v_perm_b32 v104, v80, v76, s58
  v_perm_b32 v76, v80, v76, s59
  v_mfma_f32_16x16x32_bf16 v[88:91], a[92:95], v[116:119], v[88:91]
  v_accvgpr_write_b32 a220, v76
  v_perm_b32 v105, v81, v77, s58
  v_mfma_f32_16x16x32_bf16 v[88:91], a[80:83], v[156:159], v[88:91]
  v_perm_b32 v77, v81, v77, s59
  v_accvgpr_write_b32 a221, v77
  v_mfma_f32_16x16x32_bf16 v[84:87], v[156:159], a[144:147], 0
  buffer_load_dwordx4 v6, s[8:11], s31 offen offset:0 nt lds
  v_mfma_f32_16x16x32_bf16 v[84:87], v[116:119], a[156:159], v[84:87]
  s_add_u32 m0, s30, 8064
  v_perm_b32 v106, v82, v78, s58
  v_perm_b32 v78, v82, v78, s59
  v_mfma_f32_16x16x32_bf16 v[84:87], v[132:135], a[168:171], v[84:87]
  v_cvt_pk_bf16_f32 v148, v88, v89
  v_cvt_pk_bf16_f32 v149, v90, v91
  v_mfma_f32_16x16x32_bf16 v[84:87], v[152:155], a[180:183], v[84:87]
  ds_read_b128 a[244:247], v1 offset:22528
  ds_read_b128 a[248:251], v0 offset:22528
  v_mfma_f32_16x16x32_bf16 v[84:87], a[252:255], a[192:195], v[84:87]
  buffer_load_dwordx4 v6, s[8:11], s31 offen offset:128 nt lds
  v_mfma_f32_16x16x32_bf16 v[84:87], v[172:175], a[204:207], v[84:87]
  s_add_u32 m0, s30, 16128
  ds_read_b128 v[164:167], v1 offset:14336
  ds_read_b128 v[180:183], v0 offset:14336
  v_mfma_f32_16x16x32_bf16 v[88:91], v[172:175], a[208:211], 0
  ds_read_b128 v[176:179], v1 offset:6144
  ds_read_b128 v[168:171], v0 offset:6144
  v_mfma_f32_16x16x32_bf16 v[88:91], a[252:255], a[196:199], v[88:91]
  v_accvgpr_write_b32 a222, v78
  v_perm_b32 v107, v83, v79, s58
  v_mfma_f32_16x16x32_bf16 v[88:91], v[152:155], a[184:187], v[88:91]
  buffer_load_dwordx4 v6, s[8:11], s31 offen offset:256 nt lds
  v_mfma_f32_16x16x32_bf16 v[88:91], v[132:135], a[172:175], v[88:91]
  s_add_u32 m0, s30, 4096
  v_cvt_pk_bf16_f32 v108, v84, v85
  v_cvt_pk_bf16_f32 v109, v86, v87
  v_mfma_f32_16x16x32_bf16 v[88:91], v[116:119], a[160:163], v[88:91]
  s_add_u32 s31, s31, s43
  v_perm_b32 v79, v83, v79, s59
  v_accvgpr_write_b32 a223, v79
  v_mfma_f32_16x16x32_bf16 v[88:91], v[156:159], a[148:151], v[88:91]
  ds_read2st64_b32 v[92:93], v68 offset0:16 offset1:18
  ds_read2st64_b32 v[96:97], v69 offset0:16 offset1:18
  v_mfma_f32_16x16x32_bf16 v[84:87], v[156:159], a[152:155], 0
  buffer_load_dwordx4 v6, s[8:11], s32 offen offset:0 nt lds
  v_mfma_f32_16x16x32_bf16 v[84:87], v[116:119], a[164:167], v[84:87]
  s_add_u32 m0, s30, 12160
  ds_read2st64_b32 v[94:95], v68 offset0:20 offset1:22
  ds_read2st64_b32 v[98:99], v69 offset0:20 offset1:22
  v_mfma_f32_16x16x32_bf16 v[84:87], v[132:135], a[176:179], v[84:87]
  v_cvt_pk_bf16_f32 v112, v88, v89
  v_cvt_pk_bf16_f32 v113, v90, v91
  v_mfma_f32_16x16x32_bf16 v[84:87], v[152:155], a[188:191], v[84:87]
  s_waitcnt lgkmcnt(2)
  ds_read2st64_b32 v[76:77], v54 offset0:16 offset1:18
  ds_read2st64_b32 v[80:81], v55 offset0:16 offset1:18
  v_mfma_f32_16x16x32_bf16 v[84:87], a[252:255], a[200:203], v[84:87]
  buffer_load_dwordx4 v6, s[8:11], s32 offen offset:128 nt lds
  v_mfma_f32_16x16x32_bf16 v[84:87], v[172:175], a[212:215], v[84:87]
  s_add_u32 m0, s30, 20224
  ds_read2st64_b32 v[78:79], v54 offset0:20 offset1:22
  ds_read2st64_b32 v[82:83], v55 offset0:20 offset1:22
  v_mfma_f32_16x16x32_bf16 v[68:71], a[132:135], a[244:247], 0
  s_waitcnt lgkmcnt(4)
  v_accvgpr_write_b32 a216, v104
  v_accvgpr_write_b32 a217, v105
  v_mfma_f32_16x16x32_bf16 v[68:71], a[120:123], a[248:251], v[68:71]
  s_mov_b32 s30, s5
  v_accvgpr_write_b32 a218, v106
  v_accvgpr_write_b32 a219, v107
  v_mfma_f32_16x16x32_bf16 v[68:71], a[108:111], v[164:167], v[68:71]
  buffer_load_dwordx4 v6, s[8:11], s32 offen offset:256 nt lds
  v_mfma_f32_16x16x32_bf16 v[68:71], a[96:99], v[180:183], v[68:71]
  s_add_u32 s32, s32, s43
  v_cvt_pk_bf16_f32 v116, v84, v85
  v_cvt_pk_bf16_f32 v117, v86, v87
  v_mfma_f32_16x16x32_bf16 v[68:71], a[84:87], v[176:179], v[68:71]
  s_waitcnt lgkmcnt(0)
  v_perm_b32 v54, v96, v92, s58
  v_perm_b32 v92, v96, v92, s59
  v_mfma_f32_16x16x32_bf16 v[68:71], a[72:75], v[168:171], v[68:71]
  v_accvgpr_write_b32 a224, v54
  v_accvgpr_write_b32 a228, v92
  v_mfma_f32_16x16x32_bf16 v[84:87], a[76:79], v[168:171], 0
  v_perm_b32 v55, v97, v93, s58
  v_perm_b32 v93, v97, v93, s59
  v_mfma_f32_16x16x32_bf16 v[84:87], a[88:91], v[176:179], v[84:87]
  v_accvgpr_write_b32 a225, v55
  v_accvgpr_write_b32 a229, v93
  v_mfma_f32_16x16x32_bf16 v[84:87], a[100:103], v[180:183], v[84:87]
  v_cvt_pk_bf16_f32 v150, v68, v69
  v_cvt_pk_bf16_f32 v151, v70, v71
  v_mfma_f32_16x16x32_bf16 v[84:87], a[112:115], v[164:167], v[84:87]
  v_perm_b32 v54, v98, v94, s58
  v_perm_b32 v94, v98, v94, s59
  v_mfma_f32_16x16x32_bf16 v[84:87], a[124:127], a[248:251], v[84:87]
  v_accvgpr_write_b32 a226, v54
  v_accvgpr_write_b32 a230, v94
  v_mfma_f32_16x16x32_bf16 v[84:87], a[136:139], a[244:247], v[84:87]
  v_perm_b32 v55, v99, v95, s58
  v_perm_b32 v95, v99, v95, s59
  v_mfma_f32_16x16x32_bf16 v[68:71], a[140:143], a[244:247], 0
  v_accvgpr_write_b32 a227, v55
  v_accvgpr_write_b32 a231, v95
  v_mfma_f32_16x16x32_bf16 v[68:71], a[128:131], a[248:251], v[68:71]
  v_perm_b32 v54, v80, v76, s58
  v_perm_b32 v76, v80, v76, s59
  v_mfma_f32_16x16x32_bf16 v[68:71], a[116:119], v[164:167], v[68:71]
  v_cvt_pk_bf16_f32 v152, v84, v85
  v_cvt_pk_bf16_f32 v153, v86, v87
  v_mfma_f32_16x16x32_bf16 v[68:71], a[104:107], v[180:183], v[68:71]
  v_accvgpr_write_b32 a232, v54
  v_accvgpr_write_b32 a236, v76
  v_mfma_f32_16x16x32_bf16 v[68:71], a[92:95], v[176:179], v[68:71]
  v_perm_b32 v55, v81, v77, s58
  v_perm_b32 v77, v81, v77, s59
  v_mfma_f32_16x16x32_bf16 v[68:71], a[80:83], v[168:171], v[68:71]
  v_accvgpr_write_b32 a233, v55
  v_accvgpr_write_b32 a237, v77
  v_mfma_f32_16x16x32_bf16 v[92:95], v[122:125], v[72:75], v[36:39]
  v_perm_b32 v54, v82, v78, s58
  v_perm_b32 v78, v82, v78, s59
  v_mfma_f32_16x16x32_bf16 v[92:95], v[120:123], v[12:15], v[92:95]
  v_accvgpr_write_b32 a234, v54
  v_accvgpr_write_b32 a238, v78
  v_mfma_f32_16x16x32_bf16 v[96:99], v[138:141], v[72:75], v[32:35]
  v_perm_b32 v55, v83, v79, s58
  v_perm_b32 v79, v83, v79, s59
  v_mfma_f32_16x16x32_bf16 v[96:99], v[136:139], v[12:15], v[96:99]
  v_accvgpr_write_b32 a235, v55
  v_accvgpr_write_b32 a239, v79
  v_mfma_f32_16x16x32_bf16 v[104:107], v[146:149], v[72:75], v[28:31]
  v_cvt_pk_bf16_f32 v154, v68, v69
  v_cvt_pk_bf16_f32 v155, v70, v71
  v_mfma_f32_16x16x32_bf16 v[104:107], v[144:147], v[12:15], v[104:107]
  v_exp_f32 v92, v92
  v_mfma_f32_16x16x32_bf16 v[132:135], v[152:155], v[72:75], v[24:27]
  s_lshr_b32 s44, s2, 3
  v_exp_f32 v93, v93
  v_mfma_f32_16x16x32_bf16 v[132:135], v[150:153], v[12:15], v[132:135]
  s_lshl_b32 s44, s44, 9
  v_exp_f32 v94, v94
  v_mfma_f32_16x16x32_bf16 v[84:87], v[120:123], v[128:131], v[40:43]
  s_add_u32 s44, s44, 1048576
  v_exp_f32 v95, v95
  v_mfma_f32_16x16x32_bf16 v[84:87], v[122:125], v[14:17], v[84:87]
  s_mov_b32 s45, 0
  v_exp_f32 v96, v96
  v_mfma_f32_16x16x32_bf16 v[88:91], v[136:139], v[128:131], v[36:39]
  s_mov_b32 s59, 1
  v_exp_f32 v97, v97
  v_mfma_f32_16x16x32_bf16 v[88:91], v[138:141], v[14:17], v[88:91]
  s_mov_b32 s58, 0
  v_exp_f32 v98, v98
  v_mfma_f32_16x16x32_bf16 v[68:71], v[144:147], v[128:131], v[32:35]
  s_mov_b64 s[12:13], 0
  v_exp_f32 v99, v99
  v_mfma_f32_16x16x32_bf16 v[68:71], v[146:149], v[14:17], v[68:71]
  s_mov_b64 s[16:17], 0
  v_exp_f32 v104, v104
  v_mfma_f32_16x16x32_bf16 v[72:75], v[150:153], v[128:131], v[28:31]
  s_mov_b64 s[18:19], 0
  v_exp_f32 v105, v105
  v_mfma_f32_16x16x32_bf16 v[72:75], v[152:155], v[14:17], v[72:75]
  s_mov_b64 s[60:61], 0
  v_exp_f32 v106, v106
  v_mfma_f32_16x16x32_bf16 v[76:79], v[146:149], v[100:103], v[36:39]
  s_mov_b32 s15, 0
  v_exp_f32 v107, v107
  v_mfma_f32_16x16x32_bf16 v[76:79], v[144:147], v[18:21], v[76:79]
  s_mov_b32 s99, 0
  v_exp_f32 v132, v132
  v_mfma_f32_16x16x32_bf16 v[80:83], v[152:155], v[100:103], v[32:35]
  s_mov_b64 s[100:101], 0
  v_exp_f32 v133, v133
  v_mfma_f32_16x16x32_bf16 v[80:83], v[150:153], v[18:21], v[80:83]
  s_mov_b32 s14, 0
  v_exp_f32 v134, v134
  v_mfma_f32_16x16x32_bf16 v[160:163], v[122:125], v[100:103], v[44:47]
  v_exp_f32 v135, v135
  v_mfma_f32_16x16x32_bf16 v[160:163], v[120:123], v[18:21], v[160:163]
  v_cvt_pk_bf16_f32 v92, v92, v93
  v_cvt_pk_bf16_f32 v93, v94, v95
  v_mfma_f32_16x16x32_bf16 v[156:159], v[138:141], v[100:103], v[40:43]
  v_cvt_pk_bf16_f32 v94, v96, v97
  v_cvt_pk_bf16_f32 v95, v98, v99
  v_mfma_f32_16x16x32_bf16 v[156:159], v[136:139], v[18:21], v[156:159]
  v_cvt_pk_bf16_f32 v96, v104, v105
  v_cvt_pk_bf16_f32 v97, v106, v107
  v_mfma_f32_16x16x32_bf16 v[128:131], a[0:3], v[168:171], 0
  v_cvt_pk_bf16_f32 v98, v132, v133
  v_cvt_pk_bf16_f32 v99, v134, v135
  v_mfma_f32_16x16x32_bf16 v[128:131], a[12:15], v[176:179], v[128:131]
  v_exp_f32 v84, v84
  v_mfma_f32_16x16x32_bf16 v[128:131], a[24:27], v[180:183], v[128:131]
  v_exp_f32 v85, v85
  v_mfma_f32_16x16x32_bf16 v[128:131], a[36:39], v[164:167], v[128:131]
  v_exp_f32 v86, v86
  v_mfma_f32_16x16x32_bf16 v[128:131], a[48:51], a[248:251], v[128:131]
  v_exp_f32 v87, v87
  v_mfma_f32_16x16x32_bf16 v[128:131], a[60:63], a[244:247], v[128:131]
  v_exp_f32 v88, v88
  v_mfma_f32_16x16x32_bf16 v[100:103], a[64:67], a[244:247], 0
  v_exp_f32 v89, v89
  v_mfma_f32_16x16x32_bf16 v[100:103], a[52:55], a[248:251], v[100:103]
  v_exp_f32 v90, v90
  v_mfma_f32_16x16x32_bf16 v[100:103], a[40:43], v[164:167], v[100:103]
  v_exp_f32 v91, v91
  v_mfma_f32_16x16x32_bf16 v[100:103], a[28:31], v[180:183], v[100:103]
  v_mul_f32 v128, s42, v128
  v_mul_f32 v129, s42, v129
  v_mfma_f32_16x16x32_bf16 v[100:103], a[16:19], v[176:179], v[100:103]
  v_mul_f32 v130, s42, v130
  v_mul_f32 v131, s42, v131
  v_mfma_f32_16x16x32_bf16 v[100:103], a[4:7], v[168:171], v[100:103]
  v_cvt_pk_bf16_f32 v172, v128, v129
  v_cvt_pk_bf16_f32 v173, v130, v131
  v_mfma_f32_16x16x32_bf16 v[104:107], a[8:11], v[168:171], 0
  v_exp_f32 v68, v68
  v_mfma_f32_16x16x32_bf16 v[104:107], a[20:23], v[176:179], v[104:107]
  v_exp_f32 v69, v69
  v_mfma_f32_16x16x32_bf16 v[104:107], a[32:35], v[180:183], v[104:107]
  v_exp_f32 v70, v70
  v_mfma_f32_16x16x32_bf16 v[104:107], a[44:47], v[164:167], v[104:107]
  v_mul_f32 v100, s42, v100
  v_mul_f32 v101, s42, v101
  v_mfma_f32_16x16x32_bf16 v[104:107], a[56:59], a[248:251], v[104:107]
  v_mul_f32 v102, s42, v102
  v_mul_f32 v103, s42, v103
  v_mfma_f32_16x16x32_bf16 v[104:107], a[68:71], a[244:247], v[104:107]
  v_cvt_pk_bf16_f32 v174, v100, v101
  v_cvt_pk_bf16_f32 v175, v102, v103
  v_mfma_f32_16x16x32_bf16 v[128:131], v[168:171], a[144:147], 0
  v_exp_f32 v71, v71
  v_mfma_f32_16x16x32_bf16 v[128:131], v[176:179], a[156:159], v[128:131]
  v_exp_f32 v72, v72
  v_mfma_f32_16x16x32_bf16 v[128:131], v[180:183], a[168:171], v[128:131]
  v_mul_f32 v104, s42, v104
  v_mul_f32 v105, s42, v105
  v_mfma_f32_16x16x32_bf16 v[128:131], v[164:167], a[180:183], v[128:131]
  v_mul_f32 v106, s42, v106
  v_mul_f32 v107, s42, v107
  v_cvt_pk_bf16_f32 v22, v104, v105
  v_cvt_pk_bf16_f32 v23, v106, v107
  v_mfma_f32_16x16x32_bf16 v[128:131], a[248:251], a[192:195], v[128:131]
  s_waitcnt vmcnt(6) lgkmcnt(0)
  s_barrier
  v_mfma_f32_16x16x32_bf16 v[128:131], a[244:247], a[204:207], v[128:131]
  v_exp_f32 v73, v73
  v_mfma_f32_16x16x32_bf16 v[100:103], v[144:147], v[172:175], v[40:43]
  v_exp_f32 v74, v74
  v_mfma_f32_16x16x32_bf16 v[100:103], v[146:149], v[20:23], v[100:103]
  v_exp_f32 v75, v75
  v_mfma_f32_16x16x32_bf16 v[104:107], v[150:153], v[172:175], v[36:39]
  v_cvt_pk_bf16_f32 v84, v84, v85
  v_cvt_pk_bf16_f32 v85, v86, v87
  v_mfma_f32_16x16x32_bf16 v[104:107], v[152:155], v[20:23], v[104:107]
  v_cvt_pk_bf16_f32 v110, v128, v129
  v_cvt_pk_bf16_f32 v111, v130, v131
  v_mfma_f32_16x16x32_bf16 v[132:135], v[120:123], v[172:175], v[48:51]
  v_cvt_pk_bf16_f32 v86, v88, v89
  v_cvt_pk_bf16_f32 v87, v90, v91
  v_mfma_f32_16x16x32_bf16 v[132:135], v[122:125], v[20:23], v[132:135]
  v_cvt_pk_bf16_f32 v88, v68, v69
  v_cvt_pk_bf16_f32 v89, v70, v71
  v_mfma_f32_16x16x32_bf16 v[128:131], v[136:139], v[172:175], v[44:47]
  v_cvt_pk_bf16_f32 v90, v72, v73
  v_cvt_pk_bf16_f32 v91, v74, v75
  v_mfma_f32_16x16x32_bf16 v[128:131], v[138:141], v[20:23], v[128:131]
  v_exp_f32 v76, v76
  v_mfma_f32_16x16x32_bf16 v[144:147], a[244:247], a[208:211], 0
  ds_read_b128 v[172:175], v3 offset:0
  ds_read_b128 v[136:139], v3 offset:4096
  v_mfma_f32_16x16x32_bf16 v[144:147], a[248:251], a[196:199], v[144:147]
  ds_read_b128 v[140:143], v3 offset:8192
  ds_read_b128 v[68:71], v3 offset:12288
  v_mfma_f32_16x16x32_bf16 v[144:147], v[164:167], a[184:187], v[144:147]
  ds_read_b128 v[72:75], v3 offset:16384
  ds_read_b128 v[120:123], v3 offset:20480
  v_mfma_f32_16x16x32_bf16 v[144:147], v[180:183], a[172:175], v[144:147]
  v_exp_f32 v77, v77
  v_mfma_f32_16x16x32_bf16 v[144:147], v[176:179], a[160:163], v[144:147]
  v_exp_f32 v78, v78
  v_mfma_f32_16x16x32_bf16 v[144:147], v[168:171], a[148:151], v[144:147]
  v_exp_f32 v79, v79
  v_mfma_f32_16x16x32_bf16 v[124:127], v[168:171], a[152:155], 0
  v_exp_f32 v80, v80
  v_mfma_f32_16x16x32_bf16 v[124:127], v[176:179], a[164:167], v[124:127]
  v_exp_f32 v81, v81
  v_mfma_f32_16x16x32_bf16 v[124:127], v[180:183], a[176:179], v[124:127]
  v_exp_f32 v82, v82
  v_mfma_f32_16x16x32_bf16 v[124:127], v[164:167], a[188:191], v[124:127]
  v_exp_f32 v83, v83
  v_mfma_f32_16x16x32_bf16 v[124:127], a[248:251], a[200:203], v[124:127]
  v_exp_f32 v160, v160
  v_mfma_f32_16x16x32_bf16 v[124:127], a[244:247], a[212:215], v[124:127]
  v_cvt_pk_bf16_f32 v114, v144, v145
  v_cvt_pk_bf16_f32 v115, v146, v147
  v_add_u32 v0, s28, v2
  v_xor_b32 v1, 64, v0
  s_waitcnt lgkmcnt(0)
  s_branch L_mid
  s_nop 0
  s_nop 0
  s_nop 0
  s_nop 0
  s_nop 0
  s_nop 0
  s_nop 0
  s_nop 0
  s_nop 0
  s_nop 0
  s_nop 0
  s_nop 0
  s_nop 0
  s_nop 0
  s_nop 0
  s_nop 0
  s_nop 0
  s_nop 0
  s_nop 0
  s_nop 0
  s_nop 0
  s_nop 0
  s_nop 0
  s_nop 0
  s_nop 0
  s_nop 0
  s_nop 0
  s_nop 0
  s_nop 0
  s_nop 0
  s_nop 0
  s_nop 0
  s_nop 0
  s_nop 0
  s_nop 0
  s_nop 0
  s_nop 0
  s_nop 0
  s_nop 0
  s_nop 0
  s_nop 0
  s_nop 0
  s_nop 0
  s_nop 0
  s_nop 0
  s_nop 0
  s_nop 0
  s_nop 0
  s_nop 0
  s_nop 0
  s_nop 0
  s_nop 0
  s_nop 0
  s_nop 0
  s_nop 0
  s_nop 0
  s_nop 0
  s_nop 0
  s_nop 0
  s_nop 0
  s_nop 0
  s_nop 0
  s_nop 0
  s_nop 0
  s_nop 0
  s_nop 0
  s_nop 0
  s_nop 0
  s_nop 0
  s_nop 0
  s_nop 0
  s_nop 0
  s_nop 0
  s_nop 0
  s_nop 0
  s_nop 0
  s_nop 0
  s_nop 0
  s_nop 0
  s_nop 0
  s_nop 0
  s_nop 0
  s_nop 0
  s_nop 0
  s_nop 0
  s_nop 0
  s_nop 0
  s_nop 0
  s_nop 0
  s_nop 0
  s_nop 0
  s_nop 0
  s_nop 0
  s_nop 0
  s_nop 0
  s_nop 0
  s_nop 0
  s_nop 0
  s_nop 0
  s_nop 0
  s_nop 0
  s_nop 0
  s_nop 0
  s_nop 0
  s_nop 0
  s_nop 0
  s_nop 0
  s_nop 0
  s_nop 0
  s_nop 0
  s_nop 0
  s_nop 0
  s_nop 0
  s_nop 0
  s_nop 0
  s_nop 0
  s_nop 0
  s_nop 0
  s_nop 0
  s_nop 0
  s_nop 0
  s_nop 0
  s_nop 0
  s_nop 0
  s_nop 0
  s_nop 0
  s_nop 0
  s_nop 0
  s_nop 0
  s_nop 0
  s_nop 0
  s_nop 0
  s_nop 0
  s_nop 0
  s_nop 0
  s_nop 0
  s_nop 0
  s_nop 0
  s_nop 0
  s_nop 0
  s_nop 0
  s_nop 0
  s_nop 0
  s_nop 0
  s_nop 0
  s_nop 0
  s_nop 0
  s_nop 0
  s_nop 0
  s_nop 0
  s_nop 0
  s_nop 0
  s_nop 0
  s_nop 0
  s_nop 0
  s_nop 0
  s_nop 0
  s_nop 0
  s_nop 0
  s_nop 0
  s_nop 0
  s_nop 0
  s_nop 0
  s_nop 0
  s_nop 0
  s_nop 0
  s_nop 0
  s_nop 0
  s_nop 0
  s_nop 0
  s_nop 0
  s_nop 0
  s_nop 0
  s_nop 0
  s_nop 0
  s_nop 0
  s_nop 0
  s_nop 0
  s_nop 0
  s_nop 0
  s_nop 0
  s_nop 0
  s_nop 0
  s_nop 0
  s_nop 0
  s_nop 0
  s_nop 0
  s_nop 0
  s_nop 0
  s_nop 0
  s_nop 0
  s_nop 0
  s_nop 0
  s_nop 0
  s_nop 0
  s_nop 0
  s_nop 0
  s_nop 0
  s_nop 0
  s_nop 0
  s_nop 0
  s_nop 0
  s_nop 0
  s_nop 0
  s_nop 0
  s_nop 0
  s_nop 0
  s_nop 0
  s_nop 0
  s_nop 0
  s_nop 0
  s_nop 0
  s_nop 0
  s_nop 0
  s_nop 0
  s_nop 0
  s_nop 0
  s_nop 0
  s_nop 0
  s_nop 0
  s_nop 0
  s_nop 0
  s_nop 0
  s_nop 0
  s_nop 0
  s_nop 0
  s_nop 0
  s_nop 0
  s_nop 0
  s_nop 0
  s_nop 0
  s_nop 0
  s_nop 0
  s_nop 0
  s_nop 0
  s_nop 0
  s_nop 0
  s_nop 0
  s_nop 0
  s_nop 0
  s_nop 0
  s_nop 0
  s_nop 0
  s_nop 0
  s_nop 0
  s_nop 0
  s_nop 0
  s_nop 0
  s_nop 0
  s_nop 0
  s_nop 0
  s_nop 0
  s_nop 0
  s_nop 0
  s_nop 0
  s_nop 0
  s_nop 0
  s_nop 0
  s_nop 0
  s_nop 0
  s_nop 0
  s_nop 0
  s_nop 0
  s_nop 0
  s_nop 0
  s_nop 0
  s_nop 0
  s_nop 0
  s_nop 0
  s_nop 0
  s_nop 0
  s_nop 0
  s_nop 0
  s_nop 0
  s_nop 0
  s_nop 0
  s_nop 0
  s_nop 0
  s_nop 0
  s_nop 0
  s_nop 0
  s_nop 0
  s_nop 0
  s_nop 0
  s_nop 0
  s_nop 0
  s_nop 0
  s_nop 0
  s_nop 0
  s_nop 0
  s_nop 0
  s_nop 0
  s_nop 0
  s_nop 0
  s_nop 0
  s_nop 0
  s_nop 0
  s_nop 0
  s_nop 0
  s_nop 0
  s_nop 0
  s_nop 0
  s_nop 0
  s_nop 0
  s_nop 0
  s_nop 0
  s_nop 0
  s_nop 0
  s_nop 0
  s_nop 0
  s_nop 0
  s_nop 0
  s_nop 0
  s_nop 0
  s_nop 0
  s_nop 0
  s_nop 0
  s_nop 0
  s_nop 0
  s_nop 0
  s_nop 0
  s_nop 0
  s_nop 0
  s_nop 0
  s_nop 0
  s_nop 0
  s_nop 0
  s_nop 0
  s_nop 0
  s_nop 0
  s_nop 0
  s_nop 0
  s_nop 0
  s_nop 0
  s_nop 0
  s_nop 0
  s_nop 0
  s_nop 0
  s_nop 0
  s_nop 0
  s_nop 0
  s_nop 0
  s_nop 0
  s_nop 0
  s_nop 0
  s_nop 0
  s_nop 0
  s_nop 0
  s_nop 0
  s_nop 0
  s_nop 0
  s_nop 0
  s_nop 0
  s_nop 0
  s_nop 0
  s_nop 0
  s_nop 0
  s_nop 0
  s_nop 0
  s_nop 0
  s_nop 0
  s_nop 0
  s_nop 0
  s_nop 0
  s_nop 0
  s_nop 0
  s_nop 0
  s_nop 0
  s_nop 0
  s_nop 0
  s_nop 0
  s_nop 0
  s_nop 0
  s_nop 0
  s_nop 0
  s_nop 0
  s_nop 0
  s_nop 0
  s_nop 0
  s_nop 0
  s_nop 0
  s_nop 0
  s_nop 0
  s_nop 0
  s_nop 0
  s_nop 0
  s_nop 0
  s_nop 0
  s_nop 0
  s_nop 0
  s_nop 0
  s_nop 0
  s_nop 0
  s_nop 0
  s_nop 0
  s_nop 0
  s_nop 0
  s_nop 0
  s_nop 0
  s_nop 0
  s_nop 0
  s_nop 0
  s_nop 0
  s_nop 0
  s_nop 0
  s_nop 0
  s_nop 0
  s_nop 0
  s_nop 0
  s_nop 0
  s_nop 0
  s_nop 0
  s_nop 0
  s_nop 0
  s_nop 0
  s_nop 0
  s_nop 0
  s_nop 0
  s_nop 0
  s_nop 0
  s_nop 0
  s_nop 0
  s_nop 0
  s_nop 0
  s_nop 0
  s_nop 0
  s_nop 0
  s_nop 0
  s_nop 0
  s_nop 0
  s_nop 0
  s_nop 0
  s_nop 0
  s_nop 0
  s_nop 0
  s_nop 0
  s_nop 0
  s_nop 0
  s_nop 0
  s_nop 0
  s_nop 0
  s_nop 0
  s_nop 0
  s_nop 0
  s_nop 0
  s_nop 0
  s_nop 0
  s_nop 0
  s_nop 0
  s_nop 0
  s_nop 0
  s_nop 0
  s_nop 0
  s_nop 0
  s_nop 0
  s_nop 0
  s_nop 0
  s_nop 0
  s_nop 0
  s_nop 0
  s_nop 0
  s_nop 0
  s_nop 0
  s_nop 0
  s_nop 0
  s_nop 0
  s_nop 0
  s_nop 0
  s_nop 0
  s_nop 0
  s_nop 0
  s_nop 0
  s_nop 0
  s_nop 0
  s_nop 0
  s_nop 0
  s_nop 0
  s_nop 0
  s_nop 0
  s_nop 0
  s_nop 0
  s_nop 0
  s_nop 0
  s_nop 0
  s_nop 0
  s_nop 0
  s_nop 0
  s_nop 0
  s_nop 0
  s_nop 0
  s_nop 0
  s_nop 0
  s_nop 0
  s_nop 0
  s_nop 0
  s_nop 0
  s_nop 0
  s_nop 0
  s_nop 0
  s_nop 0
  s_nop 0
  s_nop 0
  s_nop 0
  s_nop 0
  s_nop 0
  s_nop 0
  s_nop 0
  s_nop 0
  s_nop 0
  s_nop 0
  s_nop 0
  s_nop 0
  s_nop 0
  s_nop 0
  s_nop 0
  s_nop 0
  s_nop 0
  s_nop 0
  s_nop 0
  s_nop 0
  s_nop 0
  s_nop 0
  s_nop 0
  s_nop 0
  s_nop 0
  s_nop 0
  s_nop 0
  s_nop 0
  s_nop 0
  s_nop 0
  s_nop 0
  s_nop 0
  s_nop 0
  s_nop 0
  s_nop 0
  s_nop 0
  s_nop 0
  s_nop 0
  s_nop 0
  s_nop 0
  s_nop 0
  s_nop 0
  s_nop 0
  s_nop 0
  s_nop 0
  s_nop 0
  s_nop 0
  s_nop 0
  s_nop 0
  s_nop 0
  s_nop 0
  s_nop 0
  s_nop 0
  s_nop 0
  s_nop 0
  s_nop 0
  s_nop 0
  s_nop 0
  s_nop 0
  s_nop 0
  s_nop 0
  s_nop 0
  s_nop 0
  s_nop 0
  s_nop 0
  s_nop 0
  s_nop 0
  s_nop 0
  s_nop 0
  s_nop 0
  s_nop 0
  s_nop 0
  s_nop 0
  s_nop 0
  s_nop 0
  s_nop 0
  s_nop 0
  s_nop 0
  s_nop 0
  s_nop 0
  s_nop 0
  s_nop 0
  s_nop 0
  s_nop 0
  s_nop 0
  s_nop 0
  s_nop 0
  s_nop 0
  s_nop 0
  s_nop 0
  s_nop 0
  s_nop 0
  s_nop 0
  s_nop 0
  s_nop 0
  s_nop 0
  s_nop 0
  s_nop 0
  s_nop 0
  s_nop 0
  s_nop 0
  s_nop 0
  s_nop 0
  s_nop 0
  s_nop 0
  s_nop 0
  s_nop 0
  s_nop 0
  s_nop 0
  s_nop 0
  s_nop 0
  s_nop 0
  s_nop 0
  s_nop 0
  s_nop 0
  s_nop 0
  s_nop 0
  s_nop 0
  s_nop 0
  s_nop 0
  s_nop 0
  s_nop 0
  s_nop 0
  s_nop 0
  s_nop 0
  s_nop 0
  s_nop 0
  s_nop 0
  s_nop 0
  s_nop 0
  s_nop 0
  s_nop 0
  s_nop 0
  s_nop 0
  s_nop 0
  s_nop 0
  s_nop 0
  s_nop 0
  s_nop 0
  s_nop 0
  s_nop 0
  s_nop 0
  s_nop 0
  s_nop 0
  s_nop 0
  s_nop 0
  s_nop 0
  s_nop 0
  s_nop 0
  s_nop 0
  s_nop 0
  s_nop 0
  s_nop 0
  s_nop 0
  s_nop 0
  s_nop 0
  s_nop 0
  s_nop 0
  s_nop 0
  s_nop 0
  s_nop 0
  s_nop 0
  s_nop 0
  s_nop 0
  s_nop 0
  s_nop 0
  s_nop 0
  s_nop 0
  s_nop 0
  s_nop 0
  s_nop 0
  s_nop 0
  s_nop 0
  s_nop 0
  s_nop 0
  s_nop 0
  s_nop 0
  s_nop 0
  s_nop 0
  s_nop 0
  s_nop 0
  s_nop 0
  s_nop 0
  s_nop 0
  s_nop 0
  s_nop 0
  s_nop 0
  s_nop 0
  s_nop 0
  s_nop 0
  s_nop 0
  s_nop 0
  s_nop 0
  s_nop 0
  s_nop 0
  s_nop 0
  s_nop 0
  s_nop 0
  s_nop 0
  s_nop 0
  s_nop 0
  s_nop 0
  s_nop 0
  s_nop 0
  s_nop 0
  s_nop 0
  s_nop 0
  s_nop 0
  s_nop 0
  s_nop 0
  s_nop 0
  s_nop 0
  s_nop 0
  s_nop 0
  s_nop 0
  s_nop 0
  s_nop 0
  s_nop 0
  s_nop 0
  s_nop 0
  s_nop 0
  s_nop 0
  s_nop 0
  s_nop 0
  s_nop 0
  s_nop 0
  s_nop 0
  s_nop 0
  s_nop 0
  s_nop 0
  s_nop 0
  s_nop 0
  s_nop 0
  s_nop 0
  s_nop 0
  s_nop 0
  s_nop 0
  s_nop 0
  s_nop 0
  s_nop 0
  s_nop 0
  s_nop 0
  s_nop 0
  s_nop 0
  s_nop 0
  s_nop 0
  s_nop 0
  s_nop 0
  s_nop 0
  s_nop 0
  s_nop 0
  s_nop 0
  s_nop 0
  s_nop 0
  s_nop 0
  s_nop 0
  s_nop 0
  s_nop 0
  s_nop 0
  s_nop 0
  s_nop 0
  s_nop 0
  s_nop 0
  s_nop 0
  s_nop 0
  s_nop 0
  s_nop 0
  s_nop 0
  s_nop 0
  s_nop 0
  s_nop 0
  s_nop 0
  s_nop 0
  s_nop 0
  s_nop 0
  s_nop 0
  s_nop 0
  s_nop 0
  s_nop 0
  s_nop 0
  s_nop 0
  s_nop 0
  s_nop 0
  s_nop 0
  s_nop 0
  s_nop 0
  s_nop 0
  s_nop 0
  s_nop 0
  s_nop 0
  s_nop 0
  s_nop 0
  s_nop 0
  s_nop 0
  s_nop 0
  s_nop 0
  s_nop 0
  s_nop 0
  s_nop 0
  s_nop 0
  s_nop 0
  s_nop 0
  s_nop 0
  s_nop 0
  s_nop 0
  s_nop 0
  s_nop 0
  s_nop 0
  s_nop 0
  s_nop 0
  s_nop 0
  s_nop 0
  s_nop 0
  s_nop 0
  s_nop 0
  s_nop 0
  s_nop 0
  s_nop 0
  s_nop 0
  s_nop 0
  s_nop 0
  s_nop 0
  s_nop 0
  s_nop 0
  s_nop 0
  s_nop 0
  s_nop 0
  s_nop 0
  s_nop 0
  s_nop 0
  s_nop 0
  s_nop 0
  s_nop 0
  s_nop 0
  s_nop 0
  s_nop 0
  s_nop 0
  s_nop 0
  s_nop 0
  s_nop 0
  s_nop 0
  s_nop 0
  s_nop 0
  s_nop 0
  s_nop 0
  s_nop 0
  s_nop 0
  s_nop 0
  s_nop 0
  s_nop 0
  s_nop 0
  s_nop 0
  s_nop 0
  s_nop 0
  s_nop 0
  s_nop 0
  s_nop 0
  s_nop 0
  s_nop 0
  s_nop 0
  s_nop 0
  s_nop 0
  s_nop 0
  s_nop 0
  s_nop 0
  s_nop 0
  s_nop 0
  s_nop 0
  s_nop 0
  s_nop 0
  s_nop 0
  s_nop 0
  s_nop 0
  s_nop 0
  s_nop 0
  s_nop 0
  s_nop 0
  s_nop 0
  s_nop 0
  s_nop 0
  s_nop 0
  s_nop 0
  s_nop 0
  s_nop 0
  s_nop 0
  s_nop 0
  s_nop 0
  s_nop 0
  s_nop 0
  s_nop 0
  s_nop 0
  s_nop 0
  s_nop 0
  s_nop 0
  s_nop 0
L_hop_3_0:
  s_cbranch_execz L_hop_3_1
L_pad2120:
L_loop:
  v_mfma_f32_16x16x32_bf16 v[104:107], a[0:3], v[88:91], 0
L_r208:
  v_mfma_f32_16x16x32_bf16 v[104:107], a[12:15], v[92:95], v[104:107]
L_r209:
  v_mfma_f32_16x16x32_bf16 v[104:107], a[24:27], v[96:99], v[104:107]
  v_cvt_pk_bf16_f32 v66, v128, v129
  v_cvt_pk_bf16_f32 v67, v130, v131
L_r210:
  v_mfma_f32_16x16x32_bf16 v[104:107], a[36:39], v[136:139], v[104:107]
L_r211:
  v_mfma_f32_16x16x32_bf16 v[104:107], a[48:51], v[140:143], v[104:107]
  s_waitcnt lgkmcnt(0)
L_r212:
  v_mfma_f32_16x16x32_bf16 v[104:107], a[60:63], v[80:83], v[104:107]
L_r213:
  v_mfma_f32_16x16x32_bf16 v[84:87], a[64:67], v[80:83], 0
L_r214:
  v_mfma_f32_16x16x32_bf16 v[84:87], a[52:55], v[140:143], v[84:87]
L_r215:
  v_mfma_f32_16x16x32_bf16 v[84:87], a[40:43], v[136:139], v[84:87]
  v_mul_f32 v104, s42, v104
  v_mul_f32 v105, s42, v105
L_r216:
  v_mfma_f32_16x16x32_bf16 v[84:87], a[28:31], v[96:99], v[84:87]
  v_mul_f32 v106, s42, v106
  v_mul_f32 v107, s42, v107
L_r217:
  v_mfma_f32_16x16x32_bf16 v[84:87], a[16:19], v[92:95], v[84:87]
  v_cvt_pk_bf16_f32 v18, v104, v105
  v_cvt_pk_bf16_f32 v19, v106, v107
L_r218:
  v_mfma_f32_16x16x32_bf16 v[84:87], a[4:7], v[88:91], v[84:87]
L_r219:
  v_mfma_f32_16x16x32_bf16 v[108:111], a[8:11], v[88:91], 0
L_r220:
  v_mfma_f32_16x16x32_bf16 v[108:111], a[20:23], v[92:95], v[108:111]
L_r221:
  v_mfma_f32_16x16x32_bf16 v[108:111], a[32:35], v[96:99], v[108:111]
  v_mul_f32 v84, s42, v84
  v_mul_f32 v85, s42, v85
L_r222:
  v_mfma_f32_16x16x32_bf16 v[108:111], a[44:47], v[136:139], v[108:111]
  v_mul_f32 v86, s42, v86
  v_mul_f32 v87, s42, v87
L_r223:
  v_mfma_f32_16x16x32_bf16 v[108:111], a[56:59], v[140:143], v[108:111]
  v_cvt_pk_bf16_f32 v104, v84, v85
  v_cvt_pk_bf16_f32 v105, v86, v87
L_r224:
  v_mfma_f32_16x16x32_bf16 v[108:111], a[68:71], v[80:83], v[108:111]
L_r225:
  v_mfma_f32_16x16x32_bf16 v[112:115], a[132:135], v[80:83], 0
L_r226:
  v_mfma_f32_16x16x32_bf16 v[112:115], a[120:123], v[140:143], v[112:115]
L_r227:
  v_mfma_f32_16x16x32_bf16 v[112:115], a[108:111], v[136:139], v[112:115]
  v_mul_f32 v108, s42, v108
  v_mul_f32 v109, s42, v109
L_r228:
  v_mfma_f32_16x16x32_bf16 v[112:115], a[96:99], v[96:99], v[112:115]
  v_mul_f32 v110, s42, v110
  v_mul_f32 v111, s42, v111
L_r229:
  v_mfma_f32_16x16x32_bf16 v[112:115], a[84:87], v[92:95], v[112:115]
  v_cvt_pk_bf16_f32 v106, v108, v109
  v_cvt_pk_bf16_f32 v107, v110, v111
L_r230:
  v_mfma_f32_16x16x32_bf16 v[112:115], a[72:75], v[88:91], v[112:115]
L_r231:
  v_mfma_f32_16x16x32_bf16 v[84:87], a[76:79], v[88:91], 0
L_r232:
  v_mfma_f32_16x16x32_bf16 v[84:87], a[88:91], v[92:95], v[84:87]
L_r233:
  v_mfma_f32_16x16x32_bf16 v[84:87], a[100:103], v[96:99], v[84:87]
  v_cvt_pk_bf16_f32 v128, v112, v113
  v_cvt_pk_bf16_f32 v129, v114, v115
L_r234:
  v_mfma_f32_16x16x32_bf16 v[84:87], a[112:115], v[136:139], v[84:87]
L_r235:
  v_mfma_f32_16x16x32_bf16 v[84:87], a[124:127], v[140:143], v[84:87]
L_r236:
  v_mfma_f32_16x16x32_bf16 v[84:87], a[136:139], v[80:83], v[84:87]
L_r237:
  v_mfma_f32_16x16x32_bf16 v[108:111], a[140:143], v[80:83], 0
L_r238:
  v_mfma_f32_16x16x32_bf16 v[108:111], a[128:131], v[140:143], v[108:111]
L_r239:
  v_mfma_f32_16x16x32_bf16 v[108:111], a[116:119], v[136:139], v[108:111]
  v_cvt_pk_bf16_f32 v130, v84, v85
  v_cvt_pk_bf16_f32 v131, v86, v87
L_r240:
  v_mfma_f32_16x16x32_bf16 v[108:111], a[104:107], v[96:99], v[108:111]
L_r241:
  v_mfma_f32_16x16x32_bf16 v[108:111], a[92:95], v[92:95], v[108:111]
L_r242:
  v_mfma_f32_16x16x32_bf16 v[108:111], a[80:83], v[88:91], v[108:111]
L_r243:
  v_mfma_f32_16x16x32_bf16 v[84:87], v[88:91], a[144:147], 0
L_r244:
  v_mfma_f32_16x16x32_bf16 v[84:87], v[92:95], a[156:159], v[84:87]
  ds_read_b128 a[244:247], v1 offset:22528
L_r245:
  v_mfma_f32_16x16x32_bf16 v[84:87], v[96:99], a[168:171], v[84:87]
  v_cvt_pk_bf16_f32 v132, v108, v109
  v_cvt_pk_bf16_f32 v133, v110, v111
L_r246:
  v_mfma_f32_16x16x32_bf16 v[84:87], v[136:139], a[180:183], v[84:87]
  ds_read_b128 a[248:251], v0 offset:22528
L_r247:
  v_mfma_f32_16x16x32_bf16 v[84:87], v[140:143], a[192:195], v[84:87]
  ds_read_b128 a[252:255], v1 offset:14336
L_r248:
  v_mfma_f32_16x16x32_bf16 v[84:87], v[80:83], a[204:207], v[84:87]
  ds_read_b128 v[144:147], v0 offset:14336
L_r249:
  v_mfma_f32_16x16x32_bf16 v[116:119], v[80:83], a[208:211], 0
  ds_read_b128 v[148:151], v1 offset:6144
L_r250:
  v_mfma_f32_16x16x32_bf16 v[116:119], v[140:143], a[196:199], v[116:119]
  ds_read_b128 v[152:155], v0 offset:6144
L_r251:
  v_mfma_f32_16x16x32_bf16 v[116:119], v[136:139], a[184:187], v[116:119]
  v_cvt_pk_bf16_f32 v108, v84, v85
  v_cvt_pk_bf16_f32 v109, v86, v87
L_r252:
  v_mfma_f32_16x16x32_bf16 v[116:119], v[96:99], a[172:175], v[116:119]
L_r253:
  v_mfma_f32_16x16x32_bf16 v[116:119], v[92:95], a[160:163], v[116:119]
L_r254:
  v_mfma_f32_16x16x32_bf16 v[116:119], v[88:91], a[148:151], v[116:119]
L_r255:
  v_mfma_f32_16x16x32_bf16 v[156:159], v[88:91], a[152:155], 0
L_r256:
  v_mfma_f32_16x16x32_bf16 v[156:159], v[92:95], a[164:167], v[156:159]
L_r257:
  v_mfma_f32_16x16x32_bf16 v[156:159], v[96:99], a[176:179], v[156:159]
  v_cvt_pk_bf16_f32 v112, v116, v117
  v_cvt_pk_bf16_f32 v113, v118, v119
L_r258:
  v_mfma_f32_16x16x32_bf16 v[156:159], v[136:139], a[188:191], v[156:159]
L_r259:
  v_mfma_f32_16x16x32_bf16 v[156:159], v[140:143], a[200:203], v[156:159]
  buffer_load_dwordx2 v[52:53], v11, s[20:23], s44 offen sc1
  v_mfma_f32_16x16x32_bf16 v[156:159], v[80:83], a[212:215], v[156:159]
  s_waitcnt lgkmcnt(0)
  v_mfma_f32_16x16x32_bf16 v[84:87], a[132:135], a[244:247], 0
  v_mfma_f32_16x16x32_bf16 v[84:87], a[120:123], a[248:251], v[84:87]
  v_mfma_f32_16x16x32_bf16 v[84:87], a[108:111], a[252:255], v[84:87]
  v_cvt_pk_bf16_f32 v116, v156, v157
  v_cvt_pk_bf16_f32 v117, v158, v159
  v_mfma_f32_16x16x32_bf16 v[84:87], a[96:99], v[144:147], v[84:87]
  v_mfma_f32_16x16x32_bf16 v[84:87], a[84:87], v[148:151], v[84:87]
  s_waitcnt vmcnt(31)
  s_barrier
  v_mfma_f32_16x16x32_bf16 v[84:87], a[72:75], v[152:155], v[84:87]
  v_add_u32 v0, s28, v2
  v_xor_b32 v1, 64, v0
  v_mfma_f32_16x16x32_bf16 v[80:83], a[76:79], v[152:155], 0
  s_cmp_eq_u32 s59, 3
  v_mfma_f32_16x16x32_bf16 v[80:83], a[88:91], v[148:151], v[80:83]
  s_cselect_b32 s18, s16, s18
  v_mfma_f32_16x16x32_bf16 v[80:83], a[100:103], v[144:147], v[80:83]
  s_cselect_b32 s15, s60, s15
  v_cvt_pk_bf16_f32 v136, v84, v85
  v_cvt_pk_bf16_f32 v137, v86, v87
  v_mfma_f32_16x16x32_bf16 v[80:83], a[112:115], a[252:255], v[80:83]
  s_cmp_eq_u32 s59, 7
  v_mfma_f32_16x16x32_bf16 v[80:83], a[124:127], a[248:251], v[80:83]
  s_cselect_b32 s19, s16, s19
  v_mfma_f32_16x16x32_bf16 v[80:83], a[136:139], a[244:247], v[80:83]
  s_cselect_b32 s99, s60, s99
  v_mfma_f32_16x16x32_bf16 v[84:87], a[140:143], a[244:247], 0
  s_memrealtime s[16:17]
  v_mfma_f32_16x16x32_bf16 v[84:87], a[128:131], a[248:251], v[84:87]
  s_memtime s[60:61]
  v_mfma_f32_16x16x32_bf16 v[84:87], a[116:119], a[252:255], v[84:87]
  s_add_u32 s59, s59, 1
  v_cvt_pk_bf16_f32 v138, v80, v81
  v_cvt_pk_bf16_f32 v139, v82, v83
  v_mfma_f32_16x16x32_bf16 v[84:87], a[104:107], v[144:147], v[84:87]
  v_mfma_f32_16x16x32_bf16 v[84:87], a[92:95], v[148:151], v[84:87]
  v_mfma_f32_16x16x32_bf16 v[84:87], a[80:83], v[152:155], v[84:87]
  v_mfma_f32_16x16x32_bf16 v[92:95], v[70:73], v[76:79], v[36:39]
  v_mfma_f32_16x16x32_bf16 v[92:95], v[68:71], v[12:15], v[92:95]
  v_mfma_f32_16x16x32_bf16 v[96:99], v[122:125], v[76:79], v[32:35]
  v_cvt_pk_bf16_f32 v140, v84, v85
  v_cvt_pk_bf16_f32 v141, v86, v87
  v_mfma_f32_16x16x32_bf16 v[96:99], v[120:123], v[12:15], v[96:99]
  v_mfma_f32_16x16x32_bf16 v[172:175], v[130:133], v[76:79], v[28:31]
  v_exp_f32 v92, v92
  v_mfma_f32_16x16x32_bf16 v[172:175], v[128:131], v[12:15], v[172:175]
  v_exp_f32 v93, v93
  v_mfma_f32_16x16x32_bf16 v[176:179], v[138:141], v[76:79], v[24:27]
  v_exp_f32 v94, v94
  v_mfma_f32_16x16x32_bf16 v[176:179], v[136:139], v[12:15], v[176:179]
  v_exp_f32 v95, v95
  v_mfma_f32_16x16x32_bf16 v[84:87], v[68:71], v[100:103], v[40:43]
  v_exp_f32 v96, v96
  v_mfma_f32_16x16x32_bf16 v[84:87], v[70:73], v[14:17], v[84:87]
  v_exp_f32 v97, v97
  v_mfma_f32_16x16x32_bf16 v[88:91], v[120:123], v[100:103], v[36:39]
  v_exp_f32 v98, v98
  v_mfma_f32_16x16x32_bf16 v[88:91], v[122:125], v[14:17], v[88:91]
  v_exp_f32 v99, v99
  v_mfma_f32_16x16x32_bf16 v[168:171], v[128:131], v[100:103], v[32:35]
  v_exp_f32 v172, v172
  v_mfma_f32_16x16x32_bf16 v[168:171], v[130:133], v[14:17], v[168:171]
  v_exp_f32 v173, v173
  v_mfma_f32_16x16x32_bf16 v[164:167], v[136:139], v[100:103], v[28:31]
  v_exp_f32 v174, v174
  v_mfma_f32_16x16x32_bf16 v[164:167], v[138:141], v[14:17], v[164:167]
  v_exp_f32 v175, v175
  v_mfma_f32_16x16x32_bf16 v[76:79], v[130:133], v[104:107], v[36:39]
  v_exp_f32 v176, v176
  v_mfma_f32_16x16x32_bf16 v[76:79], v[128:131], v[18:21], v[76:79]
  v_exp_f32 v177, v177
  v_mfma_f32_16x16x32_bf16 v[80:83], v[138:141], v[104:107], v[32:35]
  v_exp_f32 v178, v178
  v_mfma_f32_16x16x32_bf16 v[80:83], v[136:139], v[18:21], v[80:83]
  v_exp_f32 v179, v179
  v_mfma_f32_16x16x32_bf16 v[160:163], v[70:73], v[104:107], v[44:47]
  v_cvt_pk_bf16_f32 v92, v92, v93
  v_cvt_pk_bf16_f32 v93, v94, v95
  v_mfma_f32_16x16x32_bf16 v[160:163], v[68:71], v[18:21], v[160:163]
  v_cvt_pk_bf16_f32 v94, v96, v97
  v_cvt_pk_bf16_f32 v95, v98, v99
  v_mfma_f32_16x16x32_bf16 v[156:159], v[122:125], v[104:107], v[40:43]
  v_cvt_pk_bf16_f32 v96, v172, v173
  v_cvt_pk_bf16_f32 v97, v174, v175
  v_mfma_f32_16x16x32_bf16 v[156:159], v[120:123], v[18:21], v[156:159]
  v_cvt_pk_bf16_f32 v98, v176, v177
  v_cvt_pk_bf16_f32 v99, v178, v179
  v_mfma_f32_16x16x32_bf16 v[172:175], a[0:3], v[152:155], 0
  v_exp_f32 v84, v84
  v_mfma_f32_16x16x32_bf16 v[172:175], a[12:15], v[148:151], v[172:175]
  v_exp_f32 v85, v85
  v_mfma_f32_16x16x32_bf16 v[172:175], a[24:27], v[144:147], v[172:175]
  v_exp_f32 v86, v86
  v_mfma_f32_16x16x32_bf16 v[172:175], a[36:39], a[252:255], v[172:175]
  v_exp_f32 v87, v87
  v_mfma_f32_16x16x32_bf16 v[172:175], a[48:51], a[248:251], v[172:175]
  v_exp_f32 v88, v88
  v_mfma_f32_16x16x32_bf16 v[172:175], a[60:63], a[244:247], v[172:175]
  v_exp_f32 v89, v89
  v_mfma_f32_16x16x32_bf16 v[100:103], a[64:67], a[244:247], 0
  v_exp_f32 v90, v90
  v_mfma_f32_16x16x32_bf16 v[100:103], a[52:55], a[248:251], v[100:103]
  v_exp_f32 v91, v91
  v_mfma_f32_16x16x32_bf16 v[100:103], a[40:43], a[252:255], v[100:103]
  v_mul_f32 v172, s42, v172
  v_mul_f32 v173, s42, v173
  v_mfma_f32_16x16x32_bf16 v[100:103], a[28:31], v[144:147], v[100:103]
  v_mul_f32 v174, s42, v174
  v_mul_f32 v175, s42, v175
  v_mfma_f32_16x16x32_bf16 v[100:103], a[16:19], v[148:151], v[100:103]
  v_cvt_pk_bf16_f32 v176, v172, v173
  v_cvt_pk_bf16_f32 v177, v174, v175
  v_mfma_f32_16x16x32_bf16 v[100:103], a[4:7], v[152:155], v[100:103]
  v_exp_f32 v168, v168
  v_mfma_f32_16x16x32_bf16 v[104:107], a[8:11], v[152:155], 0
  v_exp_f32 v169, v169
  v_mfma_f32_16x16x32_bf16 v[104:107], a[20:23], v[148:151], v[104:107]
  v_exp_f32 v170, v170
  v_mfma_f32_16x16x32_bf16 v[104:107], a[32:35], v[144:147], v[104:107]
  v_mul_f32 v100, s42, v100
  v_mul_f32 v101, s42, v101
  v_mfma_f32_16x16x32_bf16 v[104:107], a[44:47], a[252:255], v[104:107]
  v_mul_f32 v102, s42, v102
  v_mul_f32 v103, s42, v103
  v_mfma_f32_16x16x32_bf16 v[104:107], a[56:59], a[248:251], v[104:107]
  v_cvt_pk_bf16_f32 v178, v100, v101
  v_cvt_pk_bf16_f32 v179, v102, v103
  v_mfma_f32_16x16x32_bf16 v[104:107], a[68:71], a[244:247], v[104:107]
  v_exp_f32 v171, v171
  v_mfma_f32_16x16x32_bf16 v[180:183], v[152:155], a[144:147], 0
  v_exp_f32 v164, v164
  v_mfma_f32_16x16x32_bf16 v[180:183], v[148:151], a[156:159], v[180:183]
  v_exp_f32 v165, v165
  v_mfma_f32_16x16x32_bf16 v[180:183], v[144:147], a[168:171], v[180:183]
  v_mul_f32 v104, s42, v104
  v_mul_f32 v105, s42, v105
  v_mfma_f32_16x16x32_bf16 v[180:183], a[252:255], a[180:183], v[180:183]
  v_mul_f32 v106, s42, v106
  v_mul_f32 v107, s42, v107
  v_mfma_f32_16x16x32_bf16 v[180:183], a[248:251], a[192:195], v[180:183]
  v_cvt_pk_bf16_f32 v22, v104, v105
  v_cvt_pk_bf16_f32 v23, v106, v107
  v_mfma_f32_16x16x32_bf16 v[180:183], a[244:247], a[204:207], v[180:183]
  v_exp_f32 v166, v166
  v_mfma_f32_16x16x32_bf16 v[100:103], v[128:131], v[176:179], v[40:43]
  v_exp_f32 v167, v167
  v_mfma_f32_16x16x32_bf16 v[100:103], v[130:133], v[20:23], v[100:103]
  v_cvt_pk_bf16_f32 v84, v84, v85
  v_cvt_pk_bf16_f32 v85, v86, v87
  v_mfma_f32_16x16x32_bf16 v[104:107], v[136:139], v[176:179], v[36:39]
  v_cvt_pk_bf16_f32 v110, v180, v181
  v_cvt_pk_bf16_f32 v111, v182, v183
  v_mfma_f32_16x16x32_bf16 v[104:107], v[138:141], v[20:23], v[104:107]
  ds_read_b128 v[172:175], v3 offset:0
  v_cvt_pk_bf16_f32 v86, v88, v89
  v_mfma_f32_16x16x32_bf16 v[132:135], v[68:71], v[176:179], v[48:51]
  ds_read_b128 v[136:139], v3 offset:4096
  v_cvt_pk_bf16_f32 v87, v90, v91
  v_mfma_f32_16x16x32_bf16 v[132:135], v[70:73], v[20:23], v[132:135]
  ds_read_b128 v[140:143], v3 offset:8192
  v_cvt_pk_bf16_f32 v88, v168, v169
  v_mfma_f32_16x16x32_bf16 v[128:131], v[120:123], v[176:179], v[44:47]
  ds_read_b128 v[68:71], v3 offset:12288
  v_cvt_pk_bf16_f32 v89, v170, v171
  v_mfma_f32_16x16x32_bf16 v[128:131], v[122:125], v[20:23], v[128:131]
  ds_read_b128 v[72:75], v3 offset:16384
  v_cvt_pk_bf16_f32 v90, v164, v165
  v_mfma_f32_16x16x32_bf16 v[168:171], a[244:247], a[208:211], 0
  ds_read_b128 v[120:123], v3 offset:20480
  v_cvt_pk_bf16_f32 v91, v166, v167
  v_mfma_f32_16x16x32_bf16 v[168:171], a[248:251], a[196:199], v[168:171]
  v_exp_f32 v76, v76
  v_mfma_f32_16x16x32_bf16 v[168:171], a[252:255], a[184:187], v[168:171]
  v_exp_f32 v77, v77
  v_mfma_f32_16x16x32_bf16 v[168:171], v[144:147], a[172:175], v[168:171]
  v_exp_f32 v78, v78
  v_mfma_f32_16x16x32_bf16 v[168:171], v[148:151], a[160:163], v[168:171]
  v_exp_f32 v79, v79
  v_mfma_f32_16x16x32_bf16 v[168:171], v[152:155], a[148:151], v[168:171]
  v_exp_f32 v80, v80
  v_mfma_f32_16x16x32_bf16 v[124:127], v[152:155], a[152:155], 0
  v_exp_f32 v81, v81
  v_mfma_f32_16x16x32_bf16 v[124:127], v[148:151], a[164:167], v[124:127]
  v_exp_f32 v82, v82
  v_mfma_f32_16x16x32_bf16 v[124:127], v[144:147], a[176:179], v[124:127]
  v_cvt_pk_bf16_f32 v114, v168, v169
  v_cvt_pk_bf16_f32 v115, v170, v171
  v_mfma_f32_16x16x32_bf16 v[124:127], a[252:255], a[188:191], v[124:127]
  v_exp_f32 v83, v83
  v_mfma_f32_16x16x32_bf16 v[124:127], a[248:251], a[200:203], v[124:127]
  s_waitcnt lgkmcnt(0)
  v_exp_f32 v160, v160
  v_mfma_f32_16x16x32_bf16 v[124:127], a[244:247], a[212:215], v[124:127]
L_hop_0_1:
  s_cbranch_execz L_hop_0_2
L_mid:
  v_mfma_f32_16x16x32_bf16 v[148:151], v[172:175], v[184:187], 0
  v_exp_f32 v161, v161
  v_mfma_f32_16x16x32_bf16 v[148:151], v[136:139], v[200:203], v[148:151]
  v_exp_f32 v162, v162
  v_mfma_f32_16x16x32_bf16 v[148:151], v[140:143], v[216:219], v[148:151]
  v_cvt_pk_bf16_f32 v118, v124, v125
  v_cvt_pk_bf16_f32 v119, v126, v127
  v_mfma_f32_16x16x32_bf16 v[148:151], v[68:71], v[232:235], v[148:151]
  v_exp_f32 v163, v163
  v_mfma_f32_16x16x32_bf16 v[148:151], v[72:75], v[248:251], v[148:151]
  v_exp_f32 v156, v156
  v_mfma_f32_16x16x32_bf16 v[148:151], v[120:123], a[224:227], v[148:151]
  v_exp_f32 v157, v157
  v_mfma_f32_16x16x32_bf16 v[168:171], v[120:123], a[228:231], 0
  v_exp_f32 v158, v158
  v_mfma_f32_16x16x32_bf16 v[168:171], v[72:75], v[252:255], v[168:171]
  ds_read_b128 v[124:127], v4 offset:0
  v_cvt_pk_bf16_f32 v76, v76, v77
  v_mfma_f32_16x16x32_bf16 v[168:171], v[68:71], v[236:239], v[168:171]
  ds_read_b128 v[180:183], v4 offset:4096
  v_cvt_pk_bf16_f32 v77, v78, v79
  v_mfma_f32_16x16x32_bf16 v[168:171], v[140:143], v[220:223], v[168:171]
  ds_read_b128 a[248:251], v4 offset:8192
  v_cvt_pk_bf16_f32 v78, v80, v81
  v_mfma_f32_16x16x32_bf16 v[168:171], v[136:139], v[204:207], v[168:171]
  ds_read_b128 v[164:167], v4 offset:12288
  v_cvt_pk_bf16_f32 v79, v82, v83
  v_mfma_f32_16x16x32_bf16 v[168:171], v[172:175], v[188:191], v[168:171]
  ds_read_b128 v[144:147], v4 offset:16384
  v_cvt_pk_bf16_f32 v80, v160, v161
  v_mfma_f32_16x16x32_bf16 v[152:155], v[172:175], v[192:195], 0
  ds_read_b128 v[176:179], v4 offset:20480
  v_cvt_pk_bf16_f32 v81, v162, v163
  v_mfma_f32_16x16x32_bf16 v[152:155], v[136:139], v[208:211], v[152:155]
  v_exp_f32 v159, v159
  v_mfma_f32_16x16x32_bf16 v[152:155], v[140:143], v[224:227], v[152:155]
  v_cvt_pk_bf16_f32 v148, v148, v168
  v_cvt_pk_bf16_f32 v149, v149, v169
  v_mfma_f32_16x16x32_bf16 v[152:155], v[68:71], v[240:243], v[152:155]
  v_cvt_pk_bf16_f32 v150, v150, v170
  v_cvt_pk_bf16_f32 v151, v151, v171
  v_mfma_f32_16x16x32_bf16 v[152:155], v[72:75], a[216:219], v[152:155]
  buffer_store_dword v148, v7, s[24:27], s33 offen offset:0 nt
  v_mfma_f32_16x16x32_bf16 v[152:155], v[120:123], a[232:235], v[152:155]
  v_cvt_pk_bf16_f32 v82, v156, v157
  v_cvt_pk_bf16_f32 v83, v158, v159
  v_mfma_f32_16x16x32_bf16 v[160:163], v[120:123], a[236:239], 0
  v_exp_f32 v100, v100
  v_mfma_f32_16x16x32_bf16 v[160:163], v[72:75], a[220:223], v[160:163]
  buffer_store_dword v149, v7, s[24:27], s33 offen offset:384 nt
  v_mfma_f32_16x16x32_bf16 v[160:163], v[68:71], v[244:247], v[160:163]
  ds_read_b128 a[244:247], v3 offset:512
  v_mfma_f32_16x16x32_bf16 v[160:163], v[140:143], v[228:231], v[160:163]
  ds_read_b128 v[168:171], v3 offset:4608
  v_mfma_f32_16x16x32_bf16 v[160:163], v[136:139], v[212:215], v[160:163]
  buffer_store_dword v150, v7, s[24:27], s33 offen offset:768 nt
  v_mfma_f32_16x16x32_bf16 v[160:163], v[172:175], v[196:199], v[160:163]
  s_waitcnt lgkmcnt(2)
  ds_read_b128 a[252:255], v3 offset:8704
  v_mfma_f32_16x16x32_bf16 v[136:139], v[124:127], v[184:187], 0
  ds_read_b128 v[68:71], v3 offset:12800
  v_mfma_f32_16x16x32_bf16 v[136:139], v[180:183], v[200:203], v[136:139]
  buffer_store_dword v151, v7, s[24:27], s33 offen offset:1152 nt
  v_mfma_f32_16x16x32_bf16 v[136:139], a[248:251], v[216:219], v[136:139]
  v_cvt_pk_bf16_f32 v152, v152, v160
  v_cvt_pk_bf16_f32 v153, v153, v161
  v_mfma_f32_16x16x32_bf16 v[136:139], v[164:167], v[232:235], v[136:139]
  v_cvt_pk_bf16_f32 v154, v154, v162
  v_cvt_pk_bf16_f32 v155, v155, v163
  v_mfma_f32_16x16x32_bf16 v[136:139], v[144:147], v[248:251], v[136:139]
  buffer_store_dword v152, v8, s[24:27], s33 offen offset:0 nt
  v_mfma_f32_16x16x32_bf16 v[136:139], v[176:179], a[224:227], v[136:139]
  ds_read_b128 v[72:75], v3 offset:16896
  v_mfma_f32_16x16x32_bf16 v[120:123], v[176:179], a[228:231], 0
  ds_read_b128 v[140:143], v3 offset:20992
  v_xor_b32 v3, 40960, v3
  v_mfma_f32_16x16x32_bf16 v[120:123], v[144:147], v[252:255], v[120:123]
  buffer_store_dword v153, v8, s[24:27], s33 offen offset:384 nt
  v_mfma_f32_16x16x32_bf16 v[120:123], v[164:167], v[236:239], v[120:123]
  v_exp_f32 v101, v101
  v_mfma_f32_16x16x32_bf16 v[120:123], a[248:251], v[220:223], v[120:123]
  v_exp_f32 v102, v102
  v_mfma_f32_16x16x32_bf16 v[120:123], v[180:183], v[204:207], v[120:123]
  buffer_store_dword v154, v8, s[24:27], s33 offen offset:768 nt
  v_mfma_f32_16x16x32_bf16 v[120:123], v[124:127], v[188:191], v[120:123]
  s_waitcnt lgkmcnt(1)
  v_exp_f32 v103, v103
  v_mfma_f32_16x16x32_bf16 v[144:147], a[244:247], v[184:187], 0
  v_exp_f32 v104, v104
  v_mfma_f32_16x16x32_bf16 v[144:147], v[168:171], v[200:203], v[144:147]
  buffer_store_dword v155, v8, s[24:27], s33 offen offset:1152 nt
  v_mfma_f32_16x16x32_bf16 v[144:147], a[252:255], v[216:219], v[144:147]
  v_cvt_pk_bf16_f32 v136, v136, v120
  v_cvt_pk_bf16_f32 v137, v137, v121
  v_mfma_f32_16x16x32_bf16 v[144:147], v[68:71], v[232:235], v[144:147]
  s_waitcnt lgkmcnt(0)
  v_cvt_pk_bf16_f32 v138, v138, v122
  v_cvt_pk_bf16_f32 v139, v139, v123
  v_mfma_f32_16x16x32_bf16 v[144:147], v[72:75], v[248:251], v[144:147]
  buffer_store_dword v136, v7, s[24:27], s34 offen offset:0 nt
  v_mfma_f32_16x16x32_bf16 v[144:147], v[140:143], a[224:227], v[144:147]
  v_exp_f32 v105, v105
  v_mfma_f32_16x16x32_bf16 v[160:163], v[140:143], a[228:231], 0
  v_exp_f32 v106, v106
  v_mfma_f32_16x16x32_bf16 v[160:163], v[72:75], v[252:255], v[160:163]
  buffer_store_dword v137, v7, s[24:27], s34 offen offset:384 nt
  v_mfma_f32_16x16x32_bf16 v[160:163], v[68:71], v[236:239], v[160:163]
  ds_read_b128 v[120:123], v4 offset:512
  v_cvt_pk_bf16_f32 v100, v100, v101
  v_mfma_f32_16x16x32_bf16 v[160:163], a[252:255], v[220:223], v[160:163]
  ds_read_b128 v[124:127], v4 offset:4608
  v_cvt_pk_bf16_f32 v101, v102, v103
  v_mfma_f32_16x16x32_bf16 v[160:163], v[168:171], v[204:207], v[160:163]
  buffer_store_dword v138, v7, s[24:27], s34 offen offset:768 nt
  v_mfma_f32_16x16x32_bf16 v[160:163], a[244:247], v[188:191], v[160:163]
  ds_read_b128 v[152:155], v4 offset:8704
  v_cvt_pk_bf16_f32 v102, v104, v105
  v_mfma_f32_16x16x32_bf16 v[148:151], a[244:247], v[192:195], 0
  ds_read_b128 v[156:159], v4 offset:12800
  v_mfma_f32_16x16x32_bf16 v[148:151], v[168:171], v[208:211], v[148:151]
  buffer_store_dword v139, v7, s[24:27], s34 offen offset:1152 nt
  v_mfma_f32_16x16x32_bf16 v[148:151], a[252:255], v[224:227], v[148:151]
  v_cvt_pk_bf16_f32 v144, v144, v160
  v_cvt_pk_bf16_f32 v145, v145, v161
  v_mfma_f32_16x16x32_bf16 v[148:151], v[68:71], v[240:243], v[148:151]
  v_cvt_pk_bf16_f32 v146, v146, v162
  v_cvt_pk_bf16_f32 v147, v147, v163
  v_mfma_f32_16x16x32_bf16 v[148:151], v[72:75], a[216:219], v[148:151]
  buffer_store_dword v144, v7, s[24:27], s35 offen offset:0 nt
  v_mfma_f32_16x16x32_bf16 v[148:151], v[140:143], a[232:235], v[148:151]
  ds_read_b128 v[136:139], v4 offset:16896
  v_mfma_f32_16x16x32_bf16 v[164:167], v[140:143], a[236:239], 0
  ds_read_b128 v[160:163], v4 offset:20992
  v_xor_b32 v4, 40960, v4
  v_mfma_f32_16x16x32_bf16 v[164:167], v[72:75], a[220:223], v[164:167]
  buffer_store_dword v145, v7, s[24:27], s35 offen offset:384 nt
  v_mfma_f32_16x16x32_bf16 v[164:167], v[68:71], v[244:247], v[164:167]
  v_exp_f32 v107, v107
  v_mfma_f32_16x16x32_bf16 v[164:167], a[252:255], v[228:231], v[164:167]
  v_exp_f32 v132, v132
  v_mfma_f32_16x16x32_bf16 v[164:167], v[168:171], v[212:215], v[164:167]
  buffer_store_dword v146, v7, s[24:27], s35 offen offset:768 nt
  v_mfma_f32_16x16x32_bf16 v[164:167], a[244:247], v[196:199], v[164:167]
  s_waitcnt lgkmcnt(1)
  v_exp_f32 v133, v133
  v_mfma_f32_16x16x32_bf16 v[140:143], v[120:123], v[184:187], 0
  v_exp_f32 v134, v134
  v_mfma_f32_16x16x32_bf16 v[140:143], v[124:127], v[200:203], v[140:143]
  buffer_store_dword v147, v7, s[24:27], s35 offen offset:1152 nt
  v_mfma_f32_16x16x32_bf16 v[140:143], v[152:155], v[216:219], v[140:143]
  v_cvt_pk_bf16_f32 v148, v148, v164
  v_cvt_pk_bf16_f32 v149, v149, v165
  v_mfma_f32_16x16x32_bf16 v[140:143], v[156:159], v[232:235], v[140:143]
  s_waitcnt lgkmcnt(0)
  v_cvt_pk_bf16_f32 v150, v150, v166
  v_cvt_pk_bf16_f32 v151, v151, v167
  v_mfma_f32_16x16x32_bf16 v[140:143], v[136:139], v[248:251], v[140:143]
  buffer_store_dword v148, v8, s[24:27], s35 offen offset:0 nt
  v_mfma_f32_16x16x32_bf16 v[140:143], v[160:163], a[224:227], v[140:143]
  v_mov_b64 v[164:165], 0
  v_cvt_pk_bf16_f32 v103, v106, v107
  v_mfma_f32_16x16x32_bf16 v[144:147], v[160:163], a[228:231], 0
  v_exp_f32 v135, v135
  v_mfma_f32_16x16x32_bf16 v[144:147], v[136:139], v[252:255], v[144:147]
  buffer_store_dword v149, v8, s[24:27], s35 offen offset:384 nt
  v_mfma_f32_16x16x32_bf16 v[144:147], v[156:159], v[236:239], v[144:147]
  v_exp_f32 v128, v128
  v_mfma_f32_16x16x32_bf16 v[144:147], v[152:155], v[220:223], v[144:147]
  v_mov_b64 v[72:73], 0
  v_cvt_pk_bf16_f32 v104, v132, v133
  v_mfma_f32_16x16x32_bf16 v[144:147], v[124:127], v[204:207], v[144:147]
  buffer_store_dword v150, v8, s[24:27], s35 offen offset:768 nt
  v_mfma_f32_16x16x32_bf16 v[144:147], v[120:123], v[188:191], v[144:147]
  v_exp_f32 v129, v129
  v_smfmac_f32_16x16x64_bf16 v[164:167], a[240:243], v[92:99], v10
  v_exp_f32 v130, v130
  v_mfma_f32_16x16x32_bf16 v[168:171], v[108:111], v[96:99], 0
  buffer_store_dword v151, v8, s[24:27], s35 offen offset:1152 nt
  v_mfma_f32_16x16x32_bf16 v[168:171], v[56:59], v[92:95], v[168:171]
  v_cvt_pk_bf16_f32 v140, v140, v144
  v_cvt_pk_bf16_f32 v141, v141, v145
  v_mfma_f32_16x16x32_bf16 v[160:163], v[60:63], v[92:95], 0
  v_cvt_pk_bf16_f32 v142, v142, v146
  v_cvt_pk_bf16_f32 v143, v143, v147
  v_mfma_f32_16x16x32_bf16 v[160:163], v[112:115], v[96:99], v[160:163]
  buffer_store_dword v140, v7, s[24:27], s36 offen offset:0 nt
  v_mfma_f32_16x16x32_bf16 v[68:71], v[116:119], v[96:99], 0
  v_mov_b64 v[124:125], 0
  v_cvt_pk_bf16_f32 v105, v134, v135
  v_mfma_f32_16x16x32_bf16 v[68:71], v[64:67], v[92:95], v[68:71]
  v_exp_f32 v131, v131
  v_smfmac_f32_16x16x64_bf16 v[72:75], a[240:243], v[84:91], v10
  buffer_store_dword v141, v7, s[24:27], s36 offen offset:384 nt
  v_mfma_f32_16x16x32_bf16 v[156:159], v[108:111], v[88:91], 0
  v_cvt_pk_bf16_f32 v106, v128, v129
  v_cvt_pk_bf16_f32 v107, v130, v131
  v_mfma_f32_16x16x32_bf16 v[156:159], v[56:59], v[84:87], v[156:159]
  v_add_f32 v164, v164, v165
  v_mfma_f32_16x16x32_bf16 v[148:151], v[60:63], v[84:87], 0
  buffer_store_dword v142, v7, s[24:27], s36 offen offset:768 nt
  v_mfma_f32_16x16x32_bf16 v[148:151], v[112:115], v[88:91], v[148:151]
  ds_read_b128 a[244:247], v0 offset:0
  v_mov_b64 v[92:93], 0
  v_mfma_f32_16x16x32_bf16 v[132:135], v[116:119], v[88:91], 0
  ds_read_b128 a[248:251], v1 offset:0
  v_add_f32 v72, v72, v73
  v_mfma_f32_16x16x32_bf16 v[132:135], v[64:67], v[84:87], v[132:135]
  buffer_store_dword v143, v7, s[24:27], s36 offen offset:1152 nt
  v_smfmac_f32_16x16x64_bf16 v[124:127], a[240:243], v[76:83], v10
  ds_read_b128 v[136:139], v0 offset:8192
  v_cndmask_b32 v7, v7, v52, s[62:63]
  v_mfma_f32_16x16x32_bf16 v[128:131], v[56:59], v[80:83], 0
  ds_read_b128 v[140:143], v1 offset:8192
  v_cndmask_b32 v8, v8, v53, s[62:63]
  v_mfma_f32_16x16x32_bf16 v[128:131], v[108:111], v[76:79], v[128:131]
  s_mov_b64 s[62:63], 0
  ds_read_b128 v[152:155], v0 offset:16384
  v_mfma_f32_16x16x32_bf16 v[120:123], v[112:115], v[76:79], 0
  ds_read_b128 v[144:147], v1 offset:16384
  v_mfma_f32_16x16x32_bf16 v[120:123], v[60:63], v[80:83], v[120:123]
  v_rcp_f32 v166, v164
  v_mfma_f32_16x16x32_bf16 v[96:99], v[64:67], v[80:83], 0
  v_mul_f32 v168, v166, v168
  v_mul_f32 v169, v166, v169
  v_mfma_f32_16x16x32_bf16 v[96:99], v[116:119], v[76:79], v[96:99]
  v_mul_f32 v170, v166, v170
  v_mul_f32 v171, v166, v171
  v_smfmac_f32_16x16x64_bf16 v[92:95], a[240:243], v[100:107], v10
  v_cvt_pk_bf16_f32 v168, v168, v169
  v_cvt_pk_bf16_f32 v169, v170, v171
  v_mfma_f32_16x16x32_bf16 v[88:91], v[56:59], v[104:107], 0
  v_mul_f32 v160, v166, v160
  v_mul_f32 v161, v166, v161
  v_mfma_f32_16x16x32_bf16 v[88:91], v[108:111], v[100:103], v[88:91]
  v_mul_f32 v162, v166, v162
  v_mul_f32 v163, v166, v163
  v_mfma_f32_16x16x32_bf16 v[80:83], v[112:115], v[100:103], 0
  v_cvt_pk_bf16_f32 v160, v160, v161
  v_cvt_pk_bf16_f32 v161, v162, v163
  v_mfma_f32_16x16x32_bf16 v[80:83], v[60:63], v[104:107], v[80:83]
  v_mul_f32 v68, v166, v68
  v_mul_f32 v69, v166, v69
  v_mfma_f32_16x16x32_bf16 v[84:87], v[64:67], v[104:107], 0
  v_mul_f32 v70, v166, v70
  v_mul_f32 v71, v166, v71
  v_mfma_f32_16x16x32_bf16 v[84:87], v[116:119], v[100:103], v[84:87]
  s_waitcnt lgkmcnt(0)
  v_cvt_pk_bf16_f32 v68, v68, v69
  v_cvt_pk_bf16_f32 v69, v70, v71
  v_mfma_f32_16x16x32_bf16 v[64:67], a[0:3], a[244:247], 0
  v_max3_f32 v9, v164, v166, v9
  v_add_f32 v124, v124, v125
  v_mfma_f32_16x16x32_bf16 v[64:67], a[12:15], a[248:251], v[64:67]
  ds_write_b32 v5, v168 offset:0
  v_mfma_f32_16x16x32_bf16 v[64:67], a[24:27], v[136:139], v[64:67]
  v_rcp_f32 v74, v72
  v_mfma_f32_16x16x32_bf16 v[64:67], a[36:39], v[140:143], v[64:67]
  ds_write_b32 v5, v169 offset:1024
  v_mfma_f32_16x16x32_bf16 v[64:67], a[48:51], v[152:155], v[64:67]
  s_add_u32 m0, s30, 0
  v_mul_f32 v156, v74, v156
  v_mul_f32 v157, v74, v157
  v_mfma_f32_16x16x32_bf16 v[64:67], a[60:63], v[144:147], v[64:67]
  buffer_load_dwordx4 v6, s[8:11], s31 offen offset:0 nt lds
  v_mfma_f32_16x16x32_bf16 v[60:63], a[64:67], v[144:147], 0
  v_mul_f32 v158, v74, v158
  v_mul_f32 v159, v74, v159
  v_mfma_f32_16x16x32_bf16 v[60:63], a[52:55], v[152:155], v[60:63]
  ds_write_b32 v5, v160 offset:2048
  v_mfma_f32_16x16x32_bf16 v[60:63], a[40:43], v[140:143], v[60:63]
  v_mul_f32 v64, s42, v64
  v_mul_f32 v65, s42, v65
  v_mfma_f32_16x16x32_bf16 v[60:63], a[28:31], v[136:139], v[60:63]
  v_mul_f32 v66, s42, v66
  v_mul_f32 v67, s42, v67
  v_mfma_f32_16x16x32_bf16 v[60:63], a[16:19], a[248:251], v[60:63]
  v_cvt_pk_bf16_f32 v12, v64, v65
  v_cvt_pk_bf16_f32 v13, v66, v67
  v_mfma_f32_16x16x32_bf16 v[60:63], a[4:7], a[244:247], v[60:63]
  ds_write_b32 v5, v161 offset:3072
  v_mfma_f32_16x16x32_bf16 v[56:59], a[8:11], a[244:247], 0
  v_cvt_pk_bf16_f32 v156, v156, v157
  v_cvt_pk_bf16_f32 v157, v158, v159
  v_mfma_f32_16x16x32_bf16 v[56:59], a[20:23], a[248:251], v[56:59]
  ds_write_b32 v5, v68 offset:4096
  v_mfma_f32_16x16x32_bf16 v[56:59], a[32:35], v[136:139], v[56:59]
  v_mul_f32 v60, s42, v60
  v_mul_f32 v61, s42, v61
  v_mfma_f32_16x16x32_bf16 v[56:59], a[44:47], v[140:143], v[56:59]
  v_mul_f32 v62, s42, v62
  v_mul_f32 v63, s42, v63
  v_mfma_f32_16x16x32_bf16 v[56:59], a[56:59], v[152:155], v[56:59]
  v_cvt_pk_bf16_f32 v76, v60, v61
  v_cvt_pk_bf16_f32 v77, v62, v63
  v_mfma_f32_16x16x32_bf16 v[56:59], a[68:71], v[144:147], v[56:59]
  ds_write_b32 v5, v69 offset:5120
  v_mfma_f32_16x16x32_bf16 v[64:67], a[132:135], v[144:147], 0
  v_mul_f32 v148, v74, v148
  v_mul_f32 v149, v74, v149
  v_mfma_f32_16x16x32_bf16 v[64:67], a[120:123], v[152:155], v[64:67]
  v_mul_f32 v150, v74, v150
  v_mul_f32 v151, v74, v151
  v_mfma_f32_16x16x32_bf16 v[64:67], a[108:111], v[140:143], v[64:67]
  v_mul_f32 v56, s42, v56
  v_mul_f32 v57, s42, v57
  v_mfma_f32_16x16x32_bf16 v[64:67], a[96:99], v[136:139], v[64:67]
  v_mul_f32 v58, s42, v58
  v_mul_f32 v59, s42, v59
  v_mfma_f32_16x16x32_bf16 v[64:67], a[84:87], a[248:251], v[64:67]
  s_add_u32 m0, s30, 8064
  v_cvt_pk_bf16_f32 v78, v56, v57
  v_cvt_pk_bf16_f32 v79, v58, v59
  v_mfma_f32_16x16x32_bf16 v[64:67], a[72:75], a[244:247], v[64:67]
  buffer_load_dwordx4 v6, s[8:11], s31 offen offset:128 nt lds
  v_mfma_f32_16x16x32_bf16 v[60:63], a[76:79], a[244:247], 0
  v_cvt_pk_bf16_f32 v148, v148, v149
  v_cvt_pk_bf16_f32 v149, v150, v151
  v_mfma_f32_16x16x32_bf16 v[60:63], a[88:91], a[248:251], v[60:63]
  v_mul_f32 v132, v74, v132
  v_mul_f32 v133, v74, v133
  v_mfma_f32_16x16x32_bf16 v[60:63], a[100:103], v[136:139], v[60:63]
  v_cvt_pk_bf16_f32 v68, v64, v65
  v_cvt_pk_bf16_f32 v69, v66, v67
  v_mfma_f32_16x16x32_bf16 v[60:63], a[112:115], v[140:143], v[60:63]
  v_mul_f32 v134, v74, v134
  v_mul_f32 v135, v74, v135
  v_mfma_f32_16x16x32_bf16 v[60:63], a[124:127], v[152:155], v[60:63]
  v_cvt_pk_bf16_f32 v132, v132, v133
  v_cvt_pk_bf16_f32 v133, v134, v135
  v_mfma_f32_16x16x32_bf16 v[60:63], a[136:139], v[144:147], v[60:63]
  v_max3_f32 v9, v72, v74, v9
  v_add_f32 v92, v92, v93
  v_mfma_f32_16x16x32_bf16 v[56:59], a[140:143], v[144:147], 0
  ds_write_b32 v5, v156 offset:256
  v_mfma_f32_16x16x32_bf16 v[56:59], a[128:131], v[152:155], v[56:59]
  v_rcp_f32 v126, v124
  v_mfma_f32_16x16x32_bf16 v[56:59], a[116:119], v[140:143], v[56:59]
  v_cvt_pk_bf16_f32 v70, v60, v61
  v_cvt_pk_bf16_f32 v71, v62, v63
  v_mfma_f32_16x16x32_bf16 v[56:59], a[104:107], v[136:139], v[56:59]
  ds_write_b32 v5, v157 offset:1280
  v_mfma_f32_16x16x32_bf16 v[56:59], a[92:95], a[248:251], v[56:59]
  v_mul_f32 v128, v126, v128
  v_mul_f32 v129, v126, v129
  v_mfma_f32_16x16x32_bf16 v[56:59], a[80:83], a[244:247], v[56:59]
  ds_write_b32 v5, v148 offset:2304
  v_mfma_f32_16x16x32_bf16 v[60:63], a[244:247], a[144:147], 0
  v_mul_f32 v130, v126, v130
  v_mul_f32 v131, v126, v131
  v_mfma_f32_16x16x32_bf16 v[60:63], a[248:251], a[156:159], v[60:63]
  ds_read_b128 a[252:255], v0 offset:2048
  v_cvt_pk_bf16_f32 v128, v128, v129
  v_mfma_f32_16x16x32_bf16 v[60:63], v[136:139], a[168:171], v[60:63]
  v_cvt_pk_bf16_f32 v72, v56, v57
  v_cvt_pk_bf16_f32 v73, v58, v59
  v_mfma_f32_16x16x32_bf16 v[60:63], v[140:143], a[180:183], v[60:63]
  ds_read_b128 v[104:107], v1 offset:2048
  v_cvt_pk_bf16_f32 v129, v130, v131
  v_mfma_f32_16x16x32_bf16 v[60:63], v[152:155], a[192:195], v[60:63]
  s_add_u32 m0, s30, 16128
  ds_read_b128 v[108:111], v0 offset:10240
  v_mul_f32 v120, v126, v120
  v_mfma_f32_16x16x32_bf16 v[60:63], v[144:147], a[204:207], v[60:63]
  buffer_load_dwordx4 v6, s[8:11], s31 offen offset:256 nt lds
  v_mfma_f32_16x16x32_bf16 v[64:67], v[144:147], a[208:211], 0
  ds_read_b128 v[116:119], v1 offset:10240
  v_mul_f32 v121, v126, v121
  v_mfma_f32_16x16x32_bf16 v[64:67], v[152:155], a[196:199], v[64:67]
  ds_read_b128 v[112:115], v0 offset:18432
  v_mul_f32 v122, v126, v122
  v_mfma_f32_16x16x32_bf16 v[64:67], v[140:143], a[184:187], v[64:67]
  v_cvt_pk_bf16_f32 v56, v60, v61
  v_cvt_pk_bf16_f32 v57, v62, v63
  v_mfma_f32_16x16x32_bf16 v[64:67], v[136:139], a[172:175], v[64:67]
  ds_write_b32 v5, v149 offset:3328
  v_mfma_f32_16x16x32_bf16 v[64:67], a[248:251], a[160:163], v[64:67]
  v_mul_f32 v123, v126, v123
  v_cvt_pk_bf16_f32 v120, v120, v121
  v_mfma_f32_16x16x32_bf16 v[64:67], a[244:247], a[148:151], v[64:67]
  ds_write_b32 v5, v132 offset:4352
  v_mfma_f32_16x16x32_bf16 v[100:103], a[244:247], a[152:155], 0
  ds_write_b32 v5, v133 offset:5376
  v_mfma_f32_16x16x32_bf16 v[100:103], a[248:251], a[164:167], v[100:103]
  v_cvt_pk_bf16_f32 v121, v122, v123
  v_mul_f32 v96, v126, v96
  v_mfma_f32_16x16x32_bf16 v[100:103], v[136:139], a[176:179], v[100:103]
  ds_read_b128 a[244:247], v1 offset:18432
  v_cvt_pk_bf16_f32 v60, v64, v65
  v_mfma_f32_16x16x32_bf16 v[100:103], v[140:143], a[188:191], v[100:103]
  v_cvt_pk_bf16_f32 v61, v66, v67
  v_mul_f32 v97, v126, v97
  v_mfma_f32_16x16x32_bf16 v[100:103], v[152:155], a[200:203], v[100:103]
  v_mul_f32 v98, v126, v98
  v_mul_f32 v99, v126, v99
  v_mfma_f32_16x16x32_bf16 v[100:103], v[144:147], a[212:215], v[100:103]
  s_waitcnt lgkmcnt(4)
  v_cvt_pk_bf16_f32 v96, v96, v97
  v_cvt_pk_bf16_f32 v97, v98, v99
  v_mfma_f32_16x16x32_bf16 v[132:135], a[0:3], a[252:255], 0
  v_max3_f32 v9, v124, v126, v9
  v_mfma_f32_16x16x32_bf16 v[132:135], a[12:15], v[104:107], v[132:135]
  ds_write_b32 v5, v128 offset:512
  v_mfma_f32_16x16x32_bf16 v[132:135], a[24:27], v[108:111], v[132:135]
  v_cvt_pk_bf16_f32 v64, v100, v101
  v_cvt_pk_bf16_f32 v65, v102, v103
  v_mfma_f32_16x16x32_bf16 v[132:135], a[36:39], v[116:119], v[132:135]
  s_waitcnt lgkmcnt(1)
  ds_write_b32 v5, v129 offset:1536
  v_mfma_f32_16x16x32_bf16 v[132:135], a[48:51], v[112:115], v[132:135]
  s_add_u32 m0, s30, 4096
  v_rcp_f32 v94, v92
  v_mfma_f32_16x16x32_bf16 v[132:135], a[60:63], a[244:247], v[132:135]
  buffer_load_dwordx4 v6, s[8:11], s32 offen offset:0 nt lds
  v_mfma_f32_16x16x32_bf16 v[124:127], a[64:67], a[244:247], 0
  s_add_u32 s33, s31, s37
  v_mul_f32 v88, v94, v88
  v_mul_f32 v89, v94, v89
  v_mfma_f32_16x16x32_bf16 v[124:127], a[52:55], v[112:115], v[124:127]
  s_add_u32 s34, s31, s38
  ds_write_b32 v5, v120 offset:2560
  v_mfma_f32_16x16x32_bf16 v[124:127], a[40:43], v[116:119], v[124:127]
  s_add_u32 s35, s31, s39
  v_mul_f32 v132, s42, v132
  v_mul_f32 v133, s42, v133
  v_mfma_f32_16x16x32_bf16 v[124:127], a[28:31], v[108:111], v[124:127]
  s_add_u32 s36, s31, s40
  v_mul_f32 v134, s42, v134
  v_mul_f32 v135, s42, v135
  v_mfma_f32_16x16x32_bf16 v[124:127], a[16:19], v[104:107], v[124:127]
  s_add_u32 s31, s31, s43
  v_cvt_pk_bf16_f32 v100, v132, v133
  v_cvt_pk_bf16_f32 v101, v134, v135
  v_mfma_f32_16x16x32_bf16 v[124:127], a[4:7], a[252:255], v[124:127]
  s_mov_b32 s5, s28
  ds_write_b32 v5, v121 offset:3584
  v_mfma_f32_16x16x32_bf16 v[128:131], a[8:11], a[252:255], 0
  s_mov_b32 s28, s29
  v_mul_f32 v90, v94, v90
  v_mul_f32 v91, v94, v91
  v_mfma_f32_16x16x32_bf16 v[128:131], a[20:23], v[104:107], v[128:131]
  s_mov_b32 s29, s30
  ds_write_b32 v5, v96 offset:4608
  v_mfma_f32_16x16x32_bf16 v[128:131], a[32:35], v[108:111], v[128:131]
  v_mul_f32 v124, s42, v124
  v_mul_f32 v125, s42, v125
  v_mfma_f32_16x16x32_bf16 v[128:131], a[44:47], v[116:119], v[128:131]
  v_mul_f32 v126, s42, v126
  v_mul_f32 v127, s42, v127
  v_mfma_f32_16x16x32_bf16 v[128:131], a[56:59], v[112:115], v[128:131]
  v_cvt_pk_bf16_f32 v102, v124, v125
  v_cvt_pk_bf16_f32 v103, v126, v127
  v_mfma_f32_16x16x32_bf16 v[128:131], a[68:71], a[244:247], v[128:131]
  ds_write_b32 v5, v97 offset:5632
  v_mfma_f32_16x16x32_bf16 v[132:135], a[132:135], a[244:247], 0
  v_cvt_pk_bf16_f32 v88, v88, v89
  v_cvt_pk_bf16_f32 v89, v90, v91
  v_mfma_f32_16x16x32_bf16 v[132:135], a[120:123], v[112:115], v[132:135]
  v_mul_f32 v80, v94, v80
  v_mul_f32 v81, v94, v81
  v_mfma_f32_16x16x32_bf16 v[132:135], a[108:111], v[116:119], v[132:135]
  v_mul_f32 v128, s42, v128
  v_mul_f32 v129, s42, v129
  v_mfma_f32_16x16x32_bf16 v[132:135], a[96:99], v[108:111], v[132:135]
  v_mul_f32 v130, s42, v130
  v_mul_f32 v131, s42, v131
  v_mfma_f32_16x16x32_bf16 v[132:135], a[84:87], v[104:107], v[132:135]
  s_add_u32 m0, s30, 12160
  v_cvt_pk_bf16_f32 v16, v128, v129
  v_cvt_pk_bf16_f32 v17, v130, v131
  v_mfma_f32_16x16x32_bf16 v[132:135], a[72:75], a[252:255], v[132:135]
  buffer_load_dwordx4 v6, s[8:11], s32 offen offset:128 nt lds
  v_mfma_f32_16x16x32_bf16 v[96:99], a[76:79], a[252:255], 0
  v_mul_f32 v82, v94, v82
  v_mul_f32 v83, v94, v83
  v_mfma_f32_16x16x32_bf16 v[96:99], a[88:91], v[104:107], v[96:99]
  v_cvt_pk_bf16_f32 v80, v80, v81
  v_cvt_pk_bf16_f32 v81, v82, v83
  v_mfma_f32_16x16x32_bf16 v[96:99], a[100:103], v[108:111], v[96:99]
  v_cvt_pk_bf16_f32 v120, v132, v133
  v_cvt_pk_bf16_f32 v121, v134, v135
  v_mfma_f32_16x16x32_bf16 v[96:99], a[112:115], v[116:119], v[96:99]
  v_mul_f32 v84, v94, v84
  v_mul_f32 v85, v94, v85
  v_mfma_f32_16x16x32_bf16 v[96:99], a[124:127], v[112:115], v[96:99]
  v_mul_f32 v86, v94, v86
  v_mul_f32 v87, v94, v87
  v_mfma_f32_16x16x32_bf16 v[96:99], a[136:139], a[244:247], v[96:99]
  v_cvt_pk_bf16_f32 v84, v84, v85
  v_cvt_pk_bf16_f32 v85, v86, v87
  v_mfma_f32_16x16x32_bf16 v[132:135], a[140:143], a[244:247], 0
  v_max3_f32 v9, v92, v94, v9
  v_mfma_f32_16x16x32_bf16 v[132:135], a[128:131], v[112:115], v[132:135]
  ds_write_b32 v5, v88 offset:768
  v_mfma_f32_16x16x32_bf16 v[132:135], a[116:119], v[116:119], v[132:135]
  v_cvt_pk_bf16_f32 v122, v96, v97
  v_cvt_pk_bf16_f32 v123, v98, v99
  v_mfma_f32_16x16x32_bf16 v[132:135], a[104:107], v[108:111], v[132:135]
  ds_write_b32 v5, v89 offset:1792
  v_mfma_f32_16x16x32_bf16 v[132:135], a[92:95], v[104:107], v[132:135]
  v_mfma_f32_16x16x32_bf16 v[132:135], a[80:83], a[252:255], v[132:135]
  ds_write_b32 v5, v80 offset:2816
  v_mfma_f32_16x16x32_bf16 v[128:131], a[252:255], a[144:147], 0
  v_mfma_f32_16x16x32_bf16 v[128:131], v[104:107], a[156:159], v[128:131]
  ds_read_b128 v[88:91], v0 offset:4096
  v_mfma_f32_16x16x32_bf16 v[128:131], v[108:111], a[168:171], v[128:131]
  v_cvt_pk_bf16_f32 v124, v132, v133
  v_cvt_pk_bf16_f32 v125, v134, v135
  v_mfma_f32_16x16x32_bf16 v[128:131], v[116:119], a[180:183], v[128:131]
  ds_read_b128 v[92:95], v1 offset:4096
  v_mfma_f32_16x16x32_bf16 v[128:131], v[112:115], a[192:195], v[128:131]
  s_add_u32 m0, s30, 20224
  ds_read_b128 v[96:99], v0 offset:12288
  v_mfma_f32_16x16x32_bf16 v[128:131], a[244:247], a[204:207], v[128:131]
  buffer_load_dwordx4 v6, s[8:11], s32 offen offset:256 nt lds
  v_mfma_f32_16x16x32_bf16 v[132:135], a[244:247], a[208:211], 0
  s_add_u32 s32, s32, s43
  ds_read_b128 v[136:139], v1 offset:12288
  v_mfma_f32_16x16x32_bf16 v[132:135], v[112:115], a[196:199], v[132:135]
  s_mov_b32 s30, s5
  ds_read_b128 v[140:143], v0 offset:20480
  v_mfma_f32_16x16x32_bf16 v[132:135], v[116:119], a[184:187], v[132:135]
  v_cvt_pk_bf16_f32 v58, v128, v129
  v_cvt_pk_bf16_f32 v59, v130, v131
  v_mfma_f32_16x16x32_bf16 v[132:135], v[108:111], a[172:175], v[132:135]
  ds_write_b32 v5, v81 offset:3840
  v_mfma_f32_16x16x32_bf16 v[132:135], v[104:107], a[160:163], v[132:135]
  v_mfma_f32_16x16x32_bf16 v[132:135], a[252:255], a[148:151], v[132:135]
  ds_write_b32 v5, v84 offset:4864
  v_mfma_f32_16x16x32_bf16 v[128:131], a[252:255], a[152:155], 0
  v_mfma_f32_16x16x32_bf16 v[128:131], v[104:107], a[164:167], v[128:131]
  ds_write_b32 v5, v85 offset:5888
  v_mfma_f32_16x16x32_bf16 v[128:131], v[108:111], a[176:179], v[128:131]
  v_cvt_pk_bf16_f32 v62, v132, v133
  v_cvt_pk_bf16_f32 v63, v134, v135
  v_mfma_f32_16x16x32_bf16 v[128:131], v[116:119], a[188:191], v[128:131]
  s_waitcnt lgkmcnt(3)
  ds_read_b128 v[80:83], v1 offset:20480
  v_xor_b32 v5, s41, v5
  v_mfma_f32_16x16x32_bf16 v[128:131], v[112:115], a[200:203], v[128:131]
  s_bitcmp1_b32 s96, s59
  v_mfma_f32_16x16x32_bf16 v[128:131], a[244:247], a[212:215], v[128:131]
  s_cbranch_scc0 L_loop
L_epi:
  s_cmp_lg_u32 s59, s97
  s_cbranch_scc1 L_k2
L_full:
  v_mfma_f32_16x16x32_bf16 v[104:107], a[76:79], v[88:91], 0
  s_lshl_b32 s5, s3, 3
  v_mfma_f32_16x16x32_bf16 v[104:107], a[88:91], v[92:95], v[104:107]
  s_add_u32 s5, s5, 159744
  v_mov_b32 v11, s5
  v_mfma_f32_16x16x32_bf16 v[104:107], a[100:103], v[96:99], v[104:107]
  v_cvt_pk_bf16_f32 v66, v128, v129
  v_cvt_pk_bf16_f32 v67, v130, v131
  v_mfma_f32_16x16x32_bf16 v[104:107], a[112:115], v[136:139], v[104:107]
  ds_read_b128 v[160:163], v1 offset:22528
  v_mfma_f32_16x16x32_bf16 v[104:107], a[124:127], v[140:143], v[104:107]
  ds_read_b128 v[164:167], v0 offset:22528
  s_waitcnt lgkmcnt(2)
  v_mfma_f32_16x16x32_bf16 v[104:107], a[136:139], v[80:83], v[104:107]
  ds_read_b128 a[244:247], v1 offset:14336
  v_mfma_f32_16x16x32_bf16 v[108:111], a[132:135], v[80:83], 0
  ds_read_b128 a[252:255], v0 offset:14336
  v_mfma_f32_16x16x32_bf16 v[108:111], a[120:123], v[140:143], v[108:111]
  ds_read_b128 a[248:251], v1 offset:6144
  v_mfma_f32_16x16x32_bf16 v[108:111], a[108:111], v[136:139], v[108:111]
  v_cvt_pk_bf16_f32 v146, v104, v105
  v_cvt_pk_bf16_f32 v147, v106, v107
  v_mfma_f32_16x16x32_bf16 v[108:111], a[96:99], v[96:99], v[108:111]
  ds_read_b128 v[84:87], v0 offset:6144
  v_mfma_f32_16x16x32_bf16 v[108:111], a[84:87], v[92:95], v[108:111]
  v_mfma_f32_16x16x32_bf16 v[108:111], a[72:75], v[88:91], v[108:111]
  v_mfma_f32_16x16x32_bf16 v[112:115], a[140:143], v[80:83], 0
  v_mfma_f32_16x16x32_bf16 v[112:115], a[128:131], v[140:143], v[112:115]
  v_mfma_f32_16x16x32_bf16 v[112:115], a[116:119], v[136:139], v[112:115]
  v_cvt_pk_bf16_f32 v144, v108, v109
  v_cvt_pk_bf16_f32 v145, v110, v111
  v_mfma_f32_16x16x32_bf16 v[112:115], a[104:107], v[96:99], v[112:115]
L_hop_1_1:
  s_cbranch_execz L_hop_1_2
  v_mfma_f32_16x16x32_bf16 v[112:115], a[92:95], v[92:95], v[112:115]
  v_mfma_f32_16x16x32_bf16 v[112:115], a[80:83], v[88:91], v[112:115]
  s_waitcnt lgkmcnt(0)
  v_mfma_f32_16x16x32_bf16 v[104:107], a[132:135], v[160:163], 0
  v_mfma_f32_16x16x32_bf16 v[104:107], a[120:123], v[164:167], v[104:107]
  v_mfma_f32_16x16x32_bf16 v[104:107], a[108:111], a[244:247], v[104:107]
  v_cvt_pk_bf16_f32 v148, v112, v113
  v_cvt_pk_bf16_f32 v149, v114, v115
  v_mfma_f32_16x16x32_bf16 v[104:107], a[96:99], a[252:255], v[104:107]
  v_mfma_f32_16x16x32_bf16 v[104:107], a[84:87], a[248:251], v[104:107]
  s_waitcnt lgkmcnt(0)
  s_barrier
  v_mfma_f32_16x16x32_bf16 v[104:107], a[72:75], v[84:87], v[104:107]
  v_mfma_f32_16x16x32_bf16 v[108:111], a[76:79], v[84:87], 0
  v_mfma_f32_16x16x32_bf16 v[108:111], a[88:91], a[248:251], v[108:111]
  v_mfma_f32_16x16x32_bf16 v[108:111], a[100:103], a[252:255], v[108:111]
  v_cvt_pk_bf16_f32 v150, v104, v105
  v_cvt_pk_bf16_f32 v151, v106, v107
  v_mfma_f32_16x16x32_bf16 v[108:111], a[112:115], a[244:247], v[108:111]
  v_mfma_f32_16x16x32_bf16 v[108:111], a[124:127], v[164:167], v[108:111]
  v_mfma_f32_16x16x32_bf16 v[108:111], a[136:139], v[160:163], v[108:111]
  v_mfma_f32_16x16x32_bf16 v[104:107], a[140:143], v[160:163], 0
  v_mfma_f32_16x16x32_bf16 v[104:107], a[128:131], v[164:167], v[104:107]
  v_mfma_f32_16x16x32_bf16 v[104:107], a[116:119], a[244:247], v[104:107]
  v_cvt_pk_bf16_f32 v152, v108, v109
  v_cvt_pk_bf16_f32 v153, v110, v111
  v_mfma_f32_16x16x32_bf16 v[104:107], a[104:107], a[252:255], v[104:107]
  v_mfma_f32_16x16x32_bf16 v[104:107], a[92:95], a[248:251], v[104:107]
  v_mfma_f32_16x16x32_bf16 v[104:107], a[80:83], v[84:87], v[104:107]
  v_mfma_f32_16x16x32_bf16 v[112:115], v[70:73], v[76:79], v[36:39]
  v_mfma_f32_16x16x32_bf16 v[112:115], v[68:71], v[12:15], v[112:115]
  v_mfma_f32_16x16x32_bf16 v[116:119], v[122:125], v[76:79], v[32:35]
  v_cvt_pk_bf16_f32 v154, v104, v105
  v_cvt_pk_bf16_f32 v155, v106, v107
  v_mfma_f32_16x16x32_bf16 v[116:119], v[120:123], v[12:15], v[116:119]
  v_mfma_f32_16x16x32_bf16 v[128:131], v[146:149], v[76:79], v[28:31]
  v_exp_f32 v112, v112
  v_mfma_f32_16x16x32_bf16 v[128:131], v[144:147], v[12:15], v[128:131]
  v_exp_f32 v113, v113
  v_mfma_f32_16x16x32_bf16 v[132:135], v[152:155], v[76:79], v[24:27]
  v_exp_f32 v114, v114
  v_mfma_f32_16x16x32_bf16 v[132:135], v[150:153], v[12:15], v[132:135]
  v_exp_f32 v115, v115
  v_mfma_f32_16x16x32_bf16 v[104:107], v[68:71], v[100:103], v[40:43]
  v_exp_f32 v116, v116
  v_mfma_f32_16x16x32_bf16 v[104:107], v[70:73], v[14:17], v[104:107]
  v_exp_f32 v117, v117
  v_mfma_f32_16x16x32_bf16 v[108:111], v[120:123], v[100:103], v[36:39]
  v_exp_f32 v118, v118
  v_mfma_f32_16x16x32_bf16 v[108:111], v[122:125], v[14:17], v[108:111]
  v_exp_f32 v119, v119
  v_mfma_f32_16x16x32_bf16 v[74:77], v[144:147], v[100:103], v[32:35]
  v_exp_f32 v128, v128
  v_mfma_f32_16x16x32_bf16 v[74:77], v[146:149], v[14:17], v[74:77]
  v_exp_f32 v129, v129
  v_mfma_f32_16x16x32_bf16 v[168:171], v[150:153], v[100:103], v[28:31]
  v_exp_f32 v130, v130
  v_mfma_f32_16x16x32_bf16 v[168:171], v[152:155], v[14:17], v[168:171]
  v_exp_f32 v131, v131
  v_mfma_f32_16x16x32_bf16 v[100:103], a[0:3], v[88:91], 0
  v_exp_f32 v132, v132
  v_mfma_f32_16x16x32_bf16 v[100:103], a[12:15], v[92:95], v[100:103]
  v_exp_f32 v133, v133
  v_mfma_f32_16x16x32_bf16 v[100:103], a[24:27], v[96:99], v[100:103]
  v_exp_f32 v134, v134
  v_mfma_f32_16x16x32_bf16 v[100:103], a[36:39], v[136:139], v[100:103]
  v_exp_f32 v135, v135
  v_mfma_f32_16x16x32_bf16 v[100:103], a[48:51], v[140:143], v[100:103]
  v_cvt_pk_bf16_f32 v112, v112, v113
  v_cvt_pk_bf16_f32 v113, v114, v115
  v_mfma_f32_16x16x32_bf16 v[100:103], a[60:63], v[80:83], v[100:103]
  v_cvt_pk_bf16_f32 v114, v116, v117
  v_cvt_pk_bf16_f32 v115, v118, v119
  v_mfma_f32_16x16x32_bf16 v[172:175], a[64:67], v[80:83], 0
  v_cvt_pk_bf16_f32 v116, v128, v129
  v_cvt_pk_bf16_f32 v117, v130, v131
  v_mfma_f32_16x16x32_bf16 v[172:175], a[52:55], v[140:143], v[172:175]
  v_cvt_pk_bf16_f32 v118, v132, v133
  v_cvt_pk_bf16_f32 v119, v134, v135
  v_mfma_f32_16x16x32_bf16 v[172:175], a[40:43], v[136:139], v[172:175]
  v_mul_f32 v100, s42, v100
  v_mul_f32 v101, s42, v101
  v_mfma_f32_16x16x32_bf16 v[172:175], a[28:31], v[96:99], v[172:175]
  v_mul_f32 v102, s42, v102
  v_mul_f32 v103, s42, v103
  v_mfma_f32_16x16x32_bf16 v[172:175], a[16:19], v[92:95], v[172:175]
  v_cvt_pk_bf16_f32 v18, v100, v101
  v_cvt_pk_bf16_f32 v19, v102, v103
  v_mfma_f32_16x16x32_bf16 v[172:175], a[4:7], v[88:91], v[172:175]
  v_exp_f32 v104, v104
  v_mfma_f32_16x16x32_bf16 v[128:131], a[8:11], v[88:91], 0
  v_exp_f32 v105, v105
  v_mfma_f32_16x16x32_bf16 v[128:131], a[20:23], v[92:95], v[128:131]
  v_exp_f32 v106, v106
  v_mfma_f32_16x16x32_bf16 v[128:131], a[32:35], v[96:99], v[128:131]
  v_mul_f32 v172, s42, v172
  v_mul_f32 v173, s42, v173
  v_mfma_f32_16x16x32_bf16 v[128:131], a[44:47], v[136:139], v[128:131]
  v_mul_f32 v174, s42, v174
  v_mul_f32 v175, s42, v175
  v_mfma_f32_16x16x32_bf16 v[128:131], a[56:59], v[140:143], v[128:131]
  v_cvt_pk_bf16_f32 v176, v172, v173
  v_cvt_pk_bf16_f32 v177, v174, v175
  v_mfma_f32_16x16x32_bf16 v[128:131], a[68:71], v[80:83], v[128:131]
  v_exp_f32 v107, v107
  v_mfma_f32_16x16x32_bf16 v[132:135], a[0:3], v[84:87], 0
  v_exp_f32 v108, v108
  v_mfma_f32_16x16x32_bf16 v[132:135], a[12:15], a[248:251], v[132:135]
  v_exp_f32 v109, v109
  v_mfma_f32_16x16x32_bf16 v[132:135], a[24:27], a[252:255], v[132:135]
  v_mul_f32 v128, s42, v128
  v_mul_f32 v129, s42, v129
  v_mfma_f32_16x16x32_bf16 v[132:135], a[36:39], a[244:247], v[132:135]
  v_mul_f32 v130, s42, v130
  v_mul_f32 v131, s42, v131
  v_mfma_f32_16x16x32_bf16 v[132:135], a[48:51], v[164:167], v[132:135]
  v_cvt_pk_bf16_f32 v178, v128, v129
  v_cvt_pk_bf16_f32 v179, v130, v131
  v_mfma_f32_16x16x32_bf16 v[132:135], a[60:63], v[160:163], v[132:135]
  v_exp_f32 v110, v110
  v_mfma_f32_16x16x32_bf16 v[172:175], a[64:67], v[160:163], 0
  v_exp_f32 v111, v111
  v_mfma_f32_16x16x32_bf16 v[172:175], a[52:55], v[164:167], v[172:175]
  v_exp_f32 v74, v74
  v_mfma_f32_16x16x32_bf16 v[172:175], a[40:43], a[244:247], v[172:175]
  v_mul_f32 v132, s42, v132
  v_mul_f32 v133, s42, v133
  v_mfma_f32_16x16x32_bf16 v[172:175], a[28:31], a[252:255], v[172:175]
  v_mul_f32 v134, s42, v134
  v_mul_f32 v135, s42, v135
  v_mfma_f32_16x16x32_bf16 v[172:175], a[16:19], a[248:251], v[172:175]
  v_cvt_pk_bf16_f32 v180, v132, v133
  v_cvt_pk_bf16_f32 v181, v134, v135
  v_mfma_f32_16x16x32_bf16 v[172:175], a[4:7], v[84:87], v[172:175]
  v_exp_f32 v75, v75
  v_mfma_f32_16x16x32_bf16 v[100:103], a[8:11], v[84:87], 0
  v_exp_f32 v76, v76
  v_mfma_f32_16x16x32_bf16 v[100:103], a[20:23], a[248:251], v[100:103]
  v_exp_f32 v77, v77
  v_mfma_f32_16x16x32_bf16 v[100:103], a[32:35], a[252:255], v[100:103]
  v_mul_f32 v172, s42, v172
  v_mul_f32 v173, s42, v173
  v_mfma_f32_16x16x32_bf16 v[100:103], a[44:47], a[244:247], v[100:103]
  v_mul_f32 v174, s42, v174
  v_mul_f32 v175, s42, v175
  v_mfma_f32_16x16x32_bf16 v[100:103], a[56:59], v[164:167], v[100:103]
  v_cvt_pk_bf16_f32 v182, v172, v173
  v_cvt_pk_bf16_f32 v183, v174, v175
  v_mfma_f32_16x16x32_bf16 v[100:103], a[68:71], v[160:163], v[100:103]
  v_exp_f32 v168, v168
  v_mfma_f32_16x16x32_bf16 v[128:131], v[146:149], v[176:179], v[36:39]
  v_exp_f32 v169, v169
  v_mfma_f32_16x16x32_bf16 v[128:131], v[144:147], v[18:21], v[128:131]
  v_exp_f32 v170, v170
  v_mfma_f32_16x16x32_bf16 v[132:135], v[152:155], v[176:179], v[32:35]
  v_mul_f32 v100, s42, v100
  v_mul_f32 v101, s42, v101
  v_mfma_f32_16x16x32_bf16 v[132:135], v[150:153], v[18:21], v[132:135]
  v_mul_f32 v102, s42, v102
  v_mul_f32 v103, s42, v103
  v_mfma_f32_16x16x32_bf16 v[156:159], v[70:73], v[176:179], v[44:47]
  v_cvt_pk_bf16_f32 v22, v100, v101
  v_cvt_pk_bf16_f32 v23, v102, v103
  v_mfma_f32_16x16x32_bf16 v[156:159], v[68:71], v[18:21], v[156:159]
  v_exp_f32 v171, v171
  v_mfma_f32_16x16x32_bf16 v[172:175], v[122:125], v[176:179], v[40:43]
  v_cvt_pk_bf16_f32 v104, v104, v105
  v_cvt_pk_bf16_f32 v105, v106, v107
  v_mfma_f32_16x16x32_bf16 v[172:175], v[120:123], v[18:21], v[172:175]
  v_cvt_pk_bf16_f32 v106, v108, v109
  v_cvt_pk_bf16_f32 v107, v110, v111
  v_mfma_f32_16x16x32_bf16 v[176:179], v[88:91], a[144:147], 0
  v_cvt_pk_bf16_f32 v108, v74, v75
  v_cvt_pk_bf16_f32 v109, v76, v77
  v_mfma_f32_16x16x32_bf16 v[176:179], v[92:95], a[156:159], v[176:179]
  v_cvt_pk_bf16_f32 v110, v168, v169
  v_cvt_pk_bf16_f32 v111, v170, v171
  v_mfma_f32_16x16x32_bf16 v[176:179], v[96:99], a[168:171], v[176:179]
  v_exp_f32 v128, v128
  v_mfma_f32_16x16x32_bf16 v[176:179], v[136:139], a[180:183], v[176:179]
  v_exp_f32 v129, v129
  v_mfma_f32_16x16x32_bf16 v[176:179], v[140:143], a[192:195], v[176:179]
  v_exp_f32 v130, v130
  v_mfma_f32_16x16x32_bf16 v[176:179], v[80:83], a[204:207], v[176:179]
  v_exp_f32 v131, v131
  v_mfma_f32_16x16x32_bf16 v[76:79], v[80:83], a[208:211], 0
  v_exp_f32 v132, v132
  v_mfma_f32_16x16x32_bf16 v[76:79], v[140:143], a[196:199], v[76:79]
  v_exp_f32 v133, v133
  v_mfma_f32_16x16x32_bf16 v[76:79], v[136:139], a[184:187], v[76:79]
  v_cvt_pk_bf16_f32 v100, v176, v177
  v_cvt_pk_bf16_f32 v101, v178, v179
  v_mfma_f32_16x16x32_bf16 v[76:79], v[96:99], a[172:175], v[76:79]
  v_exp_f32 v134, v134
  v_mfma_f32_16x16x32_bf16 v[76:79], v[92:95], a[160:163], v[76:79]
  v_exp_f32 v135, v135
  v_mfma_f32_16x16x32_bf16 v[76:79], v[88:91], a[148:151], v[76:79]
  v_exp_f32 v156, v156
  v_mfma_f32_16x16x32_bf16 v[168:171], v[88:91], a[152:155], 0
  v_exp_f32 v157, v157
  v_mfma_f32_16x16x32_bf16 v[168:171], v[92:95], a[164:167], v[168:171]
  v_exp_f32 v158, v158
  v_mfma_f32_16x16x32_bf16 v[168:171], v[96:99], a[176:179], v[168:171]
  v_cvt_pk_bf16_f32 v88, v76, v77
  v_cvt_pk_bf16_f32 v89, v78, v79
  v_mfma_f32_16x16x32_bf16 v[168:171], v[136:139], a[188:191], v[168:171]
  v_exp_f32 v159, v159
  v_mfma_f32_16x16x32_bf16 v[168:171], v[140:143], a[200:203], v[168:171]
  v_exp_f32 v172, v172
  v_mfma_f32_16x16x32_bf16 v[168:171], v[80:83], a[212:215], v[168:171]
  v_exp_f32 v173, v173
  v_mfma_f32_16x16x32_bf16 v[76:79], v[144:147], v[180:183], v[40:43]
  v_exp_f32 v174, v174
  v_mfma_f32_16x16x32_bf16 v[76:79], v[146:149], v[20:23], v[76:79]
  v_exp_f32 v175, v175
  v_mfma_f32_16x16x32_bf16 v[80:83], v[150:153], v[180:183], v[36:39]
  v_cvt_pk_bf16_f32 v92, v168, v169
  v_cvt_pk_bf16_f32 v93, v170, v171
  v_mfma_f32_16x16x32_bf16 v[80:83], v[152:155], v[20:23], v[80:83]
  v_cvt_pk_bf16_f32 v128, v128, v129
  v_cvt_pk_bf16_f32 v129, v130, v131
  v_mfma_f32_16x16x32_bf16 v[144:147], v[68:71], v[180:183], v[48:51]
  v_cvt_pk_bf16_f32 v130, v132, v133
  v_cvt_pk_bf16_f32 v131, v134, v135
  v_mfma_f32_16x16x32_bf16 v[144:147], v[70:73], v[20:23], v[144:147]
  v_cvt_pk_bf16_f32 v132, v156, v157
  v_cvt_pk_bf16_f32 v133, v158, v159
  v_mfma_f32_16x16x32_bf16 v[152:155], v[120:123], v[180:183], v[44:47]
  v_cvt_pk_bf16_f32 v134, v172, v173
  v_cvt_pk_bf16_f32 v135, v174, v175
  v_mfma_f32_16x16x32_bf16 v[152:155], v[122:125], v[20:23], v[152:155]
  v_exp_f32 v76, v76
  v_mfma_f32_16x16x32_bf16 v[140:143], v[84:87], a[144:147], 0
  v_exp_f32 v77, v77
  v_mfma_f32_16x16x32_bf16 v[140:143], a[248:251], a[156:159], v[140:143]
  v_exp_f32 v78, v78
  v_mfma_f32_16x16x32_bf16 v[140:143], a[252:255], a[168:171], v[140:143]
  ds_read_b128 v[68:71], v3 offset:0
  v_cvt_pk_bf16_f32 v76, v76, v77
  v_mfma_f32_16x16x32_bf16 v[140:143], a[244:247], a[180:183], v[140:143]
  ds_read_b128 v[72:75], v3 offset:4096
  v_mfma_f32_16x16x32_bf16 v[140:143], v[164:167], a[192:195], v[140:143]
  ds_read_b128 v[96:99], v3 offset:8192
  v_mfma_f32_16x16x32_bf16 v[140:143], v[160:163], a[204:207], v[140:143]
  ds_read_b128 v[120:123], v3 offset:12288
  v_mfma_f32_16x16x32_bf16 v[148:151], v[160:163], a[208:211], 0
  ds_read_b128 v[124:127], v3 offset:16384
  v_mfma_f32_16x16x32_bf16 v[148:151], v[164:167], a[196:199], v[148:151]
  ds_read_b128 v[136:139], v3 offset:20480
  v_mfma_f32_16x16x32_bf16 v[148:151], a[244:247], a[184:187], v[148:151]
  v_cvt_pk_bf16_f32 v102, v140, v141
  v_cvt_pk_bf16_f32 v103, v142, v143
  v_mfma_f32_16x16x32_bf16 v[148:151], a[252:255], a[172:175], v[148:151]
  v_exp_f32 v79, v79
  v_mfma_f32_16x16x32_bf16 v[148:151], a[248:251], a[160:163], v[148:151]
  v_exp_f32 v80, v80
  v_mfma_f32_16x16x32_bf16 v[148:151], v[84:87], a[148:151], v[148:151]
  v_exp_f32 v81, v81
  v_mfma_f32_16x16x32_bf16 v[156:159], v[84:87], a[152:155], 0
  v_exp_f32 v82, v82
  v_mfma_f32_16x16x32_bf16 v[156:159], a[248:251], a[164:167], v[156:159]
  v_exp_f32 v83, v83
  v_mfma_f32_16x16x32_bf16 v[156:159], a[252:255], a[176:179], v[156:159]
  v_cvt_pk_bf16_f32 v90, v148, v149
  v_cvt_pk_bf16_f32 v91, v150, v151
  v_mfma_f32_16x16x32_bf16 v[156:159], a[244:247], a[188:191], v[156:159]
  v_mov_b64 v[168:169], 0
  v_cvt_pk_bf16_f32 v77, v78, v79
  v_mfma_f32_16x16x32_bf16 v[156:159], v[164:167], a[200:203], v[156:159]
  v_exp_f32 v144, v144
  v_mfma_f32_16x16x32_bf16 v[156:159], v[160:163], a[212:215], v[156:159]
  s_waitcnt lgkmcnt(0)
  v_exp_f32 v145, v145
  v_mfma_f32_16x16x32_bf16 v[140:143], v[68:71], v[184:187], 0
  v_exp_f32 v146, v146
  v_mfma_f32_16x16x32_bf16 v[140:143], v[72:75], v[200:203], v[140:143]
  v_exp_f32 v147, v147
  v_mfma_f32_16x16x32_bf16 v[140:143], v[96:99], v[216:219], v[140:143]
  v_cvt_pk_bf16_f32 v94, v156, v157
  v_cvt_pk_bf16_f32 v95, v158, v159
  v_mfma_f32_16x16x32_bf16 v[140:143], v[120:123], v[232:235], v[140:143]
  v_mov_b64 v[148:149], 0
  v_cvt_pk_bf16_f32 v78, v80, v81
  v_mfma_f32_16x16x32_bf16 v[140:143], v[124:127], v[248:251], v[140:143]
  v_exp_f32 v152, v152
  v_mfma_f32_16x16x32_bf16 v[140:143], v[136:139], a[224:227], v[140:143]
  v_exp_f32 v153, v153
  v_smfmac_f32_16x16x64_bf16 v[168:171], a[240:243], v[112:119], v10
  v_exp_f32 v154, v154
  v_mfma_f32_16x16x32_bf16 v[156:159], v[100:103], v[116:119], 0
  v_exp_f32 v155, v155
  v_mfma_f32_16x16x32_bf16 v[156:159], v[56:59], v[112:115], v[156:159]
  v_cvt_pk_bf16_f32 v79, v82, v83
  v_cvt_pk_bf16_f32 v80, v144, v145
  v_mfma_f32_16x16x32_bf16 v[160:163], v[60:63], v[112:115], 0
  v_cvt_pk_bf16_f32 v81, v146, v147
  v_cvt_pk_bf16_f32 v82, v152, v153
  v_mfma_f32_16x16x32_bf16 v[160:163], v[88:91], v[116:119], v[160:163]
  v_cvt_pk_bf16_f32 v83, v154, v155
  v_mfma_f32_16x16x32_bf16 v[164:167], v[92:95], v[116:119], 0
  v_add_f32 v168, v168, v169
  v_rcp_f32 v170, v168
  v_mfma_f32_16x16x32_bf16 v[164:167], v[64:67], v[112:115], v[164:167]
  v_max3_f32 v9, v168, v170, v9
  v_mul_f32 v156, v170, v156
  v_mul_f32 v157, v170, v157
  v_smfmac_f32_16x16x64_bf16 v[148:151], a[240:243], v[104:111], v10
  v_mul_f32 v158, v170, v158
  v_mul_f32 v159, v170, v159
  v_cvt_pk_bf16_f32 v156, v156, v157
  v_mfma_f32_16x16x32_bf16 v[144:147], v[100:103], v[108:111], 0
  v_cvt_pk_bf16_f32 v157, v158, v159
  v_mul_f32 v160, v170, v160
  v_mul_f32 v161, v170, v161
  v_mfma_f32_16x16x32_bf16 v[144:147], v[56:59], v[104:107], v[144:147]
  v_mul_f32 v162, v170, v162
  v_mul_f32 v163, v170, v163
  v_cvt_pk_bf16_f32 v160, v160, v161
  v_mfma_f32_16x16x32_bf16 v[112:115], v[60:63], v[104:107], 0
  v_cvt_pk_bf16_f32 v161, v162, v163
  v_mul_f32 v164, v170, v164
  v_mul_f32 v165, v170, v165
  v_mfma_f32_16x16x32_bf16 v[112:115], v[88:91], v[108:111], v[112:115]
  v_mul_f32 v166, v170, v166
  v_mul_f32 v167, v170, v167
  v_cvt_pk_bf16_f32 v164, v164, v165
  v_mfma_f32_16x16x32_bf16 v[84:87], v[92:95], v[108:111], 0
  v_add_f32 v148, v148, v149
  v_rcp_f32 v150, v148
  v_mfma_f32_16x16x32_bf16 v[84:87], v[64:67], v[104:107], v[84:87]
  v_cvt_pk_bf16_f32 v165, v166, v167
  v_max3_f32 v9, v148, v150, v9
  v_mul_f32 v144, v150, v144
  v_mfma_f32_16x16x32_bf16 v[104:107], v[136:139], a[228:231], 0
  v_mul_f32 v145, v150, v145
  v_mul_f32 v146, v150, v146
  v_mul_f32 v147, v150, v147
  v_mfma_f32_16x16x32_bf16 v[104:107], v[124:127], v[252:255], v[104:107]
  v_cvt_pk_bf16_f32 v144, v144, v145
  v_cvt_pk_bf16_f32 v145, v146, v147
  v_mul_f32 v112, v150, v112
  v_mfma_f32_16x16x32_bf16 v[104:107], v[120:123], v[236:239], v[104:107]
  v_mov_b64 v[172:173], 0
  v_mul_f32 v113, v150, v113
  v_mul_f32 v114, v150, v114
  v_mfma_f32_16x16x32_bf16 v[104:107], v[96:99], v[220:223], v[104:107]
  v_mul_f32 v115, v150, v115
  v_cvt_pk_bf16_f32 v112, v112, v113
  v_cvt_pk_bf16_f32 v113, v114, v115
  v_mfma_f32_16x16x32_bf16 v[104:107], v[72:75], v[204:207], v[104:107]
  v_mul_f32 v84, v150, v84
  v_mul_f32 v85, v150, v85
  v_mul_f32 v86, v150, v86
  v_mfma_f32_16x16x32_bf16 v[104:107], v[68:71], v[188:191], v[104:107]
  v_mul_f32 v87, v150, v87
  v_cvt_pk_bf16_f32 v84, v84, v85
  v_cvt_pk_bf16_f32 v85, v86, v87
  v_mfma_f32_16x16x32_bf16 v[152:155], v[68:71], v[192:195], 0
  ds_write2st64_b32 v5, v156, v157 offset0:0 offset1:4
  v_mfma_f32_16x16x32_bf16 v[152:155], v[72:75], v[208:211], v[152:155]
  ds_write2st64_b32 v5, v160, v161 offset0:8 offset1:12
  v_mfma_f32_16x16x32_bf16 v[152:155], v[96:99], v[224:227], v[152:155]
  v_cvt_pk_bf16_f32 v140, v140, v104
  v_cvt_pk_bf16_f32 v141, v141, v105
  v_mfma_f32_16x16x32_bf16 v[152:155], v[120:123], v[240:243], v[152:155]
  ds_read_b128 a[248:251], v4 offset:0
  v_cvt_pk_bf16_f32 v142, v142, v106
  v_cvt_pk_bf16_f32 v143, v143, v107
  v_mfma_f32_16x16x32_bf16 v[152:155], v[124:127], a[216:219], v[152:155]
  buffer_store_dword v140, v7, s[24:27], s33 offen offset:0 nt
  v_mfma_f32_16x16x32_bf16 v[152:155], v[136:139], a[232:235], v[152:155]
  ds_read_b128 v[148:151], v4 offset:4096
  ds_read_b128 v[156:159], v4 offset:8192
  v_smfmac_f32_16x16x64_bf16 v[172:175], a[240:243], v[128:135], v10
  ds_read_b128 v[160:163], v4 offset:12288
  ds_read_b128 v[168:171], v4 offset:16384
  v_mfma_f32_16x16x32_bf16 v[108:111], v[56:59], v[132:135], 0
  buffer_store_dword v141, v7, s[24:27], s33 offen offset:384 nt
  v_mfma_f32_16x16x32_bf16 v[108:111], v[100:103], v[128:131], v[108:111]
  ds_read_b128 v[176:179], v4 offset:20480
  v_mfma_f32_16x16x32_bf16 v[116:119], v[88:91], v[128:131], 0
  ds_write2st64_b32 v5, v164, v165 offset0:16 offset1:20
  v_mfma_f32_16x16x32_bf16 v[116:119], v[60:63], v[132:135], v[116:119]
  buffer_store_dword v142, v7, s[24:27], s33 offen offset:768 nt
  v_mfma_f32_16x16x32_bf16 v[104:107], v[64:67], v[132:135], 0
  v_add_f32 v172, v172, v173
  v_rcp_f32 v174, v172
  v_mfma_f32_16x16x32_bf16 v[104:107], v[92:95], v[128:131], v[104:107]
  v_max3_f32 v9, v172, v174, v9
  v_mul_f32 v108, v174, v108
  v_mul_f32 v109, v174, v109
  v_mfma_f32_16x16x32_bf16 v[132:135], v[136:139], a[236:239], 0
  buffer_store_dword v143, v7, s[24:27], s33 offen offset:1152 nt
  v_mul_f32 v110, v174, v110
  v_mfma_f32_16x16x32_bf16 v[132:135], v[124:127], a[220:223], v[132:135]
  v_mul_f32 v111, v174, v111
  v_cvt_pk_bf16_f32 v108, v108, v109
  v_cvt_pk_bf16_f32 v109, v110, v111
  v_mfma_f32_16x16x32_bf16 v[132:135], v[120:123], v[244:247], v[132:135]
  v_mov_b64 v[128:129], 0
  v_mul_f32 v116, v174, v116
  v_mul_f32 v117, v174, v117
  v_mfma_f32_16x16x32_bf16 v[132:135], v[96:99], v[228:231], v[132:135]
  v_mul_f32 v118, v174, v118
  v_mul_f32 v119, v174, v119
  v_cvt_pk_bf16_f32 v116, v116, v117
  v_mfma_f32_16x16x32_bf16 v[132:135], v[72:75], v[212:215], v[132:135]
  v_cvt_pk_bf16_f32 v117, v118, v119
  v_mul_f32 v104, v174, v104
  v_mul_f32 v105, v174, v105
  v_mfma_f32_16x16x32_bf16 v[132:135], v[68:71], v[196:199], v[132:135]
  s_waitcnt lgkmcnt(1)
  v_mul_f32 v106, v174, v106
  v_mul_f32 v107, v174, v107
  v_cvt_pk_bf16_f32 v104, v104, v105
  v_mfma_f32_16x16x32_bf16 v[96:99], a[248:251], v[184:187], 0
  v_cvt_pk_bf16_f32 v105, v106, v107
  v_mfma_f32_16x16x32_bf16 v[96:99], v[148:151], v[200:203], v[96:99]
  ds_write2st64_b32 v5, v144, v145 offset0:1 offset1:5
  v_mfma_f32_16x16x32_bf16 v[96:99], v[156:159], v[216:219], v[96:99]
  v_cvt_pk_bf16_f32 v152, v152, v132
  v_cvt_pk_bf16_f32 v153, v153, v133
  v_mfma_f32_16x16x32_bf16 v[96:99], v[160:163], v[232:235], v[96:99]
  ds_read_b128 a[244:247], v3 offset:512
  v_cvt_pk_bf16_f32 v154, v154, v134
  v_cvt_pk_bf16_f32 v155, v155, v135
  v_mfma_f32_16x16x32_bf16 v[96:99], v[168:171], v[248:251], v[96:99]
  buffer_store_dword v152, v8, s[24:27], s33 offen offset:0 nt
  v_mfma_f32_16x16x32_bf16 v[96:99], v[176:179], a[224:227], v[96:99]
  ds_read_b128 a[252:255], v3 offset:4608
  ds_read_b128 v[68:71], v3 offset:8704
  v_smfmac_f32_16x16x64_bf16 v[128:131], a[240:243], v[76:83], v10
  ds_read_b128 v[72:75], v3 offset:12800
  ds_read_b128 v[120:123], v3 offset:16896
  v_mfma_f32_16x16x32_bf16 v[132:135], v[56:59], v[80:83], 0
  buffer_store_dword v153, v8, s[24:27], s33 offen offset:384 nt
  v_mfma_f32_16x16x32_bf16 v[132:135], v[100:103], v[76:79], v[132:135]
  ds_read_b128 v[124:127], v3 offset:20992
  v_xor_b32 v3, 40960, v3
  v_mfma_f32_16x16x32_bf16 v[136:139], v[88:91], v[76:79], 0
  ds_write2st64_b32 v5, v112, v113 offset0:9 offset1:13
  v_mfma_f32_16x16x32_bf16 v[136:139], v[60:63], v[80:83], v[136:139]
  buffer_store_dword v154, v8, s[24:27], s33 offen offset:768 nt
  v_mfma_f32_16x16x32_bf16 v[56:59], v[64:67], v[80:83], 0
  v_add_f32 v128, v128, v129
  v_rcp_f32 v130, v128
  v_mfma_f32_16x16x32_bf16 v[56:59], v[92:95], v[76:79], v[56:59]
  v_max3_f32 v9, v128, v130, v9
  v_mul_f32 v132, v130, v132
  v_mul_f32 v133, v130, v133
  v_mfma_f32_16x16x32_bf16 v[60:63], v[176:179], a[228:231], 0
  buffer_store_dword v155, v8, s[24:27], s33 offen offset:1152 nt
  v_mul_f32 v134, v130, v134
  v_mfma_f32_16x16x32_bf16 v[60:63], v[168:171], v[252:255], v[60:63]
  s_add_u32 s33, s33, s98
  v_mul_f32 v135, v130, v135
  v_cvt_pk_bf16_f32 v132, v132, v133
  v_cvt_pk_bf16_f32 v133, v134, v135
  v_mfma_f32_16x16x32_bf16 v[60:63], v[160:163], v[236:239], v[60:63]
  v_mul_f32 v136, v130, v136
  v_mul_f32 v137, v130, v137
  v_mul_f32 v138, v130, v138
  v_mfma_f32_16x16x32_bf16 v[60:63], v[156:159], v[220:223], v[60:63]
  v_mul_f32 v139, v130, v139
  v_cvt_pk_bf16_f32 v136, v136, v137
  v_cvt_pk_bf16_f32 v137, v138, v139
  v_mfma_f32_16x16x32_bf16 v[60:63], v[148:151], v[204:207], v[60:63]
  v_mul_f32 v56, v130, v56
  v_mul_f32 v57, v130, v57
  v_mul_f32 v58, v130, v58
  v_mfma_f32_16x16x32_bf16 v[60:63], a[248:251], v[188:191], v[60:63]
  s_waitcnt lgkmcnt(1)
  v_mul_f32 v59, v130, v59
  v_cvt_pk_bf16_f32 v56, v56, v57
  v_cvt_pk_bf16_f32 v57, v58, v59
  v_mfma_f32_16x16x32_bf16 v[76:79], a[244:247], v[184:187], 0
  v_cmp_nge_f32 vcc, 0x53800000, v9
  v_mfma_f32_16x16x32_bf16 v[76:79], a[252:255], v[200:203], v[76:79]
  ds_write2st64_b32 v5, v84, v85 offset0:17 offset1:21
  v_mfma_f32_16x16x32_bf16 v[76:79], v[68:71], v[216:219], v[76:79]
  s_or_b32 s6, vcc_lo, vcc_hi
  v_cvt_pk_bf16_f32 v96, v96, v60
  v_cvt_pk_bf16_f32 v97, v97, v61
  v_mov_b32 v54, s6
  v_mfma_f32_16x16x32_bf16 v[76:79], v[72:75], v[232:235], v[76:79]
  v_cvt_pk_bf16_f32 v98, v98, v62
  v_cvt_pk_bf16_f32 v99, v99, v63
  v_mfma_f32_16x16x32_bf16 v[76:79], v[120:123], v[248:251], v[76:79]
  buffer_store_dword v96, v7, s[24:27], s34 offen offset:0 nt
  v_mfma_f32_16x16x32_bf16 v[76:79], v[124:127], a[224:227], v[76:79]
  ds_write2st64_b32 v5, v108, v109 offset0:2 offset1:6
  v_mfma_f32_16x16x32_bf16 v[80:83], v[124:127], a[228:231], 0
  ds_write2st64_b32 v5, v116, v117 offset0:10 offset1:14
  v_mfma_f32_16x16x32_bf16 v[80:83], v[120:123], v[252:255], v[80:83]
  buffer_store_dword v97, v7, s[24:27], s34 offen offset:384 nt
  v_mfma_f32_16x16x32_bf16 v[80:83], v[72:75], v[236:239], v[80:83]
  ds_read_b128 a[248:251], v4 offset:512
  ds_read_b128 v[60:63], v4 offset:4608
  v_mfma_f32_16x16x32_bf16 v[80:83], v[68:71], v[220:223], v[80:83]
  ds_write2st64_b32 v5, v104, v105 offset0:18 offset1:22
  v_mfma_f32_16x16x32_bf16 v[80:83], a[252:255], v[204:207], v[80:83]
  buffer_store_dword v98, v7, s[24:27], s34 offen offset:768 nt
  v_mfma_f32_16x16x32_bf16 v[80:83], a[244:247], v[188:191], v[80:83]
  ds_write2st64_b32 v5, v132, v133 offset0:3 offset1:7
  v_mfma_f32_16x16x32_bf16 v[64:67], a[244:247], v[192:195], 0
  ds_write2st64_b32 v5, v136, v137 offset0:11 offset1:15
  v_mfma_f32_16x16x32_bf16 v[64:67], a[252:255], v[208:211], v[64:67]
  buffer_store_dword v99, v7, s[24:27], s34 offen offset:1152 nt
  v_mfma_f32_16x16x32_bf16 v[64:67], v[68:71], v[224:227], v[64:67]
  s_add_u32 s34, s34, s98
  ds_read_b128 v[84:87], v4 offset:8704
  v_cvt_pk_bf16_f32 v76, v76, v80
  v_cvt_pk_bf16_f32 v77, v77, v81
  v_mfma_f32_16x16x32_bf16 v[64:67], v[72:75], v[240:243], v[64:67]
  ds_read_b128 v[92:95], v4 offset:12800
  v_cvt_pk_bf16_f32 v78, v78, v82
  v_cvt_pk_bf16_f32 v79, v79, v83
  v_mfma_f32_16x16x32_bf16 v[64:67], v[120:123], a[216:219], v[64:67]
  buffer_store_dword v76, v7, s[24:27], s35 offen offset:0 nt
  v_mfma_f32_16x16x32_bf16 v[64:67], v[124:127], a[232:235], v[64:67]
  ds_write2st64_b32 v5, v56, v57 offset0:19 offset1:23
  v_mfma_f32_16x16x32_bf16 v[96:99], v[124:127], a[236:239], 0
  ds_read_b128 v[88:91], v4 offset:16896
  ds_write_b32 v11, v54
  v_mfma_f32_16x16x32_bf16 v[96:99], v[120:123], a[220:223], v[96:99]
  buffer_store_dword v77, v7, s[24:27], s35 offen offset:384 nt
  v_mov_b32 v11, 159744
  v_mfma_f32_16x16x32_bf16 v[96:99], v[72:75], v[244:247], v[96:99]
  ds_read_b128 v[100:103], v4 offset:20992
  v_xor_b32 v4, 40960, v4
  v_mfma_f32_16x16x32_bf16 v[96:99], v[68:71], v[228:231], v[96:99]
  v_mfma_f32_16x16x32_bf16 v[96:99], a[252:255], v[212:215], v[96:99]
  buffer_store_dword v78, v7, s[24:27], s35 offen offset:768 nt
  v_mfma_f32_16x16x32_bf16 v[96:99], a[244:247], v[196:199], v[96:99]
  s_waitcnt lgkmcnt(9)
  v_mfma_f32_16x16x32_bf16 v[80:83], a[248:251], v[184:187], 0
  s_waitcnt lgkmcnt(1)
  s_barrier
  v_mfma_f32_16x16x32_bf16 v[80:83], v[60:63], v[200:203], v[80:83]
  buffer_store_dword v79, v7, s[24:27], s35 offen offset:1152 nt
  v_mfma_f32_16x16x32_bf16 v[80:83], v[84:87], v[216:219], v[80:83]
  s_waitcnt lgkmcnt(0)
  v_cvt_pk_bf16_f32 v64, v64, v96
  v_cvt_pk_bf16_f32 v65, v65, v97
  v_mfma_f32_16x16x32_bf16 v[80:83], v[92:95], v[232:235], v[80:83]
  v_cvt_pk_bf16_f32 v66, v66, v98
  v_cvt_pk_bf16_f32 v67, v67, v99
  v_mfma_f32_16x16x32_bf16 v[80:83], v[88:91], v[248:251], v[80:83]
  buffer_store_dword v64, v8, s[24:27], s35 offen offset:0 nt
  v_mfma_f32_16x16x32_bf16 v[80:83], v[100:103], a[224:227], v[80:83]
  ds_read_b128 a[252:255], v3 offset:0
  ds_read_b128 v[56:59], v3 offset:4096
  v_mfma_f32_16x16x32_bf16 v[76:79], v[100:103], a[228:231], 0
  ds_read_b128 v[68:71], v3 offset:8192
  ds_read_b128 v[72:75], v3 offset:12288
  v_mfma_f32_16x16x32_bf16 v[76:79], v[88:91], v[252:255], v[76:79]
  buffer_store_dword v65, v8, s[24:27], s35 offen offset:384 nt
  v_mfma_f32_16x16x32_bf16 v[76:79], v[92:95], v[236:239], v[76:79]
  ds_read_b128 a[244:247], v3 offset:16384
  ds_read_b128 v[88:91], v3 offset:20480
  v_mfma_f32_16x16x32_bf16 v[76:79], v[84:87], v[220:223], v[76:79]
  ds_read2_b32 v[92:93], v11 offset0:0 offset1:2
  ds_read2_b32 v[94:95], v11 offset0:4 offset1:6
  v_mfma_f32_16x16x32_bf16 v[76:79], v[60:63], v[204:207], v[76:79]
  buffer_store_dword v66, v8, s[24:27], s35 offen offset:768 nt
  v_mfma_f32_16x16x32_bf16 v[76:79], a[248:251], v[188:191], v[76:79]
  s_waitcnt lgkmcnt(4)
  v_mfma_f32_16x16x32_bf16 v[60:63], a[252:255], v[184:187], 0
  buffer_store_dword v67, v8, s[24:27], s35 offen offset:1152 nt
  v_mfma_f32_16x16x32_bf16 v[60:63], v[56:59], v[200:203], v[60:63]
  s_add_u32 s35, s35, s98
  v_mfma_f32_16x16x32_bf16 v[60:63], v[68:71], v[216:219], v[60:63]
  s_waitcnt lgkmcnt(0)
  v_cvt_pk_bf16_f32 v80, v80, v76
  v_cvt_pk_bf16_f32 v81, v81, v77
  v_mfma_f32_16x16x32_bf16 v[60:63], v[72:75], v[232:235], v[60:63]
  v_cvt_pk_bf16_f32 v82, v82, v78
  v_cvt_pk_bf16_f32 v83, v83, v79
  v_mfma_f32_16x16x32_bf16 v[60:63], a[244:247], v[248:251], v[60:63]
  buffer_store_dword v80, v7, s[24:27], s36 offen offset:0 nt
  v_mfma_f32_16x16x32_bf16 v[60:63], v[88:91], a[224:227], v[60:63]
  v_or3_b32 v92, v92, v93, v94
  v_or_b32 v92, v92, v95
  v_mfma_f32_16x16x32_bf16 v[64:67], v[88:91], a[228:231], 0
  buffer_store_dword v81, v7, s[24:27], s36 offen offset:384 nt
  v_mfma_f32_16x16x32_bf16 v[64:67], a[244:247], v[252:255], v[64:67]
  v_readfirstlane_b32 s49, v92
  v_mfma_f32_16x16x32_bf16 v[64:67], v[72:75], v[236:239], v[64:67]
  buffer_store_dword v82, v7, s[24:27], s36 offen offset:768 nt
  v_mfma_f32_16x16x32_bf16 v[64:67], v[68:71], v[220:223], v[64:67]
  ds_read_b128 v[76:79], v4 offset:0
  ds_read_b128 v[84:87], v4 offset:4096
  v_mfma_f32_16x16x32_bf16 v[64:67], v[56:59], v[204:207], v[64:67]
  buffer_store_dword v83, v7, s[24:27], s36 offen offset:1152 nt
  v_mfma_f32_16x16x32_bf16 v[64:67], a[252:255], v[188:191], v[64:67]
  s_add_u32 s36, s36, s98
  ds_read_b128 v[92:95], v4 offset:8192
  ds_read_b128 v[96:99], v4 offset:12288
  v_mfma_f32_16x16x32_bf16 v[80:83], a[252:255], v[192:195], 0
L_hop_2_1:
  s_cbranch_execz L_hop_2_2
  ds_read_b128 v[100:103], v4 offset:16384
  ds_read_b128 v[104:107], v4 offset:20480
  v_mfma_f32_16x16x32_bf16 v[80:83], v[56:59], v[208:211], v[80:83]
  v_mfma_f32_16x16x32_bf16 v[80:83], v[68:71], v[224:227], v[80:83]
  v_cvt_pk_bf16_f32 v60, v60, v64
  v_cvt_pk_bf16_f32 v61, v61, v65
  v_mfma_f32_16x16x32_bf16 v[80:83], v[72:75], v[240:243], v[80:83]
  v_cvt_pk_bf16_f32 v62, v62, v66
  v_cvt_pk_bf16_f32 v63, v63, v67
  v_mfma_f32_16x16x32_bf16 v[80:83], a[244:247], a[216:219], v[80:83]
  buffer_store_dword v60, v7, s[24:27], s33 offen offset:0 nt
  v_mfma_f32_16x16x32_bf16 v[80:83], v[88:91], a[232:235], v[80:83]
  v_mfma_f32_16x16x32_bf16 v[108:111], v[88:91], a[236:239], 0
  buffer_store_dword v61, v7, s[24:27], s33 offen offset:384 nt
  v_mfma_f32_16x16x32_bf16 v[108:111], a[244:247], a[220:223], v[108:111]
  v_mfma_f32_16x16x32_bf16 v[108:111], v[72:75], v[244:247], v[108:111]
  buffer_store_dword v62, v7, s[24:27], s33 offen offset:768 nt
  v_mfma_f32_16x16x32_bf16 v[108:111], v[68:71], v[228:231], v[108:111]
  ds_read_b128 a[244:247], v3 offset:512
  ds_read_b128 a[248:251], v3 offset:4608
  v_mfma_f32_16x16x32_bf16 v[108:111], v[56:59], v[212:215], v[108:111]
  buffer_store_dword v63, v7, s[24:27], s33 offen offset:1152 nt
  v_mfma_f32_16x16x32_bf16 v[108:111], a[252:255], v[196:199], v[108:111]
  s_waitcnt lgkmcnt(2)
  ds_read_b128 v[56:59], v3 offset:8704
  ds_read_b128 v[60:63], v3 offset:12800
  v_mfma_f32_16x16x32_bf16 v[88:91], v[76:79], v[184:187], 0
  ds_read_b128 a[252:255], v3 offset:16896
  ds_read_b128 v[64:67], v3 offset:20992
  v_mfma_f32_16x16x32_bf16 v[88:91], v[84:87], v[200:203], v[88:91]
  v_mfma_f32_16x16x32_bf16 v[88:91], v[92:95], v[216:219], v[88:91]
  v_cvt_pk_bf16_f32 v80, v80, v108
  v_cvt_pk_bf16_f32 v81, v81, v109
  v_mfma_f32_16x16x32_bf16 v[88:91], v[96:99], v[232:235], v[88:91]
  v_cvt_pk_bf16_f32 v82, v82, v110
  v_cvt_pk_bf16_f32 v83, v83, v111
  v_mfma_f32_16x16x32_bf16 v[88:91], v[100:103], v[248:251], v[88:91]
  buffer_store_dword v80, v8, s[24:27], s33 offen offset:0 nt
  v_mfma_f32_16x16x32_bf16 v[88:91], v[104:107], a[224:227], v[88:91]
  v_mfma_f32_16x16x32_bf16 v[68:71], v[104:107], a[228:231], 0
  buffer_store_dword v81, v8, s[24:27], s33 offen offset:384 nt
  v_mfma_f32_16x16x32_bf16 v[68:71], v[100:103], v[252:255], v[68:71]
  v_mfma_f32_16x16x32_bf16 v[68:71], v[96:99], v[236:239], v[68:71]
  buffer_store_dword v82, v8, s[24:27], s33 offen offset:768 nt
  v_mfma_f32_16x16x32_bf16 v[68:71], v[92:95], v[220:223], v[68:71]
  v_mfma_f32_16x16x32_bf16 v[68:71], v[84:87], v[204:207], v[68:71]
  buffer_store_dword v83, v8, s[24:27], s33 offen offset:1152 nt
  v_mfma_f32_16x16x32_bf16 v[68:71], v[76:79], v[188:191], v[68:71]
  s_waitcnt lgkmcnt(0)
  v_mfma_f32_16x16x32_bf16 v[84:87], a[244:247], v[184:187], 0
  v_mfma_f32_16x16x32_bf16 v[84:87], a[248:251], v[200:203], v[84:87]
  v_mfma_f32_16x16x32_bf16 v[84:87], v[56:59], v[216:219], v[84:87]
  v_cvt_pk_bf16_f32 v88, v88, v68
  v_cvt_pk_bf16_f32 v89, v89, v69
  v_mfma_f32_16x16x32_bf16 v[84:87], v[60:63], v[232:235], v[84:87]
  v_cvt_pk_bf16_f32 v90, v90, v70
  v_cvt_pk_bf16_f32 v91, v91, v71
  v_mfma_f32_16x16x32_bf16 v[84:87], a[252:255], v[248:251], v[84:87]
  buffer_store_dword v88, v7, s[24:27], s34 offen offset:0 nt
  v_mfma_f32_16x16x32_bf16 v[84:87], v[64:67], a[224:227], v[84:87]
  v_mfma_f32_16x16x32_bf16 v[100:103], v[64:67], a[228:231], 0
  buffer_store_dword v89, v7, s[24:27], s34 offen offset:384 nt
  v_mfma_f32_16x16x32_bf16 v[100:103], a[252:255], v[252:255], v[100:103]
  v_mfma_f32_16x16x32_bf16 v[100:103], v[60:63], v[236:239], v[100:103]
  buffer_store_dword v90, v7, s[24:27], s34 offen offset:768 nt
  v_mfma_f32_16x16x32_bf16 v[100:103], v[56:59], v[220:223], v[100:103]
  ds_read_b128 v[68:71], v4 offset:512
  ds_read_b128 v[72:75], v4 offset:4608
  v_mfma_f32_16x16x32_bf16 v[100:103], a[248:251], v[204:207], v[100:103]
  buffer_store_dword v91, v7, s[24:27], s34 offen offset:1152 nt
  v_mfma_f32_16x16x32_bf16 v[100:103], a[244:247], v[188:191], v[100:103]
  ds_read_b128 v[76:79], v4 offset:8704
  ds_read_b128 v[92:95], v4 offset:12800
  v_mfma_f32_16x16x32_bf16 v[80:83], a[244:247], v[192:195], 0
  ds_read_b128 v[88:91], v4 offset:16896
  ds_read_b128 v[96:99], v4 offset:20992
  v_mfma_f32_16x16x32_bf16 v[80:83], a[248:251], v[208:211], v[80:83]
  v_mfma_f32_16x16x32_bf16 v[80:83], v[56:59], v[224:227], v[80:83]
  v_cvt_pk_bf16_f32 v84, v84, v100
  v_cvt_pk_bf16_f32 v85, v85, v101
  v_mfma_f32_16x16x32_bf16 v[80:83], v[60:63], v[240:243], v[80:83]
  v_cvt_pk_bf16_f32 v86, v86, v102
  v_cvt_pk_bf16_f32 v87, v87, v103
  v_mfma_f32_16x16x32_bf16 v[80:83], a[252:255], a[216:219], v[80:83]
  buffer_store_dword v84, v7, s[24:27], s35 offen offset:0 nt
  v_mfma_f32_16x16x32_bf16 v[80:83], v[64:67], a[232:235], v[80:83]
  v_mfma_f32_16x16x32_bf16 v[100:103], v[64:67], a[236:239], 0
  buffer_store_dword v85, v7, s[24:27], s35 offen offset:384 nt
  v_mfma_f32_16x16x32_bf16 v[100:103], a[252:255], a[220:223], v[100:103]
  v_mfma_f32_16x16x32_bf16 v[100:103], v[60:63], v[244:247], v[100:103]
  buffer_store_dword v86, v7, s[24:27], s35 offen offset:768 nt
  v_mfma_f32_16x16x32_bf16 v[100:103], v[56:59], v[228:231], v[100:103]
  v_mfma_f32_16x16x32_bf16 v[100:103], a[248:251], v[212:215], v[100:103]
  buffer_store_dword v87, v7, s[24:27], s35 offen offset:1152 nt
  v_mfma_f32_16x16x32_bf16 v[100:103], a[244:247], v[196:199], v[100:103]
  s_waitcnt lgkmcnt(0)
  v_mfma_f32_16x16x32_bf16 v[56:59], v[68:71], v[184:187], 0
  v_mfma_f32_16x16x32_bf16 v[56:59], v[72:75], v[200:203], v[56:59]
  v_mfma_f32_16x16x32_bf16 v[56:59], v[76:79], v[216:219], v[56:59]
  v_cvt_pk_bf16_f32 v80, v80, v100
  v_cvt_pk_bf16_f32 v81, v81, v101
  v_mfma_f32_16x16x32_bf16 v[56:59], v[92:95], v[232:235], v[56:59]
  v_cvt_pk_bf16_f32 v82, v82, v102
  v_cvt_pk_bf16_f32 v83, v83, v103
  v_mfma_f32_16x16x32_bf16 v[56:59], v[88:91], v[248:251], v[56:59]
  buffer_store_dword v80, v8, s[24:27], s35 offen offset:0 nt
  v_mfma_f32_16x16x32_bf16 v[56:59], v[96:99], a[224:227], v[56:59]
  v_mfma_f32_16x16x32_bf16 v[60:63], v[96:99], a[228:231], 0
  buffer_store_dword v81, v8, s[24:27], s35 offen offset:384 nt
  v_mfma_f32_16x16x32_bf16 v[60:63], v[88:91], v[252:255], v[60:63]
  v_mfma_f32_16x16x32_bf16 v[60:63], v[92:95], v[236:239], v[60:63]
  buffer_store_dword v82, v8, s[24:27], s35 offen offset:768 nt
  v_mfma_f32_16x16x32_bf16 v[60:63], v[76:79], v[220:223], v[60:63]
  v_mfma_f32_16x16x32_bf16 v[60:63], v[72:75], v[204:207], v[60:63]
  buffer_store_dword v83, v8, s[24:27], s35 offen offset:1152 nt
  v_mfma_f32_16x16x32_bf16 v[60:63], v[68:71], v[188:191], v[60:63]
  s_nop 7
  v_cvt_pk_bf16_f32 v56, v56, v60
  v_cvt_pk_bf16_f32 v57, v57, v61
  v_cvt_pk_bf16_f32 v58, v58, v62
  v_cvt_pk_bf16_f32 v59, v59, v63
  buffer_store_dword v56, v7, s[24:27], s36 offen offset:0 nt
  buffer_store_dword v57, v7, s[24:27], s36 offen offset:384 nt
  buffer_store_dword v58, v7, s[24:27], s36 offen offset:768 nt
  buffer_store_dword v59, v7, s[24:27], s36 offen offset:1152 nt
  s_cmp_lg_u32 s49, 0
  s_cbranch_scc1 L_safe
L_fin:
L_end:
  s_endpgm
L_hop_3_1:
  s_cbranch_execz L_walk
L_pad3768:
L_k7:
  s_cmp_lg_u32 s59, 7
  s_cbranch_scc1 L_kh
  v_mfma_f32_16x16x32_bf16 v[104:107], a[0:3], v[88:91], 0
  s_waitcnt lgkmcnt(0)
  s_sub_u32 s49, s16, s18
  s_sub_u32 s50, s15, s60
  v_mfma_f32_16x16x32_bf16 v[104:107], a[12:15], v[92:95], v[104:107]
  s_add_u32 s50, s50, 45360
  s_mul_i32 s49, s49, s50
  s_mul_hi_u32 s49, s49, 415817
  v_mfma_f32_16x16x32_bf16 v[104:107], a[24:27], v[96:99], v[104:107]
  s_add_u32 s49, s49, s16
  v_cvt_pk_bf16_f32 v66, v128, v129
  v_cvt_pk_bf16_f32 v67, v130, v131
  v_mfma_f32_16x16x32_bf16 v[104:107], a[36:39], v[136:139], v[104:107]
  s_and_b32 s51, s2, 7
  s_lshl_b32 s51, s51, 3
  v_and_b32 v74, 56, v11
  v_mfma_f32_16x16x32_bf16 v[104:107], a[48:51], v[140:143], v[104:107]
  v_lshl_add_u32 v54, v74, 3, s51
  s_lshl_b32 s51, s51, 3
  v_mfma_f32_16x16x32_bf16 v[104:107], a[60:63], v[80:83], v[104:107]
  v_add_u32 v55, s51, v74
  v_mov_b32 v74, s49
  v_mfma_f32_16x16x32_bf16 v[84:87], a[64:67], v[80:83], 0
  buffer_store_dword v74, v54, s[20:23], s44 offen sc1
  v_mfma_f32_16x16x32_bf16 v[84:87], a[52:55], v[140:143], v[84:87]
  v_mfma_f32_16x16x32_bf16 v[84:87], a[40:43], v[136:139], v[84:87]
  v_mul_f32 v104, s42, v104
  v_mul_f32 v105, s42, v105
  v_mfma_f32_16x16x32_bf16 v[84:87], a[28:31], v[96:99], v[84:87]
  v_mul_f32 v106, s42, v106
  v_mul_f32 v107, s42, v107
  v_mfma_f32_16x16x32_bf16 v[84:87], a[16:19], v[92:95], v[84:87]
  v_cvt_pk_bf16_f32 v18, v104, v105
  v_cvt_pk_bf16_f32 v19, v106, v107
  v_mfma_f32_16x16x32_bf16 v[84:87], a[4:7], v[88:91], v[84:87]
  buffer_store_dword v74, v55, s[20:23], s44 offen offset:4 sc1
  v_mfma_f32_16x16x32_bf16 v[108:111], a[8:11], v[88:91], 0
  s_branch L_r220
L_k2:
  s_cmp_lg_u32 s59, 10
  s_cbranch_scc1 L_k7
  s_waitcnt vmcnt(30)
  v_mfma_f32_16x16x32_bf16 v[104:107], a[0:3], v[88:91], 0
  s_sub_u32 s49, s19, s18
  s_sub_u32 s50, s15, s99
  s_add_u32 s50, s50, 45360
  v_mfma_f32_16x16x32_bf16 v[104:107], a[12:15], v[92:95], v[104:107]
  s_mul_i32 s49, s49, s50
  s_mul_hi_u32 s49, s49, 415817
  s_add_u32 s49, s49, s19
  v_mfma_f32_16x16x32_bf16 v[104:107], a[24:27], v[96:99], v[104:107]
  s_and_b32 s50, s2, 7
  v_cvt_pk_bf16_f32 v66, v128, v129
  v_cvt_pk_bf16_f32 v67, v130, v131
  v_mfma_f32_16x16x32_bf16 v[104:107], a[36:39], v[136:139], v[104:107]
  s_sub_u32 s49, s49, 1024
  v_subrev_u32 v54, s49, v52
  v_subrev_u32 v55, s49, v53
  v_mfma_f32_16x16x32_bf16 v[104:107], a[48:51], v[140:143], v[104:107]
  s_waitcnt lgkmcnt(0)
  v_max_u32 v116, v54, v55
  v_bfe_u32 v74, v11, 3, 3
  v_mfma_f32_16x16x32_bf16 v[104:107], a[60:63], v[80:83], v[104:107]
  v_lshrrev_b32 v75, 6, v11
  v_lshl_add_u32 v54, v54, 3, v74
  v_mfma_f32_16x16x32_bf16 v[84:87], a[64:67], v[80:83], 0
  v_lshl_add_u32 v55, v55, 3, v75
  v_mfma_f32_16x16x32_bf16 v[84:87], a[52:55], v[140:143], v[84:87]
  v_readlane_b32 s12, v52, s50
  v_cmp_lt_u32 vcc, 2047, v116
  v_mfma_f32_16x16x32_bf16 v[84:87], a[40:43], v[136:139], v[84:87]
  v_mul_f32 v104, s42, v104
  v_mul_f32 v105, s42, v105
  v_mfma_f32_16x16x32_bf16 v[84:87], a[28:31], v[96:99], v[84:87]
  v_mul_f32 v106, s42, v106
  v_mul_f32 v107, s42, v107
  v_mfma_f32_16x16x32_bf16 v[84:87], a[16:19], v[92:95], v[84:87]
  v_cvt_pk_bf16_f32 v18, v104, v105
  v_cvt_pk_bf16_f32 v19, v106, v107
  v_mfma_f32_16x16x32_bf16 v[84:87], a[4:7], v[88:91], v[84:87]
  v_and_b32 v116, 56, v11
  v_mfma_f32_16x16x32_bf16 v[108:111], a[8:11], v[88:91], 0
  s_or_b32 s51, vcc_lo, vcc_hi
  v_cmp_lt_u32 vcc, v54, v55
  v_mfma_f32_16x16x32_bf16 v[108:111], a[20:23], v[92:95], v[108:111]
  s_sub_u32 s52, s12, s49
  s_sub_u32 s52, s52, 960
  s_lshr_b32 s52, s52, 7
  v_mfma_f32_16x16x32_bf16 v[108:111], a[32:35], v[96:99], v[108:111]
  s_or_b32 s51, s51, s52
  v_mul_f32 v84, s42, v84
  v_mul_f32 v85, s42, v85
  v_mfma_f32_16x16x32_bf16 v[108:111], a[44:47], v[136:139], v[108:111]
  v_mul_f32 v86, s42, v86
  v_mul_f32 v87, s42, v87
  v_mfma_f32_16x16x32_bf16 v[108:111], a[56:59], v[140:143], v[108:111]
  v_cvt_pk_bf16_f32 v104, v84, v85
  v_cvt_pk_bf16_f32 v105, v86, v87
  v_mfma_f32_16x16x32_bf16 v[108:111], a[68:71], v[80:83], v[108:111]
  v_lshrrev_b64 v[74:75], v116, vcc
  v_and_b32 v55, 0xff, v74
  v_mfma_f32_16x16x32_bf16 v[112:115], a[132:135], v[80:83], 0
  v_bcnt_u32_b32 v55, v55, 0
  v_mfma_f32_16x16x32_bf16 v[112:115], a[120:123], v[140:143], v[112:115]
  v_readlane_b32 s52, v55, s50
  v_mfma_f32_16x16x32_bf16 v[112:115], a[108:111], v[136:139], v[112:115]
  v_mul_f32 v108, s42, v108
  v_mul_f32 v109, s42, v109
  v_mfma_f32_16x16x32_bf16 v[112:115], a[96:99], v[96:99], v[112:115]
  s_sub_u32 s52, 7, s52
  v_mul_f32 v110, s42, v110
  v_mul_f32 v111, s42, v111
  v_mfma_f32_16x16x32_bf16 v[112:115], a[84:87], v[92:95], v[112:115]
  v_cvt_pk_bf16_f32 v106, v108, v109
  v_cvt_pk_bf16_f32 v107, v110, v111
  v_mfma_f32_16x16x32_bf16 v[112:115], a[72:75], v[88:91], v[112:115]
  v_cmp_eq_u32 vcc, s52, v55
  v_mfma_f32_16x16x32_bf16 v[84:87], a[76:79], v[88:91], 0
  v_mfma_f32_16x16x32_bf16 v[84:87], a[88:91], v[92:95], v[84:87]
  s_ff1_i32_b32 s52, vcc_lo
  s_and_b32 s52, s52, 7
  v_readlane_b32 s53, v54, s52
  v_mfma_f32_16x16x32_bf16 v[84:87], a[100:103], v[96:99], v[84:87]
  v_cvt_pk_bf16_f32 v128, v112, v113
  v_cvt_pk_bf16_f32 v129, v114, v115
  v_mfma_f32_16x16x32_bf16 v[84:87], a[112:115], v[136:139], v[84:87]
  s_lshr_b32 s53, s53, 3
  s_add_u32 s53, s53, s49
  s_sub_u32 s49, s53, s12
  v_mfma_f32_16x16x32_bf16 v[84:87], a[124:127], v[140:143], v[84:87]
  s_cmp_gt_i32 s49, 0
  s_cselect_b32 s45, 2, 1
  s_cselect_b32 s12, s53, s12
  v_mfma_f32_16x16x32_bf16 v[84:87], a[136:139], v[80:83], v[84:87]
  s_cselect_b32 s53, s52, s50
  s_cselect_b32 s96, 1, 6
  s_lshl_b32 s96, s96, 11
  v_mfma_f32_16x16x32_bf16 v[108:111], a[140:143], v[80:83], 0
  s_abs_i32 s49, s49
  s_cmp_lt_u32 s49, 235
  s_cselect_b32 s51, 1, s51
  v_mfma_f32_16x16x32_bf16 v[108:111], a[128:131], v[140:143], v[108:111]
  s_cmp_lt_u32 s49, 400
  s_cselect_b32 s14, 8, 0
  s_xnor_b32 s13, s12, s14
  v_mfma_f32_16x16x32_bf16 v[108:111], a[116:119], v[136:139], v[108:111]
  s_cmp_eq_u32 s51, 0
  v_cvt_pk_bf16_f32 v130, v84, v85
  v_cvt_pk_bf16_f32 v131, v86, v87
  v_mfma_f32_16x16x32_bf16 v[108:111], a[104:107], v[96:99], v[108:111]
  s_cselect_b32 s45, s45, 0
  s_cselect_b32 s96, s96, 0
  s_bitset1_b32 s96, 14
  v_mfma_f32_16x16x32_bf16 v[108:111], a[92:95], v[92:95], v[108:111]
  s_andn2_b32 s51, s2, 7
  s_add_u32 s51, s51, s53
  s_lshl_b32 s51, s51, 9
  v_mfma_f32_16x16x32_bf16 v[108:111], a[80:83], v[88:91], v[108:111]
  s_add_u32 s44, s51, 2097152
  s_lshr_b32 s49, s45, 1
  s_lshl_b32 s49, s49, s52
  v_mfma_f32_16x16x32_bf16 v[84:87], v[88:91], a[144:147], 0
  s_lshl_b32 s49, s49, s14
  s_lshl_b32 s54, s3, 2
  s_add_u32 s54, s54, 159808
  v_mfma_f32_16x16x32_bf16 v[84:87], v[92:95], a[156:159], v[84:87]
  ds_read_b128 a[244:247], v1 offset:22528
  v_mov_b32 v54, s54
  v_mfma_f32_16x16x32_bf16 v[84:87], v[96:99], a[168:171], v[84:87]
  v_cvt_pk_bf16_f32 v132, v108, v109
  v_cvt_pk_bf16_f32 v133, v110, v111
  v_mfma_f32_16x16x32_bf16 v[84:87], v[136:139], a[180:183], v[84:87]
  ds_read_b128 a[248:251], v0 offset:22528
  v_mov_b32 v55, s49
  v_mfma_f32_16x16x32_bf16 v[84:87], v[140:143], a[192:195], v[84:87]
  ds_read_b128 a[252:255], v1 offset:14336
  v_mfma_f32_16x16x32_bf16 v[84:87], v[80:83], a[204:207], v[84:87]
  ds_read_b128 v[144:147], v0 offset:14336
  v_mfma_f32_16x16x32_bf16 v[116:119], v[80:83], a[208:211], 0
  ds_read_b128 v[148:151], v1 offset:6144
  v_mfma_f32_16x16x32_bf16 v[116:119], v[140:143], a[196:199], v[116:119]
  ds_read_b128 v[152:155], v0 offset:6144
  v_mfma_f32_16x16x32_bf16 v[116:119], v[136:139], a[184:187], v[116:119]
  v_cvt_pk_bf16_f32 v108, v84, v85
  v_cvt_pk_bf16_f32 v109, v86, v87
  v_mfma_f32_16x16x32_bf16 v[116:119], v[96:99], a[172:175], v[116:119]
  ds_write_b32 v54, v55
  v_mfma_f32_16x16x32_bf16 v[116:119], v[92:95], a[160:163], v[116:119]
  v_mfma_f32_16x16x32_bf16 v[116:119], v[88:91], a[148:151], v[116:119]
  v_mfma_f32_16x16x32_bf16 v[156:159], v[88:91], a[152:155], 0
  v_mfma_f32_16x16x32_bf16 v[156:159], v[92:95], a[164:167], v[156:159]
  s_waitcnt lgkmcnt(0)
  v_mfma_f32_16x16x32_bf16 v[156:159], v[96:99], a[176:179], v[156:159]
  v_cvt_pk_bf16_f32 v112, v116, v117
  v_cvt_pk_bf16_f32 v113, v118, v119
  v_mfma_f32_16x16x32_bf16 v[156:159], v[136:139], a[188:191], v[156:159]
  s_branch L_r259
L_hop_0_2:
  s_cbranch_execz L_walk
L_pad3969:
L_kh:
  s_cmp_lt_u32 s59, 14
  s_cbranch_scc1 L_k11
  v_mfma_f32_16x16x32_bf16 v[104:107], a[76:79], v[88:91], 0
  s_lshl_b32 s5, s3, 3
  v_mfma_f32_16x16x32_bf16 v[104:107], a[88:91], v[92:95], v[104:107]
  s_add_u32 s5, s5, 159744
  v_mov_b32 v11, s5
  v_mfma_f32_16x16x32_bf16 v[104:107], a[100:103], v[96:99], v[104:107]
  v_cvt_pk_bf16_f32 v66, v128, v129
  v_cvt_pk_bf16_f32 v67, v130, v131
  v_mfma_f32_16x16x32_bf16 v[104:107], a[112:115], v[136:139], v[104:107]
  ds_read_b128 a[244:247], v1 offset:22528
  v_mfma_f32_16x16x32_bf16 v[104:107], a[124:127], v[140:143], v[104:107]
  ds_read_b128 a[248:251], v0 offset:22528
  s_waitcnt lgkmcnt(2)
  v_mfma_f32_16x16x32_bf16 v[104:107], a[136:139], v[80:83], v[104:107]
  ds_read_b128 a[252:255], v1 offset:14336
  v_mfma_f32_16x16x32_bf16 v[108:111], a[132:135], v[80:83], 0
  ds_read_b128 v[84:87], v0 offset:14336
  v_mfma_f32_16x16x32_bf16 v[108:111], a[120:123], v[140:143], v[108:111]
  ds_read_b128 v[128:131], v1 offset:6144
  v_mfma_f32_16x16x32_bf16 v[108:111], a[108:111], v[136:139], v[108:111]
  v_cvt_pk_bf16_f32 v146, v104, v105
  v_cvt_pk_bf16_f32 v147, v106, v107
  v_mfma_f32_16x16x32_bf16 v[108:111], a[96:99], v[96:99], v[108:111]
  ds_read_b128 v[132:135], v0 offset:6144
  v_cndmask_b32 v160, v32, v48, s[100:101]
  v_mfma_f32_16x16x32_bf16 v[108:111], a[84:87], v[92:95], v[108:111]
  v_cndmask_b32 v161, v33, v49, s[100:101]
  v_cndmask_b32 v162, v34, v50, s[100:101]
  v_mfma_f32_16x16x32_bf16 v[108:111], a[72:75], v[88:91], v[108:111]
  v_cndmask_b32 v163, v35, v51, s[100:101]
  v_cndmask_b32 v164, v28, v44, s[100:101]
  v_mfma_f32_16x16x32_bf16 v[112:115], a[140:143], v[80:83], 0
  v_cndmask_b32 v165, v29, v45, s[100:101]
  v_cndmask_b32 v166, v30, v46, s[100:101]
  v_mfma_f32_16x16x32_bf16 v[112:115], a[128:131], v[140:143], v[112:115]
  v_cndmask_b32 v167, v31, v47, s[100:101]
  v_cndmask_b32 v104, v24, v40, s[100:101]
  v_mfma_f32_16x16x32_bf16 v[112:115], a[116:119], v[136:139], v[112:115]
  v_cvt_pk_bf16_f32 v144, v108, v109
  v_cvt_pk_bf16_f32 v145, v110, v111
  v_mfma_f32_16x16x32_bf16 v[112:115], a[104:107], v[96:99], v[112:115]
  v_cndmask_b32 v105, v25, v41, s[100:101]
  v_cndmask_b32 v106, v26, v42, s[100:101]
  v_mfma_f32_16x16x32_bf16 v[112:115], a[92:95], v[92:95], v[112:115]
  v_cndmask_b32 v107, v27, v43, s[100:101]
  v_mfma_f32_16x16x32_bf16 v[112:115], a[80:83], v[88:91], v[112:115]
  s_waitcnt lgkmcnt(0)
  v_mfma_f32_16x16x32_bf16 v[108:111], a[132:135], a[244:247], 0
  v_mfma_f32_16x16x32_bf16 v[108:111], a[120:123], a[248:251], v[108:111]
  v_mfma_f32_16x16x32_bf16 v[108:111], a[108:111], a[252:255], v[108:111]
  v_cvt_pk_bf16_f32 v148, v112, v113
  v_cvt_pk_bf16_f32 v149, v114, v115
  v_mfma_f32_16x16x32_bf16 v[108:111], a[96:99], v[84:87], v[108:111]
  v_mfma_f32_16x16x32_bf16 v[108:111], a[84:87], v[128:131], v[108:111]
  s_waitcnt lgkmcnt(0)
  s_barrier
  v_mfma_f32_16x16x32_bf16 v[108:111], a[72:75], v[132:135], v[108:111]
  v_mfma_f32_16x16x32_bf16 v[112:115], a[76:79], v[132:135], 0
  v_mfma_f32_16x16x32_bf16 v[112:115], a[88:91], v[128:131], v[112:115]
  v_mfma_f32_16x16x32_bf16 v[112:115], a[100:103], v[84:87], v[112:115]
  v_cvt_pk_bf16_f32 v152, v108, v109
  v_cvt_pk_bf16_f32 v153, v110, v111
  v_mfma_f32_16x16x32_bf16 v[112:115], a[112:115], a[252:255], v[112:115]
  v_mfma_f32_16x16x32_bf16 v[112:115], a[124:127], a[248:251], v[112:115]
  v_mfma_f32_16x16x32_bf16 v[112:115], a[136:139], a[244:247], v[112:115]
  v_mfma_f32_16x16x32_bf16 v[108:111], a[140:143], a[244:247], 0
  v_mfma_f32_16x16x32_bf16 v[108:111], a[128:131], a[248:251], v[108:111]
  v_mfma_f32_16x16x32_bf16 v[108:111], a[116:119], a[252:255], v[108:111]
  v_cvt_pk_bf16_f32 v154, v112, v113
  v_cvt_pk_bf16_f32 v155, v114, v115
  v_mfma_f32_16x16x32_bf16 v[108:111], a[104:107], v[84:87], v[108:111]
  v_mfma_f32_16x16x32_bf16 v[108:111], a[92:95], v[128:131], v[108:111]
  v_mfma_f32_16x16x32_bf16 v[108:111], a[80:83], v[132:135], v[108:111]
  v_mfma_f32_16x16x32_bf16 v[112:115], v[70:73], v[76:79], v[36:39]
  v_mfma_f32_16x16x32_bf16 v[112:115], v[68:71], v[12:15], v[112:115]
  v_mfma_f32_16x16x32_bf16 v[116:119], v[122:125], v[76:79], v[32:35]
  v_cvt_pk_bf16_f32 v156, v108, v109
  v_cvt_pk_bf16_f32 v157, v110, v111
  v_mfma_f32_16x16x32_bf16 v[116:119], v[120:123], v[12:15], v[116:119]
  v_mfma_f32_16x16x32_bf16 v[168:171], v[146:149], v[76:79], v[164:167]
  v_exp_f32 v112, v112
  v_mfma_f32_16x16x32_bf16 v[168:171], v[144:147], v[12:15], v[168:171]
  v_exp_f32 v113, v113
  v_mfma_f32_16x16x32_bf16 v[172:175], v[154:157], v[76:79], v[104:107]
  v_exp_f32 v114, v114
  v_mfma_f32_16x16x32_bf16 v[172:175], v[152:155], v[12:15], v[172:175]
  v_exp_f32 v115, v115
  v_mfma_f32_16x16x32_bf16 v[104:107], v[68:71], v[100:103], v[40:43]
  v_exp_f32 v116, v116
  v_mfma_f32_16x16x32_bf16 v[104:107], v[70:73], v[14:17], v[104:107]
  v_exp_f32 v117, v117
  v_mfma_f32_16x16x32_bf16 v[108:111], v[120:123], v[100:103], v[36:39]
  v_exp_f32 v118, v118
  v_mfma_f32_16x16x32_bf16 v[108:111], v[122:125], v[14:17], v[108:111]
  v_exp_f32 v119, v119
  v_mfma_f32_16x16x32_bf16 v[72:75], v[144:147], v[100:103], v[160:163]
  v_exp_f32 v168, v168
  v_mfma_f32_16x16x32_bf16 v[72:75], v[146:149], v[14:17], v[72:75]
  v_exp_f32 v169, v169
  v_mfma_f32_16x16x32_bf16 v[68:71], v[152:155], v[100:103], v[164:167]
  v_exp_f32 v170, v170
  v_mfma_f32_16x16x32_bf16 v[68:71], v[154:157], v[14:17], v[68:71]
  v_exp_f32 v171, v171
  v_mfma_f32_16x16x32_bf16 v[76:79], v[88:91], a[144:147], 0
  v_exp_f32 v172, v172
  v_mfma_f32_16x16x32_bf16 v[76:79], v[92:95], a[156:159], v[76:79]
  v_exp_f32 v173, v173
  v_mfma_f32_16x16x32_bf16 v[76:79], v[96:99], a[168:171], v[76:79]
  v_exp_f32 v174, v174
  v_mfma_f32_16x16x32_bf16 v[76:79], v[136:139], a[180:183], v[76:79]
  v_exp_f32 v175, v175
  v_mfma_f32_16x16x32_bf16 v[76:79], v[140:143], a[192:195], v[76:79]
  v_cvt_pk_bf16_f32 v112, v112, v113
  v_cvt_pk_bf16_f32 v113, v114, v115
  v_mfma_f32_16x16x32_bf16 v[76:79], v[80:83], a[204:207], v[76:79]
  v_cvt_pk_bf16_f32 v114, v116, v117
  v_cvt_pk_bf16_f32 v115, v118, v119
  v_mfma_f32_16x16x32_bf16 v[100:103], v[80:83], a[208:211], 0
  v_cvt_pk_bf16_f32 v116, v168, v169
  v_cvt_pk_bf16_f32 v117, v170, v171
  v_mfma_f32_16x16x32_bf16 v[100:103], v[140:143], a[196:199], v[100:103]
  v_cvt_pk_bf16_f32 v118, v172, v173
  v_cvt_pk_bf16_f32 v119, v174, v175
  v_mfma_f32_16x16x32_bf16 v[100:103], v[136:139], a[184:187], v[100:103]
  v_cvt_pk_bf16_f32 v144, v76, v77
  v_cvt_pk_bf16_f32 v145, v78, v79
  v_mfma_f32_16x16x32_bf16 v[100:103], v[96:99], a[172:175], v[100:103]
  v_exp_f32 v104, v104
  v_mfma_f32_16x16x32_bf16 v[100:103], v[92:95], a[160:163], v[100:103]
  v_exp_f32 v105, v105
  v_mfma_f32_16x16x32_bf16 v[100:103], v[88:91], a[148:151], v[100:103]
  v_exp_f32 v106, v106
  v_mfma_f32_16x16x32_bf16 v[120:123], v[88:91], a[152:155], 0
  v_exp_f32 v107, v107
  v_mfma_f32_16x16x32_bf16 v[120:123], v[92:95], a[164:167], v[120:123]
  v_exp_f32 v108, v108
  v_mfma_f32_16x16x32_bf16 v[120:123], v[96:99], a[176:179], v[120:123]
  v_cvt_pk_bf16_f32 v148, v100, v101
  v_cvt_pk_bf16_f32 v149, v102, v103
  v_mfma_f32_16x16x32_bf16 v[120:123], v[136:139], a[188:191], v[120:123]
  v_exp_f32 v109, v109
  v_mfma_f32_16x16x32_bf16 v[120:123], v[140:143], a[200:203], v[120:123]
  v_exp_f32 v110, v110
  v_mfma_f32_16x16x32_bf16 v[120:123], v[80:83], a[212:215], v[120:123]
  v_exp_f32 v111, v111
  v_mfma_f32_16x16x32_bf16 v[76:79], v[132:135], a[144:147], 0
  v_exp_f32 v72, v72
  v_mfma_f32_16x16x32_bf16 v[76:79], v[128:131], a[156:159], v[76:79]
  v_exp_f32 v73, v73
  v_mfma_f32_16x16x32_bf16 v[76:79], v[84:87], a[168:171], v[76:79]
  v_cvt_pk_bf16_f32 v140, v120, v121
  v_cvt_pk_bf16_f32 v141, v122, v123
  v_mfma_f32_16x16x32_bf16 v[76:79], a[252:255], a[180:183], v[76:79]
  ds_read_b128 v[88:91], v3 offset:0
  v_cvt_pk_bf16_f32 v104, v104, v105
  v_mfma_f32_16x16x32_bf16 v[76:79], a[248:251], a[192:195], v[76:79]
  ds_read_b128 v[92:95], v3 offset:4096
  v_cvt_pk_bf16_f32 v105, v106, v107
  v_mfma_f32_16x16x32_bf16 v[76:79], a[244:247], a[204:207], v[76:79]
  ds_read_b128 v[100:103], v3 offset:8192
  v_cvt_pk_bf16_f32 v106, v108, v109
  v_mfma_f32_16x16x32_bf16 v[80:83], a[244:247], a[208:211], 0
  ds_read_b128 v[120:123], v3 offset:12288
  v_cvt_pk_bf16_f32 v107, v110, v111
  v_mfma_f32_16x16x32_bf16 v[80:83], a[248:251], a[196:199], v[80:83]
  ds_read_b128 v[124:127], v3 offset:16384
  v_cvt_pk_bf16_f32 v108, v72, v73
  v_mfma_f32_16x16x32_bf16 v[80:83], a[252:255], a[184:187], v[80:83]
  v_cvt_pk_bf16_f32 v146, v76, v77
  v_cvt_pk_bf16_f32 v147, v78, v79
  v_mfma_f32_16x16x32_bf16 v[80:83], v[84:87], a[172:175], v[80:83]
  ds_read_b128 v[136:139], v3 offset:20480
  v_mfma_f32_16x16x32_bf16 v[80:83], v[128:131], a[160:163], v[80:83]
  v_exp_f32 v74, v74
  v_mfma_f32_16x16x32_bf16 v[80:83], v[132:135], a[148:151], v[80:83]
  v_exp_f32 v75, v75
  v_mfma_f32_16x16x32_bf16 v[76:79], v[132:135], a[152:155], 0
  v_exp_f32 v68, v68
  v_mfma_f32_16x16x32_bf16 v[76:79], v[128:131], a[164:167], v[76:79]
  v_exp_f32 v69, v69
  v_mfma_f32_16x16x32_bf16 v[76:79], v[84:87], a[176:179], v[76:79]
  v_cvt_pk_bf16_f32 v150, v80, v81
  v_cvt_pk_bf16_f32 v151, v82, v83
  v_mfma_f32_16x16x32_bf16 v[76:79], a[252:255], a[188:191], v[76:79]
  v_mov_b64 v[132:133], 0
  v_cvt_pk_bf16_f32 v109, v74, v75
  v_mfma_f32_16x16x32_bf16 v[76:79], a[248:251], a[200:203], v[76:79]
  v_exp_f32 v70, v70
  v_mfma_f32_16x16x32_bf16 v[76:79], a[244:247], a[212:215], v[76:79]
  s_waitcnt lgkmcnt(0)
  v_exp_f32 v71, v71
  v_mfma_f32_16x16x32_bf16 v[128:131], v[88:91], v[184:187], 0
  v_cvt_pk_bf16_f32 v110, v68, v69
  v_cvt_pk_bf16_f32 v111, v70, v71
  v_mfma_f32_16x16x32_bf16 v[128:131], v[92:95], v[200:203], v[128:131]
  v_mfma_f32_16x16x32_bf16 v[128:131], v[100:103], v[216:219], v[128:131]
  v_cvt_pk_bf16_f32 v142, v76, v77
  v_cvt_pk_bf16_f32 v143, v78, v79
  v_mfma_f32_16x16x32_bf16 v[128:131], v[120:123], v[232:235], v[128:131]
  v_mov_b64 v[96:97], 0
  v_mfma_f32_16x16x32_bf16 v[128:131], v[124:127], v[248:251], v[128:131]
  v_mfma_f32_16x16x32_bf16 v[128:131], v[136:139], a[224:227], v[128:131]
  v_smfmac_f32_16x16x64_bf16 v[132:135], a[240:243], v[112:119], v10
  v_mfma_f32_16x16x32_bf16 v[76:79], v[144:147], v[116:119], 0
  v_mfma_f32_16x16x32_bf16 v[76:79], v[56:59], v[112:115], v[76:79]
  v_mfma_f32_16x16x32_bf16 v[80:83], v[60:63], v[112:115], 0
  v_mfma_f32_16x16x32_bf16 v[80:83], v[148:151], v[116:119], v[80:83]
  v_mfma_f32_16x16x32_bf16 v[68:71], v[140:143], v[116:119], 0
  v_add_f32 v132, v132, v133
  v_mfma_f32_16x16x32_bf16 v[68:71], v[64:67], v[112:115], v[68:71]
  v_rcp_f32 v134, v132
  v_smfmac_f32_16x16x64_bf16 v[96:99], a[240:243], v[104:111], v10
  v_max3_f32 v9, v132, v134, v9
  v_mul_f32 v76, v134, v76
  v_mfma_f32_16x16x32_bf16 v[72:75], v[144:147], v[108:111], 0
  v_mul_f32 v77, v134, v77
  v_mul_f32 v78, v134, v78
  v_mfma_f32_16x16x32_bf16 v[72:75], v[56:59], v[104:107], v[72:75]
  v_mul_f32 v79, v134, v79
  v_cvt_pk_bf16_f32 v76, v76, v77
  v_mfma_f32_16x16x32_bf16 v[84:87], v[60:63], v[104:107], 0
  v_cvt_pk_bf16_f32 v77, v78, v79
  v_mul_f32 v80, v134, v80
  v_mfma_f32_16x16x32_bf16 v[84:87], v[148:151], v[108:111], v[84:87]
  v_mul_f32 v81, v134, v81
  v_mul_f32 v82, v134, v82
  v_mfma_f32_16x16x32_bf16 v[56:59], v[140:143], v[108:111], 0
  v_add_f32 v96, v96, v97
  v_mul_f32 v83, v134, v83
  v_mfma_f32_16x16x32_bf16 v[56:59], v[64:67], v[104:107], v[56:59]
  v_rcp_f32 v98, v96
  v_mfma_f32_16x16x32_bf16 v[60:63], v[136:139], a[228:231], 0
  v_cvt_pk_bf16_f32 v80, v80, v81
  v_cvt_pk_bf16_f32 v81, v82, v83
  v_mfma_f32_16x16x32_bf16 v[60:63], v[124:127], v[252:255], v[60:63]
  v_mul_f32 v68, v134, v68
  v_mul_f32 v69, v134, v69
  v_mfma_f32_16x16x32_bf16 v[60:63], v[120:123], v[236:239], v[60:63]
  ds_read_b128 v[104:107], v4 offset:0
  ds_read_b128 v[108:111], v4 offset:4096
  v_mfma_f32_16x16x32_bf16 v[60:63], v[100:103], v[220:223], v[60:63]
  ds_read_b128 v[116:119], v4 offset:8192
  ds_read_b128 v[140:143], v4 offset:12288
  v_mfma_f32_16x16x32_bf16 v[60:63], v[92:95], v[204:207], v[60:63]
  ds_read_b128 v[144:147], v4 offset:16384
  ds_read_b128 v[148:151], v4 offset:20480
  v_mfma_f32_16x16x32_bf16 v[60:63], v[88:91], v[188:191], v[60:63]
  v_mul_f32 v70, v134, v70
  v_mul_f32 v71, v134, v71
  v_mfma_f32_16x16x32_bf16 v[112:115], v[88:91], v[192:195], 0
  v_cvt_pk_bf16_f32 v68, v68, v69
  v_cvt_pk_bf16_f32 v69, v70, v71
  v_mfma_f32_16x16x32_bf16 v[112:115], v[92:95], v[208:211], v[112:115]
  v_max3_f32 v9, v96, v98, v9
  v_mul_f32 v72, v98, v72
  v_mfma_f32_16x16x32_bf16 v[112:115], v[100:103], v[224:227], v[112:115]
L_hop_1_2:
  s_cbranch_execz L_walk
  v_cvt_pk_bf16_f32 v128, v128, v60
  v_cvt_pk_bf16_f32 v129, v129, v61
  v_mfma_f32_16x16x32_bf16 v[112:115], v[120:123], v[240:243], v[112:115]
  v_cvt_pk_bf16_f32 v130, v130, v62
  v_cvt_pk_bf16_f32 v131, v131, v63
  v_mfma_f32_16x16x32_bf16 v[112:115], v[124:127], a[216:219], v[112:115]
  buffer_store_dword v128, v7, s[24:27], s33 offen offset:0 nt
  v_mfma_f32_16x16x32_bf16 v[112:115], v[136:139], a[232:235], v[112:115]
  v_mul_f32 v73, v98, v73
  v_mul_f32 v74, v98, v74
  v_mfma_f32_16x16x32_bf16 v[132:135], v[136:139], a[236:239], 0
  v_mul_f32 v75, v98, v75
  v_cvt_pk_bf16_f32 v72, v72, v73
  v_mfma_f32_16x16x32_bf16 v[132:135], v[124:127], a[220:223], v[132:135]
  buffer_store_dword v129, v7, s[24:27], s33 offen offset:384 nt
  v_mfma_f32_16x16x32_bf16 v[132:135], v[120:123], v[244:247], v[132:135]
  ds_read_b128 a[244:247], v3 offset:512
  ds_read_b128 a[248:251], v3 offset:4608
  v_mfma_f32_16x16x32_bf16 v[132:135], v[100:103], v[228:231], v[132:135]
  ds_read_b128 a[252:255], v3 offset:8704
  ds_read_b128 v[60:63], v3 offset:12800
  v_mfma_f32_16x16x32_bf16 v[132:135], v[92:95], v[212:215], v[132:135]
  buffer_store_dword v130, v7, s[24:27], s33 offen offset:768 nt
  v_mfma_f32_16x16x32_bf16 v[132:135], v[88:91], v[196:199], v[132:135]
  s_waitcnt lgkmcnt(4)
  ds_read_b128 v[64:67], v3 offset:16896
  ds_read_b128 v[92:95], v3 offset:20992
  v_mfma_f32_16x16x32_bf16 v[88:91], v[104:107], v[184:187], 0
  v_cvt_pk_bf16_f32 v73, v74, v75
  v_mul_f32 v84, v98, v84
  v_mfma_f32_16x16x32_bf16 v[88:91], v[108:111], v[200:203], v[88:91]
  buffer_store_dword v131, v7, s[24:27], s33 offen offset:1152 nt
  v_mfma_f32_16x16x32_bf16 v[88:91], v[116:119], v[216:219], v[88:91]
  v_cvt_pk_bf16_f32 v112, v112, v132
  v_cvt_pk_bf16_f32 v113, v113, v133
  v_mfma_f32_16x16x32_bf16 v[88:91], v[140:143], v[232:235], v[88:91]
  v_cvt_pk_bf16_f32 v114, v114, v134
  v_cvt_pk_bf16_f32 v115, v115, v135
  v_mfma_f32_16x16x32_bf16 v[88:91], v[144:147], v[248:251], v[88:91]
  buffer_store_dword v112, v8, s[24:27], s33 offen offset:0 nt
  v_mfma_f32_16x16x32_bf16 v[88:91], v[148:151], a[224:227], v[88:91]
  v_mul_f32 v85, v98, v85
  v_mul_f32 v86, v98, v86
  v_mfma_f32_16x16x32_bf16 v[120:123], v[148:151], a[228:231], 0
  v_mul_f32 v87, v98, v87
  v_cvt_pk_bf16_f32 v84, v84, v85
  v_mfma_f32_16x16x32_bf16 v[120:123], v[144:147], v[252:255], v[120:123]
  buffer_store_dword v113, v8, s[24:27], s33 offen offset:384 nt
  v_mfma_f32_16x16x32_bf16 v[120:123], v[140:143], v[236:239], v[120:123]
  v_cvt_pk_bf16_f32 v85, v86, v87
  v_mul_f32 v56, v98, v56
  v_mfma_f32_16x16x32_bf16 v[120:123], v[116:119], v[220:223], v[120:123]
  v_mul_f32 v57, v98, v57
  v_mul_f32 v58, v98, v58
  v_mfma_f32_16x16x32_bf16 v[120:123], v[108:111], v[204:207], v[120:123]
  buffer_store_dword v114, v8, s[24:27], s33 offen offset:768 nt
  v_mfma_f32_16x16x32_bf16 v[120:123], v[104:107], v[188:191], v[120:123]
  s_waitcnt lgkmcnt(0)
  v_mul_f32 v59, v98, v59
  v_cvt_pk_bf16_f32 v56, v56, v57
  v_mfma_f32_16x16x32_bf16 v[100:103], a[244:247], v[184:187], 0
  v_cvt_pk_bf16_f32 v57, v58, v59
  v_cmp_nge_f32 vcc, 0x53800000, v9
  v_mfma_f32_16x16x32_bf16 v[100:103], a[248:251], v[200:203], v[100:103]
  buffer_store_dword v115, v8, s[24:27], s33 offen offset:1152 nt
  v_mfma_f32_16x16x32_bf16 v[100:103], a[252:255], v[216:219], v[100:103]
  s_add_u32 s33, s33, s98
  v_cvt_pk_bf16_f32 v88, v88, v120
  v_cvt_pk_bf16_f32 v89, v89, v121
  v_mfma_f32_16x16x32_bf16 v[100:103], v[60:63], v[232:235], v[100:103]
  s_or_b32 s6, vcc_lo, vcc_hi
  v_cvt_pk_bf16_f32 v90, v90, v122
  v_cvt_pk_bf16_f32 v91, v91, v123
  v_mfma_f32_16x16x32_bf16 v[100:103], v[64:67], v[248:251], v[100:103]
  buffer_store_dword v88, v7, s[24:27], s34 offen offset:0 nt
  v_mfma_f32_16x16x32_bf16 v[100:103], v[92:95], a[224:227], v[100:103]
  ds_write2st64_b32 v5, v76, v77 offset0:0 offset1:4
  v_mfma_f32_16x16x32_bf16 v[96:99], v[92:95], a[228:231], 0
  ds_write2st64_b32 v5, v80, v81 offset0:8 offset1:12
  v_mfma_f32_16x16x32_bf16 v[96:99], v[64:67], v[252:255], v[96:99]
  buffer_store_dword v89, v7, s[24:27], s34 offen offset:384 nt
  v_mfma_f32_16x16x32_bf16 v[96:99], v[60:63], v[236:239], v[96:99]
  ds_read_b128 v[76:79], v4 offset:512
  ds_read_b128 v[80:83], v4 offset:4608
  v_mfma_f32_16x16x32_bf16 v[96:99], a[252:255], v[220:223], v[96:99]
  ds_write2st64_b32 v5, v68, v69 offset0:16 offset1:20
  v_mfma_f32_16x16x32_bf16 v[96:99], a[248:251], v[204:207], v[96:99]
  buffer_store_dword v90, v7, s[24:27], s34 offen offset:768 nt
  v_mfma_f32_16x16x32_bf16 v[96:99], a[244:247], v[188:191], v[96:99]
  ds_write2st64_b32 v5, v72, v73 offset0:1 offset1:5
  v_mfma_f32_16x16x32_bf16 v[68:71], a[244:247], v[192:195], 0
  ds_write2st64_b32 v5, v84, v85 offset0:9 offset1:13
  v_mfma_f32_16x16x32_bf16 v[68:71], a[248:251], v[208:211], v[68:71]
  buffer_store_dword v91, v7, s[24:27], s34 offen offset:1152 nt
  v_mfma_f32_16x16x32_bf16 v[68:71], a[252:255], v[224:227], v[68:71]
  s_add_u32 s34, s34, s98
  v_cvt_pk_bf16_f32 v100, v100, v96
  v_cvt_pk_bf16_f32 v101, v101, v97
  v_mfma_f32_16x16x32_bf16 v[68:71], v[60:63], v[240:243], v[68:71]
  v_cvt_pk_bf16_f32 v102, v102, v98
  v_cvt_pk_bf16_f32 v103, v103, v99
  v_mfma_f32_16x16x32_bf16 v[68:71], v[64:67], a[216:219], v[68:71]
  buffer_store_dword v100, v7, s[24:27], s35 offen offset:0 nt
  v_mfma_f32_16x16x32_bf16 v[68:71], v[92:95], a[232:235], v[68:71]
  ds_write2st64_b32 v5, v56, v57 offset0:17 offset1:21
  v_mfma_f32_16x16x32_bf16 v[96:99], v[92:95], a[236:239], 0
  ds_read_b128 v[84:87], v4 offset:8704
  v_mov_b32 v54, s6
  v_mfma_f32_16x16x32_bf16 v[96:99], v[64:67], a[220:223], v[96:99]
  buffer_store_dword v101, v7, s[24:27], s35 offen offset:384 nt
  v_mfma_f32_16x16x32_bf16 v[96:99], v[60:63], v[244:247], v[96:99]
  ds_read_b128 v[88:91], v4 offset:12800
  ds_read_b128 v[72:75], v4 offset:16896
  v_mfma_f32_16x16x32_bf16 v[96:99], a[252:255], v[228:231], v[96:99]
  ds_write_b32 v11, v54
  v_mfma_f32_16x16x32_bf16 v[96:99], a[248:251], v[212:215], v[96:99]
  buffer_store_dword v102, v7, s[24:27], s35 offen offset:768 nt
  v_mfma_f32_16x16x32_bf16 v[96:99], a[244:247], v[196:199], v[96:99]
  s_waitcnt lgkmcnt(8)
  ds_read_b128 v[64:67], v4 offset:20992
  v_xor_b32 v3, 40960, v3
  v_xor_b32 v4, 40960, v4
  v_mfma_f32_16x16x32_bf16 v[60:63], v[76:79], v[184:187], 0
  s_waitcnt lgkmcnt(1)
  s_barrier
  v_mfma_f32_16x16x32_bf16 v[60:63], v[80:83], v[200:203], v[60:63]
  buffer_store_dword v103, v7, s[24:27], s35 offen offset:1152 nt
  v_mfma_f32_16x16x32_bf16 v[60:63], v[84:87], v[216:219], v[60:63]
  v_cvt_pk_bf16_f32 v68, v68, v96
  v_cvt_pk_bf16_f32 v69, v69, v97
  v_mfma_f32_16x16x32_bf16 v[60:63], v[88:91], v[232:235], v[60:63]
  s_waitcnt lgkmcnt(0)
  v_cvt_pk_bf16_f32 v70, v70, v98
  v_cvt_pk_bf16_f32 v71, v71, v99
  v_mfma_f32_16x16x32_bf16 v[60:63], v[72:75], v[248:251], v[60:63]
  buffer_store_dword v68, v8, s[24:27], s35 offen offset:0 nt
  v_mfma_f32_16x16x32_bf16 v[60:63], v[64:67], a[224:227], v[60:63]
  ds_read_b128 a[244:247], v3 offset:0
  ds_read_b128 a[248:251], v3 offset:4096
  v_mfma_f32_16x16x32_bf16 v[92:95], v[64:67], a[228:231], 0
  ds_read_b128 a[252:255], v3 offset:8192
  ds_read_b128 v[56:59], v3 offset:12288
  v_mfma_f32_16x16x32_bf16 v[92:95], v[72:75], v[252:255], v[92:95]
  buffer_store_dword v69, v8, s[24:27], s35 offen offset:384 nt
  v_mfma_f32_16x16x32_bf16 v[92:95], v[88:91], v[236:239], v[92:95]
  ds_read_b128 v[64:67], v3 offset:16384
  ds_read_b128 v[72:75], v3 offset:20480
  v_mfma_f32_16x16x32_bf16 v[92:95], v[84:87], v[220:223], v[92:95]
  v_mov_b32 v11, 159744
  v_mfma_f32_16x16x32_bf16 v[92:95], v[80:83], v[204:207], v[92:95]
  buffer_store_dword v70, v8, s[24:27], s35 offen offset:768 nt
  v_mfma_f32_16x16x32_bf16 v[92:95], v[76:79], v[188:191], v[92:95]
  s_waitcnt lgkmcnt(2)
  ds_read2_b32 v[80:81], v11 offset0:0 offset1:2
  ds_read2_b32 v[82:83], v11 offset0:4 offset1:6
  v_mfma_f32_16x16x32_bf16 v[76:79], a[244:247], v[184:187], 0
  buffer_store_dword v71, v8, s[24:27], s35 offen offset:1152 nt
  v_mfma_f32_16x16x32_bf16 v[76:79], a[248:251], v[200:203], v[76:79]
  v_mfma_f32_16x16x32_bf16 v[76:79], a[252:255], v[216:219], v[76:79]
  v_cvt_pk_bf16_f32 v60, v60, v92
  v_cvt_pk_bf16_f32 v61, v61, v93
  v_mfma_f32_16x16x32_bf16 v[76:79], v[56:59], v[232:235], v[76:79]
  s_waitcnt lgkmcnt(2)
  v_cvt_pk_bf16_f32 v62, v62, v94
  v_cvt_pk_bf16_f32 v63, v63, v95
  v_mfma_f32_16x16x32_bf16 v[76:79], v[64:67], v[248:251], v[76:79]
  buffer_store_dword v60, v7, s[24:27], s36 offen offset:0 nt
  v_mfma_f32_16x16x32_bf16 v[76:79], v[72:75], a[224:227], v[76:79]
  s_waitcnt lgkmcnt(0)
  v_or3_b32 v80, v80, v81, v82
  v_or_b32 v80, v80, v83
  v_mfma_f32_16x16x32_bf16 v[100:103], v[72:75], a[228:231], 0
  buffer_store_dword v61, v7, s[24:27], s36 offen offset:384 nt
  v_mfma_f32_16x16x32_bf16 v[100:103], v[64:67], v[252:255], v[100:103]
  v_readfirstlane_b32 s49, v80
  v_mfma_f32_16x16x32_bf16 v[100:103], v[56:59], v[236:239], v[100:103]
  buffer_store_dword v62, v7, s[24:27], s36 offen offset:768 nt
  v_mfma_f32_16x16x32_bf16 v[100:103], a[252:255], v[220:223], v[100:103]
  ds_read_b128 v[68:71], v4 offset:0
  ds_read_b128 v[80:83], v4 offset:4096
  v_mfma_f32_16x16x32_bf16 v[100:103], a[248:251], v[204:207], v[100:103]
  buffer_store_dword v63, v7, s[24:27], s36 offen offset:1152 nt
  v_mfma_f32_16x16x32_bf16 v[100:103], a[244:247], v[188:191], v[100:103]
  ds_read_b128 v[84:87], v4 offset:8192
  ds_read_b128 v[88:91], v4 offset:12288
  v_mfma_f32_16x16x32_bf16 v[60:63], a[244:247], v[192:195], 0
  ds_read_b128 v[92:95], v4 offset:16384
  ds_read_b128 v[96:99], v4 offset:20480
  v_mfma_f32_16x16x32_bf16 v[60:63], a[248:251], v[208:211], v[60:63]
  v_mfma_f32_16x16x32_bf16 v[60:63], a[252:255], v[224:227], v[60:63]
  v_cvt_pk_bf16_f32 v76, v76, v100
  v_cvt_pk_bf16_f32 v77, v77, v101
  v_mfma_f32_16x16x32_bf16 v[60:63], v[56:59], v[240:243], v[60:63]
  v_cvt_pk_bf16_f32 v78, v78, v102
  v_cvt_pk_bf16_f32 v79, v79, v103
  v_mfma_f32_16x16x32_bf16 v[60:63], v[64:67], a[216:219], v[60:63]
  buffer_store_dword v76, v7, s[24:27], s33 offen offset:0 nt
  v_mfma_f32_16x16x32_bf16 v[60:63], v[72:75], a[232:235], v[60:63]
  v_mfma_f32_16x16x32_bf16 v[100:103], v[72:75], a[236:239], 0
  buffer_store_dword v77, v7, s[24:27], s33 offen offset:384 nt
  v_mfma_f32_16x16x32_bf16 v[100:103], v[64:67], a[220:223], v[100:103]
  v_mfma_f32_16x16x32_bf16 v[100:103], v[56:59], v[244:247], v[100:103]
  buffer_store_dword v78, v7, s[24:27], s33 offen offset:768 nt
  v_mfma_f32_16x16x32_bf16 v[100:103], a[252:255], v[228:231], v[100:103]
  v_mfma_f32_16x16x32_bf16 v[100:103], a[248:251], v[212:215], v[100:103]
  buffer_store_dword v79, v7, s[24:27], s33 offen offset:1152 nt
  v_mfma_f32_16x16x32_bf16 v[100:103], a[244:247], v[196:199], v[100:103]
  s_waitcnt lgkmcnt(0)
  v_mfma_f32_16x16x32_bf16 v[56:59], v[68:71], v[184:187], 0
  v_mfma_f32_16x16x32_bf16 v[56:59], v[80:83], v[200:203], v[56:59]
  v_mfma_f32_16x16x32_bf16 v[56:59], v[84:87], v[216:219], v[56:59]
  v_cvt_pk_bf16_f32 v60, v60, v100
  v_cvt_pk_bf16_f32 v61, v61, v101
  v_mfma_f32_16x16x32_bf16 v[56:59], v[88:91], v[232:235], v[56:59]
  v_cvt_pk_bf16_f32 v62, v62, v102
  v_cvt_pk_bf16_f32 v63, v63, v103
  v_mfma_f32_16x16x32_bf16 v[56:59], v[92:95], v[248:251], v[56:59]
  buffer_store_dword v60, v8, s[24:27], s33 offen offset:0 nt
  v_mfma_f32_16x16x32_bf16 v[56:59], v[96:99], a[224:227], v[56:59]
  v_mfma_f32_16x16x32_bf16 v[64:67], v[96:99], a[228:231], 0
  buffer_store_dword v61, v8, s[24:27], s33 offen offset:384 nt
  v_mfma_f32_16x16x32_bf16 v[64:67], v[92:95], v[252:255], v[64:67]
  v_mfma_f32_16x16x32_bf16 v[64:67], v[88:91], v[236:239], v[64:67]
  buffer_store_dword v62, v8, s[24:27], s33 offen offset:768 nt
  v_mfma_f32_16x16x32_bf16 v[64:67], v[84:87], v[220:223], v[64:67]
  v_mfma_f32_16x16x32_bf16 v[64:67], v[80:83], v[204:207], v[64:67]
  buffer_store_dword v63, v8, s[24:27], s33 offen offset:1152 nt
  v_mfma_f32_16x16x32_bf16 v[64:67], v[68:71], v[188:191], v[64:67]
  s_nop 7
  v_cvt_pk_bf16_f32 v56, v56, v64
  v_cvt_pk_bf16_f32 v57, v57, v65
  v_cvt_pk_bf16_f32 v58, v58, v66
  v_cvt_pk_bf16_f32 v59, v59, v67
  buffer_store_dword v56, v7, s[24:27], s34 offen offset:0 nt
  buffer_store_dword v57, v7, s[24:27], s34 offen offset:384 nt
  buffer_store_dword v58, v7, s[24:27], s34 offen offset:768 nt
  buffer_store_dword v59, v7, s[24:27], s34 offen offset:1152 nt
  s_cmp_lg_u32 s49, 0
  s_cbranch_scc1 L_safe
  s_endpgm
L_hop_2_2:
  s_cbranch_execz L_walk
L_pad4469:
L_k11:
  s_cmp_lg_u32 s59, 11
  s_cbranch_scc1 L_k12
  v_mfma_f32_16x16x32_bf16 v[104:107], a[0:3], v[88:91], 0
  v_mov_b32 v54, s12
  v_mov_b32 v55, s13
  v_mfma_f32_16x16x32_bf16 v[104:107], a[12:15], v[92:95], v[104:107]
  v_mov_b32 v74, 159808
  v_mfma_f32_16x16x32_bf16 v[104:107], a[24:27], v[96:99], v[104:107]
  v_cvt_pk_bf16_f32 v66, v128, v129
  v_cvt_pk_bf16_f32 v67, v130, v131
  v_mfma_f32_16x16x32_bf16 v[104:107], a[36:39], v[136:139], v[104:107]
  ds_read_b128 v[112:115], v74
  v_mfma_f32_16x16x32_bf16 v[104:107], a[48:51], v[140:143], v[104:107]
  s_waitcnt lgkmcnt(1)
  v_mfma_f32_16x16x32_bf16 v[104:107], a[60:63], v[80:83], v[104:107]
  v_mfma_f32_16x16x32_bf16 v[84:87], a[64:67], v[80:83], 0
  v_mfma_f32_16x16x32_bf16 v[84:87], a[52:55], v[140:143], v[84:87]
  v_mfma_f32_16x16x32_bf16 v[84:87], a[40:43], v[136:139], v[84:87]
  s_waitcnt lgkmcnt(0)
  v_mul_f32 v104, s42, v104
  v_mul_f32 v105, s42, v105
  v_mfma_f32_16x16x32_bf16 v[84:87], a[28:31], v[96:99], v[84:87]
  v_mul_f32 v106, s42, v106
  v_mul_f32 v107, s42, v107
  v_mfma_f32_16x16x32_bf16 v[84:87], a[16:19], v[92:95], v[84:87]
  v_cvt_pk_bf16_f32 v18, v104, v105
  v_cvt_pk_bf16_f32 v19, v106, v107
  v_mfma_f32_16x16x32_bf16 v[84:87], a[4:7], v[88:91], v[84:87]
  v_and_b32 v112, v112, v113
  v_and_b32 v114, v114, v115
  v_mfma_f32_16x16x32_bf16 v[108:111], a[8:11], v[88:91], 0
  v_and_b32 v112, v112, v114
  v_mfma_f32_16x16x32_bf16 v[108:111], a[20:23], v[92:95], v[108:111]
  v_readfirstlane_b32 s49, v112
  v_mfma_f32_16x16x32_bf16 v[108:111], a[32:35], v[96:99], v[108:111]
  v_mul_f32 v84, s42, v84
  v_mul_f32 v85, s42, v85
  v_mfma_f32_16x16x32_bf16 v[108:111], a[44:47], v[136:139], v[108:111]
  s_cmp_lg_u32 s49, 0
  v_mul_f32 v86, s42, v86
  v_mul_f32 v87, s42, v87
  v_mfma_f32_16x16x32_bf16 v[108:111], a[56:59], v[140:143], v[108:111]
  s_cselect_b32 s49, s44, s22
  v_cvt_pk_bf16_f32 v104, v84, v85
  v_cvt_pk_bf16_f32 v105, v86, v87
  v_mfma_f32_16x16x32_bf16 v[108:111], a[68:71], v[80:83], v[108:111]
  s_cselect_b32 s96, 4096, s96
  v_mfma_f32_16x16x32_bf16 v[112:115], a[132:135], v[80:83], 0
  buffer_store_dwordx2 v[54:55], off, s[20:23], s49 sc1
  v_mfma_f32_16x16x32_bf16 v[112:115], a[120:123], v[140:143], v[112:115]
  s_branch L_r227
L_k12:
  s_cmp_lg_u32 s45, 2
  s_cbranch_scc1 L_k12g
  v_mfma_f32_16x16x32_bf16 v[104:107], a[0:3], v[88:91], 0
  s_sub_u32 s49, s44, 2097152
  s_lshr_b32 s49, s49, 9
  s_lshr_b32 s52, s49, 6
  v_mfma_f32_16x16x32_bf16 v[104:107], a[12:15], v[92:95], v[104:107]
  s_and_b32 s53, s49, 63
  s_mul_i32 s50, s52, 15
  s_lshl_b32 s51, s57, 5
  v_mfma_f32_16x16x32_bf16 v[104:107], a[24:27], v[96:99], v[104:107]
  s_cmp_eq_u32 s53, 63
  v_cvt_pk_bf16_f32 v66, v128, v129
  v_cvt_pk_bf16_f32 v67, v130, v131
  v_mfma_f32_16x16x32_bf16 v[104:107], a[36:39], v[136:139], v[104:107]
  s_cselect_b32 s53, s50, s53
  s_cselect_b32 s52, 60, s52
  s_cselect_b32 s51, 3072, s51
  v_mfma_f32_16x16x32_bf16 v[104:107], a[48:51], v[140:143], v[104:107]
  s_waitcnt lgkmcnt(0)
  s_mul_i32 s52, s52, 1572864
  s_mul_i32 s53, s53, 3072
  v_mfma_f32_16x16x32_bf16 v[104:107], a[60:63], v[80:83], v[104:107]
  s_add_u32 s52, s52, s53
  s_add_u32 s50, s52, 787968
  s_cmp_eq_u32 s51, 3072
  v_mfma_f32_16x16x32_bf16 v[84:87], a[64:67], v[80:83], 0
  s_cselect_b32 s10, 100663296, s10
  s_sub_u32 s51, s51, s43
  s_mul_i32 s51, s51, 14
  v_mfma_f32_16x16x32_bf16 v[84:87], a[52:55], v[140:143], v[84:87]
  s_sub_u32 s50, s50, s56
  s_add_u32 s58, s50, s51
  s_mul_i32 s50, s14, 98304
  v_mfma_f32_16x16x32_bf16 v[84:87], a[40:43], v[136:139], v[84:87]
  s_add_u32 s98, s58, s50
  v_mul_f32 v104, s42, v104
  v_mul_f32 v105, s42, v105
  v_mfma_f32_16x16x32_bf16 v[84:87], a[28:31], v[96:99], v[84:87]
  s_sub_u32 s49, s98, s43
  v_mul_f32 v106, s42, v106
  v_mul_f32 v107, s42, v107
  v_mfma_f32_16x16x32_bf16 v[84:87], a[16:19], v[92:95], v[84:87]
  s_add_u32 s31, s31, s49
  v_cvt_pk_bf16_f32 v18, v104, v105
  v_cvt_pk_bf16_f32 v19, v106, v107
  v_mfma_f32_16x16x32_bf16 v[84:87], a[4:7], v[88:91], v[84:87]
  s_add_u32 s32, s32, s49
  s_lshl_b32 s50, s50, 1
  s_sub_u32 s32, s32, s50
  v_mfma_f32_16x16x32_bf16 v[108:111], a[8:11], v[88:91], 0
  s_sub_u32 s37, s37, s49
  s_sub_u32 s38, s38, s49
  s_sub_u32 s39, s39, s49
  v_mfma_f32_16x16x32_bf16 v[108:111], a[20:23], v[92:95], v[108:111]
  s_sub_u32 s40, s40, s49
  s_lshl_b32 s49, s14, 2
  s_add_u32 s97, s49, 15
  v_mfma_f32_16x16x32_bf16 v[108:111], a[32:35], v[96:99], v[108:111]
  s_mov_b32 s45, 4
  v_mul_f32 v84, s42, v84
  v_mul_f32 v85, s42, v85
  v_mfma_f32_16x16x32_bf16 v[108:111], a[44:47], v[136:139], v[108:111]
  s_mov_b32 s96, 32768
  v_mul_f32 v86, s42, v86
  v_mul_f32 v87, s42, v87
  v_mfma_f32_16x16x32_bf16 v[108:111], a[56:59], v[140:143], v[108:111]
  s_mov_b64 s[100:101], -1
  v_cvt_pk_bf16_f32 v104, v84, v85
  v_cvt_pk_bf16_f32 v105, v86, v87
  v_mfma_f32_16x16x32_bf16 v[108:111], a[68:71], v[80:83], v[108:111]
  s_branch L_r225
L_k12g:
  s_cmp_lg_u32 s59, 12
  s_cbranch_scc1 L_k13
  s_waitcnt vmcnt(30)
  v_mfma_f32_16x16x32_bf16 v[104:107], a[0:3], v[88:91], 0
  v_cmp_eq_u64 vcc, s[12:13], v[52:53]
  v_mfma_f32_16x16x32_bf16 v[104:107], a[12:15], v[92:95], v[104:107]
  v_mfma_f32_16x16x32_bf16 v[104:107], a[24:27], v[96:99], v[104:107]
  s_and_b32 s49, vcc_lo, 1
  v_cvt_pk_bf16_f32 v66, v128, v129
  v_cvt_pk_bf16_f32 v67, v130, v131
  v_mfma_f32_16x16x32_bf16 v[104:107], a[36:39], v[136:139], v[104:107]
  s_lshl_b32 s49, s49, s14
  s_lshl_b32 s54, s3, 2
  s_add_u32 s54, s54, 159824
  v_mfma_f32_16x16x32_bf16 v[104:107], a[48:51], v[140:143], v[104:107]
  s_waitcnt lgkmcnt(0)
  v_mov_b32 v54, s54
  v_mov_b32 v55, s49
  v_mfma_f32_16x16x32_bf16 v[104:107], a[60:63], v[80:83], v[104:107]
  ds_write_b32 v54, v55
  v_mfma_f32_16x16x32_bf16 v[84:87], a[64:67], v[80:83], 0
  v_mfma_f32_16x16x32_bf16 v[84:87], a[52:55], v[140:143], v[84:87]
  v_mfma_f32_16x16x32_bf16 v[84:87], a[40:43], v[136:139], v[84:87]
  v_mul_f32 v104, s42, v104
  v_mul_f32 v105, s42, v105
  v_mfma_f32_16x16x32_bf16 v[84:87], a[28:31], v[96:99], v[84:87]
  s_waitcnt lgkmcnt(0)
  v_mul_f32 v106, s42, v106
  v_mul_f32 v107, s42, v107
  v_mfma_f32_16x16x32_bf16 v[84:87], a[16:19], v[92:95], v[84:87]
  v_cvt_pk_bf16_f32 v18, v104, v105
  v_cvt_pk_bf16_f32 v19, v106, v107
  v_mfma_f32_16x16x32_bf16 v[84:87], a[4:7], v[88:91], v[84:87]
  s_branch L_r219
L_k13:
  v_mov_b32 v54, 159824
  ds_read_b128 v[84:87], v54
  s_waitcnt lgkmcnt(0)
  v_and_b32 v84, v84, v85
  v_and_b32 v86, v86, v87
  v_and_b32 v84, v84, v86
  s_nop 0
  v_readfirstlane_b32 s49, v84
  s_nop 3
  s_lshr_b32 s50, s49, 3
  s_add_u32 s97, s97, s50
  s_cmp_eq_u32 s49, 1
  s_cselect_b32 s45, 3, 0
  s_cbranch_scc1 L_full
  s_branch L_loop
L_safe:
  s_nop 15
  s_waitcnt vmcnt(0) lgkmcnt(0)
  s_mov_b32 s10, 100663296
  v_mbcnt_lo_u32_b32 v58, -1, 0
  v_mbcnt_hi_u32_b32 v58, -1, v58
  v_lshrrev_b32 v59, 2, v58
  v_and_b32 v59, 4, v59
  v_xor_b32 v60, v59, v58
  s_cmp_eq_u32 s47, 63
  s_cselect_b32 s5, 4, 0
  v_and_b32 v60, s5, v60
  v_cmp_eq_u32 vcc, 0, v60
  s_cmp_eq_u32 s48, 63
  s_cselect_b32 s5, 0xc31044fe, 0
  v_mov_b32 v55, s5
  v_mov_b32 v54, 0xc31044fe
  v_cndmask_b32 v55, 0, v55, vcc
  v_cndmask_b32 v54, v54, 0, vcc
  v_add_u32 v0, s46, v2
  v_xor_b32 v1, 64, v0
  s_lshl_b32 s5, s48, 3
  s_add_u32 s5, s5, s3
  s_add_u32 s5, s5, 4
  s_mul_i32 s31, s5, s57
  s_add_u32 s5, s5, 4
  s_and_b32 s5, s5, 511
  s_mul_i32 s32, s5, s57
  v_lshrrev_b32 v59, 2, v59
  s_lshl_b32 s5, s47, 3
  s_add_u32 s5, s5, 4
  s_mul_i32 s5, s5, 384
  s_cmp_eq_u32 s47, 63
  s_cselect_b32 s49, 0, s5
  s_cselect_b32 s5, s5, 0
  s_cselect_b32 s6, s57, 0
  v_mul_u32_u24 v57, s6, v59
  v_sub_u32 v57, s5, v57
  s_lshl_b32 s50, s48, 3
  s_add_u32 s50, s50, 4
  s_xor_b32 s6, s4, 0
  s_lshl_b32 s6, s6, 1
  s_add_u32 s6, s6, s50
  s_and_b32 s6, s6, 511
  s_mul_i32 s6, s6, s57
  s_add_u32 s33, s6, s49
  s_xor_b32 s6, s4, 1
  s_lshl_b32 s6, s6, 1
  s_add_u32 s6, s6, s50
  s_and_b32 s6, s6, 511
  s_mul_i32 s6, s6, s57
  s_add_u32 s34, s6, s49
  s_xor_b32 s6, s4, 2
  s_lshl_b32 s6, s6, 1
  s_add_u32 s6, s6, s50
  s_and_b32 s6, s6, 511
  s_mul_i32 s6, s6, s57
  s_add_u32 s35, s6, s49
  s_xor_b32 s6, s4, 3
  s_lshl_b32 s6, s6, 1
  s_add_u32 s6, s6, s50
  s_and_b32 s6, s6, 511
  s_mul_i32 s6, s6, s57
  s_add_u32 s36, s6, s49
  s_lshl_b32 s5, s47, 3
  s_add_u32 s5, s5, 4
  v_lshrrev_b32 v59, 3, v58
  v_add_u32 v60, s5, v59
  v_and_b32 v60, 511, v60
  v_sub_u32 v60, v60, v59
  v_mul_i32_i24 v56, 0x180, v60
  v_add_u32 v6, v6, v56
  v_add_u32 v7, v7, v57
  v_add_u32 v8, v8, v57
  v_add_f32 v55, v54, v55
  s_cmp_eq_u32 s45, 3
  s_cselect_b32 s49, 15, 16
  s_cmp_eq_u32 s45, 4
  s_cselect_b32 s49, 17, s49
  s_mov_b32 s50, 0
  s_sub_u32 s56, s56, s43
  s_nop 7
L_sloop:
  s_barrier
  s_add_u32 m0, s46, 0
  s_nop 0
  buffer_load_dwordx4 v6, s[8:11], s31 offen offset:0 nt lds
  s_add_u32 m0, s46, 8064
  s_nop 0
  buffer_load_dwordx4 v6, s[8:11], s31 offen offset:128 nt lds
  s_add_u32 m0, s46, 16128
  s_nop 0
  buffer_load_dwordx4 v6, s[8:11], s31 offen offset:256 nt lds
  s_add_u32 m0, s46, 4096
  s_nop 0
  buffer_load_dwordx4 v6, s[8:11], s32 offen offset:0 nt lds
  s_add_u32 m0, s46, 12160
  s_nop 0
  buffer_load_dwordx4 v6, s[8:11], s32 offen offset:128 nt lds
  s_add_u32 m0, s46, 20224
  s_nop 0
  buffer_load_dwordx4 v6, s[8:11], s32 offen offset:256 nt lds
  s_waitcnt vmcnt(0)
  s_barrier
  ds_read_b128 a[244:247], v0 offset:0
  ds_read_b128 a[248:251], v1 offset:0
  ds_read_b128 a[252:255], v0 offset:8192
  ds_read_b128 v[76:79], v1 offset:8192
  ds_read_b128 v[80:83], v0 offset:16384
  ds_read_b128 v[84:87], v1 offset:16384
  s_waitcnt lgkmcnt(5)
  v_mfma_f32_16x16x32_bf16 v[68:71], a[0:3], a[244:247], 0
  s_waitcnt lgkmcnt(4)
  v_mfma_f32_16x16x32_bf16 v[68:71], a[12:15], a[248:251], v[68:71]
  s_waitcnt lgkmcnt(3)
  v_mfma_f32_16x16x32_bf16 v[68:71], a[24:27], a[252:255], v[68:71]
  s_waitcnt lgkmcnt(2)
  v_mfma_f32_16x16x32_bf16 v[68:71], a[36:39], v[76:79], v[68:71]
  s_waitcnt lgkmcnt(1)
  v_mfma_f32_16x16x32_bf16 v[68:71], a[48:51], v[80:83], v[68:71]
  s_waitcnt lgkmcnt(0)
  v_mfma_f32_16x16x32_bf16 v[68:71], a[60:63], v[84:87], v[68:71]
  v_mfma_f32_16x16x32_bf16 v[60:63], a[64:67], v[84:87], 0
  v_mfma_f32_16x16x32_bf16 v[60:63], a[52:55], v[80:83], v[60:63]
  v_mfma_f32_16x16x32_bf16 v[60:63], a[40:43], v[76:79], v[60:63]
  v_mfma_f32_16x16x32_bf16 v[60:63], a[28:31], a[252:255], v[60:63]
  v_mfma_f32_16x16x32_bf16 v[60:63], a[16:19], a[248:251], v[60:63]
  v_mfma_f32_16x16x32_bf16 v[60:63], a[4:7], a[244:247], v[60:63]
  v_mul_f32 v68, s42, v68
  v_mul_f32 v69, s42, v69
  v_mul_f32 v70, s42, v70
  v_mul_f32 v71, s42, v71
  v_cvt_pk_bf16_f32 v12, v68, v69
  v_cvt_pk_bf16_f32 v13, v70, v71
  v_mfma_f32_16x16x32_bf16 v[64:67], a[8:11], a[244:247], 0
  v_mfma_f32_16x16x32_bf16 v[64:67], a[20:23], a[248:251], v[64:67]
  v_mfma_f32_16x16x32_bf16 v[64:67], a[32:35], a[252:255], v[64:67]
  v_mfma_f32_16x16x32_bf16 v[64:67], a[44:47], v[76:79], v[64:67]
  v_mfma_f32_16x16x32_bf16 v[64:67], a[56:59], v[80:83], v[64:67]
  v_mfma_f32_16x16x32_bf16 v[64:67], a[68:71], v[84:87], v[64:67]
  v_mul_f32 v60, s42, v60
  v_mul_f32 v61, s42, v61
  v_mul_f32 v62, s42, v62
  v_mul_f32 v63, s42, v63
  v_cvt_pk_bf16_f32 v128, v60, v61
  v_cvt_pk_bf16_f32 v129, v62, v63
  v_mfma_f32_16x16x32_bf16 v[68:71], a[132:135], v[84:87], 0
  v_mfma_f32_16x16x32_bf16 v[68:71], a[120:123], v[80:83], v[68:71]
  v_mfma_f32_16x16x32_bf16 v[68:71], a[108:111], v[76:79], v[68:71]
  v_mfma_f32_16x16x32_bf16 v[68:71], a[96:99], a[252:255], v[68:71]
  v_mfma_f32_16x16x32_bf16 v[68:71], a[84:87], a[248:251], v[68:71]
  v_mfma_f32_16x16x32_bf16 v[68:71], a[72:75], a[244:247], v[68:71]
  v_mul_f32 v64, s42, v64
  v_mul_f32 v65, s42, v65
  v_mul_f32 v66, s42, v66
  v_mul_f32 v67, s42, v67
  v_cvt_pk_bf16_f32 v130, v64, v65
  v_cvt_pk_bf16_f32 v131, v66, v67
  v_mfma_f32_16x16x32_bf16 v[72:75], a[76:79], a[244:247], 0
  v_mfma_f32_16x16x32_bf16 v[72:75], a[88:91], a[248:251], v[72:75]
  v_mfma_f32_16x16x32_bf16 v[72:75], a[100:103], a[252:255], v[72:75]
  v_mfma_f32_16x16x32_bf16 v[72:75], a[112:115], v[76:79], v[72:75]
  v_mfma_f32_16x16x32_bf16 v[72:75], a[124:127], v[80:83], v[72:75]
  v_mfma_f32_16x16x32_bf16 v[72:75], a[136:139], v[84:87], v[72:75]
  v_cvt_pk_bf16_f32 v60, v68, v69
  v_cvt_pk_bf16_f32 v61, v70, v71
  v_mfma_f32_16x16x32_bf16 v[88:91], a[140:143], v[84:87], 0
  v_mfma_f32_16x16x32_bf16 v[88:91], a[128:131], v[80:83], v[88:91]
  v_mfma_f32_16x16x32_bf16 v[88:91], a[116:119], v[76:79], v[88:91]
  v_mfma_f32_16x16x32_bf16 v[88:91], a[104:107], a[252:255], v[88:91]
  v_mfma_f32_16x16x32_bf16 v[88:91], a[92:95], a[248:251], v[88:91]
  v_mfma_f32_16x16x32_bf16 v[88:91], a[80:83], a[244:247], v[88:91]
  v_cvt_pk_bf16_f32 v62, v72, v73
  v_cvt_pk_bf16_f32 v63, v74, v75
  v_mfma_f32_16x16x32_bf16 v[92:95], a[244:247], a[144:147], 0
  v_mfma_f32_16x16x32_bf16 v[92:95], a[248:251], a[156:159], v[92:95]
  v_mfma_f32_16x16x32_bf16 v[92:95], a[252:255], a[168:171], v[92:95]
  v_mfma_f32_16x16x32_bf16 v[92:95], v[76:79], a[180:183], v[92:95]
  v_mfma_f32_16x16x32_bf16 v[92:95], v[80:83], a[192:195], v[92:95]
  v_mfma_f32_16x16x32_bf16 v[92:95], v[84:87], a[204:207], v[92:95]
  v_cvt_pk_bf16_f32 v64, v88, v89
  v_cvt_pk_bf16_f32 v65, v90, v91
  v_mfma_f32_16x16x32_bf16 v[96:99], v[84:87], a[208:211], 0
  v_mfma_f32_16x16x32_bf16 v[96:99], v[80:83], a[196:199], v[96:99]
  v_mfma_f32_16x16x32_bf16 v[96:99], v[76:79], a[184:187], v[96:99]
  v_mfma_f32_16x16x32_bf16 v[96:99], a[252:255], a[172:175], v[96:99]
  v_mfma_f32_16x16x32_bf16 v[96:99], a[248:251], a[160:163], v[96:99]
  v_mfma_f32_16x16x32_bf16 v[96:99], a[244:247], a[148:151], v[96:99]
  v_cvt_pk_bf16_f32 v68, v92, v93
  v_cvt_pk_bf16_f32 v69, v94, v95
  v_mfma_f32_16x16x32_bf16 v[104:107], a[244:247], a[152:155], 0
  v_mfma_f32_16x16x32_bf16 v[104:107], a[248:251], a[164:167], v[104:107]
  v_mfma_f32_16x16x32_bf16 v[104:107], a[252:255], a[176:179], v[104:107]
  v_mfma_f32_16x16x32_bf16 v[104:107], v[76:79], a[188:191], v[104:107]
  v_mfma_f32_16x16x32_bf16 v[104:107], v[80:83], a[200:203], v[104:107]
  v_mfma_f32_16x16x32_bf16 v[104:107], v[84:87], a[212:215], v[104:107]
  v_cvt_pk_bf16_f32 v72, v96, v97
  v_cvt_pk_bf16_f32 v73, v98, v99
  s_nop 5
  v_cvt_pk_bf16_f32 v76, v104, v105
  v_cvt_pk_bf16_f32 v77, v106, v107
  ds_read_b128 a[244:247], v0 offset:2048
  ds_read_b128 a[248:251], v1 offset:2048
  ds_read_b128 a[252:255], v0 offset:10240
  ds_read_b128 v[88:91], v1 offset:10240
  ds_read_b128 v[92:95], v0 offset:18432
  ds_read_b128 v[96:99], v1 offset:18432
  s_waitcnt lgkmcnt(5)
  v_mfma_f32_16x16x32_bf16 v[100:103], a[0:3], a[244:247], 0
  s_waitcnt lgkmcnt(4)
  v_mfma_f32_16x16x32_bf16 v[100:103], a[12:15], a[248:251], v[100:103]
  s_waitcnt lgkmcnt(3)
  v_mfma_f32_16x16x32_bf16 v[100:103], a[24:27], a[252:255], v[100:103]
  s_waitcnt lgkmcnt(2)
  v_mfma_f32_16x16x32_bf16 v[100:103], a[36:39], v[88:91], v[100:103]
  s_waitcnt lgkmcnt(1)
  v_mfma_f32_16x16x32_bf16 v[100:103], a[48:51], v[92:95], v[100:103]
  s_waitcnt lgkmcnt(0)
  v_mfma_f32_16x16x32_bf16 v[100:103], a[60:63], v[96:99], v[100:103]
  v_mfma_f32_16x16x32_bf16 v[80:83], a[64:67], v[96:99], 0
  v_mfma_f32_16x16x32_bf16 v[80:83], a[52:55], v[92:95], v[80:83]
  v_mfma_f32_16x16x32_bf16 v[80:83], a[40:43], v[88:91], v[80:83]
  v_mfma_f32_16x16x32_bf16 v[80:83], a[28:31], a[252:255], v[80:83]
  v_mfma_f32_16x16x32_bf16 v[80:83], a[16:19], a[248:251], v[80:83]
  v_mfma_f32_16x16x32_bf16 v[80:83], a[4:7], a[244:247], v[80:83]
  v_mul_f32 v100, s42, v100
  v_mul_f32 v101, s42, v101
  v_mul_f32 v102, s42, v102
  v_mul_f32 v103, s42, v103
  v_cvt_pk_bf16_f32 v124, v100, v101
  v_cvt_pk_bf16_f32 v125, v102, v103
  v_mfma_f32_16x16x32_bf16 v[84:87], a[8:11], a[244:247], 0
  v_mfma_f32_16x16x32_bf16 v[84:87], a[20:23], a[248:251], v[84:87]
  v_mfma_f32_16x16x32_bf16 v[84:87], a[32:35], a[252:255], v[84:87]
  v_mfma_f32_16x16x32_bf16 v[84:87], a[44:47], v[88:91], v[84:87]
  v_mfma_f32_16x16x32_bf16 v[84:87], a[56:59], v[92:95], v[84:87]
  v_mfma_f32_16x16x32_bf16 v[84:87], a[68:71], v[96:99], v[84:87]
  v_mul_f32 v80, s42, v80
  v_mul_f32 v81, s42, v81
  v_mul_f32 v82, s42, v82
  v_mul_f32 v83, s42, v83
  v_cvt_pk_bf16_f32 v126, v80, v81
  v_cvt_pk_bf16_f32 v127, v82, v83
  v_mfma_f32_16x16x32_bf16 v[100:103], a[132:135], v[96:99], 0
  v_mfma_f32_16x16x32_bf16 v[100:103], a[120:123], v[92:95], v[100:103]
  v_mfma_f32_16x16x32_bf16 v[100:103], a[108:111], v[88:91], v[100:103]
  v_mfma_f32_16x16x32_bf16 v[100:103], a[96:99], a[252:255], v[100:103]
  v_mfma_f32_16x16x32_bf16 v[100:103], a[84:87], a[248:251], v[100:103]
  v_mfma_f32_16x16x32_bf16 v[100:103], a[72:75], a[244:247], v[100:103]
  v_mul_f32 v84, s42, v84
  v_mul_f32 v85, s42, v85
  v_mul_f32 v86, s42, v86
  v_mul_f32 v87, s42, v87
  v_cvt_pk_bf16_f32 v16, v84, v85
  v_cvt_pk_bf16_f32 v17, v86, v87
  v_mfma_f32_16x16x32_bf16 v[104:107], a[76:79], a[244:247], 0
  v_mfma_f32_16x16x32_bf16 v[104:107], a[88:91], a[248:251], v[104:107]
  v_mfma_f32_16x16x32_bf16 v[104:107], a[100:103], a[252:255], v[104:107]
  v_mfma_f32_16x16x32_bf16 v[104:107], a[112:115], v[88:91], v[104:107]
  v_mfma_f32_16x16x32_bf16 v[104:107], a[124:127], v[92:95], v[104:107]
  v_mfma_f32_16x16x32_bf16 v[104:107], a[136:139], v[96:99], v[104:107]
  v_cvt_pk_bf16_f32 v80, v100, v101
  v_cvt_pk_bf16_f32 v81, v102, v103
  v_mfma_f32_16x16x32_bf16 v[108:111], a[140:143], v[96:99], 0
  v_mfma_f32_16x16x32_bf16 v[108:111], a[128:131], v[92:95], v[108:111]
  v_mfma_f32_16x16x32_bf16 v[108:111], a[116:119], v[88:91], v[108:111]
  v_mfma_f32_16x16x32_bf16 v[108:111], a[104:107], a[252:255], v[108:111]
  v_mfma_f32_16x16x32_bf16 v[108:111], a[92:95], a[248:251], v[108:111]
  v_mfma_f32_16x16x32_bf16 v[108:111], a[80:83], a[244:247], v[108:111]
  v_cvt_pk_bf16_f32 v82, v104, v105
  v_cvt_pk_bf16_f32 v83, v106, v107
  v_mfma_f32_16x16x32_bf16 v[100:103], a[244:247], a[144:147], 0
  v_mfma_f32_16x16x32_bf16 v[100:103], a[248:251], a[156:159], v[100:103]
  v_mfma_f32_16x16x32_bf16 v[100:103], a[252:255], a[168:171], v[100:103]
  v_mfma_f32_16x16x32_bf16 v[100:103], v[88:91], a[180:183], v[100:103]
  v_mfma_f32_16x16x32_bf16 v[100:103], v[92:95], a[192:195], v[100:103]
  v_mfma_f32_16x16x32_bf16 v[100:103], v[96:99], a[204:207], v[100:103]
  v_cvt_pk_bf16_f32 v84, v108, v109
  v_cvt_pk_bf16_f32 v85, v110, v111
  v_mfma_f32_16x16x32_bf16 v[104:107], v[96:99], a[208:211], 0
  v_mfma_f32_16x16x32_bf16 v[104:107], v[92:95], a[196:199], v[104:107]
  v_mfma_f32_16x16x32_bf16 v[104:107], v[88:91], a[184:187], v[104:107]
  v_mfma_f32_16x16x32_bf16 v[104:107], a[252:255], a[172:175], v[104:107]
  v_mfma_f32_16x16x32_bf16 v[104:107], a[248:251], a[160:163], v[104:107]
  v_mfma_f32_16x16x32_bf16 v[104:107], a[244:247], a[148:151], v[104:107]
  v_cvt_pk_bf16_f32 v70, v100, v101
  v_cvt_pk_bf16_f32 v71, v102, v103
  v_mfma_f32_16x16x32_bf16 v[116:119], a[244:247], a[152:155], 0
  v_mfma_f32_16x16x32_bf16 v[116:119], a[248:251], a[164:167], v[116:119]
  v_mfma_f32_16x16x32_bf16 v[116:119], a[252:255], a[176:179], v[116:119]
  v_mfma_f32_16x16x32_bf16 v[116:119], v[88:91], a[188:191], v[116:119]
  v_mfma_f32_16x16x32_bf16 v[116:119], v[92:95], a[200:203], v[116:119]
  v_mfma_f32_16x16x32_bf16 v[116:119], v[96:99], a[212:215], v[116:119]
  v_cvt_pk_bf16_f32 v74, v104, v105
  v_cvt_pk_bf16_f32 v75, v106, v107
  s_nop 5
  v_cvt_pk_bf16_f32 v78, v116, v117
  v_cvt_pk_bf16_f32 v79, v118, v119
  ds_read_b128 a[244:247], v0 offset:4096
  ds_read_b128 a[248:251], v1 offset:4096
  ds_read_b128 a[252:255], v0 offset:12288
  ds_read_b128 v[100:103], v1 offset:12288
  ds_read_b128 v[108:111], v0 offset:20480
  ds_read_b128 v[112:115], v1 offset:20480
  s_waitcnt lgkmcnt(5)
  v_mfma_f32_16x16x32_bf16 v[96:99], a[0:3], a[244:247], 0
  s_waitcnt lgkmcnt(4)
  v_mfma_f32_16x16x32_bf16 v[96:99], a[12:15], a[248:251], v[96:99]
  s_waitcnt lgkmcnt(3)
  v_mfma_f32_16x16x32_bf16 v[96:99], a[24:27], a[252:255], v[96:99]
  s_waitcnt lgkmcnt(2)
  v_mfma_f32_16x16x32_bf16 v[96:99], a[36:39], v[100:103], v[96:99]
  s_waitcnt lgkmcnt(1)
  v_mfma_f32_16x16x32_bf16 v[96:99], a[48:51], v[108:111], v[96:99]
  s_waitcnt lgkmcnt(0)
  v_mfma_f32_16x16x32_bf16 v[96:99], a[60:63], v[112:115], v[96:99]
  v_mfma_f32_16x16x32_bf16 v[88:91], a[64:67], v[112:115], 0
  v_mfma_f32_16x16x32_bf16 v[88:91], a[52:55], v[108:111], v[88:91]
  v_mfma_f32_16x16x32_bf16 v[88:91], a[40:43], v[100:103], v[88:91]
  v_mfma_f32_16x16x32_bf16 v[88:91], a[28:31], a[252:255], v[88:91]
  v_mfma_f32_16x16x32_bf16 v[88:91], a[16:19], a[248:251], v[88:91]
  v_mfma_f32_16x16x32_bf16 v[88:91], a[4:7], a[244:247], v[88:91]
  v_mul_f32 v96, s42, v96
  v_mul_f32 v97, s42, v97
  v_mul_f32 v98, s42, v98
  v_mul_f32 v99, s42, v99
  v_cvt_pk_bf16_f32 v18, v96, v97
  v_cvt_pk_bf16_f32 v19, v98, v99
  v_mfma_f32_16x16x32_bf16 v[92:95], a[8:11], a[244:247], 0
  v_mfma_f32_16x16x32_bf16 v[92:95], a[20:23], a[248:251], v[92:95]
  v_mfma_f32_16x16x32_bf16 v[92:95], a[32:35], a[252:255], v[92:95]
  v_mfma_f32_16x16x32_bf16 v[92:95], a[44:47], v[100:103], v[92:95]
  v_mfma_f32_16x16x32_bf16 v[92:95], a[56:59], v[108:111], v[92:95]
  v_mfma_f32_16x16x32_bf16 v[92:95], a[68:71], v[112:115], v[92:95]
  v_mul_f32 v88, s42, v88
  v_mul_f32 v89, s42, v89
  v_mul_f32 v90, s42, v90
  v_mul_f32 v91, s42, v91
  v_cvt_pk_bf16_f32 v120, v88, v89
  v_cvt_pk_bf16_f32 v121, v90, v91
  v_mfma_f32_16x16x32_bf16 v[96:99], a[132:135], v[112:115], 0
  v_mfma_f32_16x16x32_bf16 v[96:99], a[120:123], v[108:111], v[96:99]
  v_mfma_f32_16x16x32_bf16 v[96:99], a[108:111], v[100:103], v[96:99]
  v_mfma_f32_16x16x32_bf16 v[96:99], a[96:99], a[252:255], v[96:99]
  v_mfma_f32_16x16x32_bf16 v[96:99], a[84:87], a[248:251], v[96:99]
  v_mfma_f32_16x16x32_bf16 v[96:99], a[72:75], a[244:247], v[96:99]
  v_mul_f32 v92, s42, v92
  v_mul_f32 v93, s42, v93
  v_mul_f32 v94, s42, v94
  v_mul_f32 v95, s42, v95
  v_cvt_pk_bf16_f32 v122, v92, v93
  v_cvt_pk_bf16_f32 v123, v94, v95
  v_mfma_f32_16x16x32_bf16 v[104:107], a[76:79], a[244:247], 0
  v_mfma_f32_16x16x32_bf16 v[104:107], a[88:91], a[248:251], v[104:107]
  v_mfma_f32_16x16x32_bf16 v[104:107], a[100:103], a[252:255], v[104:107]
  v_mfma_f32_16x16x32_bf16 v[104:107], a[112:115], v[100:103], v[104:107]
  v_mfma_f32_16x16x32_bf16 v[104:107], a[124:127], v[108:111], v[104:107]
  v_mfma_f32_16x16x32_bf16 v[104:107], a[136:139], v[112:115], v[104:107]
  v_cvt_pk_bf16_f32 v88, v96, v97
  v_cvt_pk_bf16_f32 v89, v98, v99
  v_mfma_f32_16x16x32_bf16 v[116:119], a[140:143], v[112:115], 0
  v_mfma_f32_16x16x32_bf16 v[116:119], a[128:131], v[108:111], v[116:119]
  v_mfma_f32_16x16x32_bf16 v[116:119], a[116:119], v[100:103], v[116:119]
  v_mfma_f32_16x16x32_bf16 v[116:119], a[104:107], a[252:255], v[116:119]
  v_mfma_f32_16x16x32_bf16 v[116:119], a[92:95], a[248:251], v[116:119]
  v_mfma_f32_16x16x32_bf16 v[116:119], a[80:83], a[244:247], v[116:119]
  v_cvt_pk_bf16_f32 v90, v104, v105
  v_cvt_pk_bf16_f32 v91, v106, v107
  v_mfma_f32_16x16x32_bf16 v[132:135], a[244:247], a[144:147], 0
  v_mfma_f32_16x16x32_bf16 v[132:135], a[248:251], a[156:159], v[132:135]
  v_mfma_f32_16x16x32_bf16 v[132:135], a[252:255], a[168:171], v[132:135]
  v_mfma_f32_16x16x32_bf16 v[132:135], v[100:103], a[180:183], v[132:135]
  v_mfma_f32_16x16x32_bf16 v[132:135], v[108:111], a[192:195], v[132:135]
  v_mfma_f32_16x16x32_bf16 v[132:135], v[112:115], a[204:207], v[132:135]
  v_cvt_pk_bf16_f32 v92, v116, v117
  v_cvt_pk_bf16_f32 v93, v118, v119
  v_mfma_f32_16x16x32_bf16 v[136:139], v[112:115], a[208:211], 0
  v_mfma_f32_16x16x32_bf16 v[136:139], v[108:111], a[196:199], v[136:139]
  v_mfma_f32_16x16x32_bf16 v[136:139], v[100:103], a[184:187], v[136:139]
  v_mfma_f32_16x16x32_bf16 v[136:139], a[252:255], a[172:175], v[136:139]
  v_mfma_f32_16x16x32_bf16 v[136:139], a[248:251], a[160:163], v[136:139]
  v_mfma_f32_16x16x32_bf16 v[136:139], a[244:247], a[148:151], v[136:139]
  v_cvt_pk_bf16_f32 v96, v132, v133
  v_cvt_pk_bf16_f32 v97, v134, v135
  v_mfma_f32_16x16x32_bf16 v[116:119], a[244:247], a[152:155], 0
  v_mfma_f32_16x16x32_bf16 v[116:119], a[248:251], a[164:167], v[116:119]
  v_mfma_f32_16x16x32_bf16 v[116:119], a[252:255], a[176:179], v[116:119]
  v_mfma_f32_16x16x32_bf16 v[116:119], v[100:103], a[188:191], v[116:119]
  v_mfma_f32_16x16x32_bf16 v[116:119], v[108:111], a[200:203], v[116:119]
  v_mfma_f32_16x16x32_bf16 v[116:119], v[112:115], a[212:215], v[116:119]
  v_cvt_pk_bf16_f32 v104, v136, v137
  v_cvt_pk_bf16_f32 v105, v138, v139
  s_nop 5
  v_cvt_pk_bf16_f32 v100, v116, v117
  v_cvt_pk_bf16_f32 v101, v118, v119
  ds_read_b128 a[244:247], v0 offset:6144
  ds_read_b128 a[248:251], v1 offset:6144
  ds_read_b128 a[252:255], v0 offset:14336
  ds_read_b128 v[132:135], v1 offset:14336
  ds_read_b128 v[136:139], v0 offset:22528
  ds_read_b128 v[140:143], v1 offset:22528
  s_waitcnt lgkmcnt(5)
  v_mfma_f32_16x16x32_bf16 v[144:147], a[0:3], a[244:247], 0
  s_waitcnt lgkmcnt(4)
  v_mfma_f32_16x16x32_bf16 v[144:147], a[12:15], a[248:251], v[144:147]
  s_waitcnt lgkmcnt(3)
  v_mfma_f32_16x16x32_bf16 v[144:147], a[24:27], a[252:255], v[144:147]
  s_waitcnt lgkmcnt(2)
  v_mfma_f32_16x16x32_bf16 v[144:147], a[36:39], v[132:135], v[144:147]
  s_waitcnt lgkmcnt(1)
  v_mfma_f32_16x16x32_bf16 v[144:147], a[48:51], v[136:139], v[144:147]
  s_waitcnt lgkmcnt(0)
  v_mfma_f32_16x16x32_bf16 v[144:147], a[60:63], v[140:143], v[144:147]
  v_mfma_f32_16x16x32_bf16 v[108:111], a[64:67], v[140:143], 0
  v_mfma_f32_16x16x32_bf16 v[108:111], a[52:55], v[136:139], v[108:111]
  v_mfma_f32_16x16x32_bf16 v[108:111], a[40:43], v[132:135], v[108:111]
  v_mfma_f32_16x16x32_bf16 v[108:111], a[28:31], a[252:255], v[108:111]
  v_mfma_f32_16x16x32_bf16 v[108:111], a[16:19], a[248:251], v[108:111]
  v_mfma_f32_16x16x32_bf16 v[108:111], a[4:7], a[244:247], v[108:111]
  v_mul_f32 v144, s42, v144
  v_mul_f32 v145, s42, v145
  v_mul_f32 v146, s42, v146
  v_mul_f32 v147, s42, v147
  v_cvt_pk_bf16_f32 v116, v144, v145
  v_cvt_pk_bf16_f32 v117, v146, v147
  v_mfma_f32_16x16x32_bf16 v[112:115], a[8:11], a[244:247], 0
  v_mfma_f32_16x16x32_bf16 v[112:115], a[20:23], a[248:251], v[112:115]
  v_mfma_f32_16x16x32_bf16 v[112:115], a[32:35], a[252:255], v[112:115]
  v_mfma_f32_16x16x32_bf16 v[112:115], a[44:47], v[132:135], v[112:115]
  v_mfma_f32_16x16x32_bf16 v[112:115], a[56:59], v[136:139], v[112:115]
  v_mfma_f32_16x16x32_bf16 v[112:115], a[68:71], v[140:143], v[112:115]
  v_mul_f32 v108, s42, v108
  v_mul_f32 v109, s42, v109
  v_mul_f32 v110, s42, v110
  v_mul_f32 v111, s42, v111
  v_cvt_pk_bf16_f32 v118, v108, v109
  v_cvt_pk_bf16_f32 v119, v110, v111
  v_mfma_f32_16x16x32_bf16 v[144:147], a[132:135], v[140:143], 0
  v_mfma_f32_16x16x32_bf16 v[144:147], a[120:123], v[136:139], v[144:147]
  v_mfma_f32_16x16x32_bf16 v[144:147], a[108:111], v[132:135], v[144:147]
  v_mfma_f32_16x16x32_bf16 v[144:147], a[96:99], a[252:255], v[144:147]
  v_mfma_f32_16x16x32_bf16 v[144:147], a[84:87], a[248:251], v[144:147]
  v_mfma_f32_16x16x32_bf16 v[144:147], a[72:75], a[244:247], v[144:147]
  v_mul_f32 v112, s42, v112
  v_mul_f32 v113, s42, v113
  v_mul_f32 v114, s42, v114
  v_mul_f32 v115, s42, v115
  v_cvt_pk_bf16_f32 v22, v112, v113
  v_cvt_pk_bf16_f32 v23, v114, v115
  v_mfma_f32_16x16x32_bf16 v[148:151], a[76:79], a[244:247], 0
  v_mfma_f32_16x16x32_bf16 v[148:151], a[88:91], a[248:251], v[148:151]
  v_mfma_f32_16x16x32_bf16 v[148:151], a[100:103], a[252:255], v[148:151]
  v_mfma_f32_16x16x32_bf16 v[148:151], a[112:115], v[132:135], v[148:151]
  v_mfma_f32_16x16x32_bf16 v[148:151], a[124:127], v[136:139], v[148:151]
  v_mfma_f32_16x16x32_bf16 v[148:151], a[136:139], v[140:143], v[148:151]
  v_cvt_pk_bf16_f32 v108, v144, v145
  v_cvt_pk_bf16_f32 v109, v146, v147
  v_mfma_f32_16x16x32_bf16 v[152:155], a[140:143], v[140:143], 0
  v_mfma_f32_16x16x32_bf16 v[152:155], a[128:131], v[136:139], v[152:155]
  v_mfma_f32_16x16x32_bf16 v[152:155], a[116:119], v[132:135], v[152:155]
  v_mfma_f32_16x16x32_bf16 v[152:155], a[104:107], a[252:255], v[152:155]
  v_mfma_f32_16x16x32_bf16 v[152:155], a[92:95], a[248:251], v[152:155]
  v_mfma_f32_16x16x32_bf16 v[152:155], a[80:83], a[244:247], v[152:155]
  v_cvt_pk_bf16_f32 v110, v148, v149
  v_cvt_pk_bf16_f32 v111, v150, v151
  v_mfma_f32_16x16x32_bf16 v[144:147], a[244:247], a[144:147], 0
  v_mfma_f32_16x16x32_bf16 v[144:147], a[248:251], a[156:159], v[144:147]
  v_mfma_f32_16x16x32_bf16 v[144:147], a[252:255], a[168:171], v[144:147]
  v_mfma_f32_16x16x32_bf16 v[144:147], v[132:135], a[180:183], v[144:147]
  v_mfma_f32_16x16x32_bf16 v[144:147], v[136:139], a[192:195], v[144:147]
  v_mfma_f32_16x16x32_bf16 v[144:147], v[140:143], a[204:207], v[144:147]
  v_cvt_pk_bf16_f32 v112, v152, v153
  v_cvt_pk_bf16_f32 v113, v154, v155
  v_mfma_f32_16x16x32_bf16 v[148:151], v[140:143], a[208:211], 0
  v_mfma_f32_16x16x32_bf16 v[148:151], v[136:139], a[196:199], v[148:151]
  v_mfma_f32_16x16x32_bf16 v[148:151], v[132:135], a[184:187], v[148:151]
  v_mfma_f32_16x16x32_bf16 v[148:151], a[252:255], a[172:175], v[148:151]
  v_mfma_f32_16x16x32_bf16 v[148:151], a[248:251], a[160:163], v[148:151]
  v_mfma_f32_16x16x32_bf16 v[148:151], a[244:247], a[148:151], v[148:151]
  v_cvt_pk_bf16_f32 v98, v144, v145
  v_cvt_pk_bf16_f32 v99, v146, v147
  v_mfma_f32_16x16x32_bf16 v[152:155], a[244:247], a[152:155], 0
  v_mfma_f32_16x16x32_bf16 v[152:155], a[248:251], a[164:167], v[152:155]
  v_mfma_f32_16x16x32_bf16 v[152:155], a[252:255], a[176:179], v[152:155]
  v_mfma_f32_16x16x32_bf16 v[152:155], v[132:135], a[188:191], v[152:155]
  v_mfma_f32_16x16x32_bf16 v[152:155], v[136:139], a[200:203], v[152:155]
  v_mfma_f32_16x16x32_bf16 v[152:155], v[140:143], a[212:215], v[152:155]
  v_cvt_pk_bf16_f32 v106, v148, v149
  v_cvt_pk_bf16_f32 v107, v150, v151
  s_nop 5
  v_cvt_pk_bf16_f32 v102, v152, v153
  v_cvt_pk_bf16_f32 v103, v154, v155
  v_mfma_f32_16x16x32_bf16 v[132:135], v[62:65], v[128:131], v[36:39]
  v_mfma_f32_16x16x32_bf16 v[132:135], v[60:63], v[12:15], v[132:135]
  v_mfma_f32_16x16x32_bf16 v[136:139], v[82:85], v[128:131], v[32:35]
  v_mfma_f32_16x16x32_bf16 v[136:139], v[80:83], v[12:15], v[136:139]
  v_mfma_f32_16x16x32_bf16 v[140:143], v[90:93], v[128:131], v[28:31]
  v_mfma_f32_16x16x32_bf16 v[140:143], v[88:91], v[12:15], v[140:143]
  v_mfma_f32_16x16x32_bf16 v[144:147], v[110:113], v[128:131], v[24:27]
  v_mfma_f32_16x16x32_bf16 v[144:147], v[108:111], v[12:15], v[144:147]
  v_add_f32 v132, v54, v132
  v_add_f32 v133, v54, v133
  v_add_f32 v134, v54, v134
  v_add_f32 v135, v54, v135
  v_add_f32 v136, v54, v136
  v_add_f32 v137, v54, v137
  v_add_f32 v138, v54, v138
  v_add_f32 v139, v54, v139
  v_add_f32 v140, v55, v140
  v_add_f32 v141, v55, v141
  v_add_f32 v142, v55, v142
  v_add_f32 v143, v55, v143
  v_add_f32 v144, v55, v144
  v_add_f32 v145, v55, v145
  v_add_f32 v146, v55, v146
  v_add_f32 v147, v55, v147
  v_max_f32 v58, v132, v133
  v_max3_f32 v58, v134, v135, v58
  v_max3_f32 v58, v136, v137, v58
  v_max3_f32 v58, v138, v139, v58
  v_max3_f32 v58, v140, v141, v58
  v_max3_f32 v58, v142, v143, v58
  v_max3_f32 v58, v144, v145, v58
  v_max3_f32 v58, v146, v147, v58
  v_mov_b32 v59, v58
  s_nop 1
  v_permlane32_swap_b32 v58, v59
  v_max_f32 v58, v58, v59
  v_mov_b32 v59, v58
  s_nop 1
  v_permlane16_swap_b32 v58, v59
  v_max_f32 v58, v58, v59
  v_sub_f32 v132, v132, v58
  v_sub_f32 v133, v133, v58
  v_sub_f32 v134, v134, v58
  v_sub_f32 v135, v135, v58
  v_sub_f32 v136, v136, v58
  v_sub_f32 v137, v137, v58
  v_sub_f32 v138, v138, v58
  v_sub_f32 v139, v139, v58
  v_sub_f32 v140, v140, v58
  v_sub_f32 v141, v141, v58
  v_sub_f32 v142, v142, v58
  v_sub_f32 v143, v143, v58
  v_sub_f32 v144, v144, v58
  v_sub_f32 v145, v145, v58
  v_sub_f32 v146, v146, v58
  v_sub_f32 v147, v147, v58
  v_exp_f32 v132, v132
  v_exp_f32 v133, v133
  v_exp_f32 v134, v134
  v_exp_f32 v135, v135
  v_cvt_pk_bf16_f32 v132, v132, v133
  v_cvt_pk_bf16_f32 v133, v134, v135
  v_exp_f32 v136, v136
  v_exp_f32 v137, v137
  v_exp_f32 v138, v138
  v_exp_f32 v139, v139
  v_cvt_pk_bf16_f32 v134, v136, v137
  v_cvt_pk_bf16_f32 v135, v138, v139
  v_exp_f32 v140, v140
  v_exp_f32 v141, v141
  v_exp_f32 v142, v142
  v_exp_f32 v143, v143
  v_cvt_pk_bf16_f32 v136, v140, v141
  v_cvt_pk_bf16_f32 v137, v142, v143
  v_exp_f32 v144, v144
  v_exp_f32 v145, v145
  v_exp_f32 v146, v146
  v_exp_f32 v147, v147
  v_cvt_pk_bf16_f32 v138, v144, v145
  v_cvt_pk_bf16_f32 v139, v146, v147
  v_mov_b64 v[128:129], 0
  s_nop 1
  v_smfmac_f32_16x16x64_bf16 v[128:131], a[240:243], v[132:139], v10
  v_mfma_f32_16x16x32_bf16 v[148:151], v[96:99], v[136:139], 0
  v_mfma_f32_16x16x32_bf16 v[148:151], v[68:71], v[132:135], v[148:151]
  v_mfma_f32_16x16x32_bf16 v[140:143], v[72:75], v[132:135], 0
  v_mfma_f32_16x16x32_bf16 v[140:143], v[104:107], v[136:139], v[140:143]
  v_mfma_f32_16x16x32_bf16 v[144:147], v[100:103], v[136:139], 0
  v_mfma_f32_16x16x32_bf16 v[144:147], v[76:79], v[132:135], v[144:147]
  v_add_f32 v128, v128, v129
  v_rcp_f32 v130, v128
  s_nop 0
  v_mul_f32 v148, v130, v148
  v_mul_f32 v149, v130, v149
  v_mul_f32 v150, v130, v150
  v_mul_f32 v151, v130, v151
  v_cvt_pk_bf16_f32 v148, v148, v149
  v_cvt_pk_bf16_f32 v149, v150, v151
  ds_write_b32 v5, v148 offset:0
  ds_write_b32 v5, v149 offset:1024
  v_mul_f32 v140, v130, v140
  v_mul_f32 v141, v130, v141
  v_mul_f32 v142, v130, v142
  v_mul_f32 v143, v130, v143
  v_cvt_pk_bf16_f32 v140, v140, v141
  v_cvt_pk_bf16_f32 v141, v142, v143
  ds_write_b32 v5, v140 offset:2048
  ds_write_b32 v5, v141 offset:3072
  v_mul_f32 v144, v130, v144
  v_mul_f32 v145, v130, v145
  v_mul_f32 v146, v130, v146
  v_mul_f32 v147, v130, v147
  v_cvt_pk_bf16_f32 v144, v144, v145
  v_cvt_pk_bf16_f32 v145, v146, v147
  ds_write_b32 v5, v144 offset:4096
  ds_write_b32 v5, v145 offset:5120
  v_mfma_f32_16x16x32_bf16 v[128:131], v[60:63], v[124:127], v[40:43]
  v_mfma_f32_16x16x32_bf16 v[128:131], v[62:65], v[14:17], v[128:131]
  v_mfma_f32_16x16x32_bf16 v[132:135], v[80:83], v[124:127], v[36:39]
  v_mfma_f32_16x16x32_bf16 v[132:135], v[82:85], v[14:17], v[132:135]
  v_mfma_f32_16x16x32_bf16 v[136:139], v[88:91], v[124:127], v[32:35]
  v_mfma_f32_16x16x32_bf16 v[136:139], v[90:93], v[14:17], v[136:139]
  v_mfma_f32_16x16x32_bf16 v[140:143], v[108:111], v[124:127], v[28:31]
  v_mfma_f32_16x16x32_bf16 v[140:143], v[110:113], v[14:17], v[140:143]
  v_add_f32 v128, v54, v128
  v_add_f32 v129, v54, v129
  v_add_f32 v130, v54, v130
  v_add_f32 v131, v54, v131
  v_add_f32 v132, v54, v132
  v_add_f32 v133, v54, v133
  v_add_f32 v134, v54, v134
  v_add_f32 v135, v54, v135
  v_add_f32 v136, v55, v136
  v_add_f32 v137, v55, v137
  v_add_f32 v138, v55, v138
  v_add_f32 v139, v55, v139
  v_add_f32 v140, v55, v140
  v_add_f32 v141, v55, v141
  v_add_f32 v142, v55, v142
  v_add_f32 v143, v55, v143
  v_max_f32 v58, v128, v129
  v_max3_f32 v58, v130, v131, v58
  v_max3_f32 v58, v132, v133, v58
  v_max3_f32 v58, v134, v135, v58
  v_max3_f32 v58, v136, v137, v58
  v_max3_f32 v58, v138, v139, v58
  v_max3_f32 v58, v140, v141, v58
  v_max3_f32 v58, v142, v143, v58
  v_mov_b32 v59, v58
  s_nop 1
  v_permlane32_swap_b32 v58, v59
  v_max_f32 v58, v58, v59
  v_mov_b32 v59, v58
  s_nop 1
  v_permlane16_swap_b32 v58, v59
  v_max_f32 v58, v58, v59
  v_sub_f32 v128, v128, v58
  v_sub_f32 v129, v129, v58
  v_sub_f32 v130, v130, v58
  v_sub_f32 v131, v131, v58
  v_sub_f32 v132, v132, v58
  v_sub_f32 v133, v133, v58
  v_sub_f32 v134, v134, v58
  v_sub_f32 v135, v135, v58
  v_sub_f32 v136, v136, v58
  v_sub_f32 v137, v137, v58
  v_sub_f32 v138, v138, v58
  v_sub_f32 v139, v139, v58
  v_sub_f32 v140, v140, v58
  v_sub_f32 v141, v141, v58
  v_sub_f32 v142, v142, v58
  v_sub_f32 v143, v143, v58
  v_exp_f32 v128, v128
  v_exp_f32 v129, v129
  v_exp_f32 v130, v130
  v_exp_f32 v131, v131
  v_cvt_pk_bf16_f32 v128, v128, v129
  v_cvt_pk_bf16_f32 v129, v130, v131
  v_exp_f32 v132, v132
  v_exp_f32 v133, v133
  v_exp_f32 v134, v134
  v_exp_f32 v135, v135
  v_cvt_pk_bf16_f32 v130, v132, v133
  v_cvt_pk_bf16_f32 v131, v134, v135
  v_exp_f32 v136, v136
  v_exp_f32 v137, v137
  v_exp_f32 v138, v138
  v_exp_f32 v139, v139
  v_cvt_pk_bf16_f32 v132, v136, v137
  v_cvt_pk_bf16_f32 v133, v138, v139
  v_exp_f32 v140, v140
  v_exp_f32 v141, v141
  v_exp_f32 v142, v142
  v_exp_f32 v143, v143
  v_cvt_pk_bf16_f32 v134, v140, v141
  v_cvt_pk_bf16_f32 v135, v142, v143
  v_mov_b64 v[124:125], 0
  s_nop 1
  v_smfmac_f32_16x16x64_bf16 v[124:127], a[240:243], v[128:135], v10
  v_mfma_f32_16x16x32_bf16 v[144:147], v[96:99], v[132:135], 0
  v_mfma_f32_16x16x32_bf16 v[144:147], v[68:71], v[128:131], v[144:147]
  v_mfma_f32_16x16x32_bf16 v[136:139], v[72:75], v[128:131], 0
  v_mfma_f32_16x16x32_bf16 v[136:139], v[104:107], v[132:135], v[136:139]
  v_mfma_f32_16x16x32_bf16 v[140:143], v[100:103], v[132:135], 0
  v_mfma_f32_16x16x32_bf16 v[140:143], v[76:79], v[128:131], v[140:143]
  v_add_f32 v124, v124, v125
  v_rcp_f32 v126, v124
  s_nop 0
  v_mul_f32 v144, v126, v144
  v_mul_f32 v145, v126, v145
  v_mul_f32 v146, v126, v146
  v_mul_f32 v147, v126, v147
  v_cvt_pk_bf16_f32 v144, v144, v145
  v_cvt_pk_bf16_f32 v145, v146, v147
  ds_write_b32 v5, v144 offset:256
  ds_write_b32 v5, v145 offset:1280
  v_mul_f32 v136, v126, v136
  v_mul_f32 v137, v126, v137
  v_mul_f32 v138, v126, v138
  v_mul_f32 v139, v126, v139
  v_cvt_pk_bf16_f32 v136, v136, v137
  v_cvt_pk_bf16_f32 v137, v138, v139
  ds_write_b32 v5, v136 offset:2304
  ds_write_b32 v5, v137 offset:3328
  v_mul_f32 v140, v126, v140
  v_mul_f32 v141, v126, v141
  v_mul_f32 v142, v126, v142
  v_mul_f32 v143, v126, v143
  v_cvt_pk_bf16_f32 v140, v140, v141
  v_cvt_pk_bf16_f32 v141, v142, v143
  ds_write_b32 v5, v140 offset:4352
  ds_write_b32 v5, v141 offset:5376
  v_mfma_f32_16x16x32_bf16 v[124:127], v[90:93], v[120:123], v[36:39]
  v_mfma_f32_16x16x32_bf16 v[124:127], v[88:91], v[18:21], v[124:127]
  v_mfma_f32_16x16x32_bf16 v[128:131], v[110:113], v[120:123], v[32:35]
  v_mfma_f32_16x16x32_bf16 v[128:131], v[108:111], v[18:21], v[128:131]
  v_mfma_f32_16x16x32_bf16 v[132:135], v[62:65], v[120:123], v[44:47]
  v_mfma_f32_16x16x32_bf16 v[132:135], v[60:63], v[18:21], v[132:135]
  v_mfma_f32_16x16x32_bf16 v[136:139], v[82:85], v[120:123], v[40:43]
  v_mfma_f32_16x16x32_bf16 v[136:139], v[80:83], v[18:21], v[136:139]
  v_add_f32 v124, v54, v124
  v_add_f32 v125, v54, v125
  v_add_f32 v126, v54, v126
  v_add_f32 v127, v54, v127
  v_add_f32 v128, v54, v128
  v_add_f32 v129, v54, v129
  v_add_f32 v130, v54, v130
  v_add_f32 v131, v54, v131
  v_add_f32 v132, v55, v132
  v_add_f32 v133, v55, v133
  v_add_f32 v134, v55, v134
  v_add_f32 v135, v55, v135
  v_add_f32 v136, v55, v136
  v_add_f32 v137, v55, v137
  v_add_f32 v138, v55, v138
  v_add_f32 v139, v55, v139
  v_max_f32 v58, v124, v125
  v_max3_f32 v58, v126, v127, v58
  v_max3_f32 v58, v128, v129, v58
  v_max3_f32 v58, v130, v131, v58
  v_max3_f32 v58, v132, v133, v58
  v_max3_f32 v58, v134, v135, v58
  v_max3_f32 v58, v136, v137, v58
  v_max3_f32 v58, v138, v139, v58
  v_mov_b32 v59, v58
  s_nop 1
  v_permlane32_swap_b32 v58, v59
  v_max_f32 v58, v58, v59
  v_mov_b32 v59, v58
  s_nop 1
  v_permlane16_swap_b32 v58, v59
  v_max_f32 v58, v58, v59
  v_sub_f32 v124, v124, v58
  v_sub_f32 v125, v125, v58
  v_sub_f32 v126, v126, v58
  v_sub_f32 v127, v127, v58
  v_sub_f32 v128, v128, v58
  v_sub_f32 v129, v129, v58
  v_sub_f32 v130, v130, v58
  v_sub_f32 v131, v131, v58
  v_sub_f32 v132, v132, v58
  v_sub_f32 v133, v133, v58
  v_sub_f32 v134, v134, v58
  v_sub_f32 v135, v135, v58
  v_sub_f32 v136, v136, v58
  v_sub_f32 v137, v137, v58
  v_sub_f32 v138, v138, v58
  v_sub_f32 v139, v139, v58
  v_exp_f32 v124, v124
  v_exp_f32 v125, v125
  v_exp_f32 v126, v126
  v_exp_f32 v127, v127
  v_cvt_pk_bf16_f32 v124, v124, v125
  v_cvt_pk_bf16_f32 v125, v126, v127
  v_exp_f32 v128, v128
  v_exp_f32 v129, v129
  v_exp_f32 v130, v130
  v_exp_f32 v131, v131
  v_cvt_pk_bf16_f32 v126, v128, v129
  v_cvt_pk_bf16_f32 v127, v130, v131
  v_exp_f32 v132, v132
  v_exp_f32 v133, v133
  v_exp_f32 v134, v134
  v_exp_f32 v135, v135
  v_cvt_pk_bf16_f32 v128, v132, v133
  v_cvt_pk_bf16_f32 v129, v134, v135
  v_exp_f32 v136, v136
  v_exp_f32 v137, v137
  v_exp_f32 v138, v138
  v_exp_f32 v139, v139
  v_cvt_pk_bf16_f32 v130, v136, v137
  v_cvt_pk_bf16_f32 v131, v138, v139
  v_mov_b64 v[120:121], 0
  s_nop 1
  v_smfmac_f32_16x16x64_bf16 v[120:123], a[240:243], v[124:131], v10
  v_mfma_f32_16x16x32_bf16 v[140:143], v[68:71], v[128:131], 0
  v_mfma_f32_16x16x32_bf16 v[140:143], v[96:99], v[124:127], v[140:143]
  v_mfma_f32_16x16x32_bf16 v[132:135], v[104:107], v[124:127], 0
  v_mfma_f32_16x16x32_bf16 v[132:135], v[72:75], v[128:131], v[132:135]
  v_mfma_f32_16x16x32_bf16 v[136:139], v[76:79], v[128:131], 0
  v_mfma_f32_16x16x32_bf16 v[136:139], v[100:103], v[124:127], v[136:139]
  v_add_f32 v120, v120, v121
  v_rcp_f32 v122, v120
  s_nop 0
  v_mul_f32 v140, v122, v140
  v_mul_f32 v141, v122, v141
  v_mul_f32 v142, v122, v142
  v_mul_f32 v143, v122, v143
  v_cvt_pk_bf16_f32 v140, v140, v141
  v_cvt_pk_bf16_f32 v141, v142, v143
  ds_write_b32 v5, v140 offset:512
  ds_write_b32 v5, v141 offset:1536
  v_mul_f32 v132, v122, v132
  v_mul_f32 v133, v122, v133
  v_mul_f32 v134, v122, v134
  v_mul_f32 v135, v122, v135
  v_cvt_pk_bf16_f32 v132, v132, v133
  v_cvt_pk_bf16_f32 v133, v134, v135
  ds_write_b32 v5, v132 offset:2560
  s_waitcnt lgkmcnt(12)
  ds_write_b32 v5, v133 offset:3584
  v_mul_f32 v136, v122, v136
  v_mul_f32 v137, v122, v137
  v_mul_f32 v138, v122, v138
  v_mul_f32 v139, v122, v139
  v_cvt_pk_bf16_f32 v136, v136, v137
  v_cvt_pk_bf16_f32 v137, v138, v139
  ds_write_b32 v5, v136 offset:4608
  ds_write_b32 v5, v137 offset:5632
  v_mfma_f32_16x16x32_bf16 v[120:123], v[88:91], v[116:119], v[40:43]
  v_mfma_f32_16x16x32_bf16 v[120:123], v[90:93], v[20:23], v[120:123]
  v_mfma_f32_16x16x32_bf16 v[124:127], v[108:111], v[116:119], v[36:39]
  v_mfma_f32_16x16x32_bf16 v[124:127], v[110:113], v[20:23], v[124:127]
  v_mfma_f32_16x16x32_bf16 v[128:131], v[60:63], v[116:119], v[48:51]
  v_mfma_f32_16x16x32_bf16 v[128:131], v[62:65], v[20:23], v[128:131]
  v_mfma_f32_16x16x32_bf16 v[88:91], v[80:83], v[116:119], v[44:47]
  v_mfma_f32_16x16x32_bf16 v[88:91], v[82:85], v[20:23], v[88:91]
  v_add_f32 v120, v54, v120
  v_add_f32 v121, v54, v121
  v_add_f32 v122, v54, v122
  v_add_f32 v123, v54, v123
  v_add_f32 v124, v54, v124
  v_add_f32 v125, v54, v125
  v_add_f32 v126, v54, v126
  v_add_f32 v127, v54, v127
  v_add_f32 v128, v55, v128
  v_add_f32 v129, v55, v129
  v_add_f32 v130, v55, v130
  v_add_f32 v131, v55, v131
  v_add_f32 v88, v55, v88
  v_add_f32 v89, v55, v89
  v_add_f32 v90, v55, v90
  v_add_f32 v91, v55, v91
  v_max_f32 v58, v120, v121
  v_max3_f32 v58, v122, v123, v58
  v_max3_f32 v58, v124, v125, v58
  v_max3_f32 v58, v126, v127, v58
  v_max3_f32 v58, v128, v129, v58
  v_max3_f32 v58, v130, v131, v58
  v_max3_f32 v58, v88, v89, v58
  v_max3_f32 v58, v90, v91, v58
  v_mov_b32 v59, v58
  s_nop 1
  v_permlane32_swap_b32 v58, v59
  v_max_f32 v58, v58, v59
  v_mov_b32 v59, v58
  s_nop 1
  v_permlane16_swap_b32 v58, v59
  v_max_f32 v58, v58, v59
  v_sub_f32 v120, v120, v58
  v_sub_f32 v121, v121, v58
  v_sub_f32 v122, v122, v58
  v_sub_f32 v123, v123, v58
  v_sub_f32 v124, v124, v58
  v_sub_f32 v125, v125, v58
  v_sub_f32 v126, v126, v58
  v_sub_f32 v127, v127, v58
  v_sub_f32 v128, v128, v58
  v_sub_f32 v129, v129, v58
  v_sub_f32 v130, v130, v58
  v_sub_f32 v131, v131, v58
  v_sub_f32 v88, v88, v58
  v_sub_f32 v89, v89, v58
  v_sub_f32 v90, v90, v58
  v_sub_f32 v91, v91, v58
  v_exp_f32 v120, v120
  v_exp_f32 v121, v121
  v_exp_f32 v122, v122
  v_exp_f32 v123, v123
  v_cvt_pk_bf16_f32 v120, v120, v121
  v_cvt_pk_bf16_f32 v121, v122, v123
  v_exp_f32 v124, v124
  v_exp_f32 v125, v125
  v_exp_f32 v126, v126
  v_exp_f32 v127, v127
  v_cvt_pk_bf16_f32 v122, v124, v125
  v_cvt_pk_bf16_f32 v123, v126, v127
  v_exp_f32 v128, v128
  v_exp_f32 v129, v129
  v_exp_f32 v130, v130
  v_exp_f32 v131, v131
  v_cvt_pk_bf16_f32 v124, v128, v129
  v_cvt_pk_bf16_f32 v125, v130, v131
  v_exp_f32 v88, v88
  v_exp_f32 v89, v89
  v_exp_f32 v90, v90
  v_exp_f32 v91, v91
  v_cvt_pk_bf16_f32 v126, v88, v89
  v_cvt_pk_bf16_f32 v127, v90, v91
  v_mov_b64 v[80:81], 0
  s_nop 1
  v_smfmac_f32_16x16x64_bf16 v[80:83], a[240:243], v[120:127], v10
  v_mfma_f32_16x16x32_bf16 v[84:87], v[68:71], v[124:127], 0
  v_mfma_f32_16x16x32_bf16 v[84:87], v[96:99], v[120:123], v[84:87]
  v_mfma_f32_16x16x32_bf16 v[60:63], v[104:107], v[120:123], 0
  v_mfma_f32_16x16x32_bf16 v[60:63], v[72:75], v[124:127], v[60:63]
  v_mfma_f32_16x16x32_bf16 v[64:67], v[76:79], v[124:127], 0
  v_mfma_f32_16x16x32_bf16 v[64:67], v[100:103], v[120:123], v[64:67]
  v_add_f32 v80, v80, v81
  v_rcp_f32 v82, v80
  s_nop 0
  v_mul_f32 v84, v82, v84
  v_mul_f32 v85, v82, v85
  v_mul_f32 v86, v82, v86
  v_mul_f32 v87, v82, v87
  v_cvt_pk_bf16_f32 v84, v84, v85
  v_cvt_pk_bf16_f32 v85, v86, v87
  s_waitcnt lgkmcnt(12)
  ds_write_b32 v5, v84 offset:768
  ds_write_b32 v5, v85 offset:1792
  v_mul_f32 v60, v82, v60
  v_mul_f32 v61, v82, v61
  v_mul_f32 v62, v82, v62
  v_mul_f32 v63, v82, v63
  v_cvt_pk_bf16_f32 v60, v60, v61
  v_cvt_pk_bf16_f32 v61, v62, v63
  ds_write_b32 v5, v60 offset:2816
  s_waitcnt lgkmcnt(12)
  ds_write_b32 v5, v61 offset:3840
  v_mul_f32 v64, v82, v64
  v_mul_f32 v65, v82, v65
  v_mul_f32 v66, v82, v66
  v_mul_f32 v67, v82, v67
  v_cvt_pk_bf16_f32 v64, v64, v65
  v_cvt_pk_bf16_f32 v65, v66, v67
  ds_write_b32 v5, v64 offset:4864
  ds_write_b32 v5, v65 offset:5888
  s_waitcnt lgkmcnt(0)
  s_barrier
  ds_read_b128 a[244:247], v3 offset:0
  ds_read_b128 a[248:251], v3 offset:4096
  ds_read_b128 a[252:255], v3 offset:8192
  ds_read_b128 v[72:75], v3 offset:12288
  ds_read_b128 v[76:79], v3 offset:16384
  ds_read_b128 v[84:87], v3 offset:20480
  s_waitcnt lgkmcnt(5)
  v_mfma_f32_16x16x32_bf16 v[68:71], a[244:247], v[184:187], 0
  s_waitcnt lgkmcnt(4)
  v_mfma_f32_16x16x32_bf16 v[68:71], a[248:251], v[200:203], v[68:71]
  s_waitcnt lgkmcnt(3)
  v_mfma_f32_16x16x32_bf16 v[68:71], a[252:255], v[216:219], v[68:71]
  s_waitcnt lgkmcnt(2)
  v_mfma_f32_16x16x32_bf16 v[68:71], v[72:75], v[232:235], v[68:71]
  s_waitcnt lgkmcnt(1)
  v_mfma_f32_16x16x32_bf16 v[68:71], v[76:79], v[248:251], v[68:71]
  s_waitcnt lgkmcnt(0)
  v_mfma_f32_16x16x32_bf16 v[68:71], v[84:87], a[224:227], v[68:71]
  v_mfma_f32_16x16x32_bf16 v[80:83], v[84:87], a[228:231], 0
  v_mfma_f32_16x16x32_bf16 v[80:83], v[76:79], v[252:255], v[80:83]
  v_mfma_f32_16x16x32_bf16 v[80:83], v[72:75], v[236:239], v[80:83]
  v_mfma_f32_16x16x32_bf16 v[80:83], a[252:255], v[220:223], v[80:83]
  v_mfma_f32_16x16x32_bf16 v[80:83], a[248:251], v[204:207], v[80:83]
  v_mfma_f32_16x16x32_bf16 v[80:83], a[244:247], v[188:191], v[80:83]
  v_mfma_f32_16x16x32_bf16 v[60:63], a[244:247], v[192:195], 0
  v_mfma_f32_16x16x32_bf16 v[60:63], a[248:251], v[208:211], v[60:63]
  v_mfma_f32_16x16x32_bf16 v[60:63], a[252:255], v[224:227], v[60:63]
  v_mfma_f32_16x16x32_bf16 v[60:63], v[72:75], v[240:243], v[60:63]
  v_mfma_f32_16x16x32_bf16 v[60:63], v[76:79], a[216:219], v[60:63]
  v_mfma_f32_16x16x32_bf16 v[60:63], v[84:87], a[232:235], v[60:63]
  v_mfma_f32_16x16x32_bf16 v[64:67], v[84:87], a[236:239], 0
  v_mfma_f32_16x16x32_bf16 v[64:67], v[76:79], a[220:223], v[64:67]
  v_mfma_f32_16x16x32_bf16 v[64:67], v[72:75], v[244:247], v[64:67]
  v_mfma_f32_16x16x32_bf16 v[64:67], a[252:255], v[228:231], v[64:67]
  v_mfma_f32_16x16x32_bf16 v[64:67], a[248:251], v[212:215], v[64:67]
  v_mfma_f32_16x16x32_bf16 v[64:67], a[244:247], v[196:199], v[64:67]
  v_cvt_pk_bf16_f32 v68, v68, v80
  v_cvt_pk_bf16_f32 v69, v69, v81
  v_cvt_pk_bf16_f32 v70, v70, v82
  v_cvt_pk_bf16_f32 v71, v71, v83
  buffer_store_dword v68, v7, s[24:27], s33 offen offset:0 nt
  buffer_store_dword v69, v7, s[24:27], s33 offen offset:384 nt
  buffer_store_dword v70, v7, s[24:27], s33 offen offset:768 nt
  buffer_store_dword v71, v7, s[24:27], s33 offen offset:1152 nt
  v_cvt_pk_bf16_f32 v60, v60, v64
  v_cvt_pk_bf16_f32 v61, v61, v65
  v_cvt_pk_bf16_f32 v62, v62, v66
  v_cvt_pk_bf16_f32 v63, v63, v67
  buffer_store_dword v60, v8, s[24:27], s33 offen offset:0 nt
  buffer_store_dword v61, v8, s[24:27], s33 offen offset:384 nt
  buffer_store_dword v62, v8, s[24:27], s33 offen offset:768 nt
  buffer_store_dword v63, v8, s[24:27], s33 offen offset:1152 nt
  ds_read_b128 a[244:247], v4 offset:0
  ds_read_b128 a[248:251], v4 offset:4096
  ds_read_b128 a[252:255], v4 offset:8192
  ds_read_b128 v[68:71], v4 offset:12288
  ds_read_b128 v[72:75], v4 offset:16384
  ds_read_b128 v[76:79], v4 offset:20480
  s_waitcnt lgkmcnt(5)
  v_mfma_f32_16x16x32_bf16 v[60:63], a[244:247], v[184:187], 0
  s_waitcnt lgkmcnt(4)
  v_mfma_f32_16x16x32_bf16 v[60:63], a[248:251], v[200:203], v[60:63]
  s_waitcnt lgkmcnt(3)
  v_mfma_f32_16x16x32_bf16 v[60:63], a[252:255], v[216:219], v[60:63]
  s_waitcnt lgkmcnt(2)
  v_mfma_f32_16x16x32_bf16 v[60:63], v[68:71], v[232:235], v[60:63]
  s_waitcnt lgkmcnt(1)
  v_mfma_f32_16x16x32_bf16 v[60:63], v[72:75], v[248:251], v[60:63]
  s_waitcnt lgkmcnt(0)
  v_mfma_f32_16x16x32_bf16 v[60:63], v[76:79], a[224:227], v[60:63]
  v_mfma_f32_16x16x32_bf16 v[64:67], v[76:79], a[228:231], 0
  v_mfma_f32_16x16x32_bf16 v[64:67], v[72:75], v[252:255], v[64:67]
  v_mfma_f32_16x16x32_bf16 v[64:67], v[68:71], v[236:239], v[64:67]
  v_mfma_f32_16x16x32_bf16 v[64:67], a[252:255], v[220:223], v[64:67]
  v_mfma_f32_16x16x32_bf16 v[64:67], a[248:251], v[204:207], v[64:67]
  v_mfma_f32_16x16x32_bf16 v[64:67], a[244:247], v[188:191], v[64:67]
  s_nop 7
  v_cvt_pk_bf16_f32 v60, v60, v64
  v_cvt_pk_bf16_f32 v61, v61, v65
  v_cvt_pk_bf16_f32 v62, v62, v66
  v_cvt_pk_bf16_f32 v63, v63, v67
  buffer_store_dword v60, v7, s[24:27], s34 offen offset:0 nt
  buffer_store_dword v61, v7, s[24:27], s34 offen offset:384 nt
  buffer_store_dword v62, v7, s[24:27], s34 offen offset:768 nt
  buffer_store_dword v63, v7, s[24:27], s34 offen offset:1152 nt
  ds_read_b128 a[244:247], v3 offset:512
  ds_read_b128 a[248:251], v3 offset:4608
  ds_read_b128 a[252:255], v3 offset:8704
  ds_read_b128 v[72:75], v3 offset:12800
  ds_read_b128 v[76:79], v3 offset:16896
  ds_read_b128 v[84:87], v3 offset:20992
  s_waitcnt lgkmcnt(5)
  v_mfma_f32_16x16x32_bf16 v[60:63], a[244:247], v[184:187], 0
  s_waitcnt lgkmcnt(4)
  v_mfma_f32_16x16x32_bf16 v[60:63], a[248:251], v[200:203], v[60:63]
  s_waitcnt lgkmcnt(3)
  v_mfma_f32_16x16x32_bf16 v[60:63], a[252:255], v[216:219], v[60:63]
  s_waitcnt lgkmcnt(2)
  v_mfma_f32_16x16x32_bf16 v[60:63], v[72:75], v[232:235], v[60:63]
  s_waitcnt lgkmcnt(1)
  v_mfma_f32_16x16x32_bf16 v[60:63], v[76:79], v[248:251], v[60:63]
  s_waitcnt lgkmcnt(0)
  v_mfma_f32_16x16x32_bf16 v[60:63], v[84:87], a[224:227], v[60:63]
  v_mfma_f32_16x16x32_bf16 v[80:83], v[84:87], a[228:231], 0
  v_mfma_f32_16x16x32_bf16 v[80:83], v[76:79], v[252:255], v[80:83]
  v_mfma_f32_16x16x32_bf16 v[80:83], v[72:75], v[236:239], v[80:83]
  v_mfma_f32_16x16x32_bf16 v[80:83], a[252:255], v[220:223], v[80:83]
  v_mfma_f32_16x16x32_bf16 v[80:83], a[248:251], v[204:207], v[80:83]
  v_mfma_f32_16x16x32_bf16 v[80:83], a[244:247], v[188:191], v[80:83]
  v_mfma_f32_16x16x32_bf16 v[64:67], a[244:247], v[192:195], 0
  v_mfma_f32_16x16x32_bf16 v[64:67], a[248:251], v[208:211], v[64:67]
  v_mfma_f32_16x16x32_bf16 v[64:67], a[252:255], v[224:227], v[64:67]
  v_mfma_f32_16x16x32_bf16 v[64:67], v[72:75], v[240:243], v[64:67]
  v_mfma_f32_16x16x32_bf16 v[64:67], v[76:79], a[216:219], v[64:67]
  v_mfma_f32_16x16x32_bf16 v[64:67], v[84:87], a[232:235], v[64:67]
  v_mfma_f32_16x16x32_bf16 v[68:71], v[84:87], a[236:239], 0
  v_mfma_f32_16x16x32_bf16 v[68:71], v[76:79], a[220:223], v[68:71]
  v_mfma_f32_16x16x32_bf16 v[68:71], v[72:75], v[244:247], v[68:71]
  v_mfma_f32_16x16x32_bf16 v[68:71], a[252:255], v[228:231], v[68:71]
  v_mfma_f32_16x16x32_bf16 v[68:71], a[248:251], v[212:215], v[68:71]
  v_mfma_f32_16x16x32_bf16 v[68:71], a[244:247], v[196:199], v[68:71]
  v_cvt_pk_bf16_f32 v60, v60, v80
  v_cvt_pk_bf16_f32 v61, v61, v81
  v_cvt_pk_bf16_f32 v62, v62, v82
  v_cvt_pk_bf16_f32 v63, v63, v83
  buffer_store_dword v60, v7, s[24:27], s35 offen offset:0 nt
  buffer_store_dword v61, v7, s[24:27], s35 offen offset:384 nt
  buffer_store_dword v62, v7, s[24:27], s35 offen offset:768 nt
  buffer_store_dword v63, v7, s[24:27], s35 offen offset:1152 nt
  v_cvt_pk_bf16_f32 v64, v64, v68
  v_cvt_pk_bf16_f32 v65, v65, v69
  v_cvt_pk_bf16_f32 v66, v66, v70
  v_cvt_pk_bf16_f32 v67, v67, v71
  buffer_store_dword v64, v8, s[24:27], s35 offen offset:0 nt
  buffer_store_dword v65, v8, s[24:27], s35 offen offset:384 nt
  buffer_store_dword v66, v8, s[24:27], s35 offen offset:768 nt
  buffer_store_dword v67, v8, s[24:27], s35 offen offset:1152 nt
  ds_read_b128 a[244:247], v4 offset:512
  ds_read_b128 a[248:251], v4 offset:4608
  ds_read_b128 a[252:255], v4 offset:8704
  ds_read_b128 v[72:75], v4 offset:12800
  ds_read_b128 v[76:79], v4 offset:16896
  ds_read_b128 v[80:83], v4 offset:20992
  s_waitcnt lgkmcnt(5)
  v_mfma_f32_16x16x32_bf16 v[60:63], a[244:247], v[184:187], 0
  s_waitcnt lgkmcnt(4)
  v_mfma_f32_16x16x32_bf16 v[60:63], a[248:251], v[200:203], v[60:63]
  s_waitcnt lgkmcnt(3)
  v_mfma_f32_16x16x32_bf16 v[60:63], a[252:255], v[216:219], v[60:63]
  s_waitcnt lgkmcnt(2)
  v_mfma_f32_16x16x32_bf16 v[60:63], v[72:75], v[232:235], v[60:63]
  s_waitcnt lgkmcnt(1)
  v_mfma_f32_16x16x32_bf16 v[60:63], v[76:79], v[248:251], v[60:63]
  s_waitcnt lgkmcnt(0)
  v_mfma_f32_16x16x32_bf16 v[60:63], v[80:83], a[224:227], v[60:63]
  v_mfma_f32_16x16x32_bf16 v[64:67], v[80:83], a[228:231], 0
  v_mfma_f32_16x16x32_bf16 v[64:67], v[76:79], v[252:255], v[64:67]
  v_mfma_f32_16x16x32_bf16 v[64:67], v[72:75], v[236:239], v[64:67]
  v_mfma_f32_16x16x32_bf16 v[64:67], a[252:255], v[220:223], v[64:67]
  v_mfma_f32_16x16x32_bf16 v[64:67], a[248:251], v[204:207], v[64:67]
  v_mfma_f32_16x16x32_bf16 v[64:67], a[244:247], v[188:191], v[64:67]
  s_nop 7
  v_cvt_pk_bf16_f32 v60, v60, v64
  v_cvt_pk_bf16_f32 v61, v61, v65
  v_cvt_pk_bf16_f32 v62, v62, v66
  v_cvt_pk_bf16_f32 v63, v63, v67
  buffer_store_dword v60, v7, s[24:27], s36 offen offset:0 nt
  buffer_store_dword v61, v7, s[24:27], s36 offen offset:384 nt
  buffer_store_dword v62, v7, s[24:27], s36 offen offset:768 nt
  buffer_store_dword v63, v7, s[24:27], s36 offen offset:1152 nt
  v_sub_u32 v6, v6, v56
  v_sub_u32 v7, v7, v57
  v_sub_u32 v8, v8, v57
  v_mov_b32 v54, 0
  v_mov_b32 v55, 0
  v_mov_b32 v56, 0
  v_mov_b32 v57, 0
  s_add_u32 s50, s50, 1
  s_cmp_eq_u32 s50, 16
  s_cselect_b32 s5, s58, s43
  s_add_u32 s56, s56, s5
  s_mul_i32 s5, s3, s57
  s_add_u32 s31, s56, s5
  s_add_u32 s32, s31, 786432
  s_xor_b32 s5, s4, 0
  s_mul_i32 s5, s5, 393216
  s_add_u32 s33, s5, s56
  s_xor_b32 s5, s4, 1
  s_mul_i32 s5, s5, 393216
  s_add_u32 s34, s5, s56
  s_xor_b32 s5, s4, 2
  s_mul_i32 s5, s5, 393216
  s_add_u32 s35, s5, s56
  s_xor_b32 s5, s4, 3
  s_mul_i32 s5, s5, 393216
  s_add_u32 s36, s5, s56
  s_cmp_lt_u32 s50, s49
  s_nop 7
  s_cbranch_scc1 L_sloop
  s_branch L_fin
.section .rodata,"a"
.p2align 6
.amdhsa_kernel standalone__window_attn_swin__vision_kernel
  .amdhsa_next_free_vgpr 512
  .amdhsa_next_free_sgpr 102
  .amdhsa_accum_offset 256
  .amdhsa_group_segment_fixed_size 0
  .amdhsa_kernarg_size 72
  .amdhsa_user_sgpr_count 2
  .amdhsa_user_sgpr_kernarg_segment_ptr 1
  .amdhsa_system_sgpr_workgroup_id_x 1
.end_amdhsa_kernel
```

```asm
; @launch grid=(256,1,1) block=(256,1,1) lds=163840
.amdgcn_target "amdgcn-amd-amdhsa--gfx950"
.text
.globl standalone__window_attn_swin__vision_kernel
.p2align 12
.p2align 8
.type standalone__window_attn_swin__vision_kernel,@function
standalone__window_attn_swin__vision_kernel:
  s_cmpk_ge_u32 s2, 256
  s_cbranch_scc1 L_end
  s_load_dwordx2 s[8:9], s[0:1], 0
  s_load_dwordx2 s[20:21], s[0:1], 24
  s_load_dwordx2 s[12:13], s[0:1], 8
  s_load_dwordx2 s[16:17], s[0:1], 16
  s_load_dwordx2 s[24:25], s[0:1], 48
  s_load_dwordx2 s[62:63], s[0:1], 64
  v_lshrrev_b32 v75, 6, v0
  s_lshr_b32 s49, s2, 3
  v_readfirstlane_b32 s3, v75
  s_getpc_b64 s[50:51]
  v_and_b32 v75, 15, v0
  v_mad_u32_u24 v75, s49, 9, v75
  v_lshlrev_b32 v75, 7, v75
  v_min_u32 v75, L_safe-standalone__window_attn_swin__vision_kernel-256, v75
  v_mov_b32 v59, s51
  v_add_co_u32 v58, vcc, s50, v75
  s_and_b32 s47, s2, 63
  s_lshr_b32 s48, s2, 6
  v_addc_co_u32 v59, vcc, 0, v59, vcc
  global_load_dword v67, v[58:59], off
  v_bfe_u32 v56, v0, 3, 4
  v_and_b32 v54, 7, v0
  v_lshrrev_b32 v64, 1, v56
  v_lshlrev_b32 v76, 2, v56
  v_and_b32 v76, 4, v76
  v_xor_b32 v64, v64, v76
  v_xor_b32 v64, v54, v64
  v_and_b32 v55, 7, v56
  s_add_u32 s48, s48, 60
  s_cmp_lt_u32 s2, 60
  s_cselect_b32 s48, s2, s48
  s_cselect_b32 s47, 63, s47
  s_lshl_b32 s5, s47, 3
  s_add_u32 s5, s5, 4
  v_add_u32 v76, s5, v55
  v_and_b32 v76, 511, v76
  v_mul_u32_u24 v76, 0x180, v76
  v_lshlrev_b32 v58, 4, v64
  v_add_u32 v57, v58, v76
  v_and_b32 v65, 63, v0
  v_lshlrev_b32 v60, 4, v65
  s_mov_b32 s57, 196608
  s_lshl_b32 s5, s48, 3
  s_add_u32 s5, s5, s3
  s_add_u32 s5, s5, 4
  s_mul_i32 s53, s5, s57
  s_add_u32 s5, s5, 4
  s_and_b32 s5, s5, 511
  s_mul_i32 s54, s5, s57
  s_lshl_b32 s46, s3, 10
  s_lshl_b32 s5, s3, 11
  s_add_u32 m0, s5, 151552
  s_mov_b32 s11, 0x20000
  s_mov_b32 s10, 100663296
  s_mov_b32 s23, s11
  s_movk_i32 s22, 1800
  s_mov_b32 s15, s11
  s_mov_b32 s14, 221184
  s_lshl_b32 s49, s49, 2
  s_add_u32 s51, s49, s3
  s_mul_i32 s50, s51, 1728
  v_min_u32 v59, 13, v65
  v_lshlrev_b32 v59, 7, v59
  s_waitcnt lgkmcnt(0)
  buffer_load_dword v66, v59, s[12:15], s50 offen
  buffer_load_dwordx4 v60, s[20:23], 0 offen lds
  buffer_load_dwordx4 v60, s[20:23], 0 offen offset:1024 lds
  s_add_u32 m0, s46, 0
  v_and_b32 v64, 2, v56
  buffer_load_dwordx4 v57, s[8:11], s53 offen offset:0 nt lds
  s_add_u32 m0, s46, 8064
  v_lshrrev_b32 v76, 1, v56
  buffer_load_dwordx4 v57, s[8:11], s53 offen offset:128 nt lds
  s_add_u32 m0, s46, 16128
  v_and_b32 v76, 4, v76
  buffer_load_dwordx4 v57, s[8:11], s53 offen offset:256 nt lds
  s_add_u32 m0, s46, 4096
  v_or_b32 v76, v64, v76
  buffer_load_dwordx4 v57, s[8:11], s54 offen offset:0 nt lds
  s_add_u32 m0, s46, 12160
  v_xor_b32 v76, v54, v76
  buffer_load_dwordx4 v57, s[8:11], s54 offen offset:128 nt lds
  s_add_u32 m0, s46, 20224
  v_lshlrev_b32 v76, 4, v76
  buffer_load_dwordx4 v57, s[8:11], s54 offen offset:256 nt lds
  v_mul_u32_u24 v56, 1152, v55
  v_add_u32 v61, v76, v56
  s_mul_i32 s44, s3, 9216
  v_lshlrev_b32 v64, 1, v64
  v_xor_b32 v64, v54, v64
  v_mul_u32_u24 v76, 0x180, v55
  v_lshl_add_u32 v56, v64, 4, v76
  s_mul_i32 s45, s3, 3072
  s_mov_b32 s19, s11
  s_mov_b32 s18, 73728
  s_mul_i32 s51, s51, 576
  v_min_u32 v57, 512, v59
  v_add_u32 v6, v58, v76
  s_mov_b32 s27, s11
  s_mov_b32 s26, 100663296
  v_and_b32 v54, 15, v65
  v_lshrrev_b32 v55, 4, v65
  v_lshrrev_b32 v75, 1, v54
  v_lshlrev_b32 v64, 2, v54
  v_and_b32 v64, 4, v64
  v_xor_b32 v75, v75, v64
  v_xor_b32 v75, v55, v75
  v_lshlrev_b32 v75, 4, v75
  v_lshl_add_u32 v0, v54, 7, v75
  v_xor_b32 v1, 64, v0
  v_subrev_u32 v2, s46, v0
  s_add_u32 s28, s46, 28672
  s_add_u32 s29, s46, 53248
  s_mov_b32 s30, s46
  s_and_b32 s4, s3, 1
  v_lshlrev_b32 v75, 4, v54
  v_lshl_add_u32 v64, v55, 10, v75
  s_lshl_b32 s5, s4, 8
  s_add_u32 s5, s5, 77824
  v_add_u32 v3, s5, v64
  v_xor_b32 v4, 0x100, v3
  s_mul_i32 s5, s3, 6144
  s_add_u32 s6, s5, 102400
  s_add_u32 s5, s5, 77824
  s_xor_b32 s41, s5, s6
  v_lshl_add_u32 v64, v55, 2, v75
  v_add_u32 v5, s5, v64
  v_and_b32 v70, 7, v54
  v_lshrrev_b32 v73, 3, v54
  v_and_b32 v72, 1, v55
  v_lshrrev_b32 v74, 1, v55
  v_mul_u32_u24 v75, 0x600, v72
  v_mul_u32_u24 v64, s57, v74
  v_add_u32 v75, v75, v64
  v_lshl_add_u32 v75, v54, 2, v75
  s_lshr_b32 s49, s3, 1
  s_lshl_b32 s5, s49, 6
  s_add_u32 s6, s5, 256
  v_add_u32 v53, s6, v75
  s_lshl_b32 s6, s4, 7
  s_add_u32 s5, s5, s6
  v_add_u32 v52, s5, v75
  s_lshl_b32 s5, s47, 3
  s_add_u32 s5, s5, 4
  s_mul_i32 s5, s5, 384
  s_cmp_eq_u32 s47, 63
  s_cselect_b32 s37, 0, s5
  s_cselect_b32 s5, s5, 0
  s_cselect_b32 s6, s57, 0
  v_mul_u32_u24 v64, s6, v72
  v_sub_u32 v64, s5, v64
  s_lshl_b32 s38, s48, 3
  s_add_u32 s38, s38, 4
  s_xor_b32 s6, s4, 0
  s_lshl_b32 s6, s6, 1
  s_add_u32 s6, s6, s38
  s_and_b32 s6, s6, 511
  s_mul_i32 s6, s6, s57
  s_add_u32 s33, s6, s37
  s_xor_b32 s6, s4, 1
  s_lshl_b32 s6, s6, 1
  s_add_u32 s6, s6, s38
  s_and_b32 s6, s6, 511
  s_mul_i32 s6, s6, s57
  s_add_u32 s34, s6, s37
  s_xor_b32 s6, s4, 2
  s_lshl_b32 s6, s6, 1
  s_add_u32 s6, s6, s38
  s_and_b32 s6, s6, 511
  s_mul_i32 s6, s6, s57
  s_add_u32 s35, s6, s37
  s_xor_b32 s6, s4, 3
  s_lshl_b32 s6, s6, 1
  s_add_u32 s6, s6, s38
  s_and_b32 s6, s6, 511
  s_mul_i32 s6, s6, s57
  s_add_u32 s36, s6, s37
  v_add_u32 v7, v52, v64
  v_add_u32 v8, v53, v64
  s_lshr_b32 s5, s2, 6
  s_and_b32 s6, s2, 63
  s_mul_i32 s56, s5, 15
  s_lshl_b32 s43, s57, 5
  s_cmp_eq_u32 s6, 63
  s_cselect_b32 s6, s56, s6
  s_cselect_b32 s5, 60, s5
  s_cselect_b32 s43, 3072, s43
  s_mul_i32 s5, s5, 1572864
  s_mul_i32 s6, s6, 3072
  s_add_u32 s5, s5, s6
  s_add_u32 s56, s5, 787968
  s_mul_i32 s5, s3, s57
  s_add_u32 s31, s56, s5
  s_add_u32 s32, s31, 786432
  s_mul_i32 s6, s43, 3
  s_add_u32 s5, s5, s6
  s_xor_b32 s6, s4, 0
  s_mul_i32 s6, s6, 393216
  s_sub_u32 s37, s6, s5
  s_xor_b32 s6, s4, 1
  s_mul_i32 s6, s6, 393216
  s_sub_u32 s38, s6, s5
  s_xor_b32 s6, s4, 2
  s_mul_i32 s6, s6, 393216
  s_sub_u32 s39, s6, s5
  s_xor_b32 s6, s4, 3
  s_mul_i32 s6, s6, 393216
  s_sub_u32 s40, s6, s5
  s_mov_b32 s97, 14
  s_mov_b32 s42, 0x3e553b95
  v_lshrrev_b32 v75, 2, v54
  v_lshl_add_u32 v64, v72, 1, v73
  v_lshl_add_u32 v75, v55, 3, v75
  v_lshlrev_b32 v75, 7, v75
  v_lshl_add_u32 v75, v64, 5, v75
  v_and_b32 v77, 3, v54
  v_lshl_add_u32 v75, v77, 3, v75
  s_mul_i32 s5, s3, 3
  s_and_b32 s6, s5, 3
  s_lshl_b32 s6, s6, 5
  s_lshr_b32 s7, s5, 2
  s_lshl_b32 s7, s7, 13
  s_add_u32 s7, s7, 28672
  v_xor_b32 v64, s6, v75
  v_add_u32 v62, s7, v64
  v_add_u32 v58, 73728, v62
  s_add_u32 s5, s5, 1
  s_and_b32 s6, s5, 3
  s_lshl_b32 s6, s6, 5
  s_lshr_b32 s7, s5, 2
  s_lshl_b32 s7, s7, 13
  s_add_u32 s7, s7, 28672
  v_xor_b32 v64, s6, v75
  v_add_u32 v63, s7, v64
  v_add_u32 v59, 73728, v63
  s_add_u32 s5, s5, 1
  s_and_b32 s6, s5, 3
  s_lshl_b32 s6, s6, 5
  s_lshr_b32 s7, s5, 2
  s_lshl_b32 s7, s7, 13
  s_add_u32 s7, s7, 28672
  v_xor_b32 v64, s6, v75
  v_add_u32 v71, s7, v64
  v_add_u32 v60, 73728, v71
  v_xor_b32 v64, s49, v72
  s_lshl_b32 s5, s4, 13
  v_lshl_add_u32 v75, v74, 3, v72
  v_lshl_add_u32 v75, v75, 2, v64
  v_lshl_add_u32 v75, v75, 4, v54
  v_lshlrev_b32 v75, 2, v75
  s_add_u32 s5, s5, 126976
  v_add_u32 v69, s5, v75
  v_add_u32 v68, 128, v69
  v_add_u32 v54, 143360, v75
  v_add_u32 v55, 128, v54
  s_mov_b32 s58, 0x05040100
  s_mov_b32 s59, 0x07060302
  v_cmp_gt_u32 vcc, 2, v77
  v_mov_b32 v75, 0x3f803f80
  v_mov_b32 v64, 0x44444444
  v_cndmask_b32 v75, 0, v75, vcc
  v_cmp_eq_u32 vcc, 1, v77
  v_mov_b32 v76, 0xeeeeeeee
  v_accvgpr_write_b32 a240, v75
  v_accvgpr_write_b32 a241, v75
  v_accvgpr_write_b32 a242, v75
  v_accvgpr_write_b32 a243, v75
  v_cndmask_b32 v10, v64, v76, vcc
  v_mov_b32 v9, 1.0
  s_mov_b32 s98, s43
  s_mov_b64 s[20:21], s[62:63]
  s_mov_b32 s22, 402653184
  s_min_u32 s96, s3, 1
  s_lshl_b32 s96, s96, 7
  s_xor_b32 s96, s96, 1152
  s_bitset1_b32 s96, s97
  s_mov_b64 s[62:63], -1
  v_lshlrev_b32 v11, 3, v65
  v_lshlrev_b32 v75, 2, v70
  v_add_u32 v75, 159808, v75
  v_mov_b32 v64, 0
  ds_write_b32 v75, v64
  s_lshl_b32 m0, s3, 8
  s_nop 0
  ds_write_addtid_b32 v64 offset:24576
  v_mov_b64 v[14:15], 0
  v_mov_b64 v[20:21], 0
  v_sub_u32 v75, v73, v74
  v_mul_i32_i24 v75, 15, v75
  v_lshlrev_b32 v64, 2, v72
  v_sub_u32 v76, v70, v64
  v_add3_u32 v75, v75, v76, 19
  s_mul_i32 s5, s3, 2050
  s_add_u32 s5, s5, 151552
  v_lshl_add_u32 v72, v75, 3, s5
  v_mov_b64 v[24:25], 0
  v_mov_b64 v[26:27], 0
  v_mov_b64 v[28:29], 0
  v_mov_b64 v[30:31], 0
  v_mov_b64 v[32:33], 0
  v_mov_b64 v[34:35], 0
  v_mov_b64 v[36:37], 0
  v_mov_b64 v[38:39], 0
  v_mov_b64 v[40:41], 0
  v_mov_b64 v[42:43], 0
  v_mov_b64 v[44:45], 0
  v_mov_b64 v[46:47], 0
  v_mov_b64 v[48:49], 0
  v_mov_b64 v[50:51], 0
  v_xor_b32 v75, v64, v70
  s_cmp_eq_u32 s47, 63
  s_cselect_b32 s5, 4, 0
  v_and_b32 v75, s5, v75
  v_cmp_eq_u32 vcc, 0, v75
  s_cmp_eq_u32 s48, 63
  s_cselect_b32 s5, 0xc31044fe, 0
  v_mov_b32 v64, s5
  v_mov_b32 v70, 0xc31044fe
  v_cndmask_b32 v64, 0, v64, vcc
  v_cndmask_b32 v70, v70, 0, vcc
  s_add_u32 s5, s44, 0
  s_add_u32 m0, s46, 28672
  s_nop 0
  buffer_load_dwordx4 v61, s[12:15], s5 offen offset:0 lds
  s_add_u32 m0, s46, 36736
  s_nop 0
  buffer_load_dwordx4 v61, s[12:15], s5 offen offset:128 lds
  s_add_u32 m0, s46, 44800
  s_nop 0
  buffer_load_dwordx4 v61, s[12:15], s5 offen offset:256 lds
  s_add_u32 s5, s44, 36864
  s_add_u32 m0, s46, 32768
  s_nop 0
  buffer_load_dwordx4 v61, s[12:15], s5 offen offset:0 lds
  s_add_u32 m0, s46, 40832
  s_nop 0
  buffer_load_dwordx4 v61, s[12:15], s5 offen offset:128 lds
  s_add_u32 m0, s46, 48896
  s_nop 0
  buffer_load_dwordx4 v61, s[12:15], s5 offen offset:256 lds
  s_mov_b64 exec, 0
  s_cmp_eq_u32 s3, 0
  s_cbranch_scc1 L_hop_0_0
  s_cmp_eq_u32 s3, 1
  s_cbranch_scc1 L_hop_1_0
  s_cmp_eq_u32 s3, 2
  s_cbranch_scc1 L_hop_2_0
  s_branch L_hop_3_0
L_walk:
  s_mov_b64 exec, -1
L_walked:
  s_waitcnt vmcnt(12)
  ds_read_u16_d16_hi v24, v72 offset:24
  ds_read_u16_d16_hi v25, v72 offset:16
  ds_read_u16_d16_hi v26, v72 offset:8
  ds_read_u16_d16_hi v27, v72 offset:0
  ds_read_u16_d16_hi v28, v72 offset:264
  ds_read_u16_d16_hi v29, v72 offset:256
  ds_read_u16_d16_hi v30, v72 offset:248
  ds_read_u16_d16_hi v31, v72 offset:240
  ds_read_u16_d16_hi v32, v72 offset:504
  ds_read_u16_d16_hi v33, v72 offset:496
  ds_read_u16_d16_hi v34, v72 offset:488
  ds_read_u16_d16_hi v35, v72 offset:480
  ds_read_u16_d16_hi v36, v72 offset:744
  ds_read_u16_d16_hi v37, v72 offset:736
  ds_read_u16_d16_hi v38, v72 offset:728
  ds_read_u16_d16_hi v39, v72 offset:720
  ds_read_u16_d16_hi v40, v72 offset:984
  ds_read_u16_d16_hi v41, v72 offset:976
  ds_read_u16_d16_hi v42, v72 offset:968
  ds_read_u16_d16_hi v43, v72 offset:960
  ds_read_u16_d16_hi v44, v72 offset:1224
  ds_read_u16_d16_hi v45, v72 offset:1216
  ds_read_u16_d16_hi v46, v72 offset:1208
  ds_read_u16_d16_hi v47, v72 offset:1200
  ds_read_u16_d16_hi v48, v72 offset:1464
  ds_read_u16_d16_hi v49, v72 offset:1456
  ds_read_u16_d16_hi v50, v72 offset:1448
  ds_read_u16_d16_hi v51, v72 offset:1440
  s_mov_b32 s5, 0x3fb8aa3b
  v_add_f32 v64, v70, v64
  s_waitcnt lgkmcnt(15)
  v_mul_f32 v24, s5, v24
  v_mul_f32 v25, s5, v25
  v_mul_f32 v26, s5, v26
  v_mul_f32 v27, s5, v27
  v_mul_f32 v28, s5, v28
  v_mul_f32 v29, s5, v29
  v_mul_f32 v30, s5, v30
  v_mul_f32 v31, s5, v31
  v_mul_f32 v32, s5, v32
  v_mul_f32 v33, s5, v33
  v_mul_f32 v34, s5, v34
  v_mul_f32 v35, s5, v35
  v_mul_f32 v36, s5, v36
  s_waitcnt lgkmcnt(14)
  v_mul_f32 v37, s5, v37
  s_waitcnt lgkmcnt(13)
  v_mul_f32 v38, s5, v38
  s_waitcnt lgkmcnt(12)
  v_mul_f32 v39, s5, v39
  s_waitcnt lgkmcnt(11)
  v_mul_f32 v40, s5, v40
  s_waitcnt lgkmcnt(10)
  v_mul_f32 v41, s5, v41
  s_waitcnt lgkmcnt(9)
  v_mul_f32 v42, s5, v42
  s_waitcnt lgkmcnt(8)
  v_mul_f32 v43, s5, v43
  s_waitcnt lgkmcnt(7)
  v_mul_f32 v44, s5, v44
  s_waitcnt lgkmcnt(6)
  v_mul_f32 v45, s5, v45
  s_waitcnt lgkmcnt(5)
  v_mul_f32 v46, s5, v46
  s_waitcnt lgkmcnt(4)
  v_mul_f32 v47, s5, v47
  s_waitcnt lgkmcnt(3)
  v_mul_f32 v48, s5, v48
  s_waitcnt lgkmcnt(2)
  v_mul_f32 v49, s5, v49
  s_waitcnt lgkmcnt(1)
  v_mul_f32 v50, s5, v50
  s_waitcnt lgkmcnt(0)
  v_mul_f32 v51, s5, v51
  v_add_f32 v76, v64, v48
  v_add_f32 v77, v64, v49
  v_add_f32 v78, v64, v50
  v_add_f32 v79, v64, v51
  v_add_f32 v72, v64, v44
  v_add_f32 v73, v64, v45
  v_add_f32 v74, v64, v46
  v_add_f32 v75, v64, v47
  v_add_f32 v80, v64, v40
  v_add_f32 v81, v64, v41
  v_add_f32 v82, v64, v42
  v_add_f32 v83, v64, v43
  v_add_f32 v84, v64, v32
  v_add_f32 v85, v64, v33
  v_add_f32 v86, v64, v34
  v_add_f32 v87, v64, v35
  v_add_f32 v88, v64, v28
  v_add_f32 v89, v64, v29
  v_add_f32 v90, v64, v30
  v_add_f32 v91, v64, v31
  v_add_f32 v92, v64, v24
  v_add_f32 v93, v64, v25
  v_add_f32 v94, v64, v26
  v_add_f32 v95, v64, v27
  s_add_u32 s5, s44, 73728
  s_add_u32 m0, s46, 53248
  s_nop 0
  buffer_load_dwordx4 v61, s[12:15], s5 offen offset:0 lds
  s_add_u32 m0, s46, 61312
  s_nop 0
  buffer_load_dwordx4 v61, s[12:15], s5 offen offset:128 lds
  s_add_u32 m0, s46, 69376
  s_nop 0
  buffer_load_dwordx4 v61, s[12:15], s5 offen offset:256 lds
  s_add_u32 s5, s44, 110592
  s_add_u32 m0, s46, 57344
  s_nop 0
  buffer_load_dwordx4 v61, s[12:15], s5 offen offset:0 lds
  s_add_u32 m0, s46, 65408
  s_nop 0
  buffer_load_dwordx4 v61, s[12:15], s5 offen offset:128 lds
  s_add_u32 m0, s46, 73472
  s_nop 0
  buffer_load_dwordx4 v61, s[12:15], s5 offen offset:256 lds
  s_cmp_eq_u32 s43, 3072
  s_cselect_b32 s10, s10, 95158272
  s_waitcnt vmcnt(12)
  s_barrier
  ds_read_b128 v[184:187], v0 offset:0
  ds_read_b128 v[188:191], v1 offset:0
  ds_read_b128 v[208:211], v0 offset:2048
  ds_read_b128 v[212:215], v1 offset:2048
  ds_read_b128 v[232:235], v0 offset:4096
  ds_read_b128 v[236:239], v1 offset:4096
  ds_read_b128 a[216:219], v0 offset:6144
  ds_read_b128 a[220:223], v1 offset:6144
  s_add_u32 s5, s44, 147456
  s_add_u32 m0, s46, 77824
  s_nop 0
  buffer_load_dwordx4 v61, s[12:15], s5 offen offset:0 lds
  s_add_u32 m0, s46, 85888
  s_nop 0
  buffer_load_dwordx4 v61, s[12:15], s5 offen offset:128 lds
  s_add_u32 m0, s46, 93952
  s_nop 0
  buffer_load_dwordx4 v61, s[12:15], s5 offen offset:256 lds
  s_waitcnt vmcnt(9)
  s_barrier
  ds_read_b64_tr_b16 a[0:1], v62 offset:0
  ds_read_b64_tr_b16 a[2:3], v62 offset:512
  ds_read_b64_tr_b16 a[12:13], v62 offset:4096
  ds_read_b64_tr_b16 a[14:15], v62 offset:4608
  s_waitcnt lgkmcnt(2)
  v_mfma_f32_16x16x32_bf16 v[120:123], a[0:3], v[184:187], 0
  s_add_u32 s5, s44, 184320
  s_add_u32 m0, s46, 81920
  ds_read_b64_tr_b16 a[4:5], v63 offset:0
  s_waitcnt lgkmcnt(1)
  v_mfma_f32_16x16x32_bf16 v[120:123], a[12:15], v[188:191], v[120:123]
  buffer_load_dwordx4 v61, s[12:15], s5 offen offset:0 lds
  v_mfma_f32_16x16x32_bf16 v[132:135], a[0:3], v[208:211], 0
  s_add_u32 m0, s46, 89984
  ds_read_b64_tr_b16 a[6:7], v63 offset:512
  ds_read_b64_tr_b16 a[16:17], v63 offset:4096
  v_mfma_f32_16x16x32_bf16 v[132:135], a[12:15], v[212:215], v[132:135]
  buffer_load_dwordx4 v61, s[12:15], s5 offen offset:128 lds
  v_mfma_f32_16x16x32_bf16 v[160:163], a[0:3], v[232:235], 0
  s_add_u32 m0, s46, 98048
  ds_read_b64_tr_b16 a[18:19], v63 offset:4608
  ds_read_b64_tr_b16 a[8:9], v71 offset:0
  v_mfma_f32_16x16x32_bf16 v[160:163], a[12:15], v[236:239], v[160:163]
  buffer_load_dwordx4 v61, s[12:15], s5 offen offset:256 lds
  v_mfma_f32_16x16x32_bf16 v[176:179], a[0:3], a[216:219], 0
  s_add_u32 s5, s44, 384
  s_add_u32 m0, s46, 102400
  ds_read_b64_tr_b16 a[10:11], v71 offset:512
  v_mfma_f32_16x16x32_bf16 v[176:179], a[12:15], a[220:223], v[176:179]
  s_waitcnt lgkmcnt(3)
  ds_read_b64_tr_b16 a[20:21], v71 offset:4096
  ds_read_b64_tr_b16 a[22:23], v71 offset:4608
  v_mfma_f32_16x16x32_bf16 v[140:143], a[4:7], v[184:187], 0
  buffer_load_dwordx4 v61, s[12:15], s5 offen offset:0 lds
  s_waitcnt lgkmcnt(4)
  v_mfma_f32_16x16x32_bf16 v[140:143], a[16:19], v[188:191], v[140:143]
  s_add_u32 m0, s46, 110464
  ds_read_b128 v[192:195], v0 offset:8192
  ds_read_b128 v[196:199], v1 offset:8192
  v_mfma_f32_16x16x32_bf16 v[124:127], a[4:7], v[208:211], 0
  buffer_load_dwordx4 v61, s[12:15], s5 offen offset:128 lds
  v_mfma_f32_16x16x32_bf16 v[124:127], a[16:19], v[212:215], v[124:127]
  s_add_u32 m0, s46, 118528
  ds_read_b128 v[216:219], v0 offset:10240
  ds_read_b128 v[220:223], v1 offset:10240
  v_mfma_f32_16x16x32_bf16 v[168:171], a[4:7], v[232:235], 0
  buffer_load_dwordx4 v61, s[12:15], s5 offen offset:256 lds
  v_mfma_f32_16x16x32_bf16 v[168:171], a[16:19], v[236:239], v[168:171]
  s_add_u32 s5, s44, 37248
  s_add_u32 m0, s46, 106496
  ds_read_b128 v[240:243], v0 offset:12288
  v_mfma_f32_16x16x32_bf16 v[116:119], a[4:7], a[216:219], 0
  s_waitcnt lgkmcnt(3)
  ds_read_b128 v[244:247], v1 offset:12288
  ds_read_b128 a[224:227], v0 offset:14336
  v_mfma_f32_16x16x32_bf16 v[116:119], a[16:19], a[220:223], v[116:119]
  s_waitcnt vmcnt(9)
  s_barrier
  v_mfma_f32_16x16x32_bf16 v[144:147], a[8:11], v[184:187], 0
  buffer_load_dwordx4 v61, s[12:15], s5 offen offset:0 lds
  v_mfma_f32_16x16x32_bf16 v[144:147], a[20:23], v[188:191], v[144:147]
  s_add_u32 m0, s46, 114560
  ds_read_b64_tr_b16 a[24:25], v62 offset:24576
  ds_read_b64_tr_b16 a[26:27], v62 offset:25088
  v_mfma_f32_16x16x32_bf16 v[148:151], a[8:11], v[208:211], 0
  buffer_load_dwordx4 v61, s[12:15], s5 offen offset:128 lds
  v_mfma_f32_16x16x32_bf16 v[148:151], a[20:23], v[212:215], v[148:151]
  s_add_u32 m0, s46, 122624
  ds_read_b64_tr_b16 a[36:37], v62 offset:28672
  ds_read_b64_tr_b16 a[38:39], v62 offset:29184
  v_mfma_f32_16x16x32_bf16 v[108:111], a[8:11], v[232:235], 0
  buffer_load_dwordx4 v61, s[12:15], s5 offen offset:256 lds
  v_mfma_f32_16x16x32_bf16 v[108:111], a[20:23], v[236:239], v[108:111]
  ds_read_b128 a[228:231], v1 offset:14336
  ds_read_b64_tr_b16 a[28:29], v63 offset:24576
  v_mfma_f32_16x16x32_bf16 v[96:99], a[8:11], a[216:219], 0
  ds_read_b64_tr_b16 a[30:31], v63 offset:25088
  ds_read_b64_tr_b16 a[40:41], v63 offset:28672
  v_mfma_f32_16x16x32_bf16 v[96:99], a[20:23], a[220:223], v[96:99]
  s_waitcnt lgkmcnt(6)
  ds_read_b64_tr_b16 a[42:43], v63 offset:29184
  ds_read_b64_tr_b16 a[32:33], v71 offset:24576
  v_mfma_f32_16x16x32_bf16 v[120:123], a[24:27], v[192:195], v[120:123]
  s_waitcnt lgkmcnt(6)
  ds_read_b64_tr_b16 a[34:35], v71 offset:25088
  ds_read_b64_tr_b16 a[44:45], v71 offset:28672
  v_mfma_f32_16x16x32_bf16 v[120:123], a[36:39], v[196:199], v[120:123]
  ds_read_b64_tr_b16 a[46:47], v71 offset:29184
  ds_read_b128 v[200:203], v0 offset:16384
  v_mfma_f32_16x16x32_bf16 v[132:135], a[24:27], v[216:219], v[132:135]
L_hop_0_0:
  s_cbranch_execz L_hop_0_1
  ds_read_b128 v[204:207], v1 offset:16384
  ds_read_b128 v[224:227], v0 offset:18432
  v_mfma_f32_16x16x32_bf16 v[132:135], a[36:39], v[220:223], v[132:135]
  ds_read_b128 v[228:231], v1 offset:18432
  ds_read_b128 v[248:251], v0 offset:20480
  v_mfma_f32_16x16x32_bf16 v[160:163], a[24:27], v[240:243], v[160:163]
  ds_read_b128 v[252:255], v1 offset:20480
  ds_read_b128 a[232:235], v0 offset:22528
  v_mfma_f32_16x16x32_bf16 v[160:163], a[36:39], v[244:247], v[160:163]
  s_add_u32 s5, s44, 74112
  s_add_u32 m0, s46, 126976
  ds_read_b128 a[236:239], v1 offset:22528
  v_mfma_f32_16x16x32_bf16 v[176:179], a[24:27], a[224:227], v[176:179]
  s_waitcnt lgkmcnt(7)
  v_mfma_f32_16x16x32_bf16 v[176:179], a[36:39], a[228:231], v[176:179]
  v_mfma_f32_16x16x32_bf16 v[140:143], a[28:31], v[192:195], v[140:143]
  buffer_load_dwordx4 v61, s[12:15], s5 offen offset:0 lds
  v_mfma_f32_16x16x32_bf16 v[140:143], a[40:43], v[196:199], v[140:143]
  s_add_u32 m0, s46, 135040
  v_mfma_f32_16x16x32_bf16 v[124:127], a[28:31], v[216:219], v[124:127]
  buffer_load_dwordx4 v61, s[12:15], s5 offen offset:128 lds
  v_mfma_f32_16x16x32_bf16 v[124:127], a[40:43], v[220:223], v[124:127]
  s_add_u32 m0, s46, 143104
  v_mfma_f32_16x16x32_bf16 v[168:171], a[28:31], v[240:243], v[168:171]
  buffer_load_dwordx4 v61, s[12:15], s5 offen offset:256 lds
  v_mfma_f32_16x16x32_bf16 v[168:171], a[40:43], v[244:247], v[168:171]
  s_add_u32 s5, s44, 110976
  s_add_u32 m0, s46, 131072
  v_mfma_f32_16x16x32_bf16 v[116:119], a[28:31], a[224:227], v[116:119]
  v_mfma_f32_16x16x32_bf16 v[116:119], a[40:43], a[228:231], v[116:119]
  s_waitcnt vmcnt(9)
  s_barrier
  v_mfma_f32_16x16x32_bf16 v[144:147], a[32:35], v[192:195], v[144:147]
  buffer_load_dwordx4 v61, s[12:15], s5 offen offset:0 lds
  v_mfma_f32_16x16x32_bf16 v[144:147], a[44:47], v[196:199], v[144:147]
  s_add_u32 m0, s46, 139136
  ds_read_b64_tr_b16 a[48:49], v62 offset:49152
  ds_read_b64_tr_b16 a[50:51], v62 offset:49664
  v_mfma_f32_16x16x32_bf16 v[148:151], a[32:35], v[216:219], v[148:151]
  buffer_load_dwordx4 v61, s[12:15], s5 offen offset:128 lds
  v_mfma_f32_16x16x32_bf16 v[148:151], a[44:47], v[220:223], v[148:151]
  s_add_u32 m0, s46, 147200
  ds_read_b64_tr_b16 a[60:61], v62 offset:53248
  ds_read_b64_tr_b16 a[62:63], v62 offset:53760
  v_mfma_f32_16x16x32_bf16 v[108:111], a[32:35], v[240:243], v[108:111]
  buffer_load_dwordx4 v61, s[12:15], s5 offen offset:256 lds
  v_mfma_f32_16x16x32_bf16 v[108:111], a[44:47], v[244:247], v[108:111]
  ds_read_b64_tr_b16 a[52:53], v63 offset:49152
  ds_read_b64_tr_b16 a[54:55], v63 offset:49664
  v_mfma_f32_16x16x32_bf16 v[96:99], a[32:35], a[224:227], v[96:99]
  ds_read_b64_tr_b16 a[64:65], v63 offset:53248
  ds_read_b64_tr_b16 a[66:67], v63 offset:53760
  v_mfma_f32_16x16x32_bf16 v[96:99], a[44:47], a[228:231], v[96:99]
  s_waitcnt lgkmcnt(6)
  ds_read_b64_tr_b16 a[56:57], v71 offset:49152
  ds_read_b64_tr_b16 a[58:59], v71 offset:49664
  v_mfma_f32_16x16x32_bf16 v[120:123], a[48:51], v[200:203], v[120:123]
  s_waitcnt lgkmcnt(6)
  ds_read_b64_tr_b16 a[68:69], v71 offset:53248
  ds_read_b64_tr_b16 a[70:71], v71 offset:53760
  v_mfma_f32_16x16x32_bf16 v[120:123], a[60:63], v[204:207], v[120:123]
  v_mfma_f32_16x16x32_bf16 v[132:135], a[48:51], v[224:227], v[132:135]
  v_mfma_f32_16x16x32_bf16 v[132:135], a[60:63], v[228:231], v[132:135]
  v_mfma_f32_16x16x32_bf16 v[160:163], a[48:51], v[248:251], v[160:163]
  v_mul_f32 v120, s42, v120
  v_mul_f32 v121, s42, v121
  v_mfma_f32_16x16x32_bf16 v[160:163], a[60:63], v[252:255], v[160:163]
  s_add_u32 s5, s44, 147840
  s_add_u32 m0, s46, 28672
  v_mul_f32 v122, s42, v122
  v_mfma_f32_16x16x32_bf16 v[176:179], a[48:51], a[232:235], v[176:179]
  v_mul_f32 v123, s42, v123
  v_cvt_pk_bf16_f32 v12, v120, v121
  v_mfma_f32_16x16x32_bf16 v[176:179], a[60:63], a[236:239], v[176:179]
  s_waitcnt lgkmcnt(0)
  v_cvt_pk_bf16_f32 v13, v122, v123
  v_mul_f32 v132, s42, v132
  v_mfma_f32_16x16x32_bf16 v[140:143], a[52:55], v[200:203], v[140:143]
  buffer_load_dwordx4 v61, s[12:15], s5 offen offset:0 lds
  v_mfma_f32_16x16x32_bf16 v[140:143], a[64:67], v[204:207], v[140:143]
  s_add_u32 m0, s46, 36736
  v_mul_f32 v133, s42, v133
  v_mul_f32 v134, s42, v134
  v_mfma_f32_16x16x32_bf16 v[124:127], a[52:55], v[224:227], v[124:127]
  buffer_load_dwordx4 v61, s[12:15], s5 offen offset:128 lds
  v_mfma_f32_16x16x32_bf16 v[124:127], a[64:67], v[228:231], v[124:127]
  s_add_u32 m0, s46, 44800
  v_mul_f32 v135, s42, v135
  v_cvt_pk_bf16_f32 v64, v132, v133
  v_mfma_f32_16x16x32_bf16 v[168:171], a[52:55], v[248:251], v[168:171]
  buffer_load_dwordx4 v61, s[12:15], s5 offen offset:256 lds
  v_mfma_f32_16x16x32_bf16 v[168:171], a[64:67], v[252:255], v[168:171]
  s_add_u32 s5, s44, 184704
  s_add_u32 m0, s46, 32768
  v_mul_f32 v140, s42, v140
  v_mfma_f32_16x16x32_bf16 v[116:119], a[52:55], a[232:235], v[116:119]
  v_mul_f32 v141, s42, v141
  v_mul_f32 v142, s42, v142
  v_mfma_f32_16x16x32_bf16 v[116:119], a[64:67], a[236:239], v[116:119]
  s_waitcnt vmcnt(9)
  s_barrier
  v_mfma_f32_16x16x32_bf16 v[144:147], a[56:59], v[200:203], v[144:147]
  buffer_load_dwordx4 v61, s[12:15], s5 offen offset:0 lds
  v_mfma_f32_16x16x32_bf16 v[144:147], a[68:71], v[204:207], v[144:147]
  s_add_u32 m0, s46, 40832
  ds_read_b64_tr_b16 a[72:73], v58 offset:0
  ds_read_b64_tr_b16 a[74:75], v58 offset:512
  v_mfma_f32_16x16x32_bf16 v[148:151], a[56:59], v[224:227], v[148:151]
  buffer_load_dwordx4 v61, s[12:15], s5 offen offset:128 lds
  v_mfma_f32_16x16x32_bf16 v[148:151], a[68:71], v[228:231], v[148:151]
  s_add_u32 m0, s46, 48896
  ds_read_b64_tr_b16 a[84:85], v58 offset:4096
  ds_read_b64_tr_b16 a[86:87], v58 offset:4608
  v_mfma_f32_16x16x32_bf16 v[108:111], a[56:59], v[248:251], v[108:111]
  buffer_load_dwordx4 v61, s[12:15], s5 offen offset:256 lds
  v_mfma_f32_16x16x32_bf16 v[108:111], a[68:71], v[252:255], v[108:111]
  ds_read_b64_tr_b16 a[76:77], v59 offset:0
  ds_read_b64_tr_b16 a[78:79], v59 offset:512
  v_mfma_f32_16x16x32_bf16 v[96:99], a[56:59], a[232:235], v[96:99]
  ds_read_b64_tr_b16 a[88:89], v59 offset:4096
  ds_read_b64_tr_b16 a[90:91], v59 offset:4608
  v_mfma_f32_16x16x32_bf16 v[96:99], a[68:71], a[236:239], v[96:99]
  s_waitcnt lgkmcnt(6)
  ds_read_b64_tr_b16 a[80:81], v60 offset:0
  ds_read_b64_tr_b16 a[82:83], v60 offset:512
  v_mfma_f32_16x16x32_bf16 v[128:131], a[72:75], v[184:187], 0
  s_waitcnt lgkmcnt(6)
  ds_read_b64_tr_b16 a[92:93], v60 offset:4096
  ds_read_b64_tr_b16 a[94:95], v60 offset:4608
  v_mfma_f32_16x16x32_bf16 v[128:131], a[84:87], v[188:191], v[128:131]
  v_mul_f32 v143, s42, v143
  v_cvt_pk_bf16_f32 v112, v140, v141
  v_mfma_f32_16x16x32_bf16 v[152:155], a[72:75], v[208:211], 0
  v_cvt_pk_bf16_f32 v113, v142, v143
  v_mul_f32 v144, s42, v144
  v_mfma_f32_16x16x32_bf16 v[152:155], a[84:87], v[212:215], v[152:155]
  v_mul_f32 v145, s42, v145
  v_mul_f32 v146, s42, v146
  v_mfma_f32_16x16x32_bf16 v[156:159], a[72:75], v[232:235], 0
  v_mul_f32 v147, s42, v147
  v_cvt_pk_bf16_f32 v114, v144, v145
  v_mfma_f32_16x16x32_bf16 v[156:159], a[84:87], v[236:239], v[156:159]
  s_add_u32 s5, s44, 768
  s_add_u32 m0, s46, 53248
  v_cvt_pk_bf16_f32 v115, v146, v147
  v_mfma_f32_16x16x32_bf16 v[164:167], a[72:75], a[216:219], 0
  v_cvt_pk_bf16_f32 v65, v134, v135
  v_mul_f32 v124, s42, v124
  v_mfma_f32_16x16x32_bf16 v[164:167], a[84:87], a[220:223], v[164:167]
  s_waitcnt lgkmcnt(0)
  v_mul_f32 v125, s42, v125
  v_mul_f32 v126, s42, v126
  v_mfma_f32_16x16x32_bf16 v[132:135], a[76:79], v[184:187], 0
  buffer_load_dwordx4 v61, s[12:15], s5 offen offset:0 lds
  v_mfma_f32_16x16x32_bf16 v[132:135], a[88:91], v[188:191], v[132:135]
  s_add_u32 m0, s46, 61312
  v_mul_f32 v127, s42, v127
  v_cvt_pk_bf16_f32 v66, v124, v125
  v_mfma_f32_16x16x32_bf16 v[100:103], a[76:79], v[208:211], 0
  buffer_load_dwordx4 v61, s[12:15], s5 offen offset:128 lds
  v_mfma_f32_16x16x32_bf16 v[100:103], a[88:91], v[212:215], v[100:103]
  s_add_u32 m0, s46, 69376
  v_cvt_pk_bf16_f32 v67, v126, v127
  v_mul_f32 v148, s42, v148
  v_mfma_f32_16x16x32_bf16 v[138:141], a[76:79], v[232:235], 0
  buffer_load_dwordx4 v61, s[12:15], s5 offen offset:256 lds
  v_mfma_f32_16x16x32_bf16 v[138:141], a[88:91], v[236:239], v[138:141]
  s_add_u32 s5, s44, 37632
  s_add_u32 m0, s46, 57344
  v_mul_f32 v149, s42, v149
  v_mfma_f32_16x16x32_bf16 v[180:183], a[76:79], a[216:219], 0
  v_mul_f32 v150, s42, v150
  v_mul_f32 v151, s42, v151
  v_mfma_f32_16x16x32_bf16 v[180:183], a[88:91], a[220:223], v[180:183]
  s_waitcnt vmcnt(9)
  s_barrier
  v_mfma_f32_16x16x32_bf16 v[142:145], a[80:83], v[184:187], 0
  buffer_load_dwordx4 v61, s[12:15], s5 offen offset:0 lds
  v_mfma_f32_16x16x32_bf16 v[142:145], a[92:95], v[188:191], v[142:145]
  s_add_u32 m0, s46, 65408
  ds_read_b64_tr_b16 a[96:97], v58 offset:24576
  ds_read_b64_tr_b16 a[98:99], v58 offset:25088
  v_mfma_f32_16x16x32_bf16 v[124:127], a[80:83], v[208:211], 0
  buffer_load_dwordx4 v61, s[12:15], s5 offen offset:128 lds
  v_mfma_f32_16x16x32_bf16 v[124:127], a[92:95], v[212:215], v[124:127]
  s_add_u32 m0, s46, 73472
  ds_read_b64_tr_b16 a[108:109], v58 offset:28672
  ds_read_b64_tr_b16 a[110:111], v58 offset:29184
  v_mfma_f32_16x16x32_bf16 v[104:107], a[80:83], v[232:235], 0
  buffer_load_dwordx4 v61, s[12:15], s5 offen offset:256 lds
  v_mfma_f32_16x16x32_bf16 v[104:107], a[92:95], v[236:239], v[104:107]
  ds_read_b64_tr_b16 a[100:101], v59 offset:24576
  ds_read_b64_tr_b16 a[102:103], v59 offset:25088
  v_mfma_f32_16x16x32_bf16 v[172:175], a[80:83], a[216:219], 0
  ds_read_b64_tr_b16 a[112:113], v59 offset:28672
  ds_read_b64_tr_b16 a[114:115], v59 offset:29184
  v_mfma_f32_16x16x32_bf16 v[172:175], a[92:95], a[220:223], v[172:175]
  s_waitcnt lgkmcnt(6)
  ds_read_b64_tr_b16 a[104:105], v60 offset:24576
  ds_read_b64_tr_b16 a[106:107], v60 offset:25088
  v_mfma_f32_16x16x32_bf16 v[128:131], a[96:99], v[192:195], v[128:131]
  s_waitcnt lgkmcnt(6)
  ds_read_b64_tr_b16 a[116:117], v60 offset:28672
  ds_read_b64_tr_b16 a[118:119], v60 offset:29184
  v_mfma_f32_16x16x32_bf16 v[128:131], a[108:111], v[196:199], v[128:131]
  v_cvt_pk_bf16_f32 v16, v148, v149
  v_cvt_pk_bf16_f32 v17, v150, v151
  v_mfma_f32_16x16x32_bf16 v[152:155], a[96:99], v[216:219], v[152:155]
  v_mul_f32 v160, s42, v160
  v_mul_f32 v161, s42, v161
  v_mfma_f32_16x16x32_bf16 v[152:155], a[108:111], v[220:223], v[152:155]
  v_mul_f32 v162, s42, v162
  v_mul_f32 v163, s42, v163
  v_mfma_f32_16x16x32_bf16 v[156:159], a[96:99], v[240:243], v[156:159]
  v_cvt_pk_bf16_f32 v18, v160, v161
  v_cvt_pk_bf16_f32 v19, v162, v163
  v_mfma_f32_16x16x32_bf16 v[156:159], a[108:111], v[244:247], v[156:159]
  s_add_u32 s5, s44, 74496
  s_add_u32 m0, s46, 77824
  v_mul_f32 v168, s42, v168
  v_mfma_f32_16x16x32_bf16 v[164:167], a[96:99], a[224:227], v[164:167]
  v_mul_f32 v169, s42, v169
  v_mul_f32 v170, s42, v170
  v_mfma_f32_16x16x32_bf16 v[164:167], a[108:111], a[228:231], v[164:167]
  s_waitcnt lgkmcnt(0)
  v_mul_f32 v171, s42, v171
  v_cvt_pk_bf16_f32 v136, v168, v169
  v_mfma_f32_16x16x32_bf16 v[132:135], a[100:103], v[192:195], v[132:135]
  buffer_load_dwordx4 v61, s[12:15], s5 offen offset:0 lds
  v_mfma_f32_16x16x32_bf16 v[132:135], a[112:115], v[196:199], v[132:135]
  s_add_u32 m0, s46, 85888
  v_cvt_pk_bf16_f32 v137, v170, v171
  v_mul_f32 v108, s42, v108
  v_mfma_f32_16x16x32_bf16 v[100:103], a[100:103], v[216:219], v[100:103]
  buffer_load_dwordx4 v61, s[12:15], s5 offen offset:128 lds
  v_mfma_f32_16x16x32_bf16 v[100:103], a[112:115], v[220:223], v[100:103]
  s_add_u32 m0, s46, 93952
  v_mul_f32 v109, s42, v109
  v_mul_f32 v110, s42, v110
  v_mfma_f32_16x16x32_bf16 v[138:141], a[100:103], v[240:243], v[138:141]
  buffer_load_dwordx4 v61, s[12:15], s5 offen offset:256 lds
  v_mfma_f32_16x16x32_bf16 v[138:141], a[112:115], v[244:247], v[138:141]
  s_add_u32 s5, s44, 111360
  s_add_u32 m0, s46, 81920
  v_mul_f32 v111, s42, v111
  v_mfma_f32_16x16x32_bf16 v[180:183], a[100:103], a[224:227], v[180:183]
  v_add_f32 v168, v70, v36
  v_add_f32 v169, v70, v37
  v_mfma_f32_16x16x32_bf16 v[180:183], a[112:115], a[228:231], v[180:183]
  s_waitcnt vmcnt(9)
  s_barrier
  v_mfma_f32_16x16x32_bf16 v[142:145], a[104:107], v[192:195], v[142:145]
  buffer_load_dwordx4 v61, s[12:15], s5 offen offset:0 lds
  v_mfma_f32_16x16x32_bf16 v[142:145], a[116:119], v[196:199], v[142:145]
  s_add_u32 m0, s46, 89984
  ds_read_b64_tr_b16 a[120:121], v62 offset:0
  ds_read_b64_tr_b16 a[122:123], v62 offset:512
  v_mfma_f32_16x16x32_bf16 v[124:127], a[104:107], v[216:219], v[124:127]
  buffer_load_dwordx4 v61, s[12:15], s5 offen offset:128 lds
  v_mfma_f32_16x16x32_bf16 v[124:127], a[116:119], v[220:223], v[124:127]
  s_add_u32 m0, s46, 98048
  ds_read_b64_tr_b16 a[132:133], v62 offset:4096
  ds_read_b64_tr_b16 a[134:135], v62 offset:4608
  v_mfma_f32_16x16x32_bf16 v[104:107], a[104:107], v[240:243], v[104:107]
  buffer_load_dwordx4 v61, s[12:15], s5 offen offset:256 lds
  v_mfma_f32_16x16x32_bf16 v[104:107], a[116:119], v[244:247], v[104:107]
  ds_read_b64_tr_b16 a[124:125], v63 offset:0
  ds_read_b64_tr_b16 a[126:127], v63 offset:512
  v_mfma_f32_16x16x32_bf16 v[172:175], a[104:107], a[224:227], v[172:175]
  ds_read_b64_tr_b16 a[136:137], v63 offset:4096
  ds_read_b64_tr_b16 a[138:139], v63 offset:4608
  v_mfma_f32_16x16x32_bf16 v[172:175], a[116:119], a[228:231], v[172:175]
  s_waitcnt lgkmcnt(6)
  ds_read_b64_tr_b16 a[128:129], v71 offset:0
  ds_read_b64_tr_b16 a[130:131], v71 offset:512
  v_mfma_f32_16x16x32_bf16 v[128:131], a[120:123], v[200:203], v[128:131]
  s_waitcnt lgkmcnt(6)
  ds_read_b64_tr_b16 a[140:141], v71 offset:4096
  ds_read_b64_tr_b16 a[142:143], v71 offset:4608
  v_mfma_f32_16x16x32_bf16 v[128:131], a[132:135], v[204:207], v[128:131]
  v_add_f32 v170, v70, v38
  v_add_f32 v171, v70, v39
  v_mfma_f32_16x16x32_bf16 v[152:155], a[120:123], v[224:227], v[152:155]
  v_add_f32 v146, v70, v32
  v_add_f32 v147, v70, v33
  v_mfma_f32_16x16x32_bf16 v[152:155], a[132:135], v[228:231], v[152:155]
  v_add_f32 v148, v70, v34
  v_add_f32 v149, v70, v35
  v_mfma_f32_16x16x32_bf16 v[156:159], a[120:123], v[248:251], v[156:159]
  v_cvt_pk_bf16_f32 v162, v128, v129
  v_cvt_pk_bf16_f32 v163, v130, v131
  v_mfma_f32_16x16x32_bf16 v[156:159], a[132:135], v[252:255], v[156:159]
  s_add_u32 s5, s44, 148224
  s_add_u32 m0, s46, 102400
  v_add_f32 v120, v70, v40
  v_mfma_f32_16x16x32_bf16 v[164:167], a[120:123], a[232:235], v[164:167]
  v_cvt_pk_bf16_f32 v128, v152, v153
  v_cvt_pk_bf16_f32 v129, v154, v155
  v_mfma_f32_16x16x32_bf16 v[164:167], a[132:135], a[236:239], v[164:167]
  s_waitcnt lgkmcnt(0)
  v_add_f32 v121, v70, v41
  v_add_f32 v122, v70, v42
  v_mfma_f32_16x16x32_bf16 v[132:135], a[124:127], v[200:203], v[132:135]
  buffer_load_dwordx4 v61, s[12:15], s5 offen offset:0 lds
  v_mfma_f32_16x16x32_bf16 v[132:135], a[136:139], v[204:207], v[132:135]
  s_add_u32 m0, s46, 110464
  v_cvt_pk_bf16_f32 v150, v156, v157
  v_cvt_pk_bf16_f32 v151, v158, v159
  v_mfma_f32_16x16x32_bf16 v[100:103], a[124:127], v[224:227], v[100:103]
  buffer_load_dwordx4 v61, s[12:15], s5 offen offset:128 lds
  v_mfma_f32_16x16x32_bf16 v[100:103], a[136:139], v[228:231], v[100:103]
  s_add_u32 m0, s46, 118528
  v_cvt_pk_bf16_f32 v156, v164, v165
  v_cvt_pk_bf16_f32 v157, v166, v167
  v_mfma_f32_16x16x32_bf16 v[138:141], a[124:127], v[248:251], v[138:141]
  buffer_load_dwordx4 v61, s[12:15], s5 offen offset:256 lds
  v_mfma_f32_16x16x32_bf16 v[138:141], a[136:139], v[252:255], v[138:141]
  s_add_u32 s5, s44, 185088
  s_add_u32 m0, s46, 106496
  v_cvt_pk_bf16_f32 v164, v132, v133
  v_mfma_f32_16x16x32_bf16 v[180:183], a[124:127], a[232:235], v[180:183]
  v_cvt_pk_bf16_f32 v165, v134, v135
  v_cvt_pk_bf16_f32 v130, v100, v101
  v_mfma_f32_16x16x32_bf16 v[180:183], a[136:139], a[236:239], v[180:183]
  v_cvt_pk_bf16_f32 v131, v102, v103
  v_add_f32 v123, v70, v43
  v_mfma_f32_16x16x32_bf16 v[142:145], a[128:131], v[200:203], v[142:145]
  buffer_load_dwordx4 v61, s[12:15], s5 offen offset:0 lds
  v_mfma_f32_16x16x32_bf16 v[142:145], a[140:143], v[204:207], v[142:145]
  s_add_u32 m0, s46, 114560
  v_cvt_pk_bf16_f32 v152, v138, v139
  v_cvt_pk_bf16_f32 v153, v140, v141
  v_mfma_f32_16x16x32_bf16 v[124:127], a[128:131], v[224:227], v[124:127]
  buffer_load_dwordx4 v61, s[12:15], s5 offen offset:128 lds
  v_mfma_f32_16x16x32_bf16 v[124:127], a[140:143], v[228:231], v[124:127]
  s_add_u32 m0, s46, 122624
  v_cvt_pk_bf16_f32 v158, v180, v181
  v_cvt_pk_bf16_f32 v159, v182, v183
  v_mfma_f32_16x16x32_bf16 v[104:107], a[128:131], v[248:251], v[104:107]
  buffer_load_dwordx4 v61, s[12:15], s5 offen offset:256 lds
  v_mfma_f32_16x16x32_bf16 v[104:107], a[140:143], v[252:255], v[104:107]
  v_cvt_pk_bf16_f32 v166, v142, v143
  v_cvt_pk_bf16_f32 v167, v144, v145
  v_mfma_f32_16x16x32_bf16 v[172:175], a[128:131], a[232:235], v[172:175]
  v_cvt_pk_bf16_f32 v132, v124, v125
  v_cvt_pk_bf16_f32 v133, v126, v127
  v_mfma_f32_16x16x32_bf16 v[172:175], a[140:143], a[236:239], v[172:175]
  v_cvt_pk_bf16_f32 v138, v108, v109
  v_cvt_pk_bf16_f32 v139, v110, v111
  v_mfma_f32_16x16x32_bf16 v[100:103], v[164:167], v[112:115], v[168:171]
  v_cvt_pk_bf16_f32 v154, v104, v105
  v_cvt_pk_bf16_f32 v155, v106, v107
  v_mfma_f32_16x16x32_bf16 v[100:103], v[162:165], v[12:15], v[100:103]
  v_mul_f32 v176, s42, v176
  v_mul_f32 v177, s42, v177
  v_mfma_f32_16x16x32_bf16 v[104:107], v[130:133], v[112:115], v[146:149]
  v_cvt_pk_bf16_f32 v160, v172, v173
  v_cvt_pk_bf16_f32 v161, v174, v175
  v_mfma_f32_16x16x32_bf16 v[104:107], v[128:131], v[12:15], v[104:107]
  v_mul_f32 v178, s42, v178
  v_mul_f32 v179, s42, v179
  v_mfma_f32_16x16x32_bf16 v[172:175], v[152:155], v[112:115], v[88:91]
  v_cvt_pk_bf16_f32 v140, v176, v177
  v_cvt_pk_bf16_f32 v141, v178, v179
  v_mfma_f32_16x16x32_bf16 v[172:175], v[150:153], v[12:15], v[172:175]
  v_mul_f32 v116, s42, v116
  v_mul_f32 v117, s42, v117
  v_mfma_f32_16x16x32_bf16 v[180:183], v[158:161], v[112:115], v[92:95]
  v_mul_f32 v118, s42, v118
  v_mul_f32 v119, s42, v119
  v_mfma_f32_16x16x32_bf16 v[180:183], v[156:159], v[12:15], v[180:183]
  v_cvt_pk_bf16_f32 v142, v116, v117
  v_cvt_pk_bf16_f32 v143, v118, v119
  v_mfma_f32_16x16x32_bf16 v[108:111], v[162:165], v[64:67], v[120:123]
  v_mul_f32 v96, s42, v96
  v_mul_f32 v97, s42, v97
  v_mfma_f32_16x16x32_bf16 v[108:111], v[164:167], v[14:17], v[108:111]
  v_mul_f32 v98, s42, v98
  v_mul_f32 v99, s42, v99
  v_mfma_f32_16x16x32_bf16 v[112:115], v[128:131], v[64:67], v[168:171]
  v_cvt_pk_bf16_f32 v22, v96, v97
  v_cvt_pk_bf16_f32 v23, v98, v99
  v_mfma_f32_16x16x32_bf16 v[112:115], v[130:133], v[14:17], v[112:115]
  v_exp_f32 v100, v100
  v_mfma_f32_16x16x32_bf16 v[124:127], v[150:153], v[64:67], v[84:87]
  v_exp_f32 v101, v101
  v_mfma_f32_16x16x32_bf16 v[124:127], v[152:155], v[14:17], v[124:127]
  v_exp_f32 v102, v102
  v_mfma_f32_16x16x32_bf16 v[116:119], v[156:159], v[64:67], v[88:91]
  v_exp_f32 v103, v103
  v_mfma_f32_16x16x32_bf16 v[116:119], v[158:161], v[14:17], v[116:119]
  v_exp_f32 v104, v104
  v_mfma_f32_16x16x32_bf16 v[92:95], v[152:155], v[136:139], v[168:171]
  v_exp_f32 v105, v105
  v_mfma_f32_16x16x32_bf16 v[92:95], v[150:153], v[18:21], v[92:95]
  buffer_load_dword v134, v57, s[16:19], s51 offen
  v_mfma_f32_16x16x32_bf16 v[96:99], v[158:161], v[136:139], v[146:149]
  s_add_u32 m0, s28, 0
  v_exp_f32 v106, v106
  v_mfma_f32_16x16x32_bf16 v[96:99], v[156:159], v[18:21], v[96:99]
  v_exp_f32 v107, v107
  v_mfma_f32_16x16x32_bf16 v[176:179], v[164:167], v[136:139], v[72:75]
  s_waitcnt vmcnt(7)
  s_barrier
  v_mfma_f32_16x16x32_bf16 v[176:179], v[162:165], v[18:21], v[176:179]
  buffer_load_dwordx4 v6, s[8:11], s31 offen offset:0 nt lds
  v_mfma_f32_16x16x32_bf16 v[144:147], v[130:133], v[136:139], v[80:83]
  s_add_u32 m0, s28, 8064
  ds_read_b64_tr_b16 a[144:145], v62 offset:24576
  ds_read_b64_tr_b16 a[146:147], v62 offset:25088
  v_mfma_f32_16x16x32_bf16 v[144:147], v[128:131], v[18:21], v[144:147]
  ds_read_b64_tr_b16 a[156:157], v62 offset:28672
  ds_read_b64_tr_b16 a[158:159], v62 offset:29184
  v_mfma_f32_16x16x32_bf16 v[84:87], v[150:153], v[140:143], v[120:123]
  buffer_load_dwordx4 v6, s[8:11], s31 offen offset:128 nt lds
  v_mfma_f32_16x16x32_bf16 v[84:87], v[152:155], v[20:23], v[84:87]
  s_add_u32 m0, s28, 16128
  ds_read_b64_tr_b16 a[148:149], v63 offset:24576
  ds_read_b64_tr_b16 a[150:151], v63 offset:25088
  v_mfma_f32_16x16x32_bf16 v[88:91], v[156:159], v[140:143], v[168:171]
  ds_read_b64_tr_b16 a[160:161], v63 offset:28672
  ds_read_b64_tr_b16 a[162:163], v63 offset:29184
  v_mfma_f32_16x16x32_bf16 v[88:91], v[158:161], v[20:23], v[88:91]
  buffer_load_dwordx4 v6, s[8:11], s31 offen offset:256 nt lds
  v_mfma_f32_16x16x32_bf16 v[148:151], v[162:165], v[140:143], v[76:79]
  s_add_u32 s31, s31, s43
  ds_read_b64_tr_b16 a[152:153], v71 offset:24576
  ds_read_b64_tr_b16 a[154:155], v71 offset:25088
  v_mfma_f32_16x16x32_bf16 v[148:151], v[164:167], v[20:23], v[148:151]
  ds_read_b64_tr_b16 a[164:165], v71 offset:28672
  ds_read_b64_tr_b16 a[166:167], v71 offset:29184
  v_mfma_f32_16x16x32_bf16 v[160:163], v[128:131], v[140:143], v[72:75]
  ds_read_b64_tr_b16 a[168:169], v62 offset:49152
  ds_read_b64_tr_b16 a[170:171], v62 offset:49664
  v_mfma_f32_16x16x32_bf16 v[160:163], v[130:133], v[20:23], v[160:163]
  s_waitcnt lgkmcnt(6)
  ds_read_b64_tr_b16 a[180:181], v62 offset:53248
  ds_read_b64_tr_b16 a[182:183], v62 offset:53760
  v_mfma_f32_16x16x32_bf16 v[136:139], v[184:187], a[144:147], 0
  ds_read_b64_tr_b16 a[172:173], v63 offset:49152
  ds_read_b64_tr_b16 a[174:175], v63 offset:49664
  v_mfma_f32_16x16x32_bf16 v[136:139], v[188:191], a[156:159], v[136:139]
  ds_read_b64_tr_b16 a[184:185], v63 offset:53248
  ds_read_b64_tr_b16 a[186:187], v63 offset:53760
  v_mfma_f32_16x16x32_bf16 v[72:75], v[184:187], a[148:151], 0
  ds_read_b64_tr_b16 a[176:177], v71 offset:49152
  ds_read_b64_tr_b16 a[178:179], v71 offset:49664
  v_mfma_f32_16x16x32_bf16 v[72:75], v[188:191], a[160:163], v[72:75]
  s_waitcnt lgkmcnt(8)
  ds_read_b64_tr_b16 a[188:189], v71 offset:53248
  ds_read_b64_tr_b16 a[190:191], v71 offset:53760
  v_mfma_f32_16x16x32_bf16 v[152:155], v[184:187], a[152:155], 0
  v_exp_f32 v172, v172
  v_mfma_f32_16x16x32_bf16 v[152:155], v[188:191], a[164:167], v[152:155]
  v_exp_f32 v173, v173
  v_mfma_f32_16x16x32_bf16 v[76:79], v[208:211], a[144:147], 0
  v_exp_f32 v174, v174
  v_mfma_f32_16x16x32_bf16 v[76:79], v[212:215], a[156:159], v[76:79]
  v_exp_f32 v175, v175
  v_mfma_f32_16x16x32_bf16 v[140:143], v[208:211], a[148:151], 0
  v_exp_f32 v180, v180
  v_mfma_f32_16x16x32_bf16 v[140:143], v[212:215], a[160:163], v[140:143]
  v_exp_f32 v181, v181
  v_mfma_f32_16x16x32_bf16 v[128:131], v[208:211], a[152:155], 0
  v_exp_f32 v182, v182
  v_mfma_f32_16x16x32_bf16 v[128:131], v[212:215], a[164:167], v[128:131]
  v_exp_f32 v183, v183
  v_mfma_f32_16x16x32_bf16 v[136:139], v[192:195], a[168:171], v[136:139]
  s_waitcnt lgkmcnt(0)
  v_cvt_pk_bf16_f32 v100, v100, v101
  v_cvt_pk_bf16_f32 v101, v102, v103
  v_mfma_f32_16x16x32_bf16 v[136:139], v[196:199], a[180:183], v[136:139]
  v_cvt_pk_bf16_f32 v102, v104, v105
  v_cvt_pk_bf16_f32 v103, v106, v107
  v_mfma_f32_16x16x32_bf16 v[72:75], v[192:195], a[172:175], v[72:75]
  v_cvt_pk_bf16_f32 v104, v172, v173
  v_cvt_pk_bf16_f32 v105, v174, v175
  v_mfma_f32_16x16x32_bf16 v[72:75], v[196:199], a[184:187], v[72:75]
  v_cvt_pk_bf16_f32 v106, v180, v181
  v_cvt_pk_bf16_f32 v107, v182, v183
  v_mfma_f32_16x16x32_bf16 v[152:155], v[192:195], a[176:179], v[152:155]
  v_exp_f32 v108, v108
  v_mfma_f32_16x16x32_bf16 v[152:155], v[196:199], a[188:191], v[152:155]
  s_waitcnt vmcnt(4)
  s_barrier
  v_mfma_f32_16x16x32_bf16 v[76:79], v[216:219], a[168:171], v[76:79]
  ds_read_b64_tr_b16 a[192:193], v58 offset:0
  ds_read_b64_tr_b16 a[194:195], v58 offset:512
  v_mfma_f32_16x16x32_bf16 v[76:79], v[220:223], a[180:183], v[76:79]
  ds_read_b64_tr_b16 a[204:205], v58 offset:4096
  ds_read_b64_tr_b16 a[206:207], v58 offset:4608
  v_mfma_f32_16x16x32_bf16 v[140:143], v[216:219], a[172:175], v[140:143]
  ds_read_b64_tr_b16 a[196:197], v59 offset:0
  ds_read_b64_tr_b16 a[198:199], v59 offset:512
  v_mfma_f32_16x16x32_bf16 v[140:143], v[220:223], a[184:187], v[140:143]
  s_waitcnt lgkmcnt(4)
  ds_read_b64_tr_b16 a[208:209], v59 offset:4096
  ds_read_b64_tr_b16 a[210:211], v59 offset:4608
  v_mfma_f32_16x16x32_bf16 v[128:131], v[216:219], a[176:179], v[128:131]
  s_add_u32 s5, s45, 0
  ds_read_b64_tr_b16 a[200:201], v60 offset:0
  ds_read_b64_tr_b16 a[202:203], v60 offset:512
  v_mfma_f32_16x16x32_bf16 v[128:131], v[220:223], a[188:191], v[128:131]
  s_add_u32 m0, s46, 126976
  ds_read_b64_tr_b16 a[212:213], v60 offset:4096
  ds_read_b64_tr_b16 a[214:215], v60 offset:4608
  v_mfma_f32_16x16x32_bf16 v[136:139], v[200:203], a[192:195], v[136:139]
  s_waitcnt lgkmcnt(8)
  v_exp_f32 v109, v109
  v_mfma_f32_16x16x32_bf16 v[136:139], v[204:207], a[204:207], v[136:139]
  buffer_load_dwordx4 v56, s[16:19], s5 offen offset:0 lds
  s_waitcnt lgkmcnt(6)
  v_mfma_f32_16x16x32_bf16 v[72:75], v[200:203], a[196:199], v[72:75]
  s_add_u32 m0, s46, 135040
  v_exp_f32 v110, v110
  s_waitcnt lgkmcnt(4)
  v_mfma_f32_16x16x32_bf16 v[72:75], v[204:207], a[208:211], v[72:75]
  s_waitcnt lgkmcnt(2)
  v_exp_f32 v111, v111
  v_mfma_f32_16x16x32_bf16 v[152:155], v[200:203], a[200:203], v[152:155]
  buffer_load_dwordx4 v56, s[16:19], s5 offen offset:128 lds
  s_waitcnt lgkmcnt(0)
  v_mfma_f32_16x16x32_bf16 v[152:155], v[204:207], a[212:215], v[152:155]
  s_add_u32 m0, s46, 143104
  v_cvt_pk_bf16_f32 v172, v136, v137
  v_cvt_pk_bf16_f32 v173, v138, v139
  v_mfma_f32_16x16x32_bf16 v[76:79], v[224:227], a[192:195], v[76:79]
  v_cvt_pk_bf16_f32 v168, v72, v73
  v_cvt_pk_bf16_f32 v169, v74, v75
  v_mfma_f32_16x16x32_bf16 v[76:79], v[228:231], a[204:207], v[76:79]
  buffer_load_dwordx4 v56, s[16:19], s5 offen offset:256 lds
  v_mfma_f32_16x16x32_bf16 v[140:143], v[224:227], a[196:199], v[140:143]
  s_add_u32 s5, s45, 12288
  v_cvt_pk_bf16_f32 v70, v152, v153
  v_cvt_pk_bf16_f32 v71, v154, v155
  v_mfma_f32_16x16x32_bf16 v[140:143], v[228:231], a[208:211], v[140:143]
  s_add_u32 m0, s46, 131072
  v_exp_f32 v112, v112
  v_mfma_f32_16x16x32_bf16 v[128:131], v[224:227], a[200:203], v[128:131]
  buffer_load_dwordx4 v56, s[16:19], s5 offen offset:0 lds
  v_mfma_f32_16x16x32_bf16 v[128:131], v[228:231], a[212:215], v[128:131]
  s_add_u32 m0, s46, 139136
  v_cvt_pk_bf16_f32 v174, v76, v77
  v_cvt_pk_bf16_f32 v175, v78, v79
  v_mfma_f32_16x16x32_bf16 v[60:63], v[232:235], a[144:147], 0
  v_cvt_pk_bf16_f32 v170, v140, v141
  v_cvt_pk_bf16_f32 v171, v142, v143
  v_mfma_f32_16x16x32_bf16 v[60:63], v[236:239], a[156:159], v[60:63]
  buffer_load_dwordx4 v56, s[16:19], s5 offen offset:128 lds
  v_mfma_f32_16x16x32_bf16 v[60:63], v[240:243], a[168:171], v[60:63]
  s_add_u32 m0, s46, 147200
  v_cvt_pk_bf16_f32 v72, v128, v129
  v_cvt_pk_bf16_f32 v73, v130, v131
  v_mfma_f32_16x16x32_bf16 v[60:63], v[244:247], a[180:183], v[60:63]
  v_exp_f32 v113, v113
  v_mfma_f32_16x16x32_bf16 v[60:63], v[248:251], a[192:195], v[60:63]
  buffer_load_dwordx4 v56, s[16:19], s5 offen offset:256 lds
  v_mfma_f32_16x16x32_bf16 v[60:63], v[252:255], a[204:207], v[60:63]
  v_exp_f32 v114, v114
  v_mfma_f32_16x16x32_bf16 v[128:131], v[232:235], a[148:151], 0
  v_exp_f32 v115, v115
  v_mfma_f32_16x16x32_bf16 v[128:131], v[236:239], a[160:163], v[128:131]
  v_exp_f32 v124, v124
  v_mfma_f32_16x16x32_bf16 v[128:131], v[240:243], a[172:175], v[128:131]
  v_cvt_pk_bf16_f32 v76, v60, v61
  v_cvt_pk_bf16_f32 v77, v62, v63
  v_mfma_f32_16x16x32_bf16 v[128:131], v[244:247], a[184:187], v[128:131]
  v_exp_f32 v125, v125
  v_mfma_f32_16x16x32_bf16 v[128:131], v[248:251], a[196:199], v[128:131]
  v_exp_f32 v126, v126
  v_mfma_f32_16x16x32_bf16 v[128:131], v[252:255], a[208:211], v[128:131]
  v_exp_f32 v127, v127
  v_mfma_f32_16x16x32_bf16 v[60:63], v[232:235], a[152:155], 0
L_hop_1_0:
  s_cbranch_execz L_hop_1_1
  v_exp_f32 v116, v116
  v_mfma_f32_16x16x32_bf16 v[60:63], v[236:239], a[164:167], v[60:63]
  v_exp_f32 v117, v117
  v_mfma_f32_16x16x32_bf16 v[60:63], v[240:243], a[176:179], v[60:63]
  v_cvt_pk_bf16_f32 v80, v128, v129
  v_cvt_pk_bf16_f32 v81, v130, v131
  v_cvt_pk_bf16_f32 v108, v108, v109
  v_mfma_f32_16x16x32_bf16 v[60:63], v[244:247], a[188:191], v[60:63]
  v_exp_f32 v118, v118
  v_cvt_pk_bf16_f32 v109, v110, v111
  v_mfma_f32_16x16x32_bf16 v[60:63], v[248:251], a[200:203], v[60:63]
  v_exp_f32 v119, v119
  v_cvt_pk_bf16_f32 v110, v112, v113
  v_mfma_f32_16x16x32_bf16 v[60:63], v[252:255], a[212:215], v[60:63]
  v_cvt_pk_bf16_f32 v111, v114, v115
  v_cvt_pk_bf16_f32 v112, v124, v125
  v_cvt_pk_bf16_f32 v113, v126, v127
  v_mfma_f32_16x16x32_bf16 v[128:131], a[216:219], a[144:147], 0
  v_cvt_pk_bf16_f32 v114, v116, v117
  v_cvt_pk_bf16_f32 v115, v118, v119
  v_add_u32 v0, s28, v2
  v_mfma_f32_16x16x32_bf16 v[128:131], a[220:223], a[156:159], v[128:131]
  s_add_u32 s5, s45, 24576
  s_add_u32 m0, s46, 0
  v_exp_f32 v92, v92
  v_mfma_f32_16x16x32_bf16 v[128:131], a[224:227], a[168:171], v[128:131]
  v_cvt_pk_bf16_f32 v120, v60, v61
  v_cvt_pk_bf16_f32 v121, v62, v63
  v_xor_b32 v1, 64, v0
  v_mfma_f32_16x16x32_bf16 v[128:131], a[228:231], a[180:183], v[128:131]
  v_exp_f32 v93, v93
  v_mfma_f32_16x16x32_bf16 v[128:131], a[232:235], a[192:195], v[128:131]
  buffer_load_dwordx4 v56, s[16:19], s5 offen offset:0 lds
  v_cvt_pk_bf16_f32 v92, v92, v93
  v_mfma_f32_16x16x32_bf16 v[128:131], a[236:239], a[204:207], v[128:131]
  s_add_u32 m0, s46, 8064
  v_exp_f32 v94, v94
  v_mfma_f32_16x16x32_bf16 v[124:127], a[216:219], a[148:151], 0
  v_exp_f32 v95, v95
  v_mfma_f32_16x16x32_bf16 v[124:127], a[220:223], a[160:163], v[124:127]
  buffer_load_dwordx4 v56, s[16:19], s5 offen offset:128 lds
  v_cvt_pk_bf16_f32 v93, v94, v95
  v_mfma_f32_16x16x32_bf16 v[124:127], a[224:227], a[172:175], v[124:127]
  s_add_u32 m0, s46, 16128
  v_cvt_pk_bf16_f32 v78, v128, v129
  v_cvt_pk_bf16_f32 v79, v130, v131
  v_mfma_f32_16x16x32_bf16 v[124:127], a[228:231], a[184:187], v[124:127]
  v_exp_f32 v96, v96
  v_mfma_f32_16x16x32_bf16 v[124:127], a[232:235], a[196:199], v[124:127]
  buffer_load_dwordx4 v56, s[16:19], s5 offen offset:256 lds
  v_mov_b64 v[164:165], 0
  v_mfma_f32_16x16x32_bf16 v[124:127], a[236:239], a[208:211], v[124:127]
  s_add_u32 s5, s45, 36864
  s_add_u32 m0, s46, 4096
  v_exp_f32 v97, v97
  v_mfma_f32_16x16x32_bf16 v[128:131], a[216:219], a[152:155], 0
  v_exp_f32 v98, v98
  v_cvt_pk_bf16_f32 v94, v96, v97
  v_mfma_f32_16x16x32_bf16 v[128:131], a[220:223], a[164:167], v[128:131]
  buffer_load_dwordx4 v56, s[16:19], s5 offen offset:0 lds
  v_mfma_f32_16x16x32_bf16 v[128:131], a[224:227], a[176:179], v[128:131]
  s_add_u32 m0, s46, 12160
  v_cvt_pk_bf16_f32 v82, v124, v125
  v_cvt_pk_bf16_f32 v83, v126, v127
  v_mfma_f32_16x16x32_bf16 v[128:131], a[228:231], a[188:191], v[128:131]
  v_exp_f32 v99, v99
  v_mfma_f32_16x16x32_bf16 v[128:131], a[232:235], a[200:203], v[128:131]
  buffer_load_dwordx4 v56, s[16:19], s5 offen offset:128 lds
  v_cvt_pk_bf16_f32 v95, v98, v99
  v_mfma_f32_16x16x32_bf16 v[128:131], a[236:239], a[212:215], v[128:131]
  s_add_u32 m0, s46, 20224
  v_mov_b64 v[140:141], 0
  v_exp_f32 v176, v176
  v_smfmac_f32_16x16x64_bf16 v[164:167], a[240:243], v[100:107], v10
  v_exp_f32 v177, v177
  v_mfma_f32_16x16x32_bf16 v[180:183], v[76:79], v[104:107], 0
  buffer_load_dwordx4 v56, s[16:19], s5 offen offset:256 lds
  v_cvt_pk_bf16_f32 v96, v176, v177
  v_mfma_f32_16x16x32_bf16 v[180:183], v[172:175], v[100:103], v[180:183]
  v_cvt_pk_bf16_f32 v122, v128, v129
  v_cvt_pk_bf16_f32 v123, v130, v131
  v_mfma_f32_16x16x32_bf16 v[124:127], v[168:171], v[100:103], 0
  v_exp_f32 v178, v178
  v_mfma_f32_16x16x32_bf16 v[124:127], v[80:83], v[104:107], v[124:127]
  v_exp_f32 v179, v179
  v_mfma_f32_16x16x32_bf16 v[64:67], v[120:123], v[104:107], 0
  v_exp_f32 v144, v144
  v_cvt_pk_bf16_f32 v97, v178, v179
  v_mfma_f32_16x16x32_bf16 v[64:67], v[70:73], v[100:103], v[64:67]
  v_exp_f32 v145, v145
  v_mov_b64 v[156:157], 0
  v_smfmac_f32_16x16x64_bf16 v[140:143], a[240:243], v[108:115], v10
  v_exp_f32 v146, v146
  v_cvt_pk_bf16_f32 v98, v144, v145
  v_mfma_f32_16x16x32_bf16 v[116:119], v[76:79], v[112:115], 0
  v_exp_f32 v147, v147
  v_add_f32 v164, v164, v165
  v_mfma_f32_16x16x32_bf16 v[116:119], v[172:175], v[108:111], v[116:119]
  v_cvt_pk_bf16_f32 v99, v146, v147
  v_exp_f32 v84, v84
  v_mfma_f32_16x16x32_bf16 v[136:139], v[168:171], v[108:111], 0
  v_exp_f32 v85, v85
  v_mfma_f32_16x16x32_bf16 v[136:139], v[80:83], v[112:115], v[136:139]
  v_exp_f32 v86, v86
  v_cvt_pk_bf16_f32 v84, v84, v85
  v_mfma_f32_16x16x32_bf16 v[100:103], v[120:123], v[112:115], 0
  v_exp_f32 v87, v87
  v_add_f32 v140, v140, v141
  v_mfma_f32_16x16x32_bf16 v[100:103], v[70:73], v[108:111], v[100:103]
  v_exp_f32 v88, v88
  v_cvt_pk_bf16_f32 v85, v86, v87
  v_smfmac_f32_16x16x64_bf16 v[156:159], a[240:243], v[92:99], v10
  v_exp_f32 v89, v89
  v_exp_f32 v90, v90
  v_exp_f32 v91, v91
  v_exp_f32 v148, v148
  v_exp_f32 v149, v149
  v_exp_f32 v150, v150
  v_exp_f32 v151, v151
  v_exp_f32 v160, v160
  v_exp_f32 v161, v161
  v_exp_f32 v162, v162
  v_exp_f32 v163, v163
  v_mfma_f32_16x16x32_bf16 v[144:147], v[172:175], v[96:99], 0
  s_add_u32 s5, s45, 49152
  v_cvt_pk_bf16_f32 v86, v88, v89
  v_cvt_pk_bf16_f32 v87, v90, v91
  v_cvt_pk_bf16_f32 v88, v148, v149
  v_cvt_pk_bf16_f32 v89, v150, v151
  v_cvt_pk_bf16_f32 v90, v160, v161
  v_cvt_pk_bf16_f32 v91, v162, v163
  v_mfma_f32_16x16x32_bf16 v[144:147], v[76:79], v[92:95], v[144:147]
  s_waitcnt vmcnt(6) lgkmcnt(0)
  s_barrier
  v_mfma_f32_16x16x32_bf16 v[148:151], v[80:83], v[92:95], 0
  s_add_u32 m0, s46, 102400
  ds_read_b128 v[132:135], v0 offset:0
  v_mov_b64 v[108:109], 0
  v_mfma_f32_16x16x32_bf16 v[148:151], v[168:171], v[96:99], v[148:151]
  buffer_load_dwordx4 v56, s[16:19], s5 offen offset:0 lds
  v_mfma_f32_16x16x32_bf16 v[160:163], v[70:73], v[96:99], 0
  s_add_u32 m0, s46, 110464
  ds_read_b128 v[60:63], v1 offset:0
  ds_read_b128 v[128:131], v0 offset:8192
  v_mfma_f32_16x16x32_bf16 v[160:163], v[120:123], v[92:95], v[160:163]
  ds_read_b128 v[152:155], v1 offset:8192
  ds_read_b128 v[176:179], v0 offset:16384
  v_smfmac_f32_16x16x64_bf16 v[108:111], a[240:243], v[84:91], v10
  buffer_load_dwordx4 v56, s[16:19], s5 offen offset:128 lds
  v_mfma_f32_16x16x32_bf16 v[92:95], v[172:175], v[88:91], 0
  s_add_u32 m0, s46, 118528
  ds_read_b128 a[244:247], v1 offset:16384
  ds_read2st64_b32 v[96:97], v69 offset0:0 offset1:2
  v_mfma_f32_16x16x32_bf16 v[92:95], v[76:79], v[84:87], v[92:95]
  ds_read2st64_b32 v[172:173], v68 offset0:0 offset1:2
  ds_read2st64_b32 v[98:99], v69 offset0:4 offset1:6
  v_mfma_f32_16x16x32_bf16 v[104:107], v[80:83], v[84:87], 0
  buffer_load_dwordx4 v56, s[16:19], s5 offen offset:256 lds
  v_mfma_f32_16x16x32_bf16 v[104:107], v[168:171], v[88:91], v[104:107]
  s_add_u32 s5, s45, 61440
  s_add_u32 m0, s46, 106496
  ds_read2st64_b32 v[174:175], v68 offset0:4 offset1:6
  v_mfma_f32_16x16x32_bf16 v[168:171], v[70:73], v[88:91], 0
  s_waitcnt lgkmcnt(3)
  ds_read2st64_b32 v[76:77], v54 offset0:0 offset1:2
  ds_read2st64_b32 v[80:81], v55 offset0:0 offset1:2
  v_mfma_f32_16x16x32_bf16 v[168:171], v[120:123], v[84:87], v[168:171]
  buffer_load_dwordx4 v56, s[16:19], s5 offen offset:0 lds
  v_mfma_f32_16x16x32_bf16 v[72:75], a[0:3], v[132:135], 0
  s_add_u32 m0, s46, 114560
  ds_read2st64_b32 v[78:79], v54 offset0:4 offset1:6
  ds_read2st64_b32 v[82:83], v55 offset0:4 offset1:6
  v_mfma_f32_16x16x32_bf16 v[72:75], a[12:15], v[60:63], v[72:75]
  v_rcp_f32 v166, v164
  v_mfma_f32_16x16x32_bf16 v[72:75], a[24:27], v[128:131], v[72:75]
  buffer_load_dwordx4 v56, s[16:19], s5 offen offset:128 lds
  v_mfma_f32_16x16x32_bf16 v[72:75], a[36:39], v[152:155], v[72:75]
  s_add_u32 m0, s46, 122624
  v_mul_f32 v180, v166, v180
  v_mul_f32 v181, v166, v181
  v_mfma_f32_16x16x32_bf16 v[72:75], a[48:51], v[176:179], v[72:75]
  s_waitcnt lgkmcnt(4)
  v_perm_b32 v184, v172, v96, s58
  v_perm_b32 v188, v172, v96, s59
  v_mfma_f32_16x16x32_bf16 v[72:75], a[60:63], a[244:247], v[72:75]
  buffer_load_dwordx4 v56, s[16:19], s5 offen offset:256 lds
  v_mfma_f32_16x16x32_bf16 v[84:87], a[64:67], a[244:247], 0
  s_waitcnt lgkmcnt(0)
  v_perm_b32 v185, v173, v97, s58
  v_perm_b32 v189, v173, v97, s59
  v_mfma_f32_16x16x32_bf16 v[84:87], a[52:55], v[176:179], v[84:87]
  s_add_u32 m0, s28, 4096
  v_perm_b32 v186, v174, v98, s58
  v_perm_b32 v190, v174, v98, s59
  v_mfma_f32_16x16x32_bf16 v[84:87], a[40:43], v[152:155], v[84:87]
  s_mov_b32 s5, s28
  v_mul_f32 v72, s42, v72
  v_mul_f32 v73, s42, v73
  v_mfma_f32_16x16x32_bf16 v[84:87], a[28:31], v[128:131], v[84:87]
  v_mul_f32 v74, s42, v74
  v_mul_f32 v75, s42, v75
  v_mfma_f32_16x16x32_bf16 v[84:87], a[16:19], v[60:63], v[84:87]
  buffer_load_dwordx4 v6, s[8:11], s32 offen offset:0 nt lds
  v_mfma_f32_16x16x32_bf16 v[84:87], a[4:7], v[132:135], v[84:87]
  s_add_u32 m0, s28, 12160
  v_cvt_pk_bf16_f32 v12, v72, v73
  v_cvt_pk_bf16_f32 v13, v74, v75
  v_mfma_f32_16x16x32_bf16 v[56:59], a[8:11], v[132:135], 0
  v_perm_b32 v187, v175, v99, s58
  v_perm_b32 v191, v175, v99, s59
  v_perm_b32 v192, v80, v76, s58
  v_mfma_f32_16x16x32_bf16 v[56:59], a[20:23], v[60:63], v[56:59]
  buffer_load_dwordx4 v6, s[8:11], s32 offen offset:128 nt lds
  v_perm_b32 v196, v80, v76, s59
  v_mfma_f32_16x16x32_bf16 v[56:59], a[32:35], v[128:131], v[56:59]
  s_add_u32 m0, s28, 20224
  v_mul_f32 v84, s42, v84
  v_mul_f32 v85, s42, v85
  v_mul_f32 v86, s42, v86
  v_mfma_f32_16x16x32_bf16 v[56:59], a[44:47], v[152:155], v[56:59]
  s_mov_b32 s28, s29
  v_mul_f32 v87, s42, v87
  v_cvt_pk_bf16_f32 v72, v84, v85
  v_cvt_pk_bf16_f32 v73, v86, v87
  v_mfma_f32_16x16x32_bf16 v[56:59], a[56:59], v[176:179], v[56:59]
  buffer_load_dwordx4 v6, s[8:11], s32 offen offset:256 nt lds
  v_perm_b32 v193, v81, v77, s58
  v_mfma_f32_16x16x32_bf16 v[56:59], a[68:71], a[244:247], v[56:59]
  s_add_u32 s32, s32, s43
  v_perm_b32 v197, v81, v77, s59
  v_perm_b32 v194, v82, v78, s58
  v_perm_b32 v198, v82, v78, s59
  v_mfma_f32_16x16x32_bf16 v[84:87], a[132:135], a[244:247], 0
  ds_read2st64_b32 v[96:97], v69 offset0:16 offset1:18
  v_perm_b32 v195, v83, v79, s58
  v_perm_b32 v199, v83, v79, s59
  v_mfma_f32_16x16x32_bf16 v[84:87], a[120:123], v[176:179], v[84:87]
  ds_read2st64_b32 v[172:173], v68 offset0:16 offset1:18
  ds_read2st64_b32 v[98:99], v69 offset0:20 offset1:22
  v_mul_f32 v182, v166, v182
  v_mfma_f32_16x16x32_bf16 v[84:87], a[108:111], v[152:155], v[84:87]
  v_mul_f32 v56, s42, v56
  v_mul_f32 v57, s42, v57
  v_mul_f32 v58, s42, v58
  v_mfma_f32_16x16x32_bf16 v[84:87], a[96:99], v[128:131], v[84:87]
  v_mul_f32 v59, s42, v59
  v_cvt_pk_bf16_f32 v74, v56, v57
  v_cvt_pk_bf16_f32 v75, v58, v59
  v_mfma_f32_16x16x32_bf16 v[84:87], a[84:87], v[60:63], v[84:87]
  ds_read2st64_b32 v[174:175], v68 offset0:20 offset1:22
  ds_read2st64_b32 v[76:77], v54 offset0:16 offset1:18
  v_mul_f32 v183, v166, v183
  v_mfma_f32_16x16x32_bf16 v[84:87], a[72:75], v[132:135], v[84:87]
  ds_read2st64_b32 v[80:81], v55 offset0:16 offset1:18
  ds_read2st64_b32 v[78:79], v54 offset0:20 offset1:22
  v_cvt_pk_bf16_f32 v180, v180, v181
  v_mfma_f32_16x16x32_bf16 v[56:59], a[76:79], v[132:135], 0
  ds_read2st64_b32 v[82:83], v55 offset0:20 offset1:22
  v_cvt_pk_bf16_f32 v181, v182, v183
  v_mul_f32 v124, v166, v124
  v_mfma_f32_16x16x32_bf16 v[56:59], a[88:91], v[60:63], v[56:59]
  v_mul_f32 v125, v166, v125
  v_mul_f32 v126, v166, v126
  v_mul_f32 v127, v166, v127
  v_mfma_f32_16x16x32_bf16 v[56:59], a[100:103], v[128:131], v[56:59]
  v_cvt_pk_bf16_f32 v120, v84, v85
  v_cvt_pk_bf16_f32 v121, v86, v87
  v_cvt_pk_bf16_f32 v124, v124, v125
  v_mfma_f32_16x16x32_bf16 v[56:59], a[112:115], v[152:155], v[56:59]
  s_waitcnt lgkmcnt(4)
  v_cvt_pk_bf16_f32 v125, v126, v127
  v_mul_f32 v64, v166, v64
  v_mul_f32 v65, v166, v65
  v_mfma_f32_16x16x32_bf16 v[56:59], a[124:127], v[176:179], v[56:59]
  v_mul_f32 v66, v166, v66
  v_mul_f32 v67, v166, v67
  v_cvt_pk_bf16_f32 v64, v64, v65
  v_mfma_f32_16x16x32_bf16 v[56:59], a[136:139], a[244:247], v[56:59]
  s_waitcnt lgkmcnt(0)
  v_cvt_pk_bf16_f32 v65, v66, v67
  v_max3_f32 v9, v164, v166, v9
  v_perm_b32 v200, v172, v96, s58
  v_mfma_f32_16x16x32_bf16 v[88:91], a[140:143], a[244:247], 0
  ds_write2st64_b32 v5, v180, v181 offset0:0 offset1:4
  v_mfma_f32_16x16x32_bf16 v[88:91], a[128:131], v[176:179], v[88:91]
  ds_write2st64_b32 v5, v124, v125 offset0:8 offset1:12
  v_mfma_f32_16x16x32_bf16 v[88:91], a[116:119], v[152:155], v[88:91]
  v_cvt_pk_bf16_f32 v122, v56, v57
  v_cvt_pk_bf16_f32 v123, v58, v59
  v_perm_b32 v204, v172, v96, s59
  v_mfma_f32_16x16x32_bf16 v[88:91], a[104:107], v[128:131], v[88:91]
  ds_write2st64_b32 v5, v64, v65 offset0:16 offset1:20
  v_mfma_f32_16x16x32_bf16 v[88:91], a[92:95], v[60:63], v[88:91]
  v_perm_b32 v201, v173, v97, s58
  v_perm_b32 v205, v173, v97, s59
  v_perm_b32 v202, v174, v98, s58
  v_mfma_f32_16x16x32_bf16 v[88:91], a[80:83], v[132:135], v[88:91]
  v_perm_b32 v206, v174, v98, s59
  v_perm_b32 v203, v175, v99, s58
  v_perm_b32 v207, v175, v99, s59
  v_mfma_f32_16x16x32_bf16 v[164:167], v[132:135], a[144:147], 0
  v_perm_b32 v208, v80, v76, s58
  v_perm_b32 v212, v80, v76, s59
  v_perm_b32 v209, v81, v77, s58
  v_mfma_f32_16x16x32_bf16 v[164:167], v[60:63], a[156:159], v[164:167]
  v_perm_b32 v213, v81, v77, s59
  v_perm_b32 v210, v82, v78, s58
  v_perm_b32 v214, v82, v78, s59
  v_mfma_f32_16x16x32_bf16 v[164:167], v[128:131], a[168:171], v[164:167]
  ds_read_b128 v[84:87], v0 offset:2048
  v_cvt_pk_bf16_f32 v124, v88, v89
  v_cvt_pk_bf16_f32 v125, v90, v91
  v_mfma_f32_16x16x32_bf16 v[164:167], v[152:155], a[180:183], v[164:167]
  ds_read_b128 v[112:115], v1 offset:2048
  ds_read_b128 v[180:183], v0 offset:10240
  v_perm_b32 v211, v83, v79, s58
  v_mfma_f32_16x16x32_bf16 v[164:167], v[176:179], a[192:195], v[164:167]
  s_add_u32 m0, s29, 0
  ds_read_b128 a[252:255], v1 offset:10240
  ds_read_b128 a[248:251], v0 offset:18432
  v_perm_b32 v215, v83, v79, s59
  v_mfma_f32_16x16x32_bf16 v[164:167], a[244:247], a[204:207], v[164:167]
  ds_read_b128 v[88:91], v1 offset:18432
  v_add_u32 v69, 4294840320, v69
  v_add_u32 v68, 4294840320, v68
  v_mfma_f32_16x16x32_bf16 v[64:67], a[244:247], a[208:211], 0
  s_waitcnt vmcnt(3)
  s_barrier
  v_mfma_f32_16x16x32_bf16 v[64:67], v[176:179], a[196:199], v[64:67]
  buffer_load_dwordx4 v6, s[8:11], s31 offen offset:0 nt lds
  v_add_u32 v54, 4294840320, v54
  v_mfma_f32_16x16x32_bf16 v[64:67], v[152:155], a[184:187], v[64:67]
  s_add_u32 m0, s29, 8064
  v_cvt_pk_bf16_f32 v56, v164, v165
  v_cvt_pk_bf16_f32 v57, v166, v167
  v_add_u32 v55, 4294840320, v55
  v_mfma_f32_16x16x32_bf16 v[64:67], v[128:131], a[172:175], v[64:67]
  ds_read2st64_b32 v[96:97], v69 offset0:0 offset1:2
  ds_read2st64_b32 v[172:173], v68 offset0:0 offset1:2
  v_add_f32 v156, v156, v157
  v_mfma_f32_16x16x32_bf16 v[64:67], v[60:63], a[160:163], v[64:67]
  ds_read2st64_b32 v[98:99], v69 offset0:4 offset1:6
  ds_read2st64_b32 v[174:175], v68 offset0:4 offset1:6
  v_add_f32 v108, v108, v109
  v_mfma_f32_16x16x32_bf16 v[64:67], v[132:135], a[148:151], v[64:67]
  buffer_load_dwordx4 v6, s[8:11], s31 offen offset:128 nt lds
  v_mfma_f32_16x16x32_bf16 v[164:167], v[132:135], a[152:155], 0
  s_add_u32 m0, s29, 16128
  ds_read2st64_b32 v[76:77], v54 offset0:0 offset1:2
  ds_read2st64_b32 v[80:81], v55 offset0:0 offset1:2
  v_mfma_f32_16x16x32_bf16 v[164:167], v[60:63], a[164:167], v[164:167]
  ds_read2st64_b32 v[78:79], v54 offset0:4 offset1:6
  ds_read2st64_b32 v[82:83], v55 offset0:4 offset1:6
  v_mfma_f32_16x16x32_bf16 v[164:167], v[128:131], a[176:179], v[164:167]
  v_cvt_pk_bf16_f32 v60, v64, v65
  v_cvt_pk_bf16_f32 v61, v66, v67
  v_mfma_f32_16x16x32_bf16 v[164:167], v[152:155], a[188:191], v[164:167]
  buffer_load_dwordx4 v6, s[8:11], s31 offen offset:256 nt lds
  v_mfma_f32_16x16x32_bf16 v[164:167], v[176:179], a[200:203], v[164:167]
  s_add_u32 m0, s29, 4096
  v_rcp_f32 v142, v140
  v_mfma_f32_16x16x32_bf16 v[164:167], a[244:247], a[212:215], v[164:167]
  s_waitcnt lgkmcnt(4)
  v_perm_b32 v216, v172, v96, s58
  v_perm_b32 v220, v172, v96, s59
  v_perm_b32 v217, v173, v97, s58
  v_mfma_f32_16x16x32_bf16 v[132:135], a[0:3], v[84:87], 0
  s_waitcnt lgkmcnt(0)
  v_perm_b32 v221, v173, v97, s59
  v_perm_b32 v218, v174, v98, s58
  v_perm_b32 v222, v174, v98, s59
  v_mfma_f32_16x16x32_bf16 v[132:135], a[12:15], v[112:115], v[132:135]
  buffer_load_dwordx4 v6, s[8:11], s32 offen offset:0 nt lds
  v_perm_b32 v219, v175, v99, s58
  v_mfma_f32_16x16x32_bf16 v[132:135], a[24:27], v[180:183], v[132:135]
  s_add_u32 m0, s29, 12160
  v_cvt_pk_bf16_f32 v64, v164, v165
  v_cvt_pk_bf16_f32 v65, v166, v167
  v_perm_b32 v223, v175, v99, s59
  v_mfma_f32_16x16x32_bf16 v[132:135], a[36:39], a[252:255], v[132:135]
  s_add_u32 s31, s31, s43
  v_perm_b32 v224, v80, v76, s58
  v_perm_b32 v228, v80, v76, s59
  v_perm_b32 v225, v81, v77, s58
  v_mfma_f32_16x16x32_bf16 v[132:135], a[48:51], a[248:251], v[132:135]
  v_perm_b32 v229, v81, v77, s59
  v_perm_b32 v226, v82, v78, s58
  v_perm_b32 v230, v82, v78, s59
  v_mfma_f32_16x16x32_bf16 v[132:135], a[60:63], v[88:91], v[132:135]
  buffer_load_dwordx4 v6, s[8:11], s32 offen offset:128 nt lds
  v_perm_b32 v227, v83, v79, s58
  v_mfma_f32_16x16x32_bf16 v[176:179], a[64:67], v[88:91], 0
  s_add_u32 m0, s29, 20224
  ds_read2st64_b32 v[96:97], v69 offset0:16 offset1:18
  ds_read2st64_b32 v[172:173], v68 offset0:16 offset1:18
  v_perm_b32 v231, v83, v79, s59
  v_mfma_f32_16x16x32_bf16 v[176:179], a[52:55], a[248:251], v[176:179]
  s_mov_b32 s29, s30
  ds_read2st64_b32 v[98:99], v69 offset0:20 offset1:22
  ds_read2st64_b32 v[174:175], v68 offset0:20 offset1:22
  v_mul_f32 v116, v142, v116
  v_mfma_f32_16x16x32_bf16 v[176:179], a[40:43], a[252:255], v[176:179]
  v_mul_f32 v132, s42, v132
  v_mul_f32 v133, s42, v133
  v_mul_f32 v134, s42, v134
  v_mfma_f32_16x16x32_bf16 v[176:179], a[28:31], v[180:183], v[176:179]
  buffer_load_dwordx4 v6, s[8:11], s32 offen offset:256 nt lds
  v_mul_f32 v135, s42, v135
  v_mfma_f32_16x16x32_bf16 v[176:179], a[16:19], v[112:115], v[176:179]
  s_add_u32 s32, s32, s43
  ds_read2st64_b32 v[76:77], v54 offset0:16 offset1:18
  v_cvt_pk_bf16_f32 v128, v132, v133
  v_cvt_pk_bf16_f32 v129, v134, v135
  v_mfma_f32_16x16x32_bf16 v[176:179], a[4:7], v[84:87], v[176:179]
  ds_read2st64_b32 v[80:81], v55 offset0:16 offset1:18
  ds_read2st64_b32 v[78:79], v54 offset0:20 offset1:22
  v_mul_f32 v117, v142, v117
  v_mfma_f32_16x16x32_bf16 v[164:167], a[8:11], v[84:87], 0
  s_waitcnt lgkmcnt(3)
  ds_read2st64_b32 v[82:83], v55 offset0:20 offset1:22
  v_mul_f32 v118, v142, v118
  v_mul_f32 v119, v142, v119
  v_mfma_f32_16x16x32_bf16 v[164:167], a[20:23], v[112:115], v[164:167]
  v_cvt_pk_bf16_f32 v116, v116, v117
  v_cvt_pk_bf16_f32 v117, v118, v119
  v_mul_f32 v136, v142, v136
  v_mfma_f32_16x16x32_bf16 v[164:167], a[32:35], v[180:183], v[164:167]
  v_mul_f32 v176, s42, v176
  v_mul_f32 v177, s42, v177
  v_mul_f32 v178, s42, v178
  v_mfma_f32_16x16x32_bf16 v[164:167], a[44:47], a[252:255], v[164:167]
  v_mul_f32 v179, s42, v179
  v_cvt_pk_bf16_f32 v130, v176, v177
  v_cvt_pk_bf16_f32 v131, v178, v179
  v_mfma_f32_16x16x32_bf16 v[164:167], a[56:59], a[248:251], v[164:167]
  v_mul_f32 v137, v142, v137
  v_mul_f32 v138, v142, v138
  v_mul_f32 v139, v142, v139
  v_mfma_f32_16x16x32_bf16 v[164:167], a[68:71], v[88:91], v[164:167]
  s_waitcnt lgkmcnt(0)
  v_cvt_pk_bf16_f32 v136, v136, v137
  v_cvt_pk_bf16_f32 v137, v138, v139
  v_mul_f32 v100, v142, v100
  v_mfma_f32_16x16x32_bf16 v[176:179], a[132:135], v[88:91], 0
  v_mul_f32 v101, v142, v101
  v_mul_f32 v102, v142, v102
  v_mul_f32 v103, v142, v103
  v_mfma_f32_16x16x32_bf16 v[176:179], a[120:123], a[248:251], v[176:179]
  v_cvt_pk_bf16_f32 v100, v100, v101
  v_cvt_pk_bf16_f32 v101, v102, v103
  v_max3_f32 v9, v140, v142, v9
  v_mfma_f32_16x16x32_bf16 v[176:179], a[108:111], a[252:255], v[176:179]
  v_mul_f32 v164, s42, v164
  v_mul_f32 v165, s42, v165
  v_mul_f32 v166, s42, v166
  v_mfma_f32_16x16x32_bf16 v[176:179], a[96:99], v[180:183], v[176:179]
  v_mul_f32 v167, s42, v167
  v_cvt_pk_bf16_f32 v16, v164, v165
  v_cvt_pk_bf16_f32 v17, v166, v167
  v_mfma_f32_16x16x32_bf16 v[176:179], a[84:87], v[112:115], v[176:179]
  ds_write2st64_b32 v5, v116, v117 offset0:1 offset1:5
  v_mfma_f32_16x16x32_bf16 v[176:179], a[72:75], v[84:87], v[176:179]
  ds_write2st64_b32 v5, v136, v137 offset0:9 offset1:13
  v_mfma_f32_16x16x32_bf16 v[132:135], a[76:79], v[84:87], 0
  ds_write2st64_b32 v5, v100, v101 offset0:17 offset1:21
  v_mfma_f32_16x16x32_bf16 v[132:135], a[88:91], v[112:115], v[132:135]
  v_rcp_f32 v158, v156
  v_perm_b32 v232, v172, v96, s58
  v_mfma_f32_16x16x32_bf16 v[132:135], a[100:103], v[180:183], v[132:135]
  v_cvt_pk_bf16_f32 v136, v176, v177
  v_cvt_pk_bf16_f32 v137, v178, v179
  v_mul_f32 v144, v158, v144
  v_mfma_f32_16x16x32_bf16 v[132:135], a[112:115], a[252:255], v[132:135]
  v_mul_f32 v145, v158, v145
  v_mul_f32 v146, v158, v146
  v_mul_f32 v147, v158, v147
  v_mfma_f32_16x16x32_bf16 v[132:135], a[124:127], a[248:251], v[132:135]
  v_cvt_pk_bf16_f32 v144, v144, v145
  v_cvt_pk_bf16_f32 v145, v146, v147
  v_mul_f32 v148, v158, v148
  v_mfma_f32_16x16x32_bf16 v[132:135], a[136:139], v[88:91], v[132:135]
  v_mul_f32 v149, v158, v149
  v_mul_f32 v150, v158, v150
  v_mul_f32 v151, v158, v151
  v_mfma_f32_16x16x32_bf16 v[152:155], a[140:143], v[88:91], 0
  v_cvt_pk_bf16_f32 v148, v148, v149
  v_cvt_pk_bf16_f32 v149, v150, v151
  v_mul_f32 v160, v158, v160
  v_mfma_f32_16x16x32_bf16 v[152:155], a[128:131], a[248:251], v[152:155]
  v_mul_f32 v161, v158, v161
  v_mul_f32 v162, v158, v162
  v_mul_f32 v163, v158, v163
  v_mfma_f32_16x16x32_bf16 v[152:155], a[116:119], a[252:255], v[152:155]
  v_cvt_pk_bf16_f32 v138, v132, v133
  v_cvt_pk_bf16_f32 v139, v134, v135
  v_cvt_pk_bf16_f32 v160, v160, v161
  v_mfma_f32_16x16x32_bf16 v[152:155], a[104:107], v[180:183], v[152:155]
  v_cvt_pk_bf16_f32 v161, v162, v163
  v_max3_f32 v9, v156, v158, v9
  v_perm_b32 v236, v172, v96, s59
  v_mfma_f32_16x16x32_bf16 v[152:155], a[92:95], v[112:115], v[152:155]
  ds_write2st64_b32 v5, v144, v145 offset0:2 offset1:6
  v_mfma_f32_16x16x32_bf16 v[152:155], a[80:83], v[84:87], v[152:155]
  ds_write2st64_b32 v5, v148, v149 offset0:10 offset1:14
  v_mfma_f32_16x16x32_bf16 v[164:167], v[84:87], a[144:147], 0
  ds_write2st64_b32 v5, v160, v161 offset0:18 offset1:22
  v_mfma_f32_16x16x32_bf16 v[164:167], v[112:115], a[156:159], v[164:167]
  v_rcp_f32 v110, v108
  v_perm_b32 v233, v173, v97, s58
  v_mfma_f32_16x16x32_bf16 v[164:167], v[180:183], a[168:171], v[164:167]
  v_cvt_pk_bf16_f32 v140, v152, v153
  v_cvt_pk_bf16_f32 v141, v154, v155
  v_mfma_f32_16x16x32_bf16 v[164:167], a[252:255], a[180:183], v[164:167]
  v_mul_f32 v92, v110, v92
  v_mul_f32 v93, v110, v93
  v_mfma_f32_16x16x32_bf16 v[164:167], a[248:251], a[192:195], v[164:167]
  s_waitcnt vmcnt(6) lgkmcnt(0)
  s_barrier
  v_mfma_f32_16x16x32_bf16 v[164:167], v[88:91], a[204:207], v[164:167]
  ds_read_b128 v[156:159], v0 offset:4096
  ds_read_b128 v[176:179], v1 offset:4096
  v_mfma_f32_16x16x32_bf16 v[144:147], v[88:91], a[208:211], 0
  ds_read_b128 v[160:163], v0 offset:12288
  ds_read_b128 v[116:119], v1 offset:12288
  v_mfma_f32_16x16x32_bf16 v[144:147], a[248:251], a[196:199], v[144:147]
  ds_read_b128 v[152:155], v0 offset:20480
  ds_read_b128 v[132:135], v1 offset:20480
  v_mfma_f32_16x16x32_bf16 v[144:147], a[252:255], a[184:187], v[144:147]
  v_cvt_pk_bf16_f32 v58, v164, v165
  v_cvt_pk_bf16_f32 v59, v166, v167
  v_mfma_f32_16x16x32_bf16 v[144:147], v[180:183], a[172:175], v[144:147]
  v_mul_f32 v94, v110, v94
  v_mul_f32 v95, v110, v95
  v_mfma_f32_16x16x32_bf16 v[144:147], v[112:115], a[160:163], v[144:147]
  v_cvt_pk_bf16_f32 v92, v92, v93
  v_cvt_pk_bf16_f32 v93, v94, v95
  v_mfma_f32_16x16x32_bf16 v[144:147], v[84:87], a[148:151], v[144:147]
  v_mul_f32 v104, v110, v104
  v_mul_f32 v105, v110, v105
  v_mfma_f32_16x16x32_bf16 v[148:151], v[84:87], a[152:155], 0
  v_mul_f32 v106, v110, v106
  v_mul_f32 v107, v110, v107
  v_mfma_f32_16x16x32_bf16 v[148:151], v[112:115], a[164:167], v[148:151]
  v_cvt_pk_bf16_f32 v104, v104, v105
  v_cvt_pk_bf16_f32 v105, v106, v107
  v_mfma_f32_16x16x32_bf16 v[148:151], v[180:183], a[176:179], v[148:151]
  v_cvt_pk_bf16_f32 v62, v144, v145
  v_cvt_pk_bf16_f32 v63, v146, v147
  v_mfma_f32_16x16x32_bf16 v[148:151], a[252:255], a[188:191], v[148:151]
  v_mul_f32 v168, v110, v168
  v_mul_f32 v169, v110, v169
  v_mfma_f32_16x16x32_bf16 v[148:151], a[248:251], a[200:203], v[148:151]
  v_mul_f32 v170, v110, v170
  v_mul_f32 v171, v110, v171
  v_mfma_f32_16x16x32_bf16 v[148:151], v[88:91], a[212:215], v[148:151]
  s_waitcnt lgkmcnt(0)
  v_cvt_pk_bf16_f32 v168, v168, v169
  v_cvt_pk_bf16_f32 v169, v170, v171
  v_mfma_f32_16x16x32_bf16 v[88:91], a[0:3], v[156:159], 0
  v_max3_f32 v9, v108, v110, v9
  v_perm_b32 v237, v173, v97, s59
  v_mfma_f32_16x16x32_bf16 v[88:91], a[12:15], v[176:179], v[88:91]
  ds_write2st64_b32 v5, v92, v93 offset0:3 offset1:7
  v_mfma_f32_16x16x32_bf16 v[88:91], a[24:27], v[160:163], v[88:91]
  v_cvt_pk_bf16_f32 v66, v148, v149
  v_cvt_pk_bf16_f32 v67, v150, v151
  v_mfma_f32_16x16x32_bf16 v[88:91], a[36:39], v[116:119], v[88:91]
  ds_write2st64_b32 v5, v104, v105 offset0:11 offset1:15
  v_mfma_f32_16x16x32_bf16 v[88:91], a[48:51], v[152:155], v[88:91]
  ds_write2st64_b32 v5, v168, v169 offset0:19 offset1:23
  v_mfma_f32_16x16x32_bf16 v[88:91], a[60:63], v[132:135], v[88:91]
  v_perm_b32 v234, v174, v98, s58
  v_perm_b32 v238, v174, v98, s59
  v_mfma_f32_16x16x32_bf16 v[84:87], a[64:67], v[132:135], 0
  v_perm_b32 v235, v175, v99, s58
  v_perm_b32 v239, v175, v99, s59
  v_mfma_f32_16x16x32_bf16 v[84:87], a[52:55], v[152:155], v[84:87]
  v_perm_b32 v240, v80, v76, s58
  v_perm_b32 v244, v80, v76, s59
  v_mfma_f32_16x16x32_bf16 v[84:87], a[40:43], v[116:119], v[84:87]
  v_mul_f32 v88, s42, v88
  v_mul_f32 v89, s42, v89
  v_mfma_f32_16x16x32_bf16 v[84:87], a[28:31], v[160:163], v[84:87]
  v_mul_f32 v90, s42, v90
  v_mul_f32 v91, s42, v91
  v_mfma_f32_16x16x32_bf16 v[84:87], a[16:19], v[176:179], v[84:87]
L_hop_2_0:
  s_cbranch_execz L_hop_2_1
  v_cvt_pk_bf16_f32 v18, v88, v89
  v_cvt_pk_bf16_f32 v19, v90, v91
  v_mfma_f32_16x16x32_bf16 v[84:87], a[4:7], v[156:159], v[84:87]
  v_perm_b32 v241, v81, v77, s58
  v_perm_b32 v245, v81, v77, s59
  v_mfma_f32_16x16x32_bf16 v[88:91], a[8:11], v[156:159], 0
  v_perm_b32 v242, v82, v78, s58
  v_perm_b32 v246, v82, v78, s59
  v_mfma_f32_16x16x32_bf16 v[88:91], a[20:23], v[176:179], v[88:91]
  v_perm_b32 v243, v83, v79, s58
  v_perm_b32 v247, v83, v79, s59
  v_mfma_f32_16x16x32_bf16 v[88:91], a[32:35], v[160:163], v[88:91]
  v_mul_f32 v84, s42, v84
  v_mul_f32 v85, s42, v85
  v_mfma_f32_16x16x32_bf16 v[88:91], a[44:47], v[116:119], v[88:91]
  v_mul_f32 v86, s42, v86
  v_mul_f32 v87, s42, v87
  v_mfma_f32_16x16x32_bf16 v[88:91], a[56:59], v[152:155], v[88:91]
  v_cvt_pk_bf16_f32 v100, v84, v85
  v_cvt_pk_bf16_f32 v101, v86, v87
  v_mfma_f32_16x16x32_bf16 v[88:91], a[68:71], v[132:135], v[88:91]
  v_add_u32 v69, 102400, v69
  v_add_u32 v68, 102400, v68
  v_mfma_f32_16x16x32_bf16 v[104:107], a[132:135], v[132:135], 0
  v_add_u32 v54, 102400, v54
  v_add_u32 v55, 102400, v55
  v_mfma_f32_16x16x32_bf16 v[104:107], a[120:123], v[152:155], v[104:107]
  ds_read2st64_b32 v[96:97], v69 offset0:0 offset1:2
  ds_read2st64_b32 v[172:173], v68 offset0:0 offset1:2
  v_mfma_f32_16x16x32_bf16 v[104:107], a[108:111], v[116:119], v[104:107]
  v_mul_f32 v88, s42, v88
  v_mul_f32 v89, s42, v89
  v_mfma_f32_16x16x32_bf16 v[104:107], a[96:99], v[160:163], v[104:107]
  v_mul_f32 v90, s42, v90
  v_mul_f32 v91, s42, v91
  v_mfma_f32_16x16x32_bf16 v[104:107], a[84:87], v[176:179], v[104:107]
  v_cvt_pk_bf16_f32 v102, v88, v89
  v_cvt_pk_bf16_f32 v103, v90, v91
  v_mfma_f32_16x16x32_bf16 v[104:107], a[72:75], v[156:159], v[104:107]
  ds_read2st64_b32 v[98:99], v69 offset0:4 offset1:6
  ds_read2st64_b32 v[174:175], v68 offset0:4 offset1:6
  v_mfma_f32_16x16x32_bf16 v[84:87], a[76:79], v[156:159], 0
  ds_read2st64_b32 v[76:77], v54 offset0:0 offset1:2
  ds_read2st64_b32 v[80:81], v55 offset0:0 offset1:2
  v_mfma_f32_16x16x32_bf16 v[84:87], a[88:91], v[176:179], v[84:87]
  ds_read2st64_b32 v[78:79], v54 offset0:4 offset1:6
  ds_read2st64_b32 v[82:83], v55 offset0:4 offset1:6
  v_mfma_f32_16x16x32_bf16 v[84:87], a[100:103], v[160:163], v[84:87]
  v_cvt_pk_bf16_f32 v144, v104, v105
  v_cvt_pk_bf16_f32 v145, v106, v107
  v_mfma_f32_16x16x32_bf16 v[84:87], a[112:115], v[116:119], v[84:87]
  v_xor_b32 v5, s41, v5
  v_mfma_f32_16x16x32_bf16 v[84:87], a[124:127], v[152:155], v[84:87]
  s_waitcnt lgkmcnt(4)
  v_perm_b32 v248, v172, v96, s58
  v_perm_b32 v252, v172, v96, s59
  v_mfma_f32_16x16x32_bf16 v[84:87], a[136:139], v[132:135], v[84:87]
  v_perm_b32 v249, v173, v97, s58
  v_perm_b32 v253, v173, v97, s59
  v_mfma_f32_16x16x32_bf16 v[88:91], a[140:143], v[132:135], 0
  s_waitcnt lgkmcnt(0)
  v_perm_b32 v250, v174, v98, s58
  v_perm_b32 v254, v174, v98, s59
  v_mfma_f32_16x16x32_bf16 v[88:91], a[128:131], v[152:155], v[88:91]
  v_perm_b32 v251, v175, v99, s58
  v_perm_b32 v255, v175, v99, s59
  v_mfma_f32_16x16x32_bf16 v[88:91], a[116:119], v[116:119], v[88:91]
  v_cvt_pk_bf16_f32 v146, v84, v85
  v_cvt_pk_bf16_f32 v147, v86, v87
  v_mfma_f32_16x16x32_bf16 v[88:91], a[104:107], v[160:163], v[88:91]
  s_add_u32 m0, s30, 0
  v_perm_b32 v104, v80, v76, s58
  v_perm_b32 v76, v80, v76, s59
  v_mfma_f32_16x16x32_bf16 v[88:91], a[92:95], v[176:179], v[88:91]
  v_accvgpr_write_b32 a220, v76
  v_perm_b32 v105, v81, v77, s58
  v_mfma_f32_16x16x32_bf16 v[88:91], a[80:83], v[156:159], v[88:91]
  v_perm_b32 v77, v81, v77, s59
  v_accvgpr_write_b32 a221, v77
  v_mfma_f32_16x16x32_bf16 v[84:87], v[156:159], a[144:147], 0
  buffer_load_dwordx4 v6, s[8:11], s31 offen offset:0 nt lds
  v_mfma_f32_16x16x32_bf16 v[84:87], v[176:179], a[156:159], v[84:87]
  s_add_u32 m0, s30, 8064
  v_perm_b32 v106, v82, v78, s58
  v_perm_b32 v78, v82, v78, s59
  v_mfma_f32_16x16x32_bf16 v[84:87], v[160:163], a[168:171], v[84:87]
  v_cvt_pk_bf16_f32 v148, v88, v89
  v_cvt_pk_bf16_f32 v149, v90, v91
  v_mfma_f32_16x16x32_bf16 v[84:87], v[116:119], a[180:183], v[84:87]
  ds_read_b128 a[244:247], v1 offset:22528
  ds_read_b128 a[252:255], v0 offset:22528
  v_mfma_f32_16x16x32_bf16 v[84:87], v[152:155], a[192:195], v[84:87]
  buffer_load_dwordx4 v6, s[8:11], s31 offen offset:128 nt lds
  v_mfma_f32_16x16x32_bf16 v[84:87], v[132:135], a[204:207], v[84:87]
  s_add_u32 m0, s30, 16128
  ds_read_b128 v[180:183], v1 offset:14336
  ds_read_b128 v[164:167], v0 offset:14336
  v_mfma_f32_16x16x32_bf16 v[88:91], v[132:135], a[208:211], 0
  ds_read_b128 v[168:171], v1 offset:6144
  ds_read_b128 a[248:251], v0 offset:6144
  v_mfma_f32_16x16x32_bf16 v[88:91], v[152:155], a[196:199], v[88:91]
  v_accvgpr_write_b32 a222, v78
  v_perm_b32 v107, v83, v79, s58
  v_mfma_f32_16x16x32_bf16 v[88:91], v[116:119], a[184:187], v[88:91]
  buffer_load_dwordx4 v6, s[8:11], s31 offen offset:256 nt lds
  v_mfma_f32_16x16x32_bf16 v[88:91], v[160:163], a[172:175], v[88:91]
  s_add_u32 m0, s30, 4096
  v_cvt_pk_bf16_f32 v108, v84, v85
  v_cvt_pk_bf16_f32 v109, v86, v87
  v_mfma_f32_16x16x32_bf16 v[88:91], v[176:179], a[160:163], v[88:91]
  s_add_u32 s31, s31, s43
  v_perm_b32 v79, v83, v79, s59
  v_accvgpr_write_b32 a223, v79
  v_mfma_f32_16x16x32_bf16 v[88:91], v[156:159], a[148:151], v[88:91]
  ds_read2st64_b32 v[96:97], v69 offset0:16 offset1:18
  ds_read2st64_b32 v[172:173], v68 offset0:16 offset1:18
  v_mfma_f32_16x16x32_bf16 v[84:87], v[156:159], a[152:155], 0
  buffer_load_dwordx4 v6, s[8:11], s32 offen offset:0 nt lds
  v_mfma_f32_16x16x32_bf16 v[84:87], v[176:179], a[164:167], v[84:87]
  s_add_u32 m0, s30, 12160
  ds_read2st64_b32 v[98:99], v69 offset0:20 offset1:22
  ds_read2st64_b32 v[174:175], v68 offset0:20 offset1:22
  v_mfma_f32_16x16x32_bf16 v[84:87], v[160:163], a[176:179], v[84:87]
  v_cvt_pk_bf16_f32 v112, v88, v89
  v_cvt_pk_bf16_f32 v113, v90, v91
  v_mfma_f32_16x16x32_bf16 v[84:87], v[116:119], a[188:191], v[84:87]
  s_waitcnt lgkmcnt(2)
  ds_read2st64_b32 v[76:77], v54 offset0:16 offset1:18
  ds_read2st64_b32 v[80:81], v55 offset0:16 offset1:18
  v_mfma_f32_16x16x32_bf16 v[84:87], v[152:155], a[200:203], v[84:87]
  buffer_load_dwordx4 v6, s[8:11], s32 offen offset:128 nt lds
  v_mfma_f32_16x16x32_bf16 v[84:87], v[132:135], a[212:215], v[84:87]
  s_add_u32 m0, s30, 20224
  ds_read2st64_b32 v[78:79], v54 offset0:20 offset1:22
  ds_read2st64_b32 v[82:83], v55 offset0:20 offset1:22
  v_mfma_f32_16x16x32_bf16 v[68:71], a[132:135], a[244:247], 0
  s_waitcnt lgkmcnt(4)
  v_accvgpr_write_b32 a216, v104
  v_accvgpr_write_b32 a217, v105
  v_mfma_f32_16x16x32_bf16 v[68:71], a[120:123], a[252:255], v[68:71]
  s_mov_b32 s30, s5
  v_accvgpr_write_b32 a218, v106
  v_accvgpr_write_b32 a219, v107
  v_mfma_f32_16x16x32_bf16 v[68:71], a[108:111], v[180:183], v[68:71]
  buffer_load_dwordx4 v6, s[8:11], s32 offen offset:256 nt lds
  v_mfma_f32_16x16x32_bf16 v[68:71], a[96:99], v[164:167], v[68:71]
  s_add_u32 s32, s32, s43
  v_cvt_pk_bf16_f32 v116, v84, v85
  v_cvt_pk_bf16_f32 v117, v86, v87
  v_mfma_f32_16x16x32_bf16 v[68:71], a[84:87], v[168:171], v[68:71]
  s_waitcnt lgkmcnt(0)
  v_perm_b32 v54, v172, v96, s58
  v_perm_b32 v96, v172, v96, s59
  v_mfma_f32_16x16x32_bf16 v[68:71], a[72:75], a[248:251], v[68:71]
  v_accvgpr_write_b32 a224, v54
  v_accvgpr_write_b32 a228, v96
  v_mfma_f32_16x16x32_bf16 v[84:87], a[76:79], a[248:251], 0
  v_perm_b32 v55, v173, v97, s58
  v_perm_b32 v97, v173, v97, s59
  v_mfma_f32_16x16x32_bf16 v[84:87], a[88:91], v[168:171], v[84:87]
  v_accvgpr_write_b32 a225, v55
  v_accvgpr_write_b32 a229, v97
  v_mfma_f32_16x16x32_bf16 v[84:87], a[100:103], v[164:167], v[84:87]
  v_cvt_pk_bf16_f32 v150, v68, v69
  v_cvt_pk_bf16_f32 v151, v70, v71
  v_mfma_f32_16x16x32_bf16 v[84:87], a[112:115], v[180:183], v[84:87]
  v_perm_b32 v54, v174, v98, s58
  v_perm_b32 v98, v174, v98, s59
  v_mfma_f32_16x16x32_bf16 v[84:87], a[124:127], a[252:255], v[84:87]
  v_accvgpr_write_b32 a226, v54
  v_accvgpr_write_b32 a230, v98
  v_mfma_f32_16x16x32_bf16 v[84:87], a[136:139], a[244:247], v[84:87]
  v_perm_b32 v55, v175, v99, s58
  v_perm_b32 v99, v175, v99, s59
  v_mfma_f32_16x16x32_bf16 v[68:71], a[140:143], a[244:247], 0
  v_accvgpr_write_b32 a227, v55
  v_accvgpr_write_b32 a231, v99
  v_mfma_f32_16x16x32_bf16 v[68:71], a[128:131], a[252:255], v[68:71]
  v_perm_b32 v54, v80, v76, s58
  v_perm_b32 v76, v80, v76, s59
  v_mfma_f32_16x16x32_bf16 v[68:71], a[116:119], v[180:183], v[68:71]
  v_cvt_pk_bf16_f32 v152, v84, v85
  v_cvt_pk_bf16_f32 v153, v86, v87
  v_mfma_f32_16x16x32_bf16 v[68:71], a[104:107], v[164:167], v[68:71]
  v_accvgpr_write_b32 a232, v54
  v_accvgpr_write_b32 a236, v76
  v_mfma_f32_16x16x32_bf16 v[68:71], a[92:95], v[168:171], v[68:71]
  v_perm_b32 v55, v81, v77, s58
  v_perm_b32 v77, v81, v77, s59
  v_mfma_f32_16x16x32_bf16 v[68:71], a[80:83], a[248:251], v[68:71]
  v_accvgpr_write_b32 a233, v55
  v_accvgpr_write_b32 a237, v77
  v_mfma_f32_16x16x32_bf16 v[92:95], v[122:125], v[72:75], v[36:39]
  v_perm_b32 v54, v82, v78, s58
  v_perm_b32 v78, v82, v78, s59
  v_mfma_f32_16x16x32_bf16 v[92:95], v[120:123], v[12:15], v[92:95]
  v_accvgpr_write_b32 a234, v54
  v_accvgpr_write_b32 a238, v78
  v_mfma_f32_16x16x32_bf16 v[96:99], v[138:141], v[72:75], v[32:35]
  v_perm_b32 v55, v83, v79, s58
  v_perm_b32 v79, v83, v79, s59
  v_mfma_f32_16x16x32_bf16 v[96:99], v[136:139], v[12:15], v[96:99]
  v_accvgpr_write_b32 a235, v55
  v_accvgpr_write_b32 a239, v79
  v_mfma_f32_16x16x32_bf16 v[104:107], v[146:149], v[72:75], v[28:31]
  v_cvt_pk_bf16_f32 v154, v68, v69
  v_cvt_pk_bf16_f32 v155, v70, v71
  v_mfma_f32_16x16x32_bf16 v[104:107], v[144:147], v[12:15], v[104:107]
  v_exp_f32 v92, v92
  v_mfma_f32_16x16x32_bf16 v[132:135], v[152:155], v[72:75], v[24:27]
  s_lshr_b32 s44, s2, 3
  v_exp_f32 v93, v93
  v_mfma_f32_16x16x32_bf16 v[132:135], v[150:153], v[12:15], v[132:135]
  s_lshl_b32 s44, s44, 9
  v_exp_f32 v94, v94
  v_mfma_f32_16x16x32_bf16 v[84:87], v[120:123], v[128:131], v[40:43]
  s_add_u32 s44, s44, 1048576
  v_exp_f32 v95, v95
  v_mfma_f32_16x16x32_bf16 v[84:87], v[122:125], v[14:17], v[84:87]
  s_mov_b32 s45, 0
  v_exp_f32 v96, v96
  v_mfma_f32_16x16x32_bf16 v[88:91], v[136:139], v[128:131], v[36:39]
  s_mov_b32 s59, 1
  v_exp_f32 v97, v97
  v_mfma_f32_16x16x32_bf16 v[88:91], v[138:141], v[14:17], v[88:91]
  s_mov_b32 s58, 0
  v_exp_f32 v98, v98
  v_mfma_f32_16x16x32_bf16 v[172:175], v[144:147], v[128:131], v[32:35]
  s_mov_b64 s[12:13], 0
  v_exp_f32 v99, v99
  v_mfma_f32_16x16x32_bf16 v[172:175], v[146:149], v[14:17], v[172:175]
  s_mov_b64 s[16:17], 0
  v_exp_f32 v104, v104
  v_mfma_f32_16x16x32_bf16 v[68:71], v[150:153], v[128:131], v[28:31]
  s_mov_b64 s[18:19], 0
  v_exp_f32 v105, v105
  v_mfma_f32_16x16x32_bf16 v[68:71], v[152:155], v[14:17], v[68:71]
  s_mov_b64 s[60:61], 0
  v_exp_f32 v106, v106
  v_mfma_f32_16x16x32_bf16 v[76:79], v[146:149], v[100:103], v[36:39]
  s_mov_b32 s15, 0
  v_exp_f32 v107, v107
  v_mfma_f32_16x16x32_bf16 v[76:79], v[144:147], v[18:21], v[76:79]
  s_mov_b32 s99, 0
  v_exp_f32 v132, v132
  v_mfma_f32_16x16x32_bf16 v[80:83], v[152:155], v[100:103], v[32:35]
  s_mov_b64 s[100:101], 0
  v_exp_f32 v133, v133
  v_mfma_f32_16x16x32_bf16 v[80:83], v[150:153], v[18:21], v[80:83]
  s_mov_b32 s14, 0
  v_exp_f32 v134, v134
  v_mfma_f32_16x16x32_bf16 v[160:163], v[122:125], v[100:103], v[44:47]
  v_exp_f32 v135, v135
  v_mfma_f32_16x16x32_bf16 v[160:163], v[120:123], v[18:21], v[160:163]
  v_cvt_pk_bf16_f32 v92, v92, v93
  v_cvt_pk_bf16_f32 v93, v94, v95
  v_mfma_f32_16x16x32_bf16 v[156:159], v[138:141], v[100:103], v[40:43]
  v_cvt_pk_bf16_f32 v94, v96, v97
  v_cvt_pk_bf16_f32 v95, v98, v99
  v_mfma_f32_16x16x32_bf16 v[156:159], v[136:139], v[18:21], v[156:159]
  v_cvt_pk_bf16_f32 v96, v104, v105
  v_cvt_pk_bf16_f32 v97, v106, v107
  v_mfma_f32_16x16x32_bf16 v[128:131], a[0:3], a[248:251], 0
  v_cvt_pk_bf16_f32 v98, v132, v133
  v_cvt_pk_bf16_f32 v99, v134, v135
  v_mfma_f32_16x16x32_bf16 v[128:131], a[12:15], v[168:171], v[128:131]
  v_exp_f32 v84, v84
  v_mfma_f32_16x16x32_bf16 v[128:131], a[24:27], v[164:167], v[128:131]
  v_exp_f32 v85, v85
  v_mfma_f32_16x16x32_bf16 v[128:131], a[36:39], v[180:183], v[128:131]
  v_exp_f32 v86, v86
  v_mfma_f32_16x16x32_bf16 v[128:131], a[48:51], a[252:255], v[128:131]
  v_exp_f32 v87, v87
  v_mfma_f32_16x16x32_bf16 v[128:131], a[60:63], a[244:247], v[128:131]
  v_exp_f32 v88, v88
  v_mfma_f32_16x16x32_bf16 v[100:103], a[64:67], a[244:247], 0
  v_exp_f32 v89, v89
  v_mfma_f32_16x16x32_bf16 v[100:103], a[52:55], a[252:255], v[100:103]
  v_exp_f32 v90, v90
  v_mfma_f32_16x16x32_bf16 v[100:103], a[40:43], v[180:183], v[100:103]
  v_exp_f32 v91, v91
  v_mfma_f32_16x16x32_bf16 v[100:103], a[28:31], v[164:167], v[100:103]
  v_mul_f32 v128, s42, v128
  v_mul_f32 v129, s42, v129
  v_mfma_f32_16x16x32_bf16 v[100:103], a[16:19], v[168:171], v[100:103]
  v_mul_f32 v130, s42, v130
  v_mul_f32 v131, s42, v131
  v_mfma_f32_16x16x32_bf16 v[100:103], a[4:7], a[248:251], v[100:103]
  v_cvt_pk_bf16_f32 v72, v128, v129
  v_cvt_pk_bf16_f32 v73, v130, v131
  v_mfma_f32_16x16x32_bf16 v[104:107], a[8:11], a[248:251], 0
  v_exp_f32 v172, v172
  v_mfma_f32_16x16x32_bf16 v[104:107], a[20:23], v[168:171], v[104:107]
  v_exp_f32 v173, v173
  v_mfma_f32_16x16x32_bf16 v[104:107], a[32:35], v[164:167], v[104:107]
  v_exp_f32 v174, v174
  v_mfma_f32_16x16x32_bf16 v[104:107], a[44:47], v[180:183], v[104:107]
  v_mul_f32 v100, s42, v100
  v_mul_f32 v101, s42, v101
  v_mfma_f32_16x16x32_bf16 v[104:107], a[56:59], a[252:255], v[104:107]
  v_mul_f32 v102, s42, v102
  v_mul_f32 v103, s42, v103
  v_mfma_f32_16x16x32_bf16 v[104:107], a[68:71], a[244:247], v[104:107]
  v_cvt_pk_bf16_f32 v74, v100, v101
  v_cvt_pk_bf16_f32 v75, v102, v103
  v_mfma_f32_16x16x32_bf16 v[128:131], a[248:251], a[144:147], 0
  v_exp_f32 v175, v175
  v_mfma_f32_16x16x32_bf16 v[128:131], v[168:171], a[156:159], v[128:131]
  v_exp_f32 v68, v68
  v_mfma_f32_16x16x32_bf16 v[128:131], v[164:167], a[168:171], v[128:131]
  v_mul_f32 v104, s42, v104
  v_mul_f32 v105, s42, v105
  v_mfma_f32_16x16x32_bf16 v[128:131], v[180:183], a[180:183], v[128:131]
  v_mul_f32 v106, s42, v106
  v_mul_f32 v107, s42, v107
  v_cvt_pk_bf16_f32 v22, v104, v105
  v_cvt_pk_bf16_f32 v23, v106, v107
  v_mfma_f32_16x16x32_bf16 v[128:131], a[252:255], a[192:195], v[128:131]
  s_waitcnt vmcnt(6) lgkmcnt(0)
  s_barrier
  v_mfma_f32_16x16x32_bf16 v[128:131], a[244:247], a[204:207], v[128:131]
  v_exp_f32 v69, v69
  v_mfma_f32_16x16x32_bf16 v[100:103], v[144:147], v[72:75], v[40:43]
  v_exp_f32 v70, v70
  v_mfma_f32_16x16x32_bf16 v[100:103], v[146:149], v[20:23], v[100:103]
  v_exp_f32 v71, v71
  v_mfma_f32_16x16x32_bf16 v[104:107], v[150:153], v[72:75], v[36:39]
  v_cvt_pk_bf16_f32 v84, v84, v85
  v_cvt_pk_bf16_f32 v85, v86, v87
  v_mfma_f32_16x16x32_bf16 v[104:107], v[152:155], v[20:23], v[104:107]
  v_cvt_pk_bf16_f32 v110, v128, v129
  v_cvt_pk_bf16_f32 v111, v130, v131
  v_mfma_f32_16x16x32_bf16 v[132:135], v[120:123], v[72:75], v[48:51]
  v_cvt_pk_bf16_f32 v86, v88, v89
  v_cvt_pk_bf16_f32 v87, v90, v91
  v_mfma_f32_16x16x32_bf16 v[132:135], v[122:125], v[20:23], v[132:135]
  v_cvt_pk_bf16_f32 v88, v172, v173
  v_cvt_pk_bf16_f32 v89, v174, v175
  v_mfma_f32_16x16x32_bf16 v[128:131], v[136:139], v[72:75], v[44:47]
  v_cvt_pk_bf16_f32 v90, v68, v69
  v_cvt_pk_bf16_f32 v91, v70, v71
  v_mfma_f32_16x16x32_bf16 v[128:131], v[138:141], v[20:23], v[128:131]
  v_exp_f32 v76, v76
  v_mfma_f32_16x16x32_bf16 v[144:147], a[244:247], a[208:211], 0
  ds_read_b128 v[172:175], v3 offset:0
  ds_read_b128 v[136:139], v3 offset:4096
  v_mfma_f32_16x16x32_bf16 v[144:147], a[252:255], a[196:199], v[144:147]
  ds_read_b128 v[140:143], v3 offset:8192
  ds_read_b128 v[68:71], v3 offset:12288
  v_mfma_f32_16x16x32_bf16 v[144:147], v[180:183], a[184:187], v[144:147]
  ds_read_b128 v[72:75], v3 offset:16384
  ds_read_b128 v[120:123], v3 offset:20480
  v_mfma_f32_16x16x32_bf16 v[144:147], v[164:167], a[172:175], v[144:147]
  v_exp_f32 v77, v77
  v_mfma_f32_16x16x32_bf16 v[144:147], v[168:171], a[160:163], v[144:147]
  v_exp_f32 v78, v78
  v_mfma_f32_16x16x32_bf16 v[144:147], a[248:251], a[148:151], v[144:147]
  v_exp_f32 v79, v79
  v_mfma_f32_16x16x32_bf16 v[124:127], a[248:251], a[152:155], 0
  v_exp_f32 v80, v80
  v_mfma_f32_16x16x32_bf16 v[124:127], v[168:171], a[164:167], v[124:127]
  v_exp_f32 v81, v81
  v_mfma_f32_16x16x32_bf16 v[124:127], v[164:167], a[176:179], v[124:127]
  v_exp_f32 v82, v82
  v_mfma_f32_16x16x32_bf16 v[124:127], v[180:183], a[188:191], v[124:127]
  v_exp_f32 v83, v83
  v_mfma_f32_16x16x32_bf16 v[124:127], a[252:255], a[200:203], v[124:127]
  v_exp_f32 v160, v160
  v_mfma_f32_16x16x32_bf16 v[124:127], a[244:247], a[212:215], v[124:127]
  v_cvt_pk_bf16_f32 v114, v144, v145
  v_cvt_pk_bf16_f32 v115, v146, v147
  v_add_u32 v0, s28, v2
  v_xor_b32 v1, 64, v0
  s_waitcnt lgkmcnt(0)
  s_branch L_mid
  s_nop 0
  s_nop 0
  s_nop 0
  s_nop 0
  s_nop 0
  s_nop 0
  s_nop 0
  s_nop 0
  s_nop 0
  s_nop 0
  s_nop 0
  s_nop 0
  s_nop 0
  s_nop 0
  s_nop 0
  s_nop 0
  s_nop 0
  s_nop 0
  s_nop 0
  s_nop 0
  s_nop 0
  s_nop 0
  s_nop 0
  s_nop 0
  s_nop 0
  s_nop 0
  s_nop 0
  s_nop 0
  s_nop 0
  s_nop 0
  s_nop 0
  s_nop 0
  s_nop 0
  s_nop 0
  s_nop 0
  s_nop 0
  s_nop 0
  s_nop 0
  s_nop 0
  s_nop 0
  s_nop 0
  s_nop 0
  s_nop 0
  s_nop 0
  s_nop 0
  s_nop 0
  s_nop 0
  s_nop 0
  s_nop 0
  s_nop 0
  s_nop 0
  s_nop 0
  s_nop 0
  s_nop 0
  s_nop 0
  s_nop 0
  s_nop 0
  s_nop 0
  s_nop 0
  s_nop 0
  s_nop 0
  s_nop 0
  s_nop 0
  s_nop 0
  s_nop 0
  s_nop 0
  s_nop 0
  s_nop 0
  s_nop 0
  s_nop 0
  s_nop 0
  s_nop 0
  s_nop 0
  s_nop 0
  s_nop 0
  s_nop 0
  s_nop 0
  s_nop 0
  s_nop 0
  s_nop 0
  s_nop 0
  s_nop 0
  s_nop 0
  s_nop 0
  s_nop 0
  s_nop 0
  s_nop 0
  s_nop 0
  s_nop 0
  s_nop 0
  s_nop 0
  s_nop 0
  s_nop 0
  s_nop 0
  s_nop 0
  s_nop 0
  s_nop 0
  s_nop 0
  s_nop 0
  s_nop 0
  s_nop 0
  s_nop 0
  s_nop 0
  s_nop 0
  s_nop 0
  s_nop 0
  s_nop 0
  s_nop 0
  s_nop 0
  s_nop 0
  s_nop 0
  s_nop 0
  s_nop 0
  s_nop 0
  s_nop 0
  s_nop 0
  s_nop 0
  s_nop 0
  s_nop 0
  s_nop 0
  s_nop 0
  s_nop 0
  s_nop 0
  s_nop 0
  s_nop 0
  s_nop 0
  s_nop 0
  s_nop 0
  s_nop 0
  s_nop 0
  s_nop 0
  s_nop 0
  s_nop 0
  s_nop 0
  s_nop 0
  s_nop 0
  s_nop 0
  s_nop 0
  s_nop 0
  s_nop 0
  s_nop 0
  s_nop 0
  s_nop 0
  s_nop 0
  s_nop 0
  s_nop 0
  s_nop 0
  s_nop 0
  s_nop 0
  s_nop 0
  s_nop 0
  s_nop 0
  s_nop 0
  s_nop 0
  s_nop 0
  s_nop 0
  s_nop 0
  s_nop 0
  s_nop 0
  s_nop 0
  s_nop 0
  s_nop 0
  s_nop 0
  s_nop 0
  s_nop 0
  s_nop 0
  s_nop 0
  s_nop 0
  s_nop 0
  s_nop 0
  s_nop 0
  s_nop 0
  s_nop 0
  s_nop 0
  s_nop 0
  s_nop 0
  s_nop 0
  s_nop 0
  s_nop 0
  s_nop 0
  s_nop 0
  s_nop 0
  s_nop 0
  s_nop 0
  s_nop 0
  s_nop 0
  s_nop 0
  s_nop 0
  s_nop 0
  s_nop 0
  s_nop 0
  s_nop 0
  s_nop 0
  s_nop 0
  s_nop 0
  s_nop 0
  s_nop 0
  s_nop 0
  s_nop 0
  s_nop 0
  s_nop 0
  s_nop 0
  s_nop 0
  s_nop 0
  s_nop 0
  s_nop 0
  s_nop 0
  s_nop 0
  s_nop 0
  s_nop 0
  s_nop 0
  s_nop 0
  s_nop 0
  s_nop 0
  s_nop 0
  s_nop 0
  s_nop 0
  s_nop 0
  s_nop 0
  s_nop 0
  s_nop 0
  s_nop 0
  s_nop 0
  s_nop 0
  s_nop 0
  s_nop 0
  s_nop 0
  s_nop 0
  s_nop 0
  s_nop 0
  s_nop 0
  s_nop 0
  s_nop 0
  s_nop 0
  s_nop 0
  s_nop 0
  s_nop 0
  s_nop 0
  s_nop 0
  s_nop 0
  s_nop 0
  s_nop 0
  s_nop 0
  s_nop 0
  s_nop 0
  s_nop 0
  s_nop 0
  s_nop 0
  s_nop 0
  s_nop 0
  s_nop 0
  s_nop 0
  s_nop 0
  s_nop 0
  s_nop 0
  s_nop 0
  s_nop 0
  s_nop 0
  s_nop 0
  s_nop 0
  s_nop 0
  s_nop 0
  s_nop 0
  s_nop 0
  s_nop 0
  s_nop 0
  s_nop 0
  s_nop 0
  s_nop 0
  s_nop 0
  s_nop 0
  s_nop 0
  s_nop 0
  s_nop 0
  s_nop 0
  s_nop 0
  s_nop 0
  s_nop 0
  s_nop 0
  s_nop 0
  s_nop 0
  s_nop 0
  s_nop 0
  s_nop 0
  s_nop 0
  s_nop 0
  s_nop 0
  s_nop 0
  s_nop 0
  s_nop 0
  s_nop 0
  s_nop 0
  s_nop 0
  s_nop 0
  s_nop 0
  s_nop 0
  s_nop 0
  s_nop 0
  s_nop 0
  s_nop 0
  s_nop 0
  s_nop 0
  s_nop 0
  s_nop 0
  s_nop 0
  s_nop 0
  s_nop 0
  s_nop 0
  s_nop 0
  s_nop 0
  s_nop 0
  s_nop 0
  s_nop 0
  s_nop 0
  s_nop 0
  s_nop 0
  s_nop 0
  s_nop 0
  s_nop 0
  s_nop 0
  s_nop 0
  s_nop 0
  s_nop 0
  s_nop 0
  s_nop 0
  s_nop 0
  s_nop 0
  s_nop 0
  s_nop 0
  s_nop 0
  s_nop 0
  s_nop 0
  s_nop 0
  s_nop 0
  s_nop 0
  s_nop 0
  s_nop 0
  s_nop 0
  s_nop 0
  s_nop 0
  s_nop 0
  s_nop 0
  s_nop 0
  s_nop 0
  s_nop 0
  s_nop 0
  s_nop 0
  s_nop 0
  s_nop 0
  s_nop 0
  s_nop 0
  s_nop 0
  s_nop 0
  s_nop 0
  s_nop 0
  s_nop 0
  s_nop 0
  s_nop 0
  s_nop 0
  s_nop 0
  s_nop 0
  s_nop 0
  s_nop 0
  s_nop 0
  s_nop 0
  s_nop 0
  s_nop 0
  s_nop 0
  s_nop 0
  s_nop 0
  s_nop 0
  s_nop 0
  s_nop 0
  s_nop 0
  s_nop 0
  s_nop 0
  s_nop 0
  s_nop 0
  s_nop 0
  s_nop 0
  s_nop 0
  s_nop 0
  s_nop 0
  s_nop 0
  s_nop 0
  s_nop 0
  s_nop 0
  s_nop 0
  s_nop 0
  s_nop 0
  s_nop 0
  s_nop 0
  s_nop 0
  s_nop 0
  s_nop 0
  s_nop 0
  s_nop 0
  s_nop 0
  s_nop 0
  s_nop 0
  s_nop 0
  s_nop 0
  s_nop 0
  s_nop 0
  s_nop 0
  s_nop 0
  s_nop 0
  s_nop 0
  s_nop 0
  s_nop 0
  s_nop 0
  s_nop 0
  s_nop 0
  s_nop 0
  s_nop 0
  s_nop 0
  s_nop 0
  s_nop 0
  s_nop 0
  s_nop 0
  s_nop 0
  s_nop 0
  s_nop 0
  s_nop 0
  s_nop 0
  s_nop 0
  s_nop 0
  s_nop 0
  s_nop 0
  s_nop 0
  s_nop 0
  s_nop 0
  s_nop 0
  s_nop 0
  s_nop 0
  s_nop 0
  s_nop 0
  s_nop 0
  s_nop 0
  s_nop 0
  s_nop 0
  s_nop 0
  s_nop 0
  s_nop 0
  s_nop 0
  s_nop 0
  s_nop 0
  s_nop 0
  s_nop 0
  s_nop 0
  s_nop 0
  s_nop 0
  s_nop 0
  s_nop 0
  s_nop 0
  s_nop 0
  s_nop 0
  s_nop 0
  s_nop 0
  s_nop 0
  s_nop 0
  s_nop 0
  s_nop 0
  s_nop 0
  s_nop 0
  s_nop 0
  s_nop 0
  s_nop 0
  s_nop 0
  s_nop 0
  s_nop 0
  s_nop 0
  s_nop 0
  s_nop 0
  s_nop 0
  s_nop 0
  s_nop 0
  s_nop 0
  s_nop 0
  s_nop 0
  s_nop 0
  s_nop 0
  s_nop 0
  s_nop 0
  s_nop 0
  s_nop 0
  s_nop 0
  s_nop 0
  s_nop 0
  s_nop 0
  s_nop 0
  s_nop 0
  s_nop 0
  s_nop 0
  s_nop 0
  s_nop 0
  s_nop 0
  s_nop 0
  s_nop 0
  s_nop 0
  s_nop 0
  s_nop 0
  s_nop 0
  s_nop 0
  s_nop 0
  s_nop 0
  s_nop 0
  s_nop 0
  s_nop 0
  s_nop 0
  s_nop 0
  s_nop 0
  s_nop 0
  s_nop 0
  s_nop 0
  s_nop 0
  s_nop 0
  s_nop 0
  s_nop 0
  s_nop 0
  s_nop 0
  s_nop 0
  s_nop 0
  s_nop 0
  s_nop 0
  s_nop 0
  s_nop 0
  s_nop 0
  s_nop 0
  s_nop 0
  s_nop 0
  s_nop 0
  s_nop 0
  s_nop 0
  s_nop 0
  s_nop 0
  s_nop 0
  s_nop 0
  s_nop 0
  s_nop 0
  s_nop 0
  s_nop 0
  s_nop 0
  s_nop 0
  s_nop 0
  s_nop 0
  s_nop 0
  s_nop 0
  s_nop 0
  s_nop 0
  s_nop 0
  s_nop 0
  s_nop 0
  s_nop 0
  s_nop 0
  s_nop 0
  s_nop 0
  s_nop 0
  s_nop 0
  s_nop 0
  s_nop 0
  s_nop 0
  s_nop 0
  s_nop 0
  s_nop 0
  s_nop 0
  s_nop 0
  s_nop 0
  s_nop 0
  s_nop 0
  s_nop 0
  s_nop 0
  s_nop 0
  s_nop 0
  s_nop 0
  s_nop 0
  s_nop 0
  s_nop 0
  s_nop 0
  s_nop 0
  s_nop 0
  s_nop 0
  s_nop 0
  s_nop 0
  s_nop 0
  s_nop 0
  s_nop 0
  s_nop 0
  s_nop 0
  s_nop 0
  s_nop 0
  s_nop 0
  s_nop 0
  s_nop 0
  s_nop 0
  s_nop 0
  s_nop 0
  s_nop 0
  s_nop 0
  s_nop 0
  s_nop 0
  s_nop 0
  s_nop 0
  s_nop 0
  s_nop 0
  s_nop 0
  s_nop 0
  s_nop 0
  s_nop 0
  s_nop 0
  s_nop 0
  s_nop 0
  s_nop 0
  s_nop 0
  s_nop 0
  s_nop 0
  s_nop 0
  s_nop 0
  s_nop 0
  s_nop 0
  s_nop 0
  s_nop 0
  s_nop 0
  s_nop 0
  s_nop 0
  s_nop 0
  s_nop 0
  s_nop 0
  s_nop 0
  s_nop 0
  s_nop 0
  s_nop 0
  s_nop 0
  s_nop 0
  s_nop 0
  s_nop 0
  s_nop 0
  s_nop 0
  s_nop 0
  s_nop 0
  s_nop 0
  s_nop 0
  s_nop 0
  s_nop 0
  s_nop 0
  s_nop 0
  s_nop 0
  s_nop 0
  s_nop 0
  s_nop 0
  s_nop 0
  s_nop 0
  s_nop 0
  s_nop 0
  s_nop 0
  s_nop 0
  s_nop 0
  s_nop 0
  s_nop 0
  s_nop 0
  s_nop 0
  s_nop 0
  s_nop 0
  s_nop 0
  s_nop 0
  s_nop 0
  s_nop 0
  s_nop 0
  s_nop 0
  s_nop 0
  s_nop 0
  s_nop 0
  s_nop 0
  s_nop 0
  s_nop 0
  s_nop 0
  s_nop 0
  s_nop 0
  s_nop 0
  s_nop 0
  s_nop 0
  s_nop 0
  s_nop 0
  s_nop 0
  s_nop 0
  s_nop 0
  s_nop 0
  s_nop 0
  s_nop 0
  s_nop 0
  s_nop 0
  s_nop 0
  s_nop 0
  s_nop 0
  s_nop 0
  s_nop 0
  s_nop 0
  s_nop 0
  s_nop 0
  s_nop 0
  s_nop 0
  s_nop 0
  s_nop 0
  s_nop 0
  s_nop 0
  s_nop 0
  s_nop 0
  s_nop 0
  s_nop 0
  s_nop 0
  s_nop 0
  s_nop 0
  s_nop 0
  s_nop 0
  s_nop 0
  s_nop 0
  s_nop 0
  s_nop 0
  s_nop 0
  s_nop 0
  s_nop 0
  s_nop 0
  s_nop 0
  s_nop 0
  s_nop 0
  s_nop 0
  s_nop 0
  s_nop 0
  s_nop 0
  s_nop 0
  s_nop 0
  s_nop 0
  s_nop 0
  s_nop 0
  s_nop 0
  s_nop 0
  s_nop 0
  s_nop 0
  s_nop 0
  s_nop 0
  s_nop 0
  s_nop 0
  s_nop 0
  s_nop 0
  s_nop 0
  s_nop 0
  s_nop 0
  s_nop 0
  s_nop 0
  s_nop 0
  s_nop 0
  s_nop 0
  s_nop 0
  s_nop 0
  s_nop 0
  s_nop 0
  s_nop 0
  s_nop 0
  s_nop 0
  s_nop 0
  s_nop 0
  s_nop 0
  s_nop 0
  s_nop 0
  s_nop 0
  s_nop 0
  s_nop 0
  s_nop 0
  s_nop 0
  s_nop 0
  s_nop 0
  s_nop 0
  s_nop 0
  s_nop 0
  s_nop 0
  s_nop 0
  s_nop 0
  s_nop 0
  s_nop 0
  s_nop 0
  s_nop 0
  s_nop 0
  s_nop 0
  s_nop 0
  s_nop 0
  s_nop 0
  s_nop 0
  s_nop 0
  s_nop 0
  s_nop 0
  s_nop 0
  s_nop 0
  s_nop 0
  s_nop 0
  s_nop 0
  s_nop 0
  s_nop 0
  s_nop 0
  s_nop 0
  s_nop 0
  s_nop 0
  s_nop 0
  s_nop 0
  s_nop 0
  s_nop 0
  s_nop 0
  s_nop 0
  s_nop 0
  s_nop 0
  s_nop 0
  s_nop 0
  s_nop 0
  s_nop 0
  s_nop 0
  s_nop 0
  s_nop 0
  s_nop 0
  s_nop 0
  s_nop 0
  s_nop 0
  s_nop 0
  s_nop 0
  s_nop 0
  s_nop 0
  s_nop 0
  s_nop 0
  s_nop 0
  s_nop 0
  s_nop 0
  s_nop 0
  s_nop 0
  s_nop 0
  s_nop 0
  s_nop 0
  s_nop 0
  s_nop 0
  s_nop 0
  s_nop 0
  s_nop 0
  s_nop 0
  s_nop 0
  s_nop 0
  s_nop 0
  s_nop 0
  s_nop 0
  s_nop 0
  s_nop 0
  s_nop 0
  s_nop 0
  s_nop 0
  s_nop 0
  s_nop 0
  s_nop 0
  s_nop 0
  s_nop 0
  s_nop 0
  s_nop 0
  s_nop 0
  s_nop 0
  s_nop 0
  s_nop 0
  s_nop 0
  s_nop 0
  s_nop 0
  s_nop 0
  s_nop 0
  s_nop 0
  s_nop 0
  s_nop 0
  s_nop 0
  s_nop 0
  s_nop 0
  s_nop 0
  s_nop 0
  s_nop 0
  s_nop 0
  s_nop 0
  s_nop 0
  s_nop 0
  s_nop 0
  s_nop 0
  s_nop 0
  s_nop 0
  s_nop 0
  s_nop 0
  s_nop 0
  s_nop 0
  s_nop 0
  s_nop 0
  s_nop 0
  s_nop 0
  s_nop 0
  s_nop 0
  s_nop 0
  s_nop 0
L_hop_3_0:
  s_cbranch_execz L_hop_3_1
L_pad2120:
L_loop:
  v_mfma_f32_16x16x32_bf16 v[104:107], a[0:3], v[88:91], 0
L_r208:
  v_mfma_f32_16x16x32_bf16 v[104:107], a[12:15], v[92:95], v[104:107]
L_r209:
  v_mfma_f32_16x16x32_bf16 v[104:107], a[24:27], v[96:99], v[104:107]
  v_cvt_pk_bf16_f32 v66, v128, v129
  v_cvt_pk_bf16_f32 v67, v130, v131
L_r210:
  v_mfma_f32_16x16x32_bf16 v[104:107], a[36:39], v[136:139], v[104:107]
L_r211:
  v_mfma_f32_16x16x32_bf16 v[104:107], a[48:51], v[140:143], v[104:107]
  s_waitcnt lgkmcnt(0)
L_r212:
  v_mfma_f32_16x16x32_bf16 v[104:107], a[60:63], v[80:83], v[104:107]
L_r213:
  v_mfma_f32_16x16x32_bf16 v[84:87], a[64:67], v[80:83], 0
L_r214:
  v_mfma_f32_16x16x32_bf16 v[84:87], a[52:55], v[140:143], v[84:87]
L_r215:
  v_mfma_f32_16x16x32_bf16 v[84:87], a[40:43], v[136:139], v[84:87]
  v_mul_f32 v104, s42, v104
  v_mul_f32 v105, s42, v105
L_r216:
  v_mfma_f32_16x16x32_bf16 v[84:87], a[28:31], v[96:99], v[84:87]
  v_mul_f32 v106, s42, v106
  v_mul_f32 v107, s42, v107
L_r217:
  v_mfma_f32_16x16x32_bf16 v[84:87], a[16:19], v[92:95], v[84:87]
  v_cvt_pk_bf16_f32 v18, v104, v105
  v_cvt_pk_bf16_f32 v19, v106, v107
L_r218:
  v_mfma_f32_16x16x32_bf16 v[84:87], a[4:7], v[88:91], v[84:87]
L_r219:
  v_mfma_f32_16x16x32_bf16 v[108:111], a[8:11], v[88:91], 0
L_r220:
  v_mfma_f32_16x16x32_bf16 v[108:111], a[20:23], v[92:95], v[108:111]
L_r221:
  v_mfma_f32_16x16x32_bf16 v[108:111], a[32:35], v[96:99], v[108:111]
  v_mul_f32 v84, s42, v84
  v_mul_f32 v85, s42, v85
L_r222:
  v_mfma_f32_16x16x32_bf16 v[108:111], a[44:47], v[136:139], v[108:111]
  v_mul_f32 v86, s42, v86
  v_mul_f32 v87, s42, v87
L_r223:
  v_mfma_f32_16x16x32_bf16 v[108:111], a[56:59], v[140:143], v[108:111]
  v_cvt_pk_bf16_f32 v104, v84, v85
  v_cvt_pk_bf16_f32 v105, v86, v87
L_r224:
  v_mfma_f32_16x16x32_bf16 v[108:111], a[68:71], v[80:83], v[108:111]
L_r225:
  v_mfma_f32_16x16x32_bf16 v[112:115], a[132:135], v[80:83], 0
L_r226:
  v_mfma_f32_16x16x32_bf16 v[112:115], a[120:123], v[140:143], v[112:115]
L_r227:
  v_mfma_f32_16x16x32_bf16 v[112:115], a[108:111], v[136:139], v[112:115]
  v_mul_f32 v108, s42, v108
  v_mul_f32 v109, s42, v109
L_r228:
  v_mfma_f32_16x16x32_bf16 v[112:115], a[96:99], v[96:99], v[112:115]
  v_mul_f32 v110, s42, v110
  v_mul_f32 v111, s42, v111
L_r229:
  v_mfma_f32_16x16x32_bf16 v[112:115], a[84:87], v[92:95], v[112:115]
  v_cvt_pk_bf16_f32 v106, v108, v109
  v_cvt_pk_bf16_f32 v107, v110, v111
L_r230:
  v_mfma_f32_16x16x32_bf16 v[112:115], a[72:75], v[88:91], v[112:115]
L_r231:
  v_mfma_f32_16x16x32_bf16 v[84:87], a[76:79], v[88:91], 0
L_r232:
  v_mfma_f32_16x16x32_bf16 v[84:87], a[88:91], v[92:95], v[84:87]
L_r233:
  v_mfma_f32_16x16x32_bf16 v[84:87], a[100:103], v[96:99], v[84:87]
  v_cvt_pk_bf16_f32 v128, v112, v113
  v_cvt_pk_bf16_f32 v129, v114, v115
L_r234:
  v_mfma_f32_16x16x32_bf16 v[84:87], a[112:115], v[136:139], v[84:87]
L_r235:
  v_mfma_f32_16x16x32_bf16 v[84:87], a[124:127], v[140:143], v[84:87]
L_r236:
  v_mfma_f32_16x16x32_bf16 v[84:87], a[136:139], v[80:83], v[84:87]
L_r237:
  v_mfma_f32_16x16x32_bf16 v[108:111], a[140:143], v[80:83], 0
L_r238:
  v_mfma_f32_16x16x32_bf16 v[108:111], a[128:131], v[140:143], v[108:111]
L_r239:
  v_mfma_f32_16x16x32_bf16 v[108:111], a[116:119], v[136:139], v[108:111]
  v_cvt_pk_bf16_f32 v130, v84, v85
  v_cvt_pk_bf16_f32 v131, v86, v87
L_r240:
  v_mfma_f32_16x16x32_bf16 v[108:111], a[104:107], v[96:99], v[108:111]
L_r241:
  v_mfma_f32_16x16x32_bf16 v[108:111], a[92:95], v[92:95], v[108:111]
L_r242:
  v_mfma_f32_16x16x32_bf16 v[108:111], a[80:83], v[88:91], v[108:111]
L_r243:
  v_mfma_f32_16x16x32_bf16 v[84:87], v[88:91], a[144:147], 0
L_r244:
  v_mfma_f32_16x16x32_bf16 v[84:87], v[92:95], a[156:159], v[84:87]
  ds_read_b128 a[244:247], v1 offset:22528
L_r245:
  v_mfma_f32_16x16x32_bf16 v[84:87], v[96:99], a[168:171], v[84:87]
  v_cvt_pk_bf16_f32 v132, v108, v109
  v_cvt_pk_bf16_f32 v133, v110, v111
L_r246:
  v_mfma_f32_16x16x32_bf16 v[84:87], v[136:139], a[180:183], v[84:87]
  ds_read_b128 a[248:251], v0 offset:22528
L_r247:
  v_mfma_f32_16x16x32_bf16 v[84:87], v[140:143], a[192:195], v[84:87]
  ds_read_b128 a[252:255], v1 offset:14336
L_r248:
  v_mfma_f32_16x16x32_bf16 v[84:87], v[80:83], a[204:207], v[84:87]
  ds_read_b128 v[144:147], v0 offset:14336
L_r249:
  v_mfma_f32_16x16x32_bf16 v[116:119], v[80:83], a[208:211], 0
  ds_read_b128 v[148:151], v1 offset:6144
L_r250:
  v_mfma_f32_16x16x32_bf16 v[116:119], v[140:143], a[196:199], v[116:119]
  ds_read_b128 v[152:155], v0 offset:6144
L_r251:
  v_mfma_f32_16x16x32_bf16 v[116:119], v[136:139], a[184:187], v[116:119]
  v_cvt_pk_bf16_f32 v108, v84, v85
  v_cvt_pk_bf16_f32 v109, v86, v87
L_r252:
  v_mfma_f32_16x16x32_bf16 v[116:119], v[96:99], a[172:175], v[116:119]
L_r253:
  v_mfma_f32_16x16x32_bf16 v[116:119], v[92:95], a[160:163], v[116:119]
L_r254:
  v_mfma_f32_16x16x32_bf16 v[116:119], v[88:91], a[148:151], v[116:119]
L_r255:
  v_mfma_f32_16x16x32_bf16 v[156:159], v[88:91], a[152:155], 0
L_r256:
  v_mfma_f32_16x16x32_bf16 v[156:159], v[92:95], a[164:167], v[156:159]
L_r257:
  v_mfma_f32_16x16x32_bf16 v[156:159], v[96:99], a[176:179], v[156:159]
  v_cvt_pk_bf16_f32 v112, v116, v117
  v_cvt_pk_bf16_f32 v113, v118, v119
L_r258:
  v_mfma_f32_16x16x32_bf16 v[156:159], v[136:139], a[188:191], v[156:159]
L_r259:
  v_mfma_f32_16x16x32_bf16 v[156:159], v[140:143], a[200:203], v[156:159]
  buffer_load_dwordx2 v[52:53], v11, s[20:23], s44 offen sc1
  v_mfma_f32_16x16x32_bf16 v[156:159], v[80:83], a[212:215], v[156:159]
  s_waitcnt lgkmcnt(0)
  v_mfma_f32_16x16x32_bf16 v[84:87], a[132:135], a[244:247], 0
  v_mfma_f32_16x16x32_bf16 v[84:87], a[120:123], a[248:251], v[84:87]
  v_mfma_f32_16x16x32_bf16 v[84:87], a[108:111], a[252:255], v[84:87]
  v_cvt_pk_bf16_f32 v116, v156, v157
  v_cvt_pk_bf16_f32 v117, v158, v159
  v_mfma_f32_16x16x32_bf16 v[84:87], a[96:99], v[144:147], v[84:87]
  v_mfma_f32_16x16x32_bf16 v[84:87], a[84:87], v[148:151], v[84:87]
  s_waitcnt vmcnt(31)
  s_barrier
  v_mfma_f32_16x16x32_bf16 v[84:87], a[72:75], v[152:155], v[84:87]
  v_add_u32 v0, s28, v2
  v_xor_b32 v1, 64, v0
  v_mfma_f32_16x16x32_bf16 v[80:83], a[76:79], v[152:155], 0
  s_cmp_eq_u32 s59, 3
  v_mfma_f32_16x16x32_bf16 v[80:83], a[88:91], v[148:151], v[80:83]
  s_cselect_b32 s18, s16, s18
  v_mfma_f32_16x16x32_bf16 v[80:83], a[100:103], v[144:147], v[80:83]
  s_cselect_b32 s15, s60, s15
  v_cvt_pk_bf16_f32 v136, v84, v85
  v_cvt_pk_bf16_f32 v137, v86, v87
  v_mfma_f32_16x16x32_bf16 v[80:83], a[112:115], a[252:255], v[80:83]
  s_cmp_eq_u32 s59, 7
  v_mfma_f32_16x16x32_bf16 v[80:83], a[124:127], a[248:251], v[80:83]
  s_cselect_b32 s19, s16, s19
  v_mfma_f32_16x16x32_bf16 v[80:83], a[136:139], a[244:247], v[80:83]
  s_cselect_b32 s99, s60, s99
  v_mfma_f32_16x16x32_bf16 v[84:87], a[140:143], a[244:247], 0
  s_memrealtime s[16:17]
  v_mfma_f32_16x16x32_bf16 v[84:87], a[128:131], a[248:251], v[84:87]
  s_memtime s[60:61]
  v_mfma_f32_16x16x32_bf16 v[84:87], a[116:119], a[252:255], v[84:87]
  s_add_u32 s59, s59, 1
  v_cvt_pk_bf16_f32 v138, v80, v81
  v_cvt_pk_bf16_f32 v139, v82, v83
  v_mfma_f32_16x16x32_bf16 v[84:87], a[104:107], v[144:147], v[84:87]
  v_mfma_f32_16x16x32_bf16 v[84:87], a[92:95], v[148:151], v[84:87]
  v_mfma_f32_16x16x32_bf16 v[84:87], a[80:83], v[152:155], v[84:87]
  v_mfma_f32_16x16x32_bf16 v[92:95], v[70:73], v[76:79], v[36:39]
  v_mfma_f32_16x16x32_bf16 v[92:95], v[68:71], v[12:15], v[92:95]
  v_mfma_f32_16x16x32_bf16 v[96:99], v[122:125], v[76:79], v[32:35]
  v_cvt_pk_bf16_f32 v140, v84, v85
  v_cvt_pk_bf16_f32 v141, v86, v87
  v_mfma_f32_16x16x32_bf16 v[96:99], v[120:123], v[12:15], v[96:99]
  v_mfma_f32_16x16x32_bf16 v[172:175], v[130:133], v[76:79], v[28:31]
  v_exp_f32 v92, v92
  v_mfma_f32_16x16x32_bf16 v[172:175], v[128:131], v[12:15], v[172:175]
  v_exp_f32 v93, v93
  v_mfma_f32_16x16x32_bf16 v[176:179], v[138:141], v[76:79], v[24:27]
  v_exp_f32 v94, v94
  v_mfma_f32_16x16x32_bf16 v[176:179], v[136:139], v[12:15], v[176:179]
  v_exp_f32 v95, v95
  v_mfma_f32_16x16x32_bf16 v[84:87], v[68:71], v[100:103], v[40:43]
  v_exp_f32 v96, v96
  v_mfma_f32_16x16x32_bf16 v[84:87], v[70:73], v[14:17], v[84:87]
  v_exp_f32 v97, v97
  v_mfma_f32_16x16x32_bf16 v[88:91], v[120:123], v[100:103], v[36:39]
  v_exp_f32 v98, v98
  v_mfma_f32_16x16x32_bf16 v[88:91], v[122:125], v[14:17], v[88:91]
  v_exp_f32 v99, v99
  v_mfma_f32_16x16x32_bf16 v[168:171], v[128:131], v[100:103], v[32:35]
  v_exp_f32 v172, v172
  v_mfma_f32_16x16x32_bf16 v[168:171], v[130:133], v[14:17], v[168:171]
  v_exp_f32 v173, v173
  v_mfma_f32_16x16x32_bf16 v[164:167], v[136:139], v[100:103], v[28:31]
  v_exp_f32 v174, v174
  v_mfma_f32_16x16x32_bf16 v[164:167], v[138:141], v[14:17], v[164:167]
  v_exp_f32 v175, v175
  v_mfma_f32_16x16x32_bf16 v[76:79], v[130:133], v[104:107], v[36:39]
  v_exp_f32 v176, v176
  v_mfma_f32_16x16x32_bf16 v[76:79], v[128:131], v[18:21], v[76:79]
  v_exp_f32 v177, v177
  v_mfma_f32_16x16x32_bf16 v[80:83], v[138:141], v[104:107], v[32:35]
  v_exp_f32 v178, v178
  v_mfma_f32_16x16x32_bf16 v[80:83], v[136:139], v[18:21], v[80:83]
  v_exp_f32 v179, v179
  v_mfma_f32_16x16x32_bf16 v[160:163], v[70:73], v[104:107], v[44:47]
  v_cvt_pk_bf16_f32 v92, v92, v93
  v_cvt_pk_bf16_f32 v93, v94, v95
  v_mfma_f32_16x16x32_bf16 v[160:163], v[68:71], v[18:21], v[160:163]
  v_cvt_pk_bf16_f32 v94, v96, v97
  v_cvt_pk_bf16_f32 v95, v98, v99
  v_mfma_f32_16x16x32_bf16 v[156:159], v[122:125], v[104:107], v[40:43]
  v_cvt_pk_bf16_f32 v96, v172, v173
  v_cvt_pk_bf16_f32 v97, v174, v175
  v_mfma_f32_16x16x32_bf16 v[156:159], v[120:123], v[18:21], v[156:159]
  v_cvt_pk_bf16_f32 v98, v176, v177
  v_cvt_pk_bf16_f32 v99, v178, v179
  v_mfma_f32_16x16x32_bf16 v[172:175], a[0:3], v[152:155], 0
  v_exp_f32 v84, v84
  v_mfma_f32_16x16x32_bf16 v[172:175], a[12:15], v[148:151], v[172:175]
  v_exp_f32 v85, v85
  v_mfma_f32_16x16x32_bf16 v[172:175], a[24:27], v[144:147], v[172:175]
  v_exp_f32 v86, v86
  v_mfma_f32_16x16x32_bf16 v[172:175], a[36:39], a[252:255], v[172:175]
  v_exp_f32 v87, v87
  v_mfma_f32_16x16x32_bf16 v[172:175], a[48:51], a[248:251], v[172:175]
  v_exp_f32 v88, v88
  v_mfma_f32_16x16x32_bf16 v[172:175], a[60:63], a[244:247], v[172:175]
  v_exp_f32 v89, v89
  v_mfma_f32_16x16x32_bf16 v[100:103], a[64:67], a[244:247], 0
  v_exp_f32 v90, v90
  v_mfma_f32_16x16x32_bf16 v[100:103], a[52:55], a[248:251], v[100:103]
  v_exp_f32 v91, v91
  v_mfma_f32_16x16x32_bf16 v[100:103], a[40:43], a[252:255], v[100:103]
  v_mul_f32 v172, s42, v172
  v_mul_f32 v173, s42, v173
  v_mfma_f32_16x16x32_bf16 v[100:103], a[28:31], v[144:147], v[100:103]
  v_mul_f32 v174, s42, v174
  v_mul_f32 v175, s42, v175
  v_mfma_f32_16x16x32_bf16 v[100:103], a[16:19], v[148:151], v[100:103]
  v_cvt_pk_bf16_f32 v176, v172, v173
  v_cvt_pk_bf16_f32 v177, v174, v175
  v_mfma_f32_16x16x32_bf16 v[100:103], a[4:7], v[152:155], v[100:103]
  v_exp_f32 v168, v168
  v_mfma_f32_16x16x32_bf16 v[104:107], a[8:11], v[152:155], 0
  v_exp_f32 v169, v169
  v_mfma_f32_16x16x32_bf16 v[104:107], a[20:23], v[148:151], v[104:107]
  v_exp_f32 v170, v170
  v_mfma_f32_16x16x32_bf16 v[104:107], a[32:35], v[144:147], v[104:107]
  v_mul_f32 v100, s42, v100
  v_mul_f32 v101, s42, v101
  v_mfma_f32_16x16x32_bf16 v[104:107], a[44:47], a[252:255], v[104:107]
  v_mul_f32 v102, s42, v102
  v_mul_f32 v103, s42, v103
  v_mfma_f32_16x16x32_bf16 v[104:107], a[56:59], a[248:251], v[104:107]
  v_cvt_pk_bf16_f32 v178, v100, v101
  v_cvt_pk_bf16_f32 v179, v102, v103
  v_mfma_f32_16x16x32_bf16 v[104:107], a[68:71], a[244:247], v[104:107]
  v_exp_f32 v171, v171
  v_mfma_f32_16x16x32_bf16 v[180:183], v[152:155], a[144:147], 0
  v_exp_f32 v164, v164
  v_mfma_f32_16x16x32_bf16 v[180:183], v[148:151], a[156:159], v[180:183]
  v_exp_f32 v165, v165
  v_mfma_f32_16x16x32_bf16 v[180:183], v[144:147], a[168:171], v[180:183]
  v_mul_f32 v104, s42, v104
  v_mul_f32 v105, s42, v105
  v_mfma_f32_16x16x32_bf16 v[180:183], a[252:255], a[180:183], v[180:183]
  v_mul_f32 v106, s42, v106
  v_mul_f32 v107, s42, v107
  v_mfma_f32_16x16x32_bf16 v[180:183], a[248:251], a[192:195], v[180:183]
  v_cvt_pk_bf16_f32 v22, v104, v105
  v_cvt_pk_bf16_f32 v23, v106, v107
  v_mfma_f32_16x16x32_bf16 v[180:183], a[244:247], a[204:207], v[180:183]
  v_exp_f32 v166, v166
  v_mfma_f32_16x16x32_bf16 v[100:103], v[128:131], v[176:179], v[40:43]
  v_exp_f32 v167, v167
  v_mfma_f32_16x16x32_bf16 v[100:103], v[130:133], v[20:23], v[100:103]
  v_cvt_pk_bf16_f32 v84, v84, v85
  v_cvt_pk_bf16_f32 v85, v86, v87
  v_mfma_f32_16x16x32_bf16 v[104:107], v[136:139], v[176:179], v[36:39]
  v_cvt_pk_bf16_f32 v110, v180, v181
  v_cvt_pk_bf16_f32 v111, v182, v183
  v_mfma_f32_16x16x32_bf16 v[104:107], v[138:141], v[20:23], v[104:107]
  ds_read_b128 v[172:175], v3 offset:0
  v_cvt_pk_bf16_f32 v86, v88, v89
  v_mfma_f32_16x16x32_bf16 v[132:135], v[68:71], v[176:179], v[48:51]
  ds_read_b128 v[136:139], v3 offset:4096
  v_cvt_pk_bf16_f32 v87, v90, v91
  v_mfma_f32_16x16x32_bf16 v[132:135], v[70:73], v[20:23], v[132:135]
  ds_read_b128 v[140:143], v3 offset:8192
  v_cvt_pk_bf16_f32 v88, v168, v169
  v_mfma_f32_16x16x32_bf16 v[128:131], v[120:123], v[176:179], v[44:47]
  ds_read_b128 v[68:71], v3 offset:12288
  v_cvt_pk_bf16_f32 v89, v170, v171
  v_mfma_f32_16x16x32_bf16 v[128:131], v[122:125], v[20:23], v[128:131]
  ds_read_b128 v[72:75], v3 offset:16384
  v_cvt_pk_bf16_f32 v90, v164, v165
  v_mfma_f32_16x16x32_bf16 v[168:171], a[244:247], a[208:211], 0
  ds_read_b128 v[120:123], v3 offset:20480
  v_cvt_pk_bf16_f32 v91, v166, v167
  v_mfma_f32_16x16x32_bf16 v[168:171], a[248:251], a[196:199], v[168:171]
  v_exp_f32 v76, v76
  v_mfma_f32_16x16x32_bf16 v[168:171], a[252:255], a[184:187], v[168:171]
  v_exp_f32 v77, v77
  v_mfma_f32_16x16x32_bf16 v[168:171], v[144:147], a[172:175], v[168:171]
  v_exp_f32 v78, v78
  v_mfma_f32_16x16x32_bf16 v[168:171], v[148:151], a[160:163], v[168:171]
  v_exp_f32 v79, v79
  v_mfma_f32_16x16x32_bf16 v[168:171], v[152:155], a[148:151], v[168:171]
  v_exp_f32 v80, v80
  v_mfma_f32_16x16x32_bf16 v[124:127], v[152:155], a[152:155], 0
  v_exp_f32 v81, v81
  v_mfma_f32_16x16x32_bf16 v[124:127], v[148:151], a[164:167], v[124:127]
  v_exp_f32 v82, v82
  v_mfma_f32_16x16x32_bf16 v[124:127], v[144:147], a[176:179], v[124:127]
  v_cvt_pk_bf16_f32 v114, v168, v169
  v_cvt_pk_bf16_f32 v115, v170, v171
  v_mfma_f32_16x16x32_bf16 v[124:127], a[252:255], a[188:191], v[124:127]
  v_exp_f32 v83, v83
  v_mfma_f32_16x16x32_bf16 v[124:127], a[248:251], a[200:203], v[124:127]
  s_waitcnt lgkmcnt(0)
  v_exp_f32 v160, v160
  v_mfma_f32_16x16x32_bf16 v[124:127], a[244:247], a[212:215], v[124:127]
L_hop_0_1:
  s_cbranch_execz L_hop_0_2
L_mid:
  v_mfma_f32_16x16x32_bf16 v[148:151], v[172:175], v[184:187], 0
  v_exp_f32 v161, v161
  v_mfma_f32_16x16x32_bf16 v[148:151], v[136:139], v[200:203], v[148:151]
  v_exp_f32 v162, v162
  v_mfma_f32_16x16x32_bf16 v[148:151], v[140:143], v[216:219], v[148:151]
  v_cvt_pk_bf16_f32 v118, v124, v125
  v_cvt_pk_bf16_f32 v119, v126, v127
  v_mfma_f32_16x16x32_bf16 v[148:151], v[68:71], v[232:235], v[148:151]
  v_exp_f32 v163, v163
  v_mfma_f32_16x16x32_bf16 v[148:151], v[72:75], v[248:251], v[148:151]
  v_exp_f32 v156, v156
  v_mfma_f32_16x16x32_bf16 v[148:151], v[120:123], a[224:227], v[148:151]
  v_exp_f32 v157, v157
  v_mfma_f32_16x16x32_bf16 v[168:171], v[120:123], a[228:231], 0
  v_exp_f32 v158, v158
  v_mfma_f32_16x16x32_bf16 v[168:171], v[72:75], v[252:255], v[168:171]
  ds_read_b128 v[124:127], v4 offset:0
  v_cvt_pk_bf16_f32 v76, v76, v77
  v_mfma_f32_16x16x32_bf16 v[168:171], v[68:71], v[236:239], v[168:171]
  ds_read_b128 v[180:183], v4 offset:4096
  v_cvt_pk_bf16_f32 v77, v78, v79
  v_mfma_f32_16x16x32_bf16 v[168:171], v[140:143], v[220:223], v[168:171]
  ds_read_b128 a[248:251], v4 offset:8192
  v_cvt_pk_bf16_f32 v78, v80, v81
  v_mfma_f32_16x16x32_bf16 v[168:171], v[136:139], v[204:207], v[168:171]
  ds_read_b128 v[164:167], v4 offset:12288
  v_cvt_pk_bf16_f32 v79, v82, v83
  v_mfma_f32_16x16x32_bf16 v[168:171], v[172:175], v[188:191], v[168:171]
  ds_read_b128 v[144:147], v4 offset:16384
  v_cvt_pk_bf16_f32 v80, v160, v161
  v_mfma_f32_16x16x32_bf16 v[152:155], v[172:175], v[192:195], 0
  ds_read_b128 v[176:179], v4 offset:20480
  v_cvt_pk_bf16_f32 v81, v162, v163
  v_mfma_f32_16x16x32_bf16 v[152:155], v[136:139], v[208:211], v[152:155]
  v_exp_f32 v159, v159
  v_mfma_f32_16x16x32_bf16 v[152:155], v[140:143], v[224:227], v[152:155]
  v_cvt_pk_bf16_f32 v148, v148, v168
  v_cvt_pk_bf16_f32 v149, v149, v169
  v_mfma_f32_16x16x32_bf16 v[152:155], v[68:71], v[240:243], v[152:155]
  v_cvt_pk_bf16_f32 v150, v150, v170
  v_cvt_pk_bf16_f32 v151, v151, v171
  v_mfma_f32_16x16x32_bf16 v[152:155], v[72:75], a[216:219], v[152:155]
  buffer_store_dword v148, v7, s[24:27], s33 offen offset:0 nt
  v_mfma_f32_16x16x32_bf16 v[152:155], v[120:123], a[232:235], v[152:155]
  v_cvt_pk_bf16_f32 v82, v156, v157
  v_cvt_pk_bf16_f32 v83, v158, v159
  v_mfma_f32_16x16x32_bf16 v[160:163], v[120:123], a[236:239], 0
  v_exp_f32 v100, v100
  v_mfma_f32_16x16x32_bf16 v[160:163], v[72:75], a[220:223], v[160:163]
  buffer_store_dword v149, v7, s[24:27], s33 offen offset:384 nt
  v_mfma_f32_16x16x32_bf16 v[160:163], v[68:71], v[244:247], v[160:163]
  ds_read_b128 a[244:247], v3 offset:512
  v_mfma_f32_16x16x32_bf16 v[160:163], v[140:143], v[228:231], v[160:163]
  ds_read_b128 v[168:171], v3 offset:4608
  v_mfma_f32_16x16x32_bf16 v[160:163], v[136:139], v[212:215], v[160:163]
  buffer_store_dword v150, v7, s[24:27], s33 offen offset:768 nt
  v_mfma_f32_16x16x32_bf16 v[160:163], v[172:175], v[196:199], v[160:163]
  s_waitcnt lgkmcnt(2)
  ds_read_b128 a[252:255], v3 offset:8704
  v_mfma_f32_16x16x32_bf16 v[136:139], v[124:127], v[184:187], 0
  ds_read_b128 v[68:71], v3 offset:12800
  v_mfma_f32_16x16x32_bf16 v[136:139], v[180:183], v[200:203], v[136:139]
  buffer_store_dword v151, v7, s[24:27], s33 offen offset:1152 nt
  v_mfma_f32_16x16x32_bf16 v[136:139], a[248:251], v[216:219], v[136:139]
  v_cvt_pk_bf16_f32 v152, v152, v160
  v_cvt_pk_bf16_f32 v153, v153, v161
  v_mfma_f32_16x16x32_bf16 v[136:139], v[164:167], v[232:235], v[136:139]
  v_cvt_pk_bf16_f32 v154, v154, v162
  v_cvt_pk_bf16_f32 v155, v155, v163
  v_mfma_f32_16x16x32_bf16 v[136:139], v[144:147], v[248:251], v[136:139]
  buffer_store_dword v152, v8, s[24:27], s33 offen offset:0 nt
  v_mfma_f32_16x16x32_bf16 v[136:139], v[176:179], a[224:227], v[136:139]
  ds_read_b128 v[72:75], v3 offset:16896
  v_mfma_f32_16x16x32_bf16 v[120:123], v[176:179], a[228:231], 0
  ds_read_b128 v[140:143], v3 offset:20992
  v_xor_b32 v3, 40960, v3
  v_mfma_f32_16x16x32_bf16 v[120:123], v[144:147], v[252:255], v[120:123]
  buffer_store_dword v153, v8, s[24:27], s33 offen offset:384 nt
  v_mfma_f32_16x16x32_bf16 v[120:123], v[164:167], v[236:239], v[120:123]
  v_exp_f32 v101, v101
  v_mfma_f32_16x16x32_bf16 v[120:123], a[248:251], v[220:223], v[120:123]
  v_exp_f32 v102, v102
  v_mfma_f32_16x16x32_bf16 v[120:123], v[180:183], v[204:207], v[120:123]
  buffer_store_dword v154, v8, s[24:27], s33 offen offset:768 nt
  v_mfma_f32_16x16x32_bf16 v[120:123], v[124:127], v[188:191], v[120:123]
  s_waitcnt lgkmcnt(1)
  v_exp_f32 v103, v103
  v_mfma_f32_16x16x32_bf16 v[144:147], a[244:247], v[184:187], 0
  v_exp_f32 v104, v104
  v_mfma_f32_16x16x32_bf16 v[144:147], v[168:171], v[200:203], v[144:147]
  buffer_store_dword v155, v8, s[24:27], s33 offen offset:1152 nt
  v_mfma_f32_16x16x32_bf16 v[144:147], a[252:255], v[216:219], v[144:147]
  v_cvt_pk_bf16_f32 v136, v136, v120
  v_cvt_pk_bf16_f32 v137, v137, v121
  v_mfma_f32_16x16x32_bf16 v[144:147], v[68:71], v[232:235], v[144:147]
  s_waitcnt lgkmcnt(0)
  v_cvt_pk_bf16_f32 v138, v138, v122
  v_cvt_pk_bf16_f32 v139, v139, v123
  v_mfma_f32_16x16x32_bf16 v[144:147], v[72:75], v[248:251], v[144:147]
  buffer_store_dword v136, v7, s[24:27], s34 offen offset:0 nt
  v_mfma_f32_16x16x32_bf16 v[144:147], v[140:143], a[224:227], v[144:147]
  v_exp_f32 v105, v105
  v_mfma_f32_16x16x32_bf16 v[160:163], v[140:143], a[228:231], 0
  v_exp_f32 v106, v106
  v_mfma_f32_16x16x32_bf16 v[160:163], v[72:75], v[252:255], v[160:163]
  buffer_store_dword v137, v7, s[24:27], s34 offen offset:384 nt
  v_mfma_f32_16x16x32_bf16 v[160:163], v[68:71], v[236:239], v[160:163]
  ds_read_b128 v[120:123], v4 offset:512
  v_cvt_pk_bf16_f32 v100, v100, v101
  v_mfma_f32_16x16x32_bf16 v[160:163], a[252:255], v[220:223], v[160:163]
  ds_read_b128 v[124:127], v4 offset:4608
  v_cvt_pk_bf16_f32 v101, v102, v103
  v_mfma_f32_16x16x32_bf16 v[160:163], v[168:171], v[204:207], v[160:163]
  buffer_store_dword v138, v7, s[24:27], s34 offen offset:768 nt
  v_mfma_f32_16x16x32_bf16 v[160:163], a[244:247], v[188:191], v[160:163]
  ds_read_b128 v[152:155], v4 offset:8704
  v_cvt_pk_bf16_f32 v102, v104, v105
  v_mfma_f32_16x16x32_bf16 v[148:151], a[244:247], v[192:195], 0
  ds_read_b128 v[156:159], v4 offset:12800
  v_mfma_f32_16x16x32_bf16 v[148:151], v[168:171], v[208:211], v[148:151]
  buffer_store_dword v139, v7, s[24:27], s34 offen offset:1152 nt
  v_mfma_f32_16x16x32_bf16 v[148:151], a[252:255], v[224:227], v[148:151]
  v_cvt_pk_bf16_f32 v144, v144, v160
  v_cvt_pk_bf16_f32 v145, v145, v161
  v_mfma_f32_16x16x32_bf16 v[148:151], v[68:71], v[240:243], v[148:151]
  v_cvt_pk_bf16_f32 v146, v146, v162
  v_cvt_pk_bf16_f32 v147, v147, v163
  v_mfma_f32_16x16x32_bf16 v[148:151], v[72:75], a[216:219], v[148:151]
  buffer_store_dword v144, v7, s[24:27], s35 offen offset:0 nt
  v_mfma_f32_16x16x32_bf16 v[148:151], v[140:143], a[232:235], v[148:151]
  ds_read_b128 v[136:139], v4 offset:16896
  v_mfma_f32_16x16x32_bf16 v[164:167], v[140:143], a[236:239], 0
  ds_read_b128 v[160:163], v4 offset:20992
  v_xor_b32 v4, 40960, v4
  v_mfma_f32_16x16x32_bf16 v[164:167], v[72:75], a[220:223], v[164:167]
  buffer_store_dword v145, v7, s[24:27], s35 offen offset:384 nt
  v_mfma_f32_16x16x32_bf16 v[164:167], v[68:71], v[244:247], v[164:167]
  v_exp_f32 v107, v107
  v_mfma_f32_16x16x32_bf16 v[164:167], a[252:255], v[228:231], v[164:167]
  v_exp_f32 v132, v132
  v_mfma_f32_16x16x32_bf16 v[164:167], v[168:171], v[212:215], v[164:167]
  buffer_store_dword v146, v7, s[24:27], s35 offen offset:768 nt
  v_mfma_f32_16x16x32_bf16 v[164:167], a[244:247], v[196:199], v[164:167]
  s_waitcnt lgkmcnt(1)
  v_exp_f32 v133, v133
  v_mfma_f32_16x16x32_bf16 v[140:143], v[120:123], v[184:187], 0
  v_exp_f32 v134, v134
  v_mfma_f32_16x16x32_bf16 v[140:143], v[124:127], v[200:203], v[140:143]
  buffer_store_dword v147, v7, s[24:27], s35 offen offset:1152 nt
  v_mfma_f32_16x16x32_bf16 v[140:143], v[152:155], v[216:219], v[140:143]
  v_cvt_pk_bf16_f32 v148, v148, v164
  v_cvt_pk_bf16_f32 v149, v149, v165
  v_mfma_f32_16x16x32_bf16 v[140:143], v[156:159], v[232:235], v[140:143]
  s_waitcnt lgkmcnt(0)
  v_cvt_pk_bf16_f32 v150, v150, v166
  v_cvt_pk_bf16_f32 v151, v151, v167
  v_mfma_f32_16x16x32_bf16 v[140:143], v[136:139], v[248:251], v[140:143]
  buffer_store_dword v148, v8, s[24:27], s35 offen offset:0 nt
  v_mfma_f32_16x16x32_bf16 v[140:143], v[160:163], a[224:227], v[140:143]
  v_mov_b64 v[164:165], 0
  v_cvt_pk_bf16_f32 v103, v106, v107
  v_mfma_f32_16x16x32_bf16 v[144:147], v[160:163], a[228:231], 0
  v_exp_f32 v135, v135
  v_mfma_f32_16x16x32_bf16 v[144:147], v[136:139], v[252:255], v[144:147]
  buffer_store_dword v149, v8, s[24:27], s35 offen offset:384 nt
  v_mfma_f32_16x16x32_bf16 v[144:147], v[156:159], v[236:239], v[144:147]
  v_exp_f32 v128, v128
  v_mfma_f32_16x16x32_bf16 v[144:147], v[152:155], v[220:223], v[144:147]
  v_mov_b64 v[72:73], 0
  v_cvt_pk_bf16_f32 v104, v132, v133
  v_mfma_f32_16x16x32_bf16 v[144:147], v[124:127], v[204:207], v[144:147]
  buffer_store_dword v150, v8, s[24:27], s35 offen offset:768 nt
  v_mfma_f32_16x16x32_bf16 v[144:147], v[120:123], v[188:191], v[144:147]
  v_exp_f32 v129, v129
  v_smfmac_f32_16x16x64_bf16 v[164:167], a[240:243], v[92:99], v10
  v_exp_f32 v130, v130
  v_mfma_f32_16x16x32_bf16 v[168:171], v[108:111], v[96:99], 0
  buffer_store_dword v151, v8, s[24:27], s35 offen offset:1152 nt
  v_mfma_f32_16x16x32_bf16 v[168:171], v[56:59], v[92:95], v[168:171]
  v_cvt_pk_bf16_f32 v140, v140, v144
  v_cvt_pk_bf16_f32 v141, v141, v145
  v_mfma_f32_16x16x32_bf16 v[160:163], v[60:63], v[92:95], 0
  v_cvt_pk_bf16_f32 v142, v142, v146
  v_cvt_pk_bf16_f32 v143, v143, v147
  v_mfma_f32_16x16x32_bf16 v[160:163], v[112:115], v[96:99], v[160:163]
  buffer_store_dword v140, v7, s[24:27], s36 offen offset:0 nt
  v_mfma_f32_16x16x32_bf16 v[68:71], v[116:119], v[96:99], 0
  v_mov_b64 v[124:125], 0
  v_cvt_pk_bf16_f32 v105, v134, v135
  v_mfma_f32_16x16x32_bf16 v[68:71], v[64:67], v[92:95], v[68:71]
  v_exp_f32 v131, v131
  v_smfmac_f32_16x16x64_bf16 v[72:75], a[240:243], v[84:91], v10
  buffer_store_dword v141, v7, s[24:27], s36 offen offset:384 nt
  v_mfma_f32_16x16x32_bf16 v[156:159], v[108:111], v[88:91], 0
  v_cvt_pk_bf16_f32 v106, v128, v129
  v_cvt_pk_bf16_f32 v107, v130, v131
  v_mfma_f32_16x16x32_bf16 v[156:159], v[56:59], v[84:87], v[156:159]
  v_add_f32 v164, v164, v165
  v_mfma_f32_16x16x32_bf16 v[148:151], v[60:63], v[84:87], 0
  buffer_store_dword v142, v7, s[24:27], s36 offen offset:768 nt
  v_mfma_f32_16x16x32_bf16 v[148:151], v[112:115], v[88:91], v[148:151]
  ds_read_b128 a[244:247], v0 offset:0
  v_mov_b64 v[92:93], 0
  v_mfma_f32_16x16x32_bf16 v[132:135], v[116:119], v[88:91], 0
  ds_read_b128 a[248:251], v1 offset:0
  v_add_f32 v72, v72, v73
  v_mfma_f32_16x16x32_bf16 v[132:135], v[64:67], v[84:87], v[132:135]
  buffer_store_dword v143, v7, s[24:27], s36 offen offset:1152 nt
  v_smfmac_f32_16x16x64_bf16 v[124:127], a[240:243], v[76:83], v10
  ds_read_b128 v[136:139], v0 offset:8192
  v_cndmask_b32 v7, v7, v52, s[62:63]
  v_mfma_f32_16x16x32_bf16 v[128:131], v[56:59], v[80:83], 0
  ds_read_b128 v[140:143], v1 offset:8192
  v_cndmask_b32 v8, v8, v53, s[62:63]
  v_mfma_f32_16x16x32_bf16 v[128:131], v[108:111], v[76:79], v[128:131]
  s_mov_b64 s[62:63], 0
  ds_read_b128 v[152:155], v0 offset:16384
  v_mfma_f32_16x16x32_bf16 v[120:123], v[112:115], v[76:79], 0
  ds_read_b128 v[144:147], v1 offset:16384
  v_mfma_f32_16x16x32_bf16 v[120:123], v[60:63], v[80:83], v[120:123]
  v_rcp_f32 v166, v164
  v_mfma_f32_16x16x32_bf16 v[96:99], v[64:67], v[80:83], 0
  v_mul_f32 v168, v166, v168
  v_mul_f32 v169, v166, v169
  v_mfma_f32_16x16x32_bf16 v[96:99], v[116:119], v[76:79], v[96:99]
  v_mul_f32 v170, v166, v170
  v_mul_f32 v171, v166, v171
  v_smfmac_f32_16x16x64_bf16 v[92:95], a[240:243], v[100:107], v10
  v_cvt_pk_bf16_f32 v168, v168, v169
  v_cvt_pk_bf16_f32 v169, v170, v171
  v_mfma_f32_16x16x32_bf16 v[88:91], v[56:59], v[104:107], 0
  v_mul_f32 v160, v166, v160
  v_mul_f32 v161, v166, v161
  v_mfma_f32_16x16x32_bf16 v[88:91], v[108:111], v[100:103], v[88:91]
  v_mul_f32 v162, v166, v162
  v_mul_f32 v163, v166, v163
  v_mfma_f32_16x16x32_bf16 v[80:83], v[112:115], v[100:103], 0
  v_cvt_pk_bf16_f32 v160, v160, v161
  v_cvt_pk_bf16_f32 v161, v162, v163
  v_mfma_f32_16x16x32_bf16 v[80:83], v[60:63], v[104:107], v[80:83]
  v_mul_f32 v68, v166, v68
  v_mul_f32 v69, v166, v69
  v_mfma_f32_16x16x32_bf16 v[84:87], v[64:67], v[104:107], 0
  v_mul_f32 v70, v166, v70
  v_mul_f32 v71, v166, v71
  v_mfma_f32_16x16x32_bf16 v[84:87], v[116:119], v[100:103], v[84:87]
  s_waitcnt lgkmcnt(0)
  v_cvt_pk_bf16_f32 v68, v68, v69
  v_cvt_pk_bf16_f32 v69, v70, v71
  v_mfma_f32_16x16x32_bf16 v[64:67], a[0:3], a[244:247], 0
  v_max3_f32 v9, v164, v166, v9
  v_add_f32 v124, v124, v125
  v_mfma_f32_16x16x32_bf16 v[64:67], a[12:15], a[248:251], v[64:67]
  ds_write_b32 v5, v168 offset:0
  v_mfma_f32_16x16x32_bf16 v[64:67], a[24:27], v[136:139], v[64:67]
  v_rcp_f32 v74, v72
  v_mfma_f32_16x16x32_bf16 v[64:67], a[36:39], v[140:143], v[64:67]
  ds_write_b32 v5, v169 offset:1024
  v_mfma_f32_16x16x32_bf16 v[64:67], a[48:51], v[152:155], v[64:67]
  s_add_u32 m0, s30, 0
  v_mul_f32 v156, v74, v156
  v_mul_f32 v157, v74, v157
  v_mfma_f32_16x16x32_bf16 v[64:67], a[60:63], v[144:147], v[64:67]
  buffer_load_dwordx4 v6, s[8:11], s31 offen offset:0 nt lds
  v_mfma_f32_16x16x32_bf16 v[60:63], a[64:67], v[144:147], 0
  v_mul_f32 v158, v74, v158
  v_mul_f32 v159, v74, v159
  v_mfma_f32_16x16x32_bf16 v[60:63], a[52:55], v[152:155], v[60:63]
  ds_write_b32 v5, v160 offset:2048
  v_mfma_f32_16x16x32_bf16 v[60:63], a[40:43], v[140:143], v[60:63]
  v_mul_f32 v64, s42, v64
  v_mul_f32 v65, s42, v65
  v_mfma_f32_16x16x32_bf16 v[60:63], a[28:31], v[136:139], v[60:63]
  v_mul_f32 v66, s42, v66
  v_mul_f32 v67, s42, v67
  v_mfma_f32_16x16x32_bf16 v[60:63], a[16:19], a[248:251], v[60:63]
  v_cvt_pk_bf16_f32 v12, v64, v65
  v_cvt_pk_bf16_f32 v13, v66, v67
  v_mfma_f32_16x16x32_bf16 v[60:63], a[4:7], a[244:247], v[60:63]
  ds_write_b32 v5, v161 offset:3072
  v_mfma_f32_16x16x32_bf16 v[56:59], a[8:11], a[244:247], 0
  v_cvt_pk_bf16_f32 v156, v156, v157
  v_cvt_pk_bf16_f32 v157, v158, v159
  v_mfma_f32_16x16x32_bf16 v[56:59], a[20:23], a[248:251], v[56:59]
  ds_write_b32 v5, v68 offset:4096
  v_mfma_f32_16x16x32_bf16 v[56:59], a[32:35], v[136:139], v[56:59]
  v_mul_f32 v60, s42, v60
  v_mul_f32 v61, s42, v61
  v_mfma_f32_16x16x32_bf16 v[56:59], a[44:47], v[140:143], v[56:59]
  v_mul_f32 v62, s42, v62
  v_mul_f32 v63, s42, v63
  v_mfma_f32_16x16x32_bf16 v[56:59], a[56:59], v[152:155], v[56:59]
  v_cvt_pk_bf16_f32 v76, v60, v61
  v_cvt_pk_bf16_f32 v77, v62, v63
  v_mfma_f32_16x16x32_bf16 v[56:59], a[68:71], v[144:147], v[56:59]
  ds_write_b32 v5, v69 offset:5120
  v_mfma_f32_16x16x32_bf16 v[64:67], a[132:135], v[144:147], 0
  v_mul_f32 v148, v74, v148
  v_mul_f32 v149, v74, v149
  v_mfma_f32_16x16x32_bf16 v[64:67], a[120:123], v[152:155], v[64:67]
  v_mul_f32 v150, v74, v150
  v_mul_f32 v151, v74, v151
  v_mfma_f32_16x16x32_bf16 v[64:67], a[108:111], v[140:143], v[64:67]
  v_mul_f32 v56, s42, v56
  v_mul_f32 v57, s42, v57
  v_mfma_f32_16x16x32_bf16 v[64:67], a[96:99], v[136:139], v[64:67]
  v_mul_f32 v58, s42, v58
  v_mul_f32 v59, s42, v59
  v_mfma_f32_16x16x32_bf16 v[64:67], a[84:87], a[248:251], v[64:67]
  s_add_u32 m0, s30, 8064
  v_cvt_pk_bf16_f32 v78, v56, v57
  v_cvt_pk_bf16_f32 v79, v58, v59
  v_mfma_f32_16x16x32_bf16 v[64:67], a[72:75], a[244:247], v[64:67]
  buffer_load_dwordx4 v6, s[8:11], s31 offen offset:128 nt lds
  v_mfma_f32_16x16x32_bf16 v[60:63], a[76:79], a[244:247], 0
  v_cvt_pk_bf16_f32 v148, v148, v149
  v_cvt_pk_bf16_f32 v149, v150, v151
  v_mfma_f32_16x16x32_bf16 v[60:63], a[88:91], a[248:251], v[60:63]
  v_mul_f32 v132, v74, v132
  v_mul_f32 v133, v74, v133
  v_mfma_f32_16x16x32_bf16 v[60:63], a[100:103], v[136:139], v[60:63]
  v_cvt_pk_bf16_f32 v68, v64, v65
  v_cvt_pk_bf16_f32 v69, v66, v67
  v_mfma_f32_16x16x32_bf16 v[60:63], a[112:115], v[140:143], v[60:63]
  v_mul_f32 v134, v74, v134
  v_mul_f32 v135, v74, v135
  v_mfma_f32_16x16x32_bf16 v[60:63], a[124:127], v[152:155], v[60:63]
  v_cvt_pk_bf16_f32 v132, v132, v133
  v_cvt_pk_bf16_f32 v133, v134, v135
  v_mfma_f32_16x16x32_bf16 v[60:63], a[136:139], v[144:147], v[60:63]
  v_max3_f32 v9, v72, v74, v9
  v_add_f32 v92, v92, v93
  v_mfma_f32_16x16x32_bf16 v[56:59], a[140:143], v[144:147], 0
  ds_write_b32 v5, v156 offset:256
  v_mfma_f32_16x16x32_bf16 v[56:59], a[128:131], v[152:155], v[56:59]
  v_rcp_f32 v126, v124
  v_mfma_f32_16x16x32_bf16 v[56:59], a[116:119], v[140:143], v[56:59]
  v_cvt_pk_bf16_f32 v70, v60, v61
  v_cvt_pk_bf16_f32 v71, v62, v63
  v_mfma_f32_16x16x32_bf16 v[56:59], a[104:107], v[136:139], v[56:59]
  ds_write_b32 v5, v157 offset:1280
  v_mfma_f32_16x16x32_bf16 v[56:59], a[92:95], a[248:251], v[56:59]
  v_mul_f32 v128, v126, v128
  v_mul_f32 v129, v126, v129
  v_mfma_f32_16x16x32_bf16 v[56:59], a[80:83], a[244:247], v[56:59]
  ds_write_b32 v5, v148 offset:2304
  v_mfma_f32_16x16x32_bf16 v[60:63], a[244:247], a[144:147], 0
  v_mul_f32 v130, v126, v130
  v_mul_f32 v131, v126, v131
  v_mfma_f32_16x16x32_bf16 v[60:63], a[248:251], a[156:159], v[60:63]
  ds_read_b128 a[252:255], v0 offset:2048
  v_cvt_pk_bf16_f32 v128, v128, v129
  v_mfma_f32_16x16x32_bf16 v[60:63], v[136:139], a[168:171], v[60:63]
  v_cvt_pk_bf16_f32 v72, v56, v57
  v_cvt_pk_bf16_f32 v73, v58, v59
  v_mfma_f32_16x16x32_bf16 v[60:63], v[140:143], a[180:183], v[60:63]
  ds_read_b128 v[104:107], v1 offset:2048
  v_cvt_pk_bf16_f32 v129, v130, v131
  v_mfma_f32_16x16x32_bf16 v[60:63], v[152:155], a[192:195], v[60:63]
  s_add_u32 m0, s30, 16128
  ds_read_b128 v[108:111], v0 offset:10240
  v_mul_f32 v120, v126, v120
  v_mfma_f32_16x16x32_bf16 v[60:63], v[144:147], a[204:207], v[60:63]
  buffer_load_dwordx4 v6, s[8:11], s31 offen offset:256 nt lds
  v_mfma_f32_16x16x32_bf16 v[64:67], v[144:147], a[208:211], 0
  ds_read_b128 v[116:119], v1 offset:10240
  v_mul_f32 v121, v126, v121
  v_mfma_f32_16x16x32_bf16 v[64:67], v[152:155], a[196:199], v[64:67]
  ds_read_b128 v[112:115], v0 offset:18432
  v_mul_f32 v122, v126, v122
  v_mfma_f32_16x16x32_bf16 v[64:67], v[140:143], a[184:187], v[64:67]
  v_cvt_pk_bf16_f32 v56, v60, v61
  v_cvt_pk_bf16_f32 v57, v62, v63
  v_mfma_f32_16x16x32_bf16 v[64:67], v[136:139], a[172:175], v[64:67]
  ds_write_b32 v5, v149 offset:3328
  v_mfma_f32_16x16x32_bf16 v[64:67], a[248:251], a[160:163], v[64:67]
  v_mul_f32 v123, v126, v123
  v_cvt_pk_bf16_f32 v120, v120, v121
  v_mfma_f32_16x16x32_bf16 v[64:67], a[244:247], a[148:151], v[64:67]
  ds_write_b32 v5, v132 offset:4352
  v_mfma_f32_16x16x32_bf16 v[100:103], a[244:247], a[152:155], 0
  ds_write_b32 v5, v133 offset:5376
  v_mfma_f32_16x16x32_bf16 v[100:103], a[248:251], a[164:167], v[100:103]
  v_cvt_pk_bf16_f32 v121, v122, v123
  v_mul_f32 v96, v126, v96
  v_mfma_f32_16x16x32_bf16 v[100:103], v[136:139], a[176:179], v[100:103]
  ds_read_b128 a[244:247], v1 offset:18432
  v_cvt_pk_bf16_f32 v60, v64, v65
  v_mfma_f32_16x16x32_bf16 v[100:103], v[140:143], a[188:191], v[100:103]
  v_cvt_pk_bf16_f32 v61, v66, v67
  v_mul_f32 v97, v126, v97
  v_mfma_f32_16x16x32_bf16 v[100:103], v[152:155], a[200:203], v[100:103]
  v_mul_f32 v98, v126, v98
  v_mul_f32 v99, v126, v99
  v_mfma_f32_16x16x32_bf16 v[100:103], v[144:147], a[212:215], v[100:103]
  s_waitcnt lgkmcnt(4)
  v_cvt_pk_bf16_f32 v96, v96, v97
  v_cvt_pk_bf16_f32 v97, v98, v99
  v_mfma_f32_16x16x32_bf16 v[132:135], a[0:3], a[252:255], 0
  v_max3_f32 v9, v124, v126, v9
  v_mfma_f32_16x16x32_bf16 v[132:135], a[12:15], v[104:107], v[132:135]
  ds_write_b32 v5, v128 offset:512
  v_mfma_f32_16x16x32_bf16 v[132:135], a[24:27], v[108:111], v[132:135]
  v_cvt_pk_bf16_f32 v64, v100, v101
  v_cvt_pk_bf16_f32 v65, v102, v103
  v_mfma_f32_16x16x32_bf16 v[132:135], a[36:39], v[116:119], v[132:135]
  s_waitcnt lgkmcnt(1)
  ds_write_b32 v5, v129 offset:1536
  v_mfma_f32_16x16x32_bf16 v[132:135], a[48:51], v[112:115], v[132:135]
  s_add_u32 m0, s30, 4096
  v_rcp_f32 v94, v92
  v_mfma_f32_16x16x32_bf16 v[132:135], a[60:63], a[244:247], v[132:135]
  buffer_load_dwordx4 v6, s[8:11], s32 offen offset:0 nt lds
  v_mfma_f32_16x16x32_bf16 v[124:127], a[64:67], a[244:247], 0
  s_add_u32 s33, s31, s37
  v_mul_f32 v88, v94, v88
  v_mul_f32 v89, v94, v89
  v_mfma_f32_16x16x32_bf16 v[124:127], a[52:55], v[112:115], v[124:127]
  s_add_u32 s34, s31, s38
  ds_write_b32 v5, v120 offset:2560
  v_mfma_f32_16x16x32_bf16 v[124:127], a[40:43], v[116:119], v[124:127]
  s_add_u32 s35, s31, s39
  v_mul_f32 v132, s42, v132
  v_mul_f32 v133, s42, v133
  v_mfma_f32_16x16x32_bf16 v[124:127], a[28:31], v[108:111], v[124:127]
  s_add_u32 s36, s31, s40
  v_mul_f32 v134, s42, v134
  v_mul_f32 v135, s42, v135
  v_mfma_f32_16x16x32_bf16 v[124:127], a[16:19], v[104:107], v[124:127]
  s_add_u32 s31, s31, s43
  v_cvt_pk_bf16_f32 v100, v132, v133
  v_cvt_pk_bf16_f32 v101, v134, v135
  v_mfma_f32_16x16x32_bf16 v[124:127], a[4:7], a[252:255], v[124:127]
  s_mov_b32 s5, s28
  ds_write_b32 v5, v121 offset:3584
  v_mfma_f32_16x16x32_bf16 v[128:131], a[8:11], a[252:255], 0
  s_mov_b32 s28, s29
  v_mul_f32 v90, v94, v90
  v_mul_f32 v91, v94, v91
  v_mfma_f32_16x16x32_bf16 v[128:131], a[20:23], v[104:107], v[128:131]
  s_mov_b32 s29, s30
  ds_write_b32 v5, v96 offset:4608
  v_mfma_f32_16x16x32_bf16 v[128:131], a[32:35], v[108:111], v[128:131]
  v_mul_f32 v124, s42, v124
  v_mul_f32 v125, s42, v125
  v_mfma_f32_16x16x32_bf16 v[128:131], a[44:47], v[116:119], v[128:131]
  v_mul_f32 v126, s42, v126
  v_mul_f32 v127, s42, v127
  v_mfma_f32_16x16x32_bf16 v[128:131], a[56:59], v[112:115], v[128:131]
  v_cvt_pk_bf16_f32 v102, v124, v125
  v_cvt_pk_bf16_f32 v103, v126, v127
  v_mfma_f32_16x16x32_bf16 v[128:131], a[68:71], a[244:247], v[128:131]
  ds_write_b32 v5, v97 offset:5632
  v_mfma_f32_16x16x32_bf16 v[132:135], a[132:135], a[244:247], 0
  v_cvt_pk_bf16_f32 v88, v88, v89
  v_cvt_pk_bf16_f32 v89, v90, v91
  v_mfma_f32_16x16x32_bf16 v[132:135], a[120:123], v[112:115], v[132:135]
  v_mul_f32 v80, v94, v80
  v_mul_f32 v81, v94, v81
  v_mfma_f32_16x16x32_bf16 v[132:135], a[108:111], v[116:119], v[132:135]
  v_mul_f32 v128, s42, v128
  v_mul_f32 v129, s42, v129
  v_mfma_f32_16x16x32_bf16 v[132:135], a[96:99], v[108:111], v[132:135]
  v_mul_f32 v130, s42, v130
  v_mul_f32 v131, s42, v131
  v_mfma_f32_16x16x32_bf16 v[132:135], a[84:87], v[104:107], v[132:135]
  s_add_u32 m0, s30, 12160
  v_cvt_pk_bf16_f32 v16, v128, v129
  v_cvt_pk_bf16_f32 v17, v130, v131
  v_mfma_f32_16x16x32_bf16 v[132:135], a[72:75], a[252:255], v[132:135]
  buffer_load_dwordx4 v6, s[8:11], s32 offen offset:128 nt lds
  v_mfma_f32_16x16x32_bf16 v[96:99], a[76:79], a[252:255], 0
  v_mul_f32 v82, v94, v82
  v_mul_f32 v83, v94, v83
  v_mfma_f32_16x16x32_bf16 v[96:99], a[88:91], v[104:107], v[96:99]
  v_cvt_pk_bf16_f32 v80, v80, v81
  v_cvt_pk_bf16_f32 v81, v82, v83
  v_mfma_f32_16x16x32_bf16 v[96:99], a[100:103], v[108:111], v[96:99]
  v_cvt_pk_bf16_f32 v120, v132, v133
  v_cvt_pk_bf16_f32 v121, v134, v135
  v_mfma_f32_16x16x32_bf16 v[96:99], a[112:115], v[116:119], v[96:99]
  v_mul_f32 v84, v94, v84
  v_mul_f32 v85, v94, v85
  v_mfma_f32_16x16x32_bf16 v[96:99], a[124:127], v[112:115], v[96:99]
  v_mul_f32 v86, v94, v86
  v_mul_f32 v87, v94, v87
  v_mfma_f32_16x16x32_bf16 v[96:99], a[136:139], a[244:247], v[96:99]
  v_cvt_pk_bf16_f32 v84, v84, v85
  v_cvt_pk_bf16_f32 v85, v86, v87
  v_mfma_f32_16x16x32_bf16 v[132:135], a[140:143], a[244:247], 0
  v_max3_f32 v9, v92, v94, v9
  v_mfma_f32_16x16x32_bf16 v[132:135], a[128:131], v[112:115], v[132:135]
  ds_write_b32 v5, v88 offset:768
  v_mfma_f32_16x16x32_bf16 v[132:135], a[116:119], v[116:119], v[132:135]
  v_cvt_pk_bf16_f32 v122, v96, v97
  v_cvt_pk_bf16_f32 v123, v98, v99
  v_mfma_f32_16x16x32_bf16 v[132:135], a[104:107], v[108:111], v[132:135]
  ds_write_b32 v5, v89 offset:1792
  v_mfma_f32_16x16x32_bf16 v[132:135], a[92:95], v[104:107], v[132:135]
  v_mfma_f32_16x16x32_bf16 v[132:135], a[80:83], a[252:255], v[132:135]
  ds_write_b32 v5, v80 offset:2816
  v_mfma_f32_16x16x32_bf16 v[128:131], a[252:255], a[144:147], 0
  v_mfma_f32_16x16x32_bf16 v[128:131], v[104:107], a[156:159], v[128:131]
  ds_read_b128 v[88:91], v0 offset:4096
  v_mfma_f32_16x16x32_bf16 v[128:131], v[108:111], a[168:171], v[128:131]
  v_cvt_pk_bf16_f32 v124, v132, v133
  v_cvt_pk_bf16_f32 v125, v134, v135
  v_mfma_f32_16x16x32_bf16 v[128:131], v[116:119], a[180:183], v[128:131]
  ds_read_b128 v[92:95], v1 offset:4096
  v_mfma_f32_16x16x32_bf16 v[128:131], v[112:115], a[192:195], v[128:131]
  s_add_u32 m0, s30, 20224
  ds_read_b128 v[96:99], v0 offset:12288
  v_mfma_f32_16x16x32_bf16 v[128:131], a[244:247], a[204:207], v[128:131]
  buffer_load_dwordx4 v6, s[8:11], s32 offen offset:256 nt lds
  v_mfma_f32_16x16x32_bf16 v[132:135], a[244:247], a[208:211], 0
  s_add_u32 s32, s32, s43
  ds_read_b128 v[136:139], v1 offset:12288
  v_mfma_f32_16x16x32_bf16 v[132:135], v[112:115], a[196:199], v[132:135]
  s_mov_b32 s30, s5
  ds_read_b128 v[140:143], v0 offset:20480
  v_mfma_f32_16x16x32_bf16 v[132:135], v[116:119], a[184:187], v[132:135]
  v_cvt_pk_bf16_f32 v58, v128, v129
  v_cvt_pk_bf16_f32 v59, v130, v131
  v_mfma_f32_16x16x32_bf16 v[132:135], v[108:111], a[172:175], v[132:135]
  ds_write_b32 v5, v81 offset:3840
  v_mfma_f32_16x16x32_bf16 v[132:135], v[104:107], a[160:163], v[132:135]
  v_mfma_f32_16x16x32_bf16 v[132:135], a[252:255], a[148:151], v[132:135]
  ds_write_b32 v5, v84 offset:4864
  v_mfma_f32_16x16x32_bf16 v[128:131], a[252:255], a[152:155], 0
  v_mfma_f32_16x16x32_bf16 v[128:131], v[104:107], a[164:167], v[128:131]
  ds_write_b32 v5, v85 offset:5888
  v_mfma_f32_16x16x32_bf16 v[128:131], v[108:111], a[176:179], v[128:131]
  v_cvt_pk_bf16_f32 v62, v132, v133
  v_cvt_pk_bf16_f32 v63, v134, v135
  v_mfma_f32_16x16x32_bf16 v[128:131], v[116:119], a[188:191], v[128:131]
  s_waitcnt lgkmcnt(3)
  ds_read_b128 v[80:83], v1 offset:20480
  v_xor_b32 v5, s41, v5
  v_mfma_f32_16x16x32_bf16 v[128:131], v[112:115], a[200:203], v[128:131]
  s_bitcmp1_b32 s96, s59
  v_mfma_f32_16x16x32_bf16 v[128:131], a[244:247], a[212:215], v[128:131]
  s_cbranch_scc0 L_loop
L_epi:
  s_cmp_lg_u32 s59, s97
  s_cbranch_scc1 L_k2
L_full:
  v_mfma_f32_16x16x32_bf16 v[104:107], a[76:79], v[88:91], 0
  s_lshl_b32 s5, s3, 3
  v_mfma_f32_16x16x32_bf16 v[104:107], a[88:91], v[92:95], v[104:107]
  s_add_u32 s5, s5, 159744
  v_mov_b32 v11, s5
  v_mfma_f32_16x16x32_bf16 v[104:107], a[100:103], v[96:99], v[104:107]
  v_cvt_pk_bf16_f32 v66, v128, v129
  v_cvt_pk_bf16_f32 v67, v130, v131
  v_mfma_f32_16x16x32_bf16 v[104:107], a[112:115], v[136:139], v[104:107]
  ds_read_b128 v[160:163], v1 offset:22528
  v_mfma_f32_16x16x32_bf16 v[104:107], a[124:127], v[140:143], v[104:107]
  ds_read_b128 v[164:167], v0 offset:22528
  s_waitcnt lgkmcnt(2)
  v_mfma_f32_16x16x32_bf16 v[104:107], a[136:139], v[80:83], v[104:107]
  ds_read_b128 a[244:247], v1 offset:14336
  v_mfma_f32_16x16x32_bf16 v[108:111], a[132:135], v[80:83], 0
  ds_read_b128 a[252:255], v0 offset:14336
  v_mfma_f32_16x16x32_bf16 v[108:111], a[120:123], v[140:143], v[108:111]
  ds_read_b128 a[248:251], v1 offset:6144
  v_mfma_f32_16x16x32_bf16 v[108:111], a[108:111], v[136:139], v[108:111]
  v_cvt_pk_bf16_f32 v146, v104, v105
  v_cvt_pk_bf16_f32 v147, v106, v107
  v_mfma_f32_16x16x32_bf16 v[108:111], a[96:99], v[96:99], v[108:111]
  ds_read_b128 v[84:87], v0 offset:6144
  v_mfma_f32_16x16x32_bf16 v[108:111], a[84:87], v[92:95], v[108:111]
  v_mfma_f32_16x16x32_bf16 v[108:111], a[72:75], v[88:91], v[108:111]
  v_mfma_f32_16x16x32_bf16 v[112:115], a[140:143], v[80:83], 0
  v_mfma_f32_16x16x32_bf16 v[112:115], a[128:131], v[140:143], v[112:115]
  v_mfma_f32_16x16x32_bf16 v[112:115], a[116:119], v[136:139], v[112:115]
  v_cvt_pk_bf16_f32 v144, v108, v109
  v_cvt_pk_bf16_f32 v145, v110, v111
  v_mfma_f32_16x16x32_bf16 v[112:115], a[104:107], v[96:99], v[112:115]
L_hop_1_1:
  s_cbranch_execz L_hop_1_2
  v_mfma_f32_16x16x32_bf16 v[112:115], a[92:95], v[92:95], v[112:115]
  v_mfma_f32_16x16x32_bf16 v[112:115], a[80:83], v[88:91], v[112:115]
  s_waitcnt lgkmcnt(0)
  v_mfma_f32_16x16x32_bf16 v[104:107], a[132:135], v[160:163], 0
  v_mfma_f32_16x16x32_bf16 v[104:107], a[120:123], v[164:167], v[104:107]
  v_mfma_f32_16x16x32_bf16 v[104:107], a[108:111], a[244:247], v[104:107]
  v_cvt_pk_bf16_f32 v148, v112, v113
  v_cvt_pk_bf16_f32 v149, v114, v115
  v_mfma_f32_16x16x32_bf16 v[104:107], a[96:99], a[252:255], v[104:107]
  v_mfma_f32_16x16x32_bf16 v[104:107], a[84:87], a[248:251], v[104:107]
  s_waitcnt lgkmcnt(0)
  s_barrier
  v_mfma_f32_16x16x32_bf16 v[104:107], a[72:75], v[84:87], v[104:107]
  v_mfma_f32_16x16x32_bf16 v[108:111], a[76:79], v[84:87], 0
  v_mfma_f32_16x16x32_bf16 v[108:111], a[88:91], a[248:251], v[108:111]
  v_mfma_f32_16x16x32_bf16 v[108:111], a[100:103], a[252:255], v[108:111]
  v_cvt_pk_bf16_f32 v150, v104, v105
  v_cvt_pk_bf16_f32 v151, v106, v107
  v_mfma_f32_16x16x32_bf16 v[108:111], a[112:115], a[244:247], v[108:111]
  v_mfma_f32_16x16x32_bf16 v[108:111], a[124:127], v[164:167], v[108:111]
  v_mfma_f32_16x16x32_bf16 v[108:111], a[136:139], v[160:163], v[108:111]
  v_mfma_f32_16x16x32_bf16 v[104:107], a[140:143], v[160:163], 0
  v_mfma_f32_16x16x32_bf16 v[104:107], a[128:131], v[164:167], v[104:107]
  v_mfma_f32_16x16x32_bf16 v[104:107], a[116:119], a[244:247], v[104:107]
  v_cvt_pk_bf16_f32 v152, v108, v109
  v_cvt_pk_bf16_f32 v153, v110, v111
  v_mfma_f32_16x16x32_bf16 v[104:107], a[104:107], a[252:255], v[104:107]
  v_mfma_f32_16x16x32_bf16 v[104:107], a[92:95], a[248:251], v[104:107]
  v_mfma_f32_16x16x32_bf16 v[104:107], a[80:83], v[84:87], v[104:107]
  v_mfma_f32_16x16x32_bf16 v[112:115], v[70:73], v[76:79], v[36:39]
  v_mfma_f32_16x16x32_bf16 v[112:115], v[68:71], v[12:15], v[112:115]
  v_mfma_f32_16x16x32_bf16 v[116:119], v[122:125], v[76:79], v[32:35]
  v_cvt_pk_bf16_f32 v154, v104, v105
  v_cvt_pk_bf16_f32 v155, v106, v107
  v_mfma_f32_16x16x32_bf16 v[116:119], v[120:123], v[12:15], v[116:119]
  v_mfma_f32_16x16x32_bf16 v[128:131], v[146:149], v[76:79], v[28:31]
  v_exp_f32 v112, v112
  v_mfma_f32_16x16x32_bf16 v[128:131], v[144:147], v[12:15], v[128:131]
  v_exp_f32 v113, v113
  v_mfma_f32_16x16x32_bf16 v[132:135], v[152:155], v[76:79], v[24:27]
  v_exp_f32 v114, v114
  v_mfma_f32_16x16x32_bf16 v[132:135], v[150:153], v[12:15], v[132:135]
  v_exp_f32 v115, v115
  v_mfma_f32_16x16x32_bf16 v[104:107], v[68:71], v[100:103], v[40:43]
  v_exp_f32 v116, v116
  v_mfma_f32_16x16x32_bf16 v[104:107], v[70:73], v[14:17], v[104:107]
  v_exp_f32 v117, v117
  v_mfma_f32_16x16x32_bf16 v[108:111], v[120:123], v[100:103], v[36:39]
  v_exp_f32 v118, v118
  v_mfma_f32_16x16x32_bf16 v[108:111], v[122:125], v[14:17], v[108:111]
  v_exp_f32 v119, v119
  v_mfma_f32_16x16x32_bf16 v[74:77], v[144:147], v[100:103], v[32:35]
  v_exp_f32 v128, v128
  v_mfma_f32_16x16x32_bf16 v[74:77], v[146:149], v[14:17], v[74:77]
  v_exp_f32 v129, v129
  v_mfma_f32_16x16x32_bf16 v[168:171], v[150:153], v[100:103], v[28:31]
  v_exp_f32 v130, v130
  v_mfma_f32_16x16x32_bf16 v[168:171], v[152:155], v[14:17], v[168:171]
  v_exp_f32 v131, v131
  v_mfma_f32_16x16x32_bf16 v[100:103], a[0:3], v[88:91], 0
  v_exp_f32 v132, v132
  v_mfma_f32_16x16x32_bf16 v[100:103], a[12:15], v[92:95], v[100:103]
  v_exp_f32 v133, v133
  v_mfma_f32_16x16x32_bf16 v[100:103], a[24:27], v[96:99], v[100:103]
  v_exp_f32 v134, v134
  v_mfma_f32_16x16x32_bf16 v[100:103], a[36:39], v[136:139], v[100:103]
  v_exp_f32 v135, v135
  v_mfma_f32_16x16x32_bf16 v[100:103], a[48:51], v[140:143], v[100:103]
  v_cvt_pk_bf16_f32 v112, v112, v113
  v_cvt_pk_bf16_f32 v113, v114, v115
  v_mfma_f32_16x16x32_bf16 v[100:103], a[60:63], v[80:83], v[100:103]
  v_cvt_pk_bf16_f32 v114, v116, v117
  v_cvt_pk_bf16_f32 v115, v118, v119
  v_mfma_f32_16x16x32_bf16 v[172:175], a[64:67], v[80:83], 0
  v_cvt_pk_bf16_f32 v116, v128, v129
  v_cvt_pk_bf16_f32 v117, v130, v131
  v_mfma_f32_16x16x32_bf16 v[172:175], a[52:55], v[140:143], v[172:175]
  v_cvt_pk_bf16_f32 v118, v132, v133
  v_cvt_pk_bf16_f32 v119, v134, v135
  v_mfma_f32_16x16x32_bf16 v[172:175], a[40:43], v[136:139], v[172:175]
  v_mul_f32 v100, s42, v100
  v_mul_f32 v101, s42, v101
  v_mfma_f32_16x16x32_bf16 v[172:175], a[28:31], v[96:99], v[172:175]
  v_mul_f32 v102, s42, v102
  v_mul_f32 v103, s42, v103
  v_mfma_f32_16x16x32_bf16 v[172:175], a[16:19], v[92:95], v[172:175]
  v_cvt_pk_bf16_f32 v18, v100, v101
  v_cvt_pk_bf16_f32 v19, v102, v103
  v_mfma_f32_16x16x32_bf16 v[172:175], a[4:7], v[88:91], v[172:175]
  v_exp_f32 v104, v104
  v_mfma_f32_16x16x32_bf16 v[128:131], a[8:11], v[88:91], 0
  v_exp_f32 v105, v105
  v_mfma_f32_16x16x32_bf16 v[128:131], a[20:23], v[92:95], v[128:131]
  v_exp_f32 v106, v106
  v_mfma_f32_16x16x32_bf16 v[128:131], a[32:35], v[96:99], v[128:131]
  v_mul_f32 v172, s42, v172
  v_mul_f32 v173, s42, v173
  v_mfma_f32_16x16x32_bf16 v[128:131], a[44:47], v[136:139], v[128:131]
  v_mul_f32 v174, s42, v174
  v_mul_f32 v175, s42, v175
  v_mfma_f32_16x16x32_bf16 v[128:131], a[56:59], v[140:143], v[128:131]
  v_cvt_pk_bf16_f32 v176, v172, v173
  v_cvt_pk_bf16_f32 v177, v174, v175
  v_mfma_f32_16x16x32_bf16 v[128:131], a[68:71], v[80:83], v[128:131]
  v_exp_f32 v107, v107
  v_mfma_f32_16x16x32_bf16 v[132:135], a[0:3], v[84:87], 0
  v_exp_f32 v108, v108
  v_mfma_f32_16x16x32_bf16 v[132:135], a[12:15], a[248:251], v[132:135]
  v_exp_f32 v109, v109
  v_mfma_f32_16x16x32_bf16 v[132:135], a[24:27], a[252:255], v[132:135]
  v_mul_f32 v128, s42, v128
  v_mul_f32 v129, s42, v129
  v_mfma_f32_16x16x32_bf16 v[132:135], a[36:39], a[244:247], v[132:135]
  v_mul_f32 v130, s42, v130
  v_mul_f32 v131, s42, v131
  v_mfma_f32_16x16x32_bf16 v[132:135], a[48:51], v[164:167], v[132:135]
  v_cvt_pk_bf16_f32 v178, v128, v129
  v_cvt_pk_bf16_f32 v179, v130, v131
  v_mfma_f32_16x16x32_bf16 v[132:135], a[60:63], v[160:163], v[132:135]
  v_exp_f32 v110, v110
  v_mfma_f32_16x16x32_bf16 v[172:175], a[64:67], v[160:163], 0
  v_exp_f32 v111, v111
  v_mfma_f32_16x16x32_bf16 v[172:175], a[52:55], v[164:167], v[172:175]
  v_exp_f32 v74, v74
  v_mfma_f32_16x16x32_bf16 v[172:175], a[40:43], a[244:247], v[172:175]
  v_mul_f32 v132, s42, v132
  v_mul_f32 v133, s42, v133
  v_mfma_f32_16x16x32_bf16 v[172:175], a[28:31], a[252:255], v[172:175]
  v_mul_f32 v134, s42, v134
  v_mul_f32 v135, s42, v135
  v_mfma_f32_16x16x32_bf16 v[172:175], a[16:19], a[248:251], v[172:175]
  v_cvt_pk_bf16_f32 v180, v132, v133
  v_cvt_pk_bf16_f32 v181, v134, v135
  v_mfma_f32_16x16x32_bf16 v[172:175], a[4:7], v[84:87], v[172:175]
  v_exp_f32 v75, v75
  v_mfma_f32_16x16x32_bf16 v[100:103], a[8:11], v[84:87], 0
  v_exp_f32 v76, v76
  v_mfma_f32_16x16x32_bf16 v[100:103], a[20:23], a[248:251], v[100:103]
  v_exp_f32 v77, v77
  v_mfma_f32_16x16x32_bf16 v[100:103], a[32:35], a[252:255], v[100:103]
  v_mul_f32 v172, s42, v172
  v_mul_f32 v173, s42, v173
  v_mfma_f32_16x16x32_bf16 v[100:103], a[44:47], a[244:247], v[100:103]
  v_mul_f32 v174, s42, v174
  v_mul_f32 v175, s42, v175
  v_mfma_f32_16x16x32_bf16 v[100:103], a[56:59], v[164:167], v[100:103]
  v_cvt_pk_bf16_f32 v182, v172, v173
  v_cvt_pk_bf16_f32 v183, v174, v175
  v_mfma_f32_16x16x32_bf16 v[100:103], a[68:71], v[160:163], v[100:103]
  v_exp_f32 v168, v168
  v_mfma_f32_16x16x32_bf16 v[128:131], v[146:149], v[176:179], v[36:39]
  v_exp_f32 v169, v169
  v_mfma_f32_16x16x32_bf16 v[128:131], v[144:147], v[18:21], v[128:131]
  v_exp_f32 v170, v170
  v_mfma_f32_16x16x32_bf16 v[132:135], v[152:155], v[176:179], v[32:35]
  v_mul_f32 v100, s42, v100
  v_mul_f32 v101, s42, v101
  v_mfma_f32_16x16x32_bf16 v[132:135], v[150:153], v[18:21], v[132:135]
  v_mul_f32 v102, s42, v102
  v_mul_f32 v103, s42, v103
  v_mfma_f32_16x16x32_bf16 v[156:159], v[70:73], v[176:179], v[44:47]
  v_cvt_pk_bf16_f32 v22, v100, v101
  v_cvt_pk_bf16_f32 v23, v102, v103
  v_mfma_f32_16x16x32_bf16 v[156:159], v[68:71], v[18:21], v[156:159]
  v_exp_f32 v171, v171
  v_mfma_f32_16x16x32_bf16 v[172:175], v[122:125], v[176:179], v[40:43]
  v_cvt_pk_bf16_f32 v104, v104, v105
  v_cvt_pk_bf16_f32 v105, v106, v107
  v_mfma_f32_16x16x32_bf16 v[172:175], v[120:123], v[18:21], v[172:175]
  v_cvt_pk_bf16_f32 v106, v108, v109
  v_cvt_pk_bf16_f32 v107, v110, v111
  v_mfma_f32_16x16x32_bf16 v[176:179], v[88:91], a[144:147], 0
  v_cvt_pk_bf16_f32 v108, v74, v75
  v_cvt_pk_bf16_f32 v109, v76, v77
  v_mfma_f32_16x16x32_bf16 v[176:179], v[92:95], a[156:159], v[176:179]
  v_cvt_pk_bf16_f32 v110, v168, v169
  v_cvt_pk_bf16_f32 v111, v170, v171
  v_mfma_f32_16x16x32_bf16 v[176:179], v[96:99], a[168:171], v[176:179]
  v_exp_f32 v128, v128
  v_mfma_f32_16x16x32_bf16 v[176:179], v[136:139], a[180:183], v[176:179]
  v_exp_f32 v129, v129
  v_mfma_f32_16x16x32_bf16 v[176:179], v[140:143], a[192:195], v[176:179]
  v_exp_f32 v130, v130
  v_mfma_f32_16x16x32_bf16 v[176:179], v[80:83], a[204:207], v[176:179]
  v_exp_f32 v131, v131
  v_mfma_f32_16x16x32_bf16 v[76:79], v[80:83], a[208:211], 0
  v_exp_f32 v132, v132
  v_mfma_f32_16x16x32_bf16 v[76:79], v[140:143], a[196:199], v[76:79]
  v_exp_f32 v133, v133
  v_mfma_f32_16x16x32_bf16 v[76:79], v[136:139], a[184:187], v[76:79]
  v_cvt_pk_bf16_f32 v100, v176, v177
  v_cvt_pk_bf16_f32 v101, v178, v179
  v_mfma_f32_16x16x32_bf16 v[76:79], v[96:99], a[172:175], v[76:79]
  v_exp_f32 v134, v134
  v_mfma_f32_16x16x32_bf16 v[76:79], v[92:95], a[160:163], v[76:79]
  v_exp_f32 v135, v135
  v_mfma_f32_16x16x32_bf16 v[76:79], v[88:91], a[148:151], v[76:79]
  v_exp_f32 v156, v156
  v_mfma_f32_16x16x32_bf16 v[168:171], v[88:91], a[152:155], 0
  v_exp_f32 v157, v157
  v_mfma_f32_16x16x32_bf16 v[168:171], v[92:95], a[164:167], v[168:171]
  v_exp_f32 v158, v158
  v_mfma_f32_16x16x32_bf16 v[168:171], v[96:99], a[176:179], v[168:171]
  v_cvt_pk_bf16_f32 v88, v76, v77
  v_cvt_pk_bf16_f32 v89, v78, v79
  v_mfma_f32_16x16x32_bf16 v[168:171], v[136:139], a[188:191], v[168:171]
  v_exp_f32 v159, v159
  v_mfma_f32_16x16x32_bf16 v[168:171], v[140:143], a[200:203], v[168:171]
  v_exp_f32 v172, v172
  v_mfma_f32_16x16x32_bf16 v[168:171], v[80:83], a[212:215], v[168:171]
  v_exp_f32 v173, v173
  v_mfma_f32_16x16x32_bf16 v[76:79], v[144:147], v[180:183], v[40:43]
  v_exp_f32 v174, v174
  v_mfma_f32_16x16x32_bf16 v[76:79], v[146:149], v[20:23], v[76:79]
  v_exp_f32 v175, v175
  v_mfma_f32_16x16x32_bf16 v[80:83], v[150:153], v[180:183], v[36:39]
  v_cvt_pk_bf16_f32 v92, v168, v169
  v_cvt_pk_bf16_f32 v93, v170, v171
  v_mfma_f32_16x16x32_bf16 v[80:83], v[152:155], v[20:23], v[80:83]
  v_cvt_pk_bf16_f32 v128, v128, v129
  v_cvt_pk_bf16_f32 v129, v130, v131
  v_mfma_f32_16x16x32_bf16 v[144:147], v[68:71], v[180:183], v[48:51]
  v_cvt_pk_bf16_f32 v130, v132, v133
  v_cvt_pk_bf16_f32 v131, v134, v135
  v_mfma_f32_16x16x32_bf16 v[144:147], v[70:73], v[20:23], v[144:147]
  v_cvt_pk_bf16_f32 v132, v156, v157
  v_cvt_pk_bf16_f32 v133, v158, v159
  v_mfma_f32_16x16x32_bf16 v[152:155], v[120:123], v[180:183], v[44:47]
  v_cvt_pk_bf16_f32 v134, v172, v173
  v_cvt_pk_bf16_f32 v135, v174, v175
  v_mfma_f32_16x16x32_bf16 v[152:155], v[122:125], v[20:23], v[152:155]
  v_exp_f32 v76, v76
  v_mfma_f32_16x16x32_bf16 v[140:143], v[84:87], a[144:147], 0
  v_exp_f32 v77, v77
  v_mfma_f32_16x16x32_bf16 v[140:143], a[248:251], a[156:159], v[140:143]
  v_exp_f32 v78, v78
  v_mfma_f32_16x16x32_bf16 v[140:143], a[252:255], a[168:171], v[140:143]
  ds_read_b128 v[68:71], v3 offset:0
  v_cvt_pk_bf16_f32 v76, v76, v77
  v_mfma_f32_16x16x32_bf16 v[140:143], a[244:247], a[180:183], v[140:143]
  ds_read_b128 v[72:75], v3 offset:4096
  v_mfma_f32_16x16x32_bf16 v[140:143], v[164:167], a[192:195], v[140:143]
  ds_read_b128 v[96:99], v3 offset:8192
  v_mfma_f32_16x16x32_bf16 v[140:143], v[160:163], a[204:207], v[140:143]
  ds_read_b128 v[120:123], v3 offset:12288
  v_mfma_f32_16x16x32_bf16 v[148:151], v[160:163], a[208:211], 0
  ds_read_b128 v[124:127], v3 offset:16384
  v_mfma_f32_16x16x32_bf16 v[148:151], v[164:167], a[196:199], v[148:151]
  ds_read_b128 v[136:139], v3 offset:20480
  v_mfma_f32_16x16x32_bf16 v[148:151], a[244:247], a[184:187], v[148:151]
  v_cvt_pk_bf16_f32 v102, v140, v141
  v_cvt_pk_bf16_f32 v103, v142, v143
  v_mfma_f32_16x16x32_bf16 v[148:151], a[252:255], a[172:175], v[148:151]
  v_exp_f32 v79, v79
  v_mfma_f32_16x16x32_bf16 v[148:151], a[248:251], a[160:163], v[148:151]
  v_exp_f32 v80, v80
  v_mfma_f32_16x16x32_bf16 v[148:151], v[84:87], a[148:151], v[148:151]
  v_exp_f32 v81, v81
  v_mfma_f32_16x16x32_bf16 v[156:159], v[84:87], a[152:155], 0
  v_exp_f32 v82, v82
  v_mfma_f32_16x16x32_bf16 v[156:159], a[248:251], a[164:167], v[156:159]
  v_exp_f32 v83, v83
  v_mfma_f32_16x16x32_bf16 v[156:159], a[252:255], a[176:179], v[156:159]
  v_cvt_pk_bf16_f32 v90, v148, v149
  v_cvt_pk_bf16_f32 v91, v150, v151
  v_mfma_f32_16x16x32_bf16 v[156:159], a[244:247], a[188:191], v[156:159]
  v_mov_b64 v[168:169], 0
  v_cvt_pk_bf16_f32 v77, v78, v79
  v_mfma_f32_16x16x32_bf16 v[156:159], v[164:167], a[200:203], v[156:159]
  v_exp_f32 v144, v144
  v_mfma_f32_16x16x32_bf16 v[156:159], v[160:163], a[212:215], v[156:159]
  s_waitcnt lgkmcnt(0)
  v_exp_f32 v145, v145
  v_mfma_f32_16x16x32_bf16 v[140:143], v[68:71], v[184:187], 0
  v_exp_f32 v146, v146
  v_mfma_f32_16x16x32_bf16 v[140:143], v[72:75], v[200:203], v[140:143]
  v_exp_f32 v147, v147
  v_mfma_f32_16x16x32_bf16 v[140:143], v[96:99], v[216:219], v[140:143]
  v_cvt_pk_bf16_f32 v94, v156, v157
  v_cvt_pk_bf16_f32 v95, v158, v159
  v_mfma_f32_16x16x32_bf16 v[140:143], v[120:123], v[232:235], v[140:143]
  v_mov_b64 v[148:149], 0
  v_cvt_pk_bf16_f32 v78, v80, v81
  v_mfma_f32_16x16x32_bf16 v[140:143], v[124:127], v[248:251], v[140:143]
  v_exp_f32 v152, v152
  v_mfma_f32_16x16x32_bf16 v[140:143], v[136:139], a[224:227], v[140:143]
  v_exp_f32 v153, v153
  v_smfmac_f32_16x16x64_bf16 v[168:171], a[240:243], v[112:119], v10
  v_exp_f32 v154, v154
  v_mfma_f32_16x16x32_bf16 v[156:159], v[100:103], v[116:119], 0
  v_exp_f32 v155, v155
  v_mfma_f32_16x16x32_bf16 v[156:159], v[56:59], v[112:115], v[156:159]
  v_cvt_pk_bf16_f32 v79, v82, v83
  v_cvt_pk_bf16_f32 v80, v144, v145
  v_mfma_f32_16x16x32_bf16 v[160:163], v[60:63], v[112:115], 0
  v_cvt_pk_bf16_f32 v81, v146, v147
  v_cvt_pk_bf16_f32 v82, v152, v153
  v_mfma_f32_16x16x32_bf16 v[160:163], v[88:91], v[116:119], v[160:163]
  v_cvt_pk_bf16_f32 v83, v154, v155
  v_mfma_f32_16x16x32_bf16 v[164:167], v[92:95], v[116:119], 0
  v_add_f32 v168, v168, v169
  v_rcp_f32 v170, v168
  v_mfma_f32_16x16x32_bf16 v[164:167], v[64:67], v[112:115], v[164:167]
  v_max3_f32 v9, v168, v170, v9
  v_mul_f32 v156, v170, v156
  v_mul_f32 v157, v170, v157
  v_smfmac_f32_16x16x64_bf16 v[148:151], a[240:243], v[104:111], v10
  v_mul_f32 v158, v170, v158
  v_mul_f32 v159, v170, v159
  v_cvt_pk_bf16_f32 v156, v156, v157
  v_mfma_f32_16x16x32_bf16 v[144:147], v[100:103], v[108:111], 0
  v_cvt_pk_bf16_f32 v157, v158, v159
  v_mul_f32 v160, v170, v160
  v_mul_f32 v161, v170, v161
  v_mfma_f32_16x16x32_bf16 v[144:147], v[56:59], v[104:107], v[144:147]
  v_mul_f32 v162, v170, v162
  v_mul_f32 v163, v170, v163
  v_cvt_pk_bf16_f32 v160, v160, v161
  v_mfma_f32_16x16x32_bf16 v[112:115], v[60:63], v[104:107], 0
  v_cvt_pk_bf16_f32 v161, v162, v163
  v_mul_f32 v164, v170, v164
  v_mul_f32 v165, v170, v165
  v_mfma_f32_16x16x32_bf16 v[112:115], v[88:91], v[108:111], v[112:115]
  v_mul_f32 v166, v170, v166
  v_mul_f32 v167, v170, v167
  v_cvt_pk_bf16_f32 v164, v164, v165
  v_mfma_f32_16x16x32_bf16 v[84:87], v[92:95], v[108:111], 0
  v_add_f32 v148, v148, v149
  v_rcp_f32 v150, v148
  v_mfma_f32_16x16x32_bf16 v[84:87], v[64:67], v[104:107], v[84:87]
  v_cvt_pk_bf16_f32 v165, v166, v167
  v_max3_f32 v9, v148, v150, v9
  v_mul_f32 v144, v150, v144
  v_mfma_f32_16x16x32_bf16 v[104:107], v[136:139], a[228:231], 0
  v_mul_f32 v145, v150, v145
  v_mul_f32 v146, v150, v146
  v_mul_f32 v147, v150, v147
  v_mfma_f32_16x16x32_bf16 v[104:107], v[124:127], v[252:255], v[104:107]
  v_cvt_pk_bf16_f32 v144, v144, v145
  v_cvt_pk_bf16_f32 v145, v146, v147
  v_mul_f32 v112, v150, v112
  v_mfma_f32_16x16x32_bf16 v[104:107], v[120:123], v[236:239], v[104:107]
  v_mov_b64 v[172:173], 0
  v_mul_f32 v113, v150, v113
  v_mul_f32 v114, v150, v114
  v_mfma_f32_16x16x32_bf16 v[104:107], v[96:99], v[220:223], v[104:107]
  v_mul_f32 v115, v150, v115
  v_cvt_pk_bf16_f32 v112, v112, v113
  v_cvt_pk_bf16_f32 v113, v114, v115
  v_mfma_f32_16x16x32_bf16 v[104:107], v[72:75], v[204:207], v[104:107]
  v_mul_f32 v84, v150, v84
  v_mul_f32 v85, v150, v85
  v_mul_f32 v86, v150, v86
  v_mfma_f32_16x16x32_bf16 v[104:107], v[68:71], v[188:191], v[104:107]
  v_mul_f32 v87, v150, v87
  v_cvt_pk_bf16_f32 v84, v84, v85
  v_cvt_pk_bf16_f32 v85, v86, v87
  v_mfma_f32_16x16x32_bf16 v[152:155], v[68:71], v[192:195], 0
  ds_write2st64_b32 v5, v156, v157 offset0:0 offset1:4
  v_mfma_f32_16x16x32_bf16 v[152:155], v[72:75], v[208:211], v[152:155]
  ds_write2st64_b32 v5, v160, v161 offset0:8 offset1:12
  v_mfma_f32_16x16x32_bf16 v[152:155], v[96:99], v[224:227], v[152:155]
  v_cvt_pk_bf16_f32 v140, v140, v104
  v_cvt_pk_bf16_f32 v141, v141, v105
  v_mfma_f32_16x16x32_bf16 v[152:155], v[120:123], v[240:243], v[152:155]
  ds_read_b128 a[248:251], v4 offset:0
  v_cvt_pk_bf16_f32 v142, v142, v106
  v_cvt_pk_bf16_f32 v143, v143, v107
  v_mfma_f32_16x16x32_bf16 v[152:155], v[124:127], a[216:219], v[152:155]
  buffer_store_dword v140, v7, s[24:27], s33 offen offset:0 nt
  v_mfma_f32_16x16x32_bf16 v[152:155], v[136:139], a[232:235], v[152:155]
  ds_read_b128 v[148:151], v4 offset:4096
  ds_read_b128 v[156:159], v4 offset:8192
  v_smfmac_f32_16x16x64_bf16 v[172:175], a[240:243], v[128:135], v10
  ds_read_b128 v[160:163], v4 offset:12288
  ds_read_b128 v[168:171], v4 offset:16384
  v_mfma_f32_16x16x32_bf16 v[108:111], v[56:59], v[132:135], 0
  buffer_store_dword v141, v7, s[24:27], s33 offen offset:384 nt
  v_mfma_f32_16x16x32_bf16 v[108:111], v[100:103], v[128:131], v[108:111]
  ds_read_b128 v[176:179], v4 offset:20480
  v_mfma_f32_16x16x32_bf16 v[116:119], v[88:91], v[128:131], 0
  ds_write2st64_b32 v5, v164, v165 offset0:16 offset1:20
  v_mfma_f32_16x16x32_bf16 v[116:119], v[60:63], v[132:135], v[116:119]
  buffer_store_dword v142, v7, s[24:27], s33 offen offset:768 nt
  v_mfma_f32_16x16x32_bf16 v[104:107], v[64:67], v[132:135], 0
  v_add_f32 v172, v172, v173
  v_rcp_f32 v174, v172
  v_mfma_f32_16x16x32_bf16 v[104:107], v[92:95], v[128:131], v[104:107]
  v_max3_f32 v9, v172, v174, v9
  v_mul_f32 v108, v174, v108
  v_mul_f32 v109, v174, v109
  v_mfma_f32_16x16x32_bf16 v[132:135], v[136:139], a[236:239], 0
  buffer_store_dword v143, v7, s[24:27], s33 offen offset:1152 nt
  v_mul_f32 v110, v174, v110
  v_mfma_f32_16x16x32_bf16 v[132:135], v[124:127], a[220:223], v[132:135]
  v_mul_f32 v111, v174, v111
  v_cvt_pk_bf16_f32 v108, v108, v109
  v_cvt_pk_bf16_f32 v109, v110, v111
  v_mfma_f32_16x16x32_bf16 v[132:135], v[120:123], v[244:247], v[132:135]
  v_mov_b64 v[128:129], 0
  v_mul_f32 v116, v174, v116
  v_mul_f32 v117, v174, v117
  v_mfma_f32_16x16x32_bf16 v[132:135], v[96:99], v[228:231], v[132:135]
  v_mul_f32 v118, v174, v118
  v_mul_f32 v119, v174, v119
  v_cvt_pk_bf16_f32 v116, v116, v117
  v_mfma_f32_16x16x32_bf16 v[132:135], v[72:75], v[212:215], v[132:135]
  v_cvt_pk_bf16_f32 v117, v118, v119
  v_mul_f32 v104, v174, v104
  v_mul_f32 v105, v174, v105
  v_mfma_f32_16x16x32_bf16 v[132:135], v[68:71], v[196:199], v[132:135]
  s_waitcnt lgkmcnt(1)
  v_mul_f32 v106, v174, v106
  v_mul_f32 v107, v174, v107
  v_cvt_pk_bf16_f32 v104, v104, v105
  v_mfma_f32_16x16x32_bf16 v[96:99], a[248:251], v[184:187], 0
  v_cvt_pk_bf16_f32 v105, v106, v107
  v_mfma_f32_16x16x32_bf16 v[96:99], v[148:151], v[200:203], v[96:99]
  ds_write2st64_b32 v5, v144, v145 offset0:1 offset1:5
  v_mfma_f32_16x16x32_bf16 v[96:99], v[156:159], v[216:219], v[96:99]
  v_cvt_pk_bf16_f32 v152, v152, v132
  v_cvt_pk_bf16_f32 v153, v153, v133
  v_mfma_f32_16x16x32_bf16 v[96:99], v[160:163], v[232:235], v[96:99]
  ds_read_b128 a[244:247], v3 offset:512
  v_cvt_pk_bf16_f32 v154, v154, v134
  v_cvt_pk_bf16_f32 v155, v155, v135
  v_mfma_f32_16x16x32_bf16 v[96:99], v[168:171], v[248:251], v[96:99]
  buffer_store_dword v152, v8, s[24:27], s33 offen offset:0 nt
  v_mfma_f32_16x16x32_bf16 v[96:99], v[176:179], a[224:227], v[96:99]
  ds_read_b128 a[252:255], v3 offset:4608
  ds_read_b128 v[68:71], v3 offset:8704
  v_smfmac_f32_16x16x64_bf16 v[128:131], a[240:243], v[76:83], v10
  ds_read_b128 v[72:75], v3 offset:12800
  ds_read_b128 v[120:123], v3 offset:16896
  v_mfma_f32_16x16x32_bf16 v[132:135], v[56:59], v[80:83], 0
  buffer_store_dword v153, v8, s[24:27], s33 offen offset:384 nt
  v_mfma_f32_16x16x32_bf16 v[132:135], v[100:103], v[76:79], v[132:135]
  ds_read_b128 v[124:127], v3 offset:20992
  v_xor_b32 v3, 40960, v3
  v_mfma_f32_16x16x32_bf16 v[136:139], v[88:91], v[76:79], 0
  ds_write2st64_b32 v5, v112, v113 offset0:9 offset1:13
  v_mfma_f32_16x16x32_bf16 v[136:139], v[60:63], v[80:83], v[136:139]
  buffer_store_dword v154, v8, s[24:27], s33 offen offset:768 nt
  v_mfma_f32_16x16x32_bf16 v[56:59], v[64:67], v[80:83], 0
  v_add_f32 v128, v128, v129
  v_rcp_f32 v130, v128
  v_mfma_f32_16x16x32_bf16 v[56:59], v[92:95], v[76:79], v[56:59]
  v_max3_f32 v9, v128, v130, v9
  v_mul_f32 v132, v130, v132
  v_mul_f32 v133, v130, v133
  v_mfma_f32_16x16x32_bf16 v[60:63], v[176:179], a[228:231], 0
  buffer_store_dword v155, v8, s[24:27], s33 offen offset:1152 nt
  v_mul_f32 v134, v130, v134
  v_mfma_f32_16x16x32_bf16 v[60:63], v[168:171], v[252:255], v[60:63]
  s_add_u32 s33, s33, s98
  v_mul_f32 v135, v130, v135
  v_cvt_pk_bf16_f32 v132, v132, v133
  v_cvt_pk_bf16_f32 v133, v134, v135
  v_mfma_f32_16x16x32_bf16 v[60:63], v[160:163], v[236:239], v[60:63]
  v_mul_f32 v136, v130, v136
  v_mul_f32 v137, v130, v137
  v_mul_f32 v138, v130, v138
  v_mfma_f32_16x16x32_bf16 v[60:63], v[156:159], v[220:223], v[60:63]
  v_mul_f32 v139, v130, v139
  v_cvt_pk_bf16_f32 v136, v136, v137
  v_cvt_pk_bf16_f32 v137, v138, v139
  v_mfma_f32_16x16x32_bf16 v[60:63], v[148:151], v[204:207], v[60:63]
  v_mul_f32 v56, v130, v56
  v_mul_f32 v57, v130, v57
  v_mul_f32 v58, v130, v58
  v_mfma_f32_16x16x32_bf16 v[60:63], a[248:251], v[188:191], v[60:63]
  s_waitcnt lgkmcnt(1)
  v_mul_f32 v59, v130, v59
  v_cvt_pk_bf16_f32 v56, v56, v57
  v_cvt_pk_bf16_f32 v57, v58, v59
  v_mfma_f32_16x16x32_bf16 v[76:79], a[244:247], v[184:187], 0
  v_cmp_nge_f32 vcc, 0x53800000, v9
  v_mfma_f32_16x16x32_bf16 v[76:79], a[252:255], v[200:203], v[76:79]
  ds_write2st64_b32 v5, v84, v85 offset0:17 offset1:21
  v_mfma_f32_16x16x32_bf16 v[76:79], v[68:71], v[216:219], v[76:79]
  s_or_b32 s6, vcc_lo, vcc_hi
  v_cvt_pk_bf16_f32 v96, v96, v60
  v_cvt_pk_bf16_f32 v97, v97, v61
  v_mov_b32 v54, s6
  v_mfma_f32_16x16x32_bf16 v[76:79], v[72:75], v[232:235], v[76:79]
  v_cvt_pk_bf16_f32 v98, v98, v62
  v_cvt_pk_bf16_f32 v99, v99, v63
  v_mfma_f32_16x16x32_bf16 v[76:79], v[120:123], v[248:251], v[76:79]
  buffer_store_dword v96, v7, s[24:27], s34 offen offset:0 nt
  v_mfma_f32_16x16x32_bf16 v[76:79], v[124:127], a[224:227], v[76:79]
  ds_write2st64_b32 v5, v108, v109 offset0:2 offset1:6
  v_mfma_f32_16x16x32_bf16 v[80:83], v[124:127], a[228:231], 0
  ds_write2st64_b32 v5, v116, v117 offset0:10 offset1:14
  v_mfma_f32_16x16x32_bf16 v[80:83], v[120:123], v[252:255], v[80:83]
  buffer_store_dword v97, v7, s[24:27], s34 offen offset:384 nt
  v_mfma_f32_16x16x32_bf16 v[80:83], v[72:75], v[236:239], v[80:83]
  ds_read_b128 a[248:251], v4 offset:512
  ds_read_b128 v[60:63], v4 offset:4608
  v_mfma_f32_16x16x32_bf16 v[80:83], v[68:71], v[220:223], v[80:83]
  ds_write2st64_b32 v5, v104, v105 offset0:18 offset1:22
  v_mfma_f32_16x16x32_bf16 v[80:83], a[252:255], v[204:207], v[80:83]
  buffer_store_dword v98, v7, s[24:27], s34 offen offset:768 nt
  v_mfma_f32_16x16x32_bf16 v[80:83], a[244:247], v[188:191], v[80:83]
  ds_write2st64_b32 v5, v132, v133 offset0:3 offset1:7
  v_mfma_f32_16x16x32_bf16 v[64:67], a[244:247], v[192:195], 0
  ds_write2st64_b32 v5, v136, v137 offset0:11 offset1:15
  v_mfma_f32_16x16x32_bf16 v[64:67], a[252:255], v[208:211], v[64:67]
  buffer_store_dword v99, v7, s[24:27], s34 offen offset:1152 nt
  v_mfma_f32_16x16x32_bf16 v[64:67], v[68:71], v[224:227], v[64:67]
  s_add_u32 s34, s34, s98
  ds_read_b128 v[84:87], v4 offset:8704
  v_cvt_pk_bf16_f32 v76, v76, v80
  v_cvt_pk_bf16_f32 v77, v77, v81
  v_mfma_f32_16x16x32_bf16 v[64:67], v[72:75], v[240:243], v[64:67]
  ds_read_b128 v[92:95], v4 offset:12800
  v_cvt_pk_bf16_f32 v78, v78, v82
  v_cvt_pk_bf16_f32 v79, v79, v83
  v_mfma_f32_16x16x32_bf16 v[64:67], v[120:123], a[216:219], v[64:67]
  buffer_store_dword v76, v7, s[24:27], s35 offen offset:0 nt
  v_mfma_f32_16x16x32_bf16 v[64:67], v[124:127], a[232:235], v[64:67]
  ds_write2st64_b32 v5, v56, v57 offset0:19 offset1:23
  v_mfma_f32_16x16x32_bf16 v[96:99], v[124:127], a[236:239], 0
  ds_read_b128 v[88:91], v4 offset:16896
  ds_write_b32 v11, v54
  v_mfma_f32_16x16x32_bf16 v[96:99], v[120:123], a[220:223], v[96:99]
  buffer_store_dword v77, v7, s[24:27], s35 offen offset:384 nt
  v_mov_b32 v11, 159744
  v_mfma_f32_16x16x32_bf16 v[96:99], v[72:75], v[244:247], v[96:99]
  ds_read_b128 v[100:103], v4 offset:20992
  v_xor_b32 v4, 40960, v4
  v_mfma_f32_16x16x32_bf16 v[96:99], v[68:71], v[228:231], v[96:99]
  v_mfma_f32_16x16x32_bf16 v[96:99], a[252:255], v[212:215], v[96:99]
  buffer_store_dword v78, v7, s[24:27], s35 offen offset:768 nt
  v_mfma_f32_16x16x32_bf16 v[96:99], a[244:247], v[196:199], v[96:99]
  s_waitcnt lgkmcnt(9)
  v_mfma_f32_16x16x32_bf16 v[80:83], a[248:251], v[184:187], 0
  s_waitcnt lgkmcnt(1)
  s_barrier
  v_mfma_f32_16x16x32_bf16 v[80:83], v[60:63], v[200:203], v[80:83]
  buffer_store_dword v79, v7, s[24:27], s35 offen offset:1152 nt
  v_mfma_f32_16x16x32_bf16 v[80:83], v[84:87], v[216:219], v[80:83]
  s_waitcnt lgkmcnt(0)
  v_cvt_pk_bf16_f32 v64, v64, v96
  v_cvt_pk_bf16_f32 v65, v65, v97
  v_mfma_f32_16x16x32_bf16 v[80:83], v[92:95], v[232:235], v[80:83]
  v_cvt_pk_bf16_f32 v66, v66, v98
  v_cvt_pk_bf16_f32 v67, v67, v99
  v_mfma_f32_16x16x32_bf16 v[80:83], v[88:91], v[248:251], v[80:83]
  buffer_store_dword v64, v8, s[24:27], s35 offen offset:0 nt
  v_mfma_f32_16x16x32_bf16 v[80:83], v[100:103], a[224:227], v[80:83]
  ds_read_b128 a[252:255], v3 offset:0
  ds_read_b128 v[56:59], v3 offset:4096
  v_mfma_f32_16x16x32_bf16 v[76:79], v[100:103], a[228:231], 0
  ds_read_b128 v[68:71], v3 offset:8192
  ds_read_b128 v[72:75], v3 offset:12288
  v_mfma_f32_16x16x32_bf16 v[76:79], v[88:91], v[252:255], v[76:79]
  buffer_store_dword v65, v8, s[24:27], s35 offen offset:384 nt
  v_mfma_f32_16x16x32_bf16 v[76:79], v[92:95], v[236:239], v[76:79]
  ds_read_b128 a[244:247], v3 offset:16384
  ds_read_b128 v[88:91], v3 offset:20480
  v_mfma_f32_16x16x32_bf16 v[76:79], v[84:87], v[220:223], v[76:79]
  ds_read2_b32 v[92:93], v11 offset0:0 offset1:2
  ds_read2_b32 v[94:95], v11 offset0:4 offset1:6
  v_mfma_f32_16x16x32_bf16 v[76:79], v[60:63], v[204:207], v[76:79]
  buffer_store_dword v66, v8, s[24:27], s35 offen offset:768 nt
  v_mfma_f32_16x16x32_bf16 v[76:79], a[248:251], v[188:191], v[76:79]
  s_waitcnt lgkmcnt(4)
  v_mfma_f32_16x16x32_bf16 v[60:63], a[252:255], v[184:187], 0
  buffer_store_dword v67, v8, s[24:27], s35 offen offset:1152 nt
  v_mfma_f32_16x16x32_bf16 v[60:63], v[56:59], v[200:203], v[60:63]
  s_add_u32 s35, s35, s98
  v_mfma_f32_16x16x32_bf16 v[60:63], v[68:71], v[216:219], v[60:63]
  s_waitcnt lgkmcnt(0)
  v_cvt_pk_bf16_f32 v80, v80, v76
  v_cvt_pk_bf16_f32 v81, v81, v77
  v_mfma_f32_16x16x32_bf16 v[60:63], v[72:75], v[232:235], v[60:63]
  v_cvt_pk_bf16_f32 v82, v82, v78
  v_cvt_pk_bf16_f32 v83, v83, v79
  v_mfma_f32_16x16x32_bf16 v[60:63], a[244:247], v[248:251], v[60:63]
  buffer_store_dword v80, v7, s[24:27], s36 offen offset:0 nt
  v_mfma_f32_16x16x32_bf16 v[60:63], v[88:91], a[224:227], v[60:63]
  v_or3_b32 v92, v92, v93, v94
  v_or_b32 v92, v92, v95
  v_mfma_f32_16x16x32_bf16 v[64:67], v[88:91], a[228:231], 0
  buffer_store_dword v81, v7, s[24:27], s36 offen offset:384 nt
  v_mfma_f32_16x16x32_bf16 v[64:67], a[244:247], v[252:255], v[64:67]
  v_readfirstlane_b32 s49, v92
  v_mfma_f32_16x16x32_bf16 v[64:67], v[72:75], v[236:239], v[64:67]
  buffer_store_dword v82, v7, s[24:27], s36 offen offset:768 nt
  v_mfma_f32_16x16x32_bf16 v[64:67], v[68:71], v[220:223], v[64:67]
  ds_read_b128 v[76:79], v4 offset:0
  ds_read_b128 v[84:87], v4 offset:4096
  v_mfma_f32_16x16x32_bf16 v[64:67], v[56:59], v[204:207], v[64:67]
  buffer_store_dword v83, v7, s[24:27], s36 offen offset:1152 nt
  v_mfma_f32_16x16x32_bf16 v[64:67], a[252:255], v[188:191], v[64:67]
  s_add_u32 s36, s36, s98
  ds_read_b128 v[92:95], v4 offset:8192
  ds_read_b128 v[96:99], v4 offset:12288
  v_mfma_f32_16x16x32_bf16 v[80:83], a[252:255], v[192:195], 0
L_hop_2_1:
  s_cbranch_execz L_hop_2_2
  ds_read_b128 v[100:103], v4 offset:16384
  ds_read_b128 v[104:107], v4 offset:20480
  v_mfma_f32_16x16x32_bf16 v[80:83], v[56:59], v[208:211], v[80:83]
  v_mfma_f32_16x16x32_bf16 v[80:83], v[68:71], v[224:227], v[80:83]
  v_cvt_pk_bf16_f32 v60, v60, v64
  v_cvt_pk_bf16_f32 v61, v61, v65
  v_mfma_f32_16x16x32_bf16 v[80:83], v[72:75], v[240:243], v[80:83]
  v_cvt_pk_bf16_f32 v62, v62, v66
  v_cvt_pk_bf16_f32 v63, v63, v67
  v_mfma_f32_16x16x32_bf16 v[80:83], a[244:247], a[216:219], v[80:83]
  buffer_store_dword v60, v7, s[24:27], s33 offen offset:0 nt
  v_mfma_f32_16x16x32_bf16 v[80:83], v[88:91], a[232:235], v[80:83]
  v_mfma_f32_16x16x32_bf16 v[108:111], v[88:91], a[236:239], 0
  buffer_store_dword v61, v7, s[24:27], s33 offen offset:384 nt
  v_mfma_f32_16x16x32_bf16 v[108:111], a[244:247], a[220:223], v[108:111]
  v_mfma_f32_16x16x32_bf16 v[108:111], v[72:75], v[244:247], v[108:111]
  buffer_store_dword v62, v7, s[24:27], s33 offen offset:768 nt
  v_mfma_f32_16x16x32_bf16 v[108:111], v[68:71], v[228:231], v[108:111]
  ds_read_b128 a[244:247], v3 offset:512
  ds_read_b128 a[248:251], v3 offset:4608
  v_mfma_f32_16x16x32_bf16 v[108:111], v[56:59], v[212:215], v[108:111]
  buffer_store_dword v63, v7, s[24:27], s33 offen offset:1152 nt
  v_mfma_f32_16x16x32_bf16 v[108:111], a[252:255], v[196:199], v[108:111]
  s_waitcnt lgkmcnt(2)
  ds_read_b128 v[56:59], v3 offset:8704
  ds_read_b128 v[60:63], v3 offset:12800
  v_mfma_f32_16x16x32_bf16 v[88:91], v[76:79], v[184:187], 0
  ds_read_b128 a[252:255], v3 offset:16896
  ds_read_b128 v[64:67], v3 offset:20992
  v_mfma_f32_16x16x32_bf16 v[88:91], v[84:87], v[200:203], v[88:91]
  v_mfma_f32_16x16x32_bf16 v[88:91], v[92:95], v[216:219], v[88:91]
  v_cvt_pk_bf16_f32 v80, v80, v108
  v_cvt_pk_bf16_f32 v81, v81, v109
  v_mfma_f32_16x16x32_bf16 v[88:91], v[96:99], v[232:235], v[88:91]
  v_cvt_pk_bf16_f32 v82, v82, v110
  v_cvt_pk_bf16_f32 v83, v83, v111
  v_mfma_f32_16x16x32_bf16 v[88:91], v[100:103], v[248:251], v[88:91]
  buffer_store_dword v80, v8, s[24:27], s33 offen offset:0 nt
  v_mfma_f32_16x16x32_bf16 v[88:91], v[104:107], a[224:227], v[88:91]
  v_mfma_f32_16x16x32_bf16 v[68:71], v[104:107], a[228:231], 0
  buffer_store_dword v81, v8, s[24:27], s33 offen offset:384 nt
  v_mfma_f32_16x16x32_bf16 v[68:71], v[100:103], v[252:255], v[68:71]
  v_mfma_f32_16x16x32_bf16 v[68:71], v[96:99], v[236:239], v[68:71]
  buffer_store_dword v82, v8, s[24:27], s33 offen offset:768 nt
  v_mfma_f32_16x16x32_bf16 v[68:71], v[92:95], v[220:223], v[68:71]
  v_mfma_f32_16x16x32_bf16 v[68:71], v[84:87], v[204:207], v[68:71]
  buffer_store_dword v83, v8, s[24:27], s33 offen offset:1152 nt
  v_mfma_f32_16x16x32_bf16 v[68:71], v[76:79], v[188:191], v[68:71]
  s_waitcnt lgkmcnt(0)
  v_mfma_f32_16x16x32_bf16 v[84:87], a[244:247], v[184:187], 0
  v_mfma_f32_16x16x32_bf16 v[84:87], a[248:251], v[200:203], v[84:87]
  v_mfma_f32_16x16x32_bf16 v[84:87], v[56:59], v[216:219], v[84:87]
  v_cvt_pk_bf16_f32 v88, v88, v68
  v_cvt_pk_bf16_f32 v89, v89, v69
  v_mfma_f32_16x16x32_bf16 v[84:87], v[60:63], v[232:235], v[84:87]
  v_cvt_pk_bf16_f32 v90, v90, v70
  v_cvt_pk_bf16_f32 v91, v91, v71
  v_mfma_f32_16x16x32_bf16 v[84:87], a[252:255], v[248:251], v[84:87]
  buffer_store_dword v88, v7, s[24:27], s34 offen offset:0 nt
  v_mfma_f32_16x16x32_bf16 v[84:87], v[64:67], a[224:227], v[84:87]
  v_mfma_f32_16x16x32_bf16 v[100:103], v[64:67], a[228:231], 0
  buffer_store_dword v89, v7, s[24:27], s34 offen offset:384 nt
  v_mfma_f32_16x16x32_bf16 v[100:103], a[252:255], v[252:255], v[100:103]
  v_mfma_f32_16x16x32_bf16 v[100:103], v[60:63], v[236:239], v[100:103]
  buffer_store_dword v90, v7, s[24:27], s34 offen offset:768 nt
  v_mfma_f32_16x16x32_bf16 v[100:103], v[56:59], v[220:223], v[100:103]
  ds_read_b128 v[68:71], v4 offset:512
  ds_read_b128 v[72:75], v4 offset:4608
  v_mfma_f32_16x16x32_bf16 v[100:103], a[248:251], v[204:207], v[100:103]
  buffer_store_dword v91, v7, s[24:27], s34 offen offset:1152 nt
  v_mfma_f32_16x16x32_bf16 v[100:103], a[244:247], v[188:191], v[100:103]
  ds_read_b128 v[76:79], v4 offset:8704
  ds_read_b128 v[92:95], v4 offset:12800
  v_mfma_f32_16x16x32_bf16 v[80:83], a[244:247], v[192:195], 0
  ds_read_b128 v[88:91], v4 offset:16896
  ds_read_b128 v[96:99], v4 offset:20992
  v_mfma_f32_16x16x32_bf16 v[80:83], a[248:251], v[208:211], v[80:83]
  v_mfma_f32_16x16x32_bf16 v[80:83], v[56:59], v[224:227], v[80:83]
  v_cvt_pk_bf16_f32 v84, v84, v100
  v_cvt_pk_bf16_f32 v85, v85, v101
  v_mfma_f32_16x16x32_bf16 v[80:83], v[60:63], v[240:243], v[80:83]
  v_cvt_pk_bf16_f32 v86, v86, v102
  v_cvt_pk_bf16_f32 v87, v87, v103
  v_mfma_f32_16x16x32_bf16 v[80:83], a[252:255], a[216:219], v[80:83]
  buffer_store_dword v84, v7, s[24:27], s35 offen offset:0 nt
  v_mfma_f32_16x16x32_bf16 v[80:83], v[64:67], a[232:235], v[80:83]
  v_mfma_f32_16x16x32_bf16 v[100:103], v[64:67], a[236:239], 0
  buffer_store_dword v85, v7, s[24:27], s35 offen offset:384 nt
  v_mfma_f32_16x16x32_bf16 v[100:103], a[252:255], a[220:223], v[100:103]
  v_mfma_f32_16x16x32_bf16 v[100:103], v[60:63], v[244:247], v[100:103]
  buffer_store_dword v86, v7, s[24:27], s35 offen offset:768 nt
  v_mfma_f32_16x16x32_bf16 v[100:103], v[56:59], v[228:231], v[100:103]
  v_mfma_f32_16x16x32_bf16 v[100:103], a[248:251], v[212:215], v[100:103]
  buffer_store_dword v87, v7, s[24:27], s35 offen offset:1152 nt
  v_mfma_f32_16x16x32_bf16 v[100:103], a[244:247], v[196:199], v[100:103]
  s_waitcnt lgkmcnt(0)
  v_mfma_f32_16x16x32_bf16 v[56:59], v[68:71], v[184:187], 0
  v_mfma_f32_16x16x32_bf16 v[56:59], v[72:75], v[200:203], v[56:59]
  v_mfma_f32_16x16x32_bf16 v[56:59], v[76:79], v[216:219], v[56:59]
  v_cvt_pk_bf16_f32 v80, v80, v100
  v_cvt_pk_bf16_f32 v81, v81, v101
  v_mfma_f32_16x16x32_bf16 v[56:59], v[92:95], v[232:235], v[56:59]
  v_cvt_pk_bf16_f32 v82, v82, v102
  v_cvt_pk_bf16_f32 v83, v83, v103
  v_mfma_f32_16x16x32_bf16 v[56:59], v[88:91], v[248:251], v[56:59]
  buffer_store_dword v80, v8, s[24:27], s35 offen offset:0 nt
  v_mfma_f32_16x16x32_bf16 v[56:59], v[96:99], a[224:227], v[56:59]
  v_mfma_f32_16x16x32_bf16 v[60:63], v[96:99], a[228:231], 0
  buffer_store_dword v81, v8, s[24:27], s35 offen offset:384 nt
  v_mfma_f32_16x16x32_bf16 v[60:63], v[88:91], v[252:255], v[60:63]
  v_mfma_f32_16x16x32_bf16 v[60:63], v[92:95], v[236:239], v[60:63]
  buffer_store_dword v82, v8, s[24:27], s35 offen offset:768 nt
  v_mfma_f32_16x16x32_bf16 v[60:63], v[76:79], v[220:223], v[60:63]
  v_mfma_f32_16x16x32_bf16 v[60:63], v[72:75], v[204:207], v[60:63]
  buffer_store_dword v83, v8, s[24:27], s35 offen offset:1152 nt
  v_mfma_f32_16x16x32_bf16 v[60:63], v[68:71], v[188:191], v[60:63]
  s_nop 7
  v_cvt_pk_bf16_f32 v56, v56, v60
  v_cvt_pk_bf16_f32 v57, v57, v61
  v_cvt_pk_bf16_f32 v58, v58, v62
  v_cvt_pk_bf16_f32 v59, v59, v63
  buffer_store_dword v56, v7, s[24:27], s36 offen offset:0 nt
  buffer_store_dword v57, v7, s[24:27], s36 offen offset:384 nt
  buffer_store_dword v58, v7, s[24:27], s36 offen offset:768 nt
  buffer_store_dword v59, v7, s[24:27], s36 offen offset:1152 nt
  s_cmp_lg_u32 s49, 0
  s_cbranch_scc1 L_safe
L_fin:
L_end:
  s_endpgm
L_hop_3_1:
  s_cbranch_execz L_walk
L_pad3768:
L_k7:
  s_cmp_lg_u32 s59, 7
  s_cbranch_scc1 L_kh
  v_mfma_f32_16x16x32_bf16 v[104:107], a[0:3], v[88:91], 0
  s_waitcnt lgkmcnt(0)
  s_sub_u32 s49, s16, s18
  s_sub_u32 s50, s15, s60
  v_mfma_f32_16x16x32_bf16 v[104:107], a[12:15], v[92:95], v[104:107]
  s_add_u32 s50, s50, 45360
  s_mul_i32 s49, s49, s50
  s_mul_hi_u32 s49, s49, 415817
  v_mfma_f32_16x16x32_bf16 v[104:107], a[24:27], v[96:99], v[104:107]
  s_add_u32 s49, s49, s16
  v_cvt_pk_bf16_f32 v66, v128, v129
  v_cvt_pk_bf16_f32 v67, v130, v131
  v_mfma_f32_16x16x32_bf16 v[104:107], a[36:39], v[136:139], v[104:107]
  s_and_b32 s51, s2, 7
  s_lshl_b32 s51, s51, 3
  v_and_b32 v74, 56, v11
  v_mfma_f32_16x16x32_bf16 v[104:107], a[48:51], v[140:143], v[104:107]
  v_lshl_add_u32 v54, v74, 3, s51
  s_lshl_b32 s51, s51, 3
  v_mfma_f32_16x16x32_bf16 v[104:107], a[60:63], v[80:83], v[104:107]
  v_add_u32 v55, s51, v74
  v_mov_b32 v74, s49
  v_mfma_f32_16x16x32_bf16 v[84:87], a[64:67], v[80:83], 0
  buffer_store_dword v74, v54, s[20:23], s44 offen sc1
  v_mfma_f32_16x16x32_bf16 v[84:87], a[52:55], v[140:143], v[84:87]
  v_mfma_f32_16x16x32_bf16 v[84:87], a[40:43], v[136:139], v[84:87]
  v_mul_f32 v104, s42, v104
  v_mul_f32 v105, s42, v105
  v_mfma_f32_16x16x32_bf16 v[84:87], a[28:31], v[96:99], v[84:87]
  v_mul_f32 v106, s42, v106
  v_mul_f32 v107, s42, v107
  v_mfma_f32_16x16x32_bf16 v[84:87], a[16:19], v[92:95], v[84:87]
  v_cvt_pk_bf16_f32 v18, v104, v105
  v_cvt_pk_bf16_f32 v19, v106, v107
  v_mfma_f32_16x16x32_bf16 v[84:87], a[4:7], v[88:91], v[84:87]
  buffer_store_dword v74, v55, s[20:23], s44 offen offset:4 sc1
  v_mfma_f32_16x16x32_bf16 v[108:111], a[8:11], v[88:91], 0
  s_branch L_r220
L_k2:
  s_cmp_lg_u32 s59, 10
  s_cbranch_scc1 L_k7
  s_waitcnt vmcnt(30)
  v_mfma_f32_16x16x32_bf16 v[104:107], a[0:3], v[88:91], 0
  s_sub_u32 s49, s19, s18
  s_sub_u32 s50, s15, s99
  s_add_u32 s50, s50, 45360
  v_mfma_f32_16x16x32_bf16 v[104:107], a[12:15], v[92:95], v[104:107]
  s_mul_i32 s49, s49, s50
  s_mul_hi_u32 s49, s49, 415817
  s_add_u32 s49, s49, s19
  v_mfma_f32_16x16x32_bf16 v[104:107], a[24:27], v[96:99], v[104:107]
  s_and_b32 s50, s2, 7
  v_cvt_pk_bf16_f32 v66, v128, v129
  v_cvt_pk_bf16_f32 v67, v130, v131
  v_mfma_f32_16x16x32_bf16 v[104:107], a[36:39], v[136:139], v[104:107]
  s_sub_u32 s49, s49, 1024
  v_subrev_u32 v54, s49, v52
  v_subrev_u32 v55, s49, v53
  v_mfma_f32_16x16x32_bf16 v[104:107], a[48:51], v[140:143], v[104:107]
  s_waitcnt lgkmcnt(0)
  v_max_u32 v116, v54, v55
  v_bfe_u32 v74, v11, 3, 3
  v_mfma_f32_16x16x32_bf16 v[104:107], a[60:63], v[80:83], v[104:107]
  v_lshrrev_b32 v75, 6, v11
  v_lshl_add_u32 v54, v54, 3, v74
  v_mfma_f32_16x16x32_bf16 v[84:87], a[64:67], v[80:83], 0
  v_lshl_add_u32 v55, v55, 3, v75
  v_mfma_f32_16x16x32_bf16 v[84:87], a[52:55], v[140:143], v[84:87]
  v_readlane_b32 s12, v52, s50
  v_cmp_lt_u32 vcc, 2047, v116
  v_mfma_f32_16x16x32_bf16 v[84:87], a[40:43], v[136:139], v[84:87]
  v_mul_f32 v104, s42, v104
  v_mul_f32 v105, s42, v105
  v_mfma_f32_16x16x32_bf16 v[84:87], a[28:31], v[96:99], v[84:87]
  v_mul_f32 v106, s42, v106
  v_mul_f32 v107, s42, v107
  v_mfma_f32_16x16x32_bf16 v[84:87], a[16:19], v[92:95], v[84:87]
  v_cvt_pk_bf16_f32 v18, v104, v105
  v_cvt_pk_bf16_f32 v19, v106, v107
  v_mfma_f32_16x16x32_bf16 v[84:87], a[4:7], v[88:91], v[84:87]
  v_and_b32 v116, 56, v11
  v_mfma_f32_16x16x32_bf16 v[108:111], a[8:11], v[88:91], 0
  s_or_b32 s51, vcc_lo, vcc_hi
  v_cmp_lt_u32 vcc, v54, v55
  v_mfma_f32_16x16x32_bf16 v[108:111], a[20:23], v[92:95], v[108:111]
  s_sub_u32 s52, s12, s49
  s_sub_u32 s52, s52, 960
  s_lshr_b32 s52, s52, 7
  v_mfma_f32_16x16x32_bf16 v[108:111], a[32:35], v[96:99], v[108:111]
  s_or_b32 s51, s51, s52
  v_mul_f32 v84, s42, v84
  v_mul_f32 v85, s42, v85
  v_mfma_f32_16x16x32_bf16 v[108:111], a[44:47], v[136:139], v[108:111]
  v_mul_f32 v86, s42, v86
  v_mul_f32 v87, s42, v87
  v_mfma_f32_16x16x32_bf16 v[108:111], a[56:59], v[140:143], v[108:111]
  v_cvt_pk_bf16_f32 v104, v84, v85
  v_cvt_pk_bf16_f32 v105, v86, v87
  v_mfma_f32_16x16x32_bf16 v[108:111], a[68:71], v[80:83], v[108:111]
  v_lshrrev_b64 v[74:75], v116, vcc
  v_and_b32 v55, 0xff, v74
  v_mfma_f32_16x16x32_bf16 v[112:115], a[132:135], v[80:83], 0
  v_bcnt_u32_b32 v55, v55, 0
  v_mfma_f32_16x16x32_bf16 v[112:115], a[120:123], v[140:143], v[112:115]
  v_readlane_b32 s52, v55, s50
  v_mfma_f32_16x16x32_bf16 v[112:115], a[108:111], v[136:139], v[112:115]
  v_mul_f32 v108, s42, v108
  v_mul_f32 v109, s42, v109
  v_mfma_f32_16x16x32_bf16 v[112:115], a[96:99], v[96:99], v[112:115]
  s_sub_u32 s52, 7, s52
  v_mul_f32 v110, s42, v110
  v_mul_f32 v111, s42, v111
  v_mfma_f32_16x16x32_bf16 v[112:115], a[84:87], v[92:95], v[112:115]
  v_cvt_pk_bf16_f32 v106, v108, v109
  v_cvt_pk_bf16_f32 v107, v110, v111
  v_mfma_f32_16x16x32_bf16 v[112:115], a[72:75], v[88:91], v[112:115]
  v_cmp_eq_u32 vcc, s52, v55
  v_mfma_f32_16x16x32_bf16 v[84:87], a[76:79], v[88:91], 0
  v_mfma_f32_16x16x32_bf16 v[84:87], a[88:91], v[92:95], v[84:87]
  s_ff1_i32_b32 s52, vcc_lo
  s_and_b32 s52, s52, 7
  v_readlane_b32 s53, v54, s52
  v_mfma_f32_16x16x32_bf16 v[84:87], a[100:103], v[96:99], v[84:87]
  v_cvt_pk_bf16_f32 v128, v112, v113
  v_cvt_pk_bf16_f32 v129, v114, v115
  v_mfma_f32_16x16x32_bf16 v[84:87], a[112:115], v[136:139], v[84:87]
  s_lshr_b32 s53, s53, 3
  s_add_u32 s53, s53, s49
  s_sub_u32 s49, s53, s12
  v_mfma_f32_16x16x32_bf16 v[84:87], a[124:127], v[140:143], v[84:87]
  s_cmp_gt_i32 s49, 0
  s_cselect_b32 s45, 2, 1
  s_cselect_b32 s12, s53, s12
  v_mfma_f32_16x16x32_bf16 v[84:87], a[136:139], v[80:83], v[84:87]
  s_cselect_b32 s53, s52, s50
  s_cselect_b32 s96, 1, 6
  s_lshl_b32 s96, s96, 11
  v_mfma_f32_16x16x32_bf16 v[108:111], a[140:143], v[80:83], 0
  s_abs_i32 s49, s49
  s_cmp_lt_u32 s49, 235
  s_cselect_b32 s51, 1, s51
  v_mfma_f32_16x16x32_bf16 v[108:111], a[128:131], v[140:143], v[108:111]
  s_cmp_lt_u32 s49, 400
  s_cselect_b32 s14, 8, 0
  s_xnor_b32 s13, s12, s14
  v_mfma_f32_16x16x32_bf16 v[108:111], a[116:119], v[136:139], v[108:111]
  s_cmp_eq_u32 s51, 0
  v_cvt_pk_bf16_f32 v130, v84, v85
  v_cvt_pk_bf16_f32 v131, v86, v87
  v_mfma_f32_16x16x32_bf16 v[108:111], a[104:107], v[96:99], v[108:111]
  s_cselect_b32 s45, s45, 0
  s_cselect_b32 s96, s96, 0
  s_bitset1_b32 s96, 14
  v_mfma_f32_16x16x32_bf16 v[108:111], a[92:95], v[92:95], v[108:111]
  s_andn2_b32 s51, s2, 7
  s_add_u32 s51, s51, s53
  s_lshl_b32 s51, s51, 9
  v_mfma_f32_16x16x32_bf16 v[108:111], a[80:83], v[88:91], v[108:111]
  s_add_u32 s44, s51, 2097152
  s_lshr_b32 s49, s45, 1
  s_lshl_b32 s49, s49, s52
  v_mfma_f32_16x16x32_bf16 v[84:87], v[88:91], a[144:147], 0
  s_lshl_b32 s49, s49, s14
  s_lshl_b32 s54, s3, 2
  s_add_u32 s54, s54, 159808
  v_mfma_f32_16x16x32_bf16 v[84:87], v[92:95], a[156:159], v[84:87]
  ds_read_b128 a[244:247], v1 offset:22528
  v_mov_b32 v54, s54
  v_mfma_f32_16x16x32_bf16 v[84:87], v[96:99], a[168:171], v[84:87]
  v_cvt_pk_bf16_f32 v132, v108, v109
  v_cvt_pk_bf16_f32 v133, v110, v111
  v_mfma_f32_16x16x32_bf16 v[84:87], v[136:139], a[180:183], v[84:87]
  ds_read_b128 a[248:251], v0 offset:22528
  v_mov_b32 v55, s49
  v_mfma_f32_16x16x32_bf16 v[84:87], v[140:143], a[192:195], v[84:87]
  ds_read_b128 a[252:255], v1 offset:14336
  v_mfma_f32_16x16x32_bf16 v[84:87], v[80:83], a[204:207], v[84:87]
  ds_read_b128 v[144:147], v0 offset:14336
  v_mfma_f32_16x16x32_bf16 v[116:119], v[80:83], a[208:211], 0
  ds_read_b128 v[148:151], v1 offset:6144
  v_mfma_f32_16x16x32_bf16 v[116:119], v[140:143], a[196:199], v[116:119]
  ds_read_b128 v[152:155], v0 offset:6144
  v_mfma_f32_16x16x32_bf16 v[116:119], v[136:139], a[184:187], v[116:119]
  v_cvt_pk_bf16_f32 v108, v84, v85
  v_cvt_pk_bf16_f32 v109, v86, v87
  v_mfma_f32_16x16x32_bf16 v[116:119], v[96:99], a[172:175], v[116:119]
  ds_write_b32 v54, v55
  v_mfma_f32_16x16x32_bf16 v[116:119], v[92:95], a[160:163], v[116:119]
  v_mfma_f32_16x16x32_bf16 v[116:119], v[88:91], a[148:151], v[116:119]
  v_mfma_f32_16x16x32_bf16 v[156:159], v[88:91], a[152:155], 0
  v_mfma_f32_16x16x32_bf16 v[156:159], v[92:95], a[164:167], v[156:159]
  s_waitcnt lgkmcnt(0)
  v_mfma_f32_16x16x32_bf16 v[156:159], v[96:99], a[176:179], v[156:159]
  v_cvt_pk_bf16_f32 v112, v116, v117
  v_cvt_pk_bf16_f32 v113, v118, v119
  v_mfma_f32_16x16x32_bf16 v[156:159], v[136:139], a[188:191], v[156:159]
  s_branch L_r259
L_hop_0_2:
  s_cbranch_execz L_walk
L_pad3969:
L_kh:
  s_cmp_lt_u32 s59, 14
  s_cbranch_scc1 L_k11
  v_mfma_f32_16x16x32_bf16 v[104:107], a[76:79], v[88:91], 0
  s_lshl_b32 s5, s3, 3
  v_mfma_f32_16x16x32_bf16 v[104:107], a[88:91], v[92:95], v[104:107]
  s_add_u32 s5, s5, 159744
  v_mov_b32 v11, s5
  v_mfma_f32_16x16x32_bf16 v[104:107], a[100:103], v[96:99], v[104:107]
  v_cvt_pk_bf16_f32 v66, v128, v129
  v_cvt_pk_bf16_f32 v67, v130, v131
  v_mfma_f32_16x16x32_bf16 v[104:107], a[112:115], v[136:139], v[104:107]
  ds_read_b128 a[244:247], v1 offset:22528
  v_mfma_f32_16x16x32_bf16 v[104:107], a[124:127], v[140:143], v[104:107]
  ds_read_b128 a[248:251], v0 offset:22528
  s_waitcnt lgkmcnt(2)
  v_mfma_f32_16x16x32_bf16 v[104:107], a[136:139], v[80:83], v[104:107]
  ds_read_b128 a[252:255], v1 offset:14336
  v_mfma_f32_16x16x32_bf16 v[108:111], a[132:135], v[80:83], 0
  ds_read_b128 v[84:87], v0 offset:14336
  v_mfma_f32_16x16x32_bf16 v[108:111], a[120:123], v[140:143], v[108:111]
  ds_read_b128 v[128:131], v1 offset:6144
  v_mfma_f32_16x16x32_bf16 v[108:111], a[108:111], v[136:139], v[108:111]
  v_cvt_pk_bf16_f32 v146, v104, v105
  v_cvt_pk_bf16_f32 v147, v106, v107
  v_mfma_f32_16x16x32_bf16 v[108:111], a[96:99], v[96:99], v[108:111]
  ds_read_b128 v[132:135], v0 offset:6144
  v_cndmask_b32 v160, v32, v48, s[100:101]
  v_mfma_f32_16x16x32_bf16 v[108:111], a[84:87], v[92:95], v[108:111]
  v_cndmask_b32 v161, v33, v49, s[100:101]
  v_cndmask_b32 v162, v34, v50, s[100:101]
  v_mfma_f32_16x16x32_bf16 v[108:111], a[72:75], v[88:91], v[108:111]
  v_cndmask_b32 v163, v35, v51, s[100:101]
  v_cndmask_b32 v164, v28, v44, s[100:101]
  v_mfma_f32_16x16x32_bf16 v[112:115], a[140:143], v[80:83], 0
  v_cndmask_b32 v165, v29, v45, s[100:101]
  v_cndmask_b32 v166, v30, v46, s[100:101]
  v_mfma_f32_16x16x32_bf16 v[112:115], a[128:131], v[140:143], v[112:115]
  v_cndmask_b32 v167, v31, v47, s[100:101]
  v_cndmask_b32 v104, v24, v40, s[100:101]
  v_mfma_f32_16x16x32_bf16 v[112:115], a[116:119], v[136:139], v[112:115]
  v_cvt_pk_bf16_f32 v144, v108, v109
  v_cvt_pk_bf16_f32 v145, v110, v111
  v_mfma_f32_16x16x32_bf16 v[112:115], a[104:107], v[96:99], v[112:115]
  v_cndmask_b32 v105, v25, v41, s[100:101]
  v_cndmask_b32 v106, v26, v42, s[100:101]
  v_mfma_f32_16x16x32_bf16 v[112:115], a[92:95], v[92:95], v[112:115]
  v_cndmask_b32 v107, v27, v43, s[100:101]
  v_mfma_f32_16x16x32_bf16 v[112:115], a[80:83], v[88:91], v[112:115]
  s_waitcnt lgkmcnt(0)
  v_mfma_f32_16x16x32_bf16 v[108:111], a[132:135], a[244:247], 0
  v_mfma_f32_16x16x32_bf16 v[108:111], a[120:123], a[248:251], v[108:111]
  v_mfma_f32_16x16x32_bf16 v[108:111], a[108:111], a[252:255], v[108:111]
  v_cvt_pk_bf16_f32 v148, v112, v113
  v_cvt_pk_bf16_f32 v149, v114, v115
  v_mfma_f32_16x16x32_bf16 v[108:111], a[96:99], v[84:87], v[108:111]
  v_mfma_f32_16x16x32_bf16 v[108:111], a[84:87], v[128:131], v[108:111]
  s_waitcnt lgkmcnt(0)
  s_barrier
  v_mfma_f32_16x16x32_bf16 v[108:111], a[72:75], v[132:135], v[108:111]
  v_mfma_f32_16x16x32_bf16 v[112:115], a[76:79], v[132:135], 0
  v_mfma_f32_16x16x32_bf16 v[112:115], a[88:91], v[128:131], v[112:115]
  v_mfma_f32_16x16x32_bf16 v[112:115], a[100:103], v[84:87], v[112:115]
  v_cvt_pk_bf16_f32 v152, v108, v109
  v_cvt_pk_bf16_f32 v153, v110, v111
  v_mfma_f32_16x16x32_bf16 v[112:115], a[112:115], a[252:255], v[112:115]
  v_mfma_f32_16x16x32_bf16 v[112:115], a[124:127], a[248:251], v[112:115]
  v_mfma_f32_16x16x32_bf16 v[112:115], a[136:139], a[244:247], v[112:115]
  v_mfma_f32_16x16x32_bf16 v[108:111], a[140:143], a[244:247], 0
  v_mfma_f32_16x16x32_bf16 v[108:111], a[128:131], a[248:251], v[108:111]
  v_mfma_f32_16x16x32_bf16 v[108:111], a[116:119], a[252:255], v[108:111]
  v_cvt_pk_bf16_f32 v154, v112, v113
  v_cvt_pk_bf16_f32 v155, v114, v115
  v_mfma_f32_16x16x32_bf16 v[108:111], a[104:107], v[84:87], v[108:111]
  v_mfma_f32_16x16x32_bf16 v[108:111], a[92:95], v[128:131], v[108:111]
  v_mfma_f32_16x16x32_bf16 v[108:111], a[80:83], v[132:135], v[108:111]
  v_mfma_f32_16x16x32_bf16 v[112:115], v[70:73], v[76:79], v[36:39]
  v_mfma_f32_16x16x32_bf16 v[112:115], v[68:71], v[12:15], v[112:115]
  v_mfma_f32_16x16x32_bf16 v[116:119], v[122:125], v[76:79], v[32:35]
  v_cvt_pk_bf16_f32 v156, v108, v109
  v_cvt_pk_bf16_f32 v157, v110, v111
  v_mfma_f32_16x16x32_bf16 v[116:119], v[120:123], v[12:15], v[116:119]
  v_mfma_f32_16x16x32_bf16 v[168:171], v[146:149], v[76:79], v[164:167]
  v_exp_f32 v112, v112
  v_mfma_f32_16x16x32_bf16 v[168:171], v[144:147], v[12:15], v[168:171]
  v_exp_f32 v113, v113
  v_mfma_f32_16x16x32_bf16 v[172:175], v[154:157], v[76:79], v[104:107]
  v_exp_f32 v114, v114
  v_mfma_f32_16x16x32_bf16 v[172:175], v[152:155], v[12:15], v[172:175]
  v_exp_f32 v115, v115
  v_mfma_f32_16x16x32_bf16 v[104:107], v[68:71], v[100:103], v[40:43]
  v_exp_f32 v116, v116
  v_mfma_f32_16x16x32_bf16 v[104:107], v[70:73], v[14:17], v[104:107]
  v_exp_f32 v117, v117
  v_mfma_f32_16x16x32_bf16 v[108:111], v[120:123], v[100:103], v[36:39]
  v_exp_f32 v118, v118
  v_mfma_f32_16x16x32_bf16 v[108:111], v[122:125], v[14:17], v[108:111]
  v_exp_f32 v119, v119
  v_mfma_f32_16x16x32_bf16 v[72:75], v[144:147], v[100:103], v[160:163]
  v_exp_f32 v168, v168
  v_mfma_f32_16x16x32_bf16 v[72:75], v[146:149], v[14:17], v[72:75]
  v_exp_f32 v169, v169
  v_mfma_f32_16x16x32_bf16 v[68:71], v[152:155], v[100:103], v[164:167]
  v_exp_f32 v170, v170
  v_mfma_f32_16x16x32_bf16 v[68:71], v[154:157], v[14:17], v[68:71]
  v_exp_f32 v171, v171
  v_mfma_f32_16x16x32_bf16 v[76:79], v[88:91], a[144:147], 0
  v_exp_f32 v172, v172
  v_mfma_f32_16x16x32_bf16 v[76:79], v[92:95], a[156:159], v[76:79]
  v_exp_f32 v173, v173
  v_mfma_f32_16x16x32_bf16 v[76:79], v[96:99], a[168:171], v[76:79]
  v_exp_f32 v174, v174
  v_mfma_f32_16x16x32_bf16 v[76:79], v[136:139], a[180:183], v[76:79]
  v_exp_f32 v175, v175
  v_mfma_f32_16x16x32_bf16 v[76:79], v[140:143], a[192:195], v[76:79]
  v_cvt_pk_bf16_f32 v112, v112, v113
  v_cvt_pk_bf16_f32 v113, v114, v115
  v_mfma_f32_16x16x32_bf16 v[76:79], v[80:83], a[204:207], v[76:79]
  v_cvt_pk_bf16_f32 v114, v116, v117
  v_cvt_pk_bf16_f32 v115, v118, v119
  v_mfma_f32_16x16x32_bf16 v[100:103], v[80:83], a[208:211], 0
  v_cvt_pk_bf16_f32 v116, v168, v169
  v_cvt_pk_bf16_f32 v117, v170, v171
  v_mfma_f32_16x16x32_bf16 v[100:103], v[140:143], a[196:199], v[100:103]
  v_cvt_pk_bf16_f32 v118, v172, v173
  v_cvt_pk_bf16_f32 v119, v174, v175
  v_mfma_f32_16x16x32_bf16 v[100:103], v[136:139], a[184:187], v[100:103]
  v_cvt_pk_bf16_f32 v144, v76, v77
  v_cvt_pk_bf16_f32 v145, v78, v79
  v_mfma_f32_16x16x32_bf16 v[100:103], v[96:99], a[172:175], v[100:103]
  v_exp_f32 v104, v104
  v_mfma_f32_16x16x32_bf16 v[100:103], v[92:95], a[160:163], v[100:103]
  v_exp_f32 v105, v105
  v_mfma_f32_16x16x32_bf16 v[100:103], v[88:91], a[148:151], v[100:103]
  v_exp_f32 v106, v106
  v_mfma_f32_16x16x32_bf16 v[120:123], v[88:91], a[152:155], 0
  v_exp_f32 v107, v107
  v_mfma_f32_16x16x32_bf16 v[120:123], v[92:95], a[164:167], v[120:123]
  v_exp_f32 v108, v108
  v_mfma_f32_16x16x32_bf16 v[120:123], v[96:99], a[176:179], v[120:123]
  v_cvt_pk_bf16_f32 v148, v100, v101
  v_cvt_pk_bf16_f32 v149, v102, v103
  v_mfma_f32_16x16x32_bf16 v[120:123], v[136:139], a[188:191], v[120:123]
  v_exp_f32 v109, v109
  v_mfma_f32_16x16x32_bf16 v[120:123], v[140:143], a[200:203], v[120:123]
  v_exp_f32 v110, v110
  v_mfma_f32_16x16x32_bf16 v[120:123], v[80:83], a[212:215], v[120:123]
  v_exp_f32 v111, v111
  v_mfma_f32_16x16x32_bf16 v[76:79], v[132:135], a[144:147], 0
  v_exp_f32 v72, v72
  v_mfma_f32_16x16x32_bf16 v[76:79], v[128:131], a[156:159], v[76:79]
  v_exp_f32 v73, v73
  v_mfma_f32_16x16x32_bf16 v[76:79], v[84:87], a[168:171], v[76:79]
  v_cvt_pk_bf16_f32 v140, v120, v121
  v_cvt_pk_bf16_f32 v141, v122, v123
  v_mfma_f32_16x16x32_bf16 v[76:79], a[252:255], a[180:183], v[76:79]
  ds_read_b128 v[88:91], v3 offset:0
  v_cvt_pk_bf16_f32 v104, v104, v105
  v_mfma_f32_16x16x32_bf16 v[76:79], a[248:251], a[192:195], v[76:79]
  ds_read_b128 v[92:95], v3 offset:4096
  v_cvt_pk_bf16_f32 v105, v106, v107
  v_mfma_f32_16x16x32_bf16 v[76:79], a[244:247], a[204:207], v[76:79]
  ds_read_b128 v[100:103], v3 offset:8192
  v_cvt_pk_bf16_f32 v106, v108, v109
  v_mfma_f32_16x16x32_bf16 v[80:83], a[244:247], a[208:211], 0
  ds_read_b128 v[120:123], v3 offset:12288
  v_cvt_pk_bf16_f32 v107, v110, v111
  v_mfma_f32_16x16x32_bf16 v[80:83], a[248:251], a[196:199], v[80:83]
  ds_read_b128 v[124:127], v3 offset:16384
  v_cvt_pk_bf16_f32 v108, v72, v73
  v_mfma_f32_16x16x32_bf16 v[80:83], a[252:255], a[184:187], v[80:83]
  v_cvt_pk_bf16_f32 v146, v76, v77
  v_cvt_pk_bf16_f32 v147, v78, v79
  v_mfma_f32_16x16x32_bf16 v[80:83], v[84:87], a[172:175], v[80:83]
  ds_read_b128 v[136:139], v3 offset:20480
  v_mfma_f32_16x16x32_bf16 v[80:83], v[128:131], a[160:163], v[80:83]
  v_exp_f32 v74, v74
  v_mfma_f32_16x16x32_bf16 v[80:83], v[132:135], a[148:151], v[80:83]
  v_exp_f32 v75, v75
  v_mfma_f32_16x16x32_bf16 v[76:79], v[132:135], a[152:155], 0
  v_exp_f32 v68, v68
  v_mfma_f32_16x16x32_bf16 v[76:79], v[128:131], a[164:167], v[76:79]
  v_exp_f32 v69, v69
  v_mfma_f32_16x16x32_bf16 v[76:79], v[84:87], a[176:179], v[76:79]
  v_cvt_pk_bf16_f32 v150, v80, v81
  v_cvt_pk_bf16_f32 v151, v82, v83
  v_mfma_f32_16x16x32_bf16 v[76:79], a[252:255], a[188:191], v[76:79]
  v_mov_b64 v[132:133], 0
  v_cvt_pk_bf16_f32 v109, v74, v75
  v_mfma_f32_16x16x32_bf16 v[76:79], a[248:251], a[200:203], v[76:79]
  v_exp_f32 v70, v70
  v_mfma_f32_16x16x32_bf16 v[76:79], a[244:247], a[212:215], v[76:79]
  s_waitcnt lgkmcnt(0)
  v_exp_f32 v71, v71
  v_mfma_f32_16x16x32_bf16 v[128:131], v[88:91], v[184:187], 0
  v_cvt_pk_bf16_f32 v110, v68, v69
  v_cvt_pk_bf16_f32 v111, v70, v71
  v_mfma_f32_16x16x32_bf16 v[128:131], v[92:95], v[200:203], v[128:131]
  v_mfma_f32_16x16x32_bf16 v[128:131], v[100:103], v[216:219], v[128:131]
  v_cvt_pk_bf16_f32 v142, v76, v77
  v_cvt_pk_bf16_f32 v143, v78, v79
  v_mfma_f32_16x16x32_bf16 v[128:131], v[120:123], v[232:235], v[128:131]
  v_mov_b64 v[96:97], 0
  v_mfma_f32_16x16x32_bf16 v[128:131], v[124:127], v[248:251], v[128:131]
  v_mfma_f32_16x16x32_bf16 v[128:131], v[136:139], a[224:227], v[128:131]
  v_smfmac_f32_16x16x64_bf16 v[132:135], a[240:243], v[112:119], v10
  v_mfma_f32_16x16x32_bf16 v[76:79], v[144:147], v[116:119], 0
  v_mfma_f32_16x16x32_bf16 v[76:79], v[56:59], v[112:115], v[76:79]
  v_mfma_f32_16x16x32_bf16 v[80:83], v[60:63], v[112:115], 0
  v_mfma_f32_16x16x32_bf16 v[80:83], v[148:151], v[116:119], v[80:83]
  v_mfma_f32_16x16x32_bf16 v[68:71], v[140:143], v[116:119], 0
  v_add_f32 v132, v132, v133
  v_mfma_f32_16x16x32_bf16 v[68:71], v[64:67], v[112:115], v[68:71]
  v_rcp_f32 v134, v132
  v_smfmac_f32_16x16x64_bf16 v[96:99], a[240:243], v[104:111], v10
  v_max3_f32 v9, v132, v134, v9
  v_mul_f32 v76, v134, v76
  v_mfma_f32_16x16x32_bf16 v[72:75], v[144:147], v[108:111], 0
  v_mul_f32 v77, v134, v77
  v_mul_f32 v78, v134, v78
  v_mfma_f32_16x16x32_bf16 v[72:75], v[56:59], v[104:107], v[72:75]
  v_mul_f32 v79, v134, v79
  v_cvt_pk_bf16_f32 v76, v76, v77
  v_mfma_f32_16x16x32_bf16 v[84:87], v[60:63], v[104:107], 0
  v_cvt_pk_bf16_f32 v77, v78, v79
  v_mul_f32 v80, v134, v80
  v_mfma_f32_16x16x32_bf16 v[84:87], v[148:151], v[108:111], v[84:87]
  v_mul_f32 v81, v134, v81
  v_mul_f32 v82, v134, v82
  v_mfma_f32_16x16x32_bf16 v[56:59], v[140:143], v[108:111], 0
  v_add_f32 v96, v96, v97
  v_mul_f32 v83, v134, v83
  v_mfma_f32_16x16x32_bf16 v[56:59], v[64:67], v[104:107], v[56:59]
  v_rcp_f32 v98, v96
  v_mfma_f32_16x16x32_bf16 v[60:63], v[136:139], a[228:231], 0
  v_cvt_pk_bf16_f32 v80, v80, v81
  v_cvt_pk_bf16_f32 v81, v82, v83
  v_mfma_f32_16x16x32_bf16 v[60:63], v[124:127], v[252:255], v[60:63]
  v_mul_f32 v68, v134, v68
  v_mul_f32 v69, v134, v69
  v_mfma_f32_16x16x32_bf16 v[60:63], v[120:123], v[236:239], v[60:63]
  ds_read_b128 v[104:107], v4 offset:0
  ds_read_b128 v[108:111], v4 offset:4096
  v_mfma_f32_16x16x32_bf16 v[60:63], v[100:103], v[220:223], v[60:63]
  ds_read_b128 v[116:119], v4 offset:8192
  ds_read_b128 v[140:143], v4 offset:12288
  v_mfma_f32_16x16x32_bf16 v[60:63], v[92:95], v[204:207], v[60:63]
  ds_read_b128 v[144:147], v4 offset:16384
  ds_read_b128 v[148:151], v4 offset:20480
  v_mfma_f32_16x16x32_bf16 v[60:63], v[88:91], v[188:191], v[60:63]
  v_mul_f32 v70, v134, v70
  v_mul_f32 v71, v134, v71
  v_mfma_f32_16x16x32_bf16 v[112:115], v[88:91], v[192:195], 0
  v_cvt_pk_bf16_f32 v68, v68, v69
  v_cvt_pk_bf16_f32 v69, v70, v71
  v_mfma_f32_16x16x32_bf16 v[112:115], v[92:95], v[208:211], v[112:115]
  v_max3_f32 v9, v96, v98, v9
  v_mul_f32 v72, v98, v72
  v_mfma_f32_16x16x32_bf16 v[112:115], v[100:103], v[224:227], v[112:115]
L_hop_1_2:
  s_cbranch_execz L_walk
  v_cvt_pk_bf16_f32 v128, v128, v60
  v_cvt_pk_bf16_f32 v129, v129, v61
  v_mfma_f32_16x16x32_bf16 v[112:115], v[120:123], v[240:243], v[112:115]
  v_cvt_pk_bf16_f32 v130, v130, v62
  v_cvt_pk_bf16_f32 v131, v131, v63
  v_mfma_f32_16x16x32_bf16 v[112:115], v[124:127], a[216:219], v[112:115]
  buffer_store_dword v128, v7, s[24:27], s33 offen offset:0 nt
  v_mfma_f32_16x16x32_bf16 v[112:115], v[136:139], a[232:235], v[112:115]
  v_mul_f32 v73, v98, v73
  v_mul_f32 v74, v98, v74
  v_mfma_f32_16x16x32_bf16 v[132:135], v[136:139], a[236:239], 0
  v_mul_f32 v75, v98, v75
  v_cvt_pk_bf16_f32 v72, v72, v73
  v_mfma_f32_16x16x32_bf16 v[132:135], v[124:127], a[220:223], v[132:135]
  buffer_store_dword v129, v7, s[24:27], s33 offen offset:384 nt
  v_mfma_f32_16x16x32_bf16 v[132:135], v[120:123], v[244:247], v[132:135]
  ds_read_b128 a[244:247], v3 offset:512
  ds_read_b128 a[248:251], v3 offset:4608
  v_mfma_f32_16x16x32_bf16 v[132:135], v[100:103], v[228:231], v[132:135]
  ds_read_b128 a[252:255], v3 offset:8704
  ds_read_b128 v[60:63], v3 offset:12800
  v_mfma_f32_16x16x32_bf16 v[132:135], v[92:95], v[212:215], v[132:135]
  buffer_store_dword v130, v7, s[24:27], s33 offen offset:768 nt
  v_mfma_f32_16x16x32_bf16 v[132:135], v[88:91], v[196:199], v[132:135]
  s_waitcnt lgkmcnt(4)
  ds_read_b128 v[64:67], v3 offset:16896
  ds_read_b128 v[92:95], v3 offset:20992
  v_mfma_f32_16x16x32_bf16 v[88:91], v[104:107], v[184:187], 0
  v_cvt_pk_bf16_f32 v73, v74, v75
  v_mul_f32 v84, v98, v84
  v_mfma_f32_16x16x32_bf16 v[88:91], v[108:111], v[200:203], v[88:91]
  buffer_store_dword v131, v7, s[24:27], s33 offen offset:1152 nt
  v_mfma_f32_16x16x32_bf16 v[88:91], v[116:119], v[216:219], v[88:91]
  v_cvt_pk_bf16_f32 v112, v112, v132
  v_cvt_pk_bf16_f32 v113, v113, v133
  v_mfma_f32_16x16x32_bf16 v[88:91], v[140:143], v[232:235], v[88:91]
  v_cvt_pk_bf16_f32 v114, v114, v134
  v_cvt_pk_bf16_f32 v115, v115, v135
  v_mfma_f32_16x16x32_bf16 v[88:91], v[144:147], v[248:251], v[88:91]
  buffer_store_dword v112, v8, s[24:27], s33 offen offset:0 nt
  v_mfma_f32_16x16x32_bf16 v[88:91], v[148:151], a[224:227], v[88:91]
  v_mul_f32 v85, v98, v85
  v_mul_f32 v86, v98, v86
  v_mfma_f32_16x16x32_bf16 v[120:123], v[148:151], a[228:231], 0
  v_mul_f32 v87, v98, v87
  v_cvt_pk_bf16_f32 v84, v84, v85
  v_mfma_f32_16x16x32_bf16 v[120:123], v[144:147], v[252:255], v[120:123]
  buffer_store_dword v113, v8, s[24:27], s33 offen offset:384 nt
  v_mfma_f32_16x16x32_bf16 v[120:123], v[140:143], v[236:239], v[120:123]
  v_cvt_pk_bf16_f32 v85, v86, v87
  v_mul_f32 v56, v98, v56
  v_mfma_f32_16x16x32_bf16 v[120:123], v[116:119], v[220:223], v[120:123]
  v_mul_f32 v57, v98, v57
  v_mul_f32 v58, v98, v58
  v_mfma_f32_16x16x32_bf16 v[120:123], v[108:111], v[204:207], v[120:123]
  buffer_store_dword v114, v8, s[24:27], s33 offen offset:768 nt
  v_mfma_f32_16x16x32_bf16 v[120:123], v[104:107], v[188:191], v[120:123]
  s_waitcnt lgkmcnt(0)
  v_mul_f32 v59, v98, v59
  v_cvt_pk_bf16_f32 v56, v56, v57
  v_mfma_f32_16x16x32_bf16 v[100:103], a[244:247], v[184:187], 0
  v_cvt_pk_bf16_f32 v57, v58, v59
  v_cmp_nge_f32 vcc, 0x53800000, v9
  v_mfma_f32_16x16x32_bf16 v[100:103], a[248:251], v[200:203], v[100:103]
  buffer_store_dword v115, v8, s[24:27], s33 offen offset:1152 nt
  v_mfma_f32_16x16x32_bf16 v[100:103], a[252:255], v[216:219], v[100:103]
  s_add_u32 s33, s33, s98
  v_cvt_pk_bf16_f32 v88, v88, v120
  v_cvt_pk_bf16_f32 v89, v89, v121
  v_mfma_f32_16x16x32_bf16 v[100:103], v[60:63], v[232:235], v[100:103]
  s_or_b32 s6, vcc_lo, vcc_hi
  v_cvt_pk_bf16_f32 v90, v90, v122
  v_cvt_pk_bf16_f32 v91, v91, v123
  v_mfma_f32_16x16x32_bf16 v[100:103], v[64:67], v[248:251], v[100:103]
  buffer_store_dword v88, v7, s[24:27], s34 offen offset:0 nt
  v_mfma_f32_16x16x32_bf16 v[100:103], v[92:95], a[224:227], v[100:103]
  ds_write2st64_b32 v5, v76, v77 offset0:0 offset1:4
  v_mfma_f32_16x16x32_bf16 v[96:99], v[92:95], a[228:231], 0
  ds_write2st64_b32 v5, v80, v81 offset0:8 offset1:12
  v_mfma_f32_16x16x32_bf16 v[96:99], v[64:67], v[252:255], v[96:99]
  buffer_store_dword v89, v7, s[24:27], s34 offen offset:384 nt
  v_mfma_f32_16x16x32_bf16 v[96:99], v[60:63], v[236:239], v[96:99]
  ds_read_b128 v[76:79], v4 offset:512
  ds_read_b128 v[80:83], v4 offset:4608
  v_mfma_f32_16x16x32_bf16 v[96:99], a[252:255], v[220:223], v[96:99]
  ds_write2st64_b32 v5, v68, v69 offset0:16 offset1:20
  v_mfma_f32_16x16x32_bf16 v[96:99], a[248:251], v[204:207], v[96:99]
  buffer_store_dword v90, v7, s[24:27], s34 offen offset:768 nt
  v_mfma_f32_16x16x32_bf16 v[96:99], a[244:247], v[188:191], v[96:99]
  ds_write2st64_b32 v5, v72, v73 offset0:1 offset1:5
  v_mfma_f32_16x16x32_bf16 v[68:71], a[244:247], v[192:195], 0
  ds_write2st64_b32 v5, v84, v85 offset0:9 offset1:13
  v_mfma_f32_16x16x32_bf16 v[68:71], a[248:251], v[208:211], v[68:71]
  buffer_store_dword v91, v7, s[24:27], s34 offen offset:1152 nt
  v_mfma_f32_16x16x32_bf16 v[68:71], a[252:255], v[224:227], v[68:71]
  s_add_u32 s34, s34, s98
  v_cvt_pk_bf16_f32 v100, v100, v96
  v_cvt_pk_bf16_f32 v101, v101, v97
  v_mfma_f32_16x16x32_bf16 v[68:71], v[60:63], v[240:243], v[68:71]
  v_cvt_pk_bf16_f32 v102, v102, v98
  v_cvt_pk_bf16_f32 v103, v103, v99
  v_mfma_f32_16x16x32_bf16 v[68:71], v[64:67], a[216:219], v[68:71]
  buffer_store_dword v100, v7, s[24:27], s35 offen offset:0 nt
  v_mfma_f32_16x16x32_bf16 v[68:71], v[92:95], a[232:235], v[68:71]
  ds_write2st64_b32 v5, v56, v57 offset0:17 offset1:21
  v_mfma_f32_16x16x32_bf16 v[96:99], v[92:95], a[236:239], 0
  ds_read_b128 v[84:87], v4 offset:8704
  v_mov_b32 v54, s6
  v_mfma_f32_16x16x32_bf16 v[96:99], v[64:67], a[220:223], v[96:99]
  buffer_store_dword v101, v7, s[24:27], s35 offen offset:384 nt
  v_mfma_f32_16x16x32_bf16 v[96:99], v[60:63], v[244:247], v[96:99]
  ds_read_b128 v[88:91], v4 offset:12800
  ds_read_b128 v[72:75], v4 offset:16896
  v_mfma_f32_16x16x32_bf16 v[96:99], a[252:255], v[228:231], v[96:99]
  ds_write_b32 v11, v54
  v_mfma_f32_16x16x32_bf16 v[96:99], a[248:251], v[212:215], v[96:99]
  buffer_store_dword v102, v7, s[24:27], s35 offen offset:768 nt
  v_mfma_f32_16x16x32_bf16 v[96:99], a[244:247], v[196:199], v[96:99]
  s_waitcnt lgkmcnt(8)
  ds_read_b128 v[64:67], v4 offset:20992
  v_xor_b32 v3, 40960, v3
  v_xor_b32 v4, 40960, v4
  v_mfma_f32_16x16x32_bf16 v[60:63], v[76:79], v[184:187], 0
  s_waitcnt lgkmcnt(1)
  s_barrier
  v_mfma_f32_16x16x32_bf16 v[60:63], v[80:83], v[200:203], v[60:63]
  buffer_store_dword v103, v7, s[24:27], s35 offen offset:1152 nt
  v_mfma_f32_16x16x32_bf16 v[60:63], v[84:87], v[216:219], v[60:63]
  v_cvt_pk_bf16_f32 v68, v68, v96
  v_cvt_pk_bf16_f32 v69, v69, v97
  v_mfma_f32_16x16x32_bf16 v[60:63], v[88:91], v[232:235], v[60:63]
  s_waitcnt lgkmcnt(0)
  v_cvt_pk_bf16_f32 v70, v70, v98
  v_cvt_pk_bf16_f32 v71, v71, v99
  v_mfma_f32_16x16x32_bf16 v[60:63], v[72:75], v[248:251], v[60:63]
  buffer_store_dword v68, v8, s[24:27], s35 offen offset:0 nt
  v_mfma_f32_16x16x32_bf16 v[60:63], v[64:67], a[224:227], v[60:63]
  ds_read_b128 a[244:247], v3 offset:0
  ds_read_b128 a[248:251], v3 offset:4096
  v_mfma_f32_16x16x32_bf16 v[92:95], v[64:67], a[228:231], 0
  ds_read_b128 a[252:255], v3 offset:8192
  ds_read_b128 v[56:59], v3 offset:12288
  v_mfma_f32_16x16x32_bf16 v[92:95], v[72:75], v[252:255], v[92:95]
  buffer_store_dword v69, v8, s[24:27], s35 offen offset:384 nt
  v_mfma_f32_16x16x32_bf16 v[92:95], v[88:91], v[236:239], v[92:95]
  ds_read_b128 v[64:67], v3 offset:16384
  ds_read_b128 v[72:75], v3 offset:20480
  v_mfma_f32_16x16x32_bf16 v[92:95], v[84:87], v[220:223], v[92:95]
  v_mov_b32 v11, 159744
  v_mfma_f32_16x16x32_bf16 v[92:95], v[80:83], v[204:207], v[92:95]
  buffer_store_dword v70, v8, s[24:27], s35 offen offset:768 nt
  v_mfma_f32_16x16x32_bf16 v[92:95], v[76:79], v[188:191], v[92:95]
  s_waitcnt lgkmcnt(2)
  ds_read2_b32 v[80:81], v11 offset0:0 offset1:2
  ds_read2_b32 v[82:83], v11 offset0:4 offset1:6
  v_mfma_f32_16x16x32_bf16 v[76:79], a[244:247], v[184:187], 0
  buffer_store_dword v71, v8, s[24:27], s35 offen offset:1152 nt
  v_mfma_f32_16x16x32_bf16 v[76:79], a[248:251], v[200:203], v[76:79]
  v_mfma_f32_16x16x32_bf16 v[76:79], a[252:255], v[216:219], v[76:79]
  v_cvt_pk_bf16_f32 v60, v60, v92
  v_cvt_pk_bf16_f32 v61, v61, v93
  v_mfma_f32_16x16x32_bf16 v[76:79], v[56:59], v[232:235], v[76:79]
  s_waitcnt lgkmcnt(2)
  v_cvt_pk_bf16_f32 v62, v62, v94
  v_cvt_pk_bf16_f32 v63, v63, v95
  v_mfma_f32_16x16x32_bf16 v[76:79], v[64:67], v[248:251], v[76:79]
  buffer_store_dword v60, v7, s[24:27], s36 offen offset:0 nt
  v_mfma_f32_16x16x32_bf16 v[76:79], v[72:75], a[224:227], v[76:79]
  s_waitcnt lgkmcnt(0)
  v_or3_b32 v80, v80, v81, v82
  v_or_b32 v80, v80, v83
  v_mfma_f32_16x16x32_bf16 v[100:103], v[72:75], a[228:231], 0
  buffer_store_dword v61, v7, s[24:27], s36 offen offset:384 nt
  v_mfma_f32_16x16x32_bf16 v[100:103], v[64:67], v[252:255], v[100:103]
  v_readfirstlane_b32 s49, v80
  v_mfma_f32_16x16x32_bf16 v[100:103], v[56:59], v[236:239], v[100:103]
  buffer_store_dword v62, v7, s[24:27], s36 offen offset:768 nt
  v_mfma_f32_16x16x32_bf16 v[100:103], a[252:255], v[220:223], v[100:103]
  ds_read_b128 v[68:71], v4 offset:0
  ds_read_b128 v[80:83], v4 offset:4096
  v_mfma_f32_16x16x32_bf16 v[100:103], a[248:251], v[204:207], v[100:103]
  buffer_store_dword v63, v7, s[24:27], s36 offen offset:1152 nt
  v_mfma_f32_16x16x32_bf16 v[100:103], a[244:247], v[188:191], v[100:103]
  ds_read_b128 v[84:87], v4 offset:8192
  ds_read_b128 v[88:91], v4 offset:12288
  v_mfma_f32_16x16x32_bf16 v[60:63], a[244:247], v[192:195], 0
  ds_read_b128 v[92:95], v4 offset:16384
  ds_read_b128 v[96:99], v4 offset:20480
  v_mfma_f32_16x16x32_bf16 v[60:63], a[248:251], v[208:211], v[60:63]
  v_mfma_f32_16x16x32_bf16 v[60:63], a[252:255], v[224:227], v[60:63]
  v_cvt_pk_bf16_f32 v76, v76, v100
  v_cvt_pk_bf16_f32 v77, v77, v101
  v_mfma_f32_16x16x32_bf16 v[60:63], v[56:59], v[240:243], v[60:63]
  v_cvt_pk_bf16_f32 v78, v78, v102
  v_cvt_pk_bf16_f32 v79, v79, v103
  v_mfma_f32_16x16x32_bf16 v[60:63], v[64:67], a[216:219], v[60:63]
  buffer_store_dword v76, v7, s[24:27], s33 offen offset:0 nt
  v_mfma_f32_16x16x32_bf16 v[60:63], v[72:75], a[232:235], v[60:63]
  v_mfma_f32_16x16x32_bf16 v[100:103], v[72:75], a[236:239], 0
  buffer_store_dword v77, v7, s[24:27], s33 offen offset:384 nt
  v_mfma_f32_16x16x32_bf16 v[100:103], v[64:67], a[220:223], v[100:103]
  v_mfma_f32_16x16x32_bf16 v[100:103], v[56:59], v[244:247], v[100:103]
  buffer_store_dword v78, v7, s[24:27], s33 offen offset:768 nt
  v_mfma_f32_16x16x32_bf16 v[100:103], a[252:255], v[228:231], v[100:103]
  v_mfma_f32_16x16x32_bf16 v[100:103], a[248:251], v[212:215], v[100:103]
  buffer_store_dword v79, v7, s[24:27], s33 offen offset:1152 nt
  v_mfma_f32_16x16x32_bf16 v[100:103], a[244:247], v[196:199], v[100:103]
  s_waitcnt lgkmcnt(0)
  v_mfma_f32_16x16x32_bf16 v[56:59], v[68:71], v[184:187], 0
  v_mfma_f32_16x16x32_bf16 v[56:59], v[80:83], v[200:203], v[56:59]
  v_mfma_f32_16x16x32_bf16 v[56:59], v[84:87], v[216:219], v[56:59]
  v_cvt_pk_bf16_f32 v60, v60, v100
  v_cvt_pk_bf16_f32 v61, v61, v101
  v_mfma_f32_16x16x32_bf16 v[56:59], v[88:91], v[232:235], v[56:59]
  v_cvt_pk_bf16_f32 v62, v62, v102
  v_cvt_pk_bf16_f32 v63, v63, v103
  v_mfma_f32_16x16x32_bf16 v[56:59], v[92:95], v[248:251], v[56:59]
  buffer_store_dword v60, v8, s[24:27], s33 offen offset:0 nt
  v_mfma_f32_16x16x32_bf16 v[56:59], v[96:99], a[224:227], v[56:59]
  v_mfma_f32_16x16x32_bf16 v[64:67], v[96:99], a[228:231], 0
  buffer_store_dword v61, v8, s[24:27], s33 offen offset:384 nt
  v_mfma_f32_16x16x32_bf16 v[64:67], v[92:95], v[252:255], v[64:67]
  v_mfma_f32_16x16x32_bf16 v[64:67], v[88:91], v[236:239], v[64:67]
  buffer_store_dword v62, v8, s[24:27], s33 offen offset:768 nt
  v_mfma_f32_16x16x32_bf16 v[64:67], v[84:87], v[220:223], v[64:67]
  v_mfma_f32_16x16x32_bf16 v[64:67], v[80:83], v[204:207], v[64:67]
  buffer_store_dword v63, v8, s[24:27], s33 offen offset:1152 nt
  v_mfma_f32_16x16x32_bf16 v[64:67], v[68:71], v[188:191], v[64:67]
  s_nop 7
  v_cvt_pk_bf16_f32 v56, v56, v64
  v_cvt_pk_bf16_f32 v57, v57, v65
  v_cvt_pk_bf16_f32 v58, v58, v66
  v_cvt_pk_bf16_f32 v59, v59, v67
  buffer_store_dword v56, v7, s[24:27], s34 offen offset:0 nt
  buffer_store_dword v57, v7, s[24:27], s34 offen offset:384 nt
  buffer_store_dword v58, v7, s[24:27], s34 offen offset:768 nt
  buffer_store_dword v59, v7, s[24:27], s34 offen offset:1152 nt
  s_cmp_lg_u32 s49, 0
  s_cbranch_scc1 L_safe
  s_endpgm
L_hop_2_2:
  s_cbranch_execz L_walk
L_pad4469:
L_k11:
  s_cmp_lg_u32 s59, 11
  s_cbranch_scc1 L_k12
  v_mfma_f32_16x16x32_bf16 v[104:107], a[0:3], v[88:91], 0
  v_mov_b32 v54, s12
  v_mov_b32 v55, s13
  v_mfma_f32_16x16x32_bf16 v[104:107], a[12:15], v[92:95], v[104:107]
  v_mov_b32 v74, 159808
  v_mfma_f32_16x16x32_bf16 v[104:107], a[24:27], v[96:99], v[104:107]
  v_cvt_pk_bf16_f32 v66, v128, v129
  v_cvt_pk_bf16_f32 v67, v130, v131
  v_mfma_f32_16x16x32_bf16 v[104:107], a[36:39], v[136:139], v[104:107]
  ds_read_b128 v[112:115], v74
  v_mfma_f32_16x16x32_bf16 v[104:107], a[48:51], v[140:143], v[104:107]
  s_waitcnt lgkmcnt(1)
  v_mfma_f32_16x16x32_bf16 v[104:107], a[60:63], v[80:83], v[104:107]
  v_mfma_f32_16x16x32_bf16 v[84:87], a[64:67], v[80:83], 0
  v_mfma_f32_16x16x32_bf16 v[84:87], a[52:55], v[140:143], v[84:87]
  v_mfma_f32_16x16x32_bf16 v[84:87], a[40:43], v[136:139], v[84:87]
  s_waitcnt lgkmcnt(0)
  v_mul_f32 v104, s42, v104
  v_mul_f32 v105, s42, v105
  v_mfma_f32_16x16x32_bf16 v[84:87], a[28:31], v[96:99], v[84:87]
  v_mul_f32 v106, s42, v106
  v_mul_f32 v107, s42, v107
  v_mfma_f32_16x16x32_bf16 v[84:87], a[16:19], v[92:95], v[84:87]
  v_cvt_pk_bf16_f32 v18, v104, v105
  v_cvt_pk_bf16_f32 v19, v106, v107
  v_mfma_f32_16x16x32_bf16 v[84:87], a[4:7], v[88:91], v[84:87]
  v_and_b32 v112, v112, v113
  v_and_b32 v114, v114, v115
  v_mfma_f32_16x16x32_bf16 v[108:111], a[8:11], v[88:91], 0
  v_and_b32 v112, v112, v114
  v_mfma_f32_16x16x32_bf16 v[108:111], a[20:23], v[92:95], v[108:111]
  v_readfirstlane_b32 s49, v112
  v_mfma_f32_16x16x32_bf16 v[108:111], a[32:35], v[96:99], v[108:111]
  v_mul_f32 v84, s42, v84
  v_mul_f32 v85, s42, v85
  v_mfma_f32_16x16x32_bf16 v[108:111], a[44:47], v[136:139], v[108:111]
  s_cmp_lg_u32 s49, 0
  v_mul_f32 v86, s42, v86
  v_mul_f32 v87, s42, v87
  v_mfma_f32_16x16x32_bf16 v[108:111], a[56:59], v[140:143], v[108:111]
  s_cselect_b32 s49, s44, s22
  v_cvt_pk_bf16_f32 v104, v84, v85
  v_cvt_pk_bf16_f32 v105, v86, v87
  v_mfma_f32_16x16x32_bf16 v[108:111], a[68:71], v[80:83], v[108:111]
  s_cselect_b32 s96, 4096, s96
  v_mfma_f32_16x16x32_bf16 v[112:115], a[132:135], v[80:83], 0
  buffer_store_dwordx2 v[54:55], off, s[20:23], s49 sc1
  v_mfma_f32_16x16x32_bf16 v[112:115], a[120:123], v[140:143], v[112:115]
  s_branch L_r227
L_k12:
  s_cmp_lg_u32 s45, 2
  s_cbranch_scc1 L_k12g
  v_mfma_f32_16x16x32_bf16 v[104:107], a[0:3], v[88:91], 0
  s_sub_u32 s49, s44, 2097152
  s_lshr_b32 s49, s49, 9
  s_lshr_b32 s52, s49, 6
  v_mfma_f32_16x16x32_bf16 v[104:107], a[12:15], v[92:95], v[104:107]
  s_and_b32 s53, s49, 63
  s_mul_i32 s50, s52, 15
  s_lshl_b32 s51, s57, 5
  v_mfma_f32_16x16x32_bf16 v[104:107], a[24:27], v[96:99], v[104:107]
  s_cmp_eq_u32 s53, 63
  v_cvt_pk_bf16_f32 v66, v128, v129
  v_cvt_pk_bf16_f32 v67, v130, v131
  v_mfma_f32_16x16x32_bf16 v[104:107], a[36:39], v[136:139], v[104:107]
  s_cselect_b32 s53, s50, s53
  s_cselect_b32 s52, 60, s52
  s_cselect_b32 s51, 3072, s51
  v_mfma_f32_16x16x32_bf16 v[104:107], a[48:51], v[140:143], v[104:107]
  s_waitcnt lgkmcnt(0)
  s_mul_i32 s52, s52, 1572864
  s_mul_i32 s53, s53, 3072
  v_mfma_f32_16x16x32_bf16 v[104:107], a[60:63], v[80:83], v[104:107]
  s_add_u32 s52, s52, s53
  s_add_u32 s50, s52, 787968
  s_cmp_eq_u32 s51, 3072
  v_mfma_f32_16x16x32_bf16 v[84:87], a[64:67], v[80:83], 0
  s_cselect_b32 s10, 100663296, s10
  s_sub_u32 s51, s51, s43
  s_mul_i32 s51, s51, 14
  v_mfma_f32_16x16x32_bf16 v[84:87], a[52:55], v[140:143], v[84:87]
  s_sub_u32 s50, s50, s56
  s_add_u32 s58, s50, s51
  s_mul_i32 s50, s14, 98304
  v_mfma_f32_16x16x32_bf16 v[84:87], a[40:43], v[136:139], v[84:87]
  s_add_u32 s98, s58, s50
  v_mul_f32 v104, s42, v104
  v_mul_f32 v105, s42, v105
  v_mfma_f32_16x16x32_bf16 v[84:87], a[28:31], v[96:99], v[84:87]
  s_sub_u32 s49, s98, s43
  v_mul_f32 v106, s42, v106
  v_mul_f32 v107, s42, v107
  v_mfma_f32_16x16x32_bf16 v[84:87], a[16:19], v[92:95], v[84:87]
  s_add_u32 s31, s31, s49
  v_cvt_pk_bf16_f32 v18, v104, v105
  v_cvt_pk_bf16_f32 v19, v106, v107
  v_mfma_f32_16x16x32_bf16 v[84:87], a[4:7], v[88:91], v[84:87]
  s_add_u32 s32, s32, s49
  s_lshl_b32 s50, s50, 1
  s_sub_u32 s32, s32, s50
  v_mfma_f32_16x16x32_bf16 v[108:111], a[8:11], v[88:91], 0
  s_sub_u32 s37, s37, s49
  s_sub_u32 s38, s38, s49
  s_sub_u32 s39, s39, s49
  v_mfma_f32_16x16x32_bf16 v[108:111], a[20:23], v[92:95], v[108:111]
  s_sub_u32 s40, s40, s49
  s_lshl_b32 s49, s14, 2
  s_add_u32 s97, s49, 15
  v_mfma_f32_16x16x32_bf16 v[108:111], a[32:35], v[96:99], v[108:111]
  s_mov_b32 s45, 4
  v_mul_f32 v84, s42, v84
  v_mul_f32 v85, s42, v85
  v_mfma_f32_16x16x32_bf16 v[108:111], a[44:47], v[136:139], v[108:111]
  s_mov_b32 s96, 32768
  v_mul_f32 v86, s42, v86
  v_mul_f32 v87, s42, v87
  v_mfma_f32_16x16x32_bf16 v[108:111], a[56:59], v[140:143], v[108:111]
  s_mov_b64 s[100:101], -1
  v_cvt_pk_bf16_f32 v104, v84, v85
  v_cvt_pk_bf16_f32 v105, v86, v87
  v_mfma_f32_16x16x32_bf16 v[108:111], a[68:71], v[80:83], v[108:111]
  s_branch L_r225
L_k12g:
  s_cmp_lg_u32 s59, 12
  s_cbranch_scc1 L_k13
  s_waitcnt vmcnt(30)
  v_mfma_f32_16x16x32_bf16 v[104:107], a[0:3], v[88:91], 0
  v_cmp_eq_u64 vcc, s[12:13], v[52:53]
  v_mfma_f32_16x16x32_bf16 v[104:107], a[12:15], v[92:95], v[104:107]
  v_mfma_f32_16x16x32_bf16 v[104:107], a[24:27], v[96:99], v[104:107]
  s_and_b32 s49, vcc_lo, 1
  v_cvt_pk_bf16_f32 v66, v128, v129
  v_cvt_pk_bf16_f32 v67, v130, v131
  v_mfma_f32_16x16x32_bf16 v[104:107], a[36:39], v[136:139], v[104:107]
  s_lshl_b32 s49, s49, s14
  s_lshl_b32 s54, s3, 2
  s_add_u32 s54, s54, 159824
  v_mfma_f32_16x16x32_bf16 v[104:107], a[48:51], v[140:143], v[104:107]
  s_waitcnt lgkmcnt(0)
  v_mov_b32 v54, s54
  v_mov_b32 v55, s49
  v_mfma_f32_16x16x32_bf16 v[104:107], a[60:63], v[80:83], v[104:107]
  ds_write_b32 v54, v55
  v_mfma_f32_16x16x32_bf16 v[84:87], a[64:67], v[80:83], 0
  v_mfma_f32_16x16x32_bf16 v[84:87], a[52:55], v[140:143], v[84:87]
  v_mfma_f32_16x16x32_bf16 v[84:87], a[40:43], v[136:139], v[84:87]
  v_mul_f32 v104, s42, v104
  v_mul_f32 v105, s42, v105
  v_mfma_f32_16x16x32_bf16 v[84:87], a[28:31], v[96:99], v[84:87]
  s_waitcnt lgkmcnt(0)
  v_mul_f32 v106, s42, v106
  v_mul_f32 v107, s42, v107
  v_mfma_f32_16x16x32_bf16 v[84:87], a[16:19], v[92:95], v[84:87]
  v_cvt_pk_bf16_f32 v18, v104, v105
  v_cvt_pk_bf16_f32 v19, v106, v107
  v_mfma_f32_16x16x32_bf16 v[84:87], a[4:7], v[88:91], v[84:87]
  s_branch L_r219
L_k13:
  v_mov_b32 v54, 159824
  ds_read_b128 v[84:87], v54
  s_waitcnt lgkmcnt(0)
  v_and_b32 v84, v84, v85
  v_and_b32 v86, v86, v87
  v_and_b32 v84, v84, v86
  s_nop 0
  v_readfirstlane_b32 s49, v84
  s_nop 3
  s_lshr_b32 s50, s49, 3
  s_add_u32 s97, s97, s50
  s_cmp_eq_u32 s49, 1
  s_cselect_b32 s45, 3, 0
  s_cbranch_scc1 L_full
  s_branch L_loop
L_safe:
  s_nop 15
  s_waitcnt vmcnt(0) lgkmcnt(0)
  s_mov_b32 s10, 100663296
  v_mbcnt_lo_u32_b32 v58, -1, 0
  v_mbcnt_hi_u32_b32 v58, -1, v58
  v_lshrrev_b32 v59, 2, v58
  v_and_b32 v59, 4, v59
  v_xor_b32 v60, v59, v58
  s_cmp_eq_u32 s47, 63
  s_cselect_b32 s5, 4, 0
  v_and_b32 v60, s5, v60
  v_cmp_eq_u32 vcc, 0, v60
  s_cmp_eq_u32 s48, 63
  s_cselect_b32 s5, 0xc31044fe, 0
  v_mov_b32 v55, s5
  v_mov_b32 v54, 0xc31044fe
  v_cndmask_b32 v55, 0, v55, vcc
  v_cndmask_b32 v54, v54, 0, vcc
  v_add_u32 v0, s46, v2
  v_xor_b32 v1, 64, v0
  s_lshl_b32 s5, s48, 3
  s_add_u32 s5, s5, s3
  s_add_u32 s5, s5, 4
  s_mul_i32 s31, s5, s57
  s_add_u32 s5, s5, 4
  s_and_b32 s5, s5, 511
  s_mul_i32 s32, s5, s57
  v_lshrrev_b32 v59, 2, v59
  s_lshl_b32 s5, s47, 3
  s_add_u32 s5, s5, 4
  s_mul_i32 s5, s5, 384
  s_cmp_eq_u32 s47, 63
  s_cselect_b32 s49, 0, s5
  s_cselect_b32 s5, s5, 0
  s_cselect_b32 s6, s57, 0
  v_mul_u32_u24 v57, s6, v59
  v_sub_u32 v57, s5, v57
  s_lshl_b32 s50, s48, 3
  s_add_u32 s50, s50, 4
  s_xor_b32 s6, s4, 0
  s_lshl_b32 s6, s6, 1
  s_add_u32 s6, s6, s50
  s_and_b32 s6, s6, 511
  s_mul_i32 s6, s6, s57
  s_add_u32 s33, s6, s49
  s_xor_b32 s6, s4, 1
  s_lshl_b32 s6, s6, 1
  s_add_u32 s6, s6, s50
  s_and_b32 s6, s6, 511
  s_mul_i32 s6, s6, s57
  s_add_u32 s34, s6, s49
  s_xor_b32 s6, s4, 2
  s_lshl_b32 s6, s6, 1
  s_add_u32 s6, s6, s50
  s_and_b32 s6, s6, 511
  s_mul_i32 s6, s6, s57
  s_add_u32 s35, s6, s49
  s_xor_b32 s6, s4, 3
  s_lshl_b32 s6, s6, 1
  s_add_u32 s6, s6, s50
  s_and_b32 s6, s6, 511
  s_mul_i32 s6, s6, s57
  s_add_u32 s36, s6, s49
  s_lshl_b32 s5, s47, 3
  s_add_u32 s5, s5, 4
  v_lshrrev_b32 v59, 3, v58
  v_add_u32 v60, s5, v59
  v_and_b32 v60, 511, v60
  v_sub_u32 v60, v60, v59
  v_mul_i32_i24 v56, 0x180, v60
  v_add_u32 v6, v6, v56
  v_add_u32 v7, v7, v57
  v_add_u32 v8, v8, v57
  v_add_f32 v55, v54, v55
  s_cmp_eq_u32 s45, 3
  s_cselect_b32 s49, 15, 16
  s_cmp_eq_u32 s45, 4
  s_cselect_b32 s49, 17, s49
  s_mov_b32 s50, 0
  s_sub_u32 s56, s56, s43
  s_nop 7
L_sloop:
  s_barrier
  s_add_u32 m0, s46, 0
  s_nop 0
  buffer_load_dwordx4 v6, s[8:11], s31 offen offset:0 nt lds
  s_add_u32 m0, s46, 8064
  s_nop 0
  buffer_load_dwordx4 v6, s[8:11], s31 offen offset:128 nt lds
  s_add_u32 m0, s46, 16128
  s_nop 0
  buffer_load_dwordx4 v6, s[8:11], s31 offen offset:256 nt lds
  s_add_u32 m0, s46, 4096
  s_nop 0
  buffer_load_dwordx4 v6, s[8:11], s32 offen offset:0 nt lds
  s_add_u32 m0, s46, 12160
  s_nop 0
  buffer_load_dwordx4 v6, s[8:11], s32 offen offset:128 nt lds
  s_add_u32 m0, s46, 20224
  s_nop 0
  buffer_load_dwordx4 v6, s[8:11], s32 offen offset:256 nt lds
  s_waitcnt vmcnt(0)
  s_barrier
  ds_read_b128 a[244:247], v0 offset:0
  ds_read_b128 a[248:251], v1 offset:0
  ds_read_b128 a[252:255], v0 offset:8192
  ds_read_b128 v[76:79], v1 offset:8192
  ds_read_b128 v[80:83], v0 offset:16384
  ds_read_b128 v[84:87], v1 offset:16384
  s_waitcnt lgkmcnt(5)
  v_mfma_f32_16x16x32_bf16 v[68:71], a[0:3], a[244:247], 0
  s_waitcnt lgkmcnt(4)
  v_mfma_f32_16x16x32_bf16 v[68:71], a[12:15], a[248:251], v[68:71]
  s_waitcnt lgkmcnt(3)
  v_mfma_f32_16x16x32_bf16 v[68:71], a[24:27], a[252:255], v[68:71]
  s_waitcnt lgkmcnt(2)
  v_mfma_f32_16x16x32_bf16 v[68:71], a[36:39], v[76:79], v[68:71]
  s_waitcnt lgkmcnt(1)
  v_mfma_f32_16x16x32_bf16 v[68:71], a[48:51], v[80:83], v[68:71]
  s_waitcnt lgkmcnt(0)
  v_mfma_f32_16x16x32_bf16 v[68:71], a[60:63], v[84:87], v[68:71]
  v_mfma_f32_16x16x32_bf16 v[60:63], a[64:67], v[84:87], 0
  v_mfma_f32_16x16x32_bf16 v[60:63], a[52:55], v[80:83], v[60:63]
  v_mfma_f32_16x16x32_bf16 v[60:63], a[40:43], v[76:79], v[60:63]
  v_mfma_f32_16x16x32_bf16 v[60:63], a[28:31], a[252:255], v[60:63]
  v_mfma_f32_16x16x32_bf16 v[60:63], a[16:19], a[248:251], v[60:63]
  v_mfma_f32_16x16x32_bf16 v[60:63], a[4:7], a[244:247], v[60:63]
  v_mul_f32 v68, s42, v68
  v_mul_f32 v69, s42, v69
  v_mul_f32 v70, s42, v70
  v_mul_f32 v71, s42, v71
  v_cvt_pk_bf16_f32 v12, v68, v69
  v_cvt_pk_bf16_f32 v13, v70, v71
  v_mfma_f32_16x16x32_bf16 v[64:67], a[8:11], a[244:247], 0
  v_mfma_f32_16x16x32_bf16 v[64:67], a[20:23], a[248:251], v[64:67]
  v_mfma_f32_16x16x32_bf16 v[64:67], a[32:35], a[252:255], v[64:67]
  v_mfma_f32_16x16x32_bf16 v[64:67], a[44:47], v[76:79], v[64:67]
  v_mfma_f32_16x16x32_bf16 v[64:67], a[56:59], v[80:83], v[64:67]
  v_mfma_f32_16x16x32_bf16 v[64:67], a[68:71], v[84:87], v[64:67]
  v_mul_f32 v60, s42, v60
  v_mul_f32 v61, s42, v61
  v_mul_f32 v62, s42, v62
  v_mul_f32 v63, s42, v63
  v_cvt_pk_bf16_f32 v128, v60, v61
  v_cvt_pk_bf16_f32 v129, v62, v63
  v_mfma_f32_16x16x32_bf16 v[68:71], a[132:135], v[84:87], 0
  v_mfma_f32_16x16x32_bf16 v[68:71], a[120:123], v[80:83], v[68:71]
  v_mfma_f32_16x16x32_bf16 v[68:71], a[108:111], v[76:79], v[68:71]
  v_mfma_f32_16x16x32_bf16 v[68:71], a[96:99], a[252:255], v[68:71]
  v_mfma_f32_16x16x32_bf16 v[68:71], a[84:87], a[248:251], v[68:71]
  v_mfma_f32_16x16x32_bf16 v[68:71], a[72:75], a[244:247], v[68:71]
  v_mul_f32 v64, s42, v64
  v_mul_f32 v65, s42, v65
  v_mul_f32 v66, s42, v66
  v_mul_f32 v67, s42, v67
  v_cvt_pk_bf16_f32 v130, v64, v65
  v_cvt_pk_bf16_f32 v131, v66, v67
  v_mfma_f32_16x16x32_bf16 v[72:75], a[76:79], a[244:247], 0
  v_mfma_f32_16x16x32_bf16 v[72:75], a[88:91], a[248:251], v[72:75]
  v_mfma_f32_16x16x32_bf16 v[72:75], a[100:103], a[252:255], v[72:75]
  v_mfma_f32_16x16x32_bf16 v[72:75], a[112:115], v[76:79], v[72:75]
  v_mfma_f32_16x16x32_bf16 v[72:75], a[124:127], v[80:83], v[72:75]
  v_mfma_f32_16x16x32_bf16 v[72:75], a[136:139], v[84:87], v[72:75]
  v_cvt_pk_bf16_f32 v60, v68, v69
  v_cvt_pk_bf16_f32 v61, v70, v71
  v_mfma_f32_16x16x32_bf16 v[88:91], a[140:143], v[84:87], 0
  v_mfma_f32_16x16x32_bf16 v[88:91], a[128:131], v[80:83], v[88:91]
  v_mfma_f32_16x16x32_bf16 v[88:91], a[116:119], v[76:79], v[88:91]
  v_mfma_f32_16x16x32_bf16 v[88:91], a[104:107], a[252:255], v[88:91]
  v_mfma_f32_16x16x32_bf16 v[88:91], a[92:95], a[248:251], v[88:91]
  v_mfma_f32_16x16x32_bf16 v[88:91], a[80:83], a[244:247], v[88:91]
  v_cvt_pk_bf16_f32 v62, v72, v73
  v_cvt_pk_bf16_f32 v63, v74, v75
  v_mfma_f32_16x16x32_bf16 v[92:95], a[244:247], a[144:147], 0
  v_mfma_f32_16x16x32_bf16 v[92:95], a[248:251], a[156:159], v[92:95]
  v_mfma_f32_16x16x32_bf16 v[92:95], a[252:255], a[168:171], v[92:95]
  v_mfma_f32_16x16x32_bf16 v[92:95], v[76:79], a[180:183], v[92:95]
  v_mfma_f32_16x16x32_bf16 v[92:95], v[80:83], a[192:195], v[92:95]
  v_mfma_f32_16x16x32_bf16 v[92:95], v[84:87], a[204:207], v[92:95]
  v_cvt_pk_bf16_f32 v64, v88, v89
  v_cvt_pk_bf16_f32 v65, v90, v91
  v_mfma_f32_16x16x32_bf16 v[96:99], v[84:87], a[208:211], 0
  v_mfma_f32_16x16x32_bf16 v[96:99], v[80:83], a[196:199], v[96:99]
  v_mfma_f32_16x16x32_bf16 v[96:99], v[76:79], a[184:187], v[96:99]
  v_mfma_f32_16x16x32_bf16 v[96:99], a[252:255], a[172:175], v[96:99]
  v_mfma_f32_16x16x32_bf16 v[96:99], a[248:251], a[160:163], v[96:99]
  v_mfma_f32_16x16x32_bf16 v[96:99], a[244:247], a[148:151], v[96:99]
  v_cvt_pk_bf16_f32 v68, v92, v93
  v_cvt_pk_bf16_f32 v69, v94, v95
  v_mfma_f32_16x16x32_bf16 v[104:107], a[244:247], a[152:155], 0
  v_mfma_f32_16x16x32_bf16 v[104:107], a[248:251], a[164:167], v[104:107]
  v_mfma_f32_16x16x32_bf16 v[104:107], a[252:255], a[176:179], v[104:107]
  v_mfma_f32_16x16x32_bf16 v[104:107], v[76:79], a[188:191], v[104:107]
  v_mfma_f32_16x16x32_bf16 v[104:107], v[80:83], a[200:203], v[104:107]
  v_mfma_f32_16x16x32_bf16 v[104:107], v[84:87], a[212:215], v[104:107]
  v_cvt_pk_bf16_f32 v72, v96, v97
  v_cvt_pk_bf16_f32 v73, v98, v99
  s_nop 5
  v_cvt_pk_bf16_f32 v76, v104, v105
  v_cvt_pk_bf16_f32 v77, v106, v107
  ds_read_b128 a[244:247], v0 offset:2048
  ds_read_b128 a[248:251], v1 offset:2048
  ds_read_b128 a[252:255], v0 offset:10240
  ds_read_b128 v[88:91], v1 offset:10240
  ds_read_b128 v[92:95], v0 offset:18432
  ds_read_b128 v[96:99], v1 offset:18432
  s_waitcnt lgkmcnt(5)
  v_mfma_f32_16x16x32_bf16 v[100:103], a[0:3], a[244:247], 0
  s_waitcnt lgkmcnt(4)
  v_mfma_f32_16x16x32_bf16 v[100:103], a[12:15], a[248:251], v[100:103]
  s_waitcnt lgkmcnt(3)
  v_mfma_f32_16x16x32_bf16 v[100:103], a[24:27], a[252:255], v[100:103]
  s_waitcnt lgkmcnt(2)
  v_mfma_f32_16x16x32_bf16 v[100:103], a[36:39], v[88:91], v[100:103]
  s_waitcnt lgkmcnt(1)
  v_mfma_f32_16x16x32_bf16 v[100:103], a[48:51], v[92:95], v[100:103]
  s_waitcnt lgkmcnt(0)
  v_mfma_f32_16x16x32_bf16 v[100:103], a[60:63], v[96:99], v[100:103]
  v_mfma_f32_16x16x32_bf16 v[80:83], a[64:67], v[96:99], 0
  v_mfma_f32_16x16x32_bf16 v[80:83], a[52:55], v[92:95], v[80:83]
  v_mfma_f32_16x16x32_bf16 v[80:83], a[40:43], v[88:91], v[80:83]
  v_mfma_f32_16x16x32_bf16 v[80:83], a[28:31], a[252:255], v[80:83]
  v_mfma_f32_16x16x32_bf16 v[80:83], a[16:19], a[248:251], v[80:83]
  v_mfma_f32_16x16x32_bf16 v[80:83], a[4:7], a[244:247], v[80:83]
  v_mul_f32 v100, s42, v100
  v_mul_f32 v101, s42, v101
  v_mul_f32 v102, s42, v102
  v_mul_f32 v103, s42, v103
  v_cvt_pk_bf16_f32 v124, v100, v101
  v_cvt_pk_bf16_f32 v125, v102, v103
  v_mfma_f32_16x16x32_bf16 v[84:87], a[8:11], a[244:247], 0
  v_mfma_f32_16x16x32_bf16 v[84:87], a[20:23], a[248:251], v[84:87]
  v_mfma_f32_16x16x32_bf16 v[84:87], a[32:35], a[252:255], v[84:87]
  v_mfma_f32_16x16x32_bf16 v[84:87], a[44:47], v[88:91], v[84:87]
  v_mfma_f32_16x16x32_bf16 v[84:87], a[56:59], v[92:95], v[84:87]
  v_mfma_f32_16x16x32_bf16 v[84:87], a[68:71], v[96:99], v[84:87]
  v_mul_f32 v80, s42, v80
  v_mul_f32 v81, s42, v81
  v_mul_f32 v82, s42, v82
  v_mul_f32 v83, s42, v83
  v_cvt_pk_bf16_f32 v126, v80, v81
  v_cvt_pk_bf16_f32 v127, v82, v83
  v_mfma_f32_16x16x32_bf16 v[100:103], a[132:135], v[96:99], 0
  v_mfma_f32_16x16x32_bf16 v[100:103], a[120:123], v[92:95], v[100:103]
  v_mfma_f32_16x16x32_bf16 v[100:103], a[108:111], v[88:91], v[100:103]
  v_mfma_f32_16x16x32_bf16 v[100:103], a[96:99], a[252:255], v[100:103]
  v_mfma_f32_16x16x32_bf16 v[100:103], a[84:87], a[248:251], v[100:103]
  v_mfma_f32_16x16x32_bf16 v[100:103], a[72:75], a[244:247], v[100:103]
  v_mul_f32 v84, s42, v84
  v_mul_f32 v85, s42, v85
  v_mul_f32 v86, s42, v86
  v_mul_f32 v87, s42, v87
  v_cvt_pk_bf16_f32 v16, v84, v85
  v_cvt_pk_bf16_f32 v17, v86, v87
  v_mfma_f32_16x16x32_bf16 v[104:107], a[76:79], a[244:247], 0
  v_mfma_f32_16x16x32_bf16 v[104:107], a[88:91], a[248:251], v[104:107]
  v_mfma_f32_16x16x32_bf16 v[104:107], a[100:103], a[252:255], v[104:107]
  v_mfma_f32_16x16x32_bf16 v[104:107], a[112:115], v[88:91], v[104:107]
  v_mfma_f32_16x16x32_bf16 v[104:107], a[124:127], v[92:95], v[104:107]
  v_mfma_f32_16x16x32_bf16 v[104:107], a[136:139], v[96:99], v[104:107]
  v_cvt_pk_bf16_f32 v80, v100, v101
  v_cvt_pk_bf16_f32 v81, v102, v103
  v_mfma_f32_16x16x32_bf16 v[108:111], a[140:143], v[96:99], 0
  v_mfma_f32_16x16x32_bf16 v[108:111], a[128:131], v[92:95], v[108:111]
  v_mfma_f32_16x16x32_bf16 v[108:111], a[116:119], v[88:91], v[108:111]
  v_mfma_f32_16x16x32_bf16 v[108:111], a[104:107], a[252:255], v[108:111]
  v_mfma_f32_16x16x32_bf16 v[108:111], a[92:95], a[248:251], v[108:111]
  v_mfma_f32_16x16x32_bf16 v[108:111], a[80:83], a[244:247], v[108:111]
  v_cvt_pk_bf16_f32 v82, v104, v105
  v_cvt_pk_bf16_f32 v83, v106, v107
  v_mfma_f32_16x16x32_bf16 v[100:103], a[244:247], a[144:147], 0
  v_mfma_f32_16x16x32_bf16 v[100:103], a[248:251], a[156:159], v[100:103]
  v_mfma_f32_16x16x32_bf16 v[100:103], a[252:255], a[168:171], v[100:103]
  v_mfma_f32_16x16x32_bf16 v[100:103], v[88:91], a[180:183], v[100:103]
  v_mfma_f32_16x16x32_bf16 v[100:103], v[92:95], a[192:195], v[100:103]
  v_mfma_f32_16x16x32_bf16 v[100:103], v[96:99], a[204:207], v[100:103]
  v_cvt_pk_bf16_f32 v84, v108, v109
  v_cvt_pk_bf16_f32 v85, v110, v111
  v_mfma_f32_16x16x32_bf16 v[104:107], v[96:99], a[208:211], 0
  v_mfma_f32_16x16x32_bf16 v[104:107], v[92:95], a[196:199], v[104:107]
  v_mfma_f32_16x16x32_bf16 v[104:107], v[88:91], a[184:187], v[104:107]
  v_mfma_f32_16x16x32_bf16 v[104:107], a[252:255], a[172:175], v[104:107]
  v_mfma_f32_16x16x32_bf16 v[104:107], a[248:251], a[160:163], v[104:107]
  v_mfma_f32_16x16x32_bf16 v[104:107], a[244:247], a[148:151], v[104:107]
  v_cvt_pk_bf16_f32 v70, v100, v101
  v_cvt_pk_bf16_f32 v71, v102, v103
  v_mfma_f32_16x16x32_bf16 v[116:119], a[244:247], a[152:155], 0
  v_mfma_f32_16x16x32_bf16 v[116:119], a[248:251], a[164:167], v[116:119]
  v_mfma_f32_16x16x32_bf16 v[116:119], a[252:255], a[176:179], v[116:119]
  v_mfma_f32_16x16x32_bf16 v[116:119], v[88:91], a[188:191], v[116:119]
  v_mfma_f32_16x16x32_bf16 v[116:119], v[92:95], a[200:203], v[116:119]
  v_mfma_f32_16x16x32_bf16 v[116:119], v[96:99], a[212:215], v[116:119]
  v_cvt_pk_bf16_f32 v74, v104, v105
  v_cvt_pk_bf16_f32 v75, v106, v107
  s_nop 5
  v_cvt_pk_bf16_f32 v78, v116, v117
  v_cvt_pk_bf16_f32 v79, v118, v119
  ds_read_b128 a[244:247], v0 offset:4096
  ds_read_b128 a[248:251], v1 offset:4096
  ds_read_b128 a[252:255], v0 offset:12288
  ds_read_b128 v[100:103], v1 offset:12288
  ds_read_b128 v[108:111], v0 offset:20480
  ds_read_b128 v[112:115], v1 offset:20480
  s_waitcnt lgkmcnt(5)
  v_mfma_f32_16x16x32_bf16 v[96:99], a[0:3], a[244:247], 0
  s_waitcnt lgkmcnt(4)
  v_mfma_f32_16x16x32_bf16 v[96:99], a[12:15], a[248:251], v[96:99]
  s_waitcnt lgkmcnt(3)
  v_mfma_f32_16x16x32_bf16 v[96:99], a[24:27], a[252:255], v[96:99]
  s_waitcnt lgkmcnt(2)
  v_mfma_f32_16x16x32_bf16 v[96:99], a[36:39], v[100:103], v[96:99]
  s_waitcnt lgkmcnt(1)
  v_mfma_f32_16x16x32_bf16 v[96:99], a[48:51], v[108:111], v[96:99]
  s_waitcnt lgkmcnt(0)
  v_mfma_f32_16x16x32_bf16 v[96:99], a[60:63], v[112:115], v[96:99]
  v_mfma_f32_16x16x32_bf16 v[88:91], a[64:67], v[112:115], 0
  v_mfma_f32_16x16x32_bf16 v[88:91], a[52:55], v[108:111], v[88:91]
  v_mfma_f32_16x16x32_bf16 v[88:91], a[40:43], v[100:103], v[88:91]
  v_mfma_f32_16x16x32_bf16 v[88:91], a[28:31], a[252:255], v[88:91]
  v_mfma_f32_16x16x32_bf16 v[88:91], a[16:19], a[248:251], v[88:91]
  v_mfma_f32_16x16x32_bf16 v[88:91], a[4:7], a[244:247], v[88:91]
  v_mul_f32 v96, s42, v96
  v_mul_f32 v97, s42, v97
  v_mul_f32 v98, s42, v98
  v_mul_f32 v99, s42, v99
  v_cvt_pk_bf16_f32 v18, v96, v97
  v_cvt_pk_bf16_f32 v19, v98, v99
  v_mfma_f32_16x16x32_bf16 v[92:95], a[8:11], a[244:247], 0
  v_mfma_f32_16x16x32_bf16 v[92:95], a[20:23], a[248:251], v[92:95]
  v_mfma_f32_16x16x32_bf16 v[92:95], a[32:35], a[252:255], v[92:95]
  v_mfma_f32_16x16x32_bf16 v[92:95], a[44:47], v[100:103], v[92:95]
  v_mfma_f32_16x16x32_bf16 v[92:95], a[56:59], v[108:111], v[92:95]
  v_mfma_f32_16x16x32_bf16 v[92:95], a[68:71], v[112:115], v[92:95]
  v_mul_f32 v88, s42, v88
  v_mul_f32 v89, s42, v89
  v_mul_f32 v90, s42, v90
  v_mul_f32 v91, s42, v91
  v_cvt_pk_bf16_f32 v120, v88, v89
  v_cvt_pk_bf16_f32 v121, v90, v91
  v_mfma_f32_16x16x32_bf16 v[96:99], a[132:135], v[112:115], 0
  v_mfma_f32_16x16x32_bf16 v[96:99], a[120:123], v[108:111], v[96:99]
  v_mfma_f32_16x16x32_bf16 v[96:99], a[108:111], v[100:103], v[96:99]
  v_mfma_f32_16x16x32_bf16 v[96:99], a[96:99], a[252:255], v[96:99]
  v_mfma_f32_16x16x32_bf16 v[96:99], a[84:87], a[248:251], v[96:99]
  v_mfma_f32_16x16x32_bf16 v[96:99], a[72:75], a[244:247], v[96:99]
  v_mul_f32 v92, s42, v92
  v_mul_f32 v93, s42, v93
  v_mul_f32 v94, s42, v94
  v_mul_f32 v95, s42, v95
  v_cvt_pk_bf16_f32 v122, v92, v93
  v_cvt_pk_bf16_f32 v123, v94, v95
  v_mfma_f32_16x16x32_bf16 v[104:107], a[76:79], a[244:247], 0
  v_mfma_f32_16x16x32_bf16 v[104:107], a[88:91], a[248:251], v[104:107]
  v_mfma_f32_16x16x32_bf16 v[104:107], a[100:103], a[252:255], v[104:107]
  v_mfma_f32_16x16x32_bf16 v[104:107], a[112:115], v[100:103], v[104:107]
  v_mfma_f32_16x16x32_bf16 v[104:107], a[124:127], v[108:111], v[104:107]
  v_mfma_f32_16x16x32_bf16 v[104:107], a[136:139], v[112:115], v[104:107]
  v_cvt_pk_bf16_f32 v88, v96, v97
  v_cvt_pk_bf16_f32 v89, v98, v99
  v_mfma_f32_16x16x32_bf16 v[116:119], a[140:143], v[112:115], 0
  v_mfma_f32_16x16x32_bf16 v[116:119], a[128:131], v[108:111], v[116:119]
  v_mfma_f32_16x16x32_bf16 v[116:119], a[116:119], v[100:103], v[116:119]
  v_mfma_f32_16x16x32_bf16 v[116:119], a[104:107], a[252:255], v[116:119]
  v_mfma_f32_16x16x32_bf16 v[116:119], a[92:95], a[248:251], v[116:119]
  v_mfma_f32_16x16x32_bf16 v[116:119], a[80:83], a[244:247], v[116:119]
  v_cvt_pk_bf16_f32 v90, v104, v105
  v_cvt_pk_bf16_f32 v91, v106, v107
  v_mfma_f32_16x16x32_bf16 v[132:135], a[244:247], a[144:147], 0
  v_mfma_f32_16x16x32_bf16 v[132:135], a[248:251], a[156:159], v[132:135]
  v_mfma_f32_16x16x32_bf16 v[132:135], a[252:255], a[168:171], v[132:135]
  v_mfma_f32_16x16x32_bf16 v[132:135], v[100:103], a[180:183], v[132:135]
  v_mfma_f32_16x16x32_bf16 v[132:135], v[108:111], a[192:195], v[132:135]
  v_mfma_f32_16x16x32_bf16 v[132:135], v[112:115], a[204:207], v[132:135]
  v_cvt_pk_bf16_f32 v92, v116, v117
  v_cvt_pk_bf16_f32 v93, v118, v119
  v_mfma_f32_16x16x32_bf16 v[136:139], v[112:115], a[208:211], 0
  v_mfma_f32_16x16x32_bf16 v[136:139], v[108:111], a[196:199], v[136:139]
  v_mfma_f32_16x16x32_bf16 v[136:139], v[100:103], a[184:187], v[136:139]
  v_mfma_f32_16x16x32_bf16 v[136:139], a[252:255], a[172:175], v[136:139]
  v_mfma_f32_16x16x32_bf16 v[136:139], a[248:251], a[160:163], v[136:139]
  v_mfma_f32_16x16x32_bf16 v[136:139], a[244:247], a[148:151], v[136:139]
  v_cvt_pk_bf16_f32 v96, v132, v133
  v_cvt_pk_bf16_f32 v97, v134, v135
  v_mfma_f32_16x16x32_bf16 v[116:119], a[244:247], a[152:155], 0
  v_mfma_f32_16x16x32_bf16 v[116:119], a[248:251], a[164:167], v[116:119]
  v_mfma_f32_16x16x32_bf16 v[116:119], a[252:255], a[176:179], v[116:119]
  v_mfma_f32_16x16x32_bf16 v[116:119], v[100:103], a[188:191], v[116:119]
  v_mfma_f32_16x16x32_bf16 v[116:119], v[108:111], a[200:203], v[116:119]
  v_mfma_f32_16x16x32_bf16 v[116:119], v[112:115], a[212:215], v[116:119]
  v_cvt_pk_bf16_f32 v104, v136, v137
  v_cvt_pk_bf16_f32 v105, v138, v139
  s_nop 5
  v_cvt_pk_bf16_f32 v100, v116, v117
  v_cvt_pk_bf16_f32 v101, v118, v119
  ds_read_b128 a[244:247], v0 offset:6144
  ds_read_b128 a[248:251], v1 offset:6144
  ds_read_b128 a[252:255], v0 offset:14336
  ds_read_b128 v[132:135], v1 offset:14336
  ds_read_b128 v[136:139], v0 offset:22528
  ds_read_b128 v[140:143], v1 offset:22528
  s_waitcnt lgkmcnt(5)
  v_mfma_f32_16x16x32_bf16 v[144:147], a[0:3], a[244:247], 0
  s_waitcnt lgkmcnt(4)
  v_mfma_f32_16x16x32_bf16 v[144:147], a[12:15], a[248:251], v[144:147]
  s_waitcnt lgkmcnt(3)
  v_mfma_f32_16x16x32_bf16 v[144:147], a[24:27], a[252:255], v[144:147]
  s_waitcnt lgkmcnt(2)
  v_mfma_f32_16x16x32_bf16 v[144:147], a[36:39], v[132:135], v[144:147]
  s_waitcnt lgkmcnt(1)
  v_mfma_f32_16x16x32_bf16 v[144:147], a[48:51], v[136:139], v[144:147]
  s_waitcnt lgkmcnt(0)
  v_mfma_f32_16x16x32_bf16 v[144:147], a[60:63], v[140:143], v[144:147]
  v_mfma_f32_16x16x32_bf16 v[108:111], a[64:67], v[140:143], 0
  v_mfma_f32_16x16x32_bf16 v[108:111], a[52:55], v[136:139], v[108:111]
  v_mfma_f32_16x16x32_bf16 v[108:111], a[40:43], v[132:135], v[108:111]
  v_mfma_f32_16x16x32_bf16 v[108:111], a[28:31], a[252:255], v[108:111]
  v_mfma_f32_16x16x32_bf16 v[108:111], a[16:19], a[248:251], v[108:111]
  v_mfma_f32_16x16x32_bf16 v[108:111], a[4:7], a[244:247], v[108:111]
  v_mul_f32 v144, s42, v144
  v_mul_f32 v145, s42, v145
  v_mul_f32 v146, s42, v146
  v_mul_f32 v147, s42, v147
  v_cvt_pk_bf16_f32 v116, v144, v145
  v_cvt_pk_bf16_f32 v117, v146, v147
  v_mfma_f32_16x16x32_bf16 v[112:115], a[8:11], a[244:247], 0
  v_mfma_f32_16x16x32_bf16 v[112:115], a[20:23], a[248:251], v[112:115]
  v_mfma_f32_16x16x32_bf16 v[112:115], a[32:35], a[252:255], v[112:115]
  v_mfma_f32_16x16x32_bf16 v[112:115], a[44:47], v[132:135], v[112:115]
  v_mfma_f32_16x16x32_bf16 v[112:115], a[56:59], v[136:139], v[112:115]
  v_mfma_f32_16x16x32_bf16 v[112:115], a[68:71], v[140:143], v[112:115]
  v_mul_f32 v108, s42, v108
  v_mul_f32 v109, s42, v109
  v_mul_f32 v110, s42, v110
  v_mul_f32 v111, s42, v111
  v_cvt_pk_bf16_f32 v118, v108, v109
  v_cvt_pk_bf16_f32 v119, v110, v111
  v_mfma_f32_16x16x32_bf16 v[144:147], a[132:135], v[140:143], 0
  v_mfma_f32_16x16x32_bf16 v[144:147], a[120:123], v[136:139], v[144:147]
  v_mfma_f32_16x16x32_bf16 v[144:147], a[108:111], v[132:135], v[144:147]
  v_mfma_f32_16x16x32_bf16 v[144:147], a[96:99], a[252:255], v[144:147]
  v_mfma_f32_16x16x32_bf16 v[144:147], a[84:87], a[248:251], v[144:147]
  v_mfma_f32_16x16x32_bf16 v[144:147], a[72:75], a[244:247], v[144:147]
  v_mul_f32 v112, s42, v112
  v_mul_f32 v113, s42, v113
  v_mul_f32 v114, s42, v114
  v_mul_f32 v115, s42, v115
  v_cvt_pk_bf16_f32 v22, v112, v113
  v_cvt_pk_bf16_f32 v23, v114, v115
  v_mfma_f32_16x16x32_bf16 v[148:151], a[76:79], a[244:247], 0
  v_mfma_f32_16x16x32_bf16 v[148:151], a[88:91], a[248:251], v[148:151]
  v_mfma_f32_16x16x32_bf16 v[148:151], a[100:103], a[252:255], v[148:151]
  v_mfma_f32_16x16x32_bf16 v[148:151], a[112:115], v[132:135], v[148:151]
  v_mfma_f32_16x16x32_bf16 v[148:151], a[124:127], v[136:139], v[148:151]
  v_mfma_f32_16x16x32_bf16 v[148:151], a[136:139], v[140:143], v[148:151]
  v_cvt_pk_bf16_f32 v108, v144, v145
  v_cvt_pk_bf16_f32 v109, v146, v147
  v_mfma_f32_16x16x32_bf16 v[152:155], a[140:143], v[140:143], 0
  v_mfma_f32_16x16x32_bf16 v[152:155], a[128:131], v[136:139], v[152:155]
  v_mfma_f32_16x16x32_bf16 v[152:155], a[116:119], v[132:135], v[152:155]
  v_mfma_f32_16x16x32_bf16 v[152:155], a[104:107], a[252:255], v[152:155]
  v_mfma_f32_16x16x32_bf16 v[152:155], a[92:95], a[248:251], v[152:155]
  v_mfma_f32_16x16x32_bf16 v[152:155], a[80:83], a[244:247], v[152:155]
  v_cvt_pk_bf16_f32 v110, v148, v149
  v_cvt_pk_bf16_f32 v111, v150, v151
  v_mfma_f32_16x16x32_bf16 v[144:147], a[244:247], a[144:147], 0
  v_mfma_f32_16x16x32_bf16 v[144:147], a[248:251], a[156:159], v[144:147]
  v_mfma_f32_16x16x32_bf16 v[144:147], a[252:255], a[168:171], v[144:147]
  v_mfma_f32_16x16x32_bf16 v[144:147], v[132:135], a[180:183], v[144:147]
  v_mfma_f32_16x16x32_bf16 v[144:147], v[136:139], a[192:195], v[144:147]
  v_mfma_f32_16x16x32_bf16 v[144:147], v[140:143], a[204:207], v[144:147]
  v_cvt_pk_bf16_f32 v112, v152, v153
  v_cvt_pk_bf16_f32 v113, v154, v155
  v_mfma_f32_16x16x32_bf16 v[148:151], v[140:143], a[208:211], 0
  v_mfma_f32_16x16x32_bf16 v[148:151], v[136:139], a[196:199], v[148:151]
  v_mfma_f32_16x16x32_bf16 v[148:151], v[132:135], a[184:187], v[148:151]
  v_mfma_f32_16x16x32_bf16 v[148:151], a[252:255], a[172:175], v[148:151]
  v_mfma_f32_16x16x32_bf16 v[148:151], a[248:251], a[160:163], v[148:151]
  v_mfma_f32_16x16x32_bf16 v[148:151], a[244:247], a[148:151], v[148:151]
  v_cvt_pk_bf16_f32 v98, v144, v145
  v_cvt_pk_bf16_f32 v99, v146, v147
  v_mfma_f32_16x16x32_bf16 v[152:155], a[244:247], a[152:155], 0
  v_mfma_f32_16x16x32_bf16 v[152:155], a[248:251], a[164:167], v[152:155]
  v_mfma_f32_16x16x32_bf16 v[152:155], a[252:255], a[176:179], v[152:155]
  v_mfma_f32_16x16x32_bf16 v[152:155], v[132:135], a[188:191], v[152:155]
  v_mfma_f32_16x16x32_bf16 v[152:155], v[136:139], a[200:203], v[152:155]
  v_mfma_f32_16x16x32_bf16 v[152:155], v[140:143], a[212:215], v[152:155]
  v_cvt_pk_bf16_f32 v106, v148, v149
  v_cvt_pk_bf16_f32 v107, v150, v151
  s_nop 5
  v_cvt_pk_bf16_f32 v102, v152, v153
  v_cvt_pk_bf16_f32 v103, v154, v155
  v_mfma_f32_16x16x32_bf16 v[132:135], v[62:65], v[128:131], v[36:39]
  v_mfma_f32_16x16x32_bf16 v[132:135], v[60:63], v[12:15], v[132:135]
  v_mfma_f32_16x16x32_bf16 v[136:139], v[82:85], v[128:131], v[32:35]
  v_mfma_f32_16x16x32_bf16 v[136:139], v[80:83], v[12:15], v[136:139]
  v_mfma_f32_16x16x32_bf16 v[140:143], v[90:93], v[128:131], v[28:31]
  v_mfma_f32_16x16x32_bf16 v[140:143], v[88:91], v[12:15], v[140:143]
  v_mfma_f32_16x16x32_bf16 v[144:147], v[110:113], v[128:131], v[24:27]
  v_mfma_f32_16x16x32_bf16 v[144:147], v[108:111], v[12:15], v[144:147]
  v_add_f32 v132, v54, v132
  v_add_f32 v133, v54, v133
  v_add_f32 v134, v54, v134
  v_add_f32 v135, v54, v135
  v_add_f32 v136, v54, v136
  v_add_f32 v137, v54, v137
  v_add_f32 v138, v54, v138
  v_add_f32 v139, v54, v139
  v_add_f32 v140, v55, v140
  v_add_f32 v141, v55, v141
  v_add_f32 v142, v55, v142
  v_add_f32 v143, v55, v143
  v_add_f32 v144, v55, v144
  v_add_f32 v145, v55, v145
  v_add_f32 v146, v55, v146
  v_add_f32 v147, v55, v147
  v_max_f32 v58, v132, v133
  v_max3_f32 v58, v134, v135, v58
  v_max3_f32 v58, v136, v137, v58
  v_max3_f32 v58, v138, v139, v58
  v_max3_f32 v58, v140, v141, v58
  v_max3_f32 v58, v142, v143, v58
  v_max3_f32 v58, v144, v145, v58
  v_max3_f32 v58, v146, v147, v58
  v_mov_b32 v59, v58
  s_nop 1
  v_permlane32_swap_b32 v58, v59
  v_max_f32 v58, v58, v59
  v_mov_b32 v59, v58
  s_nop 1
  v_permlane16_swap_b32 v58, v59
  v_max_f32 v58, v58, v59
  v_sub_f32 v132, v132, v58
  v_sub_f32 v133, v133, v58
  v_sub_f32 v134, v134, v58
  v_sub_f32 v135, v135, v58
  v_sub_f32 v136, v136, v58
  v_sub_f32 v137, v137, v58
  v_sub_f32 v138, v138, v58
  v_sub_f32 v139, v139, v58
  v_sub_f32 v140, v140, v58
  v_sub_f32 v141, v141, v58
  v_sub_f32 v142, v142, v58
  v_sub_f32 v143, v143, v58
  v_sub_f32 v144, v144, v58
  v_sub_f32 v145, v145, v58
  v_sub_f32 v146, v146, v58
  v_sub_f32 v147, v147, v58
  v_exp_f32 v132, v132
  v_exp_f32 v133, v133
  v_exp_f32 v134, v134
  v_exp_f32 v135, v135
  v_cvt_pk_bf16_f32 v132, v132, v133
  v_cvt_pk_bf16_f32 v133, v134, v135
  v_exp_f32 v136, v136
  v_exp_f32 v137, v137
  v_exp_f32 v138, v138
  v_exp_f32 v139, v139
  v_cvt_pk_bf16_f32 v134, v136, v137
  v_cvt_pk_bf16_f32 v135, v138, v139
  v_exp_f32 v140, v140
  v_exp_f32 v141, v141
  v_exp_f32 v142, v142
  v_exp_f32 v143, v143
  v_cvt_pk_bf16_f32 v136, v140, v141
  v_cvt_pk_bf16_f32 v137, v142, v143
  v_exp_f32 v144, v144
  v_exp_f32 v145, v145
  v_exp_f32 v146, v146
  v_exp_f32 v147, v147
  v_cvt_pk_bf16_f32 v138, v144, v145
  v_cvt_pk_bf16_f32 v139, v146, v147
  v_mov_b64 v[128:129], 0
  s_nop 1
  v_smfmac_f32_16x16x64_bf16 v[128:131], a[240:243], v[132:139], v10
  v_mfma_f32_16x16x32_bf16 v[148:151], v[96:99], v[136:139], 0
  v_mfma_f32_16x16x32_bf16 v[148:151], v[68:71], v[132:135], v[148:151]
  v_mfma_f32_16x16x32_bf16 v[140:143], v[72:75], v[132:135], 0
  v_mfma_f32_16x16x32_bf16 v[140:143], v[104:107], v[136:139], v[140:143]
  v_mfma_f32_16x16x32_bf16 v[144:147], v[100:103], v[136:139], 0
  v_mfma_f32_16x16x32_bf16 v[144:147], v[76:79], v[132:135], v[144:147]
  v_add_f32 v128, v128, v129
  v_rcp_f32 v130, v128
  s_nop 0
  v_mul_f32 v148, v130, v148
  v_mul_f32 v149, v130, v149
  v_mul_f32 v150, v130, v150
  v_mul_f32 v151, v130, v151
  v_cvt_pk_bf16_f32 v148, v148, v149
  v_cvt_pk_bf16_f32 v149, v150, v151
  ds_write_b32 v5, v148 offset:0
  ds_write_b32 v5, v149 offset:1024
  v_mul_f32 v140, v130, v140
  v_mul_f32 v141, v130, v141
  v_mul_f32 v142, v130, v142
  v_mul_f32 v143, v130, v143
  v_cvt_pk_bf16_f32 v140, v140, v141
  v_cvt_pk_bf16_f32 v141, v142, v143
  ds_write_b32 v5, v140 offset:2048
  ds_write_b32 v5, v141 offset:3072
  v_mul_f32 v144, v130, v144
  v_mul_f32 v145, v130, v145
  v_mul_f32 v146, v130, v146
  v_mul_f32 v147, v130, v147
  v_cvt_pk_bf16_f32 v144, v144, v145
  v_cvt_pk_bf16_f32 v145, v146, v147
  ds_write_b32 v5, v144 offset:4096
  ds_write_b32 v5, v145 offset:5120
  v_mfma_f32_16x16x32_bf16 v[128:131], v[60:63], v[124:127], v[40:43]
  v_mfma_f32_16x16x32_bf16 v[128:131], v[62:65], v[14:17], v[128:131]
  v_mfma_f32_16x16x32_bf16 v[132:135], v[80:83], v[124:127], v[36:39]
  v_mfma_f32_16x16x32_bf16 v[132:135], v[82:85], v[14:17], v[132:135]
  v_mfma_f32_16x16x32_bf16 v[136:139], v[88:91], v[124:127], v[32:35]
  v_mfma_f32_16x16x32_bf16 v[136:139], v[90:93], v[14:17], v[136:139]
  v_mfma_f32_16x16x32_bf16 v[140:143], v[108:111], v[124:127], v[28:31]
  v_mfma_f32_16x16x32_bf16 v[140:143], v[110:113], v[14:17], v[140:143]
  v_add_f32 v128, v54, v128
  v_add_f32 v129, v54, v129
  v_add_f32 v130, v54, v130
  v_add_f32 v131, v54, v131
  v_add_f32 v132, v54, v132
  v_add_f32 v133, v54, v133
  v_add_f32 v134, v54, v134
  v_add_f32 v135, v54, v135
  v_add_f32 v136, v55, v136
  v_add_f32 v137, v55, v137
  v_add_f32 v138, v55, v138
  v_add_f32 v139, v55, v139
  v_add_f32 v140, v55, v140
  v_add_f32 v141, v55, v141
  v_add_f32 v142, v55, v142
  v_add_f32 v143, v55, v143
  v_max_f32 v58, v128, v129
  v_max3_f32 v58, v130, v131, v58
  v_max3_f32 v58, v132, v133, v58
  v_max3_f32 v58, v134, v135, v58
  v_max3_f32 v58, v136, v137, v58
  v_max3_f32 v58, v138, v139, v58
  v_max3_f32 v58, v140, v141, v58
  v_max3_f32 v58, v142, v143, v58
  v_mov_b32 v59, v58
  s_nop 1
  v_permlane32_swap_b32 v58, v59
  v_max_f32 v58, v58, v59
  v_mov_b32 v59, v58
  s_nop 1
  v_permlane16_swap_b32 v58, v59
  v_max_f32 v58, v58, v59
  v_sub_f32 v128, v128, v58
  v_sub_f32 v129, v129, v58
  v_sub_f32 v130, v130, v58
  v_sub_f32 v131, v131, v58
  v_sub_f32 v132, v132, v58
  v_sub_f32 v133, v133, v58
  v_sub_f32 v134, v134, v58
  v_sub_f32 v135, v135, v58
  v_sub_f32 v136, v136, v58
  v_sub_f32 v137, v137, v58
  v_sub_f32 v138, v138, v58
  v_sub_f32 v139, v139, v58
  v_sub_f32 v140, v140, v58
  v_sub_f32 v141, v141, v58
  v_sub_f32 v142, v142, v58
  v_sub_f32 v143, v143, v58
  v_exp_f32 v128, v128
  v_exp_f32 v129, v129
  v_exp_f32 v130, v130
  v_exp_f32 v131, v131
  v_cvt_pk_bf16_f32 v128, v128, v129
  v_cvt_pk_bf16_f32 v129, v130, v131
  v_exp_f32 v132, v132
  v_exp_f32 v133, v133
  v_exp_f32 v134, v134
  v_exp_f32 v135, v135
  v_cvt_pk_bf16_f32 v130, v132, v133
  v_cvt_pk_bf16_f32 v131, v134, v135
  v_exp_f32 v136, v136
  v_exp_f32 v137, v137
  v_exp_f32 v138, v138
  v_exp_f32 v139, v139
  v_cvt_pk_bf16_f32 v132, v136, v137
  v_cvt_pk_bf16_f32 v133, v138, v139
  v_exp_f32 v140, v140
  v_exp_f32 v141, v141
  v_exp_f32 v142, v142
  v_exp_f32 v143, v143
  v_cvt_pk_bf16_f32 v134, v140, v141
  v_cvt_pk_bf16_f32 v135, v142, v143
  v_mov_b64 v[124:125], 0
  s_nop 1
  v_smfmac_f32_16x16x64_bf16 v[124:127], a[240:243], v[128:135], v10
  v_mfma_f32_16x16x32_bf16 v[144:147], v[96:99], v[132:135], 0
  v_mfma_f32_16x16x32_bf16 v[144:147], v[68:71], v[128:131], v[144:147]
  v_mfma_f32_16x16x32_bf16 v[136:139], v[72:75], v[128:131], 0
  v_mfma_f32_16x16x32_bf16 v[136:139], v[104:107], v[132:135], v[136:139]
  v_mfma_f32_16x16x32_bf16 v[140:143], v[100:103], v[132:135], 0
  v_mfma_f32_16x16x32_bf16 v[140:143], v[76:79], v[128:131], v[140:143]
  v_add_f32 v124, v124, v125
  v_rcp_f32 v126, v124
  s_nop 0
  v_mul_f32 v144, v126, v144
  v_mul_f32 v145, v126, v145
  v_mul_f32 v146, v126, v146
  v_mul_f32 v147, v126, v147
  v_cvt_pk_bf16_f32 v144, v144, v145
  v_cvt_pk_bf16_f32 v145, v146, v147
  ds_write_b32 v5, v144 offset:256
  ds_write_b32 v5, v145 offset:1280
  v_mul_f32 v136, v126, v136
  v_mul_f32 v137, v126, v137
  v_mul_f32 v138, v126, v138
  v_mul_f32 v139, v126, v139
  v_cvt_pk_bf16_f32 v136, v136, v137
  v_cvt_pk_bf16_f32 v137, v138, v139
  ds_write_b32 v5, v136 offset:2304
  ds_write_b32 v5, v137 offset:3328
  v_mul_f32 v140, v126, v140
  v_mul_f32 v141, v126, v141
  v_mul_f32 v142, v126, v142
  v_mul_f32 v143, v126, v143
  v_cvt_pk_bf16_f32 v140, v140, v141
  v_cvt_pk_bf16_f32 v141, v142, v143
  ds_write_b32 v5, v140 offset:4352
  ds_write_b32 v5, v141 offset:5376
  v_mfma_f32_16x16x32_bf16 v[124:127], v[90:93], v[120:123], v[36:39]
  v_mfma_f32_16x16x32_bf16 v[124:127], v[88:91], v[18:21], v[124:127]
  v_mfma_f32_16x16x32_bf16 v[128:131], v[110:113], v[120:123], v[32:35]
  v_mfma_f32_16x16x32_bf16 v[128:131], v[108:111], v[18:21], v[128:131]
  v_mfma_f32_16x16x32_bf16 v[132:135], v[62:65], v[120:123], v[44:47]
  v_mfma_f32_16x16x32_bf16 v[132:135], v[60:63], v[18:21], v[132:135]
  v_mfma_f32_16x16x32_bf16 v[136:139], v[82:85], v[120:123], v[40:43]
  v_mfma_f32_16x16x32_bf16 v[136:139], v[80:83], v[18:21], v[136:139]
  v_add_f32 v124, v54, v124
  v_add_f32 v125, v54, v125
  v_add_f32 v126, v54, v126
  v_add_f32 v127, v54, v127
  v_add_f32 v128, v54, v128
  v_add_f32 v129, v54, v129
  v_add_f32 v130, v54, v130
  v_add_f32 v131, v54, v131
  v_add_f32 v132, v55, v132
  v_add_f32 v133, v55, v133
  v_add_f32 v134, v55, v134
  v_add_f32 v135, v55, v135
  v_add_f32 v136, v55, v136
  v_add_f32 v137, v55, v137
  v_add_f32 v138, v55, v138
  v_add_f32 v139, v55, v139
  v_max_f32 v58, v124, v125
  v_max3_f32 v58, v126, v127, v58
  v_max3_f32 v58, v128, v129, v58
  v_max3_f32 v58, v130, v131, v58
  v_max3_f32 v58, v132, v133, v58
  v_max3_f32 v58, v134, v135, v58
  v_max3_f32 v58, v136, v137, v58
  v_max3_f32 v58, v138, v139, v58
  v_mov_b32 v59, v58
  s_nop 1
  v_permlane32_swap_b32 v58, v59
  v_max_f32 v58, v58, v59
  v_mov_b32 v59, v58
  s_nop 1
  v_permlane16_swap_b32 v58, v59
  v_max_f32 v58, v58, v59
  v_sub_f32 v124, v124, v58
  v_sub_f32 v125, v125, v58
  v_sub_f32 v126, v126, v58
  v_sub_f32 v127, v127, v58
  v_sub_f32 v128, v128, v58
  v_sub_f32 v129, v129, v58
  v_sub_f32 v130, v130, v58
  v_sub_f32 v131, v131, v58
  v_sub_f32 v132, v132, v58
  v_sub_f32 v133, v133, v58
  v_sub_f32 v134, v134, v58
  v_sub_f32 v135, v135, v58
  v_sub_f32 v136, v136, v58
  v_sub_f32 v137, v137, v58
  v_sub_f32 v138, v138, v58
  v_sub_f32 v139, v139, v58
  v_exp_f32 v124, v124
  v_exp_f32 v125, v125
  v_exp_f32 v126, v126
  v_exp_f32 v127, v127
  v_cvt_pk_bf16_f32 v124, v124, v125
  v_cvt_pk_bf16_f32 v125, v126, v127
  v_exp_f32 v128, v128
  v_exp_f32 v129, v129
  v_exp_f32 v130, v130
  v_exp_f32 v131, v131
  v_cvt_pk_bf16_f32 v126, v128, v129
  v_cvt_pk_bf16_f32 v127, v130, v131
  v_exp_f32 v132, v132
  v_exp_f32 v133, v133
  v_exp_f32 v134, v134
  v_exp_f32 v135, v135
  v_cvt_pk_bf16_f32 v128, v132, v133
  v_cvt_pk_bf16_f32 v129, v134, v135
  v_exp_f32 v136, v136
  v_exp_f32 v137, v137
  v_exp_f32 v138, v138
  v_exp_f32 v139, v139
  v_cvt_pk_bf16_f32 v130, v136, v137
  v_cvt_pk_bf16_f32 v131, v138, v139
  v_mov_b64 v[120:121], 0
  s_nop 1
  v_smfmac_f32_16x16x64_bf16 v[120:123], a[240:243], v[124:131], v10
  v_mfma_f32_16x16x32_bf16 v[140:143], v[68:71], v[128:131], 0
  v_mfma_f32_16x16x32_bf16 v[140:143], v[96:99], v[124:127], v[140:143]
  v_mfma_f32_16x16x32_bf16 v[132:135], v[104:107], v[124:127], 0
  v_mfma_f32_16x16x32_bf16 v[132:135], v[72:75], v[128:131], v[132:135]
  v_mfma_f32_16x16x32_bf16 v[136:139], v[76:79], v[128:131], 0
  v_mfma_f32_16x16x32_bf16 v[136:139], v[100:103], v[124:127], v[136:139]
  v_add_f32 v120, v120, v121
  v_rcp_f32 v122, v120
  s_nop 0
  v_mul_f32 v140, v122, v140
  v_mul_f32 v141, v122, v141
  v_mul_f32 v142, v122, v142
  v_mul_f32 v143, v122, v143
  v_cvt_pk_bf16_f32 v140, v140, v141
  v_cvt_pk_bf16_f32 v141, v142, v143
  ds_write_b32 v5, v140 offset:512
  ds_write_b32 v5, v141 offset:1536
  v_mul_f32 v132, v122, v132
  v_mul_f32 v133, v122, v133
  v_mul_f32 v134, v122, v134
  v_mul_f32 v135, v122, v135
  v_cvt_pk_bf16_f32 v132, v132, v133
  v_cvt_pk_bf16_f32 v133, v134, v135
  ds_write_b32 v5, v132 offset:2560
  s_waitcnt lgkmcnt(12)
  ds_write_b32 v5, v133 offset:3584
  v_mul_f32 v136, v122, v136
  v_mul_f32 v137, v122, v137
  v_mul_f32 v138, v122, v138
  v_mul_f32 v139, v122, v139
  v_cvt_pk_bf16_f32 v136, v136, v137
  v_cvt_pk_bf16_f32 v137, v138, v139
  ds_write_b32 v5, v136 offset:4608
  ds_write_b32 v5, v137 offset:5632
  v_mfma_f32_16x16x32_bf16 v[120:123], v[88:91], v[116:119], v[40:43]
  v_mfma_f32_16x16x32_bf16 v[120:123], v[90:93], v[20:23], v[120:123]
  v_mfma_f32_16x16x32_bf16 v[124:127], v[108:111], v[116:119], v[36:39]
  v_mfma_f32_16x16x32_bf16 v[124:127], v[110:113], v[20:23], v[124:127]
  v_mfma_f32_16x16x32_bf16 v[128:131], v[60:63], v[116:119], v[48:51]
  v_mfma_f32_16x16x32_bf16 v[128:131], v[62:65], v[20:23], v[128:131]
  v_mfma_f32_16x16x32_bf16 v[88:91], v[80:83], v[116:119], v[44:47]
  v_mfma_f32_16x16x32_bf16 v[88:91], v[82:85], v[20:23], v[88:91]
  v_add_f32 v120, v54, v120
  v_add_f32 v121, v54, v121
  v_add_f32 v122, v54, v122
  v_add_f32 v123, v54, v123
  v_add_f32 v124, v54, v124
  v_add_f32 v125, v54, v125
  v_add_f32 v126, v54, v126
  v_add_f32 v127, v54, v127
  v_add_f32 v128, v55, v128
  v_add_f32 v129, v55, v129
  v_add_f32 v130, v55, v130
  v_add_f32 v131, v55, v131
  v_add_f32 v88, v55, v88
  v_add_f32 v89, v55, v89
  v_add_f32 v90, v55, v90
  v_add_f32 v91, v55, v91
  v_max_f32 v58, v120, v121
  v_max3_f32 v58, v122, v123, v58
  v_max3_f32 v58, v124, v125, v58
  v_max3_f32 v58, v126, v127, v58
  v_max3_f32 v58, v128, v129, v58
  v_max3_f32 v58, v130, v131, v58
  v_max3_f32 v58, v88, v89, v58
  v_max3_f32 v58, v90, v91, v58
  v_mov_b32 v59, v58
  s_nop 1
  v_permlane32_swap_b32 v58, v59
  v_max_f32 v58, v58, v59
  v_mov_b32 v59, v58
  s_nop 1
  v_permlane16_swap_b32 v58, v59
  v_max_f32 v58, v58, v59
  v_sub_f32 v120, v120, v58
  v_sub_f32 v121, v121, v58
  v_sub_f32 v122, v122, v58
  v_sub_f32 v123, v123, v58
  v_sub_f32 v124, v124, v58
  v_sub_f32 v125, v125, v58
  v_sub_f32 v126, v126, v58
  v_sub_f32 v127, v127, v58
  v_sub_f32 v128, v128, v58
  v_sub_f32 v129, v129, v58
  v_sub_f32 v130, v130, v58
  v_sub_f32 v131, v131, v58
  v_sub_f32 v88, v88, v58
  v_sub_f32 v89, v89, v58
  v_sub_f32 v90, v90, v58
  v_sub_f32 v91, v91, v58
  v_exp_f32 v120, v120
  v_exp_f32 v121, v121
  v_exp_f32 v122, v122
  v_exp_f32 v123, v123
  v_cvt_pk_bf16_f32 v120, v120, v121
  v_cvt_pk_bf16_f32 v121, v122, v123
  v_exp_f32 v124, v124
  v_exp_f32 v125, v125
  v_exp_f32 v126, v126
  v_exp_f32 v127, v127
  v_cvt_pk_bf16_f32 v122, v124, v125
  v_cvt_pk_bf16_f32 v123, v126, v127
  v_exp_f32 v128, v128
  v_exp_f32 v129, v129
  v_exp_f32 v130, v130
  v_exp_f32 v131, v131
  v_cvt_pk_bf16_f32 v124, v128, v129
  v_cvt_pk_bf16_f32 v125, v130, v131
  v_exp_f32 v88, v88
  v_exp_f32 v89, v89
  v_exp_f32 v90, v90
  v_exp_f32 v91, v91
  v_cvt_pk_bf16_f32 v126, v88, v89
  v_cvt_pk_bf16_f32 v127, v90, v91
  v_mov_b64 v[80:81], 0
  s_nop 1
  v_smfmac_f32_16x16x64_bf16 v[80:83], a[240:243], v[120:127], v10
  v_mfma_f32_16x16x32_bf16 v[84:87], v[68:71], v[124:127], 0
  v_mfma_f32_16x16x32_bf16 v[84:87], v[96:99], v[120:123], v[84:87]
  v_mfma_f32_16x16x32_bf16 v[60:63], v[104:107], v[120:123], 0
  v_mfma_f32_16x16x32_bf16 v[60:63], v[72:75], v[124:127], v[60:63]
  v_mfma_f32_16x16x32_bf16 v[64:67], v[76:79], v[124:127], 0
  v_mfma_f32_16x16x32_bf16 v[64:67], v[100:103], v[120:123], v[64:67]
  v_add_f32 v80, v80, v81
  v_rcp_f32 v82, v80
  s_nop 0
  v_mul_f32 v84, v82, v84
  v_mul_f32 v85, v82, v85
  v_mul_f32 v86, v82, v86
  v_mul_f32 v87, v82, v87
  v_cvt_pk_bf16_f32 v84, v84, v85
  v_cvt_pk_bf16_f32 v85, v86, v87
  s_waitcnt lgkmcnt(12)
  ds_write_b32 v5, v84 offset:768
  ds_write_b32 v5, v85 offset:1792
  v_mul_f32 v60, v82, v60
  v_mul_f32 v61, v82, v61
  v_mul_f32 v62, v82, v62
  v_mul_f32 v63, v82, v63
  v_cvt_pk_bf16_f32 v60, v60, v61
  v_cvt_pk_bf16_f32 v61, v62, v63
  ds_write_b32 v5, v60 offset:2816
  s_waitcnt lgkmcnt(12)
  ds_write_b32 v5, v61 offset:3840
  v_mul_f32 v64, v82, v64
  v_mul_f32 v65, v82, v65
  v_mul_f32 v66, v82, v66
  v_mul_f32 v67, v82, v67
  v_cvt_pk_bf16_f32 v64, v64, v65
  v_cvt_pk_bf16_f32 v65, v66, v67
  ds_write_b32 v5, v64 offset:4864
  ds_write_b32 v5, v65 offset:5888
  s_waitcnt lgkmcnt(0)
  s_barrier
  ds_read_b128 a[244:247], v3 offset:0
  ds_read_b128 a[248:251], v3 offset:4096
  ds_read_b128 a[252:255], v3 offset:8192
  ds_read_b128 v[72:75], v3 offset:12288
  ds_read_b128 v[76:79], v3 offset:16384
  ds_read_b128 v[84:87], v3 offset:20480
  s_waitcnt lgkmcnt(5)
  v_mfma_f32_16x16x32_bf16 v[68:71], a[244:247], v[184:187], 0
  s_waitcnt lgkmcnt(4)
  v_mfma_f32_16x16x32_bf16 v[68:71], a[248:251], v[200:203], v[68:71]
  s_waitcnt lgkmcnt(3)
  v_mfma_f32_16x16x32_bf16 v[68:71], a[252:255], v[216:219], v[68:71]
  s_waitcnt lgkmcnt(2)
  v_mfma_f32_16x16x32_bf16 v[68:71], v[72:75], v[232:235], v[68:71]
  s_waitcnt lgkmcnt(1)
  v_mfma_f32_16x16x32_bf16 v[68:71], v[76:79], v[248:251], v[68:71]
  s_waitcnt lgkmcnt(0)
  v_mfma_f32_16x16x32_bf16 v[68:71], v[84:87], a[224:227], v[68:71]
  v_mfma_f32_16x16x32_bf16 v[80:83], v[84:87], a[228:231], 0
  v_mfma_f32_16x16x32_bf16 v[80:83], v[76:79], v[252:255], v[80:83]
  v_mfma_f32_16x16x32_bf16 v[80:83], v[72:75], v[236:239], v[80:83]
  v_mfma_f32_16x16x32_bf16 v[80:83], a[252:255], v[220:223], v[80:83]
  v_mfma_f32_16x16x32_bf16 v[80:83], a[248:251], v[204:207], v[80:83]
  v_mfma_f32_16x16x32_bf16 v[80:83], a[244:247], v[188:191], v[80:83]
  v_mfma_f32_16x16x32_bf16 v[60:63], a[244:247], v[192:195], 0
  v_mfma_f32_16x16x32_bf16 v[60:63], a[248:251], v[208:211], v[60:63]
  v_mfma_f32_16x16x32_bf16 v[60:63], a[252:255], v[224:227], v[60:63]
  v_mfma_f32_16x16x32_bf16 v[60:63], v[72:75], v[240:243], v[60:63]
  v_mfma_f32_16x16x32_bf16 v[60:63], v[76:79], a[216:219], v[60:63]
  v_mfma_f32_16x16x32_bf16 v[60:63], v[84:87], a[232:235], v[60:63]
  v_mfma_f32_16x16x32_bf16 v[64:67], v[84:87], a[236:239], 0
  v_mfma_f32_16x16x32_bf16 v[64:67], v[76:79], a[220:223], v[64:67]
  v_mfma_f32_16x16x32_bf16 v[64:67], v[72:75], v[244:247], v[64:67]
  v_mfma_f32_16x16x32_bf16 v[64:67], a[252:255], v[228:231], v[64:67]
  v_mfma_f32_16x16x32_bf16 v[64:67], a[248:251], v[212:215], v[64:67]
  v_mfma_f32_16x16x32_bf16 v[64:67], a[244:247], v[196:199], v[64:67]
  v_cvt_pk_bf16_f32 v68, v68, v80
  v_cvt_pk_bf16_f32 v69, v69, v81
  v_cvt_pk_bf16_f32 v70, v70, v82
  v_cvt_pk_bf16_f32 v71, v71, v83
  buffer_store_dword v68, v7, s[24:27], s33 offen offset:0 nt
  buffer_store_dword v69, v7, s[24:27], s33 offen offset:384 nt
  buffer_store_dword v70, v7, s[24:27], s33 offen offset:768 nt
  buffer_store_dword v71, v7, s[24:27], s33 offen offset:1152 nt
  v_cvt_pk_bf16_f32 v60, v60, v64
  v_cvt_pk_bf16_f32 v61, v61, v65
  v_cvt_pk_bf16_f32 v62, v62, v66
  v_cvt_pk_bf16_f32 v63, v63, v67
  buffer_store_dword v60, v8, s[24:27], s33 offen offset:0 nt
  buffer_store_dword v61, v8, s[24:27], s33 offen offset:384 nt
  buffer_store_dword v62, v8, s[24:27], s33 offen offset:768 nt
  buffer_store_dword v63, v8, s[24:27], s33 offen offset:1152 nt
  ds_read_b128 a[244:247], v4 offset:0
  ds_read_b128 a[248:251], v4 offset:4096
  ds_read_b128 a[252:255], v4 offset:8192
  ds_read_b128 v[68:71], v4 offset:12288
  ds_read_b128 v[72:75], v4 offset:16384
  ds_read_b128 v[76:79], v4 offset:20480
  s_waitcnt lgkmcnt(5)
  v_mfma_f32_16x16x32_bf16 v[60:63], a[244:247], v[184:187], 0
  s_waitcnt lgkmcnt(4)
  v_mfma_f32_16x16x32_bf16 v[60:63], a[248:251], v[200:203], v[60:63]
  s_waitcnt lgkmcnt(3)
  v_mfma_f32_16x16x32_bf16 v[60:63], a[252:255], v[216:219], v[60:63]
  s_waitcnt lgkmcnt(2)
  v_mfma_f32_16x16x32_bf16 v[60:63], v[68:71], v[232:235], v[60:63]
  s_waitcnt lgkmcnt(1)
  v_mfma_f32_16x16x32_bf16 v[60:63], v[72:75], v[248:251], v[60:63]
  s_waitcnt lgkmcnt(0)
  v_mfma_f32_16x16x32_bf16 v[60:63], v[76:79], a[224:227], v[60:63]
  v_mfma_f32_16x16x32_bf16 v[64:67], v[76:79], a[228:231], 0
  v_mfma_f32_16x16x32_bf16 v[64:67], v[72:75], v[252:255], v[64:67]
  v_mfma_f32_16x16x32_bf16 v[64:67], v[68:71], v[236:239], v[64:67]
  v_mfma_f32_16x16x32_bf16 v[64:67], a[252:255], v[220:223], v[64:67]
  v_mfma_f32_16x16x32_bf16 v[64:67], a[248:251], v[204:207], v[64:67]
  v_mfma_f32_16x16x32_bf16 v[64:67], a[244:247], v[188:191], v[64:67]
  s_nop 7
  v_cvt_pk_bf16_f32 v60, v60, v64
  v_cvt_pk_bf16_f32 v61, v61, v65
  v_cvt_pk_bf16_f32 v62, v62, v66
  v_cvt_pk_bf16_f32 v63, v63, v67
  buffer_store_dword v60, v7, s[24:27], s34 offen offset:0 nt
  buffer_store_dword v61, v7, s[24:27], s34 offen offset:384 nt
  buffer_store_dword v62, v7, s[24:27], s34 offen offset:768 nt
  buffer_store_dword v63, v7, s[24:27], s34 offen offset:1152 nt
  ds_read_b128 a[244:247], v3 offset:512
  ds_read_b128 a[248:251], v3 offset:4608
  ds_read_b128 a[252:255], v3 offset:8704
  ds_read_b128 v[72:75], v3 offset:12800
  ds_read_b128 v[76:79], v3 offset:16896
  ds_read_b128 v[84:87], v3 offset:20992
  s_waitcnt lgkmcnt(5)
  v_mfma_f32_16x16x32_bf16 v[60:63], a[244:247], v[184:187], 0
  s_waitcnt lgkmcnt(4)
  v_mfma_f32_16x16x32_bf16 v[60:63], a[248:251], v[200:203], v[60:63]
  s_waitcnt lgkmcnt(3)
  v_mfma_f32_16x16x32_bf16 v[60:63], a[252:255], v[216:219], v[60:63]
  s_waitcnt lgkmcnt(2)
  v_mfma_f32_16x16x32_bf16 v[60:63], v[72:75], v[232:235], v[60:63]
  s_waitcnt lgkmcnt(1)
  v_mfma_f32_16x16x32_bf16 v[60:63], v[76:79], v[248:251], v[60:63]
  s_waitcnt lgkmcnt(0)
  v_mfma_f32_16x16x32_bf16 v[60:63], v[84:87], a[224:227], v[60:63]
  v_mfma_f32_16x16x32_bf16 v[80:83], v[84:87], a[228:231], 0
  v_mfma_f32_16x16x32_bf16 v[80:83], v[76:79], v[252:255], v[80:83]
  v_mfma_f32_16x16x32_bf16 v[80:83], v[72:75], v[236:239], v[80:83]
  v_mfma_f32_16x16x32_bf16 v[80:83], a[252:255], v[220:223], v[80:83]
  v_mfma_f32_16x16x32_bf16 v[80:83], a[248:251], v[204:207], v[80:83]
  v_mfma_f32_16x16x32_bf16 v[80:83], a[244:247], v[188:191], v[80:83]
  v_mfma_f32_16x16x32_bf16 v[64:67], a[244:247], v[192:195], 0
  v_mfma_f32_16x16x32_bf16 v[64:67], a[248:251], v[208:211], v[64:67]
  v_mfma_f32_16x16x32_bf16 v[64:67], a[252:255], v[224:227], v[64:67]
  v_mfma_f32_16x16x32_bf16 v[64:67], v[72:75], v[240:243], v[64:67]
  v_mfma_f32_16x16x32_bf16 v[64:67], v[76:79], a[216:219], v[64:67]
  v_mfma_f32_16x16x32_bf16 v[64:67], v[84:87], a[232:235], v[64:67]
  v_mfma_f32_16x16x32_bf16 v[68:71], v[84:87], a[236:239], 0
  v_mfma_f32_16x16x32_bf16 v[68:71], v[76:79], a[220:223], v[68:71]
  v_mfma_f32_16x16x32_bf16 v[68:71], v[72:75], v[244:247], v[68:71]
  v_mfma_f32_16x16x32_bf16 v[68:71], a[252:255], v[228:231], v[68:71]
  v_mfma_f32_16x16x32_bf16 v[68:71], a[248:251], v[212:215], v[68:71]
  v_mfma_f32_16x16x32_bf16 v[68:71], a[244:247], v[196:199], v[68:71]
  v_cvt_pk_bf16_f32 v60, v60, v80
  v_cvt_pk_bf16_f32 v61, v61, v81
  v_cvt_pk_bf16_f32 v62, v62, v82
  v_cvt_pk_bf16_f32 v63, v63, v83
  buffer_store_dword v60, v7, s[24:27], s35 offen offset:0 nt
  buffer_store_dword v61, v7, s[24:27], s35 offen offset:384 nt
  buffer_store_dword v62, v7, s[24:27], s35 offen offset:768 nt
  buffer_store_dword v63, v7, s[24:27], s35 offen offset:1152 nt
  v_cvt_pk_bf16_f32 v64, v64, v68
  v_cvt_pk_bf16_f32 v65, v65, v69
  v_cvt_pk_bf16_f32 v66, v66, v70
  v_cvt_pk_bf16_f32 v67, v67, v71
  buffer_store_dword v64, v8, s[24:27], s35 offen offset:0 nt
  buffer_store_dword v65, v8, s[24:27], s35 offen offset:384 nt
  buffer_store_dword v66, v8, s[24:27], s35 offen offset:768 nt
  buffer_store_dword v67, v8, s[24:27], s35 offen offset:1152 nt
  ds_read_b128 a[244:247], v4 offset:512
  ds_read_b128 a[248:251], v4 offset:4608
  ds_read_b128 a[252:255], v4 offset:8704
  ds_read_b128 v[72:75], v4 offset:12800
  ds_read_b128 v[76:79], v4 offset:16896
  ds_read_b128 v[80:83], v4 offset:20992
  s_waitcnt lgkmcnt(5)
  v_mfma_f32_16x16x32_bf16 v[60:63], a[244:247], v[184:187], 0
  s_waitcnt lgkmcnt(4)
  v_mfma_f32_16x16x32_bf16 v[60:63], a[248:251], v[200:203], v[60:63]
  s_waitcnt lgkmcnt(3)
  v_mfma_f32_16x16x32_bf16 v[60:63], a[252:255], v[216:219], v[60:63]
  s_waitcnt lgkmcnt(2)
  v_mfma_f32_16x16x32_bf16 v[60:63], v[72:75], v[232:235], v[60:63]
  s_waitcnt lgkmcnt(1)
  v_mfma_f32_16x16x32_bf16 v[60:63], v[76:79], v[248:251], v[60:63]
  s_waitcnt lgkmcnt(0)
  v_mfma_f32_16x16x32_bf16 v[60:63], v[80:83], a[224:227], v[60:63]
  v_mfma_f32_16x16x32_bf16 v[64:67], v[80:83], a[228:231], 0
  v_mfma_f32_16x16x32_bf16 v[64:67], v[76:79], v[252:255], v[64:67]
  v_mfma_f32_16x16x32_bf16 v[64:67], v[72:75], v[236:239], v[64:67]
  v_mfma_f32_16x16x32_bf16 v[64:67], a[252:255], v[220:223], v[64:67]
  v_mfma_f32_16x16x32_bf16 v[64:67], a[248:251], v[204:207], v[64:67]
  v_mfma_f32_16x16x32_bf16 v[64:67], a[244:247], v[188:191], v[64:67]
  s_nop 7
  v_cvt_pk_bf16_f32 v60, v60, v64
  v_cvt_pk_bf16_f32 v61, v61, v65
  v_cvt_pk_bf16_f32 v62, v62, v66
  v_cvt_pk_bf16_f32 v63, v63, v67
  buffer_store_dword v60, v7, s[24:27], s36 offen offset:0 nt
  buffer_store_dword v61, v7, s[24:27], s36 offen offset:384 nt
  buffer_store_dword v62, v7, s[24:27], s36 offen offset:768 nt
  buffer_store_dword v63, v7, s[24:27], s36 offen offset:1152 nt
  v_sub_u32 v6, v6, v56
  v_sub_u32 v7, v7, v57
  v_sub_u32 v8, v8, v57
  v_mov_b32 v54, 0
  v_mov_b32 v55, 0
  v_mov_b32 v56, 0
  v_mov_b32 v57, 0
  s_add_u32 s50, s50, 1
  s_cmp_eq_u32 s50, 16
  s_cselect_b32 s5, s58, s43
  s_add_u32 s56, s56, s5
  s_mul_i32 s5, s3, s57
  s_add_u32 s31, s56, s5
  s_add_u32 s32, s31, 786432
  s_xor_b32 s5, s4, 0
  s_mul_i32 s5, s5, 393216
  s_add_u32 s33, s5, s56
  s_xor_b32 s5, s4, 1
  s_mul_i32 s5, s5, 393216
  s_add_u32 s34, s5, s56
  s_xor_b32 s5, s4, 2
  s_mul_i32 s5, s5, 393216
  s_add_u32 s35, s5, s56
  s_xor_b32 s5, s4, 3
  s_mul_i32 s5, s5, 393216
  s_add_u32 s36, s5, s56
  s_cmp_lt_u32 s50, s49
  s_nop 7
  s_cbranch_scc1 L_sloop
  s_branch L_fin
.section .rodata,"a"
.p2align 6
.amdhsa_kernel standalone__window_attn_swin__vision_kernel
  .amdhsa_next_free_vgpr 512
  .amdhsa_next_free_sgpr 102
  .amdhsa_accum_offset 256
  .amdhsa_group_segment_fixed_size 0
  .amdhsa_kernarg_size 72
  .amdhsa_user_sgpr_count 2
  .amdhsa_user_sgpr_kernarg_segment_ptr 1
  .amdhsa_system_sgpr_workgroup_id_x 1
.end_amdhsa_kernel
```

```asm
; @launch grid=(256,1,1) block=(256,1,1) lds=163840
.amdgcn_target "amdgcn-amd-amdhsa--gfx950"
.text
.globl standalone__window_attn_swin__vision_kernel
.p2align 12
.p2align 8
.type standalone__window_attn_swin__vision_kernel,@function
standalone__window_attn_swin__vision_kernel:
  s_cmpk_ge_u32 s2, 256
  s_cbranch_scc1 L_end
  s_load_dwordx2 s[8:9], s[0:1], 0
  s_load_dwordx2 s[20:21], s[0:1], 24
  s_load_dwordx2 s[12:13], s[0:1], 8
  s_load_dwordx2 s[16:17], s[0:1], 16
  s_load_dwordx2 s[24:25], s[0:1], 48
  s_load_dwordx2 s[62:63], s[0:1], 64
  v_lshrrev_b32 v75, 6, v0
  s_lshr_b32 s49, s2, 3
  v_readfirstlane_b32 s3, v75
  s_getpc_b64 s[50:51]
  v_and_b32 v75, 15, v0
  v_mad_u32_u24 v75, s49, 9, v75
  v_lshlrev_b32 v75, 7, v75
  v_min_u32 v75, L_safe-standalone__window_attn_swin__vision_kernel-256, v75
  v_mov_b32 v59, s51
  v_add_co_u32 v58, vcc, s50, v75
  s_and_b32 s47, s2, 63
  s_lshr_b32 s48, s2, 6
  v_addc_co_u32 v59, vcc, 0, v59, vcc
  global_load_dword v67, v[58:59], off
  v_bfe_u32 v56, v0, 3, 4
  v_and_b32 v54, 7, v0
  v_lshrrev_b32 v64, 1, v56
  v_lshlrev_b32 v76, 2, v56
  v_and_b32 v76, 4, v76
  v_xor_b32 v64, v64, v76
  v_xor_b32 v64, v54, v64
  v_and_b32 v55, 7, v56
  s_add_u32 s48, s48, 60
  s_cmp_lt_u32 s2, 60
  s_cselect_b32 s48, s2, s48
  s_cselect_b32 s47, 63, s47
  s_lshl_b32 s5, s47, 3
  s_add_u32 s5, s5, 4
  v_add_u32 v76, s5, v55
  v_and_b32 v76, 511, v76
  v_mul_u32_u24 v76, 0x180, v76
  v_lshlrev_b32 v58, 4, v64
  v_add_u32 v57, v58, v76
  v_and_b32 v65, 63, v0
  v_lshlrev_b32 v60, 4, v65
  s_mov_b32 s57, 196608
  s_lshl_b32 s5, s48, 3
  s_add_u32 s5, s5, s3
  s_add_u32 s5, s5, 4
  s_mul_i32 s53, s5, s57
  s_add_u32 s5, s5, 4
  s_and_b32 s5, s5, 511
  s_mul_i32 s54, s5, s57
  s_lshl_b32 s46, s3, 10
  s_lshl_b32 s5, s3, 11
  s_add_u32 m0, s5, 151552
  s_mov_b32 s11, 0x20000
  s_mov_b32 s10, 100663296
  s_mov_b32 s23, s11
  s_movk_i32 s22, 1800
  s_mov_b32 s15, s11
  s_mov_b32 s14, 221184
  s_lshl_b32 s49, s49, 2
  s_add_u32 s51, s49, s3
  s_mul_i32 s50, s51, 1728
  v_min_u32 v59, 13, v65
  v_lshlrev_b32 v59, 7, v59
  s_waitcnt lgkmcnt(0)
  buffer_load_dword v66, v59, s[12:15], s50 offen
  buffer_load_dwordx4 v60, s[20:23], 0 offen lds
  buffer_load_dwordx4 v60, s[20:23], 0 offen offset:1024 lds
  s_add_u32 m0, s46, 0
  v_and_b32 v64, 2, v56
  buffer_load_dwordx4 v57, s[8:11], s53 offen offset:0 nt lds
  s_add_u32 m0, s46, 8064
  v_lshrrev_b32 v76, 1, v56
  buffer_load_dwordx4 v57, s[8:11], s53 offen offset:128 nt lds
  s_add_u32 m0, s46, 16128
  v_and_b32 v76, 4, v76
  buffer_load_dwordx4 v57, s[8:11], s53 offen offset:256 nt lds
  s_add_u32 m0, s46, 4096
  v_or_b32 v76, v64, v76
  buffer_load_dwordx4 v57, s[8:11], s54 offen offset:0 nt lds
  s_add_u32 m0, s46, 12160
  v_xor_b32 v76, v54, v76
  buffer_load_dwordx4 v57, s[8:11], s54 offen offset:128 nt lds
  s_add_u32 m0, s46, 20224
  v_lshlrev_b32 v76, 4, v76
  buffer_load_dwordx4 v57, s[8:11], s54 offen offset:256 nt lds
  v_mul_u32_u24 v56, 1152, v55
  v_add_u32 v61, v76, v56
  s_mul_i32 s44, s3, 9216
  v_lshlrev_b32 v64, 1, v64
  v_xor_b32 v64, v54, v64
  v_mul_u32_u24 v76, 0x180, v55
  v_lshl_add_u32 v56, v64, 4, v76
  s_mul_i32 s45, s3, 3072
  s_mov_b32 s19, s11
  s_mov_b32 s18, 73728
  s_mul_i32 s51, s51, 576
  v_min_u32 v57, 512, v59
  v_add_u32 v6, v58, v76
  s_mov_b32 s27, s11
  s_mov_b32 s26, 100663296
  v_and_b32 v54, 15, v65
  v_lshrrev_b32 v55, 4, v65
  v_lshrrev_b32 v75, 1, v54
  v_lshlrev_b32 v64, 2, v54
  v_and_b32 v64, 4, v64
  v_xor_b32 v75, v75, v64
  v_xor_b32 v75, v55, v75
  v_lshlrev_b32 v75, 4, v75
  v_lshl_add_u32 v0, v54, 7, v75
  v_xor_b32 v1, 64, v0
  v_subrev_u32 v2, s46, v0
  s_add_u32 s28, s46, 28672
  s_add_u32 s29, s46, 53248
  s_mov_b32 s30, s46
  s_and_b32 s4, s3, 1
  v_lshlrev_b32 v75, 4, v54
  v_lshl_add_u32 v64, v55, 10, v75
  s_lshl_b32 s5, s4, 8
  s_add_u32 s5, s5, 77824
  v_add_u32 v3, s5, v64
  v_xor_b32 v4, 0x100, v3
  s_mul_i32 s5, s3, 6144
  s_add_u32 s6, s5, 102400
  s_add_u32 s5, s5, 77824
  s_xor_b32 s41, s5, s6
  v_lshl_add_u32 v64, v55, 2, v75
  v_add_u32 v5, s5, v64
  v_and_b32 v70, 7, v54
  v_lshrrev_b32 v73, 3, v54
  v_and_b32 v72, 1, v55
  v_lshrrev_b32 v74, 1, v55
  v_mul_u32_u24 v75, 0x600, v72
  v_mul_u32_u24 v64, s57, v74
  v_add_u32 v75, v75, v64
  v_lshl_add_u32 v75, v54, 2, v75
  s_lshr_b32 s49, s3, 1
  s_lshl_b32 s5, s49, 6
  s_add_u32 s6, s5, 256
  v_add_u32 v53, s6, v75
  s_lshl_b32 s6, s4, 7
  s_add_u32 s5, s5, s6
  v_add_u32 v52, s5, v75
  s_lshl_b32 s5, s47, 3
  s_add_u32 s5, s5, 4
  s_mul_i32 s5, s5, 384
  s_cmp_eq_u32 s47, 63
  s_cselect_b32 s37, 0, s5
  s_cselect_b32 s5, s5, 0
  s_cselect_b32 s6, s57, 0
  v_mul_u32_u24 v64, s6, v72
  v_sub_u32 v64, s5, v64
  s_lshl_b32 s38, s48, 3
  s_add_u32 s38, s38, 4
  s_xor_b32 s6, s4, 0
  s_lshl_b32 s6, s6, 1
  s_add_u32 s6, s6, s38
  s_and_b32 s6, s6, 511
  s_mul_i32 s6, s6, s57
  s_add_u32 s33, s6, s37
  s_xor_b32 s6, s4, 1
  s_lshl_b32 s6, s6, 1
  s_add_u32 s6, s6, s38
  s_and_b32 s6, s6, 511
  s_mul_i32 s6, s6, s57
  s_add_u32 s34, s6, s37
  s_xor_b32 s6, s4, 2
  s_lshl_b32 s6, s6, 1
  s_add_u32 s6, s6, s38
  s_and_b32 s6, s6, 511
  s_mul_i32 s6, s6, s57
  s_add_u32 s35, s6, s37
  s_xor_b32 s6, s4, 3
  s_lshl_b32 s6, s6, 1
  s_add_u32 s6, s6, s38
  s_and_b32 s6, s6, 511
  s_mul_i32 s6, s6, s57
  s_add_u32 s36, s6, s37
  v_add_u32 v7, v52, v64
  v_add_u32 v8, v53, v64
  s_lshr_b32 s5, s2, 6
  s_and_b32 s6, s2, 63
  s_mul_i32 s56, s5, 15
  s_lshl_b32 s43, s57, 5
  s_cmp_eq_u32 s6, 63
  s_cselect_b32 s6, s56, s6
  s_cselect_b32 s5, 60, s5
  s_cselect_b32 s43, 3072, s43
  s_mul_i32 s5, s5, 1572864
  s_mul_i32 s6, s6, 3072
  s_add_u32 s5, s5, s6
  s_add_u32 s56, s5, 787968
  s_mul_i32 s5, s3, s57
  s_add_u32 s31, s56, s5
  s_add_u32 s32, s31, 786432
  s_mul_i32 s6, s43, 3
  s_add_u32 s5, s5, s6
  s_xor_b32 s6, s4, 0
  s_mul_i32 s6, s6, 393216
  s_sub_u32 s37, s6, s5
  s_xor_b32 s6, s4, 1
  s_mul_i32 s6, s6, 393216
  s_sub_u32 s38, s6, s5
  s_xor_b32 s6, s4, 2
  s_mul_i32 s6, s6, 393216
  s_sub_u32 s39, s6, s5
  s_xor_b32 s6, s4, 3
  s_mul_i32 s6, s6, 393216
  s_sub_u32 s40, s6, s5
  s_mov_b32 s97, 14
  s_mov_b32 s42, 0x3e553b95
  v_lshrrev_b32 v75, 2, v54
  v_lshl_add_u32 v64, v72, 1, v73
  v_lshl_add_u32 v75, v55, 3, v75
  v_lshlrev_b32 v75, 7, v75
  v_lshl_add_u32 v75, v64, 5, v75
  v_and_b32 v77, 3, v54
  v_lshl_add_u32 v75, v77, 3, v75
  s_mul_i32 s5, s3, 3
  s_and_b32 s6, s5, 3
  s_lshl_b32 s6, s6, 5
  s_lshr_b32 s7, s5, 2
  s_lshl_b32 s7, s7, 13
  s_add_u32 s7, s7, 28672
  v_xor_b32 v64, s6, v75
  v_add_u32 v62, s7, v64
  v_add_u32 v58, 73728, v62
  s_add_u32 s5, s5, 1
  s_and_b32 s6, s5, 3
  s_lshl_b32 s6, s6, 5
  s_lshr_b32 s7, s5, 2
  s_lshl_b32 s7, s7, 13
  s_add_u32 s7, s7, 28672
  v_xor_b32 v64, s6, v75
  v_add_u32 v63, s7, v64
  v_add_u32 v59, 73728, v63
  s_add_u32 s5, s5, 1
  s_and_b32 s6, s5, 3
  s_lshl_b32 s6, s6, 5
  s_lshr_b32 s7, s5, 2
  s_lshl_b32 s7, s7, 13
  s_add_u32 s7, s7, 28672
  v_xor_b32 v64, s6, v75
  v_add_u32 v71, s7, v64
  v_add_u32 v60, 73728, v71
  v_xor_b32 v64, s49, v72
  s_lshl_b32 s5, s4, 13
  v_lshl_add_u32 v75, v74, 3, v72
  v_lshl_add_u32 v75, v75, 2, v64
  v_lshl_add_u32 v75, v75, 4, v54
  v_lshlrev_b32 v75, 2, v75
  s_add_u32 s5, s5, 126976
  v_add_u32 v69, s5, v75
  v_add_u32 v68, 128, v69
  v_add_u32 v54, 143360, v75
  v_add_u32 v55, 128, v54
  s_mov_b32 s58, 0x05040100
  s_mov_b32 s59, 0x07060302
  v_cmp_gt_u32 vcc, 2, v77
  v_mov_b32 v75, 0x3f803f80
  v_mov_b32 v64, 0x44444444
  v_cndmask_b32 v75, 0, v75, vcc
  v_cmp_eq_u32 vcc, 1, v77
  v_mov_b32 v76, 0xeeeeeeee
  v_accvgpr_write_b32 a240, v75
  v_accvgpr_write_b32 a241, v75
  v_accvgpr_write_b32 a242, v75
  v_accvgpr_write_b32 a243, v75
  v_cndmask_b32 v10, v64, v76, vcc
  v_mov_b32 v9, 1.0
  s_mov_b32 s98, s43
  s_mov_b64 s[20:21], s[62:63]
  s_mov_b32 s22, 402653184
  s_min_u32 s96, s3, 1
  s_lshl_b32 s96, s96, 7
  s_xor_b32 s96, s96, 1152
  s_bitset1_b32 s96, s97
  s_mov_b64 s[62:63], -1
  v_lshlrev_b32 v11, 3, v65
  v_lshlrev_b32 v75, 2, v70
  v_add_u32 v75, 159808, v75
  v_mov_b32 v64, 0
  ds_write_b32 v75, v64
  s_lshl_b32 m0, s3, 8
  s_nop 0
  ds_write_addtid_b32 v64 offset:24576
  v_mov_b64 v[14:15], 0
  v_mov_b64 v[20:21], 0
  v_sub_u32 v75, v73, v74
  v_mul_i32_i24 v75, 15, v75
  v_lshlrev_b32 v64, 2, v72
  v_sub_u32 v76, v70, v64
  v_add3_u32 v75, v75, v76, 19
  s_mul_i32 s5, s3, 2050
  s_add_u32 s5, s5, 151552
  v_lshl_add_u32 v72, v75, 3, s5
  v_mov_b64 v[24:25], 0
  v_mov_b64 v[26:27], 0
  v_mov_b64 v[28:29], 0
  v_mov_b64 v[30:31], 0
  v_mov_b64 v[32:33], 0
  v_mov_b64 v[34:35], 0
  v_mov_b64 v[36:37], 0
  v_mov_b64 v[38:39], 0
  v_mov_b64 v[40:41], 0
  v_mov_b64 v[42:43], 0
  v_mov_b64 v[44:45], 0
  v_mov_b64 v[46:47], 0
  v_mov_b64 v[48:49], 0
  v_mov_b64 v[50:51], 0
  v_xor_b32 v75, v64, v70
  s_cmp_eq_u32 s47, 63
  s_cselect_b32 s5, 4, 0
  v_and_b32 v75, s5, v75
  v_cmp_eq_u32 vcc, 0, v75
  s_cmp_eq_u32 s48, 63
  s_cselect_b32 s5, 0xc31044fe, 0
  v_mov_b32 v64, s5
  v_mov_b32 v70, 0xc31044fe
  v_cndmask_b32 v64, 0, v64, vcc
  v_cndmask_b32 v70, v70, 0, vcc
  s_add_u32 s5, s44, 0
  s_add_u32 m0, s46, 28672
  s_nop 0
  buffer_load_dwordx4 v61, s[12:15], s5 offen offset:0 lds
  s_add_u32 m0, s46, 36736
  s_nop 0
  buffer_load_dwordx4 v61, s[12:15], s5 offen offset:128 lds
  s_add_u32 m0, s46, 44800
  s_nop 0
  buffer_load_dwordx4 v61, s[12:15], s5 offen offset:256 lds
  s_add_u32 s5, s44, 36864
  s_add_u32 m0, s46, 32768
  s_nop 0
  buffer_load_dwordx4 v61, s[12:15], s5 offen offset:0 lds
  s_add_u32 m0, s46, 40832
  s_nop 0
  buffer_load_dwordx4 v61, s[12:15], s5 offen offset:128 lds
  s_add_u32 m0, s46, 48896
  s_nop 0
  buffer_load_dwordx4 v61, s[12:15], s5 offen offset:256 lds
  s_mov_b64 exec, 0
  s_cmp_eq_u32 s3, 0
  s_cbranch_scc1 L_hop_0_0
  s_cmp_eq_u32 s3, 1
  s_cbranch_scc1 L_hop_1_0
  s_cmp_eq_u32 s3, 2
  s_cbranch_scc1 L_hop_2_0
  s_branch L_hop_3_0
L_walk:
  s_mov_b64 exec, -1
L_walked:
  s_waitcnt vmcnt(12)
  ds_read_u16_d16_hi v24, v72 offset:24
  ds_read_u16_d16_hi v25, v72 offset:16
  ds_read_u16_d16_hi v26, v72 offset:8
  ds_read_u16_d16_hi v27, v72 offset:0
  ds_read_u16_d16_hi v28, v72 offset:264
  ds_read_u16_d16_hi v29, v72 offset:256
  ds_read_u16_d16_hi v30, v72 offset:248
  ds_read_u16_d16_hi v31, v72 offset:240
  ds_read_u16_d16_hi v32, v72 offset:504
  ds_read_u16_d16_hi v33, v72 offset:496
  ds_read_u16_d16_hi v34, v72 offset:488
  ds_read_u16_d16_hi v35, v72 offset:480
  ds_read_u16_d16_hi v36, v72 offset:744
  ds_read_u16_d16_hi v37, v72 offset:736
  ds_read_u16_d16_hi v38, v72 offset:728
  ds_read_u16_d16_hi v39, v72 offset:720
  ds_read_u16_d16_hi v40, v72 offset:984
  ds_read_u16_d16_hi v41, v72 offset:976
  ds_read_u16_d16_hi v42, v72 offset:968
  ds_read_u16_d16_hi v43, v72 offset:960
  ds_read_u16_d16_hi v44, v72 offset:1224
  ds_read_u16_d16_hi v45, v72 offset:1216
  ds_read_u16_d16_hi v46, v72 offset:1208
  ds_read_u16_d16_hi v47, v72 offset:1200
  ds_read_u16_d16_hi v48, v72 offset:1464
  ds_read_u16_d16_hi v49, v72 offset:1456
  ds_read_u16_d16_hi v50, v72 offset:1448
  ds_read_u16_d16_hi v51, v72 offset:1440
  s_mov_b32 s5, 0x3fb8aa3b
  v_add_f32 v64, v70, v64
  s_waitcnt lgkmcnt(15)
  v_mul_f32 v24, s5, v24
  v_mul_f32 v25, s5, v25
  v_mul_f32 v26, s5, v26
  v_mul_f32 v27, s5, v27
  v_mul_f32 v28, s5, v28
  v_mul_f32 v29, s5, v29
  v_mul_f32 v30, s5, v30
  v_mul_f32 v31, s5, v31
  v_mul_f32 v32, s5, v32
  v_mul_f32 v33, s5, v33
  v_mul_f32 v34, s5, v34
  v_mul_f32 v35, s5, v35
  v_mul_f32 v36, s5, v36
  s_waitcnt lgkmcnt(14)
  v_mul_f32 v37, s5, v37
  s_waitcnt lgkmcnt(13)
  v_mul_f32 v38, s5, v38
  s_waitcnt lgkmcnt(12)
  v_mul_f32 v39, s5, v39
  s_waitcnt lgkmcnt(11)
  v_mul_f32 v40, s5, v40
  s_waitcnt lgkmcnt(10)
  v_mul_f32 v41, s5, v41
  s_waitcnt lgkmcnt(9)
  v_mul_f32 v42, s5, v42
  s_waitcnt lgkmcnt(8)
  v_mul_f32 v43, s5, v43
  s_waitcnt lgkmcnt(7)
  v_mul_f32 v44, s5, v44
  s_waitcnt lgkmcnt(6)
  v_mul_f32 v45, s5, v45
  s_waitcnt lgkmcnt(5)
  v_mul_f32 v46, s5, v46
  s_waitcnt lgkmcnt(4)
  v_mul_f32 v47, s5, v47
  s_waitcnt lgkmcnt(3)
  v_mul_f32 v48, s5, v48
  s_waitcnt lgkmcnt(2)
  v_mul_f32 v49, s5, v49
  s_waitcnt lgkmcnt(1)
  v_mul_f32 v50, s5, v50
  s_waitcnt lgkmcnt(0)
  v_mul_f32 v51, s5, v51
  v_add_f32 v76, v64, v48
  v_add_f32 v77, v64, v49
  v_add_f32 v78, v64, v50
  v_add_f32 v79, v64, v51
  v_add_f32 v72, v64, v44
  v_add_f32 v73, v64, v45
  v_add_f32 v74, v64, v46
  v_add_f32 v75, v64, v47
  v_add_f32 v80, v64, v40
  v_add_f32 v81, v64, v41
  v_add_f32 v82, v64, v42
  v_add_f32 v83, v64, v43
  v_add_f32 v84, v64, v32
  v_add_f32 v85, v64, v33
  v_add_f32 v86, v64, v34
  v_add_f32 v87, v64, v35
  v_add_f32 v88, v64, v28
  v_add_f32 v89, v64, v29
  v_add_f32 v90, v64, v30
  v_add_f32 v91, v64, v31
  v_add_f32 v92, v64, v24
  v_add_f32 v93, v64, v25
  v_add_f32 v94, v64, v26
  v_add_f32 v95, v64, v27
  s_add_u32 s5, s44, 73728
  s_add_u32 m0, s46, 53248
  s_nop 0
  buffer_load_dwordx4 v61, s[12:15], s5 offen offset:0 lds
  s_add_u32 m0, s46, 61312
  s_nop 0
  buffer_load_dwordx4 v61, s[12:15], s5 offen offset:128 lds
  s_add_u32 m0, s46, 69376
  s_nop 0
  buffer_load_dwordx4 v61, s[12:15], s5 offen offset:256 lds
  s_add_u32 s5, s44, 110592
  s_add_u32 m0, s46, 57344
  s_nop 0
  buffer_load_dwordx4 v61, s[12:15], s5 offen offset:0 lds
  s_add_u32 m0, s46, 65408
  s_nop 0
  buffer_load_dwordx4 v61, s[12:15], s5 offen offset:128 lds
  s_add_u32 m0, s46, 73472
  s_nop 0
  buffer_load_dwordx4 v61, s[12:15], s5 offen offset:256 lds
  s_cmp_eq_u32 s43, 3072
  s_cselect_b32 s10, s10, 95158272
  s_waitcnt vmcnt(12)
  s_barrier
  ds_read_b128 v[184:187], v0 offset:0
  ds_read_b128 v[188:191], v1 offset:0
  ds_read_b128 v[208:211], v0 offset:2048
  ds_read_b128 v[212:215], v1 offset:2048
  ds_read_b128 v[232:235], v0 offset:4096
  ds_read_b128 v[236:239], v1 offset:4096
  ds_read_b128 a[216:219], v0 offset:6144
  ds_read_b128 a[220:223], v1 offset:6144
  s_add_u32 s5, s44, 147456
  s_add_u32 m0, s46, 77824
  s_nop 0
  buffer_load_dwordx4 v61, s[12:15], s5 offen offset:0 lds
  s_add_u32 m0, s46, 85888
  s_nop 0
  buffer_load_dwordx4 v61, s[12:15], s5 offen offset:128 lds
  s_add_u32 m0, s46, 93952
  s_nop 0
  buffer_load_dwordx4 v61, s[12:15], s5 offen offset:256 lds
  s_waitcnt vmcnt(9)
  s_barrier
  ds_read_b64_tr_b16 a[0:1], v62 offset:0
  ds_read_b64_tr_b16 a[2:3], v62 offset:512
  ds_read_b64_tr_b16 a[12:13], v62 offset:4096
  ds_read_b64_tr_b16 a[14:15], v62 offset:4608
  s_waitcnt lgkmcnt(2)
  v_mfma_f32_16x16x32_bf16 v[120:123], a[0:3], v[184:187], 0
  s_add_u32 s5, s44, 184320
  s_add_u32 m0, s46, 81920
  ds_read_b64_tr_b16 a[4:5], v63 offset:0
  s_waitcnt lgkmcnt(1)
  v_mfma_f32_16x16x32_bf16 v[120:123], a[12:15], v[188:191], v[120:123]
  buffer_load_dwordx4 v61, s[12:15], s5 offen offset:0 lds
  v_mfma_f32_16x16x32_bf16 v[132:135], a[0:3], v[208:211], 0
  s_add_u32 m0, s46, 89984
  ds_read_b64_tr_b16 a[6:7], v63 offset:512
  ds_read_b64_tr_b16 a[16:17], v63 offset:4096
  v_mfma_f32_16x16x32_bf16 v[132:135], a[12:15], v[212:215], v[132:135]
  buffer_load_dwordx4 v61, s[12:15], s5 offen offset:128 lds
  v_mfma_f32_16x16x32_bf16 v[160:163], a[0:3], v[232:235], 0
  s_add_u32 m0, s46, 98048
  ds_read_b64_tr_b16 a[18:19], v63 offset:4608
  ds_read_b64_tr_b16 a[8:9], v71 offset:0
  v_mfma_f32_16x16x32_bf16 v[160:163], a[12:15], v[236:239], v[160:163]
  buffer_load_dwordx4 v61, s[12:15], s5 offen offset:256 lds
  v_mfma_f32_16x16x32_bf16 v[176:179], a[0:3], a[216:219], 0
  s_add_u32 s5, s44, 384
  s_add_u32 m0, s46, 102400
  ds_read_b64_tr_b16 a[10:11], v71 offset:512
  v_mfma_f32_16x16x32_bf16 v[176:179], a[12:15], a[220:223], v[176:179]
  s_waitcnt lgkmcnt(3)
  ds_read_b64_tr_b16 a[20:21], v71 offset:4096
  ds_read_b64_tr_b16 a[22:23], v71 offset:4608
  v_mfma_f32_16x16x32_bf16 v[140:143], a[4:7], v[184:187], 0
  buffer_load_dwordx4 v61, s[12:15], s5 offen offset:0 lds
  s_waitcnt lgkmcnt(4)
  v_mfma_f32_16x16x32_bf16 v[140:143], a[16:19], v[188:191], v[140:143]
  s_add_u32 m0, s46, 110464
  ds_read_b128 v[192:195], v0 offset:8192
  ds_read_b128 v[196:199], v1 offset:8192
  v_mfma_f32_16x16x32_bf16 v[124:127], a[4:7], v[208:211], 0
  buffer_load_dwordx4 v61, s[12:15], s5 offen offset:128 lds
  v_mfma_f32_16x16x32_bf16 v[124:127], a[16:19], v[212:215], v[124:127]
  s_add_u32 m0, s46, 118528
  ds_read_b128 v[216:219], v0 offset:10240
  ds_read_b128 v[220:223], v1 offset:10240
  v_mfma_f32_16x16x32_bf16 v[168:171], a[4:7], v[232:235], 0
  buffer_load_dwordx4 v61, s[12:15], s5 offen offset:256 lds
  v_mfma_f32_16x16x32_bf16 v[168:171], a[16:19], v[236:239], v[168:171]
  s_add_u32 s5, s44, 37248
  s_add_u32 m0, s46, 106496
  ds_read_b128 v[240:243], v0 offset:12288
  v_mfma_f32_16x16x32_bf16 v[116:119], a[4:7], a[216:219], 0
  s_waitcnt lgkmcnt(3)
  ds_read_b128 v[244:247], v1 offset:12288
  ds_read_b128 a[224:227], v0 offset:14336
  v_mfma_f32_16x16x32_bf16 v[116:119], a[16:19], a[220:223], v[116:119]
  s_waitcnt vmcnt(9)
  s_barrier
  v_mfma_f32_16x16x32_bf16 v[144:147], a[8:11], v[184:187], 0
  buffer_load_dwordx4 v61, s[12:15], s5 offen offset:0 lds
  v_mfma_f32_16x16x32_bf16 v[144:147], a[20:23], v[188:191], v[144:147]
  s_add_u32 m0, s46, 114560
  ds_read_b64_tr_b16 a[24:25], v62 offset:24576
  ds_read_b64_tr_b16 a[26:27], v62 offset:25088
  v_mfma_f32_16x16x32_bf16 v[148:151], a[8:11], v[208:211], 0
  buffer_load_dwordx4 v61, s[12:15], s5 offen offset:128 lds
  v_mfma_f32_16x16x32_bf16 v[148:151], a[20:23], v[212:215], v[148:151]
  s_add_u32 m0, s46, 122624
  ds_read_b64_tr_b16 a[36:37], v62 offset:28672
  ds_read_b64_tr_b16 a[38:39], v62 offset:29184
  v_mfma_f32_16x16x32_bf16 v[108:111], a[8:11], v[232:235], 0
  buffer_load_dwordx4 v61, s[12:15], s5 offen offset:256 lds
  v_mfma_f32_16x16x32_bf16 v[108:111], a[20:23], v[236:239], v[108:111]
  ds_read_b128 a[228:231], v1 offset:14336
  ds_read_b64_tr_b16 a[28:29], v63 offset:24576
  v_mfma_f32_16x16x32_bf16 v[96:99], a[8:11], a[216:219], 0
  ds_read_b64_tr_b16 a[30:31], v63 offset:25088
  ds_read_b64_tr_b16 a[40:41], v63 offset:28672
  v_mfma_f32_16x16x32_bf16 v[96:99], a[20:23], a[220:223], v[96:99]
  s_waitcnt lgkmcnt(6)
  ds_read_b64_tr_b16 a[42:43], v63 offset:29184
  ds_read_b64_tr_b16 a[32:33], v71 offset:24576
  v_mfma_f32_16x16x32_bf16 v[120:123], a[24:27], v[192:195], v[120:123]
  s_waitcnt lgkmcnt(6)
  ds_read_b64_tr_b16 a[34:35], v71 offset:25088
  ds_read_b64_tr_b16 a[44:45], v71 offset:28672
  v_mfma_f32_16x16x32_bf16 v[120:123], a[36:39], v[196:199], v[120:123]
  ds_read_b64_tr_b16 a[46:47], v71 offset:29184
  ds_read_b128 v[200:203], v0 offset:16384
  v_mfma_f32_16x16x32_bf16 v[132:135], a[24:27], v[216:219], v[132:135]
L_hop_0_0:
  s_cbranch_execz L_hop_0_1
  ds_read_b128 v[204:207], v1 offset:16384
  ds_read_b128 v[224:227], v0 offset:18432
  v_mfma_f32_16x16x32_bf16 v[132:135], a[36:39], v[220:223], v[132:135]
  ds_read_b128 v[228:231], v1 offset:18432
  ds_read_b128 v[248:251], v0 offset:20480
  v_mfma_f32_16x16x32_bf16 v[160:163], a[24:27], v[240:243], v[160:163]
  ds_read_b128 v[252:255], v1 offset:20480
  ds_read_b128 a[232:235], v0 offset:22528
  v_mfma_f32_16x16x32_bf16 v[160:163], a[36:39], v[244:247], v[160:163]
  s_add_u32 s5, s44, 74112
  s_add_u32 m0, s46, 126976
  ds_read_b128 a[236:239], v1 offset:22528
  v_mfma_f32_16x16x32_bf16 v[176:179], a[24:27], a[224:227], v[176:179]
  s_waitcnt lgkmcnt(7)
  v_mfma_f32_16x16x32_bf16 v[176:179], a[36:39], a[228:231], v[176:179]
  v_mfma_f32_16x16x32_bf16 v[140:143], a[28:31], v[192:195], v[140:143]
  buffer_load_dwordx4 v61, s[12:15], s5 offen offset:0 lds
  v_mfma_f32_16x16x32_bf16 v[140:143], a[40:43], v[196:199], v[140:143]
  s_add_u32 m0, s46, 135040
  v_mfma_f32_16x16x32_bf16 v[124:127], a[28:31], v[216:219], v[124:127]
  buffer_load_dwordx4 v61, s[12:15], s5 offen offset:128 lds
  v_mfma_f32_16x16x32_bf16 v[124:127], a[40:43], v[220:223], v[124:127]
  s_add_u32 m0, s46, 143104
  v_mfma_f32_16x16x32_bf16 v[168:171], a[28:31], v[240:243], v[168:171]
  buffer_load_dwordx4 v61, s[12:15], s5 offen offset:256 lds
  v_mfma_f32_16x16x32_bf16 v[168:171], a[40:43], v[244:247], v[168:171]
  s_add_u32 s5, s44, 110976
  s_add_u32 m0, s46, 131072
  v_mfma_f32_16x16x32_bf16 v[116:119], a[28:31], a[224:227], v[116:119]
  v_mfma_f32_16x16x32_bf16 v[116:119], a[40:43], a[228:231], v[116:119]
  s_waitcnt vmcnt(9)
  s_barrier
  v_mfma_f32_16x16x32_bf16 v[144:147], a[32:35], v[192:195], v[144:147]
  buffer_load_dwordx4 v61, s[12:15], s5 offen offset:0 lds
  v_mfma_f32_16x16x32_bf16 v[144:147], a[44:47], v[196:199], v[144:147]
  s_add_u32 m0, s46, 139136
  ds_read_b64_tr_b16 a[48:49], v62 offset:49152
  ds_read_b64_tr_b16 a[50:51], v62 offset:49664
  v_mfma_f32_16x16x32_bf16 v[148:151], a[32:35], v[216:219], v[148:151]
  buffer_load_dwordx4 v61, s[12:15], s5 offen offset:128 lds
  v_mfma_f32_16x16x32_bf16 v[148:151], a[44:47], v[220:223], v[148:151]
  s_add_u32 m0, s46, 147200
  ds_read_b64_tr_b16 a[60:61], v62 offset:53248
  ds_read_b64_tr_b16 a[62:63], v62 offset:53760
  v_mfma_f32_16x16x32_bf16 v[108:111], a[32:35], v[240:243], v[108:111]
  buffer_load_dwordx4 v61, s[12:15], s5 offen offset:256 lds
  v_mfma_f32_16x16x32_bf16 v[108:111], a[44:47], v[244:247], v[108:111]
  ds_read_b64_tr_b16 a[52:53], v63 offset:49152
  ds_read_b64_tr_b16 a[54:55], v63 offset:49664
  v_mfma_f32_16x16x32_bf16 v[96:99], a[32:35], a[224:227], v[96:99]
  ds_read_b64_tr_b16 a[64:65], v63 offset:53248
  ds_read_b64_tr_b16 a[66:67], v63 offset:53760
  v_mfma_f32_16x16x32_bf16 v[96:99], a[44:47], a[228:231], v[96:99]
  s_waitcnt lgkmcnt(6)
  ds_read_b64_tr_b16 a[56:57], v71 offset:49152
  ds_read_b64_tr_b16 a[58:59], v71 offset:49664
  v_mfma_f32_16x16x32_bf16 v[120:123], a[48:51], v[200:203], v[120:123]
  s_waitcnt lgkmcnt(6)
  ds_read_b64_tr_b16 a[68:69], v71 offset:53248
  ds_read_b64_tr_b16 a[70:71], v71 offset:53760
  v_mfma_f32_16x16x32_bf16 v[120:123], a[60:63], v[204:207], v[120:123]
  v_mfma_f32_16x16x32_bf16 v[132:135], a[48:51], v[224:227], v[132:135]
  v_mfma_f32_16x16x32_bf16 v[132:135], a[60:63], v[228:231], v[132:135]
  v_mfma_f32_16x16x32_bf16 v[160:163], a[48:51], v[248:251], v[160:163]
  v_mul_f32 v120, s42, v120
  v_mul_f32 v121, s42, v121
  v_mfma_f32_16x16x32_bf16 v[160:163], a[60:63], v[252:255], v[160:163]
  s_add_u32 s5, s44, 147840
  s_add_u32 m0, s46, 28672
  v_mul_f32 v122, s42, v122
  v_mfma_f32_16x16x32_bf16 v[176:179], a[48:51], a[232:235], v[176:179]
  v_mul_f32 v123, s42, v123
  v_cvt_pk_bf16_f32 v12, v120, v121
  v_mfma_f32_16x16x32_bf16 v[176:179], a[60:63], a[236:239], v[176:179]
  s_waitcnt lgkmcnt(0)
  v_cvt_pk_bf16_f32 v13, v122, v123
  v_mul_f32 v132, s42, v132
  v_mfma_f32_16x16x32_bf16 v[140:143], a[52:55], v[200:203], v[140:143]
  buffer_load_dwordx4 v61, s[12:15], s5 offen offset:0 lds
  v_mfma_f32_16x16x32_bf16 v[140:143], a[64:67], v[204:207], v[140:143]
  s_add_u32 m0, s46, 36736
  v_mul_f32 v133, s42, v133
  v_mul_f32 v134, s42, v134
  v_mfma_f32_16x16x32_bf16 v[124:127], a[52:55], v[224:227], v[124:127]
  buffer_load_dwordx4 v61, s[12:15], s5 offen offset:128 lds
  v_mfma_f32_16x16x32_bf16 v[124:127], a[64:67], v[228:231], v[124:127]
  s_add_u32 m0, s46, 44800
  v_mul_f32 v135, s42, v135
  v_cvt_pk_bf16_f32 v64, v132, v133
  v_mfma_f32_16x16x32_bf16 v[168:171], a[52:55], v[248:251], v[168:171]
  buffer_load_dwordx4 v61, s[12:15], s5 offen offset:256 lds
  v_mfma_f32_16x16x32_bf16 v[168:171], a[64:67], v[252:255], v[168:171]
  s_add_u32 s5, s44, 184704
  s_add_u32 m0, s46, 32768
  v_mul_f32 v140, s42, v140
  v_mfma_f32_16x16x32_bf16 v[116:119], a[52:55], a[232:235], v[116:119]
  v_mul_f32 v141, s42, v141
  v_mul_f32 v142, s42, v142
  v_mfma_f32_16x16x32_bf16 v[116:119], a[64:67], a[236:239], v[116:119]
  s_waitcnt vmcnt(9)
  s_barrier
  v_mfma_f32_16x16x32_bf16 v[144:147], a[56:59], v[200:203], v[144:147]
  buffer_load_dwordx4 v61, s[12:15], s5 offen offset:0 lds
  v_mfma_f32_16x16x32_bf16 v[144:147], a[68:71], v[204:207], v[144:147]
  s_add_u32 m0, s46, 40832
  ds_read_b64_tr_b16 a[72:73], v58 offset:0
  ds_read_b64_tr_b16 a[74:75], v58 offset:512
  v_mfma_f32_16x16x32_bf16 v[148:151], a[56:59], v[224:227], v[148:151]
  buffer_load_dwordx4 v61, s[12:15], s5 offen offset:128 lds
  v_mfma_f32_16x16x32_bf16 v[148:151], a[68:71], v[228:231], v[148:151]
  s_add_u32 m0, s46, 48896
  ds_read_b64_tr_b16 a[84:85], v58 offset:4096
  ds_read_b64_tr_b16 a[86:87], v58 offset:4608
  v_mfma_f32_16x16x32_bf16 v[108:111], a[56:59], v[248:251], v[108:111]
  buffer_load_dwordx4 v61, s[12:15], s5 offen offset:256 lds
  v_mfma_f32_16x16x32_bf16 v[108:111], a[68:71], v[252:255], v[108:111]
  ds_read_b64_tr_b16 a[76:77], v59 offset:0
  ds_read_b64_tr_b16 a[78:79], v59 offset:512
  v_mfma_f32_16x16x32_bf16 v[96:99], a[56:59], a[232:235], v[96:99]
  ds_read_b64_tr_b16 a[88:89], v59 offset:4096
  ds_read_b64_tr_b16 a[90:91], v59 offset:4608
  v_mfma_f32_16x16x32_bf16 v[96:99], a[68:71], a[236:239], v[96:99]
  s_waitcnt lgkmcnt(6)
  ds_read_b64_tr_b16 a[80:81], v60 offset:0
  ds_read_b64_tr_b16 a[82:83], v60 offset:512
  v_mfma_f32_16x16x32_bf16 v[128:131], a[72:75], v[184:187], 0
  s_waitcnt lgkmcnt(6)
  ds_read_b64_tr_b16 a[92:93], v60 offset:4096
  ds_read_b64_tr_b16 a[94:95], v60 offset:4608
  v_mfma_f32_16x16x32_bf16 v[128:131], a[84:87], v[188:191], v[128:131]
  v_mul_f32 v143, s42, v143
  v_cvt_pk_bf16_f32 v112, v140, v141
  v_mfma_f32_16x16x32_bf16 v[152:155], a[72:75], v[208:211], 0
  v_cvt_pk_bf16_f32 v113, v142, v143
  v_mul_f32 v144, s42, v144
  v_mfma_f32_16x16x32_bf16 v[152:155], a[84:87], v[212:215], v[152:155]
  v_mul_f32 v145, s42, v145
  v_mul_f32 v146, s42, v146
  v_mfma_f32_16x16x32_bf16 v[156:159], a[72:75], v[232:235], 0
  v_mul_f32 v147, s42, v147
  v_cvt_pk_bf16_f32 v114, v144, v145
  v_mfma_f32_16x16x32_bf16 v[156:159], a[84:87], v[236:239], v[156:159]
  s_add_u32 s5, s44, 768
  s_add_u32 m0, s46, 53248
  v_cvt_pk_bf16_f32 v115, v146, v147
  v_mfma_f32_16x16x32_bf16 v[164:167], a[72:75], a[216:219], 0
  v_cvt_pk_bf16_f32 v65, v134, v135
  v_mul_f32 v124, s42, v124
  v_mfma_f32_16x16x32_bf16 v[164:167], a[84:87], a[220:223], v[164:167]
  s_waitcnt lgkmcnt(0)
  v_mul_f32 v125, s42, v125
  v_mul_f32 v126, s42, v126
  v_mfma_f32_16x16x32_bf16 v[132:135], a[76:79], v[184:187], 0
  buffer_load_dwordx4 v61, s[12:15], s5 offen offset:0 lds
  v_mfma_f32_16x16x32_bf16 v[132:135], a[88:91], v[188:191], v[132:135]
  s_add_u32 m0, s46, 61312
  v_mul_f32 v127, s42, v127
  v_cvt_pk_bf16_f32 v66, v124, v125
  v_mfma_f32_16x16x32_bf16 v[100:103], a[76:79], v[208:211], 0
  buffer_load_dwordx4 v61, s[12:15], s5 offen offset:128 lds
  v_mfma_f32_16x16x32_bf16 v[100:103], a[88:91], v[212:215], v[100:103]
  s_add_u32 m0, s46, 69376
  v_cvt_pk_bf16_f32 v67, v126, v127
  v_mul_f32 v148, s42, v148
  v_mfma_f32_16x16x32_bf16 v[138:141], a[76:79], v[232:235], 0
  buffer_load_dwordx4 v61, s[12:15], s5 offen offset:256 lds
  v_mfma_f32_16x16x32_bf16 v[138:141], a[88:91], v[236:239], v[138:141]
  s_add_u32 s5, s44, 37632
  s_add_u32 m0, s46, 57344
  v_mul_f32 v149, s42, v149
  v_mfma_f32_16x16x32_bf16 v[180:183], a[76:79], a[216:219], 0
  v_mul_f32 v150, s42, v150
  v_mul_f32 v151, s42, v151
  v_mfma_f32_16x16x32_bf16 v[180:183], a[88:91], a[220:223], v[180:183]
  s_waitcnt vmcnt(9)
  s_barrier
  v_mfma_f32_16x16x32_bf16 v[142:145], a[80:83], v[184:187], 0
  buffer_load_dwordx4 v61, s[12:15], s5 offen offset:0 lds
  v_mfma_f32_16x16x32_bf16 v[142:145], a[92:95], v[188:191], v[142:145]
  s_add_u32 m0, s46, 65408
  ds_read_b64_tr_b16 a[96:97], v58 offset:24576
  ds_read_b64_tr_b16 a[98:99], v58 offset:25088
  v_mfma_f32_16x16x32_bf16 v[124:127], a[80:83], v[208:211], 0
  buffer_load_dwordx4 v61, s[12:15], s5 offen offset:128 lds
  v_mfma_f32_16x16x32_bf16 v[124:127], a[92:95], v[212:215], v[124:127]
  s_add_u32 m0, s46, 73472
  ds_read_b64_tr_b16 a[108:109], v58 offset:28672
  ds_read_b64_tr_b16 a[110:111], v58 offset:29184
  v_mfma_f32_16x16x32_bf16 v[104:107], a[80:83], v[232:235], 0
  buffer_load_dwordx4 v61, s[12:15], s5 offen offset:256 lds
  v_mfma_f32_16x16x32_bf16 v[104:107], a[92:95], v[236:239], v[104:107]
  ds_read_b64_tr_b16 a[100:101], v59 offset:24576
  ds_read_b64_tr_b16 a[102:103], v59 offset:25088
  v_mfma_f32_16x16x32_bf16 v[172:175], a[80:83], a[216:219], 0
  ds_read_b64_tr_b16 a[112:113], v59 offset:28672
  ds_read_b64_tr_b16 a[114:115], v59 offset:29184
  v_mfma_f32_16x16x32_bf16 v[172:175], a[92:95], a[220:223], v[172:175]
  s_waitcnt lgkmcnt(6)
  ds_read_b64_tr_b16 a[104:105], v60 offset:24576
  ds_read_b64_tr_b16 a[106:107], v60 offset:25088
  v_mfma_f32_16x16x32_bf16 v[128:131], a[96:99], v[192:195], v[128:131]
  s_waitcnt lgkmcnt(6)
  ds_read_b64_tr_b16 a[116:117], v60 offset:28672
  ds_read_b64_tr_b16 a[118:119], v60 offset:29184
  v_mfma_f32_16x16x32_bf16 v[128:131], a[108:111], v[196:199], v[128:131]
  v_cvt_pk_bf16_f32 v16, v148, v149
  v_cvt_pk_bf16_f32 v17, v150, v151
  v_mfma_f32_16x16x32_bf16 v[152:155], a[96:99], v[216:219], v[152:155]
  v_mul_f32 v160, s42, v160
  v_mul_f32 v161, s42, v161
  v_mfma_f32_16x16x32_bf16 v[152:155], a[108:111], v[220:223], v[152:155]
  v_mul_f32 v162, s42, v162
  v_mul_f32 v163, s42, v163
  v_mfma_f32_16x16x32_bf16 v[156:159], a[96:99], v[240:243], v[156:159]
  v_cvt_pk_bf16_f32 v18, v160, v161
  v_cvt_pk_bf16_f32 v19, v162, v163
  v_mfma_f32_16x16x32_bf16 v[156:159], a[108:111], v[244:247], v[156:159]
  s_add_u32 s5, s44, 74496
  s_add_u32 m0, s46, 77824
  v_mul_f32 v168, s42, v168
  v_mfma_f32_16x16x32_bf16 v[164:167], a[96:99], a[224:227], v[164:167]
  v_mul_f32 v169, s42, v169
  v_mul_f32 v170, s42, v170
  v_mfma_f32_16x16x32_bf16 v[164:167], a[108:111], a[228:231], v[164:167]
  s_waitcnt lgkmcnt(0)
  v_mul_f32 v171, s42, v171
  v_cvt_pk_bf16_f32 v136, v168, v169
  v_mfma_f32_16x16x32_bf16 v[132:135], a[100:103], v[192:195], v[132:135]
  buffer_load_dwordx4 v61, s[12:15], s5 offen offset:0 lds
  v_mfma_f32_16x16x32_bf16 v[132:135], a[112:115], v[196:199], v[132:135]
  s_add_u32 m0, s46, 85888
  v_cvt_pk_bf16_f32 v137, v170, v171
  v_mul_f32 v108, s42, v108
  v_mfma_f32_16x16x32_bf16 v[100:103], a[100:103], v[216:219], v[100:103]
  buffer_load_dwordx4 v61, s[12:15], s5 offen offset:128 lds
  v_mfma_f32_16x16x32_bf16 v[100:103], a[112:115], v[220:223], v[100:103]
  s_add_u32 m0, s46, 93952
  v_mul_f32 v109, s42, v109
  v_mul_f32 v110, s42, v110
  v_mfma_f32_16x16x32_bf16 v[138:141], a[100:103], v[240:243], v[138:141]
  buffer_load_dwordx4 v61, s[12:15], s5 offen offset:256 lds
  v_mfma_f32_16x16x32_bf16 v[138:141], a[112:115], v[244:247], v[138:141]
  s_add_u32 s5, s44, 111360
  s_add_u32 m0, s46, 81920
  v_mul_f32 v111, s42, v111
  v_mfma_f32_16x16x32_bf16 v[180:183], a[100:103], a[224:227], v[180:183]
  v_add_f32 v168, v70, v36
  v_add_f32 v169, v70, v37
  v_mfma_f32_16x16x32_bf16 v[180:183], a[112:115], a[228:231], v[180:183]
  s_waitcnt vmcnt(9)
  s_barrier
  v_mfma_f32_16x16x32_bf16 v[142:145], a[104:107], v[192:195], v[142:145]
  buffer_load_dwordx4 v61, s[12:15], s5 offen offset:0 lds
  v_mfma_f32_16x16x32_bf16 v[142:145], a[116:119], v[196:199], v[142:145]
  s_add_u32 m0, s46, 89984
  ds_read_b64_tr_b16 a[120:121], v62 offset:0
  ds_read_b64_tr_b16 a[122:123], v62 offset:512
  v_mfma_f32_16x16x32_bf16 v[124:127], a[104:107], v[216:219], v[124:127]
  buffer_load_dwordx4 v61, s[12:15], s5 offen offset:128 lds
  v_mfma_f32_16x16x32_bf16 v[124:127], a[116:119], v[220:223], v[124:127]
  s_add_u32 m0, s46, 98048
  ds_read_b64_tr_b16 a[132:133], v62 offset:4096
  ds_read_b64_tr_b16 a[134:135], v62 offset:4608
  v_mfma_f32_16x16x32_bf16 v[104:107], a[104:107], v[240:243], v[104:107]
  buffer_load_dwordx4 v61, s[12:15], s5 offen offset:256 lds
  v_mfma_f32_16x16x32_bf16 v[104:107], a[116:119], v[244:247], v[104:107]
  ds_read_b64_tr_b16 a[124:125], v63 offset:0
  ds_read_b64_tr_b16 a[126:127], v63 offset:512
  v_mfma_f32_16x16x32_bf16 v[172:175], a[104:107], a[224:227], v[172:175]
  ds_read_b64_tr_b16 a[136:137], v63 offset:4096
  ds_read_b64_tr_b16 a[138:139], v63 offset:4608
  v_mfma_f32_16x16x32_bf16 v[172:175], a[116:119], a[228:231], v[172:175]
  s_waitcnt lgkmcnt(6)
  ds_read_b64_tr_b16 a[128:129], v71 offset:0
  ds_read_b64_tr_b16 a[130:131], v71 offset:512
  v_mfma_f32_16x16x32_bf16 v[128:131], a[120:123], v[200:203], v[128:131]
  s_waitcnt lgkmcnt(6)
  ds_read_b64_tr_b16 a[140:141], v71 offset:4096
  ds_read_b64_tr_b16 a[142:143], v71 offset:4608
  v_mfma_f32_16x16x32_bf16 v[128:131], a[132:135], v[204:207], v[128:131]
  v_add_f32 v170, v70, v38
  v_add_f32 v171, v70, v39
  v_mfma_f32_16x16x32_bf16 v[152:155], a[120:123], v[224:227], v[152:155]
  v_add_f32 v146, v70, v32
  v_add_f32 v147, v70, v33
  v_mfma_f32_16x16x32_bf16 v[152:155], a[132:135], v[228:231], v[152:155]
  v_add_f32 v148, v70, v34
  v_add_f32 v149, v70, v35
  v_mfma_f32_16x16x32_bf16 v[156:159], a[120:123], v[248:251], v[156:159]
  v_cvt_pk_bf16_f32 v162, v128, v129
  v_cvt_pk_bf16_f32 v163, v130, v131
  v_mfma_f32_16x16x32_bf16 v[156:159], a[132:135], v[252:255], v[156:159]
  s_add_u32 s5, s44, 148224
  s_add_u32 m0, s46, 102400
  v_add_f32 v120, v70, v40
  v_mfma_f32_16x16x32_bf16 v[164:167], a[120:123], a[232:235], v[164:167]
  v_cvt_pk_bf16_f32 v128, v152, v153
  v_cvt_pk_bf16_f32 v129, v154, v155
  v_mfma_f32_16x16x32_bf16 v[164:167], a[132:135], a[236:239], v[164:167]
  s_waitcnt lgkmcnt(0)
  v_add_f32 v121, v70, v41
  v_add_f32 v122, v70, v42
  v_mfma_f32_16x16x32_bf16 v[132:135], a[124:127], v[200:203], v[132:135]
  buffer_load_dwordx4 v61, s[12:15], s5 offen offset:0 lds
  v_mfma_f32_16x16x32_bf16 v[132:135], a[136:139], v[204:207], v[132:135]
  s_add_u32 m0, s46, 110464
  v_cvt_pk_bf16_f32 v150, v156, v157
  v_cvt_pk_bf16_f32 v151, v158, v159
  v_mfma_f32_16x16x32_bf16 v[100:103], a[124:127], v[224:227], v[100:103]
  buffer_load_dwordx4 v61, s[12:15], s5 offen offset:128 lds
  v_mfma_f32_16x16x32_bf16 v[100:103], a[136:139], v[228:231], v[100:103]
  s_add_u32 m0, s46, 118528
  v_cvt_pk_bf16_f32 v156, v164, v165
  v_cvt_pk_bf16_f32 v157, v166, v167
  v_mfma_f32_16x16x32_bf16 v[138:141], a[124:127], v[248:251], v[138:141]
  buffer_load_dwordx4 v61, s[12:15], s5 offen offset:256 lds
  v_mfma_f32_16x16x32_bf16 v[138:141], a[136:139], v[252:255], v[138:141]
  s_add_u32 s5, s44, 185088
  s_add_u32 m0, s46, 106496
  v_cvt_pk_bf16_f32 v164, v132, v133
  v_mfma_f32_16x16x32_bf16 v[180:183], a[124:127], a[232:235], v[180:183]
  v_cvt_pk_bf16_f32 v165, v134, v135
  v_cvt_pk_bf16_f32 v130, v100, v101
  v_mfma_f32_16x16x32_bf16 v[180:183], a[136:139], a[236:239], v[180:183]
  v_cvt_pk_bf16_f32 v131, v102, v103
  v_add_f32 v123, v70, v43
  v_mfma_f32_16x16x32_bf16 v[142:145], a[128:131], v[200:203], v[142:145]
  buffer_load_dwordx4 v61, s[12:15], s5 offen offset:0 lds
  v_mfma_f32_16x16x32_bf16 v[142:145], a[140:143], v[204:207], v[142:145]
  s_add_u32 m0, s46, 114560
  v_cvt_pk_bf16_f32 v152, v138, v139
  v_cvt_pk_bf16_f32 v153, v140, v141
  v_mfma_f32_16x16x32_bf16 v[124:127], a[128:131], v[224:227], v[124:127]
  buffer_load_dwordx4 v61, s[12:15], s5 offen offset:128 lds
  v_mfma_f32_16x16x32_bf16 v[124:127], a[140:143], v[228:231], v[124:127]
  s_add_u32 m0, s46, 122624
  v_cvt_pk_bf16_f32 v158, v180, v181
  v_cvt_pk_bf16_f32 v159, v182, v183
  v_mfma_f32_16x16x32_bf16 v[104:107], a[128:131], v[248:251], v[104:107]
  buffer_load_dwordx4 v61, s[12:15], s5 offen offset:256 lds
  v_mfma_f32_16x16x32_bf16 v[104:107], a[140:143], v[252:255], v[104:107]
  v_cvt_pk_bf16_f32 v166, v142, v143
  v_cvt_pk_bf16_f32 v167, v144, v145
  v_mfma_f32_16x16x32_bf16 v[172:175], a[128:131], a[232:235], v[172:175]
  v_cvt_pk_bf16_f32 v132, v124, v125
  v_cvt_pk_bf16_f32 v133, v126, v127
  v_mfma_f32_16x16x32_bf16 v[172:175], a[140:143], a[236:239], v[172:175]
  v_cvt_pk_bf16_f32 v138, v108, v109
  v_cvt_pk_bf16_f32 v139, v110, v111
  v_mfma_f32_16x16x32_bf16 v[100:103], v[164:167], v[112:115], v[168:171]
  v_cvt_pk_bf16_f32 v154, v104, v105
  v_cvt_pk_bf16_f32 v155, v106, v107
  v_mfma_f32_16x16x32_bf16 v[100:103], v[162:165], v[12:15], v[100:103]
  v_mul_f32 v176, s42, v176
  v_mul_f32 v177, s42, v177
  v_mfma_f32_16x16x32_bf16 v[104:107], v[130:133], v[112:115], v[146:149]
  v_cvt_pk_bf16_f32 v160, v172, v173
  v_cvt_pk_bf16_f32 v161, v174, v175
  v_mfma_f32_16x16x32_bf16 v[104:107], v[128:131], v[12:15], v[104:107]
  v_mul_f32 v178, s42, v178
  v_mul_f32 v179, s42, v179
  v_mfma_f32_16x16x32_bf16 v[172:175], v[152:155], v[112:115], v[88:91]
  v_cvt_pk_bf16_f32 v140, v176, v177
  v_cvt_pk_bf16_f32 v141, v178, v179
  v_mfma_f32_16x16x32_bf16 v[172:175], v[150:153], v[12:15], v[172:175]
  v_mul_f32 v116, s42, v116
  v_mul_f32 v117, s42, v117
  v_mfma_f32_16x16x32_bf16 v[180:183], v[158:161], v[112:115], v[92:95]
  v_mul_f32 v118, s42, v118
  v_mul_f32 v119, s42, v119
  v_mfma_f32_16x16x32_bf16 v[180:183], v[156:159], v[12:15], v[180:183]
  v_cvt_pk_bf16_f32 v142, v116, v117
  v_cvt_pk_bf16_f32 v143, v118, v119
  v_mfma_f32_16x16x32_bf16 v[108:111], v[162:165], v[64:67], v[120:123]
  v_mul_f32 v96, s42, v96
  v_mul_f32 v97, s42, v97
  v_mfma_f32_16x16x32_bf16 v[108:111], v[164:167], v[14:17], v[108:111]
  v_mul_f32 v98, s42, v98
  v_mul_f32 v99, s42, v99
  v_mfma_f32_16x16x32_bf16 v[112:115], v[128:131], v[64:67], v[168:171]
  v_cvt_pk_bf16_f32 v22, v96, v97
  v_cvt_pk_bf16_f32 v23, v98, v99
  v_mfma_f32_16x16x32_bf16 v[112:115], v[130:133], v[14:17], v[112:115]
  v_exp_f32 v100, v100
  v_mfma_f32_16x16x32_bf16 v[124:127], v[150:153], v[64:67], v[84:87]
  v_exp_f32 v101, v101
  v_mfma_f32_16x16x32_bf16 v[124:127], v[152:155], v[14:17], v[124:127]
  v_exp_f32 v102, v102
  v_mfma_f32_16x16x32_bf16 v[116:119], v[156:159], v[64:67], v[88:91]
  v_exp_f32 v103, v103
  v_mfma_f32_16x16x32_bf16 v[116:119], v[158:161], v[14:17], v[116:119]
  v_exp_f32 v104, v104
  v_mfma_f32_16x16x32_bf16 v[92:95], v[152:155], v[136:139], v[168:171]
  v_exp_f32 v105, v105
  v_mfma_f32_16x16x32_bf16 v[92:95], v[150:153], v[18:21], v[92:95]
  buffer_load_dword v134, v57, s[16:19], s51 offen
  v_mfma_f32_16x16x32_bf16 v[96:99], v[158:161], v[136:139], v[146:149]
  s_add_u32 m0, s28, 0
  v_exp_f32 v106, v106
  v_mfma_f32_16x16x32_bf16 v[96:99], v[156:159], v[18:21], v[96:99]
  v_exp_f32 v107, v107
  v_mfma_f32_16x16x32_bf16 v[176:179], v[164:167], v[136:139], v[72:75]
  s_waitcnt vmcnt(7)
  s_barrier
  v_mfma_f32_16x16x32_bf16 v[176:179], v[162:165], v[18:21], v[176:179]
  buffer_load_dwordx4 v6, s[8:11], s31 offen offset:0 nt lds
  v_mfma_f32_16x16x32_bf16 v[144:147], v[130:133], v[136:139], v[80:83]
  s_add_u32 m0, s28, 8064
  ds_read_b64_tr_b16 a[144:145], v62 offset:24576
  ds_read_b64_tr_b16 a[146:147], v62 offset:25088
  v_mfma_f32_16x16x32_bf16 v[144:147], v[128:131], v[18:21], v[144:147]
  ds_read_b64_tr_b16 a[156:157], v62 offset:28672
  ds_read_b64_tr_b16 a[158:159], v62 offset:29184
  v_mfma_f32_16x16x32_bf16 v[84:87], v[150:153], v[140:143], v[120:123]
  buffer_load_dwordx4 v6, s[8:11], s31 offen offset:128 nt lds
  v_mfma_f32_16x16x32_bf16 v[84:87], v[152:155], v[20:23], v[84:87]
  s_add_u32 m0, s28, 16128
  ds_read_b64_tr_b16 a[148:149], v63 offset:24576
  ds_read_b64_tr_b16 a[150:151], v63 offset:25088
  v_mfma_f32_16x16x32_bf16 v[88:91], v[156:159], v[140:143], v[168:171]
  ds_read_b64_tr_b16 a[160:161], v63 offset:28672
  ds_read_b64_tr_b16 a[162:163], v63 offset:29184
  v_mfma_f32_16x16x32_bf16 v[88:91], v[158:161], v[20:23], v[88:91]
  buffer_load_dwordx4 v6, s[8:11], s31 offen offset:256 nt lds
  v_mfma_f32_16x16x32_bf16 v[148:151], v[162:165], v[140:143], v[76:79]
  s_add_u32 s31, s31, s43
  ds_read_b64_tr_b16 a[152:153], v71 offset:24576
  ds_read_b64_tr_b16 a[154:155], v71 offset:25088
  v_mfma_f32_16x16x32_bf16 v[148:151], v[164:167], v[20:23], v[148:151]
  ds_read_b64_tr_b16 a[164:165], v71 offset:28672
  ds_read_b64_tr_b16 a[166:167], v71 offset:29184
  v_mfma_f32_16x16x32_bf16 v[160:163], v[128:131], v[140:143], v[72:75]
  ds_read_b64_tr_b16 a[168:169], v62 offset:49152
  ds_read_b64_tr_b16 a[170:171], v62 offset:49664
  v_mfma_f32_16x16x32_bf16 v[160:163], v[130:133], v[20:23], v[160:163]
  s_waitcnt lgkmcnt(6)
  ds_read_b64_tr_b16 a[180:181], v62 offset:53248
  ds_read_b64_tr_b16 a[182:183], v62 offset:53760
  v_mfma_f32_16x16x32_bf16 v[136:139], v[184:187], a[144:147], 0
  ds_read_b64_tr_b16 a[172:173], v63 offset:49152
  ds_read_b64_tr_b16 a[174:175], v63 offset:49664
  v_mfma_f32_16x16x32_bf16 v[136:139], v[188:191], a[156:159], v[136:139]
  ds_read_b64_tr_b16 a[184:185], v63 offset:53248
  ds_read_b64_tr_b16 a[186:187], v63 offset:53760
  v_mfma_f32_16x16x32_bf16 v[72:75], v[184:187], a[148:151], 0
  ds_read_b64_tr_b16 a[176:177], v71 offset:49152
  ds_read_b64_tr_b16 a[178:179], v71 offset:49664
  v_mfma_f32_16x16x32_bf16 v[72:75], v[188:191], a[160:163], v[72:75]
  s_waitcnt lgkmcnt(8)
  ds_read_b64_tr_b16 a[188:189], v71 offset:53248
  ds_read_b64_tr_b16 a[190:191], v71 offset:53760
  v_mfma_f32_16x16x32_bf16 v[152:155], v[184:187], a[152:155], 0
  v_exp_f32 v172, v172
  v_mfma_f32_16x16x32_bf16 v[152:155], v[188:191], a[164:167], v[152:155]
  v_exp_f32 v173, v173
  v_mfma_f32_16x16x32_bf16 v[76:79], v[208:211], a[144:147], 0
  v_exp_f32 v174, v174
  v_mfma_f32_16x16x32_bf16 v[76:79], v[212:215], a[156:159], v[76:79]
  v_exp_f32 v175, v175
  v_mfma_f32_16x16x32_bf16 v[140:143], v[208:211], a[148:151], 0
  v_exp_f32 v180, v180
  v_mfma_f32_16x16x32_bf16 v[140:143], v[212:215], a[160:163], v[140:143]
  v_exp_f32 v181, v181
  v_mfma_f32_16x16x32_bf16 v[128:131], v[208:211], a[152:155], 0
  v_exp_f32 v182, v182
  v_mfma_f32_16x16x32_bf16 v[128:131], v[212:215], a[164:167], v[128:131]
  v_exp_f32 v183, v183
  v_mfma_f32_16x16x32_bf16 v[136:139], v[192:195], a[168:171], v[136:139]
  s_waitcnt lgkmcnt(0)
  v_cvt_pk_bf16_f32 v100, v100, v101
  v_cvt_pk_bf16_f32 v101, v102, v103
  v_mfma_f32_16x16x32_bf16 v[136:139], v[196:199], a[180:183], v[136:139]
  v_cvt_pk_bf16_f32 v102, v104, v105
  v_cvt_pk_bf16_f32 v103, v106, v107
  v_mfma_f32_16x16x32_bf16 v[72:75], v[192:195], a[172:175], v[72:75]
  v_cvt_pk_bf16_f32 v104, v172, v173
  v_cvt_pk_bf16_f32 v105, v174, v175
  v_mfma_f32_16x16x32_bf16 v[72:75], v[196:199], a[184:187], v[72:75]
  v_cvt_pk_bf16_f32 v106, v180, v181
  v_cvt_pk_bf16_f32 v107, v182, v183
  v_mfma_f32_16x16x32_bf16 v[152:155], v[192:195], a[176:179], v[152:155]
  v_exp_f32 v108, v108
  v_mfma_f32_16x16x32_bf16 v[152:155], v[196:199], a[188:191], v[152:155]
  s_waitcnt vmcnt(4)
  s_barrier
  v_mfma_f32_16x16x32_bf16 v[76:79], v[216:219], a[168:171], v[76:79]
  ds_read_b64_tr_b16 a[192:193], v58 offset:0
  ds_read_b64_tr_b16 a[194:195], v58 offset:512
  v_mfma_f32_16x16x32_bf16 v[76:79], v[220:223], a[180:183], v[76:79]
  ds_read_b64_tr_b16 a[204:205], v58 offset:4096
  ds_read_b64_tr_b16 a[206:207], v58 offset:4608
  v_mfma_f32_16x16x32_bf16 v[140:143], v[216:219], a[172:175], v[140:143]
  ds_read_b64_tr_b16 a[196:197], v59 offset:0
  ds_read_b64_tr_b16 a[198:199], v59 offset:512
  v_mfma_f32_16x16x32_bf16 v[140:143], v[220:223], a[184:187], v[140:143]
  s_waitcnt lgkmcnt(4)
  ds_read_b64_tr_b16 a[208:209], v59 offset:4096
  ds_read_b64_tr_b16 a[210:211], v59 offset:4608
  v_mfma_f32_16x16x32_bf16 v[128:131], v[216:219], a[176:179], v[128:131]
  s_add_u32 s5, s45, 0
  ds_read_b64_tr_b16 a[200:201], v60 offset:0
  ds_read_b64_tr_b16 a[202:203], v60 offset:512
  v_mfma_f32_16x16x32_bf16 v[128:131], v[220:223], a[188:191], v[128:131]
  s_add_u32 m0, s46, 126976
  ds_read_b64_tr_b16 a[212:213], v60 offset:4096
  ds_read_b64_tr_b16 a[214:215], v60 offset:4608
  v_mfma_f32_16x16x32_bf16 v[136:139], v[200:203], a[192:195], v[136:139]
  s_waitcnt lgkmcnt(8)
  v_exp_f32 v109, v109
  v_mfma_f32_16x16x32_bf16 v[136:139], v[204:207], a[204:207], v[136:139]
  buffer_load_dwordx4 v56, s[16:19], s5 offen offset:0 lds
  s_waitcnt lgkmcnt(6)
  v_mfma_f32_16x16x32_bf16 v[72:75], v[200:203], a[196:199], v[72:75]
  s_add_u32 m0, s46, 135040
  v_exp_f32 v110, v110
  s_waitcnt lgkmcnt(4)
  v_mfma_f32_16x16x32_bf16 v[72:75], v[204:207], a[208:211], v[72:75]
  s_waitcnt lgkmcnt(2)
  v_exp_f32 v111, v111
  v_mfma_f32_16x16x32_bf16 v[152:155], v[200:203], a[200:203], v[152:155]
  buffer_load_dwordx4 v56, s[16:19], s5 offen offset:128 lds
  s_waitcnt lgkmcnt(0)
  v_mfma_f32_16x16x32_bf16 v[152:155], v[204:207], a[212:215], v[152:155]
  s_add_u32 m0, s46, 143104
  v_cvt_pk_bf16_f32 v172, v136, v137
  v_cvt_pk_bf16_f32 v173, v138, v139
  v_mfma_f32_16x16x32_bf16 v[76:79], v[224:227], a[192:195], v[76:79]
  v_cvt_pk_bf16_f32 v168, v72, v73
  v_cvt_pk_bf16_f32 v169, v74, v75
  v_mfma_f32_16x16x32_bf16 v[76:79], v[228:231], a[204:207], v[76:79]
  buffer_load_dwordx4 v56, s[16:19], s5 offen offset:256 lds
  v_mfma_f32_16x16x32_bf16 v[140:143], v[224:227], a[196:199], v[140:143]
  s_add_u32 s5, s45, 12288
  v_cvt_pk_bf16_f32 v70, v152, v153
  v_cvt_pk_bf16_f32 v71, v154, v155
  v_mfma_f32_16x16x32_bf16 v[140:143], v[228:231], a[208:211], v[140:143]
  s_add_u32 m0, s46, 131072
  v_exp_f32 v112, v112
  v_mfma_f32_16x16x32_bf16 v[128:131], v[224:227], a[200:203], v[128:131]
  buffer_load_dwordx4 v56, s[16:19], s5 offen offset:0 lds
  v_mfma_f32_16x16x32_bf16 v[128:131], v[228:231], a[212:215], v[128:131]
  s_add_u32 m0, s46, 139136
  v_cvt_pk_bf16_f32 v174, v76, v77
  v_cvt_pk_bf16_f32 v175, v78, v79
  v_mfma_f32_16x16x32_bf16 v[60:63], v[232:235], a[144:147], 0
  v_cvt_pk_bf16_f32 v170, v140, v141
  v_cvt_pk_bf16_f32 v171, v142, v143
  v_mfma_f32_16x16x32_bf16 v[60:63], v[236:239], a[156:159], v[60:63]
  buffer_load_dwordx4 v56, s[16:19], s5 offen offset:128 lds
  v_mfma_f32_16x16x32_bf16 v[60:63], v[240:243], a[168:171], v[60:63]
  s_add_u32 m0, s46, 147200
  v_cvt_pk_bf16_f32 v72, v128, v129
  v_cvt_pk_bf16_f32 v73, v130, v131
  v_mfma_f32_16x16x32_bf16 v[60:63], v[244:247], a[180:183], v[60:63]
  v_exp_f32 v113, v113
  v_mfma_f32_16x16x32_bf16 v[60:63], v[248:251], a[192:195], v[60:63]
  buffer_load_dwordx4 v56, s[16:19], s5 offen offset:256 lds
  v_mfma_f32_16x16x32_bf16 v[60:63], v[252:255], a[204:207], v[60:63]
  v_exp_f32 v114, v114
  v_mfma_f32_16x16x32_bf16 v[128:131], v[232:235], a[148:151], 0
  v_exp_f32 v115, v115
  v_mfma_f32_16x16x32_bf16 v[128:131], v[236:239], a[160:163], v[128:131]
  v_exp_f32 v124, v124
  v_mfma_f32_16x16x32_bf16 v[128:131], v[240:243], a[172:175], v[128:131]
  v_cvt_pk_bf16_f32 v76, v60, v61
  v_cvt_pk_bf16_f32 v77, v62, v63
  v_mfma_f32_16x16x32_bf16 v[128:131], v[244:247], a[184:187], v[128:131]
  v_exp_f32 v125, v125
  v_mfma_f32_16x16x32_bf16 v[128:131], v[248:251], a[196:199], v[128:131]
  v_exp_f32 v126, v126
  v_mfma_f32_16x16x32_bf16 v[128:131], v[252:255], a[208:211], v[128:131]
  v_exp_f32 v127, v127
  v_mfma_f32_16x16x32_bf16 v[60:63], v[232:235], a[152:155], 0
L_hop_1_0:
  s_cbranch_execz L_hop_1_1
  v_exp_f32 v116, v116
  v_mfma_f32_16x16x32_bf16 v[60:63], v[236:239], a[164:167], v[60:63]
  v_exp_f32 v117, v117
  v_mfma_f32_16x16x32_bf16 v[60:63], v[240:243], a[176:179], v[60:63]
  v_cvt_pk_bf16_f32 v80, v128, v129
  v_cvt_pk_bf16_f32 v81, v130, v131
  v_cvt_pk_bf16_f32 v108, v108, v109
  v_mfma_f32_16x16x32_bf16 v[60:63], v[244:247], a[188:191], v[60:63]
  v_exp_f32 v118, v118
  v_cvt_pk_bf16_f32 v109, v110, v111
  v_mfma_f32_16x16x32_bf16 v[60:63], v[248:251], a[200:203], v[60:63]
  v_exp_f32 v119, v119
  v_cvt_pk_bf16_f32 v110, v112, v113
  v_mfma_f32_16x16x32_bf16 v[60:63], v[252:255], a[212:215], v[60:63]
  v_cvt_pk_bf16_f32 v111, v114, v115
  v_cvt_pk_bf16_f32 v112, v124, v125
  v_cvt_pk_bf16_f32 v113, v126, v127
  v_mfma_f32_16x16x32_bf16 v[128:131], a[216:219], a[144:147], 0
  v_cvt_pk_bf16_f32 v114, v116, v117
  v_cvt_pk_bf16_f32 v115, v118, v119
  v_add_u32 v0, s28, v2
  v_mfma_f32_16x16x32_bf16 v[128:131], a[220:223], a[156:159], v[128:131]
  s_add_u32 s5, s45, 24576
  s_add_u32 m0, s46, 0
  v_exp_f32 v92, v92
  v_mfma_f32_16x16x32_bf16 v[128:131], a[224:227], a[168:171], v[128:131]
  v_cvt_pk_bf16_f32 v120, v60, v61
  v_cvt_pk_bf16_f32 v121, v62, v63
  v_xor_b32 v1, 64, v0
  v_mfma_f32_16x16x32_bf16 v[128:131], a[228:231], a[180:183], v[128:131]
  v_exp_f32 v93, v93
  v_mfma_f32_16x16x32_bf16 v[128:131], a[232:235], a[192:195], v[128:131]
  buffer_load_dwordx4 v56, s[16:19], s5 offen offset:0 lds
  v_cvt_pk_bf16_f32 v92, v92, v93
  v_mfma_f32_16x16x32_bf16 v[128:131], a[236:239], a[204:207], v[128:131]
  s_add_u32 m0, s46, 8064
  v_exp_f32 v94, v94
  v_mfma_f32_16x16x32_bf16 v[124:127], a[216:219], a[148:151], 0
  v_exp_f32 v95, v95
  v_mfma_f32_16x16x32_bf16 v[124:127], a[220:223], a[160:163], v[124:127]
  buffer_load_dwordx4 v56, s[16:19], s5 offen offset:128 lds
  v_cvt_pk_bf16_f32 v93, v94, v95
  v_mfma_f32_16x16x32_bf16 v[124:127], a[224:227], a[172:175], v[124:127]
  s_add_u32 m0, s46, 16128
  v_cvt_pk_bf16_f32 v78, v128, v129
  v_cvt_pk_bf16_f32 v79, v130, v131
  v_mfma_f32_16x16x32_bf16 v[124:127], a[228:231], a[184:187], v[124:127]
  v_exp_f32 v96, v96
  v_mfma_f32_16x16x32_bf16 v[124:127], a[232:235], a[196:199], v[124:127]
  buffer_load_dwordx4 v56, s[16:19], s5 offen offset:256 lds
  v_mov_b64 v[164:165], 0
  v_mfma_f32_16x16x32_bf16 v[124:127], a[236:239], a[208:211], v[124:127]
  s_add_u32 s5, s45, 36864
  s_add_u32 m0, s46, 4096
  v_exp_f32 v97, v97
  v_mfma_f32_16x16x32_bf16 v[128:131], a[216:219], a[152:155], 0
  v_exp_f32 v98, v98
  v_cvt_pk_bf16_f32 v94, v96, v97
  v_mfma_f32_16x16x32_bf16 v[128:131], a[220:223], a[164:167], v[128:131]
  buffer_load_dwordx4 v56, s[16:19], s5 offen offset:0 lds
  v_mfma_f32_16x16x32_bf16 v[128:131], a[224:227], a[176:179], v[128:131]
  s_add_u32 m0, s46, 12160
  v_cvt_pk_bf16_f32 v82, v124, v125
  v_cvt_pk_bf16_f32 v83, v126, v127
  v_mfma_f32_16x16x32_bf16 v[128:131], a[228:231], a[188:191], v[128:131]
  v_exp_f32 v99, v99
  v_mfma_f32_16x16x32_bf16 v[128:131], a[232:235], a[200:203], v[128:131]
  buffer_load_dwordx4 v56, s[16:19], s5 offen offset:128 lds
  v_cvt_pk_bf16_f32 v95, v98, v99
  v_mfma_f32_16x16x32_bf16 v[128:131], a[236:239], a[212:215], v[128:131]
  s_add_u32 m0, s46, 20224
  v_mov_b64 v[140:141], 0
  v_exp_f32 v176, v176
  v_smfmac_f32_16x16x64_bf16 v[164:167], a[240:243], v[100:107], v10
  v_exp_f32 v177, v177
  v_mfma_f32_16x16x32_bf16 v[180:183], v[76:79], v[104:107], 0
  buffer_load_dwordx4 v56, s[16:19], s5 offen offset:256 lds
  v_cvt_pk_bf16_f32 v96, v176, v177
  v_mfma_f32_16x16x32_bf16 v[180:183], v[172:175], v[100:103], v[180:183]
  v_cvt_pk_bf16_f32 v122, v128, v129
  v_cvt_pk_bf16_f32 v123, v130, v131
  v_mfma_f32_16x16x32_bf16 v[124:127], v[168:171], v[100:103], 0
  v_exp_f32 v178, v178
  v_mfma_f32_16x16x32_bf16 v[124:127], v[80:83], v[104:107], v[124:127]
  v_exp_f32 v179, v179
  v_mfma_f32_16x16x32_bf16 v[64:67], v[120:123], v[104:107], 0
  v_exp_f32 v144, v144
  v_cvt_pk_bf16_f32 v97, v178, v179
  v_mfma_f32_16x16x32_bf16 v[64:67], v[70:73], v[100:103], v[64:67]
  v_exp_f32 v145, v145
  v_mov_b64 v[156:157], 0
  v_smfmac_f32_16x16x64_bf16 v[140:143], a[240:243], v[108:115], v10
  v_exp_f32 v146, v146
  v_cvt_pk_bf16_f32 v98, v144, v145
  v_mfma_f32_16x16x32_bf16 v[116:119], v[76:79], v[112:115], 0
  v_exp_f32 v147, v147
  v_add_f32 v164, v164, v165
  v_mfma_f32_16x16x32_bf16 v[116:119], v[172:175], v[108:111], v[116:119]
  v_cvt_pk_bf16_f32 v99, v146, v147
  v_exp_f32 v84, v84
  v_mfma_f32_16x16x32_bf16 v[136:139], v[168:171], v[108:111], 0
  v_exp_f32 v85, v85
  v_mfma_f32_16x16x32_bf16 v[136:139], v[80:83], v[112:115], v[136:139]
  v_exp_f32 v86, v86
  v_cvt_pk_bf16_f32 v84, v84, v85
  v_mfma_f32_16x16x32_bf16 v[100:103], v[120:123], v[112:115], 0
  v_exp_f32 v87, v87
  v_add_f32 v140, v140, v141
  v_mfma_f32_16x16x32_bf16 v[100:103], v[70:73], v[108:111], v[100:103]
  v_exp_f32 v88, v88
  v_cvt_pk_bf16_f32 v85, v86, v87
  v_smfmac_f32_16x16x64_bf16 v[156:159], a[240:243], v[92:99], v10
  v_exp_f32 v89, v89
  v_exp_f32 v90, v90
  v_exp_f32 v91, v91
  v_exp_f32 v148, v148
  v_exp_f32 v149, v149
  v_exp_f32 v150, v150
  v_exp_f32 v151, v151
  v_exp_f32 v160, v160
  v_exp_f32 v161, v161
  v_exp_f32 v162, v162
  v_exp_f32 v163, v163
  v_mfma_f32_16x16x32_bf16 v[144:147], v[172:175], v[96:99], 0
  s_add_u32 s5, s45, 49152
  v_cvt_pk_bf16_f32 v86, v88, v89
  v_cvt_pk_bf16_f32 v87, v90, v91
  v_cvt_pk_bf16_f32 v88, v148, v149
  v_cvt_pk_bf16_f32 v89, v150, v151
  v_cvt_pk_bf16_f32 v90, v160, v161
  v_cvt_pk_bf16_f32 v91, v162, v163
  v_mfma_f32_16x16x32_bf16 v[144:147], v[76:79], v[92:95], v[144:147]
  s_waitcnt vmcnt(6) lgkmcnt(0)
  s_barrier
  v_mfma_f32_16x16x32_bf16 v[148:151], v[80:83], v[92:95], 0
  s_add_u32 m0, s46, 102400
  ds_read_b128 v[132:135], v0 offset:0
  v_mov_b64 v[108:109], 0
  v_mfma_f32_16x16x32_bf16 v[148:151], v[168:171], v[96:99], v[148:151]
  buffer_load_dwordx4 v56, s[16:19], s5 offen offset:0 lds
  v_mfma_f32_16x16x32_bf16 v[160:163], v[70:73], v[96:99], 0
  s_add_u32 m0, s46, 110464
  ds_read_b128 v[60:63], v1 offset:0
  ds_read_b128 v[128:131], v0 offset:8192
  v_mfma_f32_16x16x32_bf16 v[160:163], v[120:123], v[92:95], v[160:163]
  ds_read_b128 v[152:155], v1 offset:8192
  ds_read_b128 v[176:179], v0 offset:16384
  v_smfmac_f32_16x16x64_bf16 v[108:111], a[240:243], v[84:91], v10
  buffer_load_dwordx4 v56, s[16:19], s5 offen offset:128 lds
  v_mfma_f32_16x16x32_bf16 v[92:95], v[172:175], v[88:91], 0
  s_add_u32 m0, s46, 118528
  ds_read_b128 a[244:247], v1 offset:16384
  ds_read2st64_b32 v[96:97], v69 offset0:0 offset1:2
  v_mfma_f32_16x16x32_bf16 v[92:95], v[76:79], v[84:87], v[92:95]
  ds_read2st64_b32 v[172:173], v68 offset0:0 offset1:2
  ds_read2st64_b32 v[98:99], v69 offset0:4 offset1:6
  v_mfma_f32_16x16x32_bf16 v[104:107], v[80:83], v[84:87], 0
  buffer_load_dwordx4 v56, s[16:19], s5 offen offset:256 lds
  v_mfma_f32_16x16x32_bf16 v[104:107], v[168:171], v[88:91], v[104:107]
  s_add_u32 s5, s45, 61440
  s_add_u32 m0, s46, 106496
  ds_read2st64_b32 v[174:175], v68 offset0:4 offset1:6
  v_mfma_f32_16x16x32_bf16 v[168:171], v[70:73], v[88:91], 0
  s_waitcnt lgkmcnt(3)
  ds_read2st64_b32 v[76:77], v54 offset0:0 offset1:2
  ds_read2st64_b32 v[80:81], v55 offset0:0 offset1:2
  v_mfma_f32_16x16x32_bf16 v[168:171], v[120:123], v[84:87], v[168:171]
  buffer_load_dwordx4 v56, s[16:19], s5 offen offset:0 lds
  v_mfma_f32_16x16x32_bf16 v[72:75], a[0:3], v[132:135], 0
  s_add_u32 m0, s46, 114560
  ds_read2st64_b32 v[78:79], v54 offset0:4 offset1:6
  ds_read2st64_b32 v[82:83], v55 offset0:4 offset1:6
  v_mfma_f32_16x16x32_bf16 v[72:75], a[12:15], v[60:63], v[72:75]
  v_rcp_f32 v166, v164
  v_mfma_f32_16x16x32_bf16 v[72:75], a[24:27], v[128:131], v[72:75]
  buffer_load_dwordx4 v56, s[16:19], s5 offen offset:128 lds
  v_mfma_f32_16x16x32_bf16 v[72:75], a[36:39], v[152:155], v[72:75]
  s_add_u32 m0, s46, 122624
  v_mul_f32 v180, v166, v180
  v_mul_f32 v181, v166, v181
  v_mfma_f32_16x16x32_bf16 v[72:75], a[48:51], v[176:179], v[72:75]
  s_waitcnt lgkmcnt(4)
  v_perm_b32 v184, v172, v96, s58
  v_perm_b32 v188, v172, v96, s59
  v_mfma_f32_16x16x32_bf16 v[72:75], a[60:63], a[244:247], v[72:75]
  buffer_load_dwordx4 v56, s[16:19], s5 offen offset:256 lds
  v_mfma_f32_16x16x32_bf16 v[84:87], a[64:67], a[244:247], 0
  s_waitcnt lgkmcnt(0)
  v_perm_b32 v185, v173, v97, s58
  v_perm_b32 v189, v173, v97, s59
  v_mfma_f32_16x16x32_bf16 v[84:87], a[52:55], v[176:179], v[84:87]
  s_add_u32 m0, s28, 4096
  v_perm_b32 v186, v174, v98, s58
  v_perm_b32 v190, v174, v98, s59
  v_mfma_f32_16x16x32_bf16 v[84:87], a[40:43], v[152:155], v[84:87]
  s_mov_b32 s5, s28
  v_mul_f32 v72, s42, v72
  v_mul_f32 v73, s42, v73
  v_mfma_f32_16x16x32_bf16 v[84:87], a[28:31], v[128:131], v[84:87]
  v_mul_f32 v74, s42, v74
  v_mul_f32 v75, s42, v75
  v_mfma_f32_16x16x32_bf16 v[84:87], a[16:19], v[60:63], v[84:87]
  buffer_load_dwordx4 v6, s[8:11], s32 offen offset:0 nt lds
  v_mfma_f32_16x16x32_bf16 v[84:87], a[4:7], v[132:135], v[84:87]
  s_add_u32 m0, s28, 12160
  v_cvt_pk_bf16_f32 v12, v72, v73
  v_cvt_pk_bf16_f32 v13, v74, v75
  v_mfma_f32_16x16x32_bf16 v[56:59], a[8:11], v[132:135], 0
  v_perm_b32 v187, v175, v99, s58
  v_perm_b32 v191, v175, v99, s59
  v_perm_b32 v192, v80, v76, s58
  v_mfma_f32_16x16x32_bf16 v[56:59], a[20:23], v[60:63], v[56:59]
  buffer_load_dwordx4 v6, s[8:11], s32 offen offset:128 nt lds
  v_perm_b32 v196, v80, v76, s59
  v_mfma_f32_16x16x32_bf16 v[56:59], a[32:35], v[128:131], v[56:59]
  s_add_u32 m0, s28, 20224
  v_mul_f32 v84, s42, v84
  v_mul_f32 v85, s42, v85
  v_mul_f32 v86, s42, v86
  v_mfma_f32_16x16x32_bf16 v[56:59], a[44:47], v[152:155], v[56:59]
  s_mov_b32 s28, s29
  v_mul_f32 v87, s42, v87
  v_cvt_pk_bf16_f32 v72, v84, v85
  v_cvt_pk_bf16_f32 v73, v86, v87
  v_mfma_f32_16x16x32_bf16 v[56:59], a[56:59], v[176:179], v[56:59]
  buffer_load_dwordx4 v6, s[8:11], s32 offen offset:256 nt lds
  v_perm_b32 v193, v81, v77, s58
  v_mfma_f32_16x16x32_bf16 v[56:59], a[68:71], a[244:247], v[56:59]
  s_add_u32 s32, s32, s43
  v_perm_b32 v197, v81, v77, s59
  v_perm_b32 v194, v82, v78, s58
  v_perm_b32 v198, v82, v78, s59
  v_mfma_f32_16x16x32_bf16 v[84:87], a[132:135], a[244:247], 0
  ds_read2st64_b32 v[96:97], v69 offset0:16 offset1:18
  v_perm_b32 v195, v83, v79, s58
  v_perm_b32 v199, v83, v79, s59
  v_mfma_f32_16x16x32_bf16 v[84:87], a[120:123], v[176:179], v[84:87]
  ds_read2st64_b32 v[172:173], v68 offset0:16 offset1:18
  ds_read2st64_b32 v[98:99], v69 offset0:20 offset1:22
  v_mul_f32 v182, v166, v182
  v_mfma_f32_16x16x32_bf16 v[84:87], a[108:111], v[152:155], v[84:87]
  v_mul_f32 v56, s42, v56
  v_mul_f32 v57, s42, v57
  v_mul_f32 v58, s42, v58
  v_mfma_f32_16x16x32_bf16 v[84:87], a[96:99], v[128:131], v[84:87]
  v_mul_f32 v59, s42, v59
  v_cvt_pk_bf16_f32 v74, v56, v57
  v_cvt_pk_bf16_f32 v75, v58, v59
  v_mfma_f32_16x16x32_bf16 v[84:87], a[84:87], v[60:63], v[84:87]
  ds_read2st64_b32 v[174:175], v68 offset0:20 offset1:22
  ds_read2st64_b32 v[76:77], v54 offset0:16 offset1:18
  v_mul_f32 v183, v166, v183
  v_mfma_f32_16x16x32_bf16 v[84:87], a[72:75], v[132:135], v[84:87]
  ds_read2st64_b32 v[80:81], v55 offset0:16 offset1:18
  ds_read2st64_b32 v[78:79], v54 offset0:20 offset1:22
  v_cvt_pk_bf16_f32 v180, v180, v181
  v_mfma_f32_16x16x32_bf16 v[56:59], a[76:79], v[132:135], 0
  ds_read2st64_b32 v[82:83], v55 offset0:20 offset1:22
  v_cvt_pk_bf16_f32 v181, v182, v183
  v_mul_f32 v124, v166, v124
  v_mfma_f32_16x16x32_bf16 v[56:59], a[88:91], v[60:63], v[56:59]
  v_mul_f32 v125, v166, v125
  v_mul_f32 v126, v166, v126
  v_mul_f32 v127, v166, v127
  v_mfma_f32_16x16x32_bf16 v[56:59], a[100:103], v[128:131], v[56:59]
  v_cvt_pk_bf16_f32 v120, v84, v85
  v_cvt_pk_bf16_f32 v121, v86, v87
  v_cvt_pk_bf16_f32 v124, v124, v125
  v_mfma_f32_16x16x32_bf16 v[56:59], a[112:115], v[152:155], v[56:59]
  s_waitcnt lgkmcnt(4)
  v_cvt_pk_bf16_f32 v125, v126, v127
  v_mul_f32 v64, v166, v64
  v_mul_f32 v65, v166, v65
  v_mfma_f32_16x16x32_bf16 v[56:59], a[124:127], v[176:179], v[56:59]
  v_mul_f32 v66, v166, v66
  v_mul_f32 v67, v166, v67
  v_cvt_pk_bf16_f32 v64, v64, v65
  v_mfma_f32_16x16x32_bf16 v[56:59], a[136:139], a[244:247], v[56:59]
  s_waitcnt lgkmcnt(0)
  v_cvt_pk_bf16_f32 v65, v66, v67
  v_max3_f32 v9, v164, v166, v9
  v_perm_b32 v200, v172, v96, s58
  v_mfma_f32_16x16x32_bf16 v[88:91], a[140:143], a[244:247], 0
  ds_write2st64_b32 v5, v180, v181 offset0:0 offset1:4
  v_mfma_f32_16x16x32_bf16 v[88:91], a[128:131], v[176:179], v[88:91]
  ds_write2st64_b32 v5, v124, v125 offset0:8 offset1:12
  v_mfma_f32_16x16x32_bf16 v[88:91], a[116:119], v[152:155], v[88:91]
  v_cvt_pk_bf16_f32 v122, v56, v57
  v_cvt_pk_bf16_f32 v123, v58, v59
  v_perm_b32 v204, v172, v96, s59
  v_mfma_f32_16x16x32_bf16 v[88:91], a[104:107], v[128:131], v[88:91]
  ds_write2st64_b32 v5, v64, v65 offset0:16 offset1:20
  v_mfma_f32_16x16x32_bf16 v[88:91], a[92:95], v[60:63], v[88:91]
  v_perm_b32 v201, v173, v97, s58
  v_perm_b32 v205, v173, v97, s59
  v_perm_b32 v202, v174, v98, s58
  v_mfma_f32_16x16x32_bf16 v[88:91], a[80:83], v[132:135], v[88:91]
  v_perm_b32 v206, v174, v98, s59
  v_perm_b32 v203, v175, v99, s58
  v_perm_b32 v207, v175, v99, s59
  v_mfma_f32_16x16x32_bf16 v[164:167], v[132:135], a[144:147], 0
  v_perm_b32 v208, v80, v76, s58
  v_perm_b32 v212, v80, v76, s59
  v_perm_b32 v209, v81, v77, s58
  v_mfma_f32_16x16x32_bf16 v[164:167], v[60:63], a[156:159], v[164:167]
  v_perm_b32 v213, v81, v77, s59
  v_perm_b32 v210, v82, v78, s58
  v_perm_b32 v214, v82, v78, s59
  v_mfma_f32_16x16x32_bf16 v[164:167], v[128:131], a[168:171], v[164:167]
  ds_read_b128 v[84:87], v0 offset:2048
  v_cvt_pk_bf16_f32 v124, v88, v89
  v_cvt_pk_bf16_f32 v125, v90, v91
  v_mfma_f32_16x16x32_bf16 v[164:167], v[152:155], a[180:183], v[164:167]
  ds_read_b128 v[112:115], v1 offset:2048
  ds_read_b128 v[180:183], v0 offset:10240
  v_perm_b32 v211, v83, v79, s58
  v_mfma_f32_16x16x32_bf16 v[164:167], v[176:179], a[192:195], v[164:167]
  s_add_u32 m0, s29, 0
  ds_read_b128 a[252:255], v1 offset:10240
  ds_read_b128 a[248:251], v0 offset:18432
  v_perm_b32 v215, v83, v79, s59
  v_mfma_f32_16x16x32_bf16 v[164:167], a[244:247], a[204:207], v[164:167]
  ds_read_b128 v[88:91], v1 offset:18432
  v_add_u32 v69, 4294840320, v69
  v_add_u32 v68, 4294840320, v68
  v_mfma_f32_16x16x32_bf16 v[64:67], a[244:247], a[208:211], 0
  s_waitcnt vmcnt(3)
  s_barrier
  v_mfma_f32_16x16x32_bf16 v[64:67], v[176:179], a[196:199], v[64:67]
  buffer_load_dwordx4 v6, s[8:11], s31 offen offset:0 nt lds
  v_add_u32 v54, 4294840320, v54
  v_mfma_f32_16x16x32_bf16 v[64:67], v[152:155], a[184:187], v[64:67]
  s_add_u32 m0, s29, 8064
  v_cvt_pk_bf16_f32 v56, v164, v165
  v_cvt_pk_bf16_f32 v57, v166, v167
  v_add_u32 v55, 4294840320, v55
  v_mfma_f32_16x16x32_bf16 v[64:67], v[128:131], a[172:175], v[64:67]
  ds_read2st64_b32 v[96:97], v69 offset0:0 offset1:2
  ds_read2st64_b32 v[172:173], v68 offset0:0 offset1:2
  v_add_f32 v156, v156, v157
  v_mfma_f32_16x16x32_bf16 v[64:67], v[60:63], a[160:163], v[64:67]
  ds_read2st64_b32 v[98:99], v69 offset0:4 offset1:6
  ds_read2st64_b32 v[174:175], v68 offset0:4 offset1:6
  v_add_f32 v108, v108, v109
  v_mfma_f32_16x16x32_bf16 v[64:67], v[132:135], a[148:151], v[64:67]
  buffer_load_dwordx4 v6, s[8:11], s31 offen offset:128 nt lds
  v_mfma_f32_16x16x32_bf16 v[164:167], v[132:135], a[152:155], 0
  s_add_u32 m0, s29, 16128
  ds_read2st64_b32 v[76:77], v54 offset0:0 offset1:2
  ds_read2st64_b32 v[80:81], v55 offset0:0 offset1:2
  v_mfma_f32_16x16x32_bf16 v[164:167], v[60:63], a[164:167], v[164:167]
  ds_read2st64_b32 v[78:79], v54 offset0:4 offset1:6
  ds_read2st64_b32 v[82:83], v55 offset0:4 offset1:6
  v_mfma_f32_16x16x32_bf16 v[164:167], v[128:131], a[176:179], v[164:167]
  v_cvt_pk_bf16_f32 v60, v64, v65
  v_cvt_pk_bf16_f32 v61, v66, v67
  v_mfma_f32_16x16x32_bf16 v[164:167], v[152:155], a[188:191], v[164:167]
  buffer_load_dwordx4 v6, s[8:11], s31 offen offset:256 nt lds
  v_mfma_f32_16x16x32_bf16 v[164:167], v[176:179], a[200:203], v[164:167]
  s_add_u32 m0, s29, 4096
  v_rcp_f32 v142, v140
  v_mfma_f32_16x16x32_bf16 v[164:167], a[244:247], a[212:215], v[164:167]
  s_waitcnt lgkmcnt(4)
  v_perm_b32 v216, v172, v96, s58
  v_perm_b32 v220, v172, v96, s59
  v_perm_b32 v217, v173, v97, s58
  v_mfma_f32_16x16x32_bf16 v[132:135], a[0:3], v[84:87], 0
  s_waitcnt lgkmcnt(0)
  v_perm_b32 v221, v173, v97, s59
  v_perm_b32 v218, v174, v98, s58
  v_perm_b32 v222, v174, v98, s59
  v_mfma_f32_16x16x32_bf16 v[132:135], a[12:15], v[112:115], v[132:135]
  buffer_load_dwordx4 v6, s[8:11], s32 offen offset:0 nt lds
  v_perm_b32 v219, v175, v99, s58
  v_mfma_f32_16x16x32_bf16 v[132:135], a[24:27], v[180:183], v[132:135]
  s_add_u32 m0, s29, 12160
  v_cvt_pk_bf16_f32 v64, v164, v165
  v_cvt_pk_bf16_f32 v65, v166, v167
  v_perm_b32 v223, v175, v99, s59
  v_mfma_f32_16x16x32_bf16 v[132:135], a[36:39], a[252:255], v[132:135]
  s_add_u32 s31, s31, s43
  v_perm_b32 v224, v80, v76, s58
  v_perm_b32 v228, v80, v76, s59
  v_perm_b32 v225, v81, v77, s58
  v_mfma_f32_16x16x32_bf16 v[132:135], a[48:51], a[248:251], v[132:135]
  v_perm_b32 v229, v81, v77, s59
  v_perm_b32 v226, v82, v78, s58
  v_perm_b32 v230, v82, v78, s59
  v_mfma_f32_16x16x32_bf16 v[132:135], a[60:63], v[88:91], v[132:135]
  buffer_load_dwordx4 v6, s[8:11], s32 offen offset:128 nt lds
  v_perm_b32 v227, v83, v79, s58
  v_mfma_f32_16x16x32_bf16 v[176:179], a[64:67], v[88:91], 0
  s_add_u32 m0, s29, 20224
  ds_read2st64_b32 v[96:97], v69 offset0:16 offset1:18
  ds_read2st64_b32 v[172:173], v68 offset0:16 offset1:18
  v_perm_b32 v231, v83, v79, s59
  v_mfma_f32_16x16x32_bf16 v[176:179], a[52:55], a[248:251], v[176:179]
  s_mov_b32 s29, s30
  ds_read2st64_b32 v[98:99], v69 offset0:20 offset1:22
  ds_read2st64_b32 v[174:175], v68 offset0:20 offset1:22
  v_mul_f32 v116, v142, v116
  v_mfma_f32_16x16x32_bf16 v[176:179], a[40:43], a[252:255], v[176:179]
  v_mul_f32 v132, s42, v132
  v_mul_f32 v133, s42, v133
  v_mul_f32 v134, s42, v134
  v_mfma_f32_16x16x32_bf16 v[176:179], a[28:31], v[180:183], v[176:179]
  buffer_load_dwordx4 v6, s[8:11], s32 offen offset:256 nt lds
  v_mul_f32 v135, s42, v135
  v_mfma_f32_16x16x32_bf16 v[176:179], a[16:19], v[112:115], v[176:179]
  s_add_u32 s32, s32, s43
  ds_read2st64_b32 v[76:77], v54 offset0:16 offset1:18
  v_cvt_pk_bf16_f32 v128, v132, v133
  v_cvt_pk_bf16_f32 v129, v134, v135
  v_mfma_f32_16x16x32_bf16 v[176:179], a[4:7], v[84:87], v[176:179]
  ds_read2st64_b32 v[80:81], v55 offset0:16 offset1:18
  ds_read2st64_b32 v[78:79], v54 offset0:20 offset1:22
  v_mul_f32 v117, v142, v117
  v_mfma_f32_16x16x32_bf16 v[164:167], a[8:11], v[84:87], 0
  s_waitcnt lgkmcnt(3)
  ds_read2st64_b32 v[82:83], v55 offset0:20 offset1:22
  v_mul_f32 v118, v142, v118
  v_mul_f32 v119, v142, v119
  v_mfma_f32_16x16x32_bf16 v[164:167], a[20:23], v[112:115], v[164:167]
  v_cvt_pk_bf16_f32 v116, v116, v117
  v_cvt_pk_bf16_f32 v117, v118, v119
  v_mul_f32 v136, v142, v136
  v_mfma_f32_16x16x32_bf16 v[164:167], a[32:35], v[180:183], v[164:167]
  v_mul_f32 v176, s42, v176
  v_mul_f32 v177, s42, v177
  v_mul_f32 v178, s42, v178
  v_mfma_f32_16x16x32_bf16 v[164:167], a[44:47], a[252:255], v[164:167]
  v_mul_f32 v179, s42, v179
  v_cvt_pk_bf16_f32 v130, v176, v177
  v_cvt_pk_bf16_f32 v131, v178, v179
  v_mfma_f32_16x16x32_bf16 v[164:167], a[56:59], a[248:251], v[164:167]
  v_mul_f32 v137, v142, v137
  v_mul_f32 v138, v142, v138
  v_mul_f32 v139, v142, v139
  v_mfma_f32_16x16x32_bf16 v[164:167], a[68:71], v[88:91], v[164:167]
  s_waitcnt lgkmcnt(0)
  v_cvt_pk_bf16_f32 v136, v136, v137
  v_cvt_pk_bf16_f32 v137, v138, v139
  v_mul_f32 v100, v142, v100
  v_mfma_f32_16x16x32_bf16 v[176:179], a[132:135], v[88:91], 0
  v_mul_f32 v101, v142, v101
  v_mul_f32 v102, v142, v102
  v_mul_f32 v103, v142, v103
  v_mfma_f32_16x16x32_bf16 v[176:179], a[120:123], a[248:251], v[176:179]
  v_cvt_pk_bf16_f32 v100, v100, v101
  v_cvt_pk_bf16_f32 v101, v102, v103
  v_max3_f32 v9, v140, v142, v9
  v_mfma_f32_16x16x32_bf16 v[176:179], a[108:111], a[252:255], v[176:179]
  v_mul_f32 v164, s42, v164
  v_mul_f32 v165, s42, v165
  v_mul_f32 v166, s42, v166
  v_mfma_f32_16x16x32_bf16 v[176:179], a[96:99], v[180:183], v[176:179]
  v_mul_f32 v167, s42, v167
  v_cvt_pk_bf16_f32 v16, v164, v165
  v_cvt_pk_bf16_f32 v17, v166, v167
  v_mfma_f32_16x16x32_bf16 v[176:179], a[84:87], v[112:115], v[176:179]
  ds_write2st64_b32 v5, v116, v117 offset0:1 offset1:5
  v_mfma_f32_16x16x32_bf16 v[176:179], a[72:75], v[84:87], v[176:179]
  ds_write2st64_b32 v5, v136, v137 offset0:9 offset1:13
  v_mfma_f32_16x16x32_bf16 v[132:135], a[76:79], v[84:87], 0
  ds_write2st64_b32 v5, v100, v101 offset0:17 offset1:21
  v_mfma_f32_16x16x32_bf16 v[132:135], a[88:91], v[112:115], v[132:135]
  v_rcp_f32 v158, v156
  v_perm_b32 v232, v172, v96, s58
  v_mfma_f32_16x16x32_bf16 v[132:135], a[100:103], v[180:183], v[132:135]
  v_cvt_pk_bf16_f32 v136, v176, v177
  v_cvt_pk_bf16_f32 v137, v178, v179
  v_mul_f32 v144, v158, v144
  v_mfma_f32_16x16x32_bf16 v[132:135], a[112:115], a[252:255], v[132:135]
  v_mul_f32 v145, v158, v145
  v_mul_f32 v146, v158, v146
  v_mul_f32 v147, v158, v147
  v_mfma_f32_16x16x32_bf16 v[132:135], a[124:127], a[248:251], v[132:135]
  v_cvt_pk_bf16_f32 v144, v144, v145
  v_cvt_pk_bf16_f32 v145, v146, v147
  v_mul_f32 v148, v158, v148
  v_mfma_f32_16x16x32_bf16 v[132:135], a[136:139], v[88:91], v[132:135]
  v_mul_f32 v149, v158, v149
  v_mul_f32 v150, v158, v150
  v_mul_f32 v151, v158, v151
  v_mfma_f32_16x16x32_bf16 v[152:155], a[140:143], v[88:91], 0
  v_cvt_pk_bf16_f32 v148, v148, v149
  v_cvt_pk_bf16_f32 v149, v150, v151
  v_mul_f32 v160, v158, v160
  v_mfma_f32_16x16x32_bf16 v[152:155], a[128:131], a[248:251], v[152:155]
  v_mul_f32 v161, v158, v161
  v_mul_f32 v162, v158, v162
  v_mul_f32 v163, v158, v163
  v_mfma_f32_16x16x32_bf16 v[152:155], a[116:119], a[252:255], v[152:155]
  v_cvt_pk_bf16_f32 v138, v132, v133
  v_cvt_pk_bf16_f32 v139, v134, v135
  v_cvt_pk_bf16_f32 v160, v160, v161
  v_mfma_f32_16x16x32_bf16 v[152:155], a[104:107], v[180:183], v[152:155]
  v_cvt_pk_bf16_f32 v161, v162, v163
  v_max3_f32 v9, v156, v158, v9
  v_perm_b32 v236, v172, v96, s59
  v_mfma_f32_16x16x32_bf16 v[152:155], a[92:95], v[112:115], v[152:155]
  ds_write2st64_b32 v5, v144, v145 offset0:2 offset1:6
  v_mfma_f32_16x16x32_bf16 v[152:155], a[80:83], v[84:87], v[152:155]
  ds_write2st64_b32 v5, v148, v149 offset0:10 offset1:14
  v_mfma_f32_16x16x32_bf16 v[164:167], v[84:87], a[144:147], 0
  ds_write2st64_b32 v5, v160, v161 offset0:18 offset1:22
  v_mfma_f32_16x16x32_bf16 v[164:167], v[112:115], a[156:159], v[164:167]
  v_rcp_f32 v110, v108
  v_perm_b32 v233, v173, v97, s58
  v_mfma_f32_16x16x32_bf16 v[164:167], v[180:183], a[168:171], v[164:167]
  v_cvt_pk_bf16_f32 v140, v152, v153
  v_cvt_pk_bf16_f32 v141, v154, v155
  v_mfma_f32_16x16x32_bf16 v[164:167], a[252:255], a[180:183], v[164:167]
  v_mul_f32 v92, v110, v92
  v_mul_f32 v93, v110, v93
  v_mfma_f32_16x16x32_bf16 v[164:167], a[248:251], a[192:195], v[164:167]
  s_waitcnt vmcnt(6) lgkmcnt(0)
  s_barrier
  v_mfma_f32_16x16x32_bf16 v[164:167], v[88:91], a[204:207], v[164:167]
  ds_read_b128 v[156:159], v0 offset:4096
  ds_read_b128 v[176:179], v1 offset:4096
  v_mfma_f32_16x16x32_bf16 v[144:147], v[88:91], a[208:211], 0
  ds_read_b128 v[160:163], v0 offset:12288
  ds_read_b128 v[116:119], v1 offset:12288
  v_mfma_f32_16x16x32_bf16 v[144:147], a[248:251], a[196:199], v[144:147]
  ds_read_b128 v[152:155], v0 offset:20480
  ds_read_b128 v[132:135], v1 offset:20480
  v_mfma_f32_16x16x32_bf16 v[144:147], a[252:255], a[184:187], v[144:147]
  v_cvt_pk_bf16_f32 v58, v164, v165
  v_cvt_pk_bf16_f32 v59, v166, v167
  v_mfma_f32_16x16x32_bf16 v[144:147], v[180:183], a[172:175], v[144:147]
  v_mul_f32 v94, v110, v94
  v_mul_f32 v95, v110, v95
  v_mfma_f32_16x16x32_bf16 v[144:147], v[112:115], a[160:163], v[144:147]
  v_cvt_pk_bf16_f32 v92, v92, v93
  v_cvt_pk_bf16_f32 v93, v94, v95
  v_mfma_f32_16x16x32_bf16 v[144:147], v[84:87], a[148:151], v[144:147]
  v_mul_f32 v104, v110, v104
  v_mul_f32 v105, v110, v105
  v_mfma_f32_16x16x32_bf16 v[148:151], v[84:87], a[152:155], 0
  v_mul_f32 v106, v110, v106
  v_mul_f32 v107, v110, v107
  v_mfma_f32_16x16x32_bf16 v[148:151], v[112:115], a[164:167], v[148:151]
  v_cvt_pk_bf16_f32 v104, v104, v105
  v_cvt_pk_bf16_f32 v105, v106, v107
  v_mfma_f32_16x16x32_bf16 v[148:151], v[180:183], a[176:179], v[148:151]
  v_cvt_pk_bf16_f32 v62, v144, v145
  v_cvt_pk_bf16_f32 v63, v146, v147
  v_mfma_f32_16x16x32_bf16 v[148:151], a[252:255], a[188:191], v[148:151]
  v_mul_f32 v168, v110, v168
  v_mul_f32 v169, v110, v169
  v_mfma_f32_16x16x32_bf16 v[148:151], a[248:251], a[200:203], v[148:151]
  v_mul_f32 v170, v110, v170
  v_mul_f32 v171, v110, v171
  v_mfma_f32_16x16x32_bf16 v[148:151], v[88:91], a[212:215], v[148:151]
  s_waitcnt lgkmcnt(0)
  v_cvt_pk_bf16_f32 v168, v168, v169
  v_cvt_pk_bf16_f32 v169, v170, v171
  v_mfma_f32_16x16x32_bf16 v[88:91], a[0:3], v[156:159], 0
  v_max3_f32 v9, v108, v110, v9
  v_perm_b32 v237, v173, v97, s59
  v_mfma_f32_16x16x32_bf16 v[88:91], a[12:15], v[176:179], v[88:91]
  ds_write2st64_b32 v5, v92, v93 offset0:3 offset1:7
  v_mfma_f32_16x16x32_bf16 v[88:91], a[24:27], v[160:163], v[88:91]
  v_cvt_pk_bf16_f32 v66, v148, v149
  v_cvt_pk_bf16_f32 v67, v150, v151
  v_mfma_f32_16x16x32_bf16 v[88:91], a[36:39], v[116:119], v[88:91]
  ds_write2st64_b32 v5, v104, v105 offset0:11 offset1:15
  v_mfma_f32_16x16x32_bf16 v[88:91], a[48:51], v[152:155], v[88:91]
  ds_write2st64_b32 v5, v168, v169 offset0:19 offset1:23
  v_mfma_f32_16x16x32_bf16 v[88:91], a[60:63], v[132:135], v[88:91]
  v_perm_b32 v234, v174, v98, s58
  v_perm_b32 v238, v174, v98, s59
  v_mfma_f32_16x16x32_bf16 v[84:87], a[64:67], v[132:135], 0
  v_perm_b32 v235, v175, v99, s58
  v_perm_b32 v239, v175, v99, s59
  v_mfma_f32_16x16x32_bf16 v[84:87], a[52:55], v[152:155], v[84:87]
  v_perm_b32 v240, v80, v76, s58
  v_perm_b32 v244, v80, v76, s59
  v_mfma_f32_16x16x32_bf16 v[84:87], a[40:43], v[116:119], v[84:87]
  v_mul_f32 v88, s42, v88
  v_mul_f32 v89, s42, v89
  v_mfma_f32_16x16x32_bf16 v[84:87], a[28:31], v[160:163], v[84:87]
  v_mul_f32 v90, s42, v90
  v_mul_f32 v91, s42, v91
  v_mfma_f32_16x16x32_bf16 v[84:87], a[16:19], v[176:179], v[84:87]
L_hop_2_0:
  s_cbranch_execz L_hop_2_1
  v_cvt_pk_bf16_f32 v18, v88, v89
  v_cvt_pk_bf16_f32 v19, v90, v91
  v_mfma_f32_16x16x32_bf16 v[84:87], a[4:7], v[156:159], v[84:87]
  v_perm_b32 v241, v81, v77, s58
  v_perm_b32 v245, v81, v77, s59
  v_mfma_f32_16x16x32_bf16 v[88:91], a[8:11], v[156:159], 0
  v_perm_b32 v242, v82, v78, s58
  v_perm_b32 v246, v82, v78, s59
  v_mfma_f32_16x16x32_bf16 v[88:91], a[20:23], v[176:179], v[88:91]
  v_perm_b32 v243, v83, v79, s58
  v_perm_b32 v247, v83, v79, s59
  v_mfma_f32_16x16x32_bf16 v[88:91], a[32:35], v[160:163], v[88:91]
  v_mul_f32 v84, s42, v84
  v_mul_f32 v85, s42, v85
  v_mfma_f32_16x16x32_bf16 v[88:91], a[44:47], v[116:119], v[88:91]
  v_mul_f32 v86, s42, v86
  v_mul_f32 v87, s42, v87
  v_mfma_f32_16x16x32_bf16 v[88:91], a[56:59], v[152:155], v[88:91]
  v_cvt_pk_bf16_f32 v100, v84, v85
  v_cvt_pk_bf16_f32 v101, v86, v87
  v_mfma_f32_16x16x32_bf16 v[88:91], a[68:71], v[132:135], v[88:91]
  v_add_u32 v69, 102400, v69
  v_add_u32 v68, 102400, v68
  v_mfma_f32_16x16x32_bf16 v[104:107], a[132:135], v[132:135], 0
  v_add_u32 v54, 102400, v54
  v_add_u32 v55, 102400, v55
  v_mfma_f32_16x16x32_bf16 v[104:107], a[120:123], v[152:155], v[104:107]
  ds_read2st64_b32 v[96:97], v69 offset0:0 offset1:2
  ds_read2st64_b32 v[172:173], v68 offset0:0 offset1:2
  v_mfma_f32_16x16x32_bf16 v[104:107], a[108:111], v[116:119], v[104:107]
  v_mul_f32 v88, s42, v88
  v_mul_f32 v89, s42, v89
  v_mfma_f32_16x16x32_bf16 v[104:107], a[96:99], v[160:163], v[104:107]
  v_mul_f32 v90, s42, v90
  v_mul_f32 v91, s42, v91
  v_mfma_f32_16x16x32_bf16 v[104:107], a[84:87], v[176:179], v[104:107]
  v_cvt_pk_bf16_f32 v102, v88, v89
  v_cvt_pk_bf16_f32 v103, v90, v91
  v_mfma_f32_16x16x32_bf16 v[104:107], a[72:75], v[156:159], v[104:107]
  ds_read2st64_b32 v[98:99], v69 offset0:4 offset1:6
  ds_read2st64_b32 v[174:175], v68 offset0:4 offset1:6
  v_mfma_f32_16x16x32_bf16 v[84:87], a[76:79], v[156:159], 0
  ds_read2st64_b32 v[76:77], v54 offset0:0 offset1:2
  ds_read2st64_b32 v[80:81], v55 offset0:0 offset1:2
  v_mfma_f32_16x16x32_bf16 v[84:87], a[88:91], v[176:179], v[84:87]
  ds_read2st64_b32 v[78:79], v54 offset0:4 offset1:6
  ds_read2st64_b32 v[82:83], v55 offset0:4 offset1:6
  v_mfma_f32_16x16x32_bf16 v[84:87], a[100:103], v[160:163], v[84:87]
  v_cvt_pk_bf16_f32 v144, v104, v105
  v_cvt_pk_bf16_f32 v145, v106, v107
  v_mfma_f32_16x16x32_bf16 v[84:87], a[112:115], v[116:119], v[84:87]
  v_xor_b32 v5, s41, v5
  v_mfma_f32_16x16x32_bf16 v[84:87], a[124:127], v[152:155], v[84:87]
  s_waitcnt lgkmcnt(4)
  v_perm_b32 v248, v172, v96, s58
  v_perm_b32 v252, v172, v96, s59
  v_mfma_f32_16x16x32_bf16 v[84:87], a[136:139], v[132:135], v[84:87]
  v_perm_b32 v249, v173, v97, s58
  v_perm_b32 v253, v173, v97, s59
  v_mfma_f32_16x16x32_bf16 v[88:91], a[140:143], v[132:135], 0
  s_waitcnt lgkmcnt(0)
  v_perm_b32 v250, v174, v98, s58
  v_perm_b32 v254, v174, v98, s59
  v_mfma_f32_16x16x32_bf16 v[88:91], a[128:131], v[152:155], v[88:91]
  v_perm_b32 v251, v175, v99, s58
  v_perm_b32 v255, v175, v99, s59
  v_mfma_f32_16x16x32_bf16 v[88:91], a[116:119], v[116:119], v[88:91]
  v_cvt_pk_bf16_f32 v146, v84, v85
  v_cvt_pk_bf16_f32 v147, v86, v87
  v_mfma_f32_16x16x32_bf16 v[88:91], a[104:107], v[160:163], v[88:91]
  s_add_u32 m0, s30, 0
  v_perm_b32 v104, v80, v76, s58
  v_perm_b32 v76, v80, v76, s59
  v_mfma_f32_16x16x32_bf16 v[88:91], a[92:95], v[176:179], v[88:91]
  v_accvgpr_write_b32 a220, v76
  v_perm_b32 v105, v81, v77, s58
  v_mfma_f32_16x16x32_bf16 v[88:91], a[80:83], v[156:159], v[88:91]
  v_perm_b32 v77, v81, v77, s59
  v_accvgpr_write_b32 a221, v77
  v_mfma_f32_16x16x32_bf16 v[84:87], v[156:159], a[144:147], 0
  buffer_load_dwordx4 v6, s[8:11], s31 offen offset:0 nt lds
  v_mfma_f32_16x16x32_bf16 v[84:87], v[176:179], a[156:159], v[84:87]
  s_add_u32 m0, s30, 8064
  v_perm_b32 v106, v82, v78, s58
  v_perm_b32 v78, v82, v78, s59
  v_mfma_f32_16x16x32_bf16 v[84:87], v[160:163], a[168:171], v[84:87]
  v_cvt_pk_bf16_f32 v148, v88, v89
  v_cvt_pk_bf16_f32 v149, v90, v91
  v_mfma_f32_16x16x32_bf16 v[84:87], v[116:119], a[180:183], v[84:87]
  ds_read_b128 a[244:247], v1 offset:22528
  ds_read_b128 a[252:255], v0 offset:22528
  v_mfma_f32_16x16x32_bf16 v[84:87], v[152:155], a[192:195], v[84:87]
  buffer_load_dwordx4 v6, s[8:11], s31 offen offset:128 nt lds
  v_mfma_f32_16x16x32_bf16 v[84:87], v[132:135], a[204:207], v[84:87]
  s_add_u32 m0, s30, 16128
  ds_read_b128 v[180:183], v1 offset:14336
  ds_read_b128 v[164:167], v0 offset:14336
  v_mfma_f32_16x16x32_bf16 v[88:91], v[132:135], a[208:211], 0
  ds_read_b128 v[168:171], v1 offset:6144
  ds_read_b128 a[248:251], v0 offset:6144
  v_mfma_f32_16x16x32_bf16 v[88:91], v[152:155], a[196:199], v[88:91]
  v_accvgpr_write_b32 a222, v78
  v_perm_b32 v107, v83, v79, s58
  v_mfma_f32_16x16x32_bf16 v[88:91], v[116:119], a[184:187], v[88:91]
  buffer_load_dwordx4 v6, s[8:11], s31 offen offset:256 nt lds
  v_mfma_f32_16x16x32_bf16 v[88:91], v[160:163], a[172:175], v[88:91]
  s_add_u32 m0, s30, 4096
  v_cvt_pk_bf16_f32 v108, v84, v85
  v_cvt_pk_bf16_f32 v109, v86, v87
  v_mfma_f32_16x16x32_bf16 v[88:91], v[176:179], a[160:163], v[88:91]
  s_add_u32 s31, s31, s43
  v_perm_b32 v79, v83, v79, s59
  v_accvgpr_write_b32 a223, v79
  v_mfma_f32_16x16x32_bf16 v[88:91], v[156:159], a[148:151], v[88:91]
  ds_read2st64_b32 v[96:97], v69 offset0:16 offset1:18
  ds_read2st64_b32 v[172:173], v68 offset0:16 offset1:18
  v_mfma_f32_16x16x32_bf16 v[84:87], v[156:159], a[152:155], 0
  buffer_load_dwordx4 v6, s[8:11], s32 offen offset:0 nt lds
  v_mfma_f32_16x16x32_bf16 v[84:87], v[176:179], a[164:167], v[84:87]
  s_add_u32 m0, s30, 12160
  ds_read2st64_b32 v[98:99], v69 offset0:20 offset1:22
  ds_read2st64_b32 v[174:175], v68 offset0:20 offset1:22
  v_mfma_f32_16x16x32_bf16 v[84:87], v[160:163], a[176:179], v[84:87]
  v_cvt_pk_bf16_f32 v112, v88, v89
  v_cvt_pk_bf16_f32 v113, v90, v91
  v_mfma_f32_16x16x32_bf16 v[84:87], v[116:119], a[188:191], v[84:87]
  s_waitcnt lgkmcnt(2)
  ds_read2st64_b32 v[76:77], v54 offset0:16 offset1:18
  ds_read2st64_b32 v[80:81], v55 offset0:16 offset1:18
  v_mfma_f32_16x16x32_bf16 v[84:87], v[152:155], a[200:203], v[84:87]
  buffer_load_dwordx4 v6, s[8:11], s32 offen offset:128 nt lds
  v_mfma_f32_16x16x32_bf16 v[84:87], v[132:135], a[212:215], v[84:87]
  s_add_u32 m0, s30, 20224
  ds_read2st64_b32 v[78:79], v54 offset0:20 offset1:22
  ds_read2st64_b32 v[82:83], v55 offset0:20 offset1:22
  v_mfma_f32_16x16x32_bf16 v[68:71], a[132:135], a[244:247], 0
  s_waitcnt lgkmcnt(4)
  v_accvgpr_write_b32 a216, v104
  v_accvgpr_write_b32 a217, v105
  v_mfma_f32_16x16x32_bf16 v[68:71], a[120:123], a[252:255], v[68:71]
  s_mov_b32 s30, s5
  v_accvgpr_write_b32 a218, v106
  v_accvgpr_write_b32 a219, v107
  v_mfma_f32_16x16x32_bf16 v[68:71], a[108:111], v[180:183], v[68:71]
  buffer_load_dwordx4 v6, s[8:11], s32 offen offset:256 nt lds
  v_mfma_f32_16x16x32_bf16 v[68:71], a[96:99], v[164:167], v[68:71]
  s_add_u32 s32, s32, s43
  v_cvt_pk_bf16_f32 v116, v84, v85
  v_cvt_pk_bf16_f32 v117, v86, v87
  v_mfma_f32_16x16x32_bf16 v[68:71], a[84:87], v[168:171], v[68:71]
  s_waitcnt lgkmcnt(0)
  v_perm_b32 v54, v172, v96, s58
  v_perm_b32 v96, v172, v96, s59
  v_mfma_f32_16x16x32_bf16 v[68:71], a[72:75], a[248:251], v[68:71]
  v_accvgpr_write_b32 a224, v54
  v_accvgpr_write_b32 a228, v96
  v_mfma_f32_16x16x32_bf16 v[84:87], a[76:79], a[248:251], 0
  v_perm_b32 v55, v173, v97, s58
  v_perm_b32 v97, v173, v97, s59
  v_mfma_f32_16x16x32_bf16 v[84:87], a[88:91], v[168:171], v[84:87]
  v_accvgpr_write_b32 a225, v55
  v_accvgpr_write_b32 a229, v97
  v_mfma_f32_16x16x32_bf16 v[84:87], a[100:103], v[164:167], v[84:87]
  v_cvt_pk_bf16_f32 v150, v68, v69
  v_cvt_pk_bf16_f32 v151, v70, v71
  v_mfma_f32_16x16x32_bf16 v[84:87], a[112:115], v[180:183], v[84:87]
  v_perm_b32 v54, v174, v98, s58
  v_perm_b32 v98, v174, v98, s59
  v_mfma_f32_16x16x32_bf16 v[84:87], a[124:127], a[252:255], v[84:87]
  v_accvgpr_write_b32 a226, v54
  v_accvgpr_write_b32 a230, v98
  v_mfma_f32_16x16x32_bf16 v[84:87], a[136:139], a[244:247], v[84:87]
  v_perm_b32 v55, v175, v99, s58
  v_perm_b32 v99, v175, v99, s59
  v_mfma_f32_16x16x32_bf16 v[68:71], a[140:143], a[244:247], 0
  v_accvgpr_write_b32 a227, v55
  v_accvgpr_write_b32 a231, v99
  v_mfma_f32_16x16x32_bf16 v[68:71], a[128:131], a[252:255], v[68:71]
  v_perm_b32 v54, v80, v76, s58
  v_perm_b32 v76, v80, v76, s59
  v_mfma_f32_16x16x32_bf16 v[68:71], a[116:119], v[180:183], v[68:71]
  v_cvt_pk_bf16_f32 v152, v84, v85
  v_cvt_pk_bf16_f32 v153, v86, v87
  v_mfma_f32_16x16x32_bf16 v[68:71], a[104:107], v[164:167], v[68:71]
  v_accvgpr_write_b32 a232, v54
  v_accvgpr_write_b32 a236, v76
  v_mfma_f32_16x16x32_bf16 v[68:71], a[92:95], v[168:171], v[68:71]
  v_perm_b32 v55, v81, v77, s58
  v_perm_b32 v77, v81, v77, s59
  v_mfma_f32_16x16x32_bf16 v[68:71], a[80:83], a[248:251], v[68:71]
  v_accvgpr_write_b32 a233, v55
  v_accvgpr_write_b32 a237, v77
  v_mfma_f32_16x16x32_bf16 v[92:95], v[122:125], v[72:75], v[36:39]
  v_perm_b32 v54, v82, v78, s58
  v_perm_b32 v78, v82, v78, s59
  v_mfma_f32_16x16x32_bf16 v[92:95], v[120:123], v[12:15], v[92:95]
  v_accvgpr_write_b32 a234, v54
  v_accvgpr_write_b32 a238, v78
  v_mfma_f32_16x16x32_bf16 v[96:99], v[138:141], v[72:75], v[32:35]
  v_perm_b32 v55, v83, v79, s58
  v_perm_b32 v79, v83, v79, s59
  v_mfma_f32_16x16x32_bf16 v[96:99], v[136:139], v[12:15], v[96:99]
  v_accvgpr_write_b32 a235, v55
  v_accvgpr_write_b32 a239, v79
  v_mfma_f32_16x16x32_bf16 v[104:107], v[146:149], v[72:75], v[28:31]
  v_cvt_pk_bf16_f32 v154, v68, v69
  v_cvt_pk_bf16_f32 v155, v70, v71
  v_mfma_f32_16x16x32_bf16 v[104:107], v[144:147], v[12:15], v[104:107]
  v_exp_f32 v92, v92
  v_mfma_f32_16x16x32_bf16 v[132:135], v[152:155], v[72:75], v[24:27]
  s_lshr_b32 s44, s2, 3
  v_exp_f32 v93, v93
  v_mfma_f32_16x16x32_bf16 v[132:135], v[150:153], v[12:15], v[132:135]
  s_lshl_b32 s44, s44, 9
  v_exp_f32 v94, v94
  v_mfma_f32_16x16x32_bf16 v[84:87], v[120:123], v[128:131], v[40:43]
  s_add_u32 s44, s44, 1048576
  v_exp_f32 v95, v95
  v_mfma_f32_16x16x32_bf16 v[84:87], v[122:125], v[14:17], v[84:87]
  s_mov_b32 s45, 0
  v_exp_f32 v96, v96
  v_mfma_f32_16x16x32_bf16 v[88:91], v[136:139], v[128:131], v[36:39]
  s_mov_b32 s59, 1
  v_exp_f32 v97, v97
  v_mfma_f32_16x16x32_bf16 v[88:91], v[138:141], v[14:17], v[88:91]
  s_mov_b32 s58, 0
  v_exp_f32 v98, v98
  v_mfma_f32_16x16x32_bf16 v[172:175], v[144:147], v[128:131], v[32:35]
  s_mov_b64 s[12:13], 0
  v_exp_f32 v99, v99
  v_mfma_f32_16x16x32_bf16 v[172:175], v[146:149], v[14:17], v[172:175]
  s_mov_b64 s[16:17], 0
  v_exp_f32 v104, v104
  v_mfma_f32_16x16x32_bf16 v[68:71], v[150:153], v[128:131], v[28:31]
  s_mov_b64 s[18:19], 0
  v_exp_f32 v105, v105
  v_mfma_f32_16x16x32_bf16 v[68:71], v[152:155], v[14:17], v[68:71]
  s_mov_b64 s[60:61], 0
  v_exp_f32 v106, v106
  v_mfma_f32_16x16x32_bf16 v[76:79], v[146:149], v[100:103], v[36:39]
  s_mov_b32 s15, 0
  v_exp_f32 v107, v107
  v_mfma_f32_16x16x32_bf16 v[76:79], v[144:147], v[18:21], v[76:79]
  s_mov_b32 s99, 0
  v_exp_f32 v132, v132
  v_mfma_f32_16x16x32_bf16 v[80:83], v[152:155], v[100:103], v[32:35]
  s_mov_b64 s[100:101], 0
  v_exp_f32 v133, v133
  v_mfma_f32_16x16x32_bf16 v[80:83], v[150:153], v[18:21], v[80:83]
  s_mov_b32 s14, 0
  v_exp_f32 v134, v134
  v_mfma_f32_16x16x32_bf16 v[160:163], v[122:125], v[100:103], v[44:47]
  s_mov_b32 s7, s22
  v_exp_f32 v135, v135
  v_mfma_f32_16x16x32_bf16 v[160:163], v[120:123], v[18:21], v[160:163]
  v_cvt_pk_bf16_f32 v92, v92, v93
  v_cvt_pk_bf16_f32 v93, v94, v95
  v_mfma_f32_16x16x32_bf16 v[156:159], v[138:141], v[100:103], v[40:43]
  v_cvt_pk_bf16_f32 v94, v96, v97
  v_cvt_pk_bf16_f32 v95, v98, v99
  v_mfma_f32_16x16x32_bf16 v[156:159], v[136:139], v[18:21], v[156:159]
  v_cvt_pk_bf16_f32 v96, v104, v105
  v_cvt_pk_bf16_f32 v97, v106, v107
  v_mfma_f32_16x16x32_bf16 v[128:131], a[0:3], a[248:251], 0
  v_cvt_pk_bf16_f32 v98, v132, v133
  v_cvt_pk_bf16_f32 v99, v134, v135
  v_mfma_f32_16x16x32_bf16 v[128:131], a[12:15], v[168:171], v[128:131]
  v_exp_f32 v84, v84
  v_mfma_f32_16x16x32_bf16 v[128:131], a[24:27], v[164:167], v[128:131]
  v_exp_f32 v85, v85
  v_mfma_f32_16x16x32_bf16 v[128:131], a[36:39], v[180:183], v[128:131]
  v_exp_f32 v86, v86
  v_mfma_f32_16x16x32_bf16 v[128:131], a[48:51], a[252:255], v[128:131]
  v_exp_f32 v87, v87
  v_mfma_f32_16x16x32_bf16 v[128:131], a[60:63], a[244:247], v[128:131]
  v_exp_f32 v88, v88
  v_mfma_f32_16x16x32_bf16 v[100:103], a[64:67], a[244:247], 0
  v_exp_f32 v89, v89
  v_mfma_f32_16x16x32_bf16 v[100:103], a[52:55], a[252:255], v[100:103]
  v_exp_f32 v90, v90
  v_mfma_f32_16x16x32_bf16 v[100:103], a[40:43], v[180:183], v[100:103]
  v_exp_f32 v91, v91
  v_mfma_f32_16x16x32_bf16 v[100:103], a[28:31], v[164:167], v[100:103]
  v_mul_f32 v128, s42, v128
  v_mul_f32 v129, s42, v129
  v_mfma_f32_16x16x32_bf16 v[100:103], a[16:19], v[168:171], v[100:103]
  v_mul_f32 v130, s42, v130
  v_mul_f32 v131, s42, v131
  v_mfma_f32_16x16x32_bf16 v[100:103], a[4:7], a[248:251], v[100:103]
  v_cvt_pk_bf16_f32 v72, v128, v129
  v_cvt_pk_bf16_f32 v73, v130, v131
  v_mfma_f32_16x16x32_bf16 v[104:107], a[8:11], a[248:251], 0
  v_exp_f32 v172, v172
  v_mfma_f32_16x16x32_bf16 v[104:107], a[20:23], v[168:171], v[104:107]
  v_exp_f32 v173, v173
  v_mfma_f32_16x16x32_bf16 v[104:107], a[32:35], v[164:167], v[104:107]
  v_exp_f32 v174, v174
  v_mfma_f32_16x16x32_bf16 v[104:107], a[44:47], v[180:183], v[104:107]
  v_mul_f32 v100, s42, v100
  v_mul_f32 v101, s42, v101
  v_mfma_f32_16x16x32_bf16 v[104:107], a[56:59], a[252:255], v[104:107]
  v_mul_f32 v102, s42, v102
  v_mul_f32 v103, s42, v103
  v_mfma_f32_16x16x32_bf16 v[104:107], a[68:71], a[244:247], v[104:107]
  v_cvt_pk_bf16_f32 v74, v100, v101
  v_cvt_pk_bf16_f32 v75, v102, v103
  v_mfma_f32_16x16x32_bf16 v[128:131], a[248:251], a[144:147], 0
  v_exp_f32 v175, v175
  v_mfma_f32_16x16x32_bf16 v[128:131], v[168:171], a[156:159], v[128:131]
  v_exp_f32 v68, v68
  v_mfma_f32_16x16x32_bf16 v[128:131], v[164:167], a[168:171], v[128:131]
  v_mul_f32 v104, s42, v104
  v_mul_f32 v105, s42, v105
  v_mfma_f32_16x16x32_bf16 v[128:131], v[180:183], a[180:183], v[128:131]
  v_mul_f32 v106, s42, v106
  v_mul_f32 v107, s42, v107
  v_cvt_pk_bf16_f32 v22, v104, v105
  v_cvt_pk_bf16_f32 v23, v106, v107
  v_mfma_f32_16x16x32_bf16 v[128:131], a[252:255], a[192:195], v[128:131]
  s_waitcnt vmcnt(6) lgkmcnt(0)
  s_barrier
  v_mfma_f32_16x16x32_bf16 v[128:131], a[244:247], a[204:207], v[128:131]
  v_exp_f32 v69, v69
  v_mfma_f32_16x16x32_bf16 v[100:103], v[144:147], v[72:75], v[40:43]
  v_exp_f32 v70, v70
  v_mfma_f32_16x16x32_bf16 v[100:103], v[146:149], v[20:23], v[100:103]
  v_exp_f32 v71, v71
  v_mfma_f32_16x16x32_bf16 v[104:107], v[150:153], v[72:75], v[36:39]
  v_cvt_pk_bf16_f32 v84, v84, v85
  v_cvt_pk_bf16_f32 v85, v86, v87
  v_mfma_f32_16x16x32_bf16 v[104:107], v[152:155], v[20:23], v[104:107]
  v_cvt_pk_bf16_f32 v110, v128, v129
  v_cvt_pk_bf16_f32 v111, v130, v131
  v_mfma_f32_16x16x32_bf16 v[132:135], v[120:123], v[72:75], v[48:51]
  v_cvt_pk_bf16_f32 v86, v88, v89
  v_cvt_pk_bf16_f32 v87, v90, v91
  v_mfma_f32_16x16x32_bf16 v[132:135], v[122:125], v[20:23], v[132:135]
  v_cvt_pk_bf16_f32 v88, v172, v173
  v_cvt_pk_bf16_f32 v89, v174, v175
  v_mfma_f32_16x16x32_bf16 v[128:131], v[136:139], v[72:75], v[44:47]
  v_cvt_pk_bf16_f32 v90, v68, v69
  v_cvt_pk_bf16_f32 v91, v70, v71
  v_mfma_f32_16x16x32_bf16 v[128:131], v[138:141], v[20:23], v[128:131]
  v_exp_f32 v76, v76
  v_mfma_f32_16x16x32_bf16 v[144:147], a[244:247], a[208:211], 0
  ds_read_b128 v[172:175], v3 offset:0
  ds_read_b128 v[136:139], v3 offset:4096
  v_mfma_f32_16x16x32_bf16 v[144:147], a[252:255], a[196:199], v[144:147]
  ds_read_b128 v[140:143], v3 offset:8192
  ds_read_b128 v[68:71], v3 offset:12288
  v_mfma_f32_16x16x32_bf16 v[144:147], v[180:183], a[184:187], v[144:147]
  ds_read_b128 v[72:75], v3 offset:16384
  ds_read_b128 v[120:123], v3 offset:20480
  v_mfma_f32_16x16x32_bf16 v[144:147], v[164:167], a[172:175], v[144:147]
  v_exp_f32 v77, v77
  v_mfma_f32_16x16x32_bf16 v[144:147], v[168:171], a[160:163], v[144:147]
  v_exp_f32 v78, v78
  v_mfma_f32_16x16x32_bf16 v[144:147], a[248:251], a[148:151], v[144:147]
  v_exp_f32 v79, v79
  v_mfma_f32_16x16x32_bf16 v[124:127], a[248:251], a[152:155], 0
  v_exp_f32 v80, v80
  v_mfma_f32_16x16x32_bf16 v[124:127], v[168:171], a[164:167], v[124:127]
  v_exp_f32 v81, v81
  v_mfma_f32_16x16x32_bf16 v[124:127], v[164:167], a[176:179], v[124:127]
  v_exp_f32 v82, v82
  v_mfma_f32_16x16x32_bf16 v[124:127], v[180:183], a[188:191], v[124:127]
  v_exp_f32 v83, v83
  v_mfma_f32_16x16x32_bf16 v[124:127], a[252:255], a[200:203], v[124:127]
  v_exp_f32 v160, v160
  v_mfma_f32_16x16x32_bf16 v[124:127], a[244:247], a[212:215], v[124:127]
  v_cvt_pk_bf16_f32 v114, v144, v145
  v_cvt_pk_bf16_f32 v115, v146, v147
  v_add_u32 v0, s28, v2
  v_xor_b32 v1, 64, v0
  s_waitcnt lgkmcnt(0)
  s_branch L_mid
  s_nop 0
  s_nop 0
  s_nop 0
  s_nop 0
  s_nop 0
  s_nop 0
  s_nop 0
  s_nop 0
  s_nop 0
  s_nop 0
  s_nop 0
  s_nop 0
  s_nop 0
  s_nop 0
  s_nop 0
  s_nop 0
  s_nop 0
  s_nop 0
  s_nop 0
  s_nop 0
  s_nop 0
  s_nop 0
  s_nop 0
  s_nop 0
  s_nop 0
  s_nop 0
  s_nop 0
  s_nop 0
  s_nop 0
  s_nop 0
  s_nop 0
  s_nop 0
  s_nop 0
  s_nop 0
  s_nop 0
  s_nop 0
  s_nop 0
  s_nop 0
  s_nop 0
  s_nop 0
  s_nop 0
  s_nop 0
  s_nop 0
  s_nop 0
  s_nop 0
  s_nop 0
  s_nop 0
  s_nop 0
  s_nop 0
  s_nop 0
  s_nop 0
  s_nop 0
  s_nop 0
  s_nop 0
  s_nop 0
  s_nop 0
  s_nop 0
  s_nop 0
  s_nop 0
  s_nop 0
  s_nop 0
  s_nop 0
  s_nop 0
  s_nop 0
  s_nop 0
  s_nop 0
  s_nop 0
  s_nop 0
  s_nop 0
  s_nop 0
  s_nop 0
  s_nop 0
  s_nop 0
  s_nop 0
  s_nop 0
  s_nop 0
  s_nop 0
  s_nop 0
  s_nop 0
  s_nop 0
  s_nop 0
  s_nop 0
  s_nop 0
  s_nop 0
  s_nop 0
  s_nop 0
  s_nop 0
  s_nop 0
  s_nop 0
  s_nop 0
  s_nop 0
  s_nop 0
  s_nop 0
  s_nop 0
  s_nop 0
  s_nop 0
  s_nop 0
  s_nop 0
  s_nop 0
  s_nop 0
  s_nop 0
  s_nop 0
  s_nop 0
  s_nop 0
  s_nop 0
  s_nop 0
  s_nop 0
  s_nop 0
  s_nop 0
  s_nop 0
  s_nop 0
  s_nop 0
  s_nop 0
  s_nop 0
  s_nop 0
  s_nop 0
  s_nop 0
  s_nop 0
  s_nop 0
  s_nop 0
  s_nop 0
  s_nop 0
  s_nop 0
  s_nop 0
  s_nop 0
  s_nop 0
  s_nop 0
  s_nop 0
  s_nop 0
  s_nop 0
  s_nop 0
  s_nop 0
  s_nop 0
  s_nop 0
  s_nop 0
  s_nop 0
  s_nop 0
  s_nop 0
  s_nop 0
  s_nop 0
  s_nop 0
  s_nop 0
  s_nop 0
  s_nop 0
  s_nop 0
  s_nop 0
  s_nop 0
  s_nop 0
  s_nop 0
  s_nop 0
  s_nop 0
  s_nop 0
  s_nop 0
  s_nop 0
  s_nop 0
  s_nop 0
  s_nop 0
  s_nop 0
  s_nop 0
  s_nop 0
  s_nop 0
  s_nop 0
  s_nop 0
  s_nop 0
  s_nop 0
  s_nop 0
  s_nop 0
  s_nop 0
  s_nop 0
  s_nop 0
  s_nop 0
  s_nop 0
  s_nop 0
  s_nop 0
  s_nop 0
  s_nop 0
  s_nop 0
  s_nop 0
  s_nop 0
  s_nop 0
  s_nop 0
  s_nop 0
  s_nop 0
  s_nop 0
  s_nop 0
  s_nop 0
  s_nop 0
  s_nop 0
  s_nop 0
  s_nop 0
  s_nop 0
  s_nop 0
  s_nop 0
  s_nop 0
  s_nop 0
  s_nop 0
  s_nop 0
  s_nop 0
  s_nop 0
  s_nop 0
  s_nop 0
  s_nop 0
  s_nop 0
  s_nop 0
  s_nop 0
  s_nop 0
  s_nop 0
  s_nop 0
  s_nop 0
  s_nop 0
  s_nop 0
  s_nop 0
  s_nop 0
  s_nop 0
  s_nop 0
  s_nop 0
  s_nop 0
  s_nop 0
  s_nop 0
  s_nop 0
  s_nop 0
  s_nop 0
  s_nop 0
  s_nop 0
  s_nop 0
  s_nop 0
  s_nop 0
  s_nop 0
  s_nop 0
  s_nop 0
  s_nop 0
  s_nop 0
  s_nop 0
  s_nop 0
  s_nop 0
  s_nop 0
  s_nop 0
  s_nop 0
  s_nop 0
  s_nop 0
  s_nop 0
  s_nop 0
  s_nop 0
  s_nop 0
  s_nop 0
  s_nop 0
  s_nop 0
  s_nop 0
  s_nop 0
  s_nop 0
  s_nop 0
  s_nop 0
  s_nop 0
  s_nop 0
  s_nop 0
  s_nop 0
  s_nop 0
  s_nop 0
  s_nop 0
  s_nop 0
  s_nop 0
  s_nop 0
  s_nop 0
  s_nop 0
  s_nop 0
  s_nop 0
  s_nop 0
  s_nop 0
  s_nop 0
  s_nop 0
  s_nop 0
  s_nop 0
  s_nop 0
  s_nop 0
  s_nop 0
  s_nop 0
  s_nop 0
  s_nop 0
  s_nop 0
  s_nop 0
  s_nop 0
  s_nop 0
  s_nop 0
  s_nop 0
  s_nop 0
  s_nop 0
  s_nop 0
  s_nop 0
  s_nop 0
  s_nop 0
  s_nop 0
  s_nop 0
  s_nop 0
  s_nop 0
  s_nop 0
  s_nop 0
  s_nop 0
  s_nop 0
  s_nop 0
  s_nop 0
  s_nop 0
  s_nop 0
  s_nop 0
  s_nop 0
  s_nop 0
  s_nop 0
  s_nop 0
  s_nop 0
  s_nop 0
  s_nop 0
  s_nop 0
  s_nop 0
  s_nop 0
  s_nop 0
  s_nop 0
  s_nop 0
  s_nop 0
  s_nop 0
  s_nop 0
  s_nop 0
  s_nop 0
  s_nop 0
  s_nop 0
  s_nop 0
  s_nop 0
  s_nop 0
  s_nop 0
  s_nop 0
  s_nop 0
  s_nop 0
  s_nop 0
  s_nop 0
  s_nop 0
  s_nop 0
  s_nop 0
  s_nop 0
  s_nop 0
  s_nop 0
  s_nop 0
  s_nop 0
  s_nop 0
  s_nop 0
  s_nop 0
  s_nop 0
  s_nop 0
  s_nop 0
  s_nop 0
  s_nop 0
  s_nop 0
  s_nop 0
  s_nop 0
  s_nop 0
  s_nop 0
  s_nop 0
  s_nop 0
  s_nop 0
  s_nop 0
  s_nop 0
  s_nop 0
  s_nop 0
  s_nop 0
  s_nop 0
  s_nop 0
  s_nop 0
  s_nop 0
  s_nop 0
  s_nop 0
  s_nop 0
  s_nop 0
  s_nop 0
  s_nop 0
  s_nop 0
  s_nop 0
  s_nop 0
  s_nop 0
  s_nop 0
  s_nop 0
  s_nop 0
  s_nop 0
  s_nop 0
  s_nop 0
  s_nop 0
  s_nop 0
  s_nop 0
  s_nop 0
  s_nop 0
  s_nop 0
  s_nop 0
  s_nop 0
  s_nop 0
  s_nop 0
  s_nop 0
  s_nop 0
  s_nop 0
  s_nop 0
  s_nop 0
  s_nop 0
  s_nop 0
  s_nop 0
  s_nop 0
  s_nop 0
  s_nop 0
  s_nop 0
  s_nop 0
  s_nop 0
  s_nop 0
  s_nop 0
  s_nop 0
  s_nop 0
  s_nop 0
  s_nop 0
  s_nop 0
  s_nop 0
  s_nop 0
  s_nop 0
  s_nop 0
  s_nop 0
  s_nop 0
  s_nop 0
  s_nop 0
  s_nop 0
  s_nop 0
  s_nop 0
  s_nop 0
  s_nop 0
  s_nop 0
  s_nop 0
  s_nop 0
  s_nop 0
  s_nop 0
  s_nop 0
  s_nop 0
  s_nop 0
  s_nop 0
  s_nop 0
  s_nop 0
  s_nop 0
  s_nop 0
  s_nop 0
  s_nop 0
  s_nop 0
  s_nop 0
  s_nop 0
  s_nop 0
  s_nop 0
  s_nop 0
  s_nop 0
  s_nop 0
  s_nop 0
  s_nop 0
  s_nop 0
  s_nop 0
  s_nop 0
  s_nop 0
  s_nop 0
  s_nop 0
  s_nop 0
  s_nop 0
  s_nop 0
  s_nop 0
  s_nop 0
  s_nop 0
  s_nop 0
  s_nop 0
  s_nop 0
  s_nop 0
  s_nop 0
  s_nop 0
  s_nop 0
  s_nop 0
  s_nop 0
  s_nop 0
  s_nop 0
  s_nop 0
  s_nop 0
  s_nop 0
  s_nop 0
  s_nop 0
  s_nop 0
  s_nop 0
  s_nop 0
  s_nop 0
  s_nop 0
  s_nop 0
  s_nop 0
  s_nop 0
  s_nop 0
  s_nop 0
  s_nop 0
  s_nop 0
  s_nop 0
  s_nop 0
  s_nop 0
  s_nop 0
  s_nop 0
  s_nop 0
  s_nop 0
  s_nop 0
  s_nop 0
  s_nop 0
  s_nop 0
  s_nop 0
  s_nop 0
  s_nop 0
  s_nop 0
  s_nop 0
  s_nop 0
  s_nop 0
  s_nop 0
  s_nop 0
  s_nop 0
  s_nop 0
  s_nop 0
  s_nop 0
  s_nop 0
  s_nop 0
  s_nop 0
  s_nop 0
  s_nop 0
  s_nop 0
  s_nop 0
  s_nop 0
  s_nop 0
  s_nop 0
  s_nop 0
  s_nop 0
  s_nop 0
  s_nop 0
  s_nop 0
  s_nop 0
  s_nop 0
  s_nop 0
  s_nop 0
  s_nop 0
  s_nop 0
  s_nop 0
  s_nop 0
  s_nop 0
  s_nop 0
  s_nop 0
  s_nop 0
  s_nop 0
  s_nop 0
  s_nop 0
  s_nop 0
  s_nop 0
  s_nop 0
  s_nop 0
  s_nop 0
  s_nop 0
  s_nop 0
  s_nop 0
  s_nop 0
  s_nop 0
  s_nop 0
  s_nop 0
  s_nop 0
  s_nop 0
  s_nop 0
  s_nop 0
  s_nop 0
  s_nop 0
  s_nop 0
  s_nop 0
  s_nop 0
  s_nop 0
  s_nop 0
  s_nop 0
  s_nop 0
  s_nop 0
  s_nop 0
  s_nop 0
  s_nop 0
  s_nop 0
  s_nop 0
  s_nop 0
  s_nop 0
  s_nop 0
  s_nop 0
  s_nop 0
  s_nop 0
  s_nop 0
  s_nop 0
  s_nop 0
  s_nop 0
  s_nop 0
  s_nop 0
  s_nop 0
  s_nop 0
  s_nop 0
  s_nop 0
  s_nop 0
  s_nop 0
  s_nop 0
  s_nop 0
  s_nop 0
  s_nop 0
  s_nop 0
  s_nop 0
  s_nop 0
  s_nop 0
  s_nop 0
  s_nop 0
  s_nop 0
  s_nop 0
  s_nop 0
  s_nop 0
  s_nop 0
  s_nop 0
  s_nop 0
  s_nop 0
  s_nop 0
  s_nop 0
  s_nop 0
  s_nop 0
  s_nop 0
  s_nop 0
  s_nop 0
  s_nop 0
  s_nop 0
  s_nop 0
  s_nop 0
  s_nop 0
  s_nop 0
  s_nop 0
  s_nop 0
  s_nop 0
  s_nop 0
  s_nop 0
  s_nop 0
  s_nop 0
  s_nop 0
  s_nop 0
  s_nop 0
  s_nop 0
  s_nop 0
  s_nop 0
  s_nop 0
  s_nop 0
  s_nop 0
  s_nop 0
  s_nop 0
  s_nop 0
  s_nop 0
  s_nop 0
  s_nop 0
  s_nop 0
  s_nop 0
  s_nop 0
  s_nop 0
  s_nop 0
  s_nop 0
  s_nop 0
  s_nop 0
  s_nop 0
  s_nop 0
  s_nop 0
  s_nop 0
  s_nop 0
  s_nop 0
  s_nop 0
  s_nop 0
  s_nop 0
  s_nop 0
  s_nop 0
  s_nop 0
  s_nop 0
  s_nop 0
  s_nop 0
  s_nop 0
  s_nop 0
  s_nop 0
  s_nop 0
  s_nop 0
  s_nop 0
  s_nop 0
  s_nop 0
  s_nop 0
  s_nop 0
  s_nop 0
  s_nop 0
  s_nop 0
  s_nop 0
  s_nop 0
  s_nop 0
  s_nop 0
  s_nop 0
  s_nop 0
  s_nop 0
  s_nop 0
  s_nop 0
  s_nop 0
  s_nop 0
  s_nop 0
  s_nop 0
  s_nop 0
  s_nop 0
  s_nop 0
  s_nop 0
  s_nop 0
  s_nop 0
  s_nop 0
  s_nop 0
  s_nop 0
  s_nop 0
  s_nop 0
  s_nop 0
  s_nop 0
  s_nop 0
  s_nop 0
  s_nop 0
  s_nop 0
  s_nop 0
  s_nop 0
  s_nop 0
  s_nop 0
  s_nop 0
  s_nop 0
  s_nop 0
  s_nop 0
  s_nop 0
  s_nop 0
  s_nop 0
  s_nop 0
  s_nop 0
  s_nop 0
  s_nop 0
  s_nop 0
  s_nop 0
  s_nop 0
  s_nop 0
  s_nop 0
  s_nop 0
  s_nop 0
  s_nop 0
  s_nop 0
  s_nop 0
  s_nop 0
  s_nop 0
  s_nop 0
  s_nop 0
  s_nop 0
  s_nop 0
  s_nop 0
  s_nop 0
  s_nop 0
  s_nop 0
  s_nop 0
  s_nop 0
  s_nop 0
  s_nop 0
  s_nop 0
  s_nop 0
  s_nop 0
  s_nop 0
  s_nop 0
  s_nop 0
  s_nop 0
  s_nop 0
  s_nop 0
  s_nop 0
  s_nop 0
  s_nop 0
  s_nop 0
  s_nop 0
  s_nop 0
  s_nop 0
  s_nop 0
  s_nop 0
  s_nop 0
  s_nop 0
  s_nop 0
  s_nop 0
  s_nop 0
  s_nop 0
  s_nop 0
  s_nop 0
  s_nop 0
  s_nop 0
  s_nop 0
  s_nop 0
  s_nop 0
  s_nop 0
  s_nop 0
  s_nop 0
  s_nop 0
  s_nop 0
  s_nop 0
  s_nop 0
  s_nop 0
  s_nop 0
  s_nop 0
  s_nop 0
  s_nop 0
  s_nop 0
  s_nop 0
  s_nop 0
  s_nop 0
  s_nop 0
  s_nop 0
  s_nop 0
  s_nop 0
  s_nop 0
  s_nop 0
  s_nop 0
  s_nop 0
  s_nop 0
  s_nop 0
  s_nop 0
  s_nop 0
  s_nop 0
  s_nop 0
  s_nop 0
  s_nop 0
  s_nop 0
  s_nop 0
  s_nop 0
  s_nop 0
  s_nop 0
  s_nop 0
  s_nop 0
  s_nop 0
  s_nop 0
  s_nop 0
  s_nop 0
  s_nop 0
  s_nop 0
  s_nop 0
  s_nop 0
  s_nop 0
  s_nop 0
  s_nop 0
  s_nop 0
  s_nop 0
  s_nop 0
  s_nop 0
  s_nop 0
  s_nop 0
  s_nop 0
  s_nop 0
  s_nop 0
  s_nop 0
  s_nop 0
  s_nop 0
  s_nop 0
  s_nop 0
  s_nop 0
  s_nop 0
  s_nop 0
  s_nop 0
  s_nop 0
  s_nop 0
  s_nop 0
  s_nop 0
  s_nop 0
  s_nop 0
  s_nop 0
  s_nop 0
  s_nop 0
  s_nop 0
  s_nop 0
  s_nop 0
  s_nop 0
  s_nop 0
  s_nop 0
  s_nop 0
  s_nop 0
  s_nop 0
  s_nop 0
  s_nop 0
  s_nop 0
  s_nop 0
  s_nop 0
  s_nop 0
  s_nop 0
  s_nop 0
  s_nop 0
  s_nop 0
L_hop_3_0:
  s_cbranch_execz L_hop_3_1
L_pad2121:
L_loop:
  v_mfma_f32_16x16x32_bf16 v[104:107], a[0:3], v[88:91], 0
L_r208:
  v_mfma_f32_16x16x32_bf16 v[104:107], a[12:15], v[92:95], v[104:107]
L_r209:
  v_mfma_f32_16x16x32_bf16 v[104:107], a[24:27], v[96:99], v[104:107]
  v_cvt_pk_bf16_f32 v66, v128, v129
  v_cvt_pk_bf16_f32 v67, v130, v131
L_r210:
  v_mfma_f32_16x16x32_bf16 v[104:107], a[36:39], v[136:139], v[104:107]
L_r211:
  v_mfma_f32_16x16x32_bf16 v[104:107], a[48:51], v[140:143], v[104:107]
  s_waitcnt lgkmcnt(0)
L_r212:
  v_mfma_f32_16x16x32_bf16 v[104:107], a[60:63], v[80:83], v[104:107]
L_r213:
  v_mfma_f32_16x16x32_bf16 v[84:87], a[64:67], v[80:83], 0
L_r214:
  v_mfma_f32_16x16x32_bf16 v[84:87], a[52:55], v[140:143], v[84:87]
L_r215:
  v_mfma_f32_16x16x32_bf16 v[84:87], a[40:43], v[136:139], v[84:87]
  v_mul_f32 v104, s42, v104
  v_mul_f32 v105, s42, v105
L_r216:
  v_mfma_f32_16x16x32_bf16 v[84:87], a[28:31], v[96:99], v[84:87]
  v_mul_f32 v106, s42, v106
  v_mul_f32 v107, s42, v107
L_r217:
  v_mfma_f32_16x16x32_bf16 v[84:87], a[16:19], v[92:95], v[84:87]
  v_cvt_pk_bf16_f32 v18, v104, v105
  v_cvt_pk_bf16_f32 v19, v106, v107
L_r218:
  v_mfma_f32_16x16x32_bf16 v[84:87], a[4:7], v[88:91], v[84:87]
L_r219:
  v_mfma_f32_16x16x32_bf16 v[108:111], a[8:11], v[88:91], 0
L_r220:
  v_mfma_f32_16x16x32_bf16 v[108:111], a[20:23], v[92:95], v[108:111]
L_r221:
  v_mfma_f32_16x16x32_bf16 v[108:111], a[32:35], v[96:99], v[108:111]
  v_mul_f32 v84, s42, v84
  v_mul_f32 v85, s42, v85
L_r222:
  v_mfma_f32_16x16x32_bf16 v[108:111], a[44:47], v[136:139], v[108:111]
  v_mul_f32 v86, s42, v86
  v_mul_f32 v87, s42, v87
L_r223:
  v_mfma_f32_16x16x32_bf16 v[108:111], a[56:59], v[140:143], v[108:111]
  v_cvt_pk_bf16_f32 v104, v84, v85
  v_cvt_pk_bf16_f32 v105, v86, v87
L_r224:
  v_mfma_f32_16x16x32_bf16 v[108:111], a[68:71], v[80:83], v[108:111]
L_r225:
  v_mfma_f32_16x16x32_bf16 v[112:115], a[132:135], v[80:83], 0
L_r226:
  v_mfma_f32_16x16x32_bf16 v[112:115], a[120:123], v[140:143], v[112:115]
L_r227:
  v_mfma_f32_16x16x32_bf16 v[112:115], a[108:111], v[136:139], v[112:115]
  v_mul_f32 v108, s42, v108
  v_mul_f32 v109, s42, v109
L_r228:
  v_mfma_f32_16x16x32_bf16 v[112:115], a[96:99], v[96:99], v[112:115]
  v_mul_f32 v110, s42, v110
  v_mul_f32 v111, s42, v111
L_r229:
  v_mfma_f32_16x16x32_bf16 v[112:115], a[84:87], v[92:95], v[112:115]
  v_cvt_pk_bf16_f32 v106, v108, v109
  v_cvt_pk_bf16_f32 v107, v110, v111
L_r230:
  v_mfma_f32_16x16x32_bf16 v[112:115], a[72:75], v[88:91], v[112:115]
L_r231:
  v_mfma_f32_16x16x32_bf16 v[84:87], a[76:79], v[88:91], 0
L_r232:
  v_mfma_f32_16x16x32_bf16 v[84:87], a[88:91], v[92:95], v[84:87]
L_r233:
  v_mfma_f32_16x16x32_bf16 v[84:87], a[100:103], v[96:99], v[84:87]
  v_cvt_pk_bf16_f32 v128, v112, v113
  v_cvt_pk_bf16_f32 v129, v114, v115
L_r234:
  v_mfma_f32_16x16x32_bf16 v[84:87], a[112:115], v[136:139], v[84:87]
L_r235:
  v_mfma_f32_16x16x32_bf16 v[84:87], a[124:127], v[140:143], v[84:87]
L_r236:
  v_mfma_f32_16x16x32_bf16 v[84:87], a[136:139], v[80:83], v[84:87]
L_r237:
  v_mfma_f32_16x16x32_bf16 v[108:111], a[140:143], v[80:83], 0
L_r238:
  v_mfma_f32_16x16x32_bf16 v[108:111], a[128:131], v[140:143], v[108:111]
L_r239:
  v_mfma_f32_16x16x32_bf16 v[108:111], a[116:119], v[136:139], v[108:111]
  v_cvt_pk_bf16_f32 v130, v84, v85
  v_cvt_pk_bf16_f32 v131, v86, v87
L_r240:
  v_mfma_f32_16x16x32_bf16 v[108:111], a[104:107], v[96:99], v[108:111]
L_r241:
  v_mfma_f32_16x16x32_bf16 v[108:111], a[92:95], v[92:95], v[108:111]
L_r242:
  v_mfma_f32_16x16x32_bf16 v[108:111], a[80:83], v[88:91], v[108:111]
L_r243:
  v_mfma_f32_16x16x32_bf16 v[84:87], v[88:91], a[144:147], 0
L_r244:
  v_mfma_f32_16x16x32_bf16 v[84:87], v[92:95], a[156:159], v[84:87]
  ds_read_b128 a[244:247], v1 offset:22528
L_r245:
  v_mfma_f32_16x16x32_bf16 v[84:87], v[96:99], a[168:171], v[84:87]
  v_cvt_pk_bf16_f32 v132, v108, v109
  v_cvt_pk_bf16_f32 v133, v110, v111
L_r246:
  v_mfma_f32_16x16x32_bf16 v[84:87], v[136:139], a[180:183], v[84:87]
  ds_read_b128 a[248:251], v0 offset:22528
L_r247:
  v_mfma_f32_16x16x32_bf16 v[84:87], v[140:143], a[192:195], v[84:87]
  ds_read_b128 a[252:255], v1 offset:14336
L_r248:
  v_mfma_f32_16x16x32_bf16 v[84:87], v[80:83], a[204:207], v[84:87]
  ds_read_b128 v[144:147], v0 offset:14336
L_r249:
  v_mfma_f32_16x16x32_bf16 v[116:119], v[80:83], a[208:211], 0
  ds_read_b128 v[148:151], v1 offset:6144
L_r250:
  v_mfma_f32_16x16x32_bf16 v[116:119], v[140:143], a[196:199], v[116:119]
  ds_read_b128 v[152:155], v0 offset:6144
L_r251:
  v_mfma_f32_16x16x32_bf16 v[116:119], v[136:139], a[184:187], v[116:119]
  v_cvt_pk_bf16_f32 v108, v84, v85
  v_cvt_pk_bf16_f32 v109, v86, v87
L_r252:
  v_mfma_f32_16x16x32_bf16 v[116:119], v[96:99], a[172:175], v[116:119]
L_r253:
  v_mfma_f32_16x16x32_bf16 v[116:119], v[92:95], a[160:163], v[116:119]
L_r254:
  v_mfma_f32_16x16x32_bf16 v[116:119], v[88:91], a[148:151], v[116:119]
L_r255:
  v_mfma_f32_16x16x32_bf16 v[156:159], v[88:91], a[152:155], 0
L_r256:
  v_mfma_f32_16x16x32_bf16 v[156:159], v[92:95], a[164:167], v[156:159]
L_r257:
  v_mfma_f32_16x16x32_bf16 v[156:159], v[96:99], a[176:179], v[156:159]
  v_cvt_pk_bf16_f32 v112, v116, v117
  v_cvt_pk_bf16_f32 v113, v118, v119
L_r258:
  v_mfma_f32_16x16x32_bf16 v[156:159], v[136:139], a[188:191], v[156:159]
L_r259:
  v_mfma_f32_16x16x32_bf16 v[156:159], v[140:143], a[200:203], v[156:159]
  buffer_load_dwordx2 v[52:53], v11, s[20:23], s7 offen sc1
  v_mfma_f32_16x16x32_bf16 v[156:159], v[80:83], a[212:215], v[156:159]
  s_waitcnt lgkmcnt(0)
  v_mfma_f32_16x16x32_bf16 v[84:87], a[132:135], a[244:247], 0
  v_mfma_f32_16x16x32_bf16 v[84:87], a[120:123], a[248:251], v[84:87]
  v_mfma_f32_16x16x32_bf16 v[84:87], a[108:111], a[252:255], v[84:87]
  v_cvt_pk_bf16_f32 v116, v156, v157
  v_cvt_pk_bf16_f32 v117, v158, v159
  v_mfma_f32_16x16x32_bf16 v[84:87], a[96:99], v[144:147], v[84:87]
  v_mfma_f32_16x16x32_bf16 v[84:87], a[84:87], v[148:151], v[84:87]
  s_waitcnt vmcnt(31)
  s_barrier
  v_mfma_f32_16x16x32_bf16 v[84:87], a[72:75], v[152:155], v[84:87]
  v_add_u32 v0, s28, v2
  v_xor_b32 v1, 64, v0
  v_mfma_f32_16x16x32_bf16 v[80:83], a[76:79], v[152:155], 0
  s_cmp_eq_u32 s59, 3
  v_mfma_f32_16x16x32_bf16 v[80:83], a[88:91], v[148:151], v[80:83]
  s_cselect_b32 s18, s16, s18
  v_mfma_f32_16x16x32_bf16 v[80:83], a[100:103], v[144:147], v[80:83]
  s_cselect_b32 s15, s60, s15
  v_cvt_pk_bf16_f32 v136, v84, v85
  v_cvt_pk_bf16_f32 v137, v86, v87
  v_mfma_f32_16x16x32_bf16 v[80:83], a[112:115], a[252:255], v[80:83]
  s_cmp_eq_u32 s59, 7
  v_mfma_f32_16x16x32_bf16 v[80:83], a[124:127], a[248:251], v[80:83]
  s_cselect_b32 s19, s16, s19
  v_mfma_f32_16x16x32_bf16 v[80:83], a[136:139], a[244:247], v[80:83]
  s_cselect_b32 s99, s60, s99
  v_mfma_f32_16x16x32_bf16 v[84:87], a[140:143], a[244:247], 0
  s_memrealtime s[16:17]
  v_mfma_f32_16x16x32_bf16 v[84:87], a[128:131], a[248:251], v[84:87]
  s_memtime s[60:61]
  v_mfma_f32_16x16x32_bf16 v[84:87], a[116:119], a[252:255], v[84:87]
  s_add_u32 s59, s59, 1
  v_cvt_pk_bf16_f32 v138, v80, v81
  v_cvt_pk_bf16_f32 v139, v82, v83
  v_mfma_f32_16x16x32_bf16 v[84:87], a[104:107], v[144:147], v[84:87]
  s_bitcmp1_b32 2560, s59
  v_mfma_f32_16x16x32_bf16 v[84:87], a[92:95], v[148:151], v[84:87]
  s_cselect_b32 s7, s44, s22
  v_mfma_f32_16x16x32_bf16 v[84:87], a[80:83], v[152:155], v[84:87]
  v_mfma_f32_16x16x32_bf16 v[92:95], v[70:73], v[76:79], v[36:39]
  v_mfma_f32_16x16x32_bf16 v[92:95], v[68:71], v[12:15], v[92:95]
  v_mfma_f32_16x16x32_bf16 v[96:99], v[122:125], v[76:79], v[32:35]
  v_cvt_pk_bf16_f32 v140, v84, v85
  v_cvt_pk_bf16_f32 v141, v86, v87
  v_mfma_f32_16x16x32_bf16 v[96:99], v[120:123], v[12:15], v[96:99]
  v_mfma_f32_16x16x32_bf16 v[172:175], v[130:133], v[76:79], v[28:31]
  v_exp_f32 v92, v92
  v_mfma_f32_16x16x32_bf16 v[172:175], v[128:131], v[12:15], v[172:175]
  v_exp_f32 v93, v93
  v_mfma_f32_16x16x32_bf16 v[176:179], v[138:141], v[76:79], v[24:27]
  v_exp_f32 v94, v94
  v_mfma_f32_16x16x32_bf16 v[176:179], v[136:139], v[12:15], v[176:179]
  v_exp_f32 v95, v95
  v_mfma_f32_16x16x32_bf16 v[84:87], v[68:71], v[100:103], v[40:43]
  v_exp_f32 v96, v96
  v_mfma_f32_16x16x32_bf16 v[84:87], v[70:73], v[14:17], v[84:87]
  v_exp_f32 v97, v97
  v_mfma_f32_16x16x32_bf16 v[88:91], v[120:123], v[100:103], v[36:39]
  v_exp_f32 v98, v98
  v_mfma_f32_16x16x32_bf16 v[88:91], v[122:125], v[14:17], v[88:91]
  v_exp_f32 v99, v99
  v_mfma_f32_16x16x32_bf16 v[168:171], v[128:131], v[100:103], v[32:35]
  v_exp_f32 v172, v172
  v_mfma_f32_16x16x32_bf16 v[168:171], v[130:133], v[14:17], v[168:171]
  v_exp_f32 v173, v173
  v_mfma_f32_16x16x32_bf16 v[164:167], v[136:139], v[100:103], v[28:31]
  v_exp_f32 v174, v174
  v_mfma_f32_16x16x32_bf16 v[164:167], v[138:141], v[14:17], v[164:167]
  v_exp_f32 v175, v175
  v_mfma_f32_16x16x32_bf16 v[76:79], v[130:133], v[104:107], v[36:39]
  v_exp_f32 v176, v176
  v_mfma_f32_16x16x32_bf16 v[76:79], v[128:131], v[18:21], v[76:79]
  v_exp_f32 v177, v177
  v_mfma_f32_16x16x32_bf16 v[80:83], v[138:141], v[104:107], v[32:35]
  v_exp_f32 v178, v178
  v_mfma_f32_16x16x32_bf16 v[80:83], v[136:139], v[18:21], v[80:83]
  v_exp_f32 v179, v179
  v_mfma_f32_16x16x32_bf16 v[160:163], v[70:73], v[104:107], v[44:47]
  v_cvt_pk_bf16_f32 v92, v92, v93
  v_cvt_pk_bf16_f32 v93, v94, v95
  v_mfma_f32_16x16x32_bf16 v[160:163], v[68:71], v[18:21], v[160:163]
  v_cvt_pk_bf16_f32 v94, v96, v97
  v_cvt_pk_bf16_f32 v95, v98, v99
  v_mfma_f32_16x16x32_bf16 v[156:159], v[122:125], v[104:107], v[40:43]
  v_cvt_pk_bf16_f32 v96, v172, v173
  v_cvt_pk_bf16_f32 v97, v174, v175
  v_mfma_f32_16x16x32_bf16 v[156:159], v[120:123], v[18:21], v[156:159]
  v_cvt_pk_bf16_f32 v98, v176, v177
  v_cvt_pk_bf16_f32 v99, v178, v179
  v_mfma_f32_16x16x32_bf16 v[172:175], a[0:3], v[152:155], 0
  v_exp_f32 v84, v84
  v_mfma_f32_16x16x32_bf16 v[172:175], a[12:15], v[148:151], v[172:175]
  v_exp_f32 v85, v85
  v_mfma_f32_16x16x32_bf16 v[172:175], a[24:27], v[144:147], v[172:175]
  v_exp_f32 v86, v86
  v_mfma_f32_16x16x32_bf16 v[172:175], a[36:39], a[252:255], v[172:175]
  v_exp_f32 v87, v87
  v_mfma_f32_16x16x32_bf16 v[172:175], a[48:51], a[248:251], v[172:175]
  v_exp_f32 v88, v88
  v_mfma_f32_16x16x32_bf16 v[172:175], a[60:63], a[244:247], v[172:175]
  v_exp_f32 v89, v89
  v_mfma_f32_16x16x32_bf16 v[100:103], a[64:67], a[244:247], 0
  v_exp_f32 v90, v90
  v_mfma_f32_16x16x32_bf16 v[100:103], a[52:55], a[248:251], v[100:103]
  v_exp_f32 v91, v91
  v_mfma_f32_16x16x32_bf16 v[100:103], a[40:43], a[252:255], v[100:103]
  v_mul_f32 v172, s42, v172
  v_mul_f32 v173, s42, v173
  v_mfma_f32_16x16x32_bf16 v[100:103], a[28:31], v[144:147], v[100:103]
  v_mul_f32 v174, s42, v174
  v_mul_f32 v175, s42, v175
  v_mfma_f32_16x16x32_bf16 v[100:103], a[16:19], v[148:151], v[100:103]
  v_cvt_pk_bf16_f32 v176, v172, v173
  v_cvt_pk_bf16_f32 v177, v174, v175
  v_mfma_f32_16x16x32_bf16 v[100:103], a[4:7], v[152:155], v[100:103]
  v_exp_f32 v168, v168
  v_mfma_f32_16x16x32_bf16 v[104:107], a[8:11], v[152:155], 0
  v_exp_f32 v169, v169
  v_mfma_f32_16x16x32_bf16 v[104:107], a[20:23], v[148:151], v[104:107]
  v_exp_f32 v170, v170
  v_mfma_f32_16x16x32_bf16 v[104:107], a[32:35], v[144:147], v[104:107]
  v_mul_f32 v100, s42, v100
  v_mul_f32 v101, s42, v101
  v_mfma_f32_16x16x32_bf16 v[104:107], a[44:47], a[252:255], v[104:107]
  v_mul_f32 v102, s42, v102
  v_mul_f32 v103, s42, v103
  v_mfma_f32_16x16x32_bf16 v[104:107], a[56:59], a[248:251], v[104:107]
  v_cvt_pk_bf16_f32 v178, v100, v101
  v_cvt_pk_bf16_f32 v179, v102, v103
  v_mfma_f32_16x16x32_bf16 v[104:107], a[68:71], a[244:247], v[104:107]
  v_exp_f32 v171, v171
  v_mfma_f32_16x16x32_bf16 v[180:183], v[152:155], a[144:147], 0
  v_exp_f32 v164, v164
  v_mfma_f32_16x16x32_bf16 v[180:183], v[148:151], a[156:159], v[180:183]
  v_exp_f32 v165, v165
  v_mfma_f32_16x16x32_bf16 v[180:183], v[144:147], a[168:171], v[180:183]
  v_mul_f32 v104, s42, v104
  v_mul_f32 v105, s42, v105
  v_mfma_f32_16x16x32_bf16 v[180:183], a[252:255], a[180:183], v[180:183]
  v_mul_f32 v106, s42, v106
  v_mul_f32 v107, s42, v107
  v_mfma_f32_16x16x32_bf16 v[180:183], a[248:251], a[192:195], v[180:183]
  v_cvt_pk_bf16_f32 v22, v104, v105
  v_cvt_pk_bf16_f32 v23, v106, v107
  v_mfma_f32_16x16x32_bf16 v[180:183], a[244:247], a[204:207], v[180:183]
  v_exp_f32 v166, v166
  v_mfma_f32_16x16x32_bf16 v[100:103], v[128:131], v[176:179], v[40:43]
  v_exp_f32 v167, v167
  v_mfma_f32_16x16x32_bf16 v[100:103], v[130:133], v[20:23], v[100:103]
  v_cvt_pk_bf16_f32 v84, v84, v85
  v_cvt_pk_bf16_f32 v85, v86, v87
  v_mfma_f32_16x16x32_bf16 v[104:107], v[136:139], v[176:179], v[36:39]
  v_cvt_pk_bf16_f32 v110, v180, v181
  v_cvt_pk_bf16_f32 v111, v182, v183
  v_mfma_f32_16x16x32_bf16 v[104:107], v[138:141], v[20:23], v[104:107]
  ds_read_b128 v[172:175], v3 offset:0
  v_cvt_pk_bf16_f32 v86, v88, v89
  v_mfma_f32_16x16x32_bf16 v[132:135], v[68:71], v[176:179], v[48:51]
  ds_read_b128 v[136:139], v3 offset:4096
  v_cvt_pk_bf16_f32 v87, v90, v91
  v_mfma_f32_16x16x32_bf16 v[132:135], v[70:73], v[20:23], v[132:135]
  ds_read_b128 v[140:143], v3 offset:8192
  v_cvt_pk_bf16_f32 v88, v168, v169
  v_mfma_f32_16x16x32_bf16 v[128:131], v[120:123], v[176:179], v[44:47]
  ds_read_b128 v[68:71], v3 offset:12288
  v_cvt_pk_bf16_f32 v89, v170, v171
  v_mfma_f32_16x16x32_bf16 v[128:131], v[122:125], v[20:23], v[128:131]
  ds_read_b128 v[72:75], v3 offset:16384
  v_cvt_pk_bf16_f32 v90, v164, v165
  v_mfma_f32_16x16x32_bf16 v[168:171], a[244:247], a[208:211], 0
  ds_read_b128 v[120:123], v3 offset:20480
  v_cvt_pk_bf16_f32 v91, v166, v167
  v_mfma_f32_16x16x32_bf16 v[168:171], a[248:251], a[196:199], v[168:171]
  v_exp_f32 v76, v76
  v_mfma_f32_16x16x32_bf16 v[168:171], a[252:255], a[184:187], v[168:171]
  v_exp_f32 v77, v77
  v_mfma_f32_16x16x32_bf16 v[168:171], v[144:147], a[172:175], v[168:171]
  v_exp_f32 v78, v78
  v_mfma_f32_16x16x32_bf16 v[168:171], v[148:151], a[160:163], v[168:171]
  v_exp_f32 v79, v79
  v_mfma_f32_16x16x32_bf16 v[168:171], v[152:155], a[148:151], v[168:171]
  v_exp_f32 v80, v80
  v_mfma_f32_16x16x32_bf16 v[124:127], v[152:155], a[152:155], 0
  v_exp_f32 v81, v81
  v_mfma_f32_16x16x32_bf16 v[124:127], v[148:151], a[164:167], v[124:127]
  v_exp_f32 v82, v82
  v_mfma_f32_16x16x32_bf16 v[124:127], v[144:147], a[176:179], v[124:127]
  v_cvt_pk_bf16_f32 v114, v168, v169
  v_cvt_pk_bf16_f32 v115, v170, v171
  v_mfma_f32_16x16x32_bf16 v[124:127], a[252:255], a[188:191], v[124:127]
  v_exp_f32 v83, v83
  v_mfma_f32_16x16x32_bf16 v[124:127], a[248:251], a[200:203], v[124:127]
  s_waitcnt lgkmcnt(0)
  v_exp_f32 v160, v160
  v_mfma_f32_16x16x32_bf16 v[124:127], a[244:247], a[212:215], v[124:127]
L_hop_0_1:
  s_cbranch_execz L_hop_0_2
L_mid:
  v_mfma_f32_16x16x32_bf16 v[148:151], v[172:175], v[184:187], 0
  v_exp_f32 v161, v161
  v_mfma_f32_16x16x32_bf16 v[148:151], v[136:139], v[200:203], v[148:151]
  v_exp_f32 v162, v162
  v_mfma_f32_16x16x32_bf16 v[148:151], v[140:143], v[216:219], v[148:151]
  v_cvt_pk_bf16_f32 v118, v124, v125
  v_cvt_pk_bf16_f32 v119, v126, v127
  v_mfma_f32_16x16x32_bf16 v[148:151], v[68:71], v[232:235], v[148:151]
  v_exp_f32 v163, v163
  v_mfma_f32_16x16x32_bf16 v[148:151], v[72:75], v[248:251], v[148:151]
  v_exp_f32 v156, v156
  v_mfma_f32_16x16x32_bf16 v[148:151], v[120:123], a[224:227], v[148:151]
  v_exp_f32 v157, v157
  v_mfma_f32_16x16x32_bf16 v[168:171], v[120:123], a[228:231], 0
  v_exp_f32 v158, v158
  v_mfma_f32_16x16x32_bf16 v[168:171], v[72:75], v[252:255], v[168:171]
  ds_read_b128 v[124:127], v4 offset:0
  v_cvt_pk_bf16_f32 v76, v76, v77
  v_mfma_f32_16x16x32_bf16 v[168:171], v[68:71], v[236:239], v[168:171]
  ds_read_b128 v[180:183], v4 offset:4096
  v_cvt_pk_bf16_f32 v77, v78, v79
  v_mfma_f32_16x16x32_bf16 v[168:171], v[140:143], v[220:223], v[168:171]
  ds_read_b128 a[248:251], v4 offset:8192
  v_cvt_pk_bf16_f32 v78, v80, v81
  v_mfma_f32_16x16x32_bf16 v[168:171], v[136:139], v[204:207], v[168:171]
  ds_read_b128 v[164:167], v4 offset:12288
  v_cvt_pk_bf16_f32 v79, v82, v83
  v_mfma_f32_16x16x32_bf16 v[168:171], v[172:175], v[188:191], v[168:171]
  ds_read_b128 v[144:147], v4 offset:16384
  v_cvt_pk_bf16_f32 v80, v160, v161
  v_mfma_f32_16x16x32_bf16 v[152:155], v[172:175], v[192:195], 0
  ds_read_b128 v[176:179], v4 offset:20480
  v_cvt_pk_bf16_f32 v81, v162, v163
  v_mfma_f32_16x16x32_bf16 v[152:155], v[136:139], v[208:211], v[152:155]
  v_exp_f32 v159, v159
  v_mfma_f32_16x16x32_bf16 v[152:155], v[140:143], v[224:227], v[152:155]
  v_cvt_pk_bf16_f32 v148, v148, v168
  v_cvt_pk_bf16_f32 v149, v149, v169
  v_mfma_f32_16x16x32_bf16 v[152:155], v[68:71], v[240:243], v[152:155]
  v_cvt_pk_bf16_f32 v150, v150, v170
  v_cvt_pk_bf16_f32 v151, v151, v171
  v_mfma_f32_16x16x32_bf16 v[152:155], v[72:75], a[216:219], v[152:155]
  buffer_store_dword v148, v7, s[24:27], s33 offen offset:0 nt
  v_mfma_f32_16x16x32_bf16 v[152:155], v[120:123], a[232:235], v[152:155]
  v_cvt_pk_bf16_f32 v82, v156, v157
  v_cvt_pk_bf16_f32 v83, v158, v159
  v_mfma_f32_16x16x32_bf16 v[160:163], v[120:123], a[236:239], 0
  v_exp_f32 v100, v100
  v_mfma_f32_16x16x32_bf16 v[160:163], v[72:75], a[220:223], v[160:163]
  buffer_store_dword v149, v7, s[24:27], s33 offen offset:384 nt
  v_mfma_f32_16x16x32_bf16 v[160:163], v[68:71], v[244:247], v[160:163]
  ds_read_b128 a[244:247], v3 offset:512
  v_mfma_f32_16x16x32_bf16 v[160:163], v[140:143], v[228:231], v[160:163]
  ds_read_b128 v[168:171], v3 offset:4608
  v_mfma_f32_16x16x32_bf16 v[160:163], v[136:139], v[212:215], v[160:163]
  buffer_store_dword v150, v7, s[24:27], s33 offen offset:768 nt
  v_mfma_f32_16x16x32_bf16 v[160:163], v[172:175], v[196:199], v[160:163]
  s_waitcnt lgkmcnt(2)
  ds_read_b128 a[252:255], v3 offset:8704
  v_mfma_f32_16x16x32_bf16 v[136:139], v[124:127], v[184:187], 0
  ds_read_b128 v[68:71], v3 offset:12800
  v_mfma_f32_16x16x32_bf16 v[136:139], v[180:183], v[200:203], v[136:139]
  buffer_store_dword v151, v7, s[24:27], s33 offen offset:1152 nt
  v_mfma_f32_16x16x32_bf16 v[136:139], a[248:251], v[216:219], v[136:139]
  v_cvt_pk_bf16_f32 v152, v152, v160
  v_cvt_pk_bf16_f32 v153, v153, v161
  v_mfma_f32_16x16x32_bf16 v[136:139], v[164:167], v[232:235], v[136:139]
  v_cvt_pk_bf16_f32 v154, v154, v162
  v_cvt_pk_bf16_f32 v155, v155, v163
  v_mfma_f32_16x16x32_bf16 v[136:139], v[144:147], v[248:251], v[136:139]
  buffer_store_dword v152, v8, s[24:27], s33 offen offset:0 nt
  v_mfma_f32_16x16x32_bf16 v[136:139], v[176:179], a[224:227], v[136:139]
  ds_read_b128 v[72:75], v3 offset:16896
  v_mfma_f32_16x16x32_bf16 v[120:123], v[176:179], a[228:231], 0
  ds_read_b128 v[140:143], v3 offset:20992
  v_xor_b32 v3, 40960, v3
  v_mfma_f32_16x16x32_bf16 v[120:123], v[144:147], v[252:255], v[120:123]
  buffer_store_dword v153, v8, s[24:27], s33 offen offset:384 nt
  v_mfma_f32_16x16x32_bf16 v[120:123], v[164:167], v[236:239], v[120:123]
  v_exp_f32 v101, v101
  v_mfma_f32_16x16x32_bf16 v[120:123], a[248:251], v[220:223], v[120:123]
  v_exp_f32 v102, v102
  v_mfma_f32_16x16x32_bf16 v[120:123], v[180:183], v[204:207], v[120:123]
  buffer_store_dword v154, v8, s[24:27], s33 offen offset:768 nt
  v_mfma_f32_16x16x32_bf16 v[120:123], v[124:127], v[188:191], v[120:123]
  s_waitcnt lgkmcnt(1)
  v_exp_f32 v103, v103
  v_mfma_f32_16x16x32_bf16 v[144:147], a[244:247], v[184:187], 0
  v_exp_f32 v104, v104
  v_mfma_f32_16x16x32_bf16 v[144:147], v[168:171], v[200:203], v[144:147]
  buffer_store_dword v155, v8, s[24:27], s33 offen offset:1152 nt
  v_mfma_f32_16x16x32_bf16 v[144:147], a[252:255], v[216:219], v[144:147]
  v_cvt_pk_bf16_f32 v136, v136, v120
  v_cvt_pk_bf16_f32 v137, v137, v121
  v_mfma_f32_16x16x32_bf16 v[144:147], v[68:71], v[232:235], v[144:147]
  s_waitcnt lgkmcnt(0)
  v_cvt_pk_bf16_f32 v138, v138, v122
  v_cvt_pk_bf16_f32 v139, v139, v123
  v_mfma_f32_16x16x32_bf16 v[144:147], v[72:75], v[248:251], v[144:147]
  buffer_store_dword v136, v7, s[24:27], s34 offen offset:0 nt
  v_mfma_f32_16x16x32_bf16 v[144:147], v[140:143], a[224:227], v[144:147]
  v_exp_f32 v105, v105
  v_mfma_f32_16x16x32_bf16 v[160:163], v[140:143], a[228:231], 0
  v_exp_f32 v106, v106
  v_mfma_f32_16x16x32_bf16 v[160:163], v[72:75], v[252:255], v[160:163]
  buffer_store_dword v137, v7, s[24:27], s34 offen offset:384 nt
  v_mfma_f32_16x16x32_bf16 v[160:163], v[68:71], v[236:239], v[160:163]
  ds_read_b128 v[120:123], v4 offset:512
  v_cvt_pk_bf16_f32 v100, v100, v101
  v_mfma_f32_16x16x32_bf16 v[160:163], a[252:255], v[220:223], v[160:163]
  ds_read_b128 v[124:127], v4 offset:4608
  v_cvt_pk_bf16_f32 v101, v102, v103
  v_mfma_f32_16x16x32_bf16 v[160:163], v[168:171], v[204:207], v[160:163]
  buffer_store_dword v138, v7, s[24:27], s34 offen offset:768 nt
  v_mfma_f32_16x16x32_bf16 v[160:163], a[244:247], v[188:191], v[160:163]
  ds_read_b128 v[152:155], v4 offset:8704
  v_cvt_pk_bf16_f32 v102, v104, v105
  v_mfma_f32_16x16x32_bf16 v[148:151], a[244:247], v[192:195], 0
  ds_read_b128 v[156:159], v4 offset:12800
  v_mfma_f32_16x16x32_bf16 v[148:151], v[168:171], v[208:211], v[148:151]
  buffer_store_dword v139, v7, s[24:27], s34 offen offset:1152 nt
  v_mfma_f32_16x16x32_bf16 v[148:151], a[252:255], v[224:227], v[148:151]
  v_cvt_pk_bf16_f32 v144, v144, v160
  v_cvt_pk_bf16_f32 v145, v145, v161
  v_mfma_f32_16x16x32_bf16 v[148:151], v[68:71], v[240:243], v[148:151]
  v_cvt_pk_bf16_f32 v146, v146, v162
  v_cvt_pk_bf16_f32 v147, v147, v163
  v_mfma_f32_16x16x32_bf16 v[148:151], v[72:75], a[216:219], v[148:151]
  buffer_store_dword v144, v7, s[24:27], s35 offen offset:0 nt
  v_mfma_f32_16x16x32_bf16 v[148:151], v[140:143], a[232:235], v[148:151]
  ds_read_b128 v[136:139], v4 offset:16896
  v_mfma_f32_16x16x32_bf16 v[164:167], v[140:143], a[236:239], 0
  ds_read_b128 v[160:163], v4 offset:20992
  v_xor_b32 v4, 40960, v4
  v_mfma_f32_16x16x32_bf16 v[164:167], v[72:75], a[220:223], v[164:167]
  buffer_store_dword v145, v7, s[24:27], s35 offen offset:384 nt
  v_mfma_f32_16x16x32_bf16 v[164:167], v[68:71], v[244:247], v[164:167]
  v_exp_f32 v107, v107
  v_mfma_f32_16x16x32_bf16 v[164:167], a[252:255], v[228:231], v[164:167]
  v_exp_f32 v132, v132
  v_mfma_f32_16x16x32_bf16 v[164:167], v[168:171], v[212:215], v[164:167]
  buffer_store_dword v146, v7, s[24:27], s35 offen offset:768 nt
  v_mfma_f32_16x16x32_bf16 v[164:167], a[244:247], v[196:199], v[164:167]
  s_waitcnt lgkmcnt(1)
  v_exp_f32 v133, v133
  v_mfma_f32_16x16x32_bf16 v[140:143], v[120:123], v[184:187], 0
  v_exp_f32 v134, v134
  v_mfma_f32_16x16x32_bf16 v[140:143], v[124:127], v[200:203], v[140:143]
  buffer_store_dword v147, v7, s[24:27], s35 offen offset:1152 nt
  v_mfma_f32_16x16x32_bf16 v[140:143], v[152:155], v[216:219], v[140:143]
  v_cvt_pk_bf16_f32 v148, v148, v164
  v_cvt_pk_bf16_f32 v149, v149, v165
  v_mfma_f32_16x16x32_bf16 v[140:143], v[156:159], v[232:235], v[140:143]
  s_waitcnt lgkmcnt(0)
  v_cvt_pk_bf16_f32 v150, v150, v166
  v_cvt_pk_bf16_f32 v151, v151, v167
  v_mfma_f32_16x16x32_bf16 v[140:143], v[136:139], v[248:251], v[140:143]
  buffer_store_dword v148, v8, s[24:27], s35 offen offset:0 nt
  v_mfma_f32_16x16x32_bf16 v[140:143], v[160:163], a[224:227], v[140:143]
  v_mov_b64 v[164:165], 0
  v_cvt_pk_bf16_f32 v103, v106, v107
  v_mfma_f32_16x16x32_bf16 v[144:147], v[160:163], a[228:231], 0
  v_exp_f32 v135, v135
  v_mfma_f32_16x16x32_bf16 v[144:147], v[136:139], v[252:255], v[144:147]
  buffer_store_dword v149, v8, s[24:27], s35 offen offset:384 nt
  v_mfma_f32_16x16x32_bf16 v[144:147], v[156:159], v[236:239], v[144:147]
  v_exp_f32 v128, v128
  v_mfma_f32_16x16x32_bf16 v[144:147], v[152:155], v[220:223], v[144:147]
  v_mov_b64 v[72:73], 0
  v_cvt_pk_bf16_f32 v104, v132, v133
  v_mfma_f32_16x16x32_bf16 v[144:147], v[124:127], v[204:207], v[144:147]
  buffer_store_dword v150, v8, s[24:27], s35 offen offset:768 nt
  v_mfma_f32_16x16x32_bf16 v[144:147], v[120:123], v[188:191], v[144:147]
  v_exp_f32 v129, v129
  v_smfmac_f32_16x16x64_bf16 v[164:167], a[240:243], v[92:99], v10
  v_exp_f32 v130, v130
  v_mfma_f32_16x16x32_bf16 v[168:171], v[108:111], v[96:99], 0
  buffer_store_dword v151, v8, s[24:27], s35 offen offset:1152 nt
  v_mfma_f32_16x16x32_bf16 v[168:171], v[56:59], v[92:95], v[168:171]
  v_cvt_pk_bf16_f32 v140, v140, v144
  v_cvt_pk_bf16_f32 v141, v141, v145
  v_mfma_f32_16x16x32_bf16 v[160:163], v[60:63], v[92:95], 0
  v_cvt_pk_bf16_f32 v142, v142, v146
  v_cvt_pk_bf16_f32 v143, v143, v147
  v_mfma_f32_16x16x32_bf16 v[160:163], v[112:115], v[96:99], v[160:163]
  buffer_store_dword v140, v7, s[24:27], s36 offen offset:0 nt
  v_mfma_f32_16x16x32_bf16 v[68:71], v[116:119], v[96:99], 0
  v_mov_b64 v[124:125], 0
  v_cvt_pk_bf16_f32 v105, v134, v135
  v_mfma_f32_16x16x32_bf16 v[68:71], v[64:67], v[92:95], v[68:71]
  v_exp_f32 v131, v131
  v_smfmac_f32_16x16x64_bf16 v[72:75], a[240:243], v[84:91], v10
  buffer_store_dword v141, v7, s[24:27], s36 offen offset:384 nt
  v_mfma_f32_16x16x32_bf16 v[156:159], v[108:111], v[88:91], 0
  v_cvt_pk_bf16_f32 v106, v128, v129
  v_cvt_pk_bf16_f32 v107, v130, v131
  v_mfma_f32_16x16x32_bf16 v[156:159], v[56:59], v[84:87], v[156:159]
  v_add_f32 v164, v164, v165
  v_mfma_f32_16x16x32_bf16 v[148:151], v[60:63], v[84:87], 0
  buffer_store_dword v142, v7, s[24:27], s36 offen offset:768 nt
  v_mfma_f32_16x16x32_bf16 v[148:151], v[112:115], v[88:91], v[148:151]
  ds_read_b128 a[244:247], v0 offset:0
  v_mov_b64 v[92:93], 0
  v_mfma_f32_16x16x32_bf16 v[132:135], v[116:119], v[88:91], 0
  ds_read_b128 a[248:251], v1 offset:0
  v_add_f32 v72, v72, v73
  v_mfma_f32_16x16x32_bf16 v[132:135], v[64:67], v[84:87], v[132:135]
  buffer_store_dword v143, v7, s[24:27], s36 offen offset:1152 nt
  v_smfmac_f32_16x16x64_bf16 v[124:127], a[240:243], v[76:83], v10
  ds_read_b128 v[136:139], v0 offset:8192
  v_cndmask_b32 v7, v7, v52, s[62:63]
  v_mfma_f32_16x16x32_bf16 v[128:131], v[56:59], v[80:83], 0
  ds_read_b128 v[140:143], v1 offset:8192
  v_cndmask_b32 v8, v8, v53, s[62:63]
  v_mfma_f32_16x16x32_bf16 v[128:131], v[108:111], v[76:79], v[128:131]
  s_mov_b64 s[62:63], 0
  ds_read_b128 v[152:155], v0 offset:16384
  v_mfma_f32_16x16x32_bf16 v[120:123], v[112:115], v[76:79], 0
  ds_read_b128 v[144:147], v1 offset:16384
  v_mfma_f32_16x16x32_bf16 v[120:123], v[60:63], v[80:83], v[120:123]
  v_rcp_f32 v166, v164
  v_mfma_f32_16x16x32_bf16 v[96:99], v[64:67], v[80:83], 0
  v_mul_f32 v168, v166, v168
  v_mul_f32 v169, v166, v169
  v_mfma_f32_16x16x32_bf16 v[96:99], v[116:119], v[76:79], v[96:99]
  v_mul_f32 v170, v166, v170
  v_mul_f32 v171, v166, v171
  v_smfmac_f32_16x16x64_bf16 v[92:95], a[240:243], v[100:107], v10
  v_cvt_pk_bf16_f32 v168, v168, v169
  v_cvt_pk_bf16_f32 v169, v170, v171
  v_mfma_f32_16x16x32_bf16 v[88:91], v[56:59], v[104:107], 0
  v_mul_f32 v160, v166, v160
  v_mul_f32 v161, v166, v161
  v_mfma_f32_16x16x32_bf16 v[88:91], v[108:111], v[100:103], v[88:91]
  v_mul_f32 v162, v166, v162
  v_mul_f32 v163, v166, v163
  v_mfma_f32_16x16x32_bf16 v[80:83], v[112:115], v[100:103], 0
  v_cvt_pk_bf16_f32 v160, v160, v161
  v_cvt_pk_bf16_f32 v161, v162, v163
  v_mfma_f32_16x16x32_bf16 v[80:83], v[60:63], v[104:107], v[80:83]
  v_mul_f32 v68, v166, v68
  v_mul_f32 v69, v166, v69
  v_mfma_f32_16x16x32_bf16 v[84:87], v[64:67], v[104:107], 0
  v_mul_f32 v70, v166, v70
  v_mul_f32 v71, v166, v71
  v_mfma_f32_16x16x32_bf16 v[84:87], v[116:119], v[100:103], v[84:87]
  s_waitcnt lgkmcnt(0)
  v_cvt_pk_bf16_f32 v68, v68, v69
  v_cvt_pk_bf16_f32 v69, v70, v71
  v_mfma_f32_16x16x32_bf16 v[64:67], a[0:3], a[244:247], 0
  v_max3_f32 v9, v164, v166, v9
  v_add_f32 v124, v124, v125
  v_mfma_f32_16x16x32_bf16 v[64:67], a[12:15], a[248:251], v[64:67]
  ds_write_b32 v5, v168 offset:0
  v_mfma_f32_16x16x32_bf16 v[64:67], a[24:27], v[136:139], v[64:67]
  v_rcp_f32 v74, v72
  v_mfma_f32_16x16x32_bf16 v[64:67], a[36:39], v[140:143], v[64:67]
  ds_write_b32 v5, v169 offset:1024
  v_mfma_f32_16x16x32_bf16 v[64:67], a[48:51], v[152:155], v[64:67]
  s_add_u32 m0, s30, 0
  v_mul_f32 v156, v74, v156
  v_mul_f32 v157, v74, v157
  v_mfma_f32_16x16x32_bf16 v[64:67], a[60:63], v[144:147], v[64:67]
  buffer_load_dwordx4 v6, s[8:11], s31 offen offset:0 nt lds
  v_mfma_f32_16x16x32_bf16 v[60:63], a[64:67], v[144:147], 0
  v_mul_f32 v158, v74, v158
  v_mul_f32 v159, v74, v159
  v_mfma_f32_16x16x32_bf16 v[60:63], a[52:55], v[152:155], v[60:63]
  ds_write_b32 v5, v160 offset:2048
  v_mfma_f32_16x16x32_bf16 v[60:63], a[40:43], v[140:143], v[60:63]
  v_mul_f32 v64, s42, v64
  v_mul_f32 v65, s42, v65
  v_mfma_f32_16x16x32_bf16 v[60:63], a[28:31], v[136:139], v[60:63]
  v_mul_f32 v66, s42, v66
  v_mul_f32 v67, s42, v67
  v_mfma_f32_16x16x32_bf16 v[60:63], a[16:19], a[248:251], v[60:63]
  v_cvt_pk_bf16_f32 v12, v64, v65
  v_cvt_pk_bf16_f32 v13, v66, v67
  v_mfma_f32_16x16x32_bf16 v[60:63], a[4:7], a[244:247], v[60:63]
  ds_write_b32 v5, v161 offset:3072
  v_mfma_f32_16x16x32_bf16 v[56:59], a[8:11], a[244:247], 0
  v_cvt_pk_bf16_f32 v156, v156, v157
  v_cvt_pk_bf16_f32 v157, v158, v159
  v_mfma_f32_16x16x32_bf16 v[56:59], a[20:23], a[248:251], v[56:59]
  ds_write_b32 v5, v68 offset:4096
  v_mfma_f32_16x16x32_bf16 v[56:59], a[32:35], v[136:139], v[56:59]
  v_mul_f32 v60, s42, v60
  v_mul_f32 v61, s42, v61
  v_mfma_f32_16x16x32_bf16 v[56:59], a[44:47], v[140:143], v[56:59]
  v_mul_f32 v62, s42, v62
  v_mul_f32 v63, s42, v63
  v_mfma_f32_16x16x32_bf16 v[56:59], a[56:59], v[152:155], v[56:59]
  v_cvt_pk_bf16_f32 v76, v60, v61
  v_cvt_pk_bf16_f32 v77, v62, v63
  v_mfma_f32_16x16x32_bf16 v[56:59], a[68:71], v[144:147], v[56:59]
  ds_write_b32 v5, v69 offset:5120
  v_mfma_f32_16x16x32_bf16 v[64:67], a[132:135], v[144:147], 0
  v_mul_f32 v148, v74, v148
  v_mul_f32 v149, v74, v149
  v_mfma_f32_16x16x32_bf16 v[64:67], a[120:123], v[152:155], v[64:67]
  v_mul_f32 v150, v74, v150
  v_mul_f32 v151, v74, v151
  v_mfma_f32_16x16x32_bf16 v[64:67], a[108:111], v[140:143], v[64:67]
  v_mul_f32 v56, s42, v56
  v_mul_f32 v57, s42, v57
  v_mfma_f32_16x16x32_bf16 v[64:67], a[96:99], v[136:139], v[64:67]
  v_mul_f32 v58, s42, v58
  v_mul_f32 v59, s42, v59
  v_mfma_f32_16x16x32_bf16 v[64:67], a[84:87], a[248:251], v[64:67]
  s_add_u32 m0, s30, 8064
  v_cvt_pk_bf16_f32 v78, v56, v57
  v_cvt_pk_bf16_f32 v79, v58, v59
  v_mfma_f32_16x16x32_bf16 v[64:67], a[72:75], a[244:247], v[64:67]
  buffer_load_dwordx4 v6, s[8:11], s31 offen offset:128 nt lds
  v_mfma_f32_16x16x32_bf16 v[60:63], a[76:79], a[244:247], 0
  v_cvt_pk_bf16_f32 v148, v148, v149
  v_cvt_pk_bf16_f32 v149, v150, v151
  v_mfma_f32_16x16x32_bf16 v[60:63], a[88:91], a[248:251], v[60:63]
  v_mul_f32 v132, v74, v132
  v_mul_f32 v133, v74, v133
  v_mfma_f32_16x16x32_bf16 v[60:63], a[100:103], v[136:139], v[60:63]
  v_cvt_pk_bf16_f32 v68, v64, v65
  v_cvt_pk_bf16_f32 v69, v66, v67
  v_mfma_f32_16x16x32_bf16 v[60:63], a[112:115], v[140:143], v[60:63]
  v_mul_f32 v134, v74, v134
  v_mul_f32 v135, v74, v135
  v_mfma_f32_16x16x32_bf16 v[60:63], a[124:127], v[152:155], v[60:63]
  v_cvt_pk_bf16_f32 v132, v132, v133
  v_cvt_pk_bf16_f32 v133, v134, v135
  v_mfma_f32_16x16x32_bf16 v[60:63], a[136:139], v[144:147], v[60:63]
  v_max3_f32 v9, v72, v74, v9
  v_add_f32 v92, v92, v93
  v_mfma_f32_16x16x32_bf16 v[56:59], a[140:143], v[144:147], 0
  ds_write_b32 v5, v156 offset:256
  v_mfma_f32_16x16x32_bf16 v[56:59], a[128:131], v[152:155], v[56:59]
  v_rcp_f32 v126, v124
  v_mfma_f32_16x16x32_bf16 v[56:59], a[116:119], v[140:143], v[56:59]
  v_cvt_pk_bf16_f32 v70, v60, v61
  v_cvt_pk_bf16_f32 v71, v62, v63
  v_mfma_f32_16x16x32_bf16 v[56:59], a[104:107], v[136:139], v[56:59]
  ds_write_b32 v5, v157 offset:1280
  v_mfma_f32_16x16x32_bf16 v[56:59], a[92:95], a[248:251], v[56:59]
  v_mul_f32 v128, v126, v128
  v_mul_f32 v129, v126, v129
  v_mfma_f32_16x16x32_bf16 v[56:59], a[80:83], a[244:247], v[56:59]
  ds_write_b32 v5, v148 offset:2304
  v_mfma_f32_16x16x32_bf16 v[60:63], a[244:247], a[144:147], 0
  v_mul_f32 v130, v126, v130
  v_mul_f32 v131, v126, v131
  v_mfma_f32_16x16x32_bf16 v[60:63], a[248:251], a[156:159], v[60:63]
  ds_read_b128 a[252:255], v0 offset:2048
  v_cvt_pk_bf16_f32 v128, v128, v129
  v_mfma_f32_16x16x32_bf16 v[60:63], v[136:139], a[168:171], v[60:63]
  v_cvt_pk_bf16_f32 v72, v56, v57
  v_cvt_pk_bf16_f32 v73, v58, v59
  v_mfma_f32_16x16x32_bf16 v[60:63], v[140:143], a[180:183], v[60:63]
  ds_read_b128 v[104:107], v1 offset:2048
  v_cvt_pk_bf16_f32 v129, v130, v131
  v_mfma_f32_16x16x32_bf16 v[60:63], v[152:155], a[192:195], v[60:63]
  s_add_u32 m0, s30, 16128
  ds_read_b128 v[108:111], v0 offset:10240
  v_mul_f32 v120, v126, v120
  v_mfma_f32_16x16x32_bf16 v[60:63], v[144:147], a[204:207], v[60:63]
  buffer_load_dwordx4 v6, s[8:11], s31 offen offset:256 nt lds
  v_mfma_f32_16x16x32_bf16 v[64:67], v[144:147], a[208:211], 0
  ds_read_b128 v[116:119], v1 offset:10240
  v_mul_f32 v121, v126, v121
  v_mfma_f32_16x16x32_bf16 v[64:67], v[152:155], a[196:199], v[64:67]
  ds_read_b128 v[112:115], v0 offset:18432
  v_mul_f32 v122, v126, v122
  v_mfma_f32_16x16x32_bf16 v[64:67], v[140:143], a[184:187], v[64:67]
  v_cvt_pk_bf16_f32 v56, v60, v61
  v_cvt_pk_bf16_f32 v57, v62, v63
  v_mfma_f32_16x16x32_bf16 v[64:67], v[136:139], a[172:175], v[64:67]
  ds_write_b32 v5, v149 offset:3328
  v_mfma_f32_16x16x32_bf16 v[64:67], a[248:251], a[160:163], v[64:67]
  v_mul_f32 v123, v126, v123
  v_cvt_pk_bf16_f32 v120, v120, v121
  v_mfma_f32_16x16x32_bf16 v[64:67], a[244:247], a[148:151], v[64:67]
  ds_write_b32 v5, v132 offset:4352
  v_mfma_f32_16x16x32_bf16 v[100:103], a[244:247], a[152:155], 0
  ds_write_b32 v5, v133 offset:5376
  v_mfma_f32_16x16x32_bf16 v[100:103], a[248:251], a[164:167], v[100:103]
  v_cvt_pk_bf16_f32 v121, v122, v123
  v_mul_f32 v96, v126, v96
  v_mfma_f32_16x16x32_bf16 v[100:103], v[136:139], a[176:179], v[100:103]
  ds_read_b128 a[244:247], v1 offset:18432
  v_cvt_pk_bf16_f32 v60, v64, v65
  v_mfma_f32_16x16x32_bf16 v[100:103], v[140:143], a[188:191], v[100:103]
  v_cvt_pk_bf16_f32 v61, v66, v67
  v_mul_f32 v97, v126, v97
  v_mfma_f32_16x16x32_bf16 v[100:103], v[152:155], a[200:203], v[100:103]
  v_mul_f32 v98, v126, v98
  v_mul_f32 v99, v126, v99
  v_mfma_f32_16x16x32_bf16 v[100:103], v[144:147], a[212:215], v[100:103]
  s_waitcnt lgkmcnt(4)
  v_cvt_pk_bf16_f32 v96, v96, v97
  v_cvt_pk_bf16_f32 v97, v98, v99
  v_mfma_f32_16x16x32_bf16 v[132:135], a[0:3], a[252:255], 0
  v_max3_f32 v9, v124, v126, v9
  v_mfma_f32_16x16x32_bf16 v[132:135], a[12:15], v[104:107], v[132:135]
  ds_write_b32 v5, v128 offset:512
  v_mfma_f32_16x16x32_bf16 v[132:135], a[24:27], v[108:111], v[132:135]
  v_cvt_pk_bf16_f32 v64, v100, v101
  v_cvt_pk_bf16_f32 v65, v102, v103
  v_mfma_f32_16x16x32_bf16 v[132:135], a[36:39], v[116:119], v[132:135]
  s_waitcnt lgkmcnt(1)
  ds_write_b32 v5, v129 offset:1536
  v_mfma_f32_16x16x32_bf16 v[132:135], a[48:51], v[112:115], v[132:135]
  s_add_u32 m0, s30, 4096
  v_rcp_f32 v94, v92
  v_mfma_f32_16x16x32_bf16 v[132:135], a[60:63], a[244:247], v[132:135]
  buffer_load_dwordx4 v6, s[8:11], s32 offen offset:0 nt lds
  v_mfma_f32_16x16x32_bf16 v[124:127], a[64:67], a[244:247], 0
  s_add_u32 s33, s31, s37
  v_mul_f32 v88, v94, v88
  v_mul_f32 v89, v94, v89
  v_mfma_f32_16x16x32_bf16 v[124:127], a[52:55], v[112:115], v[124:127]
  s_add_u32 s34, s31, s38
  ds_write_b32 v5, v120 offset:2560
  v_mfma_f32_16x16x32_bf16 v[124:127], a[40:43], v[116:119], v[124:127]
  s_add_u32 s35, s31, s39
  v_mul_f32 v132, s42, v132
  v_mul_f32 v133, s42, v133
  v_mfma_f32_16x16x32_bf16 v[124:127], a[28:31], v[108:111], v[124:127]
  s_add_u32 s36, s31, s40
  v_mul_f32 v134, s42, v134
  v_mul_f32 v135, s42, v135
  v_mfma_f32_16x16x32_bf16 v[124:127], a[16:19], v[104:107], v[124:127]
  s_add_u32 s31, s31, s43
  v_cvt_pk_bf16_f32 v100, v132, v133
  v_cvt_pk_bf16_f32 v101, v134, v135
  v_mfma_f32_16x16x32_bf16 v[124:127], a[4:7], a[252:255], v[124:127]
  s_mov_b32 s5, s28
  ds_write_b32 v5, v121 offset:3584
  v_mfma_f32_16x16x32_bf16 v[128:131], a[8:11], a[252:255], 0
  s_mov_b32 s28, s29
  v_mul_f32 v90, v94, v90
  v_mul_f32 v91, v94, v91
  v_mfma_f32_16x16x32_bf16 v[128:131], a[20:23], v[104:107], v[128:131]
  s_mov_b32 s29, s30
  ds_write_b32 v5, v96 offset:4608
  v_mfma_f32_16x16x32_bf16 v[128:131], a[32:35], v[108:111], v[128:131]
  v_mul_f32 v124, s42, v124
  v_mul_f32 v125, s42, v125
  v_mfma_f32_16x16x32_bf16 v[128:131], a[44:47], v[116:119], v[128:131]
  v_mul_f32 v126, s42, v126
  v_mul_f32 v127, s42, v127
  v_mfma_f32_16x16x32_bf16 v[128:131], a[56:59], v[112:115], v[128:131]
  v_cvt_pk_bf16_f32 v102, v124, v125
  v_cvt_pk_bf16_f32 v103, v126, v127
  v_mfma_f32_16x16x32_bf16 v[128:131], a[68:71], a[244:247], v[128:131]
  ds_write_b32 v5, v97 offset:5632
  v_mfma_f32_16x16x32_bf16 v[132:135], a[132:135], a[244:247], 0
  v_cvt_pk_bf16_f32 v88, v88, v89
  v_cvt_pk_bf16_f32 v89, v90, v91
  v_mfma_f32_16x16x32_bf16 v[132:135], a[120:123], v[112:115], v[132:135]
  v_mul_f32 v80, v94, v80
  v_mul_f32 v81, v94, v81
  v_mfma_f32_16x16x32_bf16 v[132:135], a[108:111], v[116:119], v[132:135]
  v_mul_f32 v128, s42, v128
  v_mul_f32 v129, s42, v129
  v_mfma_f32_16x16x32_bf16 v[132:135], a[96:99], v[108:111], v[132:135]
  v_mul_f32 v130, s42, v130
  v_mul_f32 v131, s42, v131
  v_mfma_f32_16x16x32_bf16 v[132:135], a[84:87], v[104:107], v[132:135]
  s_add_u32 m0, s30, 12160
  v_cvt_pk_bf16_f32 v16, v128, v129
  v_cvt_pk_bf16_f32 v17, v130, v131
  v_mfma_f32_16x16x32_bf16 v[132:135], a[72:75], a[252:255], v[132:135]
  buffer_load_dwordx4 v6, s[8:11], s32 offen offset:128 nt lds
  v_mfma_f32_16x16x32_bf16 v[96:99], a[76:79], a[252:255], 0
  v_mul_f32 v82, v94, v82
  v_mul_f32 v83, v94, v83
  v_mfma_f32_16x16x32_bf16 v[96:99], a[88:91], v[104:107], v[96:99]
  v_cvt_pk_bf16_f32 v80, v80, v81
  v_cvt_pk_bf16_f32 v81, v82, v83
  v_mfma_f32_16x16x32_bf16 v[96:99], a[100:103], v[108:111], v[96:99]
  v_cvt_pk_bf16_f32 v120, v132, v133
  v_cvt_pk_bf16_f32 v121, v134, v135
  v_mfma_f32_16x16x32_bf16 v[96:99], a[112:115], v[116:119], v[96:99]
  v_mul_f32 v84, v94, v84
  v_mul_f32 v85, v94, v85
  v_mfma_f32_16x16x32_bf16 v[96:99], a[124:127], v[112:115], v[96:99]
  v_mul_f32 v86, v94, v86
  v_mul_f32 v87, v94, v87
  v_mfma_f32_16x16x32_bf16 v[96:99], a[136:139], a[244:247], v[96:99]
  v_cvt_pk_bf16_f32 v84, v84, v85
  v_cvt_pk_bf16_f32 v85, v86, v87
  v_mfma_f32_16x16x32_bf16 v[132:135], a[140:143], a[244:247], 0
  v_max3_f32 v9, v92, v94, v9
  v_mfma_f32_16x16x32_bf16 v[132:135], a[128:131], v[112:115], v[132:135]
  ds_write_b32 v5, v88 offset:768
  v_mfma_f32_16x16x32_bf16 v[132:135], a[116:119], v[116:119], v[132:135]
  v_cvt_pk_bf16_f32 v122, v96, v97
  v_cvt_pk_bf16_f32 v123, v98, v99
  v_mfma_f32_16x16x32_bf16 v[132:135], a[104:107], v[108:111], v[132:135]
  ds_write_b32 v5, v89 offset:1792
  v_mfma_f32_16x16x32_bf16 v[132:135], a[92:95], v[104:107], v[132:135]
  v_mfma_f32_16x16x32_bf16 v[132:135], a[80:83], a[252:255], v[132:135]
  ds_write_b32 v5, v80 offset:2816
  v_mfma_f32_16x16x32_bf16 v[128:131], a[252:255], a[144:147], 0
  v_mfma_f32_16x16x32_bf16 v[128:131], v[104:107], a[156:159], v[128:131]
  ds_read_b128 v[88:91], v0 offset:4096
  v_mfma_f32_16x16x32_bf16 v[128:131], v[108:111], a[168:171], v[128:131]
  v_cvt_pk_bf16_f32 v124, v132, v133
  v_cvt_pk_bf16_f32 v125, v134, v135
  v_mfma_f32_16x16x32_bf16 v[128:131], v[116:119], a[180:183], v[128:131]
  ds_read_b128 v[92:95], v1 offset:4096
  v_mfma_f32_16x16x32_bf16 v[128:131], v[112:115], a[192:195], v[128:131]
  s_add_u32 m0, s30, 20224
  ds_read_b128 v[96:99], v0 offset:12288
  v_mfma_f32_16x16x32_bf16 v[128:131], a[244:247], a[204:207], v[128:131]
  buffer_load_dwordx4 v6, s[8:11], s32 offen offset:256 nt lds
  v_mfma_f32_16x16x32_bf16 v[132:135], a[244:247], a[208:211], 0
  s_add_u32 s32, s32, s43
  ds_read_b128 v[136:139], v1 offset:12288
  v_mfma_f32_16x16x32_bf16 v[132:135], v[112:115], a[196:199], v[132:135]
  s_mov_b32 s30, s5
  ds_read_b128 v[140:143], v0 offset:20480
  v_mfma_f32_16x16x32_bf16 v[132:135], v[116:119], a[184:187], v[132:135]
  v_cvt_pk_bf16_f32 v58, v128, v129
  v_cvt_pk_bf16_f32 v59, v130, v131
  v_mfma_f32_16x16x32_bf16 v[132:135], v[108:111], a[172:175], v[132:135]
  ds_write_b32 v5, v81 offset:3840
  v_mfma_f32_16x16x32_bf16 v[132:135], v[104:107], a[160:163], v[132:135]
  v_mfma_f32_16x16x32_bf16 v[132:135], a[252:255], a[148:151], v[132:135]
  ds_write_b32 v5, v84 offset:4864
  v_mfma_f32_16x16x32_bf16 v[128:131], a[252:255], a[152:155], 0
  v_mfma_f32_16x16x32_bf16 v[128:131], v[104:107], a[164:167], v[128:131]
  ds_write_b32 v5, v85 offset:5888
  v_mfma_f32_16x16x32_bf16 v[128:131], v[108:111], a[176:179], v[128:131]
  v_cvt_pk_bf16_f32 v62, v132, v133
  v_cvt_pk_bf16_f32 v63, v134, v135
  v_mfma_f32_16x16x32_bf16 v[128:131], v[116:119], a[188:191], v[128:131]
  s_waitcnt lgkmcnt(3)
  ds_read_b128 v[80:83], v1 offset:20480
  v_xor_b32 v5, s41, v5
  v_mfma_f32_16x16x32_bf16 v[128:131], v[112:115], a[200:203], v[128:131]
  s_bitcmp1_b32 s96, s59
  v_mfma_f32_16x16x32_bf16 v[128:131], a[244:247], a[212:215], v[128:131]
  s_cbranch_scc0 L_loop
L_epi:
  s_cmp_lg_u32 s59, s97
  s_cbranch_scc1 L_k2
L_full:
  v_mfma_f32_16x16x32_bf16 v[104:107], a[76:79], v[88:91], 0
  s_lshl_b32 s5, s3, 3
  v_mfma_f32_16x16x32_bf16 v[104:107], a[88:91], v[92:95], v[104:107]
  s_add_u32 s5, s5, 159744
  v_mov_b32 v11, s5
  v_mfma_f32_16x16x32_bf16 v[104:107], a[100:103], v[96:99], v[104:107]
  v_cvt_pk_bf16_f32 v66, v128, v129
  v_cvt_pk_bf16_f32 v67, v130, v131
  v_mfma_f32_16x16x32_bf16 v[104:107], a[112:115], v[136:139], v[104:107]
  ds_read_b128 v[160:163], v1 offset:22528
  v_mfma_f32_16x16x32_bf16 v[104:107], a[124:127], v[140:143], v[104:107]
  ds_read_b128 v[164:167], v0 offset:22528
  s_waitcnt lgkmcnt(2)
  v_mfma_f32_16x16x32_bf16 v[104:107], a[136:139], v[80:83], v[104:107]
  ds_read_b128 a[244:247], v1 offset:14336
  v_mfma_f32_16x16x32_bf16 v[108:111], a[132:135], v[80:83], 0
  ds_read_b128 a[252:255], v0 offset:14336
  v_mfma_f32_16x16x32_bf16 v[108:111], a[120:123], v[140:143], v[108:111]
  ds_read_b128 a[248:251], v1 offset:6144
  v_mfma_f32_16x16x32_bf16 v[108:111], a[108:111], v[136:139], v[108:111]
  v_cvt_pk_bf16_f32 v146, v104, v105
  v_cvt_pk_bf16_f32 v147, v106, v107
  v_mfma_f32_16x16x32_bf16 v[108:111], a[96:99], v[96:99], v[108:111]
  ds_read_b128 v[84:87], v0 offset:6144
  v_mfma_f32_16x16x32_bf16 v[108:111], a[84:87], v[92:95], v[108:111]
  v_mfma_f32_16x16x32_bf16 v[108:111], a[72:75], v[88:91], v[108:111]
  v_mfma_f32_16x16x32_bf16 v[112:115], a[140:143], v[80:83], 0
  v_mfma_f32_16x16x32_bf16 v[112:115], a[128:131], v[140:143], v[112:115]
  v_mfma_f32_16x16x32_bf16 v[112:115], a[116:119], v[136:139], v[112:115]
  v_cvt_pk_bf16_f32 v144, v108, v109
  v_cvt_pk_bf16_f32 v145, v110, v111
  v_mfma_f32_16x16x32_bf16 v[112:115], a[104:107], v[96:99], v[112:115]
  v_mfma_f32_16x16x32_bf16 v[112:115], a[92:95], v[92:95], v[112:115]
  v_mfma_f32_16x16x32_bf16 v[112:115], a[80:83], v[88:91], v[112:115]
  s_waitcnt lgkmcnt(0)
  v_mfma_f32_16x16x32_bf16 v[104:107], a[132:135], v[160:163], 0
L_hop_1_1:
  s_cbranch_execz L_hop_1_2
  v_mfma_f32_16x16x32_bf16 v[104:107], a[120:123], v[164:167], v[104:107]
  v_mfma_f32_16x16x32_bf16 v[104:107], a[108:111], a[244:247], v[104:107]
  v_cvt_pk_bf16_f32 v148, v112, v113
  v_cvt_pk_bf16_f32 v149, v114, v115
  v_mfma_f32_16x16x32_bf16 v[104:107], a[96:99], a[252:255], v[104:107]
  v_mfma_f32_16x16x32_bf16 v[104:107], a[84:87], a[248:251], v[104:107]
  s_waitcnt lgkmcnt(0)
  s_barrier
  v_mfma_f32_16x16x32_bf16 v[104:107], a[72:75], v[84:87], v[104:107]
  v_mfma_f32_16x16x32_bf16 v[108:111], a[76:79], v[84:87], 0
  v_mfma_f32_16x16x32_bf16 v[108:111], a[88:91], a[248:251], v[108:111]
  v_mfma_f32_16x16x32_bf16 v[108:111], a[100:103], a[252:255], v[108:111]
  v_cvt_pk_bf16_f32 v150, v104, v105
  v_cvt_pk_bf16_f32 v151, v106, v107
  v_mfma_f32_16x16x32_bf16 v[108:111], a[112:115], a[244:247], v[108:111]
  v_mfma_f32_16x16x32_bf16 v[108:111], a[124:127], v[164:167], v[108:111]
  v_mfma_f32_16x16x32_bf16 v[108:111], a[136:139], v[160:163], v[108:111]
  v_mfma_f32_16x16x32_bf16 v[104:107], a[140:143], v[160:163], 0
  v_mfma_f32_16x16x32_bf16 v[104:107], a[128:131], v[164:167], v[104:107]
  v_mfma_f32_16x16x32_bf16 v[104:107], a[116:119], a[244:247], v[104:107]
  v_cvt_pk_bf16_f32 v152, v108, v109
  v_cvt_pk_bf16_f32 v153, v110, v111
  v_mfma_f32_16x16x32_bf16 v[104:107], a[104:107], a[252:255], v[104:107]
  v_mfma_f32_16x16x32_bf16 v[104:107], a[92:95], a[248:251], v[104:107]
  v_mfma_f32_16x16x32_bf16 v[104:107], a[80:83], v[84:87], v[104:107]
  v_mfma_f32_16x16x32_bf16 v[112:115], v[70:73], v[76:79], v[36:39]
  v_mfma_f32_16x16x32_bf16 v[112:115], v[68:71], v[12:15], v[112:115]
  v_mfma_f32_16x16x32_bf16 v[116:119], v[122:125], v[76:79], v[32:35]
  v_cvt_pk_bf16_f32 v154, v104, v105
  v_cvt_pk_bf16_f32 v155, v106, v107
  v_mfma_f32_16x16x32_bf16 v[116:119], v[120:123], v[12:15], v[116:119]
  v_mfma_f32_16x16x32_bf16 v[128:131], v[146:149], v[76:79], v[28:31]
  v_exp_f32 v112, v112
  v_mfma_f32_16x16x32_bf16 v[128:131], v[144:147], v[12:15], v[128:131]
  v_exp_f32 v113, v113
  v_mfma_f32_16x16x32_bf16 v[132:135], v[152:155], v[76:79], v[24:27]
  v_exp_f32 v114, v114
  v_mfma_f32_16x16x32_bf16 v[132:135], v[150:153], v[12:15], v[132:135]
  v_exp_f32 v115, v115
  v_mfma_f32_16x16x32_bf16 v[104:107], v[68:71], v[100:103], v[40:43]
  v_exp_f32 v116, v116
  v_mfma_f32_16x16x32_bf16 v[104:107], v[70:73], v[14:17], v[104:107]
  v_exp_f32 v117, v117
  v_mfma_f32_16x16x32_bf16 v[108:111], v[120:123], v[100:103], v[36:39]
  v_exp_f32 v118, v118
  v_mfma_f32_16x16x32_bf16 v[108:111], v[122:125], v[14:17], v[108:111]
  v_exp_f32 v119, v119
  v_mfma_f32_16x16x32_bf16 v[74:77], v[144:147], v[100:103], v[32:35]
  v_exp_f32 v128, v128
  v_mfma_f32_16x16x32_bf16 v[74:77], v[146:149], v[14:17], v[74:77]
  v_exp_f32 v129, v129
  v_mfma_f32_16x16x32_bf16 v[168:171], v[150:153], v[100:103], v[28:31]
  v_exp_f32 v130, v130
  v_mfma_f32_16x16x32_bf16 v[168:171], v[152:155], v[14:17], v[168:171]
  v_exp_f32 v131, v131
  v_mfma_f32_16x16x32_bf16 v[100:103], a[0:3], v[88:91], 0
  v_exp_f32 v132, v132
  v_mfma_f32_16x16x32_bf16 v[100:103], a[12:15], v[92:95], v[100:103]
  v_exp_f32 v133, v133
  v_mfma_f32_16x16x32_bf16 v[100:103], a[24:27], v[96:99], v[100:103]
  v_exp_f32 v134, v134
  v_mfma_f32_16x16x32_bf16 v[100:103], a[36:39], v[136:139], v[100:103]
  v_exp_f32 v135, v135
  v_mfma_f32_16x16x32_bf16 v[100:103], a[48:51], v[140:143], v[100:103]
  v_cvt_pk_bf16_f32 v112, v112, v113
  v_cvt_pk_bf16_f32 v113, v114, v115
  v_mfma_f32_16x16x32_bf16 v[100:103], a[60:63], v[80:83], v[100:103]
  v_cvt_pk_bf16_f32 v114, v116, v117
  v_cvt_pk_bf16_f32 v115, v118, v119
  v_mfma_f32_16x16x32_bf16 v[172:175], a[64:67], v[80:83], 0
  v_cvt_pk_bf16_f32 v116, v128, v129
  v_cvt_pk_bf16_f32 v117, v130, v131
  v_mfma_f32_16x16x32_bf16 v[172:175], a[52:55], v[140:143], v[172:175]
  v_cvt_pk_bf16_f32 v118, v132, v133
  v_cvt_pk_bf16_f32 v119, v134, v135
  v_mfma_f32_16x16x32_bf16 v[172:175], a[40:43], v[136:139], v[172:175]
  v_mul_f32 v100, s42, v100
  v_mul_f32 v101, s42, v101
  v_mfma_f32_16x16x32_bf16 v[172:175], a[28:31], v[96:99], v[172:175]
  v_mul_f32 v102, s42, v102
  v_mul_f32 v103, s42, v103
  v_mfma_f32_16x16x32_bf16 v[172:175], a[16:19], v[92:95], v[172:175]
  v_cvt_pk_bf16_f32 v18, v100, v101
  v_cvt_pk_bf16_f32 v19, v102, v103
  v_mfma_f32_16x16x32_bf16 v[172:175], a[4:7], v[88:91], v[172:175]
  v_exp_f32 v104, v104
  v_mfma_f32_16x16x32_bf16 v[128:131], a[8:11], v[88:91], 0
  v_exp_f32 v105, v105
  v_mfma_f32_16x16x32_bf16 v[128:131], a[20:23], v[92:95], v[128:131]
  v_exp_f32 v106, v106
  v_mfma_f32_16x16x32_bf16 v[128:131], a[32:35], v[96:99], v[128:131]
  v_mul_f32 v172, s42, v172
  v_mul_f32 v173, s42, v173
  v_mfma_f32_16x16x32_bf16 v[128:131], a[44:47], v[136:139], v[128:131]
  v_mul_f32 v174, s42, v174
  v_mul_f32 v175, s42, v175
  v_mfma_f32_16x16x32_bf16 v[128:131], a[56:59], v[140:143], v[128:131]
  v_cvt_pk_bf16_f32 v176, v172, v173
  v_cvt_pk_bf16_f32 v177, v174, v175
  v_mfma_f32_16x16x32_bf16 v[128:131], a[68:71], v[80:83], v[128:131]
  v_exp_f32 v107, v107
  v_mfma_f32_16x16x32_bf16 v[132:135], a[0:3], v[84:87], 0
  v_exp_f32 v108, v108
  v_mfma_f32_16x16x32_bf16 v[132:135], a[12:15], a[248:251], v[132:135]
  v_exp_f32 v109, v109
  v_mfma_f32_16x16x32_bf16 v[132:135], a[24:27], a[252:255], v[132:135]
  v_mul_f32 v128, s42, v128
  v_mul_f32 v129, s42, v129
  v_mfma_f32_16x16x32_bf16 v[132:135], a[36:39], a[244:247], v[132:135]
  v_mul_f32 v130, s42, v130
  v_mul_f32 v131, s42, v131
  v_mfma_f32_16x16x32_bf16 v[132:135], a[48:51], v[164:167], v[132:135]
  v_cvt_pk_bf16_f32 v178, v128, v129
  v_cvt_pk_bf16_f32 v179, v130, v131
  v_mfma_f32_16x16x32_bf16 v[132:135], a[60:63], v[160:163], v[132:135]
  v_exp_f32 v110, v110
  v_mfma_f32_16x16x32_bf16 v[172:175], a[64:67], v[160:163], 0
  v_exp_f32 v111, v111
  v_mfma_f32_16x16x32_bf16 v[172:175], a[52:55], v[164:167], v[172:175]
  v_exp_f32 v74, v74
  v_mfma_f32_16x16x32_bf16 v[172:175], a[40:43], a[244:247], v[172:175]
  v_mul_f32 v132, s42, v132
  v_mul_f32 v133, s42, v133
  v_mfma_f32_16x16x32_bf16 v[172:175], a[28:31], a[252:255], v[172:175]
  v_mul_f32 v134, s42, v134
  v_mul_f32 v135, s42, v135
  v_mfma_f32_16x16x32_bf16 v[172:175], a[16:19], a[248:251], v[172:175]
  v_cvt_pk_bf16_f32 v180, v132, v133
  v_cvt_pk_bf16_f32 v181, v134, v135
  v_mfma_f32_16x16x32_bf16 v[172:175], a[4:7], v[84:87], v[172:175]
  v_exp_f32 v75, v75
  v_mfma_f32_16x16x32_bf16 v[100:103], a[8:11], v[84:87], 0
  v_exp_f32 v76, v76
  v_mfma_f32_16x16x32_bf16 v[100:103], a[20:23], a[248:251], v[100:103]
  v_exp_f32 v77, v77
  v_mfma_f32_16x16x32_bf16 v[100:103], a[32:35], a[252:255], v[100:103]
  v_mul_f32 v172, s42, v172
  v_mul_f32 v173, s42, v173
  v_mfma_f32_16x16x32_bf16 v[100:103], a[44:47], a[244:247], v[100:103]
  v_mul_f32 v174, s42, v174
  v_mul_f32 v175, s42, v175
  v_mfma_f32_16x16x32_bf16 v[100:103], a[56:59], v[164:167], v[100:103]
  v_cvt_pk_bf16_f32 v182, v172, v173
  v_cvt_pk_bf16_f32 v183, v174, v175
  v_mfma_f32_16x16x32_bf16 v[100:103], a[68:71], v[160:163], v[100:103]
  v_exp_f32 v168, v168
  v_mfma_f32_16x16x32_bf16 v[128:131], v[146:149], v[176:179], v[36:39]
  v_exp_f32 v169, v169
  v_mfma_f32_16x16x32_bf16 v[128:131], v[144:147], v[18:21], v[128:131]
  v_exp_f32 v170, v170
  v_mfma_f32_16x16x32_bf16 v[132:135], v[152:155], v[176:179], v[32:35]
  v_mul_f32 v100, s42, v100
  v_mul_f32 v101, s42, v101
  v_mfma_f32_16x16x32_bf16 v[132:135], v[150:153], v[18:21], v[132:135]
  v_mul_f32 v102, s42, v102
  v_mul_f32 v103, s42, v103
  v_mfma_f32_16x16x32_bf16 v[156:159], v[70:73], v[176:179], v[44:47]
  v_cvt_pk_bf16_f32 v22, v100, v101
  v_cvt_pk_bf16_f32 v23, v102, v103
  v_mfma_f32_16x16x32_bf16 v[156:159], v[68:71], v[18:21], v[156:159]
  v_exp_f32 v171, v171
  v_mfma_f32_16x16x32_bf16 v[172:175], v[122:125], v[176:179], v[40:43]
  v_cvt_pk_bf16_f32 v104, v104, v105
  v_cvt_pk_bf16_f32 v105, v106, v107
  v_mfma_f32_16x16x32_bf16 v[172:175], v[120:123], v[18:21], v[172:175]
  v_cvt_pk_bf16_f32 v106, v108, v109
  v_cvt_pk_bf16_f32 v107, v110, v111
  v_mfma_f32_16x16x32_bf16 v[176:179], v[88:91], a[144:147], 0
  v_cvt_pk_bf16_f32 v108, v74, v75
  v_cvt_pk_bf16_f32 v109, v76, v77
  v_mfma_f32_16x16x32_bf16 v[176:179], v[92:95], a[156:159], v[176:179]
  v_cvt_pk_bf16_f32 v110, v168, v169
  v_cvt_pk_bf16_f32 v111, v170, v171
  v_mfma_f32_16x16x32_bf16 v[176:179], v[96:99], a[168:171], v[176:179]
  v_exp_f32 v128, v128
  v_mfma_f32_16x16x32_bf16 v[176:179], v[136:139], a[180:183], v[176:179]
  v_exp_f32 v129, v129
  v_mfma_f32_16x16x32_bf16 v[176:179], v[140:143], a[192:195], v[176:179]
  v_exp_f32 v130, v130
  v_mfma_f32_16x16x32_bf16 v[176:179], v[80:83], a[204:207], v[176:179]
  v_exp_f32 v131, v131
  v_mfma_f32_16x16x32_bf16 v[76:79], v[80:83], a[208:211], 0
  v_exp_f32 v132, v132
  v_mfma_f32_16x16x32_bf16 v[76:79], v[140:143], a[196:199], v[76:79]
  v_exp_f32 v133, v133
  v_mfma_f32_16x16x32_bf16 v[76:79], v[136:139], a[184:187], v[76:79]
  v_cvt_pk_bf16_f32 v100, v176, v177
  v_cvt_pk_bf16_f32 v101, v178, v179
  v_mfma_f32_16x16x32_bf16 v[76:79], v[96:99], a[172:175], v[76:79]
  v_exp_f32 v134, v134
  v_mfma_f32_16x16x32_bf16 v[76:79], v[92:95], a[160:163], v[76:79]
  v_exp_f32 v135, v135
  v_mfma_f32_16x16x32_bf16 v[76:79], v[88:91], a[148:151], v[76:79]
  v_exp_f32 v156, v156
  v_mfma_f32_16x16x32_bf16 v[168:171], v[88:91], a[152:155], 0
  v_exp_f32 v157, v157
  v_mfma_f32_16x16x32_bf16 v[168:171], v[92:95], a[164:167], v[168:171]
  v_exp_f32 v158, v158
  v_mfma_f32_16x16x32_bf16 v[168:171], v[96:99], a[176:179], v[168:171]
  v_cvt_pk_bf16_f32 v88, v76, v77
  v_cvt_pk_bf16_f32 v89, v78, v79
  v_mfma_f32_16x16x32_bf16 v[168:171], v[136:139], a[188:191], v[168:171]
  v_exp_f32 v159, v159
  v_mfma_f32_16x16x32_bf16 v[168:171], v[140:143], a[200:203], v[168:171]
  v_exp_f32 v172, v172
  v_mfma_f32_16x16x32_bf16 v[168:171], v[80:83], a[212:215], v[168:171]
  v_exp_f32 v173, v173
  v_mfma_f32_16x16x32_bf16 v[76:79], v[144:147], v[180:183], v[40:43]
  v_exp_f32 v174, v174
  v_mfma_f32_16x16x32_bf16 v[76:79], v[146:149], v[20:23], v[76:79]
  v_exp_f32 v175, v175
  v_mfma_f32_16x16x32_bf16 v[80:83], v[150:153], v[180:183], v[36:39]
  v_cvt_pk_bf16_f32 v92, v168, v169
  v_cvt_pk_bf16_f32 v93, v170, v171
  v_mfma_f32_16x16x32_bf16 v[80:83], v[152:155], v[20:23], v[80:83]
  v_cvt_pk_bf16_f32 v128, v128, v129
  v_cvt_pk_bf16_f32 v129, v130, v131
  v_mfma_f32_16x16x32_bf16 v[144:147], v[68:71], v[180:183], v[48:51]
  v_cvt_pk_bf16_f32 v130, v132, v133
  v_cvt_pk_bf16_f32 v131, v134, v135
  v_mfma_f32_16x16x32_bf16 v[144:147], v[70:73], v[20:23], v[144:147]
  v_cvt_pk_bf16_f32 v132, v156, v157
  v_cvt_pk_bf16_f32 v133, v158, v159
  v_mfma_f32_16x16x32_bf16 v[152:155], v[120:123], v[180:183], v[44:47]
  v_cvt_pk_bf16_f32 v134, v172, v173
  v_cvt_pk_bf16_f32 v135, v174, v175
  v_mfma_f32_16x16x32_bf16 v[152:155], v[122:125], v[20:23], v[152:155]
  v_exp_f32 v76, v76
  v_mfma_f32_16x16x32_bf16 v[140:143], v[84:87], a[144:147], 0
  v_exp_f32 v77, v77
  v_mfma_f32_16x16x32_bf16 v[140:143], a[248:251], a[156:159], v[140:143]
  v_exp_f32 v78, v78
  v_mfma_f32_16x16x32_bf16 v[140:143], a[252:255], a[168:171], v[140:143]
  ds_read_b128 v[68:71], v3 offset:0
  v_cvt_pk_bf16_f32 v76, v76, v77
  v_mfma_f32_16x16x32_bf16 v[140:143], a[244:247], a[180:183], v[140:143]
  ds_read_b128 v[72:75], v3 offset:4096
  v_mfma_f32_16x16x32_bf16 v[140:143], v[164:167], a[192:195], v[140:143]
  ds_read_b128 v[96:99], v3 offset:8192
  v_mfma_f32_16x16x32_bf16 v[140:143], v[160:163], a[204:207], v[140:143]
  ds_read_b128 v[120:123], v3 offset:12288
  v_mfma_f32_16x16x32_bf16 v[148:151], v[160:163], a[208:211], 0
  ds_read_b128 v[124:127], v3 offset:16384
  v_mfma_f32_16x16x32_bf16 v[148:151], v[164:167], a[196:199], v[148:151]
  ds_read_b128 v[136:139], v3 offset:20480
  v_mfma_f32_16x16x32_bf16 v[148:151], a[244:247], a[184:187], v[148:151]
  v_cvt_pk_bf16_f32 v102, v140, v141
  v_cvt_pk_bf16_f32 v103, v142, v143
  v_mfma_f32_16x16x32_bf16 v[148:151], a[252:255], a[172:175], v[148:151]
  v_exp_f32 v79, v79
  v_mfma_f32_16x16x32_bf16 v[148:151], a[248:251], a[160:163], v[148:151]
  v_exp_f32 v80, v80
  v_mfma_f32_16x16x32_bf16 v[148:151], v[84:87], a[148:151], v[148:151]
  v_exp_f32 v81, v81
  v_mfma_f32_16x16x32_bf16 v[156:159], v[84:87], a[152:155], 0
  v_exp_f32 v82, v82
  v_mfma_f32_16x16x32_bf16 v[156:159], a[248:251], a[164:167], v[156:159]
  v_exp_f32 v83, v83
  v_mfma_f32_16x16x32_bf16 v[156:159], a[252:255], a[176:179], v[156:159]
  v_cvt_pk_bf16_f32 v90, v148, v149
  v_cvt_pk_bf16_f32 v91, v150, v151
  v_mfma_f32_16x16x32_bf16 v[156:159], a[244:247], a[188:191], v[156:159]
  v_mov_b64 v[168:169], 0
  v_cvt_pk_bf16_f32 v77, v78, v79
  v_mfma_f32_16x16x32_bf16 v[156:159], v[164:167], a[200:203], v[156:159]
  v_exp_f32 v144, v144
  v_mfma_f32_16x16x32_bf16 v[156:159], v[160:163], a[212:215], v[156:159]
  s_waitcnt lgkmcnt(0)
  v_exp_f32 v145, v145
  v_mfma_f32_16x16x32_bf16 v[140:143], v[68:71], v[184:187], 0
  v_exp_f32 v146, v146
  v_mfma_f32_16x16x32_bf16 v[140:143], v[72:75], v[200:203], v[140:143]
  v_exp_f32 v147, v147
  v_mfma_f32_16x16x32_bf16 v[140:143], v[96:99], v[216:219], v[140:143]
  v_cvt_pk_bf16_f32 v94, v156, v157
  v_cvt_pk_bf16_f32 v95, v158, v159
  v_mfma_f32_16x16x32_bf16 v[140:143], v[120:123], v[232:235], v[140:143]
  v_mov_b64 v[148:149], 0
  v_cvt_pk_bf16_f32 v78, v80, v81
  v_mfma_f32_16x16x32_bf16 v[140:143], v[124:127], v[248:251], v[140:143]
  v_exp_f32 v152, v152
  v_mfma_f32_16x16x32_bf16 v[140:143], v[136:139], a[224:227], v[140:143]
  v_exp_f32 v153, v153
  v_smfmac_f32_16x16x64_bf16 v[168:171], a[240:243], v[112:119], v10
  v_exp_f32 v154, v154
  v_mfma_f32_16x16x32_bf16 v[156:159], v[100:103], v[116:119], 0
  v_exp_f32 v155, v155
  v_mfma_f32_16x16x32_bf16 v[156:159], v[56:59], v[112:115], v[156:159]
  v_cvt_pk_bf16_f32 v79, v82, v83
  v_cvt_pk_bf16_f32 v80, v144, v145
  v_mfma_f32_16x16x32_bf16 v[160:163], v[60:63], v[112:115], 0
  v_cvt_pk_bf16_f32 v81, v146, v147
  v_cvt_pk_bf16_f32 v82, v152, v153
  v_mfma_f32_16x16x32_bf16 v[160:163], v[88:91], v[116:119], v[160:163]
  v_cvt_pk_bf16_f32 v83, v154, v155
  v_mfma_f32_16x16x32_bf16 v[164:167], v[92:95], v[116:119], 0
  v_add_f32 v168, v168, v169
  v_rcp_f32 v170, v168
  v_mfma_f32_16x16x32_bf16 v[164:167], v[64:67], v[112:115], v[164:167]
  v_max3_f32 v9, v168, v170, v9
  v_mul_f32 v156, v170, v156
  v_mul_f32 v157, v170, v157
  v_smfmac_f32_16x16x64_bf16 v[148:151], a[240:243], v[104:111], v10
  v_mul_f32 v158, v170, v158
  v_mul_f32 v159, v170, v159
  v_cvt_pk_bf16_f32 v156, v156, v157
  v_mfma_f32_16x16x32_bf16 v[144:147], v[100:103], v[108:111], 0
  v_cvt_pk_bf16_f32 v157, v158, v159
  v_mul_f32 v160, v170, v160
  v_mul_f32 v161, v170, v161
  v_mfma_f32_16x16x32_bf16 v[144:147], v[56:59], v[104:107], v[144:147]
  v_mul_f32 v162, v170, v162
  v_mul_f32 v163, v170, v163
  v_cvt_pk_bf16_f32 v160, v160, v161
  v_mfma_f32_16x16x32_bf16 v[112:115], v[60:63], v[104:107], 0
  v_cvt_pk_bf16_f32 v161, v162, v163
  v_mul_f32 v164, v170, v164
  v_mul_f32 v165, v170, v165
  v_mfma_f32_16x16x32_bf16 v[112:115], v[88:91], v[108:111], v[112:115]
  v_mul_f32 v166, v170, v166
  v_mul_f32 v167, v170, v167
  v_cvt_pk_bf16_f32 v164, v164, v165
  v_mfma_f32_16x16x32_bf16 v[84:87], v[92:95], v[108:111], 0
  v_add_f32 v148, v148, v149
  v_rcp_f32 v150, v148
  v_mfma_f32_16x16x32_bf16 v[84:87], v[64:67], v[104:107], v[84:87]
  v_cvt_pk_bf16_f32 v165, v166, v167
  v_max3_f32 v9, v148, v150, v9
  v_mul_f32 v144, v150, v144
  v_mfma_f32_16x16x32_bf16 v[104:107], v[136:139], a[228:231], 0
  v_mul_f32 v145, v150, v145
  v_mul_f32 v146, v150, v146
  v_mul_f32 v147, v150, v147
  v_mfma_f32_16x16x32_bf16 v[104:107], v[124:127], v[252:255], v[104:107]
  v_cvt_pk_bf16_f32 v144, v144, v145
  v_cvt_pk_bf16_f32 v145, v146, v147
  v_mul_f32 v112, v150, v112
  v_mfma_f32_16x16x32_bf16 v[104:107], v[120:123], v[236:239], v[104:107]
  v_mov_b64 v[172:173], 0
  v_mul_f32 v113, v150, v113
  v_mul_f32 v114, v150, v114
  v_mfma_f32_16x16x32_bf16 v[104:107], v[96:99], v[220:223], v[104:107]
  v_mul_f32 v115, v150, v115
  v_cvt_pk_bf16_f32 v112, v112, v113
  v_cvt_pk_bf16_f32 v113, v114, v115
  v_mfma_f32_16x16x32_bf16 v[104:107], v[72:75], v[204:207], v[104:107]
  v_mul_f32 v84, v150, v84
  v_mul_f32 v85, v150, v85
  v_mul_f32 v86, v150, v86
  v_mfma_f32_16x16x32_bf16 v[104:107], v[68:71], v[188:191], v[104:107]
  v_mul_f32 v87, v150, v87
  v_cvt_pk_bf16_f32 v84, v84, v85
  v_cvt_pk_bf16_f32 v85, v86, v87
  v_mfma_f32_16x16x32_bf16 v[152:155], v[68:71], v[192:195], 0
  ds_write2st64_b32 v5, v156, v157 offset0:0 offset1:4
  v_mfma_f32_16x16x32_bf16 v[152:155], v[72:75], v[208:211], v[152:155]
  ds_write2st64_b32 v5, v160, v161 offset0:8 offset1:12
  v_mfma_f32_16x16x32_bf16 v[152:155], v[96:99], v[224:227], v[152:155]
  v_cvt_pk_bf16_f32 v140, v140, v104
  v_cvt_pk_bf16_f32 v141, v141, v105
  v_mfma_f32_16x16x32_bf16 v[152:155], v[120:123], v[240:243], v[152:155]
  ds_read_b128 a[248:251], v4 offset:0
  v_cvt_pk_bf16_f32 v142, v142, v106
  v_cvt_pk_bf16_f32 v143, v143, v107
  v_mfma_f32_16x16x32_bf16 v[152:155], v[124:127], a[216:219], v[152:155]
  buffer_store_dword v140, v7, s[24:27], s33 offen offset:0 nt
  v_mfma_f32_16x16x32_bf16 v[152:155], v[136:139], a[232:235], v[152:155]
  ds_read_b128 v[148:151], v4 offset:4096
  ds_read_b128 v[156:159], v4 offset:8192
  v_smfmac_f32_16x16x64_bf16 v[172:175], a[240:243], v[128:135], v10
  ds_read_b128 v[160:163], v4 offset:12288
  ds_read_b128 v[168:171], v4 offset:16384
  v_mfma_f32_16x16x32_bf16 v[108:111], v[56:59], v[132:135], 0
  buffer_store_dword v141, v7, s[24:27], s33 offen offset:384 nt
  v_mfma_f32_16x16x32_bf16 v[108:111], v[100:103], v[128:131], v[108:111]
  ds_read_b128 v[176:179], v4 offset:20480
  v_mfma_f32_16x16x32_bf16 v[116:119], v[88:91], v[128:131], 0
  ds_write2st64_b32 v5, v164, v165 offset0:16 offset1:20
  v_mfma_f32_16x16x32_bf16 v[116:119], v[60:63], v[132:135], v[116:119]
  buffer_store_dword v142, v7, s[24:27], s33 offen offset:768 nt
  v_mfma_f32_16x16x32_bf16 v[104:107], v[64:67], v[132:135], 0
  v_add_f32 v172, v172, v173
  v_rcp_f32 v174, v172
  v_mfma_f32_16x16x32_bf16 v[104:107], v[92:95], v[128:131], v[104:107]
  v_max3_f32 v9, v172, v174, v9
  v_mul_f32 v108, v174, v108
  v_mul_f32 v109, v174, v109
  v_mfma_f32_16x16x32_bf16 v[132:135], v[136:139], a[236:239], 0
  buffer_store_dword v143, v7, s[24:27], s33 offen offset:1152 nt
  v_mul_f32 v110, v174, v110
  v_mfma_f32_16x16x32_bf16 v[132:135], v[124:127], a[220:223], v[132:135]
  v_mul_f32 v111, v174, v111
  v_cvt_pk_bf16_f32 v108, v108, v109
  v_cvt_pk_bf16_f32 v109, v110, v111
  v_mfma_f32_16x16x32_bf16 v[132:135], v[120:123], v[244:247], v[132:135]
  v_mov_b64 v[128:129], 0
  v_mul_f32 v116, v174, v116
  v_mul_f32 v117, v174, v117
  v_mfma_f32_16x16x32_bf16 v[132:135], v[96:99], v[228:231], v[132:135]
  v_mul_f32 v118, v174, v118
  v_mul_f32 v119, v174, v119
  v_cvt_pk_bf16_f32 v116, v116, v117
  v_mfma_f32_16x16x32_bf16 v[132:135], v[72:75], v[212:215], v[132:135]
  v_cvt_pk_bf16_f32 v117, v118, v119
  v_mul_f32 v104, v174, v104
  v_mul_f32 v105, v174, v105
  v_mfma_f32_16x16x32_bf16 v[132:135], v[68:71], v[196:199], v[132:135]
  s_waitcnt lgkmcnt(1)
  v_mul_f32 v106, v174, v106
  v_mul_f32 v107, v174, v107
  v_cvt_pk_bf16_f32 v104, v104, v105
  v_mfma_f32_16x16x32_bf16 v[96:99], a[248:251], v[184:187], 0
  v_cvt_pk_bf16_f32 v105, v106, v107
  v_mfma_f32_16x16x32_bf16 v[96:99], v[148:151], v[200:203], v[96:99]
  ds_write2st64_b32 v5, v144, v145 offset0:1 offset1:5
  v_mfma_f32_16x16x32_bf16 v[96:99], v[156:159], v[216:219], v[96:99]
  v_cvt_pk_bf16_f32 v152, v152, v132
  v_cvt_pk_bf16_f32 v153, v153, v133
  v_mfma_f32_16x16x32_bf16 v[96:99], v[160:163], v[232:235], v[96:99]
  ds_read_b128 a[244:247], v3 offset:512
  v_cvt_pk_bf16_f32 v154, v154, v134
  v_cvt_pk_bf16_f32 v155, v155, v135
  v_mfma_f32_16x16x32_bf16 v[96:99], v[168:171], v[248:251], v[96:99]
  buffer_store_dword v152, v8, s[24:27], s33 offen offset:0 nt
  v_mfma_f32_16x16x32_bf16 v[96:99], v[176:179], a[224:227], v[96:99]
  ds_read_b128 a[252:255], v3 offset:4608
  ds_read_b128 v[68:71], v3 offset:8704
  v_smfmac_f32_16x16x64_bf16 v[128:131], a[240:243], v[76:83], v10
  ds_read_b128 v[72:75], v3 offset:12800
  ds_read_b128 v[120:123], v3 offset:16896
  v_mfma_f32_16x16x32_bf16 v[132:135], v[56:59], v[80:83], 0
  buffer_store_dword v153, v8, s[24:27], s33 offen offset:384 nt
  v_mfma_f32_16x16x32_bf16 v[132:135], v[100:103], v[76:79], v[132:135]
  ds_read_b128 v[124:127], v3 offset:20992
  v_xor_b32 v3, 40960, v3
  v_mfma_f32_16x16x32_bf16 v[136:139], v[88:91], v[76:79], 0
  ds_write2st64_b32 v5, v112, v113 offset0:9 offset1:13
  v_mfma_f32_16x16x32_bf16 v[136:139], v[60:63], v[80:83], v[136:139]
  buffer_store_dword v154, v8, s[24:27], s33 offen offset:768 nt
  v_mfma_f32_16x16x32_bf16 v[56:59], v[64:67], v[80:83], 0
  v_add_f32 v128, v128, v129
  v_rcp_f32 v130, v128
  v_mfma_f32_16x16x32_bf16 v[56:59], v[92:95], v[76:79], v[56:59]
  v_max3_f32 v9, v128, v130, v9
  v_mul_f32 v132, v130, v132
  v_mul_f32 v133, v130, v133
  v_mfma_f32_16x16x32_bf16 v[60:63], v[176:179], a[228:231], 0
  buffer_store_dword v155, v8, s[24:27], s33 offen offset:1152 nt
  v_mul_f32 v134, v130, v134
  v_mfma_f32_16x16x32_bf16 v[60:63], v[168:171], v[252:255], v[60:63]
  s_add_u32 s33, s33, s98
  v_mul_f32 v135, v130, v135
  v_cvt_pk_bf16_f32 v132, v132, v133
  v_cvt_pk_bf16_f32 v133, v134, v135
  v_mfma_f32_16x16x32_bf16 v[60:63], v[160:163], v[236:239], v[60:63]
  v_mul_f32 v136, v130, v136
  v_mul_f32 v137, v130, v137
  v_mul_f32 v138, v130, v138
  v_mfma_f32_16x16x32_bf16 v[60:63], v[156:159], v[220:223], v[60:63]
  v_mul_f32 v139, v130, v139
  v_cvt_pk_bf16_f32 v136, v136, v137
  v_cvt_pk_bf16_f32 v137, v138, v139
  v_mfma_f32_16x16x32_bf16 v[60:63], v[148:151], v[204:207], v[60:63]
  v_mul_f32 v56, v130, v56
  v_mul_f32 v57, v130, v57
  v_mul_f32 v58, v130, v58
  v_mfma_f32_16x16x32_bf16 v[60:63], a[248:251], v[188:191], v[60:63]
  s_waitcnt lgkmcnt(1)
  v_mul_f32 v59, v130, v59
  v_cvt_pk_bf16_f32 v56, v56, v57
  v_cvt_pk_bf16_f32 v57, v58, v59
  v_mfma_f32_16x16x32_bf16 v[76:79], a[244:247], v[184:187], 0
  v_cmp_nge_f32 vcc, 0x53800000, v9
  v_mfma_f32_16x16x32_bf16 v[76:79], a[252:255], v[200:203], v[76:79]
  ds_write2st64_b32 v5, v84, v85 offset0:17 offset1:21
  v_mfma_f32_16x16x32_bf16 v[76:79], v[68:71], v[216:219], v[76:79]
  s_or_b32 s6, vcc_lo, vcc_hi
  v_cvt_pk_bf16_f32 v96, v96, v60
  v_cvt_pk_bf16_f32 v97, v97, v61
  v_mov_b32 v54, s6
  v_mfma_f32_16x16x32_bf16 v[76:79], v[72:75], v[232:235], v[76:79]
  v_cvt_pk_bf16_f32 v98, v98, v62
  v_cvt_pk_bf16_f32 v99, v99, v63
  v_mfma_f32_16x16x32_bf16 v[76:79], v[120:123], v[248:251], v[76:79]
  buffer_store_dword v96, v7, s[24:27], s34 offen offset:0 nt
  v_mfma_f32_16x16x32_bf16 v[76:79], v[124:127], a[224:227], v[76:79]
  ds_write2st64_b32 v5, v108, v109 offset0:2 offset1:6
  v_mfma_f32_16x16x32_bf16 v[80:83], v[124:127], a[228:231], 0
  ds_write2st64_b32 v5, v116, v117 offset0:10 offset1:14
  v_mfma_f32_16x16x32_bf16 v[80:83], v[120:123], v[252:255], v[80:83]
  buffer_store_dword v97, v7, s[24:27], s34 offen offset:384 nt
  v_mfma_f32_16x16x32_bf16 v[80:83], v[72:75], v[236:239], v[80:83]
  ds_read_b128 a[248:251], v4 offset:512
  ds_read_b128 v[60:63], v4 offset:4608
  v_mfma_f32_16x16x32_bf16 v[80:83], v[68:71], v[220:223], v[80:83]
  ds_write2st64_b32 v5, v104, v105 offset0:18 offset1:22
  v_mfma_f32_16x16x32_bf16 v[80:83], a[252:255], v[204:207], v[80:83]
  buffer_store_dword v98, v7, s[24:27], s34 offen offset:768 nt
  v_mfma_f32_16x16x32_bf16 v[80:83], a[244:247], v[188:191], v[80:83]
  ds_write2st64_b32 v5, v132, v133 offset0:3 offset1:7
  v_mfma_f32_16x16x32_bf16 v[64:67], a[244:247], v[192:195], 0
  ds_write2st64_b32 v5, v136, v137 offset0:11 offset1:15
  v_mfma_f32_16x16x32_bf16 v[64:67], a[252:255], v[208:211], v[64:67]
  buffer_store_dword v99, v7, s[24:27], s34 offen offset:1152 nt
  v_mfma_f32_16x16x32_bf16 v[64:67], v[68:71], v[224:227], v[64:67]
  s_add_u32 s34, s34, s98
  ds_read_b128 v[84:87], v4 offset:8704
  v_cvt_pk_bf16_f32 v76, v76, v80
  v_cvt_pk_bf16_f32 v77, v77, v81
  v_mfma_f32_16x16x32_bf16 v[64:67], v[72:75], v[240:243], v[64:67]
  ds_read_b128 v[92:95], v4 offset:12800
  v_cvt_pk_bf16_f32 v78, v78, v82
  v_cvt_pk_bf16_f32 v79, v79, v83
  v_mfma_f32_16x16x32_bf16 v[64:67], v[120:123], a[216:219], v[64:67]
  buffer_store_dword v76, v7, s[24:27], s35 offen offset:0 nt
  v_mfma_f32_16x16x32_bf16 v[64:67], v[124:127], a[232:235], v[64:67]
  ds_write2st64_b32 v5, v56, v57 offset0:19 offset1:23
  v_mfma_f32_16x16x32_bf16 v[96:99], v[124:127], a[236:239], 0
  ds_read_b128 v[88:91], v4 offset:16896
  ds_write_b32 v11, v54
  v_mfma_f32_16x16x32_bf16 v[96:99], v[120:123], a[220:223], v[96:99]
  buffer_store_dword v77, v7, s[24:27], s35 offen offset:384 nt
  v_mov_b32 v11, 159744
  v_mfma_f32_16x16x32_bf16 v[96:99], v[72:75], v[244:247], v[96:99]
  ds_read_b128 v[100:103], v4 offset:20992
  v_xor_b32 v4, 40960, v4
  v_mfma_f32_16x16x32_bf16 v[96:99], v[68:71], v[228:231], v[96:99]
  v_mfma_f32_16x16x32_bf16 v[96:99], a[252:255], v[212:215], v[96:99]
  buffer_store_dword v78, v7, s[24:27], s35 offen offset:768 nt
  v_mfma_f32_16x16x32_bf16 v[96:99], a[244:247], v[196:199], v[96:99]
  s_waitcnt lgkmcnt(9)
  v_mfma_f32_16x16x32_bf16 v[80:83], a[248:251], v[184:187], 0
  s_waitcnt lgkmcnt(1)
  s_barrier
  v_mfma_f32_16x16x32_bf16 v[80:83], v[60:63], v[200:203], v[80:83]
  buffer_store_dword v79, v7, s[24:27], s35 offen offset:1152 nt
  v_mfma_f32_16x16x32_bf16 v[80:83], v[84:87], v[216:219], v[80:83]
  s_waitcnt lgkmcnt(0)
  v_cvt_pk_bf16_f32 v64, v64, v96
  v_cvt_pk_bf16_f32 v65, v65, v97
  v_mfma_f32_16x16x32_bf16 v[80:83], v[92:95], v[232:235], v[80:83]
  v_cvt_pk_bf16_f32 v66, v66, v98
  v_cvt_pk_bf16_f32 v67, v67, v99
  v_mfma_f32_16x16x32_bf16 v[80:83], v[88:91], v[248:251], v[80:83]
  buffer_store_dword v64, v8, s[24:27], s35 offen offset:0 nt
  v_mfma_f32_16x16x32_bf16 v[80:83], v[100:103], a[224:227], v[80:83]
  ds_read_b128 a[252:255], v3 offset:0
  ds_read_b128 v[56:59], v3 offset:4096
  v_mfma_f32_16x16x32_bf16 v[76:79], v[100:103], a[228:231], 0
  ds_read_b128 v[68:71], v3 offset:8192
  ds_read_b128 v[72:75], v3 offset:12288
  v_mfma_f32_16x16x32_bf16 v[76:79], v[88:91], v[252:255], v[76:79]
  buffer_store_dword v65, v8, s[24:27], s35 offen offset:384 nt
  v_mfma_f32_16x16x32_bf16 v[76:79], v[92:95], v[236:239], v[76:79]
  ds_read_b128 a[244:247], v3 offset:16384
  ds_read_b128 v[88:91], v3 offset:20480
  v_mfma_f32_16x16x32_bf16 v[76:79], v[84:87], v[220:223], v[76:79]
  ds_read2_b32 v[92:93], v11 offset0:0 offset1:2
  ds_read2_b32 v[94:95], v11 offset0:4 offset1:6
  v_mfma_f32_16x16x32_bf16 v[76:79], v[60:63], v[204:207], v[76:79]
  buffer_store_dword v66, v8, s[24:27], s35 offen offset:768 nt
  v_mfma_f32_16x16x32_bf16 v[76:79], a[248:251], v[188:191], v[76:79]
  s_waitcnt lgkmcnt(4)
  v_mfma_f32_16x16x32_bf16 v[60:63], a[252:255], v[184:187], 0
  buffer_store_dword v67, v8, s[24:27], s35 offen offset:1152 nt
  v_mfma_f32_16x16x32_bf16 v[60:63], v[56:59], v[200:203], v[60:63]
  s_add_u32 s35, s35, s98
  v_mfma_f32_16x16x32_bf16 v[60:63], v[68:71], v[216:219], v[60:63]
  s_waitcnt lgkmcnt(0)
  v_cvt_pk_bf16_f32 v80, v80, v76
  v_cvt_pk_bf16_f32 v81, v81, v77
  v_mfma_f32_16x16x32_bf16 v[60:63], v[72:75], v[232:235], v[60:63]
  v_cvt_pk_bf16_f32 v82, v82, v78
  v_cvt_pk_bf16_f32 v83, v83, v79
  v_mfma_f32_16x16x32_bf16 v[60:63], a[244:247], v[248:251], v[60:63]
  buffer_store_dword v80, v7, s[24:27], s36 offen offset:0 nt
  v_mfma_f32_16x16x32_bf16 v[60:63], v[88:91], a[224:227], v[60:63]
  v_or3_b32 v92, v92, v93, v94
  v_or_b32 v92, v92, v95
  v_mfma_f32_16x16x32_bf16 v[64:67], v[88:91], a[228:231], 0
  buffer_store_dword v81, v7, s[24:27], s36 offen offset:384 nt
  v_mfma_f32_16x16x32_bf16 v[64:67], a[244:247], v[252:255], v[64:67]
  v_readfirstlane_b32 s49, v92
  v_mfma_f32_16x16x32_bf16 v[64:67], v[72:75], v[236:239], v[64:67]
  buffer_store_dword v82, v7, s[24:27], s36 offen offset:768 nt
  v_mfma_f32_16x16x32_bf16 v[64:67], v[68:71], v[220:223], v[64:67]
  ds_read_b128 v[76:79], v4 offset:0
  ds_read_b128 v[84:87], v4 offset:4096
  v_mfma_f32_16x16x32_bf16 v[64:67], v[56:59], v[204:207], v[64:67]
  buffer_store_dword v83, v7, s[24:27], s36 offen offset:1152 nt
  v_mfma_f32_16x16x32_bf16 v[64:67], a[252:255], v[188:191], v[64:67]
  s_add_u32 s36, s36, s98
  ds_read_b128 v[92:95], v4 offset:8192
  ds_read_b128 v[96:99], v4 offset:12288
  v_mfma_f32_16x16x32_bf16 v[80:83], a[252:255], v[192:195], 0
  ds_read_b128 v[100:103], v4 offset:16384
  ds_read_b128 v[104:107], v4 offset:20480
  v_mfma_f32_16x16x32_bf16 v[80:83], v[56:59], v[208:211], v[80:83]
L_hop_2_1:
  s_cbranch_execz L_hop_2_2
  v_mfma_f32_16x16x32_bf16 v[80:83], v[68:71], v[224:227], v[80:83]
  v_cvt_pk_bf16_f32 v60, v60, v64
  v_cvt_pk_bf16_f32 v61, v61, v65
  v_mfma_f32_16x16x32_bf16 v[80:83], v[72:75], v[240:243], v[80:83]
  v_cvt_pk_bf16_f32 v62, v62, v66
  v_cvt_pk_bf16_f32 v63, v63, v67
  v_mfma_f32_16x16x32_bf16 v[80:83], a[244:247], a[216:219], v[80:83]
  buffer_store_dword v60, v7, s[24:27], s33 offen offset:0 nt
  v_mfma_f32_16x16x32_bf16 v[80:83], v[88:91], a[232:235], v[80:83]
  v_mfma_f32_16x16x32_bf16 v[108:111], v[88:91], a[236:239], 0
  buffer_store_dword v61, v7, s[24:27], s33 offen offset:384 nt
  v_mfma_f32_16x16x32_bf16 v[108:111], a[244:247], a[220:223], v[108:111]
  v_mfma_f32_16x16x32_bf16 v[108:111], v[72:75], v[244:247], v[108:111]
  buffer_store_dword v62, v7, s[24:27], s33 offen offset:768 nt
  v_mfma_f32_16x16x32_bf16 v[108:111], v[68:71], v[228:231], v[108:111]
  ds_read_b128 a[244:247], v3 offset:512
  ds_read_b128 a[248:251], v3 offset:4608
  v_mfma_f32_16x16x32_bf16 v[108:111], v[56:59], v[212:215], v[108:111]
  buffer_store_dword v63, v7, s[24:27], s33 offen offset:1152 nt
  v_mfma_f32_16x16x32_bf16 v[108:111], a[252:255], v[196:199], v[108:111]
  s_waitcnt lgkmcnt(2)
  ds_read_b128 v[56:59], v3 offset:8704
  ds_read_b128 v[60:63], v3 offset:12800
  v_mfma_f32_16x16x32_bf16 v[88:91], v[76:79], v[184:187], 0
  ds_read_b128 a[252:255], v3 offset:16896
  ds_read_b128 v[64:67], v3 offset:20992
  v_mfma_f32_16x16x32_bf16 v[88:91], v[84:87], v[200:203], v[88:91]
  v_mfma_f32_16x16x32_bf16 v[88:91], v[92:95], v[216:219], v[88:91]
  v_cvt_pk_bf16_f32 v80, v80, v108
  v_cvt_pk_bf16_f32 v81, v81, v109
  v_mfma_f32_16x16x32_bf16 v[88:91], v[96:99], v[232:235], v[88:91]
  v_cvt_pk_bf16_f32 v82, v82, v110
  v_cvt_pk_bf16_f32 v83, v83, v111
  v_mfma_f32_16x16x32_bf16 v[88:91], v[100:103], v[248:251], v[88:91]
  buffer_store_dword v80, v8, s[24:27], s33 offen offset:0 nt
  v_mfma_f32_16x16x32_bf16 v[88:91], v[104:107], a[224:227], v[88:91]
  v_mfma_f32_16x16x32_bf16 v[68:71], v[104:107], a[228:231], 0
  buffer_store_dword v81, v8, s[24:27], s33 offen offset:384 nt
  v_mfma_f32_16x16x32_bf16 v[68:71], v[100:103], v[252:255], v[68:71]
  v_mfma_f32_16x16x32_bf16 v[68:71], v[96:99], v[236:239], v[68:71]
  buffer_store_dword v82, v8, s[24:27], s33 offen offset:768 nt
  v_mfma_f32_16x16x32_bf16 v[68:71], v[92:95], v[220:223], v[68:71]
  v_mfma_f32_16x16x32_bf16 v[68:71], v[84:87], v[204:207], v[68:71]
  buffer_store_dword v83, v8, s[24:27], s33 offen offset:1152 nt
  v_mfma_f32_16x16x32_bf16 v[68:71], v[76:79], v[188:191], v[68:71]
  s_waitcnt lgkmcnt(0)
  v_mfma_f32_16x16x32_bf16 v[84:87], a[244:247], v[184:187], 0
  v_mfma_f32_16x16x32_bf16 v[84:87], a[248:251], v[200:203], v[84:87]
  v_mfma_f32_16x16x32_bf16 v[84:87], v[56:59], v[216:219], v[84:87]
  v_cvt_pk_bf16_f32 v88, v88, v68
  v_cvt_pk_bf16_f32 v89, v89, v69
  v_mfma_f32_16x16x32_bf16 v[84:87], v[60:63], v[232:235], v[84:87]
  v_cvt_pk_bf16_f32 v90, v90, v70
  v_cvt_pk_bf16_f32 v91, v91, v71
  v_mfma_f32_16x16x32_bf16 v[84:87], a[252:255], v[248:251], v[84:87]
  buffer_store_dword v88, v7, s[24:27], s34 offen offset:0 nt
  v_mfma_f32_16x16x32_bf16 v[84:87], v[64:67], a[224:227], v[84:87]
  v_mfma_f32_16x16x32_bf16 v[100:103], v[64:67], a[228:231], 0
  buffer_store_dword v89, v7, s[24:27], s34 offen offset:384 nt
  v_mfma_f32_16x16x32_bf16 v[100:103], a[252:255], v[252:255], v[100:103]
  v_mfma_f32_16x16x32_bf16 v[100:103], v[60:63], v[236:239], v[100:103]
  buffer_store_dword v90, v7, s[24:27], s34 offen offset:768 nt
  v_mfma_f32_16x16x32_bf16 v[100:103], v[56:59], v[220:223], v[100:103]
  ds_read_b128 v[68:71], v4 offset:512
  ds_read_b128 v[72:75], v4 offset:4608
  v_mfma_f32_16x16x32_bf16 v[100:103], a[248:251], v[204:207], v[100:103]
  buffer_store_dword v91, v7, s[24:27], s34 offen offset:1152 nt
  v_mfma_f32_16x16x32_bf16 v[100:103], a[244:247], v[188:191], v[100:103]
  ds_read_b128 v[76:79], v4 offset:8704
  ds_read_b128 v[92:95], v4 offset:12800
  v_mfma_f32_16x16x32_bf16 v[80:83], a[244:247], v[192:195], 0
  ds_read_b128 v[88:91], v4 offset:16896
  ds_read_b128 v[96:99], v4 offset:20992
  v_mfma_f32_16x16x32_bf16 v[80:83], a[248:251], v[208:211], v[80:83]
  v_mfma_f32_16x16x32_bf16 v[80:83], v[56:59], v[224:227], v[80:83]
  v_cvt_pk_bf16_f32 v84, v84, v100
  v_cvt_pk_bf16_f32 v85, v85, v101
  v_mfma_f32_16x16x32_bf16 v[80:83], v[60:63], v[240:243], v[80:83]
  v_cvt_pk_bf16_f32 v86, v86, v102
  v_cvt_pk_bf16_f32 v87, v87, v103
  v_mfma_f32_16x16x32_bf16 v[80:83], a[252:255], a[216:219], v[80:83]
  buffer_store_dword v84, v7, s[24:27], s35 offen offset:0 nt
  v_mfma_f32_16x16x32_bf16 v[80:83], v[64:67], a[232:235], v[80:83]
  v_mfma_f32_16x16x32_bf16 v[100:103], v[64:67], a[236:239], 0
  buffer_store_dword v85, v7, s[24:27], s35 offen offset:384 nt
  v_mfma_f32_16x16x32_bf16 v[100:103], a[252:255], a[220:223], v[100:103]
  v_mfma_f32_16x16x32_bf16 v[100:103], v[60:63], v[244:247], v[100:103]
  buffer_store_dword v86, v7, s[24:27], s35 offen offset:768 nt
  v_mfma_f32_16x16x32_bf16 v[100:103], v[56:59], v[228:231], v[100:103]
  v_mfma_f32_16x16x32_bf16 v[100:103], a[248:251], v[212:215], v[100:103]
  buffer_store_dword v87, v7, s[24:27], s35 offen offset:1152 nt
  v_mfma_f32_16x16x32_bf16 v[100:103], a[244:247], v[196:199], v[100:103]
  s_waitcnt lgkmcnt(0)
  v_mfma_f32_16x16x32_bf16 v[56:59], v[68:71], v[184:187], 0
  v_mfma_f32_16x16x32_bf16 v[56:59], v[72:75], v[200:203], v[56:59]
  v_mfma_f32_16x16x32_bf16 v[56:59], v[76:79], v[216:219], v[56:59]
  v_cvt_pk_bf16_f32 v80, v80, v100
  v_cvt_pk_bf16_f32 v81, v81, v101
  v_mfma_f32_16x16x32_bf16 v[56:59], v[92:95], v[232:235], v[56:59]
  v_cvt_pk_bf16_f32 v82, v82, v102
  v_cvt_pk_bf16_f32 v83, v83, v103
  v_mfma_f32_16x16x32_bf16 v[56:59], v[88:91], v[248:251], v[56:59]
  buffer_store_dword v80, v8, s[24:27], s35 offen offset:0 nt
  v_mfma_f32_16x16x32_bf16 v[56:59], v[96:99], a[224:227], v[56:59]
  v_mfma_f32_16x16x32_bf16 v[60:63], v[96:99], a[228:231], 0
  buffer_store_dword v81, v8, s[24:27], s35 offen offset:384 nt
  v_mfma_f32_16x16x32_bf16 v[60:63], v[88:91], v[252:255], v[60:63]
  v_mfma_f32_16x16x32_bf16 v[60:63], v[92:95], v[236:239], v[60:63]
  buffer_store_dword v82, v8, s[24:27], s35 offen offset:768 nt
  v_mfma_f32_16x16x32_bf16 v[60:63], v[76:79], v[220:223], v[60:63]
  v_mfma_f32_16x16x32_bf16 v[60:63], v[72:75], v[204:207], v[60:63]
  buffer_store_dword v83, v8, s[24:27], s35 offen offset:1152 nt
  v_mfma_f32_16x16x32_bf16 v[60:63], v[68:71], v[188:191], v[60:63]
  s_nop 7
  v_cvt_pk_bf16_f32 v56, v56, v60
  v_cvt_pk_bf16_f32 v57, v57, v61
  v_cvt_pk_bf16_f32 v58, v58, v62
  v_cvt_pk_bf16_f32 v59, v59, v63
  buffer_store_dword v56, v7, s[24:27], s36 offen offset:0 nt
  buffer_store_dword v57, v7, s[24:27], s36 offen offset:384 nt
  buffer_store_dword v58, v7, s[24:27], s36 offen offset:768 nt
  buffer_store_dword v59, v7, s[24:27], s36 offen offset:1152 nt
  s_cmp_lg_u32 s49, 0
  s_cbranch_scc1 L_safe
L_fin:
L_end:
  s_endpgm
L_hop_3_1:
  s_cbranch_execz L_walk
L_pad3771:
L_k7:
  s_cmp_lg_u32 s59, 7
  s_cbranch_scc1 L_kh
  v_mfma_f32_16x16x32_bf16 v[104:107], a[0:3], v[88:91], 0
  s_waitcnt lgkmcnt(0)
  s_sub_u32 s49, s16, s18
  s_sub_u32 s50, s15, s60
  v_mfma_f32_16x16x32_bf16 v[104:107], a[12:15], v[92:95], v[104:107]
  s_add_u32 s50, s50, 45360
  s_mul_i32 s49, s49, s50
  s_mul_hi_u32 s49, s49, 415817
  v_mfma_f32_16x16x32_bf16 v[104:107], a[24:27], v[96:99], v[104:107]
  s_add_u32 s49, s49, s16
  v_cvt_pk_bf16_f32 v66, v128, v129
  v_cvt_pk_bf16_f32 v67, v130, v131
  v_mfma_f32_16x16x32_bf16 v[104:107], a[36:39], v[136:139], v[104:107]
  s_and_b32 s51, s2, 7
  s_lshl_b32 s51, s51, 3
  v_and_b32 v74, 56, v11
  v_mfma_f32_16x16x32_bf16 v[104:107], a[48:51], v[140:143], v[104:107]
  v_lshl_add_u32 v54, v74, 3, s51
  s_lshl_b32 s51, s51, 3
  v_mfma_f32_16x16x32_bf16 v[104:107], a[60:63], v[80:83], v[104:107]
  v_add_u32 v55, s51, v74
  v_mov_b32 v74, s49
  v_mfma_f32_16x16x32_bf16 v[84:87], a[64:67], v[80:83], 0
  buffer_store_dword v74, v54, s[20:23], s44 offen sc1
  v_mfma_f32_16x16x32_bf16 v[84:87], a[52:55], v[140:143], v[84:87]
  v_mfma_f32_16x16x32_bf16 v[84:87], a[40:43], v[136:139], v[84:87]
  v_mul_f32 v104, s42, v104
  v_mul_f32 v105, s42, v105
  v_mfma_f32_16x16x32_bf16 v[84:87], a[28:31], v[96:99], v[84:87]
  v_mul_f32 v106, s42, v106
  v_mul_f32 v107, s42, v107
  v_mfma_f32_16x16x32_bf16 v[84:87], a[16:19], v[92:95], v[84:87]
  v_cvt_pk_bf16_f32 v18, v104, v105
  v_cvt_pk_bf16_f32 v19, v106, v107
  v_mfma_f32_16x16x32_bf16 v[84:87], a[4:7], v[88:91], v[84:87]
  buffer_store_dword v74, v55, s[20:23], s44 offen offset:4 sc1
  v_mfma_f32_16x16x32_bf16 v[108:111], a[8:11], v[88:91], 0
  s_branch L_r220
L_k2:
  s_cmp_lg_u32 s59, 10
  s_cbranch_scc1 L_k7
  s_waitcnt vmcnt(30)
  v_mfma_f32_16x16x32_bf16 v[104:107], a[0:3], v[88:91], 0
  s_sub_u32 s49, s19, s18
  s_sub_u32 s50, s15, s99
  s_add_u32 s50, s50, 45360
  v_mfma_f32_16x16x32_bf16 v[104:107], a[12:15], v[92:95], v[104:107]
  s_mul_i32 s49, s49, s50
  s_mul_hi_u32 s49, s49, 415817
  s_add_u32 s49, s49, s19
  v_mfma_f32_16x16x32_bf16 v[104:107], a[24:27], v[96:99], v[104:107]
  s_and_b32 s50, s2, 7
  v_cvt_pk_bf16_f32 v66, v128, v129
  v_cvt_pk_bf16_f32 v67, v130, v131
  v_mfma_f32_16x16x32_bf16 v[104:107], a[36:39], v[136:139], v[104:107]
  s_sub_u32 s49, s49, 1024
  v_subrev_u32 v54, s49, v52
  v_subrev_u32 v55, s49, v53
  v_mfma_f32_16x16x32_bf16 v[104:107], a[48:51], v[140:143], v[104:107]
  s_waitcnt lgkmcnt(0)
  v_max_u32 v116, v54, v55
  v_bfe_u32 v74, v11, 3, 3
  v_mfma_f32_16x16x32_bf16 v[104:107], a[60:63], v[80:83], v[104:107]
  v_lshrrev_b32 v75, 6, v11
  v_lshl_add_u32 v54, v54, 3, v74
  v_mfma_f32_16x16x32_bf16 v[84:87], a[64:67], v[80:83], 0
  v_lshl_add_u32 v55, v55, 3, v75
  v_mfma_f32_16x16x32_bf16 v[84:87], a[52:55], v[140:143], v[84:87]
  v_readlane_b32 s12, v52, s50
  v_cmp_lt_u32 vcc, 2047, v116
  v_mfma_f32_16x16x32_bf16 v[84:87], a[40:43], v[136:139], v[84:87]
  v_mul_f32 v104, s42, v104
  v_mul_f32 v105, s42, v105
  v_mfma_f32_16x16x32_bf16 v[84:87], a[28:31], v[96:99], v[84:87]
  v_mul_f32 v106, s42, v106
  v_mul_f32 v107, s42, v107
  v_mfma_f32_16x16x32_bf16 v[84:87], a[16:19], v[92:95], v[84:87]
  v_cvt_pk_bf16_f32 v18, v104, v105
  v_cvt_pk_bf16_f32 v19, v106, v107
  v_mfma_f32_16x16x32_bf16 v[84:87], a[4:7], v[88:91], v[84:87]
  v_and_b32 v116, 56, v11
  v_mfma_f32_16x16x32_bf16 v[108:111], a[8:11], v[88:91], 0
  s_or_b32 s51, vcc_lo, vcc_hi
  v_cmp_lt_u32 vcc, v54, v55
  v_mfma_f32_16x16x32_bf16 v[108:111], a[20:23], v[92:95], v[108:111]
  s_sub_u32 s52, s12, s49
  s_sub_u32 s52, s52, 960
  s_lshr_b32 s52, s52, 7
  v_mfma_f32_16x16x32_bf16 v[108:111], a[32:35], v[96:99], v[108:111]
  s_or_b32 s51, s51, s52
  v_mul_f32 v84, s42, v84
  v_mul_f32 v85, s42, v85
  v_mfma_f32_16x16x32_bf16 v[108:111], a[44:47], v[136:139], v[108:111]
  v_mul_f32 v86, s42, v86
  v_mul_f32 v87, s42, v87
  v_mfma_f32_16x16x32_bf16 v[108:111], a[56:59], v[140:143], v[108:111]
  v_cvt_pk_bf16_f32 v104, v84, v85
  v_cvt_pk_bf16_f32 v105, v86, v87
  v_mfma_f32_16x16x32_bf16 v[108:111], a[68:71], v[80:83], v[108:111]
  v_lshrrev_b64 v[74:75], v116, vcc
  v_and_b32 v55, 0xff, v74
  v_mfma_f32_16x16x32_bf16 v[112:115], a[132:135], v[80:83], 0
  v_bcnt_u32_b32 v55, v55, 0
  v_mfma_f32_16x16x32_bf16 v[112:115], a[120:123], v[140:143], v[112:115]
  v_readlane_b32 s52, v55, s50
  v_mfma_f32_16x16x32_bf16 v[112:115], a[108:111], v[136:139], v[112:115]
  v_mul_f32 v108, s42, v108
  v_mul_f32 v109, s42, v109
  v_mfma_f32_16x16x32_bf16 v[112:115], a[96:99], v[96:99], v[112:115]
  s_sub_u32 s52, 7, s52
  v_mul_f32 v110, s42, v110
  v_mul_f32 v111, s42, v111
  v_mfma_f32_16x16x32_bf16 v[112:115], a[84:87], v[92:95], v[112:115]
  v_cvt_pk_bf16_f32 v106, v108, v109
  v_cvt_pk_bf16_f32 v107, v110, v111
  v_mfma_f32_16x16x32_bf16 v[112:115], a[72:75], v[88:91], v[112:115]
  v_cmp_eq_u32 vcc, s52, v55
  v_mfma_f32_16x16x32_bf16 v[84:87], a[76:79], v[88:91], 0
  v_mfma_f32_16x16x32_bf16 v[84:87], a[88:91], v[92:95], v[84:87]
  s_ff1_i32_b32 s52, vcc_lo
  s_and_b32 s52, s52, 7
  v_readlane_b32 s53, v54, s52
  v_mfma_f32_16x16x32_bf16 v[84:87], a[100:103], v[96:99], v[84:87]
  v_cvt_pk_bf16_f32 v128, v112, v113
  v_cvt_pk_bf16_f32 v129, v114, v115
  v_mfma_f32_16x16x32_bf16 v[84:87], a[112:115], v[136:139], v[84:87]
  s_lshr_b32 s53, s53, 3
  s_add_u32 s53, s53, s49
  s_sub_u32 s49, s53, s12
  v_mfma_f32_16x16x32_bf16 v[84:87], a[124:127], v[140:143], v[84:87]
  s_cmp_gt_i32 s49, 0
  s_cselect_b32 s45, 2, 1
  s_cselect_b32 s12, s53, s12
  v_mfma_f32_16x16x32_bf16 v[84:87], a[136:139], v[80:83], v[84:87]
  s_cselect_b32 s53, s52, s50
  s_cselect_b32 s96, 1, 6
  s_lshl_b32 s96, s96, 11
  v_mfma_f32_16x16x32_bf16 v[108:111], a[140:143], v[80:83], 0
  s_abs_i32 s49, s49
  s_cmp_lt_u32 s49, 235
  s_cselect_b32 s51, 1, s51
  v_mfma_f32_16x16x32_bf16 v[108:111], a[128:131], v[140:143], v[108:111]
  s_cmp_lt_u32 s49, 400
  s_cselect_b32 s14, 8, 0
  s_xnor_b32 s13, s12, s14
  v_mfma_f32_16x16x32_bf16 v[108:111], a[116:119], v[136:139], v[108:111]
  s_cmp_eq_u32 s51, 0
  v_cvt_pk_bf16_f32 v130, v84, v85
  v_cvt_pk_bf16_f32 v131, v86, v87
  v_mfma_f32_16x16x32_bf16 v[108:111], a[104:107], v[96:99], v[108:111]
  s_cselect_b32 s45, s45, 0
  s_cselect_b32 s96, s96, 0
  s_bitset1_b32 s96, 14
  v_mfma_f32_16x16x32_bf16 v[108:111], a[92:95], v[92:95], v[108:111]
  s_andn2_b32 s51, s2, 7
  s_add_u32 s51, s51, s53
  s_lshl_b32 s51, s51, 9
  v_mfma_f32_16x16x32_bf16 v[108:111], a[80:83], v[88:91], v[108:111]
  s_add_u32 s44, s51, 2097152
  s_lshr_b32 s49, s45, 1
  s_lshl_b32 s49, s49, s52
  v_mfma_f32_16x16x32_bf16 v[84:87], v[88:91], a[144:147], 0
  s_lshl_b32 s49, s49, s14
  s_lshl_b32 s54, s3, 2
  s_add_u32 s54, s54, 159808
  v_mfma_f32_16x16x32_bf16 v[84:87], v[92:95], a[156:159], v[84:87]
  ds_read_b128 a[244:247], v1 offset:22528
  v_mov_b32 v54, s54
  v_mfma_f32_16x16x32_bf16 v[84:87], v[96:99], a[168:171], v[84:87]
  v_cvt_pk_bf16_f32 v132, v108, v109
  v_cvt_pk_bf16_f32 v133, v110, v111
  v_mfma_f32_16x16x32_bf16 v[84:87], v[136:139], a[180:183], v[84:87]
  ds_read_b128 a[248:251], v0 offset:22528
  v_mov_b32 v55, s49
  v_mfma_f32_16x16x32_bf16 v[84:87], v[140:143], a[192:195], v[84:87]
  ds_read_b128 a[252:255], v1 offset:14336
  v_mfma_f32_16x16x32_bf16 v[84:87], v[80:83], a[204:207], v[84:87]
  ds_read_b128 v[144:147], v0 offset:14336
  v_mfma_f32_16x16x32_bf16 v[116:119], v[80:83], a[208:211], 0
  ds_read_b128 v[148:151], v1 offset:6144
  v_mfma_f32_16x16x32_bf16 v[116:119], v[140:143], a[196:199], v[116:119]
  ds_read_b128 v[152:155], v0 offset:6144
  v_mfma_f32_16x16x32_bf16 v[116:119], v[136:139], a[184:187], v[116:119]
  v_cvt_pk_bf16_f32 v108, v84, v85
  v_cvt_pk_bf16_f32 v109, v86, v87
  v_mfma_f32_16x16x32_bf16 v[116:119], v[96:99], a[172:175], v[116:119]
  ds_write_b32 v54, v55
  v_mfma_f32_16x16x32_bf16 v[116:119], v[92:95], a[160:163], v[116:119]
  v_mfma_f32_16x16x32_bf16 v[116:119], v[88:91], a[148:151], v[116:119]
  v_mfma_f32_16x16x32_bf16 v[156:159], v[88:91], a[152:155], 0
  v_mfma_f32_16x16x32_bf16 v[156:159], v[92:95], a[164:167], v[156:159]
  s_waitcnt lgkmcnt(0)
  v_mfma_f32_16x16x32_bf16 v[156:159], v[96:99], a[176:179], v[156:159]
  v_cvt_pk_bf16_f32 v112, v116, v117
  v_cvt_pk_bf16_f32 v113, v118, v119
  v_mfma_f32_16x16x32_bf16 v[156:159], v[136:139], a[188:191], v[156:159]
  s_branch L_r259
L_hop_0_2:
  s_cbranch_execz L_walk
L_pad3972:
L_kh:
  s_cmp_lt_u32 s59, 14
  s_cbranch_scc1 L_k11
  v_mfma_f32_16x16x32_bf16 v[104:107], a[76:79], v[88:91], 0
  s_lshl_b32 s5, s3, 3
  v_mfma_f32_16x16x32_bf16 v[104:107], a[88:91], v[92:95], v[104:107]
  s_add_u32 s5, s5, 159744
  v_mov_b32 v11, s5
  v_mfma_f32_16x16x32_bf16 v[104:107], a[100:103], v[96:99], v[104:107]
  v_cvt_pk_bf16_f32 v66, v128, v129
  v_cvt_pk_bf16_f32 v67, v130, v131
  v_mfma_f32_16x16x32_bf16 v[104:107], a[112:115], v[136:139], v[104:107]
  ds_read_b128 a[244:247], v1 offset:22528
  v_mfma_f32_16x16x32_bf16 v[104:107], a[124:127], v[140:143], v[104:107]
  ds_read_b128 a[248:251], v0 offset:22528
  s_waitcnt lgkmcnt(2)
  v_mfma_f32_16x16x32_bf16 v[104:107], a[136:139], v[80:83], v[104:107]
  ds_read_b128 a[252:255], v1 offset:14336
  v_mfma_f32_16x16x32_bf16 v[108:111], a[132:135], v[80:83], 0
  ds_read_b128 v[84:87], v0 offset:14336
  v_mfma_f32_16x16x32_bf16 v[108:111], a[120:123], v[140:143], v[108:111]
  ds_read_b128 v[128:131], v1 offset:6144
  v_mfma_f32_16x16x32_bf16 v[108:111], a[108:111], v[136:139], v[108:111]
  v_cvt_pk_bf16_f32 v146, v104, v105
  v_cvt_pk_bf16_f32 v147, v106, v107
  v_mfma_f32_16x16x32_bf16 v[108:111], a[96:99], v[96:99], v[108:111]
  ds_read_b128 v[132:135], v0 offset:6144
  v_cndmask_b32 v160, v32, v48, s[100:101]
  v_mfma_f32_16x16x32_bf16 v[108:111], a[84:87], v[92:95], v[108:111]
  v_cndmask_b32 v161, v33, v49, s[100:101]
  v_cndmask_b32 v162, v34, v50, s[100:101]
  v_mfma_f32_16x16x32_bf16 v[108:111], a[72:75], v[88:91], v[108:111]
  v_cndmask_b32 v163, v35, v51, s[100:101]
  v_cndmask_b32 v164, v28, v44, s[100:101]
  v_mfma_f32_16x16x32_bf16 v[112:115], a[140:143], v[80:83], 0
  v_cndmask_b32 v165, v29, v45, s[100:101]
  v_cndmask_b32 v166, v30, v46, s[100:101]
  v_mfma_f32_16x16x32_bf16 v[112:115], a[128:131], v[140:143], v[112:115]
  v_cndmask_b32 v167, v31, v47, s[100:101]
  v_cndmask_b32 v104, v24, v40, s[100:101]
  v_mfma_f32_16x16x32_bf16 v[112:115], a[116:119], v[136:139], v[112:115]
  v_cvt_pk_bf16_f32 v144, v108, v109
  v_cvt_pk_bf16_f32 v145, v110, v111
  v_mfma_f32_16x16x32_bf16 v[112:115], a[104:107], v[96:99], v[112:115]
  v_cndmask_b32 v105, v25, v41, s[100:101]
  v_cndmask_b32 v106, v26, v42, s[100:101]
  v_mfma_f32_16x16x32_bf16 v[112:115], a[92:95], v[92:95], v[112:115]
  v_cndmask_b32 v107, v27, v43, s[100:101]
  v_mfma_f32_16x16x32_bf16 v[112:115], a[80:83], v[88:91], v[112:115]
  s_waitcnt lgkmcnt(0)
  v_mfma_f32_16x16x32_bf16 v[108:111], a[132:135], a[244:247], 0
  v_mfma_f32_16x16x32_bf16 v[108:111], a[120:123], a[248:251], v[108:111]
  v_mfma_f32_16x16x32_bf16 v[108:111], a[108:111], a[252:255], v[108:111]
  v_cvt_pk_bf16_f32 v148, v112, v113
  v_cvt_pk_bf16_f32 v149, v114, v115
  v_mfma_f32_16x16x32_bf16 v[108:111], a[96:99], v[84:87], v[108:111]
  v_mfma_f32_16x16x32_bf16 v[108:111], a[84:87], v[128:131], v[108:111]
  s_waitcnt lgkmcnt(0)
  s_barrier
  v_mfma_f32_16x16x32_bf16 v[108:111], a[72:75], v[132:135], v[108:111]
  v_mfma_f32_16x16x32_bf16 v[112:115], a[76:79], v[132:135], 0
  v_mfma_f32_16x16x32_bf16 v[112:115], a[88:91], v[128:131], v[112:115]
  v_mfma_f32_16x16x32_bf16 v[112:115], a[100:103], v[84:87], v[112:115]
  v_cvt_pk_bf16_f32 v152, v108, v109
  v_cvt_pk_bf16_f32 v153, v110, v111
  v_mfma_f32_16x16x32_bf16 v[112:115], a[112:115], a[252:255], v[112:115]
  v_mfma_f32_16x16x32_bf16 v[112:115], a[124:127], a[248:251], v[112:115]
  v_mfma_f32_16x16x32_bf16 v[112:115], a[136:139], a[244:247], v[112:115]
  v_mfma_f32_16x16x32_bf16 v[108:111], a[140:143], a[244:247], 0
  v_mfma_f32_16x16x32_bf16 v[108:111], a[128:131], a[248:251], v[108:111]
  v_mfma_f32_16x16x32_bf16 v[108:111], a[116:119], a[252:255], v[108:111]
  v_cvt_pk_bf16_f32 v154, v112, v113
  v_cvt_pk_bf16_f32 v155, v114, v115
  v_mfma_f32_16x16x32_bf16 v[108:111], a[104:107], v[84:87], v[108:111]
  v_mfma_f32_16x16x32_bf16 v[108:111], a[92:95], v[128:131], v[108:111]
  v_mfma_f32_16x16x32_bf16 v[108:111], a[80:83], v[132:135], v[108:111]
  v_mfma_f32_16x16x32_bf16 v[112:115], v[70:73], v[76:79], v[36:39]
  v_mfma_f32_16x16x32_bf16 v[112:115], v[68:71], v[12:15], v[112:115]
  v_mfma_f32_16x16x32_bf16 v[116:119], v[122:125], v[76:79], v[32:35]
  v_cvt_pk_bf16_f32 v156, v108, v109
  v_cvt_pk_bf16_f32 v157, v110, v111
  v_mfma_f32_16x16x32_bf16 v[116:119], v[120:123], v[12:15], v[116:119]
  v_mfma_f32_16x16x32_bf16 v[168:171], v[146:149], v[76:79], v[164:167]
  v_exp_f32 v112, v112
  v_mfma_f32_16x16x32_bf16 v[168:171], v[144:147], v[12:15], v[168:171]
  v_exp_f32 v113, v113
  v_mfma_f32_16x16x32_bf16 v[172:175], v[154:157], v[76:79], v[104:107]
  v_exp_f32 v114, v114
  v_mfma_f32_16x16x32_bf16 v[172:175], v[152:155], v[12:15], v[172:175]
  v_exp_f32 v115, v115
  v_mfma_f32_16x16x32_bf16 v[104:107], v[68:71], v[100:103], v[40:43]
  v_exp_f32 v116, v116
  v_mfma_f32_16x16x32_bf16 v[104:107], v[70:73], v[14:17], v[104:107]
  v_exp_f32 v117, v117
  v_mfma_f32_16x16x32_bf16 v[108:111], v[120:123], v[100:103], v[36:39]
  v_exp_f32 v118, v118
  v_mfma_f32_16x16x32_bf16 v[108:111], v[122:125], v[14:17], v[108:111]
  v_exp_f32 v119, v119
  v_mfma_f32_16x16x32_bf16 v[72:75], v[144:147], v[100:103], v[160:163]
  v_exp_f32 v168, v168
  v_mfma_f32_16x16x32_bf16 v[72:75], v[146:149], v[14:17], v[72:75]
  v_exp_f32 v169, v169
  v_mfma_f32_16x16x32_bf16 v[68:71], v[152:155], v[100:103], v[164:167]
  v_exp_f32 v170, v170
  v_mfma_f32_16x16x32_bf16 v[68:71], v[154:157], v[14:17], v[68:71]
  v_exp_f32 v171, v171
  v_mfma_f32_16x16x32_bf16 v[76:79], v[88:91], a[144:147], 0
  v_exp_f32 v172, v172
  v_mfma_f32_16x16x32_bf16 v[76:79], v[92:95], a[156:159], v[76:79]
  v_exp_f32 v173, v173
  v_mfma_f32_16x16x32_bf16 v[76:79], v[96:99], a[168:171], v[76:79]
  v_exp_f32 v174, v174
  v_mfma_f32_16x16x32_bf16 v[76:79], v[136:139], a[180:183], v[76:79]
  v_exp_f32 v175, v175
  v_mfma_f32_16x16x32_bf16 v[76:79], v[140:143], a[192:195], v[76:79]
  v_cvt_pk_bf16_f32 v112, v112, v113
  v_cvt_pk_bf16_f32 v113, v114, v115
  v_mfma_f32_16x16x32_bf16 v[76:79], v[80:83], a[204:207], v[76:79]
  v_cvt_pk_bf16_f32 v114, v116, v117
  v_cvt_pk_bf16_f32 v115, v118, v119
  v_mfma_f32_16x16x32_bf16 v[100:103], v[80:83], a[208:211], 0
  v_cvt_pk_bf16_f32 v116, v168, v169
  v_cvt_pk_bf16_f32 v117, v170, v171
  v_mfma_f32_16x16x32_bf16 v[100:103], v[140:143], a[196:199], v[100:103]
  v_cvt_pk_bf16_f32 v118, v172, v173
  v_cvt_pk_bf16_f32 v119, v174, v175
  v_mfma_f32_16x16x32_bf16 v[100:103], v[136:139], a[184:187], v[100:103]
  v_cvt_pk_bf16_f32 v144, v76, v77
  v_cvt_pk_bf16_f32 v145, v78, v79
  v_mfma_f32_16x16x32_bf16 v[100:103], v[96:99], a[172:175], v[100:103]
  v_exp_f32 v104, v104
  v_mfma_f32_16x16x32_bf16 v[100:103], v[92:95], a[160:163], v[100:103]
  v_exp_f32 v105, v105
  v_mfma_f32_16x16x32_bf16 v[100:103], v[88:91], a[148:151], v[100:103]
  v_exp_f32 v106, v106
  v_mfma_f32_16x16x32_bf16 v[120:123], v[88:91], a[152:155], 0
  v_exp_f32 v107, v107
  v_mfma_f32_16x16x32_bf16 v[120:123], v[92:95], a[164:167], v[120:123]
  v_exp_f32 v108, v108
  v_mfma_f32_16x16x32_bf16 v[120:123], v[96:99], a[176:179], v[120:123]
  v_cvt_pk_bf16_f32 v148, v100, v101
  v_cvt_pk_bf16_f32 v149, v102, v103
  v_mfma_f32_16x16x32_bf16 v[120:123], v[136:139], a[188:191], v[120:123]
  v_exp_f32 v109, v109
  v_mfma_f32_16x16x32_bf16 v[120:123], v[140:143], a[200:203], v[120:123]
  v_exp_f32 v110, v110
  v_mfma_f32_16x16x32_bf16 v[120:123], v[80:83], a[212:215], v[120:123]
  v_exp_f32 v111, v111
  v_mfma_f32_16x16x32_bf16 v[76:79], v[132:135], a[144:147], 0
  v_exp_f32 v72, v72
  v_mfma_f32_16x16x32_bf16 v[76:79], v[128:131], a[156:159], v[76:79]
  v_exp_f32 v73, v73
  v_mfma_f32_16x16x32_bf16 v[76:79], v[84:87], a[168:171], v[76:79]
  v_cvt_pk_bf16_f32 v140, v120, v121
  v_cvt_pk_bf16_f32 v141, v122, v123
  v_mfma_f32_16x16x32_bf16 v[76:79], a[252:255], a[180:183], v[76:79]
  ds_read_b128 v[88:91], v3 offset:0
  v_cvt_pk_bf16_f32 v104, v104, v105
  v_mfma_f32_16x16x32_bf16 v[76:79], a[248:251], a[192:195], v[76:79]
  ds_read_b128 v[92:95], v3 offset:4096
  v_cvt_pk_bf16_f32 v105, v106, v107
  v_mfma_f32_16x16x32_bf16 v[76:79], a[244:247], a[204:207], v[76:79]
  ds_read_b128 v[100:103], v3 offset:8192
  v_cvt_pk_bf16_f32 v106, v108, v109
  v_mfma_f32_16x16x32_bf16 v[80:83], a[244:247], a[208:211], 0
  ds_read_b128 v[120:123], v3 offset:12288
  v_cvt_pk_bf16_f32 v107, v110, v111
  v_mfma_f32_16x16x32_bf16 v[80:83], a[248:251], a[196:199], v[80:83]
  ds_read_b128 v[124:127], v3 offset:16384
  v_cvt_pk_bf16_f32 v108, v72, v73
  v_mfma_f32_16x16x32_bf16 v[80:83], a[252:255], a[184:187], v[80:83]
  v_cvt_pk_bf16_f32 v146, v76, v77
  v_cvt_pk_bf16_f32 v147, v78, v79
  v_mfma_f32_16x16x32_bf16 v[80:83], v[84:87], a[172:175], v[80:83]
  ds_read_b128 v[136:139], v3 offset:20480
  v_mfma_f32_16x16x32_bf16 v[80:83], v[128:131], a[160:163], v[80:83]
  v_exp_f32 v74, v74
  v_mfma_f32_16x16x32_bf16 v[80:83], v[132:135], a[148:151], v[80:83]
  v_exp_f32 v75, v75
  v_mfma_f32_16x16x32_bf16 v[76:79], v[132:135], a[152:155], 0
  v_exp_f32 v68, v68
  v_mfma_f32_16x16x32_bf16 v[76:79], v[128:131], a[164:167], v[76:79]
  v_exp_f32 v69, v69
  v_mfma_f32_16x16x32_bf16 v[76:79], v[84:87], a[176:179], v[76:79]
  v_cvt_pk_bf16_f32 v150, v80, v81
  v_cvt_pk_bf16_f32 v151, v82, v83
  v_mfma_f32_16x16x32_bf16 v[76:79], a[252:255], a[188:191], v[76:79]
  v_mov_b64 v[132:133], 0
  v_cvt_pk_bf16_f32 v109, v74, v75
  v_mfma_f32_16x16x32_bf16 v[76:79], a[248:251], a[200:203], v[76:79]
  v_exp_f32 v70, v70
  v_mfma_f32_16x16x32_bf16 v[76:79], a[244:247], a[212:215], v[76:79]
  s_waitcnt lgkmcnt(0)
  v_exp_f32 v71, v71
  v_mfma_f32_16x16x32_bf16 v[128:131], v[88:91], v[184:187], 0
  v_cvt_pk_bf16_f32 v110, v68, v69
  v_cvt_pk_bf16_f32 v111, v70, v71
  v_mfma_f32_16x16x32_bf16 v[128:131], v[92:95], v[200:203], v[128:131]
  v_mfma_f32_16x16x32_bf16 v[128:131], v[100:103], v[216:219], v[128:131]
  v_cvt_pk_bf16_f32 v142, v76, v77
  v_cvt_pk_bf16_f32 v143, v78, v79
  v_mfma_f32_16x16x32_bf16 v[128:131], v[120:123], v[232:235], v[128:131]
  v_mov_b64 v[96:97], 0
  v_mfma_f32_16x16x32_bf16 v[128:131], v[124:127], v[248:251], v[128:131]
  v_mfma_f32_16x16x32_bf16 v[128:131], v[136:139], a[224:227], v[128:131]
  v_smfmac_f32_16x16x64_bf16 v[132:135], a[240:243], v[112:119], v10
  v_mfma_f32_16x16x32_bf16 v[76:79], v[144:147], v[116:119], 0
  v_mfma_f32_16x16x32_bf16 v[76:79], v[56:59], v[112:115], v[76:79]
  v_mfma_f32_16x16x32_bf16 v[80:83], v[60:63], v[112:115], 0
  v_mfma_f32_16x16x32_bf16 v[80:83], v[148:151], v[116:119], v[80:83]
  v_mfma_f32_16x16x32_bf16 v[68:71], v[140:143], v[116:119], 0
  v_add_f32 v132, v132, v133
  v_mfma_f32_16x16x32_bf16 v[68:71], v[64:67], v[112:115], v[68:71]
  v_rcp_f32 v134, v132
  v_smfmac_f32_16x16x64_bf16 v[96:99], a[240:243], v[104:111], v10
  v_max3_f32 v9, v132, v134, v9
  v_mul_f32 v76, v134, v76
  v_mfma_f32_16x16x32_bf16 v[72:75], v[144:147], v[108:111], 0
  v_mul_f32 v77, v134, v77
  v_mul_f32 v78, v134, v78
  v_mfma_f32_16x16x32_bf16 v[72:75], v[56:59], v[104:107], v[72:75]
  v_mul_f32 v79, v134, v79
  v_cvt_pk_bf16_f32 v76, v76, v77
  v_mfma_f32_16x16x32_bf16 v[84:87], v[60:63], v[104:107], 0
  v_cvt_pk_bf16_f32 v77, v78, v79
  v_mul_f32 v80, v134, v80
  v_mfma_f32_16x16x32_bf16 v[84:87], v[148:151], v[108:111], v[84:87]
  v_mul_f32 v81, v134, v81
  v_mul_f32 v82, v134, v82
  v_mfma_f32_16x16x32_bf16 v[56:59], v[140:143], v[108:111], 0
  v_add_f32 v96, v96, v97
  v_mul_f32 v83, v134, v83
  v_mfma_f32_16x16x32_bf16 v[56:59], v[64:67], v[104:107], v[56:59]
  v_rcp_f32 v98, v96
  v_mfma_f32_16x16x32_bf16 v[60:63], v[136:139], a[228:231], 0
  v_cvt_pk_bf16_f32 v80, v80, v81
  v_cvt_pk_bf16_f32 v81, v82, v83
  v_mfma_f32_16x16x32_bf16 v[60:63], v[124:127], v[252:255], v[60:63]
  v_mul_f32 v68, v134, v68
  v_mul_f32 v69, v134, v69
  v_mfma_f32_16x16x32_bf16 v[60:63], v[120:123], v[236:239], v[60:63]
  ds_read_b128 v[104:107], v4 offset:0
  ds_read_b128 v[108:111], v4 offset:4096
  v_mfma_f32_16x16x32_bf16 v[60:63], v[100:103], v[220:223], v[60:63]
  ds_read_b128 v[116:119], v4 offset:8192
  ds_read_b128 v[140:143], v4 offset:12288
  v_mfma_f32_16x16x32_bf16 v[60:63], v[92:95], v[204:207], v[60:63]
  ds_read_b128 v[144:147], v4 offset:16384
  ds_read_b128 v[148:151], v4 offset:20480
  v_mfma_f32_16x16x32_bf16 v[60:63], v[88:91], v[188:191], v[60:63]
  v_mul_f32 v70, v134, v70
  v_mul_f32 v71, v134, v71
  v_mfma_f32_16x16x32_bf16 v[112:115], v[88:91], v[192:195], 0
  v_cvt_pk_bf16_f32 v68, v68, v69
  v_cvt_pk_bf16_f32 v69, v70, v71
  v_mfma_f32_16x16x32_bf16 v[112:115], v[92:95], v[208:211], v[112:115]
  v_max3_f32 v9, v96, v98, v9
  v_mul_f32 v72, v98, v72
  v_mfma_f32_16x16x32_bf16 v[112:115], v[100:103], v[224:227], v[112:115]
  v_cvt_pk_bf16_f32 v128, v128, v60
  v_cvt_pk_bf16_f32 v129, v129, v61
  v_mfma_f32_16x16x32_bf16 v[112:115], v[120:123], v[240:243], v[112:115]
  v_cvt_pk_bf16_f32 v130, v130, v62
  v_cvt_pk_bf16_f32 v131, v131, v63
  v_mfma_f32_16x16x32_bf16 v[112:115], v[124:127], a[216:219], v[112:115]
L_hop_1_2:
  s_cbranch_execz L_walk
  buffer_store_dword v128, v7, s[24:27], s33 offen offset:0 nt
  v_mfma_f32_16x16x32_bf16 v[112:115], v[136:139], a[232:235], v[112:115]
  v_mul_f32 v73, v98, v73
  v_mul_f32 v74, v98, v74
  v_mfma_f32_16x16x32_bf16 v[132:135], v[136:139], a[236:239], 0
  v_mul_f32 v75, v98, v75
  v_cvt_pk_bf16_f32 v72, v72, v73
  v_mfma_f32_16x16x32_bf16 v[132:135], v[124:127], a[220:223], v[132:135]
  buffer_store_dword v129, v7, s[24:27], s33 offen offset:384 nt
  v_mfma_f32_16x16x32_bf16 v[132:135], v[120:123], v[244:247], v[132:135]
  ds_read_b128 a[244:247], v3 offset:512
  ds_read_b128 a[248:251], v3 offset:4608
  v_mfma_f32_16x16x32_bf16 v[132:135], v[100:103], v[228:231], v[132:135]
  ds_read_b128 a[252:255], v3 offset:8704
  ds_read_b128 v[60:63], v3 offset:12800
  v_mfma_f32_16x16x32_bf16 v[132:135], v[92:95], v[212:215], v[132:135]
  buffer_store_dword v130, v7, s[24:27], s33 offen offset:768 nt
  v_mfma_f32_16x16x32_bf16 v[132:135], v[88:91], v[196:199], v[132:135]
  s_waitcnt lgkmcnt(4)
  ds_read_b128 v[64:67], v3 offset:16896
  ds_read_b128 v[92:95], v3 offset:20992
  v_mfma_f32_16x16x32_bf16 v[88:91], v[104:107], v[184:187], 0
  v_cvt_pk_bf16_f32 v73, v74, v75
  v_mul_f32 v84, v98, v84
  v_mfma_f32_16x16x32_bf16 v[88:91], v[108:111], v[200:203], v[88:91]
  buffer_store_dword v131, v7, s[24:27], s33 offen offset:1152 nt
  v_mfma_f32_16x16x32_bf16 v[88:91], v[116:119], v[216:219], v[88:91]
  v_cvt_pk_bf16_f32 v112, v112, v132
  v_cvt_pk_bf16_f32 v113, v113, v133
  v_mfma_f32_16x16x32_bf16 v[88:91], v[140:143], v[232:235], v[88:91]
  v_cvt_pk_bf16_f32 v114, v114, v134
  v_cvt_pk_bf16_f32 v115, v115, v135
  v_mfma_f32_16x16x32_bf16 v[88:91], v[144:147], v[248:251], v[88:91]
  buffer_store_dword v112, v8, s[24:27], s33 offen offset:0 nt
  v_mfma_f32_16x16x32_bf16 v[88:91], v[148:151], a[224:227], v[88:91]
  v_mul_f32 v85, v98, v85
  v_mul_f32 v86, v98, v86
  v_mfma_f32_16x16x32_bf16 v[120:123], v[148:151], a[228:231], 0
  v_mul_f32 v87, v98, v87
  v_cvt_pk_bf16_f32 v84, v84, v85
  v_mfma_f32_16x16x32_bf16 v[120:123], v[144:147], v[252:255], v[120:123]
  buffer_store_dword v113, v8, s[24:27], s33 offen offset:384 nt
  v_mfma_f32_16x16x32_bf16 v[120:123], v[140:143], v[236:239], v[120:123]
  v_cvt_pk_bf16_f32 v85, v86, v87
  v_mul_f32 v56, v98, v56
  v_mfma_f32_16x16x32_bf16 v[120:123], v[116:119], v[220:223], v[120:123]
  v_mul_f32 v57, v98, v57
  v_mul_f32 v58, v98, v58
  v_mfma_f32_16x16x32_bf16 v[120:123], v[108:111], v[204:207], v[120:123]
  buffer_store_dword v114, v8, s[24:27], s33 offen offset:768 nt
  v_mfma_f32_16x16x32_bf16 v[120:123], v[104:107], v[188:191], v[120:123]
  s_waitcnt lgkmcnt(0)
  v_mul_f32 v59, v98, v59
  v_cvt_pk_bf16_f32 v56, v56, v57
  v_mfma_f32_16x16x32_bf16 v[100:103], a[244:247], v[184:187], 0
  v_cvt_pk_bf16_f32 v57, v58, v59
  v_cmp_nge_f32 vcc, 0x53800000, v9
  v_mfma_f32_16x16x32_bf16 v[100:103], a[248:251], v[200:203], v[100:103]
  buffer_store_dword v115, v8, s[24:27], s33 offen offset:1152 nt
  v_mfma_f32_16x16x32_bf16 v[100:103], a[252:255], v[216:219], v[100:103]
  s_add_u32 s33, s33, s98
  v_cvt_pk_bf16_f32 v88, v88, v120
  v_cvt_pk_bf16_f32 v89, v89, v121
  v_mfma_f32_16x16x32_bf16 v[100:103], v[60:63], v[232:235], v[100:103]
  s_or_b32 s6, vcc_lo, vcc_hi
  v_cvt_pk_bf16_f32 v90, v90, v122
  v_cvt_pk_bf16_f32 v91, v91, v123
  v_mfma_f32_16x16x32_bf16 v[100:103], v[64:67], v[248:251], v[100:103]
  buffer_store_dword v88, v7, s[24:27], s34 offen offset:0 nt
  v_mfma_f32_16x16x32_bf16 v[100:103], v[92:95], a[224:227], v[100:103]
  ds_write2st64_b32 v5, v76, v77 offset0:0 offset1:4
  v_mfma_f32_16x16x32_bf16 v[96:99], v[92:95], a[228:231], 0
  ds_write2st64_b32 v5, v80, v81 offset0:8 offset1:12
  v_mfma_f32_16x16x32_bf16 v[96:99], v[64:67], v[252:255], v[96:99]
  buffer_store_dword v89, v7, s[24:27], s34 offen offset:384 nt
  v_mfma_f32_16x16x32_bf16 v[96:99], v[60:63], v[236:239], v[96:99]
  ds_read_b128 v[76:79], v4 offset:512
  ds_read_b128 v[80:83], v4 offset:4608
  v_mfma_f32_16x16x32_bf16 v[96:99], a[252:255], v[220:223], v[96:99]
  ds_write2st64_b32 v5, v68, v69 offset0:16 offset1:20
  v_mfma_f32_16x16x32_bf16 v[96:99], a[248:251], v[204:207], v[96:99]
  buffer_store_dword v90, v7, s[24:27], s34 offen offset:768 nt
  v_mfma_f32_16x16x32_bf16 v[96:99], a[244:247], v[188:191], v[96:99]
  ds_write2st64_b32 v5, v72, v73 offset0:1 offset1:5
  v_mfma_f32_16x16x32_bf16 v[68:71], a[244:247], v[192:195], 0
  ds_write2st64_b32 v5, v84, v85 offset0:9 offset1:13
  v_mfma_f32_16x16x32_bf16 v[68:71], a[248:251], v[208:211], v[68:71]
  buffer_store_dword v91, v7, s[24:27], s34 offen offset:1152 nt
  v_mfma_f32_16x16x32_bf16 v[68:71], a[252:255], v[224:227], v[68:71]
  s_add_u32 s34, s34, s98
  v_cvt_pk_bf16_f32 v100, v100, v96
  v_cvt_pk_bf16_f32 v101, v101, v97
  v_mfma_f32_16x16x32_bf16 v[68:71], v[60:63], v[240:243], v[68:71]
  v_cvt_pk_bf16_f32 v102, v102, v98
  v_cvt_pk_bf16_f32 v103, v103, v99
  v_mfma_f32_16x16x32_bf16 v[68:71], v[64:67], a[216:219], v[68:71]
  buffer_store_dword v100, v7, s[24:27], s35 offen offset:0 nt
  v_mfma_f32_16x16x32_bf16 v[68:71], v[92:95], a[232:235], v[68:71]
  ds_write2st64_b32 v5, v56, v57 offset0:17 offset1:21
  v_mfma_f32_16x16x32_bf16 v[96:99], v[92:95], a[236:239], 0
  ds_read_b128 v[84:87], v4 offset:8704
  v_mov_b32 v54, s6
  v_mfma_f32_16x16x32_bf16 v[96:99], v[64:67], a[220:223], v[96:99]
  buffer_store_dword v101, v7, s[24:27], s35 offen offset:384 nt
  v_mfma_f32_16x16x32_bf16 v[96:99], v[60:63], v[244:247], v[96:99]
  ds_read_b128 v[88:91], v4 offset:12800
  ds_read_b128 v[72:75], v4 offset:16896
  v_mfma_f32_16x16x32_bf16 v[96:99], a[252:255], v[228:231], v[96:99]
  ds_write_b32 v11, v54
  v_mfma_f32_16x16x32_bf16 v[96:99], a[248:251], v[212:215], v[96:99]
  buffer_store_dword v102, v7, s[24:27], s35 offen offset:768 nt
  v_mfma_f32_16x16x32_bf16 v[96:99], a[244:247], v[196:199], v[96:99]
  s_waitcnt lgkmcnt(8)
  ds_read_b128 v[64:67], v4 offset:20992
  v_xor_b32 v3, 40960, v3
  v_xor_b32 v4, 40960, v4
  v_mfma_f32_16x16x32_bf16 v[60:63], v[76:79], v[184:187], 0
  s_waitcnt lgkmcnt(1)
  s_barrier
  v_mfma_f32_16x16x32_bf16 v[60:63], v[80:83], v[200:203], v[60:63]
  buffer_store_dword v103, v7, s[24:27], s35 offen offset:1152 nt
  v_mfma_f32_16x16x32_bf16 v[60:63], v[84:87], v[216:219], v[60:63]
  v_cvt_pk_bf16_f32 v68, v68, v96
  v_cvt_pk_bf16_f32 v69, v69, v97
  v_mfma_f32_16x16x32_bf16 v[60:63], v[88:91], v[232:235], v[60:63]
  s_waitcnt lgkmcnt(0)
  v_cvt_pk_bf16_f32 v70, v70, v98
  v_cvt_pk_bf16_f32 v71, v71, v99
  v_mfma_f32_16x16x32_bf16 v[60:63], v[72:75], v[248:251], v[60:63]
  buffer_store_dword v68, v8, s[24:27], s35 offen offset:0 nt
  v_mfma_f32_16x16x32_bf16 v[60:63], v[64:67], a[224:227], v[60:63]
  ds_read_b128 a[244:247], v3 offset:0
  ds_read_b128 a[248:251], v3 offset:4096
  v_mfma_f32_16x16x32_bf16 v[92:95], v[64:67], a[228:231], 0
  ds_read_b128 a[252:255], v3 offset:8192
  ds_read_b128 v[56:59], v3 offset:12288
  v_mfma_f32_16x16x32_bf16 v[92:95], v[72:75], v[252:255], v[92:95]
  buffer_store_dword v69, v8, s[24:27], s35 offen offset:384 nt
  v_mfma_f32_16x16x32_bf16 v[92:95], v[88:91], v[236:239], v[92:95]
  ds_read_b128 v[64:67], v3 offset:16384
  ds_read_b128 v[72:75], v3 offset:20480
  v_mfma_f32_16x16x32_bf16 v[92:95], v[84:87], v[220:223], v[92:95]
  v_mov_b32 v11, 159744
  v_mfma_f32_16x16x32_bf16 v[92:95], v[80:83], v[204:207], v[92:95]
  buffer_store_dword v70, v8, s[24:27], s35 offen offset:768 nt
  v_mfma_f32_16x16x32_bf16 v[92:95], v[76:79], v[188:191], v[92:95]
  s_waitcnt lgkmcnt(2)
  ds_read2_b32 v[80:81], v11 offset0:0 offset1:2
  ds_read2_b32 v[82:83], v11 offset0:4 offset1:6
  v_mfma_f32_16x16x32_bf16 v[76:79], a[244:247], v[184:187], 0
  buffer_store_dword v71, v8, s[24:27], s35 offen offset:1152 nt
  v_mfma_f32_16x16x32_bf16 v[76:79], a[248:251], v[200:203], v[76:79]
  v_mfma_f32_16x16x32_bf16 v[76:79], a[252:255], v[216:219], v[76:79]
  v_cvt_pk_bf16_f32 v60, v60, v92
  v_cvt_pk_bf16_f32 v61, v61, v93
  v_mfma_f32_16x16x32_bf16 v[76:79], v[56:59], v[232:235], v[76:79]
  s_waitcnt lgkmcnt(2)
  v_cvt_pk_bf16_f32 v62, v62, v94
  v_cvt_pk_bf16_f32 v63, v63, v95
  v_mfma_f32_16x16x32_bf16 v[76:79], v[64:67], v[248:251], v[76:79]
  buffer_store_dword v60, v7, s[24:27], s36 offen offset:0 nt
  v_mfma_f32_16x16x32_bf16 v[76:79], v[72:75], a[224:227], v[76:79]
  s_waitcnt lgkmcnt(0)
  v_or3_b32 v80, v80, v81, v82
  v_or_b32 v80, v80, v83
  v_mfma_f32_16x16x32_bf16 v[100:103], v[72:75], a[228:231], 0
  buffer_store_dword v61, v7, s[24:27], s36 offen offset:384 nt
  v_mfma_f32_16x16x32_bf16 v[100:103], v[64:67], v[252:255], v[100:103]
  v_readfirstlane_b32 s49, v80
  v_mfma_f32_16x16x32_bf16 v[100:103], v[56:59], v[236:239], v[100:103]
  buffer_store_dword v62, v7, s[24:27], s36 offen offset:768 nt
  v_mfma_f32_16x16x32_bf16 v[100:103], a[252:255], v[220:223], v[100:103]
  ds_read_b128 v[68:71], v4 offset:0
  ds_read_b128 v[80:83], v4 offset:4096
  v_mfma_f32_16x16x32_bf16 v[100:103], a[248:251], v[204:207], v[100:103]
  buffer_store_dword v63, v7, s[24:27], s36 offen offset:1152 nt
  v_mfma_f32_16x16x32_bf16 v[100:103], a[244:247], v[188:191], v[100:103]
  ds_read_b128 v[84:87], v4 offset:8192
  ds_read_b128 v[88:91], v4 offset:12288
  v_mfma_f32_16x16x32_bf16 v[60:63], a[244:247], v[192:195], 0
  ds_read_b128 v[92:95], v4 offset:16384
  ds_read_b128 v[96:99], v4 offset:20480
  v_mfma_f32_16x16x32_bf16 v[60:63], a[248:251], v[208:211], v[60:63]
  v_mfma_f32_16x16x32_bf16 v[60:63], a[252:255], v[224:227], v[60:63]
  v_cvt_pk_bf16_f32 v76, v76, v100
  v_cvt_pk_bf16_f32 v77, v77, v101
  v_mfma_f32_16x16x32_bf16 v[60:63], v[56:59], v[240:243], v[60:63]
  v_cvt_pk_bf16_f32 v78, v78, v102
  v_cvt_pk_bf16_f32 v79, v79, v103
  v_mfma_f32_16x16x32_bf16 v[60:63], v[64:67], a[216:219], v[60:63]
  buffer_store_dword v76, v7, s[24:27], s33 offen offset:0 nt
  v_mfma_f32_16x16x32_bf16 v[60:63], v[72:75], a[232:235], v[60:63]
  v_mfma_f32_16x16x32_bf16 v[100:103], v[72:75], a[236:239], 0
  buffer_store_dword v77, v7, s[24:27], s33 offen offset:384 nt
  v_mfma_f32_16x16x32_bf16 v[100:103], v[64:67], a[220:223], v[100:103]
  v_mfma_f32_16x16x32_bf16 v[100:103], v[56:59], v[244:247], v[100:103]
  buffer_store_dword v78, v7, s[24:27], s33 offen offset:768 nt
  v_mfma_f32_16x16x32_bf16 v[100:103], a[252:255], v[228:231], v[100:103]
  v_mfma_f32_16x16x32_bf16 v[100:103], a[248:251], v[212:215], v[100:103]
  buffer_store_dword v79, v7, s[24:27], s33 offen offset:1152 nt
  v_mfma_f32_16x16x32_bf16 v[100:103], a[244:247], v[196:199], v[100:103]
  s_waitcnt lgkmcnt(0)
  v_mfma_f32_16x16x32_bf16 v[56:59], v[68:71], v[184:187], 0
  v_mfma_f32_16x16x32_bf16 v[56:59], v[80:83], v[200:203], v[56:59]
  v_mfma_f32_16x16x32_bf16 v[56:59], v[84:87], v[216:219], v[56:59]
  v_cvt_pk_bf16_f32 v60, v60, v100
  v_cvt_pk_bf16_f32 v61, v61, v101
  v_mfma_f32_16x16x32_bf16 v[56:59], v[88:91], v[232:235], v[56:59]
  v_cvt_pk_bf16_f32 v62, v62, v102
  v_cvt_pk_bf16_f32 v63, v63, v103
  v_mfma_f32_16x16x32_bf16 v[56:59], v[92:95], v[248:251], v[56:59]
  buffer_store_dword v60, v8, s[24:27], s33 offen offset:0 nt
  v_mfma_f32_16x16x32_bf16 v[56:59], v[96:99], a[224:227], v[56:59]
  v_mfma_f32_16x16x32_bf16 v[64:67], v[96:99], a[228:231], 0
  buffer_store_dword v61, v8, s[24:27], s33 offen offset:384 nt
  v_mfma_f32_16x16x32_bf16 v[64:67], v[92:95], v[252:255], v[64:67]
  v_mfma_f32_16x16x32_bf16 v[64:67], v[88:91], v[236:239], v[64:67]
  buffer_store_dword v62, v8, s[24:27], s33 offen offset:768 nt
  v_mfma_f32_16x16x32_bf16 v[64:67], v[84:87], v[220:223], v[64:67]
  v_mfma_f32_16x16x32_bf16 v[64:67], v[80:83], v[204:207], v[64:67]
  buffer_store_dword v63, v8, s[24:27], s33 offen offset:1152 nt
  v_mfma_f32_16x16x32_bf16 v[64:67], v[68:71], v[188:191], v[64:67]
  s_nop 7
  v_cvt_pk_bf16_f32 v56, v56, v64
  v_cvt_pk_bf16_f32 v57, v57, v65
  v_cvt_pk_bf16_f32 v58, v58, v66
  v_cvt_pk_bf16_f32 v59, v59, v67
  buffer_store_dword v56, v7, s[24:27], s34 offen offset:0 nt
  buffer_store_dword v57, v7, s[24:27], s34 offen offset:384 nt
  buffer_store_dword v58, v7, s[24:27], s34 offen offset:768 nt
  buffer_store_dword v59, v7, s[24:27], s34 offen offset:1152 nt
  s_cmp_lg_u32 s49, 0
  s_cbranch_scc1 L_safe
  s_endpgm
L_hop_2_2:
  s_cbranch_execz L_walk
L_pad4472:
L_k11:
  s_cmp_lg_u32 s59, 11
  s_cbranch_scc1 L_k12
  v_mfma_f32_16x16x32_bf16 v[104:107], a[0:3], v[88:91], 0
  v_mov_b32 v54, s12
  v_mov_b32 v55, s13
  v_mfma_f32_16x16x32_bf16 v[104:107], a[12:15], v[92:95], v[104:107]
  v_mov_b32 v74, 159808
  v_mfma_f32_16x16x32_bf16 v[104:107], a[24:27], v[96:99], v[104:107]
  v_cvt_pk_bf16_f32 v66, v128, v129
  v_cvt_pk_bf16_f32 v67, v130, v131
  v_mfma_f32_16x16x32_bf16 v[104:107], a[36:39], v[136:139], v[104:107]
  ds_read_b128 v[112:115], v74
  v_mfma_f32_16x16x32_bf16 v[104:107], a[48:51], v[140:143], v[104:107]
  s_waitcnt lgkmcnt(1)
  v_mfma_f32_16x16x32_bf16 v[104:107], a[60:63], v[80:83], v[104:107]
  v_mfma_f32_16x16x32_bf16 v[84:87], a[64:67], v[80:83], 0
  v_mfma_f32_16x16x32_bf16 v[84:87], a[52:55], v[140:143], v[84:87]
  v_mfma_f32_16x16x32_bf16 v[84:87], a[40:43], v[136:139], v[84:87]
  s_waitcnt lgkmcnt(0)
  v_mul_f32 v104, s42, v104
  v_mul_f32 v105, s42, v105
  v_mfma_f32_16x16x32_bf16 v[84:87], a[28:31], v[96:99], v[84:87]
  v_mul_f32 v106, s42, v106
  v_mul_f32 v107, s42, v107
  v_mfma_f32_16x16x32_bf16 v[84:87], a[16:19], v[92:95], v[84:87]
  v_cvt_pk_bf16_f32 v18, v104, v105
  v_cvt_pk_bf16_f32 v19, v106, v107
  v_mfma_f32_16x16x32_bf16 v[84:87], a[4:7], v[88:91], v[84:87]
  v_and_b32 v112, v112, v113
  v_and_b32 v114, v114, v115
  v_mfma_f32_16x16x32_bf16 v[108:111], a[8:11], v[88:91], 0
  v_and_b32 v112, v112, v114
  v_mfma_f32_16x16x32_bf16 v[108:111], a[20:23], v[92:95], v[108:111]
  v_readfirstlane_b32 s49, v112
  v_mfma_f32_16x16x32_bf16 v[108:111], a[32:35], v[96:99], v[108:111]
  v_mul_f32 v84, s42, v84
  v_mul_f32 v85, s42, v85
  v_mfma_f32_16x16x32_bf16 v[108:111], a[44:47], v[136:139], v[108:111]
  s_cmp_lg_u32 s49, 0
  v_mul_f32 v86, s42, v86
  v_mul_f32 v87, s42, v87
  v_mfma_f32_16x16x32_bf16 v[108:111], a[56:59], v[140:143], v[108:111]
  s_cselect_b32 s49, s44, s22
  v_cvt_pk_bf16_f32 v104, v84, v85
  v_cvt_pk_bf16_f32 v105, v86, v87
  v_mfma_f32_16x16x32_bf16 v[108:111], a[68:71], v[80:83], v[108:111]
  s_cselect_b32 s96, 4096, s96
  v_mfma_f32_16x16x32_bf16 v[112:115], a[132:135], v[80:83], 0
  buffer_store_dwordx2 v[54:55], off, s[20:23], s49 sc1
  v_mfma_f32_16x16x32_bf16 v[112:115], a[120:123], v[140:143], v[112:115]
  s_branch L_r227
L_k12:
  s_cmp_lg_u32 s45, 2
  s_cbranch_scc1 L_k12g
  v_mfma_f32_16x16x32_bf16 v[104:107], a[0:3], v[88:91], 0
  s_sub_u32 s49, s44, 2097152
  s_lshr_b32 s49, s49, 9
  s_lshr_b32 s52, s49, 6
  v_mfma_f32_16x16x32_bf16 v[104:107], a[12:15], v[92:95], v[104:107]
  s_and_b32 s53, s49, 63
  s_mul_i32 s50, s52, 15
  s_lshl_b32 s51, s57, 5
  v_mfma_f32_16x16x32_bf16 v[104:107], a[24:27], v[96:99], v[104:107]
  s_cmp_eq_u32 s53, 63
  v_cvt_pk_bf16_f32 v66, v128, v129
  v_cvt_pk_bf16_f32 v67, v130, v131
  v_mfma_f32_16x16x32_bf16 v[104:107], a[36:39], v[136:139], v[104:107]
  s_cselect_b32 s53, s50, s53
  s_cselect_b32 s52, 60, s52
  s_cselect_b32 s51, 3072, s51
  v_mfma_f32_16x16x32_bf16 v[104:107], a[48:51], v[140:143], v[104:107]
  s_waitcnt lgkmcnt(0)
  s_mul_i32 s52, s52, 1572864
  s_mul_i32 s53, s53, 3072
  v_mfma_f32_16x16x32_bf16 v[104:107], a[60:63], v[80:83], v[104:107]
  s_add_u32 s52, s52, s53
  s_add_u32 s50, s52, 787968
  s_cmp_eq_u32 s51, 3072
  v_mfma_f32_16x16x32_bf16 v[84:87], a[64:67], v[80:83], 0
  s_cselect_b32 s10, 100663296, s10
  s_sub_u32 s51, s51, s43
  s_mul_i32 s51, s51, 14
  v_mfma_f32_16x16x32_bf16 v[84:87], a[52:55], v[140:143], v[84:87]
  s_sub_u32 s50, s50, s56
  s_add_u32 s58, s50, s51
  s_mul_i32 s50, s14, 98304
  v_mfma_f32_16x16x32_bf16 v[84:87], a[40:43], v[136:139], v[84:87]
  s_add_u32 s98, s58, s50
  v_mul_f32 v104, s42, v104
  v_mul_f32 v105, s42, v105
  v_mfma_f32_16x16x32_bf16 v[84:87], a[28:31], v[96:99], v[84:87]
  s_sub_u32 s49, s98, s43
  v_mul_f32 v106, s42, v106
  v_mul_f32 v107, s42, v107
  v_mfma_f32_16x16x32_bf16 v[84:87], a[16:19], v[92:95], v[84:87]
  s_add_u32 s31, s31, s49
  v_cvt_pk_bf16_f32 v18, v104, v105
  v_cvt_pk_bf16_f32 v19, v106, v107
  v_mfma_f32_16x16x32_bf16 v[84:87], a[4:7], v[88:91], v[84:87]
  s_add_u32 s32, s32, s49
  s_lshl_b32 s50, s50, 1
  s_sub_u32 s32, s32, s50
  v_mfma_f32_16x16x32_bf16 v[108:111], a[8:11], v[88:91], 0
  s_sub_u32 s37, s37, s49
  s_sub_u32 s38, s38, s49
  s_sub_u32 s39, s39, s49
  v_mfma_f32_16x16x32_bf16 v[108:111], a[20:23], v[92:95], v[108:111]
  s_sub_u32 s40, s40, s49
  s_lshl_b32 s49, s14, 2
  s_add_u32 s97, s49, 15
  v_mfma_f32_16x16x32_bf16 v[108:111], a[32:35], v[96:99], v[108:111]
  s_mov_b32 s45, 4
  v_mul_f32 v84, s42, v84
  v_mul_f32 v85, s42, v85
  v_mfma_f32_16x16x32_bf16 v[108:111], a[44:47], v[136:139], v[108:111]
  s_mov_b32 s96, 32768
  v_mul_f32 v86, s42, v86
  v_mul_f32 v87, s42, v87
  v_mfma_f32_16x16x32_bf16 v[108:111], a[56:59], v[140:143], v[108:111]
  s_mov_b64 s[100:101], -1
  v_cvt_pk_bf16_f32 v104, v84, v85
  v_cvt_pk_bf16_f32 v105, v86, v87
  v_mfma_f32_16x16x32_bf16 v[108:111], a[68:71], v[80:83], v[108:111]
  s_branch L_r225
L_k12g:
  s_cmp_lg_u32 s59, 12
  s_cbranch_scc1 L_k13
  s_waitcnt vmcnt(30)
  v_mfma_f32_16x16x32_bf16 v[104:107], a[0:3], v[88:91], 0
  v_cmp_eq_u64 vcc, s[12:13], v[52:53]
  v_mfma_f32_16x16x32_bf16 v[104:107], a[12:15], v[92:95], v[104:107]
  v_mfma_f32_16x16x32_bf16 v[104:107], a[24:27], v[96:99], v[104:107]
  s_and_b32 s49, vcc_lo, 1
  v_cvt_pk_bf16_f32 v66, v128, v129
  v_cvt_pk_bf16_f32 v67, v130, v131
  v_mfma_f32_16x16x32_bf16 v[104:107], a[36:39], v[136:139], v[104:107]
  s_lshl_b32 s49, s49, s14
  s_lshl_b32 s54, s3, 2
  s_add_u32 s54, s54, 159824
  v_mfma_f32_16x16x32_bf16 v[104:107], a[48:51], v[140:143], v[104:107]
  s_waitcnt lgkmcnt(0)
  v_mov_b32 v54, s54
  v_mov_b32 v55, s49
  v_mfma_f32_16x16x32_bf16 v[104:107], a[60:63], v[80:83], v[104:107]
  ds_write_b32 v54, v55
  v_mfma_f32_16x16x32_bf16 v[84:87], a[64:67], v[80:83], 0
  v_mfma_f32_16x16x32_bf16 v[84:87], a[52:55], v[140:143], v[84:87]
  v_mfma_f32_16x16x32_bf16 v[84:87], a[40:43], v[136:139], v[84:87]
  v_mul_f32 v104, s42, v104
  v_mul_f32 v105, s42, v105
  v_mfma_f32_16x16x32_bf16 v[84:87], a[28:31], v[96:99], v[84:87]
  s_waitcnt lgkmcnt(0)
  v_mul_f32 v106, s42, v106
  v_mul_f32 v107, s42, v107
  v_mfma_f32_16x16x32_bf16 v[84:87], a[16:19], v[92:95], v[84:87]
  v_cvt_pk_bf16_f32 v18, v104, v105
  v_cvt_pk_bf16_f32 v19, v106, v107
  v_mfma_f32_16x16x32_bf16 v[84:87], a[4:7], v[88:91], v[84:87]
  s_branch L_r219
L_k13:
  v_mov_b32 v54, 159824
  ds_read_b128 v[84:87], v54
  s_waitcnt lgkmcnt(0)
  v_and_b32 v84, v84, v85
  v_and_b32 v86, v86, v87
  v_and_b32 v84, v84, v86
  s_nop 0
  v_readfirstlane_b32 s49, v84
  s_nop 3
  s_lshr_b32 s50, s49, 3
  s_add_u32 s97, s97, s50
  s_cmp_eq_u32 s49, 1
  s_cselect_b32 s45, 3, 0
  s_cbranch_scc1 L_full
  s_branch L_loop
L_safe:
  s_nop 15
  s_waitcnt vmcnt(0) lgkmcnt(0)
  s_mov_b32 s10, 100663296
  v_mbcnt_lo_u32_b32 v58, -1, 0
  v_mbcnt_hi_u32_b32 v58, -1, v58
  v_lshrrev_b32 v59, 2, v58
  v_and_b32 v59, 4, v59
  v_xor_b32 v60, v59, v58
  s_cmp_eq_u32 s47, 63
  s_cselect_b32 s5, 4, 0
  v_and_b32 v60, s5, v60
  v_cmp_eq_u32 vcc, 0, v60
  s_cmp_eq_u32 s48, 63
  s_cselect_b32 s5, 0xc31044fe, 0
  v_mov_b32 v55, s5
  v_mov_b32 v54, 0xc31044fe
  v_cndmask_b32 v55, 0, v55, vcc
  v_cndmask_b32 v54, v54, 0, vcc
  v_add_u32 v0, s46, v2
  v_xor_b32 v1, 64, v0
  s_lshl_b32 s5, s48, 3
  s_add_u32 s5, s5, s3
  s_add_u32 s5, s5, 4
  s_mul_i32 s31, s5, s57
  s_add_u32 s5, s5, 4
  s_and_b32 s5, s5, 511
  s_mul_i32 s32, s5, s57
  v_lshrrev_b32 v59, 2, v59
  s_lshl_b32 s5, s47, 3
  s_add_u32 s5, s5, 4
  s_mul_i32 s5, s5, 384
  s_cmp_eq_u32 s47, 63
  s_cselect_b32 s49, 0, s5
  s_cselect_b32 s5, s5, 0
  s_cselect_b32 s6, s57, 0
  v_mul_u32_u24 v57, s6, v59
  v_sub_u32 v57, s5, v57
  s_lshl_b32 s50, s48, 3
  s_add_u32 s50, s50, 4
  s_xor_b32 s6, s4, 0
  s_lshl_b32 s6, s6, 1
  s_add_u32 s6, s6, s50
  s_and_b32 s6, s6, 511
  s_mul_i32 s6, s6, s57
  s_add_u32 s33, s6, s49
  s_xor_b32 s6, s4, 1
  s_lshl_b32 s6, s6, 1
  s_add_u32 s6, s6, s50
  s_and_b32 s6, s6, 511
  s_mul_i32 s6, s6, s57
  s_add_u32 s34, s6, s49
  s_xor_b32 s6, s4, 2
  s_lshl_b32 s6, s6, 1
  s_add_u32 s6, s6, s50
  s_and_b32 s6, s6, 511
  s_mul_i32 s6, s6, s57
  s_add_u32 s35, s6, s49
  s_xor_b32 s6, s4, 3
  s_lshl_b32 s6, s6, 1
  s_add_u32 s6, s6, s50
  s_and_b32 s6, s6, 511
  s_mul_i32 s6, s6, s57
  s_add_u32 s36, s6, s49
  s_lshl_b32 s5, s47, 3
  s_add_u32 s5, s5, 4
  v_lshrrev_b32 v59, 3, v58
  v_add_u32 v60, s5, v59
  v_and_b32 v60, 511, v60
  v_sub_u32 v60, v60, v59
  v_mul_i32_i24 v56, 0x180, v60
  v_add_u32 v6, v6, v56
  v_add_u32 v7, v7, v57
  v_add_u32 v8, v8, v57
  v_add_f32 v55, v54, v55
  s_cmp_eq_u32 s45, 3
  s_cselect_b32 s49, 15, 16
  s_cmp_eq_u32 s45, 4
  s_cselect_b32 s49, 17, s49
  s_mov_b32 s50, 0
  s_sub_u32 s56, s56, s43
  s_nop 7
L_sloop:
  s_barrier
  s_add_u32 m0, s46, 0
  s_nop 0
  buffer_load_dwordx4 v6, s[8:11], s31 offen offset:0 nt lds
  s_add_u32 m0, s46, 8064
  s_nop 0
  buffer_load_dwordx4 v6, s[8:11], s31 offen offset:128 nt lds
  s_add_u32 m0, s46, 16128
  s_nop 0
  buffer_load_dwordx4 v6, s[8:11], s31 offen offset:256 nt lds
  s_add_u32 m0, s46, 4096
  s_nop 0
  buffer_load_dwordx4 v6, s[8:11], s32 offen offset:0 nt lds
  s_add_u32 m0, s46, 12160
  s_nop 0
  buffer_load_dwordx4 v6, s[8:11], s32 offen offset:128 nt lds
  s_add_u32 m0, s46, 20224
  s_nop 0
  buffer_load_dwordx4 v6, s[8:11], s32 offen offset:256 nt lds
  s_waitcnt vmcnt(0)
  s_barrier
  ds_read_b128 a[244:247], v0 offset:0
  ds_read_b128 a[248:251], v1 offset:0
  ds_read_b128 a[252:255], v0 offset:8192
  ds_read_b128 v[76:79], v1 offset:8192
  ds_read_b128 v[80:83], v0 offset:16384
  ds_read_b128 v[84:87], v1 offset:16384
  s_waitcnt lgkmcnt(5)
  v_mfma_f32_16x16x32_bf16 v[68:71], a[0:3], a[244:247], 0
  s_waitcnt lgkmcnt(4)
  v_mfma_f32_16x16x32_bf16 v[68:71], a[12:15], a[248:251], v[68:71]
  s_waitcnt lgkmcnt(3)
  v_mfma_f32_16x16x32_bf16 v[68:71], a[24:27], a[252:255], v[68:71]
  s_waitcnt lgkmcnt(2)
  v_mfma_f32_16x16x32_bf16 v[68:71], a[36:39], v[76:79], v[68:71]
  s_waitcnt lgkmcnt(1)
  v_mfma_f32_16x16x32_bf16 v[68:71], a[48:51], v[80:83], v[68:71]
  s_waitcnt lgkmcnt(0)
  v_mfma_f32_16x16x32_bf16 v[68:71], a[60:63], v[84:87], v[68:71]
  v_mfma_f32_16x16x32_bf16 v[60:63], a[64:67], v[84:87], 0
  v_mfma_f32_16x16x32_bf16 v[60:63], a[52:55], v[80:83], v[60:63]
  v_mfma_f32_16x16x32_bf16 v[60:63], a[40:43], v[76:79], v[60:63]
  v_mfma_f32_16x16x32_bf16 v[60:63], a[28:31], a[252:255], v[60:63]
  v_mfma_f32_16x16x32_bf16 v[60:63], a[16:19], a[248:251], v[60:63]
  v_mfma_f32_16x16x32_bf16 v[60:63], a[4:7], a[244:247], v[60:63]
  v_mul_f32 v68, s42, v68
  v_mul_f32 v69, s42, v69
  v_mul_f32 v70, s42, v70
  v_mul_f32 v71, s42, v71
  v_cvt_pk_bf16_f32 v12, v68, v69
  v_cvt_pk_bf16_f32 v13, v70, v71
  v_mfma_f32_16x16x32_bf16 v[64:67], a[8:11], a[244:247], 0
  v_mfma_f32_16x16x32_bf16 v[64:67], a[20:23], a[248:251], v[64:67]
  v_mfma_f32_16x16x32_bf16 v[64:67], a[32:35], a[252:255], v[64:67]
  v_mfma_f32_16x16x32_bf16 v[64:67], a[44:47], v[76:79], v[64:67]
  v_mfma_f32_16x16x32_bf16 v[64:67], a[56:59], v[80:83], v[64:67]
  v_mfma_f32_16x16x32_bf16 v[64:67], a[68:71], v[84:87], v[64:67]
  v_mul_f32 v60, s42, v60
  v_mul_f32 v61, s42, v61
  v_mul_f32 v62, s42, v62
  v_mul_f32 v63, s42, v63
  v_cvt_pk_bf16_f32 v128, v60, v61
  v_cvt_pk_bf16_f32 v129, v62, v63
  v_mfma_f32_16x16x32_bf16 v[68:71], a[132:135], v[84:87], 0
  v_mfma_f32_16x16x32_bf16 v[68:71], a[120:123], v[80:83], v[68:71]
  v_mfma_f32_16x16x32_bf16 v[68:71], a[108:111], v[76:79], v[68:71]
  v_mfma_f32_16x16x32_bf16 v[68:71], a[96:99], a[252:255], v[68:71]
  v_mfma_f32_16x16x32_bf16 v[68:71], a[84:87], a[248:251], v[68:71]
  v_mfma_f32_16x16x32_bf16 v[68:71], a[72:75], a[244:247], v[68:71]
  v_mul_f32 v64, s42, v64
  v_mul_f32 v65, s42, v65
  v_mul_f32 v66, s42, v66
  v_mul_f32 v67, s42, v67
  v_cvt_pk_bf16_f32 v130, v64, v65
  v_cvt_pk_bf16_f32 v131, v66, v67
  v_mfma_f32_16x16x32_bf16 v[72:75], a[76:79], a[244:247], 0
  v_mfma_f32_16x16x32_bf16 v[72:75], a[88:91], a[248:251], v[72:75]
  v_mfma_f32_16x16x32_bf16 v[72:75], a[100:103], a[252:255], v[72:75]
  v_mfma_f32_16x16x32_bf16 v[72:75], a[112:115], v[76:79], v[72:75]
  v_mfma_f32_16x16x32_bf16 v[72:75], a[124:127], v[80:83], v[72:75]
  v_mfma_f32_16x16x32_bf16 v[72:75], a[136:139], v[84:87], v[72:75]
  v_cvt_pk_bf16_f32 v60, v68, v69
  v_cvt_pk_bf16_f32 v61, v70, v71
  v_mfma_f32_16x16x32_bf16 v[88:91], a[140:143], v[84:87], 0
  v_mfma_f32_16x16x32_bf16 v[88:91], a[128:131], v[80:83], v[88:91]
  v_mfma_f32_16x16x32_bf16 v[88:91], a[116:119], v[76:79], v[88:91]
  v_mfma_f32_16x16x32_bf16 v[88:91], a[104:107], a[252:255], v[88:91]
  v_mfma_f32_16x16x32_bf16 v[88:91], a[92:95], a[248:251], v[88:91]
  v_mfma_f32_16x16x32_bf16 v[88:91], a[80:83], a[244:247], v[88:91]
  v_cvt_pk_bf16_f32 v62, v72, v73
  v_cvt_pk_bf16_f32 v63, v74, v75
  v_mfma_f32_16x16x32_bf16 v[92:95], a[244:247], a[144:147], 0
  v_mfma_f32_16x16x32_bf16 v[92:95], a[248:251], a[156:159], v[92:95]
  v_mfma_f32_16x16x32_bf16 v[92:95], a[252:255], a[168:171], v[92:95]
  v_mfma_f32_16x16x32_bf16 v[92:95], v[76:79], a[180:183], v[92:95]
  v_mfma_f32_16x16x32_bf16 v[92:95], v[80:83], a[192:195], v[92:95]
  v_mfma_f32_16x16x32_bf16 v[92:95], v[84:87], a[204:207], v[92:95]
  v_cvt_pk_bf16_f32 v64, v88, v89
  v_cvt_pk_bf16_f32 v65, v90, v91
  v_mfma_f32_16x16x32_bf16 v[96:99], v[84:87], a[208:211], 0
  v_mfma_f32_16x16x32_bf16 v[96:99], v[80:83], a[196:199], v[96:99]
  v_mfma_f32_16x16x32_bf16 v[96:99], v[76:79], a[184:187], v[96:99]
  v_mfma_f32_16x16x32_bf16 v[96:99], a[252:255], a[172:175], v[96:99]
  v_mfma_f32_16x16x32_bf16 v[96:99], a[248:251], a[160:163], v[96:99]
  v_mfma_f32_16x16x32_bf16 v[96:99], a[244:247], a[148:151], v[96:99]
  v_cvt_pk_bf16_f32 v68, v92, v93
  v_cvt_pk_bf16_f32 v69, v94, v95
  v_mfma_f32_16x16x32_bf16 v[104:107], a[244:247], a[152:155], 0
  v_mfma_f32_16x16x32_bf16 v[104:107], a[248:251], a[164:167], v[104:107]
  v_mfma_f32_16x16x32_bf16 v[104:107], a[252:255], a[176:179], v[104:107]
  v_mfma_f32_16x16x32_bf16 v[104:107], v[76:79], a[188:191], v[104:107]
  v_mfma_f32_16x16x32_bf16 v[104:107], v[80:83], a[200:203], v[104:107]
  v_mfma_f32_16x16x32_bf16 v[104:107], v[84:87], a[212:215], v[104:107]
  v_cvt_pk_bf16_f32 v72, v96, v97
  v_cvt_pk_bf16_f32 v73, v98, v99
  s_nop 5
  v_cvt_pk_bf16_f32 v76, v104, v105
  v_cvt_pk_bf16_f32 v77, v106, v107
  ds_read_b128 a[244:247], v0 offset:2048
  ds_read_b128 a[248:251], v1 offset:2048
  ds_read_b128 a[252:255], v0 offset:10240
  ds_read_b128 v[88:91], v1 offset:10240
  ds_read_b128 v[92:95], v0 offset:18432
  ds_read_b128 v[96:99], v1 offset:18432
  s_waitcnt lgkmcnt(5)
  v_mfma_f32_16x16x32_bf16 v[100:103], a[0:3], a[244:247], 0
  s_waitcnt lgkmcnt(4)
  v_mfma_f32_16x16x32_bf16 v[100:103], a[12:15], a[248:251], v[100:103]
  s_waitcnt lgkmcnt(3)
  v_mfma_f32_16x16x32_bf16 v[100:103], a[24:27], a[252:255], v[100:103]
  s_waitcnt lgkmcnt(2)
  v_mfma_f32_16x16x32_bf16 v[100:103], a[36:39], v[88:91], v[100:103]
  s_waitcnt lgkmcnt(1)
  v_mfma_f32_16x16x32_bf16 v[100:103], a[48:51], v[92:95], v[100:103]
  s_waitcnt lgkmcnt(0)
  v_mfma_f32_16x16x32_bf16 v[100:103], a[60:63], v[96:99], v[100:103]
  v_mfma_f32_16x16x32_bf16 v[80:83], a[64:67], v[96:99], 0
  v_mfma_f32_16x16x32_bf16 v[80:83], a[52:55], v[92:95], v[80:83]
  v_mfma_f32_16x16x32_bf16 v[80:83], a[40:43], v[88:91], v[80:83]
  v_mfma_f32_16x16x32_bf16 v[80:83], a[28:31], a[252:255], v[80:83]
  v_mfma_f32_16x16x32_bf16 v[80:83], a[16:19], a[248:251], v[80:83]
  v_mfma_f32_16x16x32_bf16 v[80:83], a[4:7], a[244:247], v[80:83]
  v_mul_f32 v100, s42, v100
  v_mul_f32 v101, s42, v101
  v_mul_f32 v102, s42, v102
  v_mul_f32 v103, s42, v103
  v_cvt_pk_bf16_f32 v124, v100, v101
  v_cvt_pk_bf16_f32 v125, v102, v103
  v_mfma_f32_16x16x32_bf16 v[84:87], a[8:11], a[244:247], 0
  v_mfma_f32_16x16x32_bf16 v[84:87], a[20:23], a[248:251], v[84:87]
  v_mfma_f32_16x16x32_bf16 v[84:87], a[32:35], a[252:255], v[84:87]
  v_mfma_f32_16x16x32_bf16 v[84:87], a[44:47], v[88:91], v[84:87]
  v_mfma_f32_16x16x32_bf16 v[84:87], a[56:59], v[92:95], v[84:87]
  v_mfma_f32_16x16x32_bf16 v[84:87], a[68:71], v[96:99], v[84:87]
  v_mul_f32 v80, s42, v80
  v_mul_f32 v81, s42, v81
  v_mul_f32 v82, s42, v82
  v_mul_f32 v83, s42, v83
  v_cvt_pk_bf16_f32 v126, v80, v81
  v_cvt_pk_bf16_f32 v127, v82, v83
  v_mfma_f32_16x16x32_bf16 v[100:103], a[132:135], v[96:99], 0
  v_mfma_f32_16x16x32_bf16 v[100:103], a[120:123], v[92:95], v[100:103]
  v_mfma_f32_16x16x32_bf16 v[100:103], a[108:111], v[88:91], v[100:103]
  v_mfma_f32_16x16x32_bf16 v[100:103], a[96:99], a[252:255], v[100:103]
  v_mfma_f32_16x16x32_bf16 v[100:103], a[84:87], a[248:251], v[100:103]
  v_mfma_f32_16x16x32_bf16 v[100:103], a[72:75], a[244:247], v[100:103]
  v_mul_f32 v84, s42, v84
  v_mul_f32 v85, s42, v85
  v_mul_f32 v86, s42, v86
  v_mul_f32 v87, s42, v87
  v_cvt_pk_bf16_f32 v16, v84, v85
  v_cvt_pk_bf16_f32 v17, v86, v87
  v_mfma_f32_16x16x32_bf16 v[104:107], a[76:79], a[244:247], 0
  v_mfma_f32_16x16x32_bf16 v[104:107], a[88:91], a[248:251], v[104:107]
  v_mfma_f32_16x16x32_bf16 v[104:107], a[100:103], a[252:255], v[104:107]
  v_mfma_f32_16x16x32_bf16 v[104:107], a[112:115], v[88:91], v[104:107]
  v_mfma_f32_16x16x32_bf16 v[104:107], a[124:127], v[92:95], v[104:107]
  v_mfma_f32_16x16x32_bf16 v[104:107], a[136:139], v[96:99], v[104:107]
  v_cvt_pk_bf16_f32 v80, v100, v101
  v_cvt_pk_bf16_f32 v81, v102, v103
  v_mfma_f32_16x16x32_bf16 v[108:111], a[140:143], v[96:99], 0
  v_mfma_f32_16x16x32_bf16 v[108:111], a[128:131], v[92:95], v[108:111]
  v_mfma_f32_16x16x32_bf16 v[108:111], a[116:119], v[88:91], v[108:111]
  v_mfma_f32_16x16x32_bf16 v[108:111], a[104:107], a[252:255], v[108:111]
  v_mfma_f32_16x16x32_bf16 v[108:111], a[92:95], a[248:251], v[108:111]
  v_mfma_f32_16x16x32_bf16 v[108:111], a[80:83], a[244:247], v[108:111]
  v_cvt_pk_bf16_f32 v82, v104, v105
  v_cvt_pk_bf16_f32 v83, v106, v107
  v_mfma_f32_16x16x32_bf16 v[100:103], a[244:247], a[144:147], 0
  v_mfma_f32_16x16x32_bf16 v[100:103], a[248:251], a[156:159], v[100:103]
  v_mfma_f32_16x16x32_bf16 v[100:103], a[252:255], a[168:171], v[100:103]
  v_mfma_f32_16x16x32_bf16 v[100:103], v[88:91], a[180:183], v[100:103]
  v_mfma_f32_16x16x32_bf16 v[100:103], v[92:95], a[192:195], v[100:103]
  v_mfma_f32_16x16x32_bf16 v[100:103], v[96:99], a[204:207], v[100:103]
  v_cvt_pk_bf16_f32 v84, v108, v109
  v_cvt_pk_bf16_f32 v85, v110, v111
  v_mfma_f32_16x16x32_bf16 v[104:107], v[96:99], a[208:211], 0
  v_mfma_f32_16x16x32_bf16 v[104:107], v[92:95], a[196:199], v[104:107]
  v_mfma_f32_16x16x32_bf16 v[104:107], v[88:91], a[184:187], v[104:107]
  v_mfma_f32_16x16x32_bf16 v[104:107], a[252:255], a[172:175], v[104:107]
  v_mfma_f32_16x16x32_bf16 v[104:107], a[248:251], a[160:163], v[104:107]
  v_mfma_f32_16x16x32_bf16 v[104:107], a[244:247], a[148:151], v[104:107]
  v_cvt_pk_bf16_f32 v70, v100, v101
  v_cvt_pk_bf16_f32 v71, v102, v103
  v_mfma_f32_16x16x32_bf16 v[116:119], a[244:247], a[152:155], 0
  v_mfma_f32_16x16x32_bf16 v[116:119], a[248:251], a[164:167], v[116:119]
  v_mfma_f32_16x16x32_bf16 v[116:119], a[252:255], a[176:179], v[116:119]
  v_mfma_f32_16x16x32_bf16 v[116:119], v[88:91], a[188:191], v[116:119]
  v_mfma_f32_16x16x32_bf16 v[116:119], v[92:95], a[200:203], v[116:119]
  v_mfma_f32_16x16x32_bf16 v[116:119], v[96:99], a[212:215], v[116:119]
  v_cvt_pk_bf16_f32 v74, v104, v105
  v_cvt_pk_bf16_f32 v75, v106, v107
  s_nop 5
  v_cvt_pk_bf16_f32 v78, v116, v117
  v_cvt_pk_bf16_f32 v79, v118, v119
  ds_read_b128 a[244:247], v0 offset:4096
  ds_read_b128 a[248:251], v1 offset:4096
  ds_read_b128 a[252:255], v0 offset:12288
  ds_read_b128 v[100:103], v1 offset:12288
  ds_read_b128 v[108:111], v0 offset:20480
  ds_read_b128 v[112:115], v1 offset:20480
  s_waitcnt lgkmcnt(5)
  v_mfma_f32_16x16x32_bf16 v[96:99], a[0:3], a[244:247], 0
  s_waitcnt lgkmcnt(4)
  v_mfma_f32_16x16x32_bf16 v[96:99], a[12:15], a[248:251], v[96:99]
  s_waitcnt lgkmcnt(3)
  v_mfma_f32_16x16x32_bf16 v[96:99], a[24:27], a[252:255], v[96:99]
  s_waitcnt lgkmcnt(2)
  v_mfma_f32_16x16x32_bf16 v[96:99], a[36:39], v[100:103], v[96:99]
  s_waitcnt lgkmcnt(1)
  v_mfma_f32_16x16x32_bf16 v[96:99], a[48:51], v[108:111], v[96:99]
  s_waitcnt lgkmcnt(0)
  v_mfma_f32_16x16x32_bf16 v[96:99], a[60:63], v[112:115], v[96:99]
  v_mfma_f32_16x16x32_bf16 v[88:91], a[64:67], v[112:115], 0
  v_mfma_f32_16x16x32_bf16 v[88:91], a[52:55], v[108:111], v[88:91]
  v_mfma_f32_16x16x32_bf16 v[88:91], a[40:43], v[100:103], v[88:91]
  v_mfma_f32_16x16x32_bf16 v[88:91], a[28:31], a[252:255], v[88:91]
  v_mfma_f32_16x16x32_bf16 v[88:91], a[16:19], a[248:251], v[88:91]
  v_mfma_f32_16x16x32_bf16 v[88:91], a[4:7], a[244:247], v[88:91]
  v_mul_f32 v96, s42, v96
  v_mul_f32 v97, s42, v97
  v_mul_f32 v98, s42, v98
  v_mul_f32 v99, s42, v99
  v_cvt_pk_bf16_f32 v18, v96, v97
  v_cvt_pk_bf16_f32 v19, v98, v99
  v_mfma_f32_16x16x32_bf16 v[92:95], a[8:11], a[244:247], 0
  v_mfma_f32_16x16x32_bf16 v[92:95], a[20:23], a[248:251], v[92:95]
  v_mfma_f32_16x16x32_bf16 v[92:95], a[32:35], a[252:255], v[92:95]
  v_mfma_f32_16x16x32_bf16 v[92:95], a[44:47], v[100:103], v[92:95]
  v_mfma_f32_16x16x32_bf16 v[92:95], a[56:59], v[108:111], v[92:95]
  v_mfma_f32_16x16x32_bf16 v[92:95], a[68:71], v[112:115], v[92:95]
  v_mul_f32 v88, s42, v88
  v_mul_f32 v89, s42, v89
  v_mul_f32 v90, s42, v90
  v_mul_f32 v91, s42, v91
  v_cvt_pk_bf16_f32 v120, v88, v89
  v_cvt_pk_bf16_f32 v121, v90, v91
  v_mfma_f32_16x16x32_bf16 v[96:99], a[132:135], v[112:115], 0
  v_mfma_f32_16x16x32_bf16 v[96:99], a[120:123], v[108:111], v[96:99]
  v_mfma_f32_16x16x32_bf16 v[96:99], a[108:111], v[100:103], v[96:99]
  v_mfma_f32_16x16x32_bf16 v[96:99], a[96:99], a[252:255], v[96:99]
  v_mfma_f32_16x16x32_bf16 v[96:99], a[84:87], a[248:251], v[96:99]
  v_mfma_f32_16x16x32_bf16 v[96:99], a[72:75], a[244:247], v[96:99]
  v_mul_f32 v92, s42, v92
  v_mul_f32 v93, s42, v93
  v_mul_f32 v94, s42, v94
  v_mul_f32 v95, s42, v95
  v_cvt_pk_bf16_f32 v122, v92, v93
  v_cvt_pk_bf16_f32 v123, v94, v95
  v_mfma_f32_16x16x32_bf16 v[104:107], a[76:79], a[244:247], 0
  v_mfma_f32_16x16x32_bf16 v[104:107], a[88:91], a[248:251], v[104:107]
  v_mfma_f32_16x16x32_bf16 v[104:107], a[100:103], a[252:255], v[104:107]
  v_mfma_f32_16x16x32_bf16 v[104:107], a[112:115], v[100:103], v[104:107]
  v_mfma_f32_16x16x32_bf16 v[104:107], a[124:127], v[108:111], v[104:107]
  v_mfma_f32_16x16x32_bf16 v[104:107], a[136:139], v[112:115], v[104:107]
  v_cvt_pk_bf16_f32 v88, v96, v97
  v_cvt_pk_bf16_f32 v89, v98, v99
  v_mfma_f32_16x16x32_bf16 v[116:119], a[140:143], v[112:115], 0
  v_mfma_f32_16x16x32_bf16 v[116:119], a[128:131], v[108:111], v[116:119]
  v_mfma_f32_16x16x32_bf16 v[116:119], a[116:119], v[100:103], v[116:119]
  v_mfma_f32_16x16x32_bf16 v[116:119], a[104:107], a[252:255], v[116:119]
  v_mfma_f32_16x16x32_bf16 v[116:119], a[92:95], a[248:251], v[116:119]
  v_mfma_f32_16x16x32_bf16 v[116:119], a[80:83], a[244:247], v[116:119]
  v_cvt_pk_bf16_f32 v90, v104, v105
  v_cvt_pk_bf16_f32 v91, v106, v107
  v_mfma_f32_16x16x32_bf16 v[132:135], a[244:247], a[144:147], 0
  v_mfma_f32_16x16x32_bf16 v[132:135], a[248:251], a[156:159], v[132:135]
  v_mfma_f32_16x16x32_bf16 v[132:135], a[252:255], a[168:171], v[132:135]
  v_mfma_f32_16x16x32_bf16 v[132:135], v[100:103], a[180:183], v[132:135]
  v_mfma_f32_16x16x32_bf16 v[132:135], v[108:111], a[192:195], v[132:135]
  v_mfma_f32_16x16x32_bf16 v[132:135], v[112:115], a[204:207], v[132:135]
  v_cvt_pk_bf16_f32 v92, v116, v117
  v_cvt_pk_bf16_f32 v93, v118, v119
  v_mfma_f32_16x16x32_bf16 v[136:139], v[112:115], a[208:211], 0
  v_mfma_f32_16x16x32_bf16 v[136:139], v[108:111], a[196:199], v[136:139]
  v_mfma_f32_16x16x32_bf16 v[136:139], v[100:103], a[184:187], v[136:139]
  v_mfma_f32_16x16x32_bf16 v[136:139], a[252:255], a[172:175], v[136:139]
  v_mfma_f32_16x16x32_bf16 v[136:139], a[248:251], a[160:163], v[136:139]
  v_mfma_f32_16x16x32_bf16 v[136:139], a[244:247], a[148:151], v[136:139]
  v_cvt_pk_bf16_f32 v96, v132, v133
  v_cvt_pk_bf16_f32 v97, v134, v135
  v_mfma_f32_16x16x32_bf16 v[116:119], a[244:247], a[152:155], 0
  v_mfma_f32_16x16x32_bf16 v[116:119], a[248:251], a[164:167], v[116:119]
  v_mfma_f32_16x16x32_bf16 v[116:119], a[252:255], a[176:179], v[116:119]
  v_mfma_f32_16x16x32_bf16 v[116:119], v[100:103], a[188:191], v[116:119]
  v_mfma_f32_16x16x32_bf16 v[116:119], v[108:111], a[200:203], v[116:119]
  v_mfma_f32_16x16x32_bf16 v[116:119], v[112:115], a[212:215], v[116:119]
  v_cvt_pk_bf16_f32 v104, v136, v137
  v_cvt_pk_bf16_f32 v105, v138, v139
  s_nop 5
  v_cvt_pk_bf16_f32 v100, v116, v117
  v_cvt_pk_bf16_f32 v101, v118, v119
  ds_read_b128 a[244:247], v0 offset:6144
  ds_read_b128 a[248:251], v1 offset:6144
  ds_read_b128 a[252:255], v0 offset:14336
  ds_read_b128 v[132:135], v1 offset:14336
  ds_read_b128 v[136:139], v0 offset:22528
  ds_read_b128 v[140:143], v1 offset:22528
  s_waitcnt lgkmcnt(5)
  v_mfma_f32_16x16x32_bf16 v[144:147], a[0:3], a[244:247], 0
  s_waitcnt lgkmcnt(4)
  v_mfma_f32_16x16x32_bf16 v[144:147], a[12:15], a[248:251], v[144:147]
  s_waitcnt lgkmcnt(3)
  v_mfma_f32_16x16x32_bf16 v[144:147], a[24:27], a[252:255], v[144:147]
  s_waitcnt lgkmcnt(2)
  v_mfma_f32_16x16x32_bf16 v[144:147], a[36:39], v[132:135], v[144:147]
  s_waitcnt lgkmcnt(1)
  v_mfma_f32_16x16x32_bf16 v[144:147], a[48:51], v[136:139], v[144:147]
  s_waitcnt lgkmcnt(0)
  v_mfma_f32_16x16x32_bf16 v[144:147], a[60:63], v[140:143], v[144:147]
  v_mfma_f32_16x16x32_bf16 v[108:111], a[64:67], v[140:143], 0
  v_mfma_f32_16x16x32_bf16 v[108:111], a[52:55], v[136:139], v[108:111]
  v_mfma_f32_16x16x32_bf16 v[108:111], a[40:43], v[132:135], v[108:111]
  v_mfma_f32_16x16x32_bf16 v[108:111], a[28:31], a[252:255], v[108:111]
  v_mfma_f32_16x16x32_bf16 v[108:111], a[16:19], a[248:251], v[108:111]
  v_mfma_f32_16x16x32_bf16 v[108:111], a[4:7], a[244:247], v[108:111]
  v_mul_f32 v144, s42, v144
  v_mul_f32 v145, s42, v145
  v_mul_f32 v146, s42, v146
  v_mul_f32 v147, s42, v147
  v_cvt_pk_bf16_f32 v116, v144, v145
  v_cvt_pk_bf16_f32 v117, v146, v147
  v_mfma_f32_16x16x32_bf16 v[112:115], a[8:11], a[244:247], 0
  v_mfma_f32_16x16x32_bf16 v[112:115], a[20:23], a[248:251], v[112:115]
  v_mfma_f32_16x16x32_bf16 v[112:115], a[32:35], a[252:255], v[112:115]
  v_mfma_f32_16x16x32_bf16 v[112:115], a[44:47], v[132:135], v[112:115]
  v_mfma_f32_16x16x32_bf16 v[112:115], a[56:59], v[136:139], v[112:115]
  v_mfma_f32_16x16x32_bf16 v[112:115], a[68:71], v[140:143], v[112:115]
  v_mul_f32 v108, s42, v108
  v_mul_f32 v109, s42, v109
  v_mul_f32 v110, s42, v110
  v_mul_f32 v111, s42, v111
  v_cvt_pk_bf16_f32 v118, v108, v109
  v_cvt_pk_bf16_f32 v119, v110, v111
  v_mfma_f32_16x16x32_bf16 v[144:147], a[132:135], v[140:143], 0
  v_mfma_f32_16x16x32_bf16 v[144:147], a[120:123], v[136:139], v[144:147]
  v_mfma_f32_16x16x32_bf16 v[144:147], a[108:111], v[132:135], v[144:147]
  v_mfma_f32_16x16x32_bf16 v[144:147], a[96:99], a[252:255], v[144:147]
  v_mfma_f32_16x16x32_bf16 v[144:147], a[84:87], a[248:251], v[144:147]
  v_mfma_f32_16x16x32_bf16 v[144:147], a[72:75], a[244:247], v[144:147]
  v_mul_f32 v112, s42, v112
  v_mul_f32 v113, s42, v113
  v_mul_f32 v114, s42, v114
  v_mul_f32 v115, s42, v115
  v_cvt_pk_bf16_f32 v22, v112, v113
  v_cvt_pk_bf16_f32 v23, v114, v115
  v_mfma_f32_16x16x32_bf16 v[148:151], a[76:79], a[244:247], 0
  v_mfma_f32_16x16x32_bf16 v[148:151], a[88:91], a[248:251], v[148:151]
  v_mfma_f32_16x16x32_bf16 v[148:151], a[100:103], a[252:255], v[148:151]
  v_mfma_f32_16x16x32_bf16 v[148:151], a[112:115], v[132:135], v[148:151]
  v_mfma_f32_16x16x32_bf16 v[148:151], a[124:127], v[136:139], v[148:151]
  v_mfma_f32_16x16x32_bf16 v[148:151], a[136:139], v[140:143], v[148:151]
  v_cvt_pk_bf16_f32 v108, v144, v145
  v_cvt_pk_bf16_f32 v109, v146, v147
  v_mfma_f32_16x16x32_bf16 v[152:155], a[140:143], v[140:143], 0
  v_mfma_f32_16x16x32_bf16 v[152:155], a[128:131], v[136:139], v[152:155]
  v_mfma_f32_16x16x32_bf16 v[152:155], a[116:119], v[132:135], v[152:155]
  v_mfma_f32_16x16x32_bf16 v[152:155], a[104:107], a[252:255], v[152:155]
  v_mfma_f32_16x16x32_bf16 v[152:155], a[92:95], a[248:251], v[152:155]
  v_mfma_f32_16x16x32_bf16 v[152:155], a[80:83], a[244:247], v[152:155]
  v_cvt_pk_bf16_f32 v110, v148, v149
  v_cvt_pk_bf16_f32 v111, v150, v151
  v_mfma_f32_16x16x32_bf16 v[144:147], a[244:247], a[144:147], 0
  v_mfma_f32_16x16x32_bf16 v[144:147], a[248:251], a[156:159], v[144:147]
  v_mfma_f32_16x16x32_bf16 v[144:147], a[252:255], a[168:171], v[144:147]
  v_mfma_f32_16x16x32_bf16 v[144:147], v[132:135], a[180:183], v[144:147]
  v_mfma_f32_16x16x32_bf16 v[144:147], v[136:139], a[192:195], v[144:147]
  v_mfma_f32_16x16x32_bf16 v[144:147], v[140:143], a[204:207], v[144:147]
  v_cvt_pk_bf16_f32 v112, v152, v153
  v_cvt_pk_bf16_f32 v113, v154, v155
  v_mfma_f32_16x16x32_bf16 v[148:151], v[140:143], a[208:211], 0
  v_mfma_f32_16x16x32_bf16 v[148:151], v[136:139], a[196:199], v[148:151]
  v_mfma_f32_16x16x32_bf16 v[148:151], v[132:135], a[184:187], v[148:151]
  v_mfma_f32_16x16x32_bf16 v[148:151], a[252:255], a[172:175], v[148:151]
  v_mfma_f32_16x16x32_bf16 v[148:151], a[248:251], a[160:163], v[148:151]
  v_mfma_f32_16x16x32_bf16 v[148:151], a[244:247], a[148:151], v[148:151]
  v_cvt_pk_bf16_f32 v98, v144, v145
  v_cvt_pk_bf16_f32 v99, v146, v147
  v_mfma_f32_16x16x32_bf16 v[152:155], a[244:247], a[152:155], 0
  v_mfma_f32_16x16x32_bf16 v[152:155], a[248:251], a[164:167], v[152:155]
  v_mfma_f32_16x16x32_bf16 v[152:155], a[252:255], a[176:179], v[152:155]
  v_mfma_f32_16x16x32_bf16 v[152:155], v[132:135], a[188:191], v[152:155]
  v_mfma_f32_16x16x32_bf16 v[152:155], v[136:139], a[200:203], v[152:155]
  v_mfma_f32_16x16x32_bf16 v[152:155], v[140:143], a[212:215], v[152:155]
  v_cvt_pk_bf16_f32 v106, v148, v149
  v_cvt_pk_bf16_f32 v107, v150, v151
  s_nop 5
  v_cvt_pk_bf16_f32 v102, v152, v153
  v_cvt_pk_bf16_f32 v103, v154, v155
  v_mfma_f32_16x16x32_bf16 v[132:135], v[62:65], v[128:131], v[36:39]
  v_mfma_f32_16x16x32_bf16 v[132:135], v[60:63], v[12:15], v[132:135]
  v_mfma_f32_16x16x32_bf16 v[136:139], v[82:85], v[128:131], v[32:35]
  v_mfma_f32_16x16x32_bf16 v[136:139], v[80:83], v[12:15], v[136:139]
  v_mfma_f32_16x16x32_bf16 v[140:143], v[90:93], v[128:131], v[28:31]
  v_mfma_f32_16x16x32_bf16 v[140:143], v[88:91], v[12:15], v[140:143]
  v_mfma_f32_16x16x32_bf16 v[144:147], v[110:113], v[128:131], v[24:27]
  v_mfma_f32_16x16x32_bf16 v[144:147], v[108:111], v[12:15], v[144:147]
  v_add_f32 v132, v54, v132
  v_add_f32 v133, v54, v133
  v_add_f32 v134, v54, v134
  v_add_f32 v135, v54, v135
  v_add_f32 v136, v54, v136
  v_add_f32 v137, v54, v137
  v_add_f32 v138, v54, v138
  v_add_f32 v139, v54, v139
  v_add_f32 v140, v55, v140
  v_add_f32 v141, v55, v141
  v_add_f32 v142, v55, v142
  v_add_f32 v143, v55, v143
  v_add_f32 v144, v55, v144
  v_add_f32 v145, v55, v145
  v_add_f32 v146, v55, v146
  v_add_f32 v147, v55, v147
  v_max_f32 v58, v132, v133
  v_max3_f32 v58, v134, v135, v58
  v_max3_f32 v58, v136, v137, v58
  v_max3_f32 v58, v138, v139, v58
  v_max3_f32 v58, v140, v141, v58
  v_max3_f32 v58, v142, v143, v58
  v_max3_f32 v58, v144, v145, v58
  v_max3_f32 v58, v146, v147, v58
  v_mov_b32 v59, v58
  s_nop 1
  v_permlane32_swap_b32 v58, v59
  v_max_f32 v58, v58, v59
  v_mov_b32 v59, v58
  s_nop 1
  v_permlane16_swap_b32 v58, v59
  v_max_f32 v58, v58, v59
  v_sub_f32 v132, v132, v58
  v_sub_f32 v133, v133, v58
  v_sub_f32 v134, v134, v58
  v_sub_f32 v135, v135, v58
  v_sub_f32 v136, v136, v58
  v_sub_f32 v137, v137, v58
  v_sub_f32 v138, v138, v58
  v_sub_f32 v139, v139, v58
  v_sub_f32 v140, v140, v58
  v_sub_f32 v141, v141, v58
  v_sub_f32 v142, v142, v58
  v_sub_f32 v143, v143, v58
  v_sub_f32 v144, v144, v58
  v_sub_f32 v145, v145, v58
  v_sub_f32 v146, v146, v58
  v_sub_f32 v147, v147, v58
  v_exp_f32 v132, v132
  v_exp_f32 v133, v133
  v_exp_f32 v134, v134
  v_exp_f32 v135, v135
  v_cvt_pk_bf16_f32 v132, v132, v133
  v_cvt_pk_bf16_f32 v133, v134, v135
  v_exp_f32 v136, v136
  v_exp_f32 v137, v137
  v_exp_f32 v138, v138
  v_exp_f32 v139, v139
  v_cvt_pk_bf16_f32 v134, v136, v137
  v_cvt_pk_bf16_f32 v135, v138, v139
  v_exp_f32 v140, v140
  v_exp_f32 v141, v141
  v_exp_f32 v142, v142
  v_exp_f32 v143, v143
  v_cvt_pk_bf16_f32 v136, v140, v141
  v_cvt_pk_bf16_f32 v137, v142, v143
  v_exp_f32 v144, v144
  v_exp_f32 v145, v145
  v_exp_f32 v146, v146
  v_exp_f32 v147, v147
  v_cvt_pk_bf16_f32 v138, v144, v145
  v_cvt_pk_bf16_f32 v139, v146, v147
  v_mov_b64 v[128:129], 0
  s_nop 1
  v_smfmac_f32_16x16x64_bf16 v[128:131], a[240:243], v[132:139], v10
  v_mfma_f32_16x16x32_bf16 v[148:151], v[96:99], v[136:139], 0
  v_mfma_f32_16x16x32_bf16 v[148:151], v[68:71], v[132:135], v[148:151]
  v_mfma_f32_16x16x32_bf16 v[140:143], v[72:75], v[132:135], 0
  v_mfma_f32_16x16x32_bf16 v[140:143], v[104:107], v[136:139], v[140:143]
  v_mfma_f32_16x16x32_bf16 v[144:147], v[100:103], v[136:139], 0
  v_mfma_f32_16x16x32_bf16 v[144:147], v[76:79], v[132:135], v[144:147]
  v_add_f32 v128, v128, v129
  v_rcp_f32 v130, v128
  s_nop 0
  v_mul_f32 v148, v130, v148
  v_mul_f32 v149, v130, v149
  v_mul_f32 v150, v130, v150
  v_mul_f32 v151, v130, v151
  v_cvt_pk_bf16_f32 v148, v148, v149
  v_cvt_pk_bf16_f32 v149, v150, v151
  ds_write_b32 v5, v148 offset:0
  ds_write_b32 v5, v149 offset:1024
  v_mul_f32 v140, v130, v140
  v_mul_f32 v141, v130, v141
  v_mul_f32 v142, v130, v142
  v_mul_f32 v143, v130, v143
  v_cvt_pk_bf16_f32 v140, v140, v141
  v_cvt_pk_bf16_f32 v141, v142, v143
  ds_write_b32 v5, v140 offset:2048
  ds_write_b32 v5, v141 offset:3072
  v_mul_f32 v144, v130, v144
  v_mul_f32 v145, v130, v145
  v_mul_f32 v146, v130, v146
  v_mul_f32 v147, v130, v147
  v_cvt_pk_bf16_f32 v144, v144, v145
  v_cvt_pk_bf16_f32 v145, v146, v147
  ds_write_b32 v5, v144 offset:4096
  ds_write_b32 v5, v145 offset:5120
  v_mfma_f32_16x16x32_bf16 v[128:131], v[60:63], v[124:127], v[40:43]
  v_mfma_f32_16x16x32_bf16 v[128:131], v[62:65], v[14:17], v[128:131]
  v_mfma_f32_16x16x32_bf16 v[132:135], v[80:83], v[124:127], v[36:39]
  v_mfma_f32_16x16x32_bf16 v[132:135], v[82:85], v[14:17], v[132:135]
  v_mfma_f32_16x16x32_bf16 v[136:139], v[88:91], v[124:127], v[32:35]
  v_mfma_f32_16x16x32_bf16 v[136:139], v[90:93], v[14:17], v[136:139]
  v_mfma_f32_16x16x32_bf16 v[140:143], v[108:111], v[124:127], v[28:31]
  v_mfma_f32_16x16x32_bf16 v[140:143], v[110:113], v[14:17], v[140:143]
  v_add_f32 v128, v54, v128
  v_add_f32 v129, v54, v129
  v_add_f32 v130, v54, v130
  v_add_f32 v131, v54, v131
  v_add_f32 v132, v54, v132
  v_add_f32 v133, v54, v133
  v_add_f32 v134, v54, v134
  v_add_f32 v135, v54, v135
  v_add_f32 v136, v55, v136
  v_add_f32 v137, v55, v137
  v_add_f32 v138, v55, v138
  v_add_f32 v139, v55, v139
  v_add_f32 v140, v55, v140
  v_add_f32 v141, v55, v141
  v_add_f32 v142, v55, v142
  v_add_f32 v143, v55, v143
  v_max_f32 v58, v128, v129
  v_max3_f32 v58, v130, v131, v58
  v_max3_f32 v58, v132, v133, v58
  v_max3_f32 v58, v134, v135, v58
  v_max3_f32 v58, v136, v137, v58
  v_max3_f32 v58, v138, v139, v58
  v_max3_f32 v58, v140, v141, v58
  v_max3_f32 v58, v142, v143, v58
  v_mov_b32 v59, v58
  s_nop 1
  v_permlane32_swap_b32 v58, v59
  v_max_f32 v58, v58, v59
  v_mov_b32 v59, v58
  s_nop 1
  v_permlane16_swap_b32 v58, v59
  v_max_f32 v58, v58, v59
  v_sub_f32 v128, v128, v58
  v_sub_f32 v129, v129, v58
  v_sub_f32 v130, v130, v58
  v_sub_f32 v131, v131, v58
  v_sub_f32 v132, v132, v58
  v_sub_f32 v133, v133, v58
  v_sub_f32 v134, v134, v58
  v_sub_f32 v135, v135, v58
  v_sub_f32 v136, v136, v58
  v_sub_f32 v137, v137, v58
  v_sub_f32 v138, v138, v58
  v_sub_f32 v139, v139, v58
  v_sub_f32 v140, v140, v58
  v_sub_f32 v141, v141, v58
  v_sub_f32 v142, v142, v58
  v_sub_f32 v143, v143, v58
  v_exp_f32 v128, v128
  v_exp_f32 v129, v129
  v_exp_f32 v130, v130
  v_exp_f32 v131, v131
  v_cvt_pk_bf16_f32 v128, v128, v129
  v_cvt_pk_bf16_f32 v129, v130, v131
  v_exp_f32 v132, v132
  v_exp_f32 v133, v133
  v_exp_f32 v134, v134
  v_exp_f32 v135, v135
  v_cvt_pk_bf16_f32 v130, v132, v133
  v_cvt_pk_bf16_f32 v131, v134, v135
  v_exp_f32 v136, v136
  v_exp_f32 v137, v137
  v_exp_f32 v138, v138
  v_exp_f32 v139, v139
  v_cvt_pk_bf16_f32 v132, v136, v137
  v_cvt_pk_bf16_f32 v133, v138, v139
  v_exp_f32 v140, v140
  v_exp_f32 v141, v141
  v_exp_f32 v142, v142
  v_exp_f32 v143, v143
  v_cvt_pk_bf16_f32 v134, v140, v141
  v_cvt_pk_bf16_f32 v135, v142, v143
  v_mov_b64 v[124:125], 0
  s_nop 1
  v_smfmac_f32_16x16x64_bf16 v[124:127], a[240:243], v[128:135], v10
  v_mfma_f32_16x16x32_bf16 v[144:147], v[96:99], v[132:135], 0
  v_mfma_f32_16x16x32_bf16 v[144:147], v[68:71], v[128:131], v[144:147]
  v_mfma_f32_16x16x32_bf16 v[136:139], v[72:75], v[128:131], 0
  v_mfma_f32_16x16x32_bf16 v[136:139], v[104:107], v[132:135], v[136:139]
  v_mfma_f32_16x16x32_bf16 v[140:143], v[100:103], v[132:135], 0
  v_mfma_f32_16x16x32_bf16 v[140:143], v[76:79], v[128:131], v[140:143]
  v_add_f32 v124, v124, v125
  v_rcp_f32 v126, v124
  s_nop 0
  v_mul_f32 v144, v126, v144
  v_mul_f32 v145, v126, v145
  v_mul_f32 v146, v126, v146
  v_mul_f32 v147, v126, v147
  v_cvt_pk_bf16_f32 v144, v144, v145
  v_cvt_pk_bf16_f32 v145, v146, v147
  ds_write_b32 v5, v144 offset:256
  ds_write_b32 v5, v145 offset:1280
  v_mul_f32 v136, v126, v136
  v_mul_f32 v137, v126, v137
  v_mul_f32 v138, v126, v138
  v_mul_f32 v139, v126, v139
  v_cvt_pk_bf16_f32 v136, v136, v137
  v_cvt_pk_bf16_f32 v137, v138, v139
  ds_write_b32 v5, v136 offset:2304
  ds_write_b32 v5, v137 offset:3328
  v_mul_f32 v140, v126, v140
  v_mul_f32 v141, v126, v141
  v_mul_f32 v142, v126, v142
  v_mul_f32 v143, v126, v143
  v_cvt_pk_bf16_f32 v140, v140, v141
  v_cvt_pk_bf16_f32 v141, v142, v143
  ds_write_b32 v5, v140 offset:4352
  ds_write_b32 v5, v141 offset:5376
  v_mfma_f32_16x16x32_bf16 v[124:127], v[90:93], v[120:123], v[36:39]
  v_mfma_f32_16x16x32_bf16 v[124:127], v[88:91], v[18:21], v[124:127]
  v_mfma_f32_16x16x32_bf16 v[128:131], v[110:113], v[120:123], v[32:35]
  v_mfma_f32_16x16x32_bf16 v[128:131], v[108:111], v[18:21], v[128:131]
  v_mfma_f32_16x16x32_bf16 v[132:135], v[62:65], v[120:123], v[44:47]
  v_mfma_f32_16x16x32_bf16 v[132:135], v[60:63], v[18:21], v[132:135]
  v_mfma_f32_16x16x32_bf16 v[136:139], v[82:85], v[120:123], v[40:43]
  v_mfma_f32_16x16x32_bf16 v[136:139], v[80:83], v[18:21], v[136:139]
  v_add_f32 v124, v54, v124
  v_add_f32 v125, v54, v125
  v_add_f32 v126, v54, v126
  v_add_f32 v127, v54, v127
  v_add_f32 v128, v54, v128
  v_add_f32 v129, v54, v129
  v_add_f32 v130, v54, v130
  v_add_f32 v131, v54, v131
  v_add_f32 v132, v55, v132
  v_add_f32 v133, v55, v133
  v_add_f32 v134, v55, v134
  v_add_f32 v135, v55, v135
  v_add_f32 v136, v55, v136
  v_add_f32 v137, v55, v137
  v_add_f32 v138, v55, v138
  v_add_f32 v139, v55, v139
  v_max_f32 v58, v124, v125
  v_max3_f32 v58, v126, v127, v58
  v_max3_f32 v58, v128, v129, v58
  v_max3_f32 v58, v130, v131, v58
  v_max3_f32 v58, v132, v133, v58
  v_max3_f32 v58, v134, v135, v58
  v_max3_f32 v58, v136, v137, v58
  v_max3_f32 v58, v138, v139, v58
  v_mov_b32 v59, v58
  s_nop 1
  v_permlane32_swap_b32 v58, v59
  v_max_f32 v58, v58, v59
  v_mov_b32 v59, v58
  s_nop 1
  v_permlane16_swap_b32 v58, v59
  v_max_f32 v58, v58, v59
  v_sub_f32 v124, v124, v58
  v_sub_f32 v125, v125, v58
  v_sub_f32 v126, v126, v58
  v_sub_f32 v127, v127, v58
  v_sub_f32 v128, v128, v58
  v_sub_f32 v129, v129, v58
  v_sub_f32 v130, v130, v58
  v_sub_f32 v131, v131, v58
  v_sub_f32 v132, v132, v58
  v_sub_f32 v133, v133, v58
  v_sub_f32 v134, v134, v58
  v_sub_f32 v135, v135, v58
  v_sub_f32 v136, v136, v58
  v_sub_f32 v137, v137, v58
  v_sub_f32 v138, v138, v58
  v_sub_f32 v139, v139, v58
  v_exp_f32 v124, v124
  v_exp_f32 v125, v125
  v_exp_f32 v126, v126
  v_exp_f32 v127, v127
  v_cvt_pk_bf16_f32 v124, v124, v125
  v_cvt_pk_bf16_f32 v125, v126, v127
  v_exp_f32 v128, v128
  v_exp_f32 v129, v129
  v_exp_f32 v130, v130
  v_exp_f32 v131, v131
  v_cvt_pk_bf16_f32 v126, v128, v129
  v_cvt_pk_bf16_f32 v127, v130, v131
  v_exp_f32 v132, v132
  v_exp_f32 v133, v133
  v_exp_f32 v134, v134
  v_exp_f32 v135, v135
  v_cvt_pk_bf16_f32 v128, v132, v133
  v_cvt_pk_bf16_f32 v129, v134, v135
  v_exp_f32 v136, v136
  v_exp_f32 v137, v137
  v_exp_f32 v138, v138
  v_exp_f32 v139, v139
  v_cvt_pk_bf16_f32 v130, v136, v137
  v_cvt_pk_bf16_f32 v131, v138, v139
  v_mov_b64 v[120:121], 0
  s_nop 1
  v_smfmac_f32_16x16x64_bf16 v[120:123], a[240:243], v[124:131], v10
  v_mfma_f32_16x16x32_bf16 v[140:143], v[68:71], v[128:131], 0
  v_mfma_f32_16x16x32_bf16 v[140:143], v[96:99], v[124:127], v[140:143]
  v_mfma_f32_16x16x32_bf16 v[132:135], v[104:107], v[124:127], 0
  v_mfma_f32_16x16x32_bf16 v[132:135], v[72:75], v[128:131], v[132:135]
  v_mfma_f32_16x16x32_bf16 v[136:139], v[76:79], v[128:131], 0
  v_mfma_f32_16x16x32_bf16 v[136:139], v[100:103], v[124:127], v[136:139]
  v_add_f32 v120, v120, v121
  v_rcp_f32 v122, v120
  s_nop 0
  v_mul_f32 v140, v122, v140
  v_mul_f32 v141, v122, v141
  v_mul_f32 v142, v122, v142
  v_mul_f32 v143, v122, v143
  v_cvt_pk_bf16_f32 v140, v140, v141
  v_cvt_pk_bf16_f32 v141, v142, v143
  ds_write_b32 v5, v140 offset:512
  ds_write_b32 v5, v141 offset:1536
  v_mul_f32 v132, v122, v132
  v_mul_f32 v133, v122, v133
  v_mul_f32 v134, v122, v134
  v_mul_f32 v135, v122, v135
  v_cvt_pk_bf16_f32 v132, v132, v133
  v_cvt_pk_bf16_f32 v133, v134, v135
  ds_write_b32 v5, v132 offset:2560
  s_waitcnt lgkmcnt(12)
  ds_write_b32 v5, v133 offset:3584
  v_mul_f32 v136, v122, v136
  v_mul_f32 v137, v122, v137
  v_mul_f32 v138, v122, v138
  v_mul_f32 v139, v122, v139
  v_cvt_pk_bf16_f32 v136, v136, v137
  v_cvt_pk_bf16_f32 v137, v138, v139
  ds_write_b32 v5, v136 offset:4608
  ds_write_b32 v5, v137 offset:5632
  v_mfma_f32_16x16x32_bf16 v[120:123], v[88:91], v[116:119], v[40:43]
  v_mfma_f32_16x16x32_bf16 v[120:123], v[90:93], v[20:23], v[120:123]
  v_mfma_f32_16x16x32_bf16 v[124:127], v[108:111], v[116:119], v[36:39]
  v_mfma_f32_16x16x32_bf16 v[124:127], v[110:113], v[20:23], v[124:127]
  v_mfma_f32_16x16x32_bf16 v[128:131], v[60:63], v[116:119], v[48:51]
  v_mfma_f32_16x16x32_bf16 v[128:131], v[62:65], v[20:23], v[128:131]
  v_mfma_f32_16x16x32_bf16 v[88:91], v[80:83], v[116:119], v[44:47]
  v_mfma_f32_16x16x32_bf16 v[88:91], v[82:85], v[20:23], v[88:91]
  v_add_f32 v120, v54, v120
  v_add_f32 v121, v54, v121
  v_add_f32 v122, v54, v122
  v_add_f32 v123, v54, v123
  v_add_f32 v124, v54, v124
  v_add_f32 v125, v54, v125
  v_add_f32 v126, v54, v126
  v_add_f32 v127, v54, v127
  v_add_f32 v128, v55, v128
  v_add_f32 v129, v55, v129
  v_add_f32 v130, v55, v130
  v_add_f32 v131, v55, v131
  v_add_f32 v88, v55, v88
  v_add_f32 v89, v55, v89
  v_add_f32 v90, v55, v90
  v_add_f32 v91, v55, v91
  v_max_f32 v58, v120, v121
  v_max3_f32 v58, v122, v123, v58
  v_max3_f32 v58, v124, v125, v58
  v_max3_f32 v58, v126, v127, v58
  v_max3_f32 v58, v128, v129, v58
  v_max3_f32 v58, v130, v131, v58
  v_max3_f32 v58, v88, v89, v58
  v_max3_f32 v58, v90, v91, v58
  v_mov_b32 v59, v58
  s_nop 1
  v_permlane32_swap_b32 v58, v59
  v_max_f32 v58, v58, v59
  v_mov_b32 v59, v58
  s_nop 1
  v_permlane16_swap_b32 v58, v59
  v_max_f32 v58, v58, v59
  v_sub_f32 v120, v120, v58
  v_sub_f32 v121, v121, v58
  v_sub_f32 v122, v122, v58
  v_sub_f32 v123, v123, v58
  v_sub_f32 v124, v124, v58
  v_sub_f32 v125, v125, v58
  v_sub_f32 v126, v126, v58
  v_sub_f32 v127, v127, v58
  v_sub_f32 v128, v128, v58
  v_sub_f32 v129, v129, v58
  v_sub_f32 v130, v130, v58
  v_sub_f32 v131, v131, v58
  v_sub_f32 v88, v88, v58
  v_sub_f32 v89, v89, v58
  v_sub_f32 v90, v90, v58
  v_sub_f32 v91, v91, v58
  v_exp_f32 v120, v120
  v_exp_f32 v121, v121
  v_exp_f32 v122, v122
  v_exp_f32 v123, v123
  v_cvt_pk_bf16_f32 v120, v120, v121
  v_cvt_pk_bf16_f32 v121, v122, v123
  v_exp_f32 v124, v124
  v_exp_f32 v125, v125
  v_exp_f32 v126, v126
  v_exp_f32 v127, v127
  v_cvt_pk_bf16_f32 v122, v124, v125
  v_cvt_pk_bf16_f32 v123, v126, v127
  v_exp_f32 v128, v128
  v_exp_f32 v129, v129
  v_exp_f32 v130, v130
  v_exp_f32 v131, v131
  v_cvt_pk_bf16_f32 v124, v128, v129
  v_cvt_pk_bf16_f32 v125, v130, v131
  v_exp_f32 v88, v88
  v_exp_f32 v89, v89
  v_exp_f32 v90, v90
  v_exp_f32 v91, v91
  v_cvt_pk_bf16_f32 v126, v88, v89
  v_cvt_pk_bf16_f32 v127, v90, v91
  v_mov_b64 v[80:81], 0
  s_nop 1
  v_smfmac_f32_16x16x64_bf16 v[80:83], a[240:243], v[120:127], v10
  v_mfma_f32_16x16x32_bf16 v[84:87], v[68:71], v[124:127], 0
  v_mfma_f32_16x16x32_bf16 v[84:87], v[96:99], v[120:123], v[84:87]
  v_mfma_f32_16x16x32_bf16 v[60:63], v[104:107], v[120:123], 0
  v_mfma_f32_16x16x32_bf16 v[60:63], v[72:75], v[124:127], v[60:63]
  v_mfma_f32_16x16x32_bf16 v[64:67], v[76:79], v[124:127], 0
  v_mfma_f32_16x16x32_bf16 v[64:67], v[100:103], v[120:123], v[64:67]
  v_add_f32 v80, v80, v81
  v_rcp_f32 v82, v80
  s_nop 0
  v_mul_f32 v84, v82, v84
  v_mul_f32 v85, v82, v85
  v_mul_f32 v86, v82, v86
  v_mul_f32 v87, v82, v87
  v_cvt_pk_bf16_f32 v84, v84, v85
  v_cvt_pk_bf16_f32 v85, v86, v87
  s_waitcnt lgkmcnt(12)
  ds_write_b32 v5, v84 offset:768
  ds_write_b32 v5, v85 offset:1792
  v_mul_f32 v60, v82, v60
  v_mul_f32 v61, v82, v61
  v_mul_f32 v62, v82, v62
  v_mul_f32 v63, v82, v63
  v_cvt_pk_bf16_f32 v60, v60, v61
  v_cvt_pk_bf16_f32 v61, v62, v63
  ds_write_b32 v5, v60 offset:2816
  s_waitcnt lgkmcnt(12)
  ds_write_b32 v5, v61 offset:3840
  v_mul_f32 v64, v82, v64
  v_mul_f32 v65, v82, v65
  v_mul_f32 v66, v82, v66
  v_mul_f32 v67, v82, v67
  v_cvt_pk_bf16_f32 v64, v64, v65
  v_cvt_pk_bf16_f32 v65, v66, v67
  ds_write_b32 v5, v64 offset:4864
  ds_write_b32 v5, v65 offset:5888
  s_waitcnt lgkmcnt(0)
  s_barrier
  ds_read_b128 a[244:247], v3 offset:0
  ds_read_b128 a[248:251], v3 offset:4096
  ds_read_b128 a[252:255], v3 offset:8192
  ds_read_b128 v[72:75], v3 offset:12288
  ds_read_b128 v[76:79], v3 offset:16384
  ds_read_b128 v[84:87], v3 offset:20480
  s_waitcnt lgkmcnt(5)
  v_mfma_f32_16x16x32_bf16 v[68:71], a[244:247], v[184:187], 0
  s_waitcnt lgkmcnt(4)
  v_mfma_f32_16x16x32_bf16 v[68:71], a[248:251], v[200:203], v[68:71]
  s_waitcnt lgkmcnt(3)
  v_mfma_f32_16x16x32_bf16 v[68:71], a[252:255], v[216:219], v[68:71]
  s_waitcnt lgkmcnt(2)
  v_mfma_f32_16x16x32_bf16 v[68:71], v[72:75], v[232:235], v[68:71]
  s_waitcnt lgkmcnt(1)
  v_mfma_f32_16x16x32_bf16 v[68:71], v[76:79], v[248:251], v[68:71]
  s_waitcnt lgkmcnt(0)
  v_mfma_f32_16x16x32_bf16 v[68:71], v[84:87], a[224:227], v[68:71]
  v_mfma_f32_16x16x32_bf16 v[80:83], v[84:87], a[228:231], 0
  v_mfma_f32_16x16x32_bf16 v[80:83], v[76:79], v[252:255], v[80:83]
  v_mfma_f32_16x16x32_bf16 v[80:83], v[72:75], v[236:239], v[80:83]
  v_mfma_f32_16x16x32_bf16 v[80:83], a[252:255], v[220:223], v[80:83]
  v_mfma_f32_16x16x32_bf16 v[80:83], a[248:251], v[204:207], v[80:83]
  v_mfma_f32_16x16x32_bf16 v[80:83], a[244:247], v[188:191], v[80:83]
  v_mfma_f32_16x16x32_bf16 v[60:63], a[244:247], v[192:195], 0
  v_mfma_f32_16x16x32_bf16 v[60:63], a[248:251], v[208:211], v[60:63]
  v_mfma_f32_16x16x32_bf16 v[60:63], a[252:255], v[224:227], v[60:63]
  v_mfma_f32_16x16x32_bf16 v[60:63], v[72:75], v[240:243], v[60:63]
  v_mfma_f32_16x16x32_bf16 v[60:63], v[76:79], a[216:219], v[60:63]
  v_mfma_f32_16x16x32_bf16 v[60:63], v[84:87], a[232:235], v[60:63]
  v_mfma_f32_16x16x32_bf16 v[64:67], v[84:87], a[236:239], 0
  v_mfma_f32_16x16x32_bf16 v[64:67], v[76:79], a[220:223], v[64:67]
  v_mfma_f32_16x16x32_bf16 v[64:67], v[72:75], v[244:247], v[64:67]
  v_mfma_f32_16x16x32_bf16 v[64:67], a[252:255], v[228:231], v[64:67]
  v_mfma_f32_16x16x32_bf16 v[64:67], a[248:251], v[212:215], v[64:67]
  v_mfma_f32_16x16x32_bf16 v[64:67], a[244:247], v[196:199], v[64:67]
  v_cvt_pk_bf16_f32 v68, v68, v80
  v_cvt_pk_bf16_f32 v69, v69, v81
  v_cvt_pk_bf16_f32 v70, v70, v82
  v_cvt_pk_bf16_f32 v71, v71, v83
  buffer_store_dword v68, v7, s[24:27], s33 offen offset:0 nt
  buffer_store_dword v69, v7, s[24:27], s33 offen offset:384 nt
  buffer_store_dword v70, v7, s[24:27], s33 offen offset:768 nt
  buffer_store_dword v71, v7, s[24:27], s33 offen offset:1152 nt
  v_cvt_pk_bf16_f32 v60, v60, v64
  v_cvt_pk_bf16_f32 v61, v61, v65
  v_cvt_pk_bf16_f32 v62, v62, v66
  v_cvt_pk_bf16_f32 v63, v63, v67
  buffer_store_dword v60, v8, s[24:27], s33 offen offset:0 nt
  buffer_store_dword v61, v8, s[24:27], s33 offen offset:384 nt
  buffer_store_dword v62, v8, s[24:27], s33 offen offset:768 nt
  buffer_store_dword v63, v8, s[24:27], s33 offen offset:1152 nt
  ds_read_b128 a[244:247], v4 offset:0
  ds_read_b128 a[248:251], v4 offset:4096
  ds_read_b128 a[252:255], v4 offset:8192
  ds_read_b128 v[68:71], v4 offset:12288
  ds_read_b128 v[72:75], v4 offset:16384
  ds_read_b128 v[76:79], v4 offset:20480
  s_waitcnt lgkmcnt(5)
  v_mfma_f32_16x16x32_bf16 v[60:63], a[244:247], v[184:187], 0
  s_waitcnt lgkmcnt(4)
  v_mfma_f32_16x16x32_bf16 v[60:63], a[248:251], v[200:203], v[60:63]
  s_waitcnt lgkmcnt(3)
  v_mfma_f32_16x16x32_bf16 v[60:63], a[252:255], v[216:219], v[60:63]
  s_waitcnt lgkmcnt(2)
  v_mfma_f32_16x16x32_bf16 v[60:63], v[68:71], v[232:235], v[60:63]
  s_waitcnt lgkmcnt(1)
  v_mfma_f32_16x16x32_bf16 v[60:63], v[72:75], v[248:251], v[60:63]
  s_waitcnt lgkmcnt(0)
  v_mfma_f32_16x16x32_bf16 v[60:63], v[76:79], a[224:227], v[60:63]
  v_mfma_f32_16x16x32_bf16 v[64:67], v[76:79], a[228:231], 0
  v_mfma_f32_16x16x32_bf16 v[64:67], v[72:75], v[252:255], v[64:67]
  v_mfma_f32_16x16x32_bf16 v[64:67], v[68:71], v[236:239], v[64:67]
  v_mfma_f32_16x16x32_bf16 v[64:67], a[252:255], v[220:223], v[64:67]
  v_mfma_f32_16x16x32_bf16 v[64:67], a[248:251], v[204:207], v[64:67]
  v_mfma_f32_16x16x32_bf16 v[64:67], a[244:247], v[188:191], v[64:67]
  s_nop 7
  v_cvt_pk_bf16_f32 v60, v60, v64
  v_cvt_pk_bf16_f32 v61, v61, v65
  v_cvt_pk_bf16_f32 v62, v62, v66
  v_cvt_pk_bf16_f32 v63, v63, v67
  buffer_store_dword v60, v7, s[24:27], s34 offen offset:0 nt
  buffer_store_dword v61, v7, s[24:27], s34 offen offset:384 nt
  buffer_store_dword v62, v7, s[24:27], s34 offen offset:768 nt
  buffer_store_dword v63, v7, s[24:27], s34 offen offset:1152 nt
  ds_read_b128 a[244:247], v3 offset:512
  ds_read_b128 a[248:251], v3 offset:4608
  ds_read_b128 a[252:255], v3 offset:8704
  ds_read_b128 v[72:75], v3 offset:12800
  ds_read_b128 v[76:79], v3 offset:16896
  ds_read_b128 v[84:87], v3 offset:20992
  s_waitcnt lgkmcnt(5)
  v_mfma_f32_16x16x32_bf16 v[60:63], a[244:247], v[184:187], 0
  s_waitcnt lgkmcnt(4)
  v_mfma_f32_16x16x32_bf16 v[60:63], a[248:251], v[200:203], v[60:63]
  s_waitcnt lgkmcnt(3)
  v_mfma_f32_16x16x32_bf16 v[60:63], a[252:255], v[216:219], v[60:63]
  s_waitcnt lgkmcnt(2)
  v_mfma_f32_16x16x32_bf16 v[60:63], v[72:75], v[232:235], v[60:63]
  s_waitcnt lgkmcnt(1)
  v_mfma_f32_16x16x32_bf16 v[60:63], v[76:79], v[248:251], v[60:63]
  s_waitcnt lgkmcnt(0)
  v_mfma_f32_16x16x32_bf16 v[60:63], v[84:87], a[224:227], v[60:63]
  v_mfma_f32_16x16x32_bf16 v[80:83], v[84:87], a[228:231], 0
  v_mfma_f32_16x16x32_bf16 v[80:83], v[76:79], v[252:255], v[80:83]
  v_mfma_f32_16x16x32_bf16 v[80:83], v[72:75], v[236:239], v[80:83]
  v_mfma_f32_16x16x32_bf16 v[80:83], a[252:255], v[220:223], v[80:83]
  v_mfma_f32_16x16x32_bf16 v[80:83], a[248:251], v[204:207], v[80:83]
  v_mfma_f32_16x16x32_bf16 v[80:83], a[244:247], v[188:191], v[80:83]
  v_mfma_f32_16x16x32_bf16 v[64:67], a[244:247], v[192:195], 0
  v_mfma_f32_16x16x32_bf16 v[64:67], a[248:251], v[208:211], v[64:67]
  v_mfma_f32_16x16x32_bf16 v[64:67], a[252:255], v[224:227], v[64:67]
  v_mfma_f32_16x16x32_bf16 v[64:67], v[72:75], v[240:243], v[64:67]
  v_mfma_f32_16x16x32_bf16 v[64:67], v[76:79], a[216:219], v[64:67]
  v_mfma_f32_16x16x32_bf16 v[64:67], v[84:87], a[232:235], v[64:67]
  v_mfma_f32_16x16x32_bf16 v[68:71], v[84:87], a[236:239], 0
  v_mfma_f32_16x16x32_bf16 v[68:71], v[76:79], a[220:223], v[68:71]
  v_mfma_f32_16x16x32_bf16 v[68:71], v[72:75], v[244:247], v[68:71]
  v_mfma_f32_16x16x32_bf16 v[68:71], a[252:255], v[228:231], v[68:71]
  v_mfma_f32_16x16x32_bf16 v[68:71], a[248:251], v[212:215], v[68:71]
  v_mfma_f32_16x16x32_bf16 v[68:71], a[244:247], v[196:199], v[68:71]
  v_cvt_pk_bf16_f32 v60, v60, v80
  v_cvt_pk_bf16_f32 v61, v61, v81
  v_cvt_pk_bf16_f32 v62, v62, v82
  v_cvt_pk_bf16_f32 v63, v63, v83
  buffer_store_dword v60, v7, s[24:27], s35 offen offset:0 nt
  buffer_store_dword v61, v7, s[24:27], s35 offen offset:384 nt
  buffer_store_dword v62, v7, s[24:27], s35 offen offset:768 nt
  buffer_store_dword v63, v7, s[24:27], s35 offen offset:1152 nt
  v_cvt_pk_bf16_f32 v64, v64, v68
  v_cvt_pk_bf16_f32 v65, v65, v69
  v_cvt_pk_bf16_f32 v66, v66, v70
  v_cvt_pk_bf16_f32 v67, v67, v71
  buffer_store_dword v64, v8, s[24:27], s35 offen offset:0 nt
  buffer_store_dword v65, v8, s[24:27], s35 offen offset:384 nt
  buffer_store_dword v66, v8, s[24:27], s35 offen offset:768 nt
  buffer_store_dword v67, v8, s[24:27], s35 offen offset:1152 nt
  ds_read_b128 a[244:247], v4 offset:512
  ds_read_b128 a[248:251], v4 offset:4608
  ds_read_b128 a[252:255], v4 offset:8704
  ds_read_b128 v[72:75], v4 offset:12800
  ds_read_b128 v[76:79], v4 offset:16896
  ds_read_b128 v[80:83], v4 offset:20992
  s_waitcnt lgkmcnt(5)
  v_mfma_f32_16x16x32_bf16 v[60:63], a[244:247], v[184:187], 0
  s_waitcnt lgkmcnt(4)
  v_mfma_f32_16x16x32_bf16 v[60:63], a[248:251], v[200:203], v[60:63]
  s_waitcnt lgkmcnt(3)
  v_mfma_f32_16x16x32_bf16 v[60:63], a[252:255], v[216:219], v[60:63]
  s_waitcnt lgkmcnt(2)
  v_mfma_f32_16x16x32_bf16 v[60:63], v[72:75], v[232:235], v[60:63]
  s_waitcnt lgkmcnt(1)
  v_mfma_f32_16x16x32_bf16 v[60:63], v[76:79], v[248:251], v[60:63]
  s_waitcnt lgkmcnt(0)
  v_mfma_f32_16x16x32_bf16 v[60:63], v[80:83], a[224:227], v[60:63]
  v_mfma_f32_16x16x32_bf16 v[64:67], v[80:83], a[228:231], 0
  v_mfma_f32_16x16x32_bf16 v[64:67], v[76:79], v[252:255], v[64:67]
  v_mfma_f32_16x16x32_bf16 v[64:67], v[72:75], v[236:239], v[64:67]
  v_mfma_f32_16x16x32_bf16 v[64:67], a[252:255], v[220:223], v[64:67]
  v_mfma_f32_16x16x32_bf16 v[64:67], a[248:251], v[204:207], v[64:67]
  v_mfma_f32_16x16x32_bf16 v[64:67], a[244:247], v[188:191], v[64:67]
  s_nop 7
  v_cvt_pk_bf16_f32 v60, v60, v64
  v_cvt_pk_bf16_f32 v61, v61, v65
  v_cvt_pk_bf16_f32 v62, v62, v66
  v_cvt_pk_bf16_f32 v63, v63, v67
  buffer_store_dword v60, v7, s[24:27], s36 offen offset:0 nt
  buffer_store_dword v61, v7, s[24:27], s36 offen offset:384 nt
  buffer_store_dword v62, v7, s[24:27], s36 offen offset:768 nt
  buffer_store_dword v63, v7, s[24:27], s36 offen offset:1152 nt
  v_sub_u32 v6, v6, v56
  v_sub_u32 v7, v7, v57
  v_sub_u32 v8, v8, v57
  v_mov_b32 v54, 0
  v_mov_b32 v55, 0
  v_mov_b32 v56, 0
  v_mov_b32 v57, 0
  s_add_u32 s50, s50, 1
  s_cmp_eq_u32 s50, 16
  s_cselect_b32 s5, s58, s43
  s_add_u32 s56, s56, s5
  s_mul_i32 s5, s3, s57
  s_add_u32 s31, s56, s5
  s_add_u32 s32, s31, 786432
  s_xor_b32 s5, s4, 0
  s_mul_i32 s5, s5, 393216
  s_add_u32 s33, s5, s56
  s_xor_b32 s5, s4, 1
  s_mul_i32 s5, s5, 393216
  s_add_u32 s34, s5, s56
  s_xor_b32 s5, s4, 2
  s_mul_i32 s5, s5, 393216
  s_add_u32 s35, s5, s56
  s_xor_b32 s5, s4, 3
  s_mul_i32 s5, s5, 393216
  s_add_u32 s36, s5, s56
  s_cmp_lt_u32 s50, s49
  s_nop 7
  s_cbranch_scc1 L_sloop
  s_branch L_fin
.section .rodata,"a"
.p2align 6
.amdhsa_kernel standalone__window_attn_swin__vision_kernel
  .amdhsa_next_free_vgpr 512
  .amdhsa_next_free_sgpr 102
  .amdhsa_accum_offset 256
  .amdhsa_group_segment_fixed_size 0
  .amdhsa_kernarg_size 72
  .amdhsa_user_sgpr_count 2
  .amdhsa_user_sgpr_kernarg_segment_ptr 1
  .amdhsa_system_sgpr_workgroup_id_x 1
.end_amdhsa_kernel
```

```asm
; @launch grid=(256,1,1) block=(256,1,1) lds=163840
.amdgcn_target "amdgcn-amd-amdhsa--gfx950"
.text
.globl standalone__window_attn_swin__vision_kernel
.p2align 12
.p2align 8
.type standalone__window_attn_swin__vision_kernel,@function
standalone__window_attn_swin__vision_kernel:
  s_cmpk_ge_u32 s2, 256
  s_cbranch_scc1 L_end
  s_load_dwordx2 s[8:9], s[0:1], 0
  s_load_dwordx2 s[20:21], s[0:1], 24
  s_load_dwordx2 s[12:13], s[0:1], 8
  s_load_dwordx2 s[16:17], s[0:1], 16
  s_load_dwordx2 s[24:25], s[0:1], 48
  s_load_dwordx2 s[62:63], s[0:1], 64
  v_lshrrev_b32 v75, 6, v0
  s_lshr_b32 s49, s2, 3
  v_readfirstlane_b32 s3, v75
  s_getpc_b64 s[50:51]
  v_and_b32 v75, 15, v0
  v_mad_u32_u24 v75, s49, 9, v75
  v_lshlrev_b32 v75, 7, v75
  v_min_u32 v75, L_safe-standalone__window_attn_swin__vision_kernel-256, v75
  v_mov_b32 v59, s51
  v_add_co_u32 v58, vcc, s50, v75
  s_and_b32 s47, s2, 63
  s_lshr_b32 s48, s2, 6
  v_addc_co_u32 v59, vcc, 0, v59, vcc
  global_load_dword v67, v[58:59], off
  v_bfe_u32 v56, v0, 3, 4
  v_and_b32 v54, 7, v0
  v_lshrrev_b32 v64, 1, v56
  v_lshlrev_b32 v76, 2, v56
  v_and_b32 v76, 4, v76
  v_xor_b32 v64, v64, v76
  v_xor_b32 v64, v54, v64
  v_and_b32 v55, 7, v56
  s_add_u32 s48, s48, 60
  s_cmp_lt_u32 s2, 60
  s_cselect_b32 s48, s2, s48
  s_cselect_b32 s47, 63, s47
  s_lshl_b32 s5, s47, 3
  s_add_u32 s5, s5, 4
  v_add_u32 v76, s5, v55
  v_and_b32 v76, 511, v76
  v_mul_u32_u24 v76, 0x180, v76
  v_lshlrev_b32 v58, 4, v64
  v_add_u32 v57, v58, v76
  v_and_b32 v65, 63, v0
  v_lshlrev_b32 v60, 4, v65
  s_mov_b32 s57, 196608
  s_lshl_b32 s5, s48, 3
  s_add_u32 s5, s5, s3
  s_add_u32 s5, s5, 4
  s_mul_i32 s53, s5, s57
  s_add_u32 s5, s5, 4
  s_and_b32 s5, s5, 511
  s_mul_i32 s54, s5, s57
  s_lshl_b32 s46, s3, 10
  s_lshl_b32 s5, s3, 11
  s_add_u32 m0, s5, 151552
  s_mov_b32 s11, 0x20000
  s_mov_b32 s10, 100663296
  s_mov_b32 s23, s11
  s_movk_i32 s22, 1800
  s_mov_b32 s15, s11
  s_mov_b32 s14, 221184
  s_lshl_b32 s49, s49, 2
  s_add_u32 s51, s49, s3
  s_mul_i32 s50, s51, 1728
  v_min_u32 v59, 13, v65
  v_lshlrev_b32 v59, 7, v59
  s_waitcnt lgkmcnt(0)
  buffer_load_dword v66, v59, s[12:15], s50 offen
  buffer_load_dwordx4 v60, s[20:23], 0 offen lds
  buffer_load_dwordx4 v60, s[20:23], 0 offen offset:1024 lds
  s_add_u32 m0, s46, 0
  v_and_b32 v64, 2, v56
  buffer_load_dwordx4 v57, s[8:11], s53 offen offset:0 nt lds
  s_add_u32 m0, s46, 8064
  v_lshrrev_b32 v76, 1, v56
  buffer_load_dwordx4 v57, s[8:11], s53 offen offset:128 nt lds
  s_add_u32 m0, s46, 16128
  v_and_b32 v76, 4, v76
  buffer_load_dwordx4 v57, s[8:11], s53 offen offset:256 nt lds
  s_add_u32 m0, s46, 4096
  v_or_b32 v76, v64, v76
  buffer_load_dwordx4 v57, s[8:11], s54 offen offset:0 nt lds
  s_add_u32 m0, s46, 12160
  v_xor_b32 v76, v54, v76
  buffer_load_dwordx4 v57, s[8:11], s54 offen offset:128 nt lds
  s_add_u32 m0, s46, 20224
  v_lshlrev_b32 v76, 4, v76
  buffer_load_dwordx4 v57, s[8:11], s54 offen offset:256 nt lds
  v_mul_u32_u24 v56, 1152, v55
  v_add_u32 v61, v76, v56
  s_mul_i32 s44, s3, 9216
  v_lshlrev_b32 v64, 1, v64
  v_xor_b32 v64, v54, v64
  v_mul_u32_u24 v76, 0x180, v55
  v_lshl_add_u32 v56, v64, 4, v76
  s_mul_i32 s45, s3, 3072
  s_mov_b32 s19, s11
  s_mov_b32 s18, 73728
  s_mul_i32 s51, s51, 576
  v_min_u32 v57, 512, v59
  v_add_u32 v6, v58, v76
  s_mov_b32 s27, s11
  s_mov_b32 s26, 100663296
  v_and_b32 v54, 15, v65
  v_lshrrev_b32 v55, 4, v65
  v_lshrrev_b32 v75, 1, v54
  v_lshlrev_b32 v64, 2, v54
  v_and_b32 v64, 4, v64
  v_xor_b32 v75, v75, v64
  v_xor_b32 v75, v55, v75
  v_lshlrev_b32 v75, 4, v75
  v_lshl_add_u32 v0, v54, 7, v75
  v_xor_b32 v1, 64, v0
  v_subrev_u32 v2, s46, v0
  s_add_u32 s28, s46, 28672
  s_add_u32 s29, s46, 53248
  s_mov_b32 s30, s46
  s_and_b32 s4, s3, 1
  v_lshlrev_b32 v75, 4, v54
  v_lshl_add_u32 v64, v55, 10, v75
  s_lshl_b32 s5, s4, 8
  s_add_u32 s5, s5, 77824
  v_add_u32 v3, s5, v64
  v_xor_b32 v4, 0x100, v3
  s_mul_i32 s5, s3, 6144
  s_add_u32 s6, s5, 102400
  s_add_u32 s5, s5, 77824
  s_xor_b32 s41, s5, s6
  v_lshl_add_u32 v64, v55, 2, v75
  v_add_u32 v5, s5, v64
  v_and_b32 v70, 7, v54
  v_lshrrev_b32 v73, 3, v54
  v_and_b32 v72, 1, v55
  v_lshrrev_b32 v74, 1, v55
  v_mul_u32_u24 v75, 0x600, v72
  v_mul_u32_u24 v64, s57, v74
  v_add_u32 v75, v75, v64
  v_lshl_add_u32 v75, v54, 2, v75
  s_lshr_b32 s49, s3, 1
  s_lshl_b32 s5, s49, 6
  s_add_u32 s6, s5, 256
  v_add_u32 v53, s6, v75
  s_lshl_b32 s6, s4, 7
  s_add_u32 s5, s5, s6
  v_add_u32 v52, s5, v75
  s_lshl_b32 s5, s47, 3
  s_add_u32 s5, s5, 4
  s_mul_i32 s5, s5, 384
  s_cmp_eq_u32 s47, 63
  s_cselect_b32 s37, 0, s5
  s_cselect_b32 s5, s5, 0
  s_cselect_b32 s6, s57, 0
  v_mul_u32_u24 v64, s6, v72
  v_sub_u32 v64, s5, v64
  s_lshl_b32 s38, s48, 3
  s_add_u32 s38, s38, 4
  s_xor_b32 s6, s4, 0
  s_lshl_b32 s6, s6, 1
  s_add_u32 s6, s6, s38
  s_and_b32 s6, s6, 511
  s_mul_i32 s6, s6, s57
  s_add_u32 s33, s6, s37
  s_xor_b32 s6, s4, 1
  s_lshl_b32 s6, s6, 1
  s_add_u32 s6, s6, s38
  s_and_b32 s6, s6, 511
  s_mul_i32 s6, s6, s57
  s_add_u32 s34, s6, s37
  s_xor_b32 s6, s4, 2
  s_lshl_b32 s6, s6, 1
  s_add_u32 s6, s6, s38
  s_and_b32 s6, s6, 511
  s_mul_i32 s6, s6, s57
  s_add_u32 s35, s6, s37
  s_xor_b32 s6, s4, 3
  s_lshl_b32 s6, s6, 1
  s_add_u32 s6, s6, s38
  s_and_b32 s6, s6, 511
  s_mul_i32 s6, s6, s57
  s_add_u32 s36, s6, s37
  v_add_u32 v7, v52, v64
  v_add_u32 v8, v53, v64
  s_lshr_b32 s5, s2, 6
  s_and_b32 s6, s2, 63
  s_mul_i32 s56, s5, 15
  s_lshl_b32 s43, s57, 5
  s_cmp_eq_u32 s6, 63
  s_cselect_b32 s6, s56, s6
  s_cselect_b32 s5, 60, s5
  s_cselect_b32 s43, 3072, s43
  s_mul_i32 s5, s5, 1572864
  s_mul_i32 s6, s6, 3072
  s_add_u32 s5, s5, s6
  s_add_u32 s56, s5, 787968
  s_mul_i32 s5, s3, s57
  s_add_u32 s31, s56, s5
  s_add_u32 s32, s31, 786432
  s_mul_i32 s6, s43, 3
  s_add_u32 s5, s5, s6
  s_xor_b32 s6, s4, 0
  s_mul_i32 s6, s6, 393216
  s_sub_u32 s37, s6, s5
  s_xor_b32 s6, s4, 1
  s_mul_i32 s6, s6, 393216
  s_sub_u32 s38, s6, s5
  s_xor_b32 s6, s4, 2
  s_mul_i32 s6, s6, 393216
  s_sub_u32 s39, s6, s5
  s_xor_b32 s6, s4, 3
  s_mul_i32 s6, s6, 393216
  s_sub_u32 s40, s6, s5
  s_mov_b32 s97, 14
  s_mov_b32 s42, 0x3e553b95
  v_lshrrev_b32 v75, 2, v54
  v_lshl_add_u32 v64, v72, 1, v73
  v_lshl_add_u32 v75, v55, 3, v75
  v_lshlrev_b32 v75, 7, v75
  v_lshl_add_u32 v75, v64, 5, v75
  v_and_b32 v77, 3, v54
  v_lshl_add_u32 v75, v77, 3, v75
  s_mul_i32 s5, s3, 3
  s_and_b32 s6, s5, 3
  s_lshl_b32 s6, s6, 5
  s_lshr_b32 s7, s5, 2
  s_lshl_b32 s7, s7, 13
  s_add_u32 s7, s7, 28672
  v_xor_b32 v64, s6, v75
  v_add_u32 v62, s7, v64
  v_add_u32 v58, 73728, v62
  s_add_u32 s5, s5, 1
  s_and_b32 s6, s5, 3
  s_lshl_b32 s6, s6, 5
  s_lshr_b32 s7, s5, 2
  s_lshl_b32 s7, s7, 13
  s_add_u32 s7, s7, 28672
  v_xor_b32 v64, s6, v75
  v_add_u32 v63, s7, v64
  v_add_u32 v59, 73728, v63
  s_add_u32 s5, s5, 1
  s_and_b32 s6, s5, 3
  s_lshl_b32 s6, s6, 5
  s_lshr_b32 s7, s5, 2
  s_lshl_b32 s7, s7, 13
  s_add_u32 s7, s7, 28672
  v_xor_b32 v64, s6, v75
  v_add_u32 v71, s7, v64
  v_add_u32 v60, 73728, v71
  v_xor_b32 v64, s49, v72
  s_lshl_b32 s5, s4, 13
  v_lshl_add_u32 v75, v74, 3, v72
  v_lshl_add_u32 v75, v75, 2, v64
  v_lshl_add_u32 v75, v75, 4, v54
  v_lshlrev_b32 v75, 2, v75
  s_add_u32 s5, s5, 126976
  v_add_u32 v69, s5, v75
  v_add_u32 v68, 128, v69
  v_add_u32 v54, 143360, v75
  v_add_u32 v55, 128, v54
  s_mov_b32 s58, 0x05040100
  s_mov_b32 s59, 0x07060302
  v_cmp_gt_u32 vcc, 2, v77
  v_mov_b32 v75, 0x3f803f80
  v_mov_b32 v64, 0x44444444
  v_cndmask_b32 v75, 0, v75, vcc
  v_cmp_eq_u32 vcc, 1, v77
  v_mov_b32 v76, 0xeeeeeeee
  v_accvgpr_write_b32 a240, v75
  v_accvgpr_write_b32 a241, v75
  v_accvgpr_write_b32 a242, v75
  v_accvgpr_write_b32 a243, v75
  v_cndmask_b32 v10, v64, v76, vcc
  v_mov_b32 v9, 1.0
  s_mov_b32 s98, s43
  s_mov_b64 s[20:21], s[62:63]
  s_mov_b32 s22, 402653184
  s_min_u32 s96, s3, 1
  s_lshl_b32 s96, s96, 7
  s_xor_b32 s96, s96, 1152
  s_bitset1_b32 s96, s97
  s_mov_b64 s[62:63], -1
  v_lshlrev_b32 v11, 3, v65
  v_lshlrev_b32 v75, 2, v70
  v_add_u32 v75, 159808, v75
  v_mov_b32 v64, 0
  ds_write_b32 v75, v64
  s_lshl_b32 m0, s3, 8
  s_nop 0
  ds_write_addtid_b32 v64 offset:24576
  v_mov_b64 v[14:15], 0
  v_mov_b64 v[20:21], 0
  v_sub_u32 v75, v73, v74
  v_mul_i32_i24 v75, 15, v75
  v_lshlrev_b32 v64, 2, v72
  v_sub_u32 v76, v70, v64
  v_add3_u32 v75, v75, v76, 19
  s_mul_i32 s5, s3, 2050
  s_add_u32 s5, s5, 151552
  v_lshl_add_u32 v72, v75, 3, s5
  v_mov_b64 v[24:25], 0
  v_mov_b64 v[26:27], 0
  v_mov_b64 v[28:29], 0
  v_mov_b64 v[30:31], 0
  v_mov_b64 v[32:33], 0
  v_mov_b64 v[34:35], 0
  v_mov_b64 v[36:37], 0
  v_mov_b64 v[38:39], 0
  v_mov_b64 v[40:41], 0
  v_mov_b64 v[42:43], 0
  v_mov_b64 v[44:45], 0
  v_mov_b64 v[46:47], 0
  v_mov_b64 v[48:49], 0
  v_mov_b64 v[50:51], 0
  v_xor_b32 v75, v64, v70
  s_cmp_eq_u32 s47, 63
  s_cselect_b32 s5, 4, 0
  v_and_b32 v75, s5, v75
  v_cmp_eq_u32 vcc, 0, v75
  s_cmp_eq_u32 s48, 63
  s_cselect_b32 s5, 0xc31044fe, 0
  v_mov_b32 v64, s5
  v_mov_b32 v70, 0xc31044fe
  v_cndmask_b32 v64, 0, v64, vcc
  v_cndmask_b32 v70, v70, 0, vcc
  s_add_u32 s5, s44, 0
  s_add_u32 m0, s46, 28672
  s_nop 0
  buffer_load_dwordx4 v61, s[12:15], s5 offen offset:0 lds
  s_add_u32 m0, s46, 36736
  s_nop 0
  buffer_load_dwordx4 v61, s[12:15], s5 offen offset:128 lds
  s_add_u32 m0, s46, 44800
  s_nop 0
  buffer_load_dwordx4 v61, s[12:15], s5 offen offset:256 lds
  s_add_u32 s5, s44, 36864
  s_add_u32 m0, s46, 32768
  s_nop 0
  buffer_load_dwordx4 v61, s[12:15], s5 offen offset:0 lds
  s_add_u32 m0, s46, 40832
  s_nop 0
  buffer_load_dwordx4 v61, s[12:15], s5 offen offset:128 lds
  s_add_u32 m0, s46, 48896
  s_nop 0
  buffer_load_dwordx4 v61, s[12:15], s5 offen offset:256 lds
  s_mov_b64 exec, 0
  s_cmp_eq_u32 s3, 0
  s_cbranch_scc1 L_hop_0_0
  s_cmp_eq_u32 s3, 1
  s_cbranch_scc1 L_hop_1_0
  s_cmp_eq_u32 s3, 2
  s_cbranch_scc1 L_hop_2_0
  s_branch L_hop_3_0
L_walk:
  s_mov_b64 exec, -1
L_walked:
  s_waitcnt vmcnt(12)
  ds_read_u16_d16_hi v24, v72 offset:24
  ds_read_u16_d16_hi v25, v72 offset:16
  ds_read_u16_d16_hi v26, v72 offset:8
  ds_read_u16_d16_hi v27, v72 offset:0
  ds_read_u16_d16_hi v28, v72 offset:264
  ds_read_u16_d16_hi v29, v72 offset:256
  ds_read_u16_d16_hi v30, v72 offset:248
  ds_read_u16_d16_hi v31, v72 offset:240
  ds_read_u16_d16_hi v32, v72 offset:504
  ds_read_u16_d16_hi v33, v72 offset:496
  ds_read_u16_d16_hi v34, v72 offset:488
  ds_read_u16_d16_hi v35, v72 offset:480
  ds_read_u16_d16_hi v36, v72 offset:744
  ds_read_u16_d16_hi v37, v72 offset:736
  ds_read_u16_d16_hi v38, v72 offset:728
  ds_read_u16_d16_hi v39, v72 offset:720
  ds_read_u16_d16_hi v40, v72 offset:984
  ds_read_u16_d16_hi v41, v72 offset:976
  ds_read_u16_d16_hi v42, v72 offset:968
  ds_read_u16_d16_hi v43, v72 offset:960
  ds_read_u16_d16_hi v44, v72 offset:1224
  ds_read_u16_d16_hi v45, v72 offset:1216
  ds_read_u16_d16_hi v46, v72 offset:1208
  ds_read_u16_d16_hi v47, v72 offset:1200
  ds_read_u16_d16_hi v48, v72 offset:1464
  ds_read_u16_d16_hi v49, v72 offset:1456
  ds_read_u16_d16_hi v50, v72 offset:1448
  ds_read_u16_d16_hi v51, v72 offset:1440
  s_mov_b32 s5, 0x3fb8aa3b
  v_add_f32 v64, v70, v64
  s_waitcnt lgkmcnt(15)
  v_mul_f32 v24, s5, v24
  v_mul_f32 v25, s5, v25
  v_mul_f32 v26, s5, v26
  v_mul_f32 v27, s5, v27
  v_mul_f32 v28, s5, v28
  v_mul_f32 v29, s5, v29
  v_mul_f32 v30, s5, v30
  v_mul_f32 v31, s5, v31
  v_mul_f32 v32, s5, v32
  v_mul_f32 v33, s5, v33
  v_mul_f32 v34, s5, v34
  v_mul_f32 v35, s5, v35
  v_mul_f32 v36, s5, v36
  s_waitcnt lgkmcnt(14)
  v_mul_f32 v37, s5, v37
  s_waitcnt lgkmcnt(13)
  v_mul_f32 v38, s5, v38
  s_waitcnt lgkmcnt(12)
  v_mul_f32 v39, s5, v39
  s_waitcnt lgkmcnt(11)
  v_mul_f32 v40, s5, v40
  s_waitcnt lgkmcnt(10)
  v_mul_f32 v41, s5, v41
  s_waitcnt lgkmcnt(9)
  v_mul_f32 v42, s5, v42
  s_waitcnt lgkmcnt(8)
  v_mul_f32 v43, s5, v43
  s_waitcnt lgkmcnt(7)
  v_mul_f32 v44, s5, v44
  s_waitcnt lgkmcnt(6)
  v_mul_f32 v45, s5, v45
  s_waitcnt lgkmcnt(5)
  v_mul_f32 v46, s5, v46
  s_waitcnt lgkmcnt(4)
  v_mul_f32 v47, s5, v47
  s_waitcnt lgkmcnt(3)
  v_mul_f32 v48, s5, v48
  s_waitcnt lgkmcnt(2)
  v_mul_f32 v49, s5, v49
  s_waitcnt lgkmcnt(1)
  v_mul_f32 v50, s5, v50
  s_waitcnt lgkmcnt(0)
  v_mul_f32 v51, s5, v51
  v_add_f32 v76, v64, v48
  v_add_f32 v77, v64, v49
  v_add_f32 v78, v64, v50
  v_add_f32 v79, v64, v51
  v_add_f32 v72, v64, v44
  v_add_f32 v73, v64, v45
  v_add_f32 v74, v64, v46
  v_add_f32 v75, v64, v47
  v_add_f32 v80, v64, v40
  v_add_f32 v81, v64, v41
  v_add_f32 v82, v64, v42
  v_add_f32 v83, v64, v43
  v_add_f32 v84, v64, v32
  v_add_f32 v85, v64, v33
  v_add_f32 v86, v64, v34
  v_add_f32 v87, v64, v35
  v_add_f32 v88, v64, v28
  v_add_f32 v89, v64, v29
  v_add_f32 v90, v64, v30
  v_add_f32 v91, v64, v31
  v_add_f32 v92, v64, v24
  v_add_f32 v93, v64, v25
  v_add_f32 v94, v64, v26
  v_add_f32 v95, v64, v27
  s_add_u32 s5, s44, 73728
  s_add_u32 m0, s46, 53248
  s_nop 0
  buffer_load_dwordx4 v61, s[12:15], s5 offen offset:0 lds
  s_add_u32 m0, s46, 61312
  s_nop 0
  buffer_load_dwordx4 v61, s[12:15], s5 offen offset:128 lds
  s_add_u32 m0, s46, 69376
  s_nop 0
  buffer_load_dwordx4 v61, s[12:15], s5 offen offset:256 lds
  s_add_u32 s5, s44, 110592
  s_add_u32 m0, s46, 57344
  s_nop 0
  buffer_load_dwordx4 v61, s[12:15], s5 offen offset:0 lds
  s_add_u32 m0, s46, 65408
  s_nop 0
  buffer_load_dwordx4 v61, s[12:15], s5 offen offset:128 lds
  s_add_u32 m0, s46, 73472
  s_nop 0
  buffer_load_dwordx4 v61, s[12:15], s5 offen offset:256 lds
  s_cmp_eq_u32 s43, 3072
  s_cselect_b32 s10, s10, 95158272
  s_waitcnt vmcnt(12)
  s_barrier
  ds_read_b128 v[184:187], v0 offset:0
  ds_read_b128 v[188:191], v1 offset:0
  ds_read_b128 v[208:211], v0 offset:2048
  ds_read_b128 v[212:215], v1 offset:2048
  ds_read_b128 v[232:235], v0 offset:4096
  ds_read_b128 v[236:239], v1 offset:4096
  ds_read_b128 a[216:219], v0 offset:6144
  ds_read_b128 a[220:223], v1 offset:6144
  s_add_u32 s5, s44, 147456
  s_add_u32 m0, s46, 77824
  s_nop 0
  buffer_load_dwordx4 v61, s[12:15], s5 offen offset:0 lds
  s_add_u32 m0, s46, 85888
  s_nop 0
  buffer_load_dwordx4 v61, s[12:15], s5 offen offset:128 lds
  s_add_u32 m0, s46, 93952
  s_nop 0
  buffer_load_dwordx4 v61, s[12:15], s5 offen offset:256 lds
  s_waitcnt vmcnt(9)
  s_barrier
  ds_read_b64_tr_b16 a[0:1], v62 offset:0
  ds_read_b64_tr_b16 a[2:3], v62 offset:512
  ds_read_b64_tr_b16 a[12:13], v62 offset:4096
  ds_read_b64_tr_b16 a[14:15], v62 offset:4608
  s_waitcnt lgkmcnt(2)
  v_mfma_f32_16x16x32_bf16 v[120:123], a[0:3], v[184:187], 0
  s_add_u32 s5, s44, 184320
  s_add_u32 m0, s46, 81920
  ds_read_b64_tr_b16 a[4:5], v63 offset:0
  s_waitcnt lgkmcnt(1)
  v_mfma_f32_16x16x32_bf16 v[120:123], a[12:15], v[188:191], v[120:123]
  buffer_load_dwordx4 v61, s[12:15], s5 offen offset:0 lds
  v_mfma_f32_16x16x32_bf16 v[132:135], a[0:3], v[208:211], 0
  s_add_u32 m0, s46, 89984
  ds_read_b64_tr_b16 a[6:7], v63 offset:512
  ds_read_b64_tr_b16 a[16:17], v63 offset:4096
  v_mfma_f32_16x16x32_bf16 v[132:135], a[12:15], v[212:215], v[132:135]
  buffer_load_dwordx4 v61, s[12:15], s5 offen offset:128 lds
  v_mfma_f32_16x16x32_bf16 v[160:163], a[0:3], v[232:235], 0
  s_add_u32 m0, s46, 98048
  ds_read_b64_tr_b16 a[18:19], v63 offset:4608
  ds_read_b64_tr_b16 a[8:9], v71 offset:0
  v_mfma_f32_16x16x32_bf16 v[160:163], a[12:15], v[236:239], v[160:163]
  buffer_load_dwordx4 v61, s[12:15], s5 offen offset:256 lds
  v_mfma_f32_16x16x32_bf16 v[176:179], a[0:3], a[216:219], 0
  s_add_u32 s5, s44, 384
  s_add_u32 m0, s46, 102400
  ds_read_b64_tr_b16 a[10:11], v71 offset:512
  v_mfma_f32_16x16x32_bf16 v[176:179], a[12:15], a[220:223], v[176:179]
  s_waitcnt lgkmcnt(3)
  ds_read_b64_tr_b16 a[20:21], v71 offset:4096
  ds_read_b64_tr_b16 a[22:23], v71 offset:4608
  v_mfma_f32_16x16x32_bf16 v[140:143], a[4:7], v[184:187], 0
  buffer_load_dwordx4 v61, s[12:15], s5 offen offset:0 lds
  s_waitcnt lgkmcnt(4)
  v_mfma_f32_16x16x32_bf16 v[140:143], a[16:19], v[188:191], v[140:143]
  s_add_u32 m0, s46, 110464
  ds_read_b128 v[192:195], v0 offset:8192
  ds_read_b128 v[196:199], v1 offset:8192
  v_mfma_f32_16x16x32_bf16 v[124:127], a[4:7], v[208:211], 0
  buffer_load_dwordx4 v61, s[12:15], s5 offen offset:128 lds
  v_mfma_f32_16x16x32_bf16 v[124:127], a[16:19], v[212:215], v[124:127]
  s_add_u32 m0, s46, 118528
  ds_read_b128 v[216:219], v0 offset:10240
  ds_read_b128 v[220:223], v1 offset:10240
  v_mfma_f32_16x16x32_bf16 v[168:171], a[4:7], v[232:235], 0
  buffer_load_dwordx4 v61, s[12:15], s5 offen offset:256 lds
  v_mfma_f32_16x16x32_bf16 v[168:171], a[16:19], v[236:239], v[168:171]
  s_add_u32 s5, s44, 37248
  s_add_u32 m0, s46, 106496
  ds_read_b128 v[240:243], v0 offset:12288
  v_mfma_f32_16x16x32_bf16 v[116:119], a[4:7], a[216:219], 0
  s_waitcnt lgkmcnt(3)
  ds_read_b128 v[244:247], v1 offset:12288
  ds_read_b128 a[224:227], v0 offset:14336
  v_mfma_f32_16x16x32_bf16 v[116:119], a[16:19], a[220:223], v[116:119]
  s_waitcnt vmcnt(9)
  s_barrier
  v_mfma_f32_16x16x32_bf16 v[144:147], a[8:11], v[184:187], 0
  buffer_load_dwordx4 v61, s[12:15], s5 offen offset:0 lds
  v_mfma_f32_16x16x32_bf16 v[144:147], a[20:23], v[188:191], v[144:147]
  s_add_u32 m0, s46, 114560
  ds_read_b64_tr_b16 a[24:25], v62 offset:24576
  ds_read_b64_tr_b16 a[26:27], v62 offset:25088
  v_mfma_f32_16x16x32_bf16 v[148:151], a[8:11], v[208:211], 0
  buffer_load_dwordx4 v61, s[12:15], s5 offen offset:128 lds
  v_mfma_f32_16x16x32_bf16 v[148:151], a[20:23], v[212:215], v[148:151]
  s_add_u32 m0, s46, 122624
  ds_read_b64_tr_b16 a[36:37], v62 offset:28672
  ds_read_b64_tr_b16 a[38:39], v62 offset:29184
  v_mfma_f32_16x16x32_bf16 v[108:111], a[8:11], v[232:235], 0
  buffer_load_dwordx4 v61, s[12:15], s5 offen offset:256 lds
  v_mfma_f32_16x16x32_bf16 v[108:111], a[20:23], v[236:239], v[108:111]
  ds_read_b128 a[228:231], v1 offset:14336
  ds_read_b64_tr_b16 a[28:29], v63 offset:24576
  v_mfma_f32_16x16x32_bf16 v[96:99], a[8:11], a[216:219], 0
  ds_read_b64_tr_b16 a[30:31], v63 offset:25088
  ds_read_b64_tr_b16 a[40:41], v63 offset:28672
  v_mfma_f32_16x16x32_bf16 v[96:99], a[20:23], a[220:223], v[96:99]
  s_waitcnt lgkmcnt(6)
  ds_read_b64_tr_b16 a[42:43], v63 offset:29184
  ds_read_b64_tr_b16 a[32:33], v71 offset:24576
  v_mfma_f32_16x16x32_bf16 v[120:123], a[24:27], v[192:195], v[120:123]
  s_waitcnt lgkmcnt(6)
  ds_read_b64_tr_b16 a[34:35], v71 offset:25088
  ds_read_b64_tr_b16 a[44:45], v71 offset:28672
  v_mfma_f32_16x16x32_bf16 v[120:123], a[36:39], v[196:199], v[120:123]
  ds_read_b64_tr_b16 a[46:47], v71 offset:29184
  ds_read_b128 v[200:203], v0 offset:16384
  v_mfma_f32_16x16x32_bf16 v[132:135], a[24:27], v[216:219], v[132:135]
L_hop_0_0:
  s_cbranch_execz L_hop_0_1
  ds_read_b128 v[204:207], v1 offset:16384
  ds_read_b128 v[224:227], v0 offset:18432
  v_mfma_f32_16x16x32_bf16 v[132:135], a[36:39], v[220:223], v[132:135]
  ds_read_b128 v[228:231], v1 offset:18432
  ds_read_b128 v[248:251], v0 offset:20480
  v_mfma_f32_16x16x32_bf16 v[160:163], a[24:27], v[240:243], v[160:163]
  ds_read_b128 v[252:255], v1 offset:20480
  ds_read_b128 a[232:235], v0 offset:22528
  v_mfma_f32_16x16x32_bf16 v[160:163], a[36:39], v[244:247], v[160:163]
  s_add_u32 s5, s44, 74112
  s_add_u32 m0, s46, 126976
  ds_read_b128 a[236:239], v1 offset:22528
  v_mfma_f32_16x16x32_bf16 v[176:179], a[24:27], a[224:227], v[176:179]
  s_waitcnt lgkmcnt(7)
  v_mfma_f32_16x16x32_bf16 v[176:179], a[36:39], a[228:231], v[176:179]
  v_mfma_f32_16x16x32_bf16 v[140:143], a[28:31], v[192:195], v[140:143]
  buffer_load_dwordx4 v61, s[12:15], s5 offen offset:0 lds
  v_mfma_f32_16x16x32_bf16 v[140:143], a[40:43], v[196:199], v[140:143]
  s_add_u32 m0, s46, 135040
  v_mfma_f32_16x16x32_bf16 v[124:127], a[28:31], v[216:219], v[124:127]
  buffer_load_dwordx4 v61, s[12:15], s5 offen offset:128 lds
  v_mfma_f32_16x16x32_bf16 v[124:127], a[40:43], v[220:223], v[124:127]
  s_add_u32 m0, s46, 143104
  v_mfma_f32_16x16x32_bf16 v[168:171], a[28:31], v[240:243], v[168:171]
  buffer_load_dwordx4 v61, s[12:15], s5 offen offset:256 lds
  v_mfma_f32_16x16x32_bf16 v[168:171], a[40:43], v[244:247], v[168:171]
  s_add_u32 s5, s44, 110976
  s_add_u32 m0, s46, 131072
  v_mfma_f32_16x16x32_bf16 v[116:119], a[28:31], a[224:227], v[116:119]
  v_mfma_f32_16x16x32_bf16 v[116:119], a[40:43], a[228:231], v[116:119]
  s_waitcnt vmcnt(9)
  s_barrier
  v_mfma_f32_16x16x32_bf16 v[144:147], a[32:35], v[192:195], v[144:147]
  buffer_load_dwordx4 v61, s[12:15], s5 offen offset:0 lds
  v_mfma_f32_16x16x32_bf16 v[144:147], a[44:47], v[196:199], v[144:147]
  s_add_u32 m0, s46, 139136
  ds_read_b64_tr_b16 a[48:49], v62 offset:49152
  ds_read_b64_tr_b16 a[50:51], v62 offset:49664
  v_mfma_f32_16x16x32_bf16 v[148:151], a[32:35], v[216:219], v[148:151]
  buffer_load_dwordx4 v61, s[12:15], s5 offen offset:128 lds
  v_mfma_f32_16x16x32_bf16 v[148:151], a[44:47], v[220:223], v[148:151]
  s_add_u32 m0, s46, 147200
  ds_read_b64_tr_b16 a[60:61], v62 offset:53248
  ds_read_b64_tr_b16 a[62:63], v62 offset:53760
  v_mfma_f32_16x16x32_bf16 v[108:111], a[32:35], v[240:243], v[108:111]
  buffer_load_dwordx4 v61, s[12:15], s5 offen offset:256 lds
  v_mfma_f32_16x16x32_bf16 v[108:111], a[44:47], v[244:247], v[108:111]
  ds_read_b64_tr_b16 a[52:53], v63 offset:49152
  ds_read_b64_tr_b16 a[54:55], v63 offset:49664
  v_mfma_f32_16x16x32_bf16 v[96:99], a[32:35], a[224:227], v[96:99]
  ds_read_b64_tr_b16 a[64:65], v63 offset:53248
  ds_read_b64_tr_b16 a[66:67], v63 offset:53760
  v_mfma_f32_16x16x32_bf16 v[96:99], a[44:47], a[228:231], v[96:99]
  s_waitcnt lgkmcnt(6)
  ds_read_b64_tr_b16 a[56:57], v71 offset:49152
  ds_read_b64_tr_b16 a[58:59], v71 offset:49664
  v_mfma_f32_16x16x32_bf16 v[120:123], a[48:51], v[200:203], v[120:123]
  s_waitcnt lgkmcnt(6)
  ds_read_b64_tr_b16 a[68:69], v71 offset:53248
  ds_read_b64_tr_b16 a[70:71], v71 offset:53760
  v_mfma_f32_16x16x32_bf16 v[120:123], a[60:63], v[204:207], v[120:123]
  v_mfma_f32_16x16x32_bf16 v[132:135], a[48:51], v[224:227], v[132:135]
  v_mfma_f32_16x16x32_bf16 v[132:135], a[60:63], v[228:231], v[132:135]
  v_mfma_f32_16x16x32_bf16 v[160:163], a[48:51], v[248:251], v[160:163]
  v_mul_f32 v120, s42, v120
  v_mul_f32 v121, s42, v121
  v_mfma_f32_16x16x32_bf16 v[160:163], a[60:63], v[252:255], v[160:163]
  s_add_u32 s5, s44, 147840
  s_add_u32 m0, s46, 28672
  v_mul_f32 v122, s42, v122
  v_mfma_f32_16x16x32_bf16 v[176:179], a[48:51], a[232:235], v[176:179]
  v_mul_f32 v123, s42, v123
  v_cvt_pk_bf16_f32 v12, v120, v121
  v_mfma_f32_16x16x32_bf16 v[176:179], a[60:63], a[236:239], v[176:179]
  s_waitcnt lgkmcnt(0)
  v_cvt_pk_bf16_f32 v13, v122, v123
  v_mul_f32 v132, s42, v132
  v_mfma_f32_16x16x32_bf16 v[140:143], a[52:55], v[200:203], v[140:143]
  buffer_load_dwordx4 v61, s[12:15], s5 offen offset:0 lds
  v_mfma_f32_16x16x32_bf16 v[140:143], a[64:67], v[204:207], v[140:143]
  s_add_u32 m0, s46, 36736
  v_mul_f32 v133, s42, v133
  v_mul_f32 v134, s42, v134
  v_mfma_f32_16x16x32_bf16 v[124:127], a[52:55], v[224:227], v[124:127]
  buffer_load_dwordx4 v61, s[12:15], s5 offen offset:128 lds
  v_mfma_f32_16x16x32_bf16 v[124:127], a[64:67], v[228:231], v[124:127]
  s_add_u32 m0, s46, 44800
  v_mul_f32 v135, s42, v135
  v_cvt_pk_bf16_f32 v64, v132, v133
  v_mfma_f32_16x16x32_bf16 v[168:171], a[52:55], v[248:251], v[168:171]
  buffer_load_dwordx4 v61, s[12:15], s5 offen offset:256 lds
  v_mfma_f32_16x16x32_bf16 v[168:171], a[64:67], v[252:255], v[168:171]
  s_add_u32 s5, s44, 184704
  s_add_u32 m0, s46, 32768
  v_mul_f32 v140, s42, v140
  v_mfma_f32_16x16x32_bf16 v[116:119], a[52:55], a[232:235], v[116:119]
  v_mul_f32 v141, s42, v141
  v_mul_f32 v142, s42, v142
  v_mfma_f32_16x16x32_bf16 v[116:119], a[64:67], a[236:239], v[116:119]
  s_waitcnt vmcnt(9)
  s_barrier
  v_mfma_f32_16x16x32_bf16 v[144:147], a[56:59], v[200:203], v[144:147]
  buffer_load_dwordx4 v61, s[12:15], s5 offen offset:0 lds
  v_mfma_f32_16x16x32_bf16 v[144:147], a[68:71], v[204:207], v[144:147]
  s_add_u32 m0, s46, 40832
  ds_read_b64_tr_b16 a[72:73], v58 offset:0
  ds_read_b64_tr_b16 a[74:75], v58 offset:512
  v_mfma_f32_16x16x32_bf16 v[148:151], a[56:59], v[224:227], v[148:151]
  buffer_load_dwordx4 v61, s[12:15], s5 offen offset:128 lds
  v_mfma_f32_16x16x32_bf16 v[148:151], a[68:71], v[228:231], v[148:151]
  s_add_u32 m0, s46, 48896
  ds_read_b64_tr_b16 a[84:85], v58 offset:4096
  ds_read_b64_tr_b16 a[86:87], v58 offset:4608
  v_mfma_f32_16x16x32_bf16 v[108:111], a[56:59], v[248:251], v[108:111]
  buffer_load_dwordx4 v61, s[12:15], s5 offen offset:256 lds
  v_mfma_f32_16x16x32_bf16 v[108:111], a[68:71], v[252:255], v[108:111]
  ds_read_b64_tr_b16 a[76:77], v59 offset:0
  ds_read_b64_tr_b16 a[78:79], v59 offset:512
  v_mfma_f32_16x16x32_bf16 v[96:99], a[56:59], a[232:235], v[96:99]
  ds_read_b64_tr_b16 a[88:89], v59 offset:4096
  ds_read_b64_tr_b16 a[90:91], v59 offset:4608
  v_mfma_f32_16x16x32_bf16 v[96:99], a[68:71], a[236:239], v[96:99]
  s_waitcnt lgkmcnt(6)
  ds_read_b64_tr_b16 a[80:81], v60 offset:0
  ds_read_b64_tr_b16 a[82:83], v60 offset:512
  v_mfma_f32_16x16x32_bf16 v[128:131], a[72:75], v[184:187], 0
  s_waitcnt lgkmcnt(6)
  ds_read_b64_tr_b16 a[92:93], v60 offset:4096
  ds_read_b64_tr_b16 a[94:95], v60 offset:4608
  v_mfma_f32_16x16x32_bf16 v[128:131], a[84:87], v[188:191], v[128:131]
  v_mul_f32 v143, s42, v143
  v_cvt_pk_bf16_f32 v112, v140, v141
  v_mfma_f32_16x16x32_bf16 v[152:155], a[72:75], v[208:211], 0
  v_cvt_pk_bf16_f32 v113, v142, v143
  v_mul_f32 v144, s42, v144
  v_mfma_f32_16x16x32_bf16 v[152:155], a[84:87], v[212:215], v[152:155]
  v_mul_f32 v145, s42, v145
  v_mul_f32 v146, s42, v146
  v_mfma_f32_16x16x32_bf16 v[156:159], a[72:75], v[232:235], 0
  v_mul_f32 v147, s42, v147
  v_cvt_pk_bf16_f32 v114, v144, v145
  v_mfma_f32_16x16x32_bf16 v[156:159], a[84:87], v[236:239], v[156:159]
  s_add_u32 s5, s44, 768
  s_add_u32 m0, s46, 53248
  v_cvt_pk_bf16_f32 v115, v146, v147
  v_mfma_f32_16x16x32_bf16 v[164:167], a[72:75], a[216:219], 0
  v_cvt_pk_bf16_f32 v65, v134, v135
  v_mul_f32 v124, s42, v124
  v_mfma_f32_16x16x32_bf16 v[164:167], a[84:87], a[220:223], v[164:167]
  s_waitcnt lgkmcnt(0)
  v_mul_f32 v125, s42, v125
  v_mul_f32 v126, s42, v126
  v_mfma_f32_16x16x32_bf16 v[132:135], a[76:79], v[184:187], 0
  buffer_load_dwordx4 v61, s[12:15], s5 offen offset:0 lds
  v_mfma_f32_16x16x32_bf16 v[132:135], a[88:91], v[188:191], v[132:135]
  s_add_u32 m0, s46, 61312
  v_mul_f32 v127, s42, v127
  v_cvt_pk_bf16_f32 v66, v124, v125
  v_mfma_f32_16x16x32_bf16 v[100:103], a[76:79], v[208:211], 0
  buffer_load_dwordx4 v61, s[12:15], s5 offen offset:128 lds
  v_mfma_f32_16x16x32_bf16 v[100:103], a[88:91], v[212:215], v[100:103]
  s_add_u32 m0, s46, 69376
  v_cvt_pk_bf16_f32 v67, v126, v127
  v_mul_f32 v148, s42, v148
  v_mfma_f32_16x16x32_bf16 v[138:141], a[76:79], v[232:235], 0
  buffer_load_dwordx4 v61, s[12:15], s5 offen offset:256 lds
  v_mfma_f32_16x16x32_bf16 v[138:141], a[88:91], v[236:239], v[138:141]
  s_add_u32 s5, s44, 37632
  s_add_u32 m0, s46, 57344
  v_mul_f32 v149, s42, v149
  v_mfma_f32_16x16x32_bf16 v[180:183], a[76:79], a[216:219], 0
  v_mul_f32 v150, s42, v150
  v_mul_f32 v151, s42, v151
  v_mfma_f32_16x16x32_bf16 v[180:183], a[88:91], a[220:223], v[180:183]
  s_waitcnt vmcnt(9)
  s_barrier
  v_mfma_f32_16x16x32_bf16 v[142:145], a[80:83], v[184:187], 0
  buffer_load_dwordx4 v61, s[12:15], s5 offen offset:0 lds
  v_mfma_f32_16x16x32_bf16 v[142:145], a[92:95], v[188:191], v[142:145]
  s_add_u32 m0, s46, 65408
  ds_read_b64_tr_b16 a[96:97], v58 offset:24576
  ds_read_b64_tr_b16 a[98:99], v58 offset:25088
  v_mfma_f32_16x16x32_bf16 v[124:127], a[80:83], v[208:211], 0
  buffer_load_dwordx4 v61, s[12:15], s5 offen offset:128 lds
  v_mfma_f32_16x16x32_bf16 v[124:127], a[92:95], v[212:215], v[124:127]
  s_add_u32 m0, s46, 73472
  ds_read_b64_tr_b16 a[108:109], v58 offset:28672
  ds_read_b64_tr_b16 a[110:111], v58 offset:29184
  v_mfma_f32_16x16x32_bf16 v[104:107], a[80:83], v[232:235], 0
  buffer_load_dwordx4 v61, s[12:15], s5 offen offset:256 lds
  v_mfma_f32_16x16x32_bf16 v[104:107], a[92:95], v[236:239], v[104:107]
  ds_read_b64_tr_b16 a[100:101], v59 offset:24576
  ds_read_b64_tr_b16 a[102:103], v59 offset:25088
  v_mfma_f32_16x16x32_bf16 v[172:175], a[80:83], a[216:219], 0
  ds_read_b64_tr_b16 a[112:113], v59 offset:28672
  ds_read_b64_tr_b16 a[114:115], v59 offset:29184
  v_mfma_f32_16x16x32_bf16 v[172:175], a[92:95], a[220:223], v[172:175]
  s_waitcnt lgkmcnt(6)
  ds_read_b64_tr_b16 a[104:105], v60 offset:24576
  ds_read_b64_tr_b16 a[106:107], v60 offset:25088
  v_mfma_f32_16x16x32_bf16 v[128:131], a[96:99], v[192:195], v[128:131]
  s_waitcnt lgkmcnt(6)
  ds_read_b64_tr_b16 a[116:117], v60 offset:28672
  ds_read_b64_tr_b16 a[118:119], v60 offset:29184
  v_mfma_f32_16x16x32_bf16 v[128:131], a[108:111], v[196:199], v[128:131]
  v_cvt_pk_bf16_f32 v16, v148, v149
  v_cvt_pk_bf16_f32 v17, v150, v151
  v_mfma_f32_16x16x32_bf16 v[152:155], a[96:99], v[216:219], v[152:155]
  v_mul_f32 v160, s42, v160
  v_mul_f32 v161, s42, v161
  v_mfma_f32_16x16x32_bf16 v[152:155], a[108:111], v[220:223], v[152:155]
  v_mul_f32 v162, s42, v162
  v_mul_f32 v163, s42, v163
  v_mfma_f32_16x16x32_bf16 v[156:159], a[96:99], v[240:243], v[156:159]
  v_cvt_pk_bf16_f32 v18, v160, v161
  v_cvt_pk_bf16_f32 v19, v162, v163
  v_mfma_f32_16x16x32_bf16 v[156:159], a[108:111], v[244:247], v[156:159]
  s_add_u32 s5, s44, 74496
  s_add_u32 m0, s46, 77824
  v_mul_f32 v168, s42, v168
  v_mfma_f32_16x16x32_bf16 v[164:167], a[96:99], a[224:227], v[164:167]
  v_mul_f32 v169, s42, v169
  v_mul_f32 v170, s42, v170
  v_mfma_f32_16x16x32_bf16 v[164:167], a[108:111], a[228:231], v[164:167]
  s_waitcnt lgkmcnt(0)
  v_mul_f32 v171, s42, v171
  v_cvt_pk_bf16_f32 v136, v168, v169
  v_mfma_f32_16x16x32_bf16 v[132:135], a[100:103], v[192:195], v[132:135]
  buffer_load_dwordx4 v61, s[12:15], s5 offen offset:0 lds
  v_mfma_f32_16x16x32_bf16 v[132:135], a[112:115], v[196:199], v[132:135]
  s_add_u32 m0, s46, 85888
  v_cvt_pk_bf16_f32 v137, v170, v171
  v_mul_f32 v108, s42, v108
  v_mfma_f32_16x16x32_bf16 v[100:103], a[100:103], v[216:219], v[100:103]
  buffer_load_dwordx4 v61, s[12:15], s5 offen offset:128 lds
  v_mfma_f32_16x16x32_bf16 v[100:103], a[112:115], v[220:223], v[100:103]
  s_add_u32 m0, s46, 93952
  v_mul_f32 v109, s42, v109
  v_mul_f32 v110, s42, v110
  v_mfma_f32_16x16x32_bf16 v[138:141], a[100:103], v[240:243], v[138:141]
  buffer_load_dwordx4 v61, s[12:15], s5 offen offset:256 lds
  v_mfma_f32_16x16x32_bf16 v[138:141], a[112:115], v[244:247], v[138:141]
  s_add_u32 s5, s44, 111360
  s_add_u32 m0, s46, 81920
  v_mul_f32 v111, s42, v111
  v_mfma_f32_16x16x32_bf16 v[180:183], a[100:103], a[224:227], v[180:183]
  v_add_f32 v168, v70, v36
  v_add_f32 v169, v70, v37
  v_mfma_f32_16x16x32_bf16 v[180:183], a[112:115], a[228:231], v[180:183]
  s_waitcnt vmcnt(9)
  s_barrier
  v_mfma_f32_16x16x32_bf16 v[142:145], a[104:107], v[192:195], v[142:145]
  buffer_load_dwordx4 v61, s[12:15], s5 offen offset:0 lds
  v_mfma_f32_16x16x32_bf16 v[142:145], a[116:119], v[196:199], v[142:145]
  s_add_u32 m0, s46, 89984
  ds_read_b64_tr_b16 a[120:121], v62 offset:0
  ds_read_b64_tr_b16 a[122:123], v62 offset:512
  v_mfma_f32_16x16x32_bf16 v[124:127], a[104:107], v[216:219], v[124:127]
  buffer_load_dwordx4 v61, s[12:15], s5 offen offset:128 lds
  v_mfma_f32_16x16x32_bf16 v[124:127], a[116:119], v[220:223], v[124:127]
  s_add_u32 m0, s46, 98048
  ds_read_b64_tr_b16 a[132:133], v62 offset:4096
  ds_read_b64_tr_b16 a[134:135], v62 offset:4608
  v_mfma_f32_16x16x32_bf16 v[104:107], a[104:107], v[240:243], v[104:107]
  buffer_load_dwordx4 v61, s[12:15], s5 offen offset:256 lds
  v_mfma_f32_16x16x32_bf16 v[104:107], a[116:119], v[244:247], v[104:107]
  ds_read_b64_tr_b16 a[124:125], v63 offset:0
  ds_read_b64_tr_b16 a[126:127], v63 offset:512
  v_mfma_f32_16x16x32_bf16 v[172:175], a[104:107], a[224:227], v[172:175]
  ds_read_b64_tr_b16 a[136:137], v63 offset:4096
  ds_read_b64_tr_b16 a[138:139], v63 offset:4608
  v_mfma_f32_16x16x32_bf16 v[172:175], a[116:119], a[228:231], v[172:175]
  s_waitcnt lgkmcnt(6)
  ds_read_b64_tr_b16 a[128:129], v71 offset:0
  ds_read_b64_tr_b16 a[130:131], v71 offset:512
  v_mfma_f32_16x16x32_bf16 v[128:131], a[120:123], v[200:203], v[128:131]
  s_waitcnt lgkmcnt(6)
  ds_read_b64_tr_b16 a[140:141], v71 offset:4096
  ds_read_b64_tr_b16 a[142:143], v71 offset:4608
  v_mfma_f32_16x16x32_bf16 v[128:131], a[132:135], v[204:207], v[128:131]
  v_add_f32 v170, v70, v38
  v_add_f32 v171, v70, v39
  v_mfma_f32_16x16x32_bf16 v[152:155], a[120:123], v[224:227], v[152:155]
  v_add_f32 v146, v70, v32
  v_add_f32 v147, v70, v33
  v_mfma_f32_16x16x32_bf16 v[152:155], a[132:135], v[228:231], v[152:155]
  v_add_f32 v148, v70, v34
  v_add_f32 v149, v70, v35
  v_mfma_f32_16x16x32_bf16 v[156:159], a[120:123], v[248:251], v[156:159]
  v_cvt_pk_bf16_f32 v162, v128, v129
  v_cvt_pk_bf16_f32 v163, v130, v131
  v_mfma_f32_16x16x32_bf16 v[156:159], a[132:135], v[252:255], v[156:159]
  s_add_u32 s5, s44, 148224
  s_add_u32 m0, s46, 102400
  v_add_f32 v120, v70, v40
  v_mfma_f32_16x16x32_bf16 v[164:167], a[120:123], a[232:235], v[164:167]
  v_cvt_pk_bf16_f32 v128, v152, v153
  v_cvt_pk_bf16_f32 v129, v154, v155
  v_mfma_f32_16x16x32_bf16 v[164:167], a[132:135], a[236:239], v[164:167]
  s_waitcnt lgkmcnt(0)
  v_add_f32 v121, v70, v41
  v_add_f32 v122, v70, v42
  v_mfma_f32_16x16x32_bf16 v[132:135], a[124:127], v[200:203], v[132:135]
  buffer_load_dwordx4 v61, s[12:15], s5 offen offset:0 lds
  v_mfma_f32_16x16x32_bf16 v[132:135], a[136:139], v[204:207], v[132:135]
  s_add_u32 m0, s46, 110464
  v_cvt_pk_bf16_f32 v150, v156, v157
  v_cvt_pk_bf16_f32 v151, v158, v159
  v_mfma_f32_16x16x32_bf16 v[100:103], a[124:127], v[224:227], v[100:103]
  buffer_load_dwordx4 v61, s[12:15], s5 offen offset:128 lds
  v_mfma_f32_16x16x32_bf16 v[100:103], a[136:139], v[228:231], v[100:103]
  s_add_u32 m0, s46, 118528
  v_cvt_pk_bf16_f32 v156, v164, v165
  v_cvt_pk_bf16_f32 v157, v166, v167
  v_mfma_f32_16x16x32_bf16 v[138:141], a[124:127], v[248:251], v[138:141]
  buffer_load_dwordx4 v61, s[12:15], s5 offen offset:256 lds
  v_mfma_f32_16x16x32_bf16 v[138:141], a[136:139], v[252:255], v[138:141]
  s_add_u32 s5, s44, 185088
  s_add_u32 m0, s46, 106496
  v_cvt_pk_bf16_f32 v164, v132, v133
  v_mfma_f32_16x16x32_bf16 v[180:183], a[124:127], a[232:235], v[180:183]
  v_cvt_pk_bf16_f32 v165, v134, v135
  v_cvt_pk_bf16_f32 v130, v100, v101
  v_mfma_f32_16x16x32_bf16 v[180:183], a[136:139], a[236:239], v[180:183]
  v_cvt_pk_bf16_f32 v131, v102, v103
  v_add_f32 v123, v70, v43
  v_mfma_f32_16x16x32_bf16 v[142:145], a[128:131], v[200:203], v[142:145]
  buffer_load_dwordx4 v61, s[12:15], s5 offen offset:0 lds
  v_mfma_f32_16x16x32_bf16 v[142:145], a[140:143], v[204:207], v[142:145]
  s_add_u32 m0, s46, 114560
  v_cvt_pk_bf16_f32 v152, v138, v139
  v_cvt_pk_bf16_f32 v153, v140, v141
  v_mfma_f32_16x16x32_bf16 v[124:127], a[128:131], v[224:227], v[124:127]
  buffer_load_dwordx4 v61, s[12:15], s5 offen offset:128 lds
  v_mfma_f32_16x16x32_bf16 v[124:127], a[140:143], v[228:231], v[124:127]
  s_add_u32 m0, s46, 122624
  v_cvt_pk_bf16_f32 v158, v180, v181
  v_cvt_pk_bf16_f32 v159, v182, v183
  v_mfma_f32_16x16x32_bf16 v[104:107], a[128:131], v[248:251], v[104:107]
  buffer_load_dwordx4 v61, s[12:15], s5 offen offset:256 lds
  v_mfma_f32_16x16x32_bf16 v[104:107], a[140:143], v[252:255], v[104:107]
  v_cvt_pk_bf16_f32 v166, v142, v143
  v_cvt_pk_bf16_f32 v167, v144, v145
  v_mfma_f32_16x16x32_bf16 v[172:175], a[128:131], a[232:235], v[172:175]
  v_cvt_pk_bf16_f32 v132, v124, v125
  v_cvt_pk_bf16_f32 v133, v126, v127
  v_mfma_f32_16x16x32_bf16 v[172:175], a[140:143], a[236:239], v[172:175]
  v_cvt_pk_bf16_f32 v138, v108, v109
  v_cvt_pk_bf16_f32 v139, v110, v111
  v_mfma_f32_16x16x32_bf16 v[100:103], v[164:167], v[112:115], v[168:171]
  v_cvt_pk_bf16_f32 v154, v104, v105
  v_cvt_pk_bf16_f32 v155, v106, v107
  v_mfma_f32_16x16x32_bf16 v[100:103], v[162:165], v[12:15], v[100:103]
  v_mul_f32 v176, s42, v176
  v_mul_f32 v177, s42, v177
  v_mfma_f32_16x16x32_bf16 v[104:107], v[130:133], v[112:115], v[146:149]
  v_cvt_pk_bf16_f32 v160, v172, v173
  v_cvt_pk_bf16_f32 v161, v174, v175
  v_mfma_f32_16x16x32_bf16 v[104:107], v[128:131], v[12:15], v[104:107]
  v_mul_f32 v178, s42, v178
  v_mul_f32 v179, s42, v179
  v_mfma_f32_16x16x32_bf16 v[172:175], v[152:155], v[112:115], v[88:91]
  v_cvt_pk_bf16_f32 v140, v176, v177
  v_cvt_pk_bf16_f32 v141, v178, v179
  v_mfma_f32_16x16x32_bf16 v[172:175], v[150:153], v[12:15], v[172:175]
  v_mul_f32 v116, s42, v116
  v_mul_f32 v117, s42, v117
  v_mfma_f32_16x16x32_bf16 v[180:183], v[158:161], v[112:115], v[92:95]
  v_mul_f32 v118, s42, v118
  v_mul_f32 v119, s42, v119
  v_mfma_f32_16x16x32_bf16 v[180:183], v[156:159], v[12:15], v[180:183]
  v_cvt_pk_bf16_f32 v142, v116, v117
  v_cvt_pk_bf16_f32 v143, v118, v119
  v_mfma_f32_16x16x32_bf16 v[108:111], v[162:165], v[64:67], v[120:123]
  v_mul_f32 v96, s42, v96
  v_mul_f32 v97, s42, v97
  v_mfma_f32_16x16x32_bf16 v[108:111], v[164:167], v[14:17], v[108:111]
  v_mul_f32 v98, s42, v98
  v_mul_f32 v99, s42, v99
  v_mfma_f32_16x16x32_bf16 v[112:115], v[128:131], v[64:67], v[168:171]
  v_cvt_pk_bf16_f32 v22, v96, v97
  v_cvt_pk_bf16_f32 v23, v98, v99
  v_mfma_f32_16x16x32_bf16 v[112:115], v[130:133], v[14:17], v[112:115]
  v_exp_f32 v100, v100
  v_mfma_f32_16x16x32_bf16 v[124:127], v[150:153], v[64:67], v[84:87]
  v_exp_f32 v101, v101
  v_mfma_f32_16x16x32_bf16 v[124:127], v[152:155], v[14:17], v[124:127]
  v_exp_f32 v102, v102
  v_mfma_f32_16x16x32_bf16 v[116:119], v[156:159], v[64:67], v[88:91]
  v_exp_f32 v103, v103
  v_mfma_f32_16x16x32_bf16 v[116:119], v[158:161], v[14:17], v[116:119]
  v_exp_f32 v104, v104
  v_mfma_f32_16x16x32_bf16 v[92:95], v[152:155], v[136:139], v[168:171]
  v_exp_f32 v105, v105
  v_mfma_f32_16x16x32_bf16 v[92:95], v[150:153], v[18:21], v[92:95]
  buffer_load_dword v134, v57, s[16:19], s51 offen
  v_mfma_f32_16x16x32_bf16 v[96:99], v[158:161], v[136:139], v[146:149]
  s_add_u32 m0, s28, 0
  v_exp_f32 v106, v106
  v_mfma_f32_16x16x32_bf16 v[96:99], v[156:159], v[18:21], v[96:99]
  v_exp_f32 v107, v107
  v_mfma_f32_16x16x32_bf16 v[176:179], v[164:167], v[136:139], v[72:75]
  s_waitcnt vmcnt(7)
  s_barrier
  v_mfma_f32_16x16x32_bf16 v[176:179], v[162:165], v[18:21], v[176:179]
  buffer_load_dwordx4 v6, s[8:11], s31 offen offset:0 nt lds
  v_mfma_f32_16x16x32_bf16 v[144:147], v[130:133], v[136:139], v[80:83]
  s_add_u32 m0, s28, 8064
  ds_read_b64_tr_b16 a[144:145], v62 offset:24576
  ds_read_b64_tr_b16 a[146:147], v62 offset:25088
  v_mfma_f32_16x16x32_bf16 v[144:147], v[128:131], v[18:21], v[144:147]
  ds_read_b64_tr_b16 a[156:157], v62 offset:28672
  ds_read_b64_tr_b16 a[158:159], v62 offset:29184
  v_mfma_f32_16x16x32_bf16 v[84:87], v[150:153], v[140:143], v[120:123]
  buffer_load_dwordx4 v6, s[8:11], s31 offen offset:128 nt lds
  v_mfma_f32_16x16x32_bf16 v[84:87], v[152:155], v[20:23], v[84:87]
  s_add_u32 m0, s28, 16128
  ds_read_b64_tr_b16 a[148:149], v63 offset:24576
  ds_read_b64_tr_b16 a[150:151], v63 offset:25088
  v_mfma_f32_16x16x32_bf16 v[88:91], v[156:159], v[140:143], v[168:171]
  ds_read_b64_tr_b16 a[160:161], v63 offset:28672
  ds_read_b64_tr_b16 a[162:163], v63 offset:29184
  v_mfma_f32_16x16x32_bf16 v[88:91], v[158:161], v[20:23], v[88:91]
  buffer_load_dwordx4 v6, s[8:11], s31 offen offset:256 nt lds
  v_mfma_f32_16x16x32_bf16 v[148:151], v[162:165], v[140:143], v[76:79]
  s_add_u32 s31, s31, s43
  ds_read_b64_tr_b16 a[152:153], v71 offset:24576
  ds_read_b64_tr_b16 a[154:155], v71 offset:25088
  v_mfma_f32_16x16x32_bf16 v[148:151], v[164:167], v[20:23], v[148:151]
  ds_read_b64_tr_b16 a[164:165], v71 offset:28672
  ds_read_b64_tr_b16 a[166:167], v71 offset:29184
  v_mfma_f32_16x16x32_bf16 v[160:163], v[128:131], v[140:143], v[72:75]
  ds_read_b64_tr_b16 a[168:169], v62 offset:49152
  ds_read_b64_tr_b16 a[170:171], v62 offset:49664
  v_mfma_f32_16x16x32_bf16 v[160:163], v[130:133], v[20:23], v[160:163]
  s_waitcnt lgkmcnt(6)
  ds_read_b64_tr_b16 a[180:181], v62 offset:53248
  ds_read_b64_tr_b16 a[182:183], v62 offset:53760
  v_mfma_f32_16x16x32_bf16 v[136:139], v[184:187], a[144:147], 0
  ds_read_b64_tr_b16 a[172:173], v63 offset:49152
  ds_read_b64_tr_b16 a[174:175], v63 offset:49664
  v_mfma_f32_16x16x32_bf16 v[136:139], v[188:191], a[156:159], v[136:139]
  ds_read_b64_tr_b16 a[184:185], v63 offset:53248
  ds_read_b64_tr_b16 a[186:187], v63 offset:53760
  v_mfma_f32_16x16x32_bf16 v[72:75], v[184:187], a[148:151], 0
  ds_read_b64_tr_b16 a[176:177], v71 offset:49152
  ds_read_b64_tr_b16 a[178:179], v71 offset:49664
  v_mfma_f32_16x16x32_bf16 v[72:75], v[188:191], a[160:163], v[72:75]
  s_waitcnt lgkmcnt(8)
  ds_read_b64_tr_b16 a[188:189], v71 offset:53248
  ds_read_b64_tr_b16 a[190:191], v71 offset:53760
  v_mfma_f32_16x16x32_bf16 v[152:155], v[184:187], a[152:155], 0
  v_exp_f32 v172, v172
  v_mfma_f32_16x16x32_bf16 v[152:155], v[188:191], a[164:167], v[152:155]
  v_exp_f32 v173, v173
  v_mfma_f32_16x16x32_bf16 v[76:79], v[208:211], a[144:147], 0
  v_exp_f32 v174, v174
  v_mfma_f32_16x16x32_bf16 v[76:79], v[212:215], a[156:159], v[76:79]
  v_exp_f32 v175, v175
  v_mfma_f32_16x16x32_bf16 v[140:143], v[208:211], a[148:151], 0
  v_exp_f32 v180, v180
  v_mfma_f32_16x16x32_bf16 v[140:143], v[212:215], a[160:163], v[140:143]
  v_exp_f32 v181, v181
  v_mfma_f32_16x16x32_bf16 v[128:131], v[208:211], a[152:155], 0
  v_exp_f32 v182, v182
  v_mfma_f32_16x16x32_bf16 v[128:131], v[212:215], a[164:167], v[128:131]
  v_exp_f32 v183, v183
  v_mfma_f32_16x16x32_bf16 v[136:139], v[192:195], a[168:171], v[136:139]
  s_waitcnt lgkmcnt(0)
  v_cvt_pk_bf16_f32 v100, v100, v101
  v_cvt_pk_bf16_f32 v101, v102, v103
  v_mfma_f32_16x16x32_bf16 v[136:139], v[196:199], a[180:183], v[136:139]
  v_cvt_pk_bf16_f32 v102, v104, v105
  v_cvt_pk_bf16_f32 v103, v106, v107
  v_mfma_f32_16x16x32_bf16 v[72:75], v[192:195], a[172:175], v[72:75]
  v_cvt_pk_bf16_f32 v104, v172, v173
  v_cvt_pk_bf16_f32 v105, v174, v175
  v_mfma_f32_16x16x32_bf16 v[72:75], v[196:199], a[184:187], v[72:75]
  v_cvt_pk_bf16_f32 v106, v180, v181
  v_cvt_pk_bf16_f32 v107, v182, v183
  v_mfma_f32_16x16x32_bf16 v[152:155], v[192:195], a[176:179], v[152:155]
  v_exp_f32 v108, v108
  v_mfma_f32_16x16x32_bf16 v[152:155], v[196:199], a[188:191], v[152:155]
  s_waitcnt vmcnt(4)
  s_barrier
  v_mfma_f32_16x16x32_bf16 v[76:79], v[216:219], a[168:171], v[76:79]
  ds_read_b64_tr_b16 a[192:193], v58 offset:0
  ds_read_b64_tr_b16 a[194:195], v58 offset:512
  v_mfma_f32_16x16x32_bf16 v[76:79], v[220:223], a[180:183], v[76:79]
  ds_read_b64_tr_b16 a[204:205], v58 offset:4096
  ds_read_b64_tr_b16 a[206:207], v58 offset:4608
  v_mfma_f32_16x16x32_bf16 v[140:143], v[216:219], a[172:175], v[140:143]
  ds_read_b64_tr_b16 a[196:197], v59 offset:0
  ds_read_b64_tr_b16 a[198:199], v59 offset:512
  v_mfma_f32_16x16x32_bf16 v[140:143], v[220:223], a[184:187], v[140:143]
  s_waitcnt lgkmcnt(4)
  ds_read_b64_tr_b16 a[208:209], v59 offset:4096
  ds_read_b64_tr_b16 a[210:211], v59 offset:4608
  v_mfma_f32_16x16x32_bf16 v[128:131], v[216:219], a[176:179], v[128:131]
  s_add_u32 s5, s45, 0
  ds_read_b64_tr_b16 a[200:201], v60 offset:0
  ds_read_b64_tr_b16 a[202:203], v60 offset:512
  v_mfma_f32_16x16x32_bf16 v[128:131], v[220:223], a[188:191], v[128:131]
  s_add_u32 m0, s46, 126976
  ds_read_b64_tr_b16 a[212:213], v60 offset:4096
  ds_read_b64_tr_b16 a[214:215], v60 offset:4608
  v_mfma_f32_16x16x32_bf16 v[136:139], v[200:203], a[192:195], v[136:139]
  s_waitcnt lgkmcnt(8)
  v_exp_f32 v109, v109
  v_mfma_f32_16x16x32_bf16 v[136:139], v[204:207], a[204:207], v[136:139]
  buffer_load_dwordx4 v56, s[16:19], s5 offen offset:0 lds
  s_waitcnt lgkmcnt(6)
  v_mfma_f32_16x16x32_bf16 v[72:75], v[200:203], a[196:199], v[72:75]
  s_add_u32 m0, s46, 135040
  v_exp_f32 v110, v110
  s_waitcnt lgkmcnt(4)
  v_mfma_f32_16x16x32_bf16 v[72:75], v[204:207], a[208:211], v[72:75]
  s_waitcnt lgkmcnt(2)
  v_exp_f32 v111, v111
  v_mfma_f32_16x16x32_bf16 v[152:155], v[200:203], a[200:203], v[152:155]
  buffer_load_dwordx4 v56, s[16:19], s5 offen offset:128 lds
  s_waitcnt lgkmcnt(0)
  v_mfma_f32_16x16x32_bf16 v[152:155], v[204:207], a[212:215], v[152:155]
  s_add_u32 m0, s46, 143104
  v_cvt_pk_bf16_f32 v172, v136, v137
  v_cvt_pk_bf16_f32 v173, v138, v139
  v_mfma_f32_16x16x32_bf16 v[76:79], v[224:227], a[192:195], v[76:79]
  v_cvt_pk_bf16_f32 v168, v72, v73
  v_cvt_pk_bf16_f32 v169, v74, v75
  v_mfma_f32_16x16x32_bf16 v[76:79], v[228:231], a[204:207], v[76:79]
  buffer_load_dwordx4 v56, s[16:19], s5 offen offset:256 lds
  v_mfma_f32_16x16x32_bf16 v[140:143], v[224:227], a[196:199], v[140:143]
  s_add_u32 s5, s45, 12288
  v_cvt_pk_bf16_f32 v70, v152, v153
  v_cvt_pk_bf16_f32 v71, v154, v155
  v_mfma_f32_16x16x32_bf16 v[140:143], v[228:231], a[208:211], v[140:143]
  s_add_u32 m0, s46, 131072
  v_exp_f32 v112, v112
  v_mfma_f32_16x16x32_bf16 v[128:131], v[224:227], a[200:203], v[128:131]
  buffer_load_dwordx4 v56, s[16:19], s5 offen offset:0 lds
  v_mfma_f32_16x16x32_bf16 v[128:131], v[228:231], a[212:215], v[128:131]
  s_add_u32 m0, s46, 139136
  v_cvt_pk_bf16_f32 v174, v76, v77
  v_cvt_pk_bf16_f32 v175, v78, v79
  v_mfma_f32_16x16x32_bf16 v[60:63], v[232:235], a[144:147], 0
  v_cvt_pk_bf16_f32 v170, v140, v141
  v_cvt_pk_bf16_f32 v171, v142, v143
  v_mfma_f32_16x16x32_bf16 v[60:63], v[236:239], a[156:159], v[60:63]
  buffer_load_dwordx4 v56, s[16:19], s5 offen offset:128 lds
  v_mfma_f32_16x16x32_bf16 v[60:63], v[240:243], a[168:171], v[60:63]
  s_add_u32 m0, s46, 147200
  v_cvt_pk_bf16_f32 v72, v128, v129
  v_cvt_pk_bf16_f32 v73, v130, v131
  v_mfma_f32_16x16x32_bf16 v[60:63], v[244:247], a[180:183], v[60:63]
  v_exp_f32 v113, v113
  v_mfma_f32_16x16x32_bf16 v[60:63], v[248:251], a[192:195], v[60:63]
  buffer_load_dwordx4 v56, s[16:19], s5 offen offset:256 lds
  v_mfma_f32_16x16x32_bf16 v[60:63], v[252:255], a[204:207], v[60:63]
  v_exp_f32 v114, v114
  v_mfma_f32_16x16x32_bf16 v[128:131], v[232:235], a[148:151], 0
  v_exp_f32 v115, v115
  v_mfma_f32_16x16x32_bf16 v[128:131], v[236:239], a[160:163], v[128:131]
  v_exp_f32 v124, v124
  v_mfma_f32_16x16x32_bf16 v[128:131], v[240:243], a[172:175], v[128:131]
  v_cvt_pk_bf16_f32 v76, v60, v61
  v_cvt_pk_bf16_f32 v77, v62, v63
  v_mfma_f32_16x16x32_bf16 v[128:131], v[244:247], a[184:187], v[128:131]
  v_exp_f32 v125, v125
  v_mfma_f32_16x16x32_bf16 v[128:131], v[248:251], a[196:199], v[128:131]
  v_exp_f32 v126, v126
  v_mfma_f32_16x16x32_bf16 v[128:131], v[252:255], a[208:211], v[128:131]
  v_exp_f32 v127, v127
  v_mfma_f32_16x16x32_bf16 v[60:63], v[232:235], a[152:155], 0
L_hop_1_0:
  s_cbranch_execz L_hop_1_1
  v_exp_f32 v116, v116
  v_mfma_f32_16x16x32_bf16 v[60:63], v[236:239], a[164:167], v[60:63]
  v_exp_f32 v117, v117
  v_mfma_f32_16x16x32_bf16 v[60:63], v[240:243], a[176:179], v[60:63]
  v_cvt_pk_bf16_f32 v80, v128, v129
  v_cvt_pk_bf16_f32 v81, v130, v131
  v_cvt_pk_bf16_f32 v108, v108, v109
  v_mfma_f32_16x16x32_bf16 v[60:63], v[244:247], a[188:191], v[60:63]
  v_exp_f32 v118, v118
  v_cvt_pk_bf16_f32 v109, v110, v111
  v_mfma_f32_16x16x32_bf16 v[60:63], v[248:251], a[200:203], v[60:63]
  v_exp_f32 v119, v119
  v_cvt_pk_bf16_f32 v110, v112, v113
  v_mfma_f32_16x16x32_bf16 v[60:63], v[252:255], a[212:215], v[60:63]
  v_cvt_pk_bf16_f32 v111, v114, v115
  v_cvt_pk_bf16_f32 v112, v124, v125
  v_cvt_pk_bf16_f32 v113, v126, v127
  v_mfma_f32_16x16x32_bf16 v[128:131], a[216:219], a[144:147], 0
  v_cvt_pk_bf16_f32 v114, v116, v117
  v_cvt_pk_bf16_f32 v115, v118, v119
  v_add_u32 v0, s28, v2
  v_mfma_f32_16x16x32_bf16 v[128:131], a[220:223], a[156:159], v[128:131]
  s_add_u32 s5, s45, 24576
  s_add_u32 m0, s46, 0
  v_exp_f32 v92, v92
  v_mfma_f32_16x16x32_bf16 v[128:131], a[224:227], a[168:171], v[128:131]
  v_cvt_pk_bf16_f32 v120, v60, v61
  v_cvt_pk_bf16_f32 v121, v62, v63
  v_xor_b32 v1, 64, v0
  v_mfma_f32_16x16x32_bf16 v[128:131], a[228:231], a[180:183], v[128:131]
  v_exp_f32 v93, v93
  v_mfma_f32_16x16x32_bf16 v[128:131], a[232:235], a[192:195], v[128:131]
  buffer_load_dwordx4 v56, s[16:19], s5 offen offset:0 lds
  v_cvt_pk_bf16_f32 v92, v92, v93
  v_mfma_f32_16x16x32_bf16 v[128:131], a[236:239], a[204:207], v[128:131]
  s_add_u32 m0, s46, 8064
  v_exp_f32 v94, v94
  v_mfma_f32_16x16x32_bf16 v[124:127], a[216:219], a[148:151], 0
  v_exp_f32 v95, v95
  v_mfma_f32_16x16x32_bf16 v[124:127], a[220:223], a[160:163], v[124:127]
  buffer_load_dwordx4 v56, s[16:19], s5 offen offset:128 lds
  v_cvt_pk_bf16_f32 v93, v94, v95
  v_mfma_f32_16x16x32_bf16 v[124:127], a[224:227], a[172:175], v[124:127]
  s_add_u32 m0, s46, 16128
  v_cvt_pk_bf16_f32 v78, v128, v129
  v_cvt_pk_bf16_f32 v79, v130, v131
  v_mfma_f32_16x16x32_bf16 v[124:127], a[228:231], a[184:187], v[124:127]
  v_exp_f32 v96, v96
  v_mfma_f32_16x16x32_bf16 v[124:127], a[232:235], a[196:199], v[124:127]
  buffer_load_dwordx4 v56, s[16:19], s5 offen offset:256 lds
  v_mov_b64 v[164:165], 0
  v_mfma_f32_16x16x32_bf16 v[124:127], a[236:239], a[208:211], v[124:127]
  s_add_u32 s5, s45, 36864
  s_add_u32 m0, s46, 4096
  v_exp_f32 v97, v97
  v_mfma_f32_16x16x32_bf16 v[128:131], a[216:219], a[152:155], 0
  v_exp_f32 v98, v98
  v_cvt_pk_bf16_f32 v94, v96, v97
  v_mfma_f32_16x16x32_bf16 v[128:131], a[220:223], a[164:167], v[128:131]
  buffer_load_dwordx4 v56, s[16:19], s5 offen offset:0 lds
  v_mfma_f32_16x16x32_bf16 v[128:131], a[224:227], a[176:179], v[128:131]
  s_add_u32 m0, s46, 12160
  v_cvt_pk_bf16_f32 v82, v124, v125
  v_cvt_pk_bf16_f32 v83, v126, v127
  v_mfma_f32_16x16x32_bf16 v[128:131], a[228:231], a[188:191], v[128:131]
  v_exp_f32 v99, v99
  v_mfma_f32_16x16x32_bf16 v[128:131], a[232:235], a[200:203], v[128:131]
  buffer_load_dwordx4 v56, s[16:19], s5 offen offset:128 lds
  v_cvt_pk_bf16_f32 v95, v98, v99
  v_mfma_f32_16x16x32_bf16 v[128:131], a[236:239], a[212:215], v[128:131]
  s_add_u32 m0, s46, 20224
  v_mov_b64 v[140:141], 0
  v_exp_f32 v176, v176
  v_smfmac_f32_16x16x64_bf16 v[164:167], a[240:243], v[100:107], v10
  v_exp_f32 v177, v177
  v_mfma_f32_16x16x32_bf16 v[180:183], v[76:79], v[104:107], 0
  buffer_load_dwordx4 v56, s[16:19], s5 offen offset:256 lds
  v_cvt_pk_bf16_f32 v96, v176, v177
  v_mfma_f32_16x16x32_bf16 v[180:183], v[172:175], v[100:103], v[180:183]
  v_cvt_pk_bf16_f32 v122, v128, v129
  v_cvt_pk_bf16_f32 v123, v130, v131
  v_mfma_f32_16x16x32_bf16 v[124:127], v[168:171], v[100:103], 0
  v_exp_f32 v178, v178
  v_mfma_f32_16x16x32_bf16 v[124:127], v[80:83], v[104:107], v[124:127]
  v_exp_f32 v179, v179
  v_mfma_f32_16x16x32_bf16 v[64:67], v[120:123], v[104:107], 0
  v_exp_f32 v144, v144
  v_cvt_pk_bf16_f32 v97, v178, v179
  v_mfma_f32_16x16x32_bf16 v[64:67], v[70:73], v[100:103], v[64:67]
  v_exp_f32 v145, v145
  v_mov_b64 v[156:157], 0
  v_smfmac_f32_16x16x64_bf16 v[140:143], a[240:243], v[108:115], v10
  v_exp_f32 v146, v146
  v_cvt_pk_bf16_f32 v98, v144, v145
  v_mfma_f32_16x16x32_bf16 v[116:119], v[76:79], v[112:115], 0
  v_exp_f32 v147, v147
  v_add_f32 v164, v164, v165
  v_mfma_f32_16x16x32_bf16 v[116:119], v[172:175], v[108:111], v[116:119]
  v_cvt_pk_bf16_f32 v99, v146, v147
  v_exp_f32 v84, v84
  v_mfma_f32_16x16x32_bf16 v[136:139], v[168:171], v[108:111], 0
  v_exp_f32 v85, v85
  v_mfma_f32_16x16x32_bf16 v[136:139], v[80:83], v[112:115], v[136:139]
  v_exp_f32 v86, v86
  v_cvt_pk_bf16_f32 v84, v84, v85
  v_mfma_f32_16x16x32_bf16 v[100:103], v[120:123], v[112:115], 0
  v_exp_f32 v87, v87
  v_add_f32 v140, v140, v141
  v_mfma_f32_16x16x32_bf16 v[100:103], v[70:73], v[108:111], v[100:103]
  v_exp_f32 v88, v88
  v_cvt_pk_bf16_f32 v85, v86, v87
  v_smfmac_f32_16x16x64_bf16 v[156:159], a[240:243], v[92:99], v10
  v_exp_f32 v89, v89
  v_exp_f32 v90, v90
  v_exp_f32 v91, v91
  v_exp_f32 v148, v148
  v_exp_f32 v149, v149
  v_exp_f32 v150, v150
  v_exp_f32 v151, v151
  v_exp_f32 v160, v160
  v_exp_f32 v161, v161
  v_exp_f32 v162, v162
  v_exp_f32 v163, v163
  v_mfma_f32_16x16x32_bf16 v[144:147], v[172:175], v[96:99], 0
  s_add_u32 s5, s45, 49152
  v_cvt_pk_bf16_f32 v86, v88, v89
  v_cvt_pk_bf16_f32 v87, v90, v91
  v_cvt_pk_bf16_f32 v88, v148, v149
  v_cvt_pk_bf16_f32 v89, v150, v151
  v_cvt_pk_bf16_f32 v90, v160, v161
  v_cvt_pk_bf16_f32 v91, v162, v163
  v_mfma_f32_16x16x32_bf16 v[144:147], v[76:79], v[92:95], v[144:147]
  s_waitcnt vmcnt(6) lgkmcnt(0)
  s_barrier
  v_mfma_f32_16x16x32_bf16 v[148:151], v[80:83], v[92:95], 0
  s_add_u32 m0, s46, 102400
  ds_read_b128 v[132:135], v0 offset:0
  v_mov_b64 v[108:109], 0
  v_mfma_f32_16x16x32_bf16 v[148:151], v[168:171], v[96:99], v[148:151]
  buffer_load_dwordx4 v56, s[16:19], s5 offen offset:0 lds
  v_mfma_f32_16x16x32_bf16 v[160:163], v[70:73], v[96:99], 0
  s_add_u32 m0, s46, 110464
  ds_read_b128 v[60:63], v1 offset:0
  ds_read_b128 v[128:131], v0 offset:8192
  v_mfma_f32_16x16x32_bf16 v[160:163], v[120:123], v[92:95], v[160:163]
  ds_read_b128 v[152:155], v1 offset:8192
  ds_read_b128 v[176:179], v0 offset:16384
  v_smfmac_f32_16x16x64_bf16 v[108:111], a[240:243], v[84:91], v10
  buffer_load_dwordx4 v56, s[16:19], s5 offen offset:128 lds
  v_mfma_f32_16x16x32_bf16 v[92:95], v[172:175], v[88:91], 0
  s_add_u32 m0, s46, 118528
  ds_read_b128 a[244:247], v1 offset:16384
  ds_read2st64_b32 v[96:97], v69 offset0:0 offset1:2
  v_mfma_f32_16x16x32_bf16 v[92:95], v[76:79], v[84:87], v[92:95]
  ds_read2st64_b32 v[172:173], v68 offset0:0 offset1:2
  ds_read2st64_b32 v[98:99], v69 offset0:4 offset1:6
  v_mfma_f32_16x16x32_bf16 v[104:107], v[80:83], v[84:87], 0
  buffer_load_dwordx4 v56, s[16:19], s5 offen offset:256 lds
  v_mfma_f32_16x16x32_bf16 v[104:107], v[168:171], v[88:91], v[104:107]
  s_add_u32 s5, s45, 61440
  s_add_u32 m0, s46, 106496
  ds_read2st64_b32 v[174:175], v68 offset0:4 offset1:6
  v_mfma_f32_16x16x32_bf16 v[168:171], v[70:73], v[88:91], 0
  s_waitcnt lgkmcnt(3)
  ds_read2st64_b32 v[76:77], v54 offset0:0 offset1:2
  ds_read2st64_b32 v[80:81], v55 offset0:0 offset1:2
  v_mfma_f32_16x16x32_bf16 v[168:171], v[120:123], v[84:87], v[168:171]
  buffer_load_dwordx4 v56, s[16:19], s5 offen offset:0 lds
  v_mfma_f32_16x16x32_bf16 v[72:75], a[0:3], v[132:135], 0
  s_add_u32 m0, s46, 114560
  ds_read2st64_b32 v[78:79], v54 offset0:4 offset1:6
  ds_read2st64_b32 v[82:83], v55 offset0:4 offset1:6
  v_mfma_f32_16x16x32_bf16 v[72:75], a[12:15], v[60:63], v[72:75]
  v_rcp_f32 v166, v164
  v_mfma_f32_16x16x32_bf16 v[72:75], a[24:27], v[128:131], v[72:75]
  buffer_load_dwordx4 v56, s[16:19], s5 offen offset:128 lds
  v_mfma_f32_16x16x32_bf16 v[72:75], a[36:39], v[152:155], v[72:75]
  s_add_u32 m0, s46, 122624
  v_mul_f32 v180, v166, v180
  v_mul_f32 v181, v166, v181
  v_mfma_f32_16x16x32_bf16 v[72:75], a[48:51], v[176:179], v[72:75]
  s_waitcnt lgkmcnt(4)
  v_perm_b32 v184, v172, v96, s58
  v_perm_b32 v188, v172, v96, s59
  v_mfma_f32_16x16x32_bf16 v[72:75], a[60:63], a[244:247], v[72:75]
  buffer_load_dwordx4 v56, s[16:19], s5 offen offset:256 lds
  v_mfma_f32_16x16x32_bf16 v[84:87], a[64:67], a[244:247], 0
  s_waitcnt lgkmcnt(0)
  v_perm_b32 v185, v173, v97, s58
  v_perm_b32 v189, v173, v97, s59
  v_mfma_f32_16x16x32_bf16 v[84:87], a[52:55], v[176:179], v[84:87]
  s_add_u32 m0, s28, 4096
  v_perm_b32 v186, v174, v98, s58
  v_perm_b32 v190, v174, v98, s59
  v_mfma_f32_16x16x32_bf16 v[84:87], a[40:43], v[152:155], v[84:87]
  s_mov_b32 s5, s28
  v_mul_f32 v72, s42, v72
  v_mul_f32 v73, s42, v73
  v_mfma_f32_16x16x32_bf16 v[84:87], a[28:31], v[128:131], v[84:87]
  v_mul_f32 v74, s42, v74
  v_mul_f32 v75, s42, v75
  v_mfma_f32_16x16x32_bf16 v[84:87], a[16:19], v[60:63], v[84:87]
  buffer_load_dwordx4 v6, s[8:11], s32 offen offset:0 nt lds
  v_mfma_f32_16x16x32_bf16 v[84:87], a[4:7], v[132:135], v[84:87]
  s_add_u32 m0, s28, 12160
  v_cvt_pk_bf16_f32 v12, v72, v73
  v_cvt_pk_bf16_f32 v13, v74, v75
  v_mfma_f32_16x16x32_bf16 v[56:59], a[8:11], v[132:135], 0
  v_perm_b32 v187, v175, v99, s58
  v_perm_b32 v191, v175, v99, s59
  v_perm_b32 v192, v80, v76, s58
  v_mfma_f32_16x16x32_bf16 v[56:59], a[20:23], v[60:63], v[56:59]
  buffer_load_dwordx4 v6, s[8:11], s32 offen offset:128 nt lds
  v_perm_b32 v196, v80, v76, s59
  v_mfma_f32_16x16x32_bf16 v[56:59], a[32:35], v[128:131], v[56:59]
  s_add_u32 m0, s28, 20224
  v_mul_f32 v84, s42, v84
  v_mul_f32 v85, s42, v85
  v_mul_f32 v86, s42, v86
  v_mfma_f32_16x16x32_bf16 v[56:59], a[44:47], v[152:155], v[56:59]
  s_mov_b32 s28, s29
  v_mul_f32 v87, s42, v87
  v_cvt_pk_bf16_f32 v72, v84, v85
  v_cvt_pk_bf16_f32 v73, v86, v87
  v_mfma_f32_16x16x32_bf16 v[56:59], a[56:59], v[176:179], v[56:59]
  buffer_load_dwordx4 v6, s[8:11], s32 offen offset:256 nt lds
  v_perm_b32 v193, v81, v77, s58
  v_mfma_f32_16x16x32_bf16 v[56:59], a[68:71], a[244:247], v[56:59]
  s_add_u32 s32, s32, s43
  v_perm_b32 v197, v81, v77, s59
  v_perm_b32 v194, v82, v78, s58
  v_perm_b32 v198, v82, v78, s59
  v_mfma_f32_16x16x32_bf16 v[84:87], a[132:135], a[244:247], 0
  ds_read2st64_b32 v[96:97], v69 offset0:16 offset1:18
  v_perm_b32 v195, v83, v79, s58
  v_perm_b32 v199, v83, v79, s59
  v_mfma_f32_16x16x32_bf16 v[84:87], a[120:123], v[176:179], v[84:87]
  ds_read2st64_b32 v[172:173], v68 offset0:16 offset1:18
  ds_read2st64_b32 v[98:99], v69 offset0:20 offset1:22
  v_mul_f32 v182, v166, v182
  v_mfma_f32_16x16x32_bf16 v[84:87], a[108:111], v[152:155], v[84:87]
  v_mul_f32 v56, s42, v56
  v_mul_f32 v57, s42, v57
  v_mul_f32 v58, s42, v58
  v_mfma_f32_16x16x32_bf16 v[84:87], a[96:99], v[128:131], v[84:87]
  v_mul_f32 v59, s42, v59
  v_cvt_pk_bf16_f32 v74, v56, v57
  v_cvt_pk_bf16_f32 v75, v58, v59
  v_mfma_f32_16x16x32_bf16 v[84:87], a[84:87], v[60:63], v[84:87]
  ds_read2st64_b32 v[174:175], v68 offset0:20 offset1:22
  ds_read2st64_b32 v[76:77], v54 offset0:16 offset1:18
  v_mul_f32 v183, v166, v183
  v_mfma_f32_16x16x32_bf16 v[84:87], a[72:75], v[132:135], v[84:87]
  ds_read2st64_b32 v[80:81], v55 offset0:16 offset1:18
  ds_read2st64_b32 v[78:79], v54 offset0:20 offset1:22
  v_cvt_pk_bf16_f32 v180, v180, v181
  v_mfma_f32_16x16x32_bf16 v[56:59], a[76:79], v[132:135], 0
  ds_read2st64_b32 v[82:83], v55 offset0:20 offset1:22
  v_cvt_pk_bf16_f32 v181, v182, v183
  v_mul_f32 v124, v166, v124
  v_mfma_f32_16x16x32_bf16 v[56:59], a[88:91], v[60:63], v[56:59]
  v_mul_f32 v125, v166, v125
  v_mul_f32 v126, v166, v126
  v_mul_f32 v127, v166, v127
  v_mfma_f32_16x16x32_bf16 v[56:59], a[100:103], v[128:131], v[56:59]
  v_cvt_pk_bf16_f32 v120, v84, v85
  v_cvt_pk_bf16_f32 v121, v86, v87
  v_cvt_pk_bf16_f32 v124, v124, v125
  v_mfma_f32_16x16x32_bf16 v[56:59], a[112:115], v[152:155], v[56:59]
  s_waitcnt lgkmcnt(4)
  v_cvt_pk_bf16_f32 v125, v126, v127
  v_mul_f32 v64, v166, v64
  v_mul_f32 v65, v166, v65
  v_mfma_f32_16x16x32_bf16 v[56:59], a[124:127], v[176:179], v[56:59]
  v_mul_f32 v66, v166, v66
  v_mul_f32 v67, v166, v67
  v_cvt_pk_bf16_f32 v64, v64, v65
  v_mfma_f32_16x16x32_bf16 v[56:59], a[136:139], a[244:247], v[56:59]
  s_waitcnt lgkmcnt(0)
  v_cvt_pk_bf16_f32 v65, v66, v67
  v_max3_f32 v9, v164, v166, v9
  v_perm_b32 v200, v172, v96, s58
  v_mfma_f32_16x16x32_bf16 v[88:91], a[140:143], a[244:247], 0
  ds_write2st64_b32 v5, v180, v181 offset0:0 offset1:4
  v_mfma_f32_16x16x32_bf16 v[88:91], a[128:131], v[176:179], v[88:91]
  ds_write2st64_b32 v5, v124, v125 offset0:8 offset1:12
  v_mfma_f32_16x16x32_bf16 v[88:91], a[116:119], v[152:155], v[88:91]
  v_cvt_pk_bf16_f32 v122, v56, v57
  v_cvt_pk_bf16_f32 v123, v58, v59
  v_perm_b32 v204, v172, v96, s59
  v_mfma_f32_16x16x32_bf16 v[88:91], a[104:107], v[128:131], v[88:91]
  ds_write2st64_b32 v5, v64, v65 offset0:16 offset1:20
  v_mfma_f32_16x16x32_bf16 v[88:91], a[92:95], v[60:63], v[88:91]
  v_perm_b32 v201, v173, v97, s58
  v_perm_b32 v205, v173, v97, s59
  v_perm_b32 v202, v174, v98, s58
  v_mfma_f32_16x16x32_bf16 v[88:91], a[80:83], v[132:135], v[88:91]
  v_perm_b32 v206, v174, v98, s59
  v_perm_b32 v203, v175, v99, s58
  v_perm_b32 v207, v175, v99, s59
  v_mfma_f32_16x16x32_bf16 v[164:167], v[132:135], a[144:147], 0
  v_perm_b32 v208, v80, v76, s58
  v_perm_b32 v212, v80, v76, s59
  v_perm_b32 v209, v81, v77, s58
  v_mfma_f32_16x16x32_bf16 v[164:167], v[60:63], a[156:159], v[164:167]
  v_perm_b32 v213, v81, v77, s59
  v_perm_b32 v210, v82, v78, s58
  v_perm_b32 v214, v82, v78, s59
  v_mfma_f32_16x16x32_bf16 v[164:167], v[128:131], a[168:171], v[164:167]
  ds_read_b128 v[84:87], v0 offset:2048
  v_cvt_pk_bf16_f32 v124, v88, v89
  v_cvt_pk_bf16_f32 v125, v90, v91
  v_mfma_f32_16x16x32_bf16 v[164:167], v[152:155], a[180:183], v[164:167]
  ds_read_b128 v[112:115], v1 offset:2048
  ds_read_b128 v[180:183], v0 offset:10240
  v_perm_b32 v211, v83, v79, s58
  v_mfma_f32_16x16x32_bf16 v[164:167], v[176:179], a[192:195], v[164:167]
  s_add_u32 m0, s29, 0
  ds_read_b128 a[252:255], v1 offset:10240
  ds_read_b128 a[248:251], v0 offset:18432
  v_perm_b32 v215, v83, v79, s59
  v_mfma_f32_16x16x32_bf16 v[164:167], a[244:247], a[204:207], v[164:167]
  ds_read_b128 v[88:91], v1 offset:18432
  v_add_u32 v69, 4294840320, v69
  v_add_u32 v68, 4294840320, v68
  v_mfma_f32_16x16x32_bf16 v[64:67], a[244:247], a[208:211], 0
  s_waitcnt vmcnt(3)
  s_barrier
  v_mfma_f32_16x16x32_bf16 v[64:67], v[176:179], a[196:199], v[64:67]
  buffer_load_dwordx4 v6, s[8:11], s31 offen offset:0 nt lds
  v_add_u32 v54, 4294840320, v54
  v_mfma_f32_16x16x32_bf16 v[64:67], v[152:155], a[184:187], v[64:67]
  s_add_u32 m0, s29, 8064
  v_cvt_pk_bf16_f32 v56, v164, v165
  v_cvt_pk_bf16_f32 v57, v166, v167
  v_add_u32 v55, 4294840320, v55
  v_mfma_f32_16x16x32_bf16 v[64:67], v[128:131], a[172:175], v[64:67]
  ds_read2st64_b32 v[96:97], v69 offset0:0 offset1:2
  ds_read2st64_b32 v[172:173], v68 offset0:0 offset1:2
  v_add_f32 v156, v156, v157
  v_mfma_f32_16x16x32_bf16 v[64:67], v[60:63], a[160:163], v[64:67]
  ds_read2st64_b32 v[98:99], v69 offset0:4 offset1:6
  ds_read2st64_b32 v[174:175], v68 offset0:4 offset1:6
  v_add_f32 v108, v108, v109
  v_mfma_f32_16x16x32_bf16 v[64:67], v[132:135], a[148:151], v[64:67]
  buffer_load_dwordx4 v6, s[8:11], s31 offen offset:128 nt lds
  v_mfma_f32_16x16x32_bf16 v[164:167], v[132:135], a[152:155], 0
  s_add_u32 m0, s29, 16128
  ds_read2st64_b32 v[76:77], v54 offset0:0 offset1:2
  ds_read2st64_b32 v[80:81], v55 offset0:0 offset1:2
  v_mfma_f32_16x16x32_bf16 v[164:167], v[60:63], a[164:167], v[164:167]
  ds_read2st64_b32 v[78:79], v54 offset0:4 offset1:6
  ds_read2st64_b32 v[82:83], v55 offset0:4 offset1:6
  v_mfma_f32_16x16x32_bf16 v[164:167], v[128:131], a[176:179], v[164:167]
  v_cvt_pk_bf16_f32 v60, v64, v65
  v_cvt_pk_bf16_f32 v61, v66, v67
  v_mfma_f32_16x16x32_bf16 v[164:167], v[152:155], a[188:191], v[164:167]
  buffer_load_dwordx4 v6, s[8:11], s31 offen offset:256 nt lds
  v_mfma_f32_16x16x32_bf16 v[164:167], v[176:179], a[200:203], v[164:167]
  s_add_u32 m0, s29, 4096
  v_rcp_f32 v142, v140
  v_mfma_f32_16x16x32_bf16 v[164:167], a[244:247], a[212:215], v[164:167]
  s_waitcnt lgkmcnt(4)
  v_perm_b32 v216, v172, v96, s58
  v_perm_b32 v220, v172, v96, s59
  v_perm_b32 v217, v173, v97, s58
  v_mfma_f32_16x16x32_bf16 v[132:135], a[0:3], v[84:87], 0
  s_waitcnt lgkmcnt(0)
  v_perm_b32 v221, v173, v97, s59
  v_perm_b32 v218, v174, v98, s58
  v_perm_b32 v222, v174, v98, s59
  v_mfma_f32_16x16x32_bf16 v[132:135], a[12:15], v[112:115], v[132:135]
  buffer_load_dwordx4 v6, s[8:11], s32 offen offset:0 nt lds
  v_perm_b32 v219, v175, v99, s58
  v_mfma_f32_16x16x32_bf16 v[132:135], a[24:27], v[180:183], v[132:135]
  s_add_u32 m0, s29, 12160
  v_cvt_pk_bf16_f32 v64, v164, v165
  v_cvt_pk_bf16_f32 v65, v166, v167
  v_perm_b32 v223, v175, v99, s59
  v_mfma_f32_16x16x32_bf16 v[132:135], a[36:39], a[252:255], v[132:135]
  s_add_u32 s31, s31, s43
  v_perm_b32 v224, v80, v76, s58
  v_perm_b32 v228, v80, v76, s59
  v_perm_b32 v225, v81, v77, s58
  v_mfma_f32_16x16x32_bf16 v[132:135], a[48:51], a[248:251], v[132:135]
  v_perm_b32 v229, v81, v77, s59
  v_perm_b32 v226, v82, v78, s58
  v_perm_b32 v230, v82, v78, s59
  v_mfma_f32_16x16x32_bf16 v[132:135], a[60:63], v[88:91], v[132:135]
  buffer_load_dwordx4 v6, s[8:11], s32 offen offset:128 nt lds
  v_perm_b32 v227, v83, v79, s58
  v_mfma_f32_16x16x32_bf16 v[176:179], a[64:67], v[88:91], 0
  s_add_u32 m0, s29, 20224
  ds_read2st64_b32 v[96:97], v69 offset0:16 offset1:18
  ds_read2st64_b32 v[172:173], v68 offset0:16 offset1:18
  v_perm_b32 v231, v83, v79, s59
  v_mfma_f32_16x16x32_bf16 v[176:179], a[52:55], a[248:251], v[176:179]
  s_mov_b32 s29, s30
  ds_read2st64_b32 v[98:99], v69 offset0:20 offset1:22
  ds_read2st64_b32 v[174:175], v68 offset0:20 offset1:22
  v_mul_f32 v116, v142, v116
  v_mfma_f32_16x16x32_bf16 v[176:179], a[40:43], a[252:255], v[176:179]
  v_mul_f32 v132, s42, v132
  v_mul_f32 v133, s42, v133
  v_mul_f32 v134, s42, v134
  v_mfma_f32_16x16x32_bf16 v[176:179], a[28:31], v[180:183], v[176:179]
  buffer_load_dwordx4 v6, s[8:11], s32 offen offset:256 nt lds
  v_mul_f32 v135, s42, v135
  v_mfma_f32_16x16x32_bf16 v[176:179], a[16:19], v[112:115], v[176:179]
  s_add_u32 s32, s32, s43
  ds_read2st64_b32 v[76:77], v54 offset0:16 offset1:18
  v_cvt_pk_bf16_f32 v128, v132, v133
  v_cvt_pk_bf16_f32 v129, v134, v135
  v_mfma_f32_16x16x32_bf16 v[176:179], a[4:7], v[84:87], v[176:179]
  ds_read2st64_b32 v[80:81], v55 offset0:16 offset1:18
  ds_read2st64_b32 v[78:79], v54 offset0:20 offset1:22
  v_mul_f32 v117, v142, v117
  v_mfma_f32_16x16x32_bf16 v[164:167], a[8:11], v[84:87], 0
  s_waitcnt lgkmcnt(3)
  ds_read2st64_b32 v[82:83], v55 offset0:20 offset1:22
  v_mul_f32 v118, v142, v118
  v_mul_f32 v119, v142, v119
  v_mfma_f32_16x16x32_bf16 v[164:167], a[20:23], v[112:115], v[164:167]
  v_cvt_pk_bf16_f32 v116, v116, v117
  v_cvt_pk_bf16_f32 v117, v118, v119
  v_mul_f32 v136, v142, v136
  v_mfma_f32_16x16x32_bf16 v[164:167], a[32:35], v[180:183], v[164:167]
  v_mul_f32 v176, s42, v176
  v_mul_f32 v177, s42, v177
  v_mul_f32 v178, s42, v178
  v_mfma_f32_16x16x32_bf16 v[164:167], a[44:47], a[252:255], v[164:167]
  v_mul_f32 v179, s42, v179
  v_cvt_pk_bf16_f32 v130, v176, v177
  v_cvt_pk_bf16_f32 v131, v178, v179
  v_mfma_f32_16x16x32_bf16 v[164:167], a[56:59], a[248:251], v[164:167]
  v_mul_f32 v137, v142, v137
  v_mul_f32 v138, v142, v138
  v_mul_f32 v139, v142, v139
  v_mfma_f32_16x16x32_bf16 v[164:167], a[68:71], v[88:91], v[164:167]
  s_waitcnt lgkmcnt(0)
  v_cvt_pk_bf16_f32 v136, v136, v137
  v_cvt_pk_bf16_f32 v137, v138, v139
  v_mul_f32 v100, v142, v100
  v_mfma_f32_16x16x32_bf16 v[176:179], a[132:135], v[88:91], 0
  v_mul_f32 v101, v142, v101
  v_mul_f32 v102, v142, v102
  v_mul_f32 v103, v142, v103
  v_mfma_f32_16x16x32_bf16 v[176:179], a[120:123], a[248:251], v[176:179]
  v_cvt_pk_bf16_f32 v100, v100, v101
  v_cvt_pk_bf16_f32 v101, v102, v103
  v_max3_f32 v9, v140, v142, v9
  v_mfma_f32_16x16x32_bf16 v[176:179], a[108:111], a[252:255], v[176:179]
  v_mul_f32 v164, s42, v164
  v_mul_f32 v165, s42, v165
  v_mul_f32 v166, s42, v166
  v_mfma_f32_16x16x32_bf16 v[176:179], a[96:99], v[180:183], v[176:179]
  v_mul_f32 v167, s42, v167
  v_cvt_pk_bf16_f32 v16, v164, v165
  v_cvt_pk_bf16_f32 v17, v166, v167
  v_mfma_f32_16x16x32_bf16 v[176:179], a[84:87], v[112:115], v[176:179]
  ds_write2st64_b32 v5, v116, v117 offset0:1 offset1:5
  v_mfma_f32_16x16x32_bf16 v[176:179], a[72:75], v[84:87], v[176:179]
  ds_write2st64_b32 v5, v136, v137 offset0:9 offset1:13
  v_mfma_f32_16x16x32_bf16 v[132:135], a[76:79], v[84:87], 0
  ds_write2st64_b32 v5, v100, v101 offset0:17 offset1:21
  v_mfma_f32_16x16x32_bf16 v[132:135], a[88:91], v[112:115], v[132:135]
  v_rcp_f32 v158, v156
  v_perm_b32 v232, v172, v96, s58
  v_mfma_f32_16x16x32_bf16 v[132:135], a[100:103], v[180:183], v[132:135]
  v_cvt_pk_bf16_f32 v136, v176, v177
  v_cvt_pk_bf16_f32 v137, v178, v179
  v_mul_f32 v144, v158, v144
  v_mfma_f32_16x16x32_bf16 v[132:135], a[112:115], a[252:255], v[132:135]
  v_mul_f32 v145, v158, v145
  v_mul_f32 v146, v158, v146
  v_mul_f32 v147, v158, v147
  v_mfma_f32_16x16x32_bf16 v[132:135], a[124:127], a[248:251], v[132:135]
  v_cvt_pk_bf16_f32 v144, v144, v145
  v_cvt_pk_bf16_f32 v145, v146, v147
  v_mul_f32 v148, v158, v148
  v_mfma_f32_16x16x32_bf16 v[132:135], a[136:139], v[88:91], v[132:135]
  v_mul_f32 v149, v158, v149
  v_mul_f32 v150, v158, v150
  v_mul_f32 v151, v158, v151
  v_mfma_f32_16x16x32_bf16 v[152:155], a[140:143], v[88:91], 0
  v_cvt_pk_bf16_f32 v148, v148, v149
  v_cvt_pk_bf16_f32 v149, v150, v151
  v_mul_f32 v160, v158, v160
  v_mfma_f32_16x16x32_bf16 v[152:155], a[128:131], a[248:251], v[152:155]
  v_mul_f32 v161, v158, v161
  v_mul_f32 v162, v158, v162
  v_mul_f32 v163, v158, v163
  v_mfma_f32_16x16x32_bf16 v[152:155], a[116:119], a[252:255], v[152:155]
  v_cvt_pk_bf16_f32 v138, v132, v133
  v_cvt_pk_bf16_f32 v139, v134, v135
  v_cvt_pk_bf16_f32 v160, v160, v161
  v_mfma_f32_16x16x32_bf16 v[152:155], a[104:107], v[180:183], v[152:155]
  v_cvt_pk_bf16_f32 v161, v162, v163
  v_max3_f32 v9, v156, v158, v9
  v_perm_b32 v236, v172, v96, s59
  v_mfma_f32_16x16x32_bf16 v[152:155], a[92:95], v[112:115], v[152:155]
  ds_write2st64_b32 v5, v144, v145 offset0:2 offset1:6
  v_mfma_f32_16x16x32_bf16 v[152:155], a[80:83], v[84:87], v[152:155]
  ds_write2st64_b32 v5, v148, v149 offset0:10 offset1:14
  v_mfma_f32_16x16x32_bf16 v[164:167], v[84:87], a[144:147], 0
  ds_write2st64_b32 v5, v160, v161 offset0:18 offset1:22
  v_mfma_f32_16x16x32_bf16 v[164:167], v[112:115], a[156:159], v[164:167]
  v_rcp_f32 v110, v108
  v_perm_b32 v233, v173, v97, s58
  v_mfma_f32_16x16x32_bf16 v[164:167], v[180:183], a[168:171], v[164:167]
  v_cvt_pk_bf16_f32 v140, v152, v153
  v_cvt_pk_bf16_f32 v141, v154, v155
  v_mfma_f32_16x16x32_bf16 v[164:167], a[252:255], a[180:183], v[164:167]
  v_mul_f32 v92, v110, v92
  v_mul_f32 v93, v110, v93
  v_mfma_f32_16x16x32_bf16 v[164:167], a[248:251], a[192:195], v[164:167]
  s_waitcnt vmcnt(6) lgkmcnt(0)
  s_barrier
  v_mfma_f32_16x16x32_bf16 v[164:167], v[88:91], a[204:207], v[164:167]
  ds_read_b128 v[156:159], v0 offset:4096
  ds_read_b128 v[176:179], v1 offset:4096
  v_mfma_f32_16x16x32_bf16 v[144:147], v[88:91], a[208:211], 0
  ds_read_b128 v[160:163], v0 offset:12288
  ds_read_b128 v[116:119], v1 offset:12288
  v_mfma_f32_16x16x32_bf16 v[144:147], a[248:251], a[196:199], v[144:147]
  ds_read_b128 v[152:155], v0 offset:20480
  ds_read_b128 v[132:135], v1 offset:20480
  v_mfma_f32_16x16x32_bf16 v[144:147], a[252:255], a[184:187], v[144:147]
  v_cvt_pk_bf16_f32 v58, v164, v165
  v_cvt_pk_bf16_f32 v59, v166, v167
  v_mfma_f32_16x16x32_bf16 v[144:147], v[180:183], a[172:175], v[144:147]
  v_mul_f32 v94, v110, v94
  v_mul_f32 v95, v110, v95
  v_mfma_f32_16x16x32_bf16 v[144:147], v[112:115], a[160:163], v[144:147]
  v_cvt_pk_bf16_f32 v92, v92, v93
  v_cvt_pk_bf16_f32 v93, v94, v95
  v_mfma_f32_16x16x32_bf16 v[144:147], v[84:87], a[148:151], v[144:147]
  v_mul_f32 v104, v110, v104
  v_mul_f32 v105, v110, v105
  v_mfma_f32_16x16x32_bf16 v[148:151], v[84:87], a[152:155], 0
  v_mul_f32 v106, v110, v106
  v_mul_f32 v107, v110, v107
  v_mfma_f32_16x16x32_bf16 v[148:151], v[112:115], a[164:167], v[148:151]
  v_cvt_pk_bf16_f32 v104, v104, v105
  v_cvt_pk_bf16_f32 v105, v106, v107
  v_mfma_f32_16x16x32_bf16 v[148:151], v[180:183], a[176:179], v[148:151]
  v_cvt_pk_bf16_f32 v62, v144, v145
  v_cvt_pk_bf16_f32 v63, v146, v147
  v_mfma_f32_16x16x32_bf16 v[148:151], a[252:255], a[188:191], v[148:151]
  v_mul_f32 v168, v110, v168
  v_mul_f32 v169, v110, v169
  v_mfma_f32_16x16x32_bf16 v[148:151], a[248:251], a[200:203], v[148:151]
  v_mul_f32 v170, v110, v170
  v_mul_f32 v171, v110, v171
  v_mfma_f32_16x16x32_bf16 v[148:151], v[88:91], a[212:215], v[148:151]
  s_waitcnt lgkmcnt(0)
  v_cvt_pk_bf16_f32 v168, v168, v169
  v_cvt_pk_bf16_f32 v169, v170, v171
  v_mfma_f32_16x16x32_bf16 v[88:91], a[0:3], v[156:159], 0
  v_max3_f32 v9, v108, v110, v9
  v_perm_b32 v237, v173, v97, s59
  v_mfma_f32_16x16x32_bf16 v[88:91], a[12:15], v[176:179], v[88:91]
  ds_write2st64_b32 v5, v92, v93 offset0:3 offset1:7
  v_mfma_f32_16x16x32_bf16 v[88:91], a[24:27], v[160:163], v[88:91]
  v_cvt_pk_bf16_f32 v66, v148, v149
  v_cvt_pk_bf16_f32 v67, v150, v151
  v_mfma_f32_16x16x32_bf16 v[88:91], a[36:39], v[116:119], v[88:91]
  ds_write2st64_b32 v5, v104, v105 offset0:11 offset1:15
  v_mfma_f32_16x16x32_bf16 v[88:91], a[48:51], v[152:155], v[88:91]
  ds_write2st64_b32 v5, v168, v169 offset0:19 offset1:23
  v_mfma_f32_16x16x32_bf16 v[88:91], a[60:63], v[132:135], v[88:91]
  v_perm_b32 v234, v174, v98, s58
  v_perm_b32 v238, v174, v98, s59
  v_mfma_f32_16x16x32_bf16 v[84:87], a[64:67], v[132:135], 0
  v_perm_b32 v235, v175, v99, s58
  v_perm_b32 v239, v175, v99, s59
  v_mfma_f32_16x16x32_bf16 v[84:87], a[52:55], v[152:155], v[84:87]
  v_perm_b32 v240, v80, v76, s58
  v_perm_b32 v244, v80, v76, s59
  v_mfma_f32_16x16x32_bf16 v[84:87], a[40:43], v[116:119], v[84:87]
  v_mul_f32 v88, s42, v88
  v_mul_f32 v89, s42, v89
  v_mfma_f32_16x16x32_bf16 v[84:87], a[28:31], v[160:163], v[84:87]
  v_mul_f32 v90, s42, v90
  v_mul_f32 v91, s42, v91
  v_mfma_f32_16x16x32_bf16 v[84:87], a[16:19], v[176:179], v[84:87]
L_hop_2_0:
  s_cbranch_execz L_hop_2_1
  v_cvt_pk_bf16_f32 v18, v88, v89
  v_cvt_pk_bf16_f32 v19, v90, v91
  v_mfma_f32_16x16x32_bf16 v[84:87], a[4:7], v[156:159], v[84:87]
  v_perm_b32 v241, v81, v77, s58
  v_perm_b32 v245, v81, v77, s59
  v_mfma_f32_16x16x32_bf16 v[88:91], a[8:11], v[156:159], 0
  v_perm_b32 v242, v82, v78, s58
  v_perm_b32 v246, v82, v78, s59
  v_mfma_f32_16x16x32_bf16 v[88:91], a[20:23], v[176:179], v[88:91]
  v_perm_b32 v243, v83, v79, s58
  v_perm_b32 v247, v83, v79, s59
  v_mfma_f32_16x16x32_bf16 v[88:91], a[32:35], v[160:163], v[88:91]
  v_mul_f32 v84, s42, v84
  v_mul_f32 v85, s42, v85
  v_mfma_f32_16x16x32_bf16 v[88:91], a[44:47], v[116:119], v[88:91]
  v_mul_f32 v86, s42, v86
  v_mul_f32 v87, s42, v87
  v_mfma_f32_16x16x32_bf16 v[88:91], a[56:59], v[152:155], v[88:91]
  v_cvt_pk_bf16_f32 v100, v84, v85
  v_cvt_pk_bf16_f32 v101, v86, v87
  v_mfma_f32_16x16x32_bf16 v[88:91], a[68:71], v[132:135], v[88:91]
  v_add_u32 v69, 102400, v69
  v_add_u32 v68, 102400, v68
  v_mfma_f32_16x16x32_bf16 v[104:107], a[132:135], v[132:135], 0
  v_add_u32 v54, 102400, v54
  v_add_u32 v55, 102400, v55
  v_mfma_f32_16x16x32_bf16 v[104:107], a[120:123], v[152:155], v[104:107]
  ds_read2st64_b32 v[96:97], v69 offset0:0 offset1:2
  ds_read2st64_b32 v[172:173], v68 offset0:0 offset1:2
  v_mfma_f32_16x16x32_bf16 v[104:107], a[108:111], v[116:119], v[104:107]
  v_mul_f32 v88, s42, v88
  v_mul_f32 v89, s42, v89
  v_mfma_f32_16x16x32_bf16 v[104:107], a[96:99], v[160:163], v[104:107]
  v_mul_f32 v90, s42, v90
  v_mul_f32 v91, s42, v91
  v_mfma_f32_16x16x32_bf16 v[104:107], a[84:87], v[176:179], v[104:107]
  v_cvt_pk_bf16_f32 v102, v88, v89
  v_cvt_pk_bf16_f32 v103, v90, v91
  v_mfma_f32_16x16x32_bf16 v[104:107], a[72:75], v[156:159], v[104:107]
  ds_read2st64_b32 v[98:99], v69 offset0:4 offset1:6
  ds_read2st64_b32 v[174:175], v68 offset0:4 offset1:6
  v_mfma_f32_16x16x32_bf16 v[84:87], a[76:79], v[156:159], 0
  ds_read2st64_b32 v[76:77], v54 offset0:0 offset1:2
  ds_read2st64_b32 v[80:81], v55 offset0:0 offset1:2
  v_mfma_f32_16x16x32_bf16 v[84:87], a[88:91], v[176:179], v[84:87]
  ds_read2st64_b32 v[78:79], v54 offset0:4 offset1:6
  ds_read2st64_b32 v[82:83], v55 offset0:4 offset1:6
  v_mfma_f32_16x16x32_bf16 v[84:87], a[100:103], v[160:163], v[84:87]
  v_cvt_pk_bf16_f32 v144, v104, v105
  v_cvt_pk_bf16_f32 v145, v106, v107
  v_mfma_f32_16x16x32_bf16 v[84:87], a[112:115], v[116:119], v[84:87]
  v_xor_b32 v5, s41, v5
  v_mfma_f32_16x16x32_bf16 v[84:87], a[124:127], v[152:155], v[84:87]
  s_waitcnt lgkmcnt(4)
  v_perm_b32 v248, v172, v96, s58
  v_perm_b32 v252, v172, v96, s59
  v_mfma_f32_16x16x32_bf16 v[84:87], a[136:139], v[132:135], v[84:87]
  v_perm_b32 v249, v173, v97, s58
  v_perm_b32 v253, v173, v97, s59
  v_mfma_f32_16x16x32_bf16 v[88:91], a[140:143], v[132:135], 0
  s_waitcnt lgkmcnt(0)
  v_perm_b32 v250, v174, v98, s58
  v_perm_b32 v254, v174, v98, s59
  v_mfma_f32_16x16x32_bf16 v[88:91], a[128:131], v[152:155], v[88:91]
  v_perm_b32 v251, v175, v99, s58
  v_perm_b32 v255, v175, v99, s59
  v_mfma_f32_16x16x32_bf16 v[88:91], a[116:119], v[116:119], v[88:91]
  v_cvt_pk_bf16_f32 v146, v84, v85
  v_cvt_pk_bf16_f32 v147, v86, v87
  v_mfma_f32_16x16x32_bf16 v[88:91], a[104:107], v[160:163], v[88:91]
  s_add_u32 m0, s30, 0
  v_perm_b32 v104, v80, v76, s58
  v_perm_b32 v76, v80, v76, s59
  v_mfma_f32_16x16x32_bf16 v[88:91], a[92:95], v[176:179], v[88:91]
  v_accvgpr_write_b32 a220, v76
  v_perm_b32 v105, v81, v77, s58
  v_mfma_f32_16x16x32_bf16 v[88:91], a[80:83], v[156:159], v[88:91]
  v_perm_b32 v77, v81, v77, s59
  v_accvgpr_write_b32 a221, v77
  v_mfma_f32_16x16x32_bf16 v[84:87], v[156:159], a[144:147], 0
  buffer_load_dwordx4 v6, s[8:11], s31 offen offset:0 nt lds
  v_mfma_f32_16x16x32_bf16 v[84:87], v[176:179], a[156:159], v[84:87]
  s_add_u32 m0, s30, 8064
  v_perm_b32 v106, v82, v78, s58
  v_perm_b32 v78, v82, v78, s59
  v_mfma_f32_16x16x32_bf16 v[84:87], v[160:163], a[168:171], v[84:87]
  v_cvt_pk_bf16_f32 v148, v88, v89
  v_cvt_pk_bf16_f32 v149, v90, v91
  v_mfma_f32_16x16x32_bf16 v[84:87], v[116:119], a[180:183], v[84:87]
  ds_read_b128 a[244:247], v1 offset:22528
  ds_read_b128 a[252:255], v0 offset:22528
  v_mfma_f32_16x16x32_bf16 v[84:87], v[152:155], a[192:195], v[84:87]
  buffer_load_dwordx4 v6, s[8:11], s31 offen offset:128 nt lds
  v_mfma_f32_16x16x32_bf16 v[84:87], v[132:135], a[204:207], v[84:87]
  s_add_u32 m0, s30, 16128
  ds_read_b128 v[180:183], v1 offset:14336
  ds_read_b128 v[164:167], v0 offset:14336
  v_mfma_f32_16x16x32_bf16 v[88:91], v[132:135], a[208:211], 0
  ds_read_b128 v[168:171], v1 offset:6144
  ds_read_b128 a[248:251], v0 offset:6144
  v_mfma_f32_16x16x32_bf16 v[88:91], v[152:155], a[196:199], v[88:91]
  v_accvgpr_write_b32 a222, v78
  v_perm_b32 v107, v83, v79, s58
  v_mfma_f32_16x16x32_bf16 v[88:91], v[116:119], a[184:187], v[88:91]
  buffer_load_dwordx4 v6, s[8:11], s31 offen offset:256 nt lds
  v_mfma_f32_16x16x32_bf16 v[88:91], v[160:163], a[172:175], v[88:91]
  s_add_u32 m0, s30, 4096
  v_cvt_pk_bf16_f32 v108, v84, v85
  v_cvt_pk_bf16_f32 v109, v86, v87
  v_mfma_f32_16x16x32_bf16 v[88:91], v[176:179], a[160:163], v[88:91]
  s_add_u32 s31, s31, s43
  v_perm_b32 v79, v83, v79, s59
  v_accvgpr_write_b32 a223, v79
  v_mfma_f32_16x16x32_bf16 v[88:91], v[156:159], a[148:151], v[88:91]
  ds_read2st64_b32 v[96:97], v69 offset0:16 offset1:18
  ds_read2st64_b32 v[172:173], v68 offset0:16 offset1:18
  v_mfma_f32_16x16x32_bf16 v[84:87], v[156:159], a[152:155], 0
  buffer_load_dwordx4 v6, s[8:11], s32 offen offset:0 nt lds
  v_mfma_f32_16x16x32_bf16 v[84:87], v[176:179], a[164:167], v[84:87]
  s_add_u32 m0, s30, 12160
  ds_read2st64_b32 v[98:99], v69 offset0:20 offset1:22
  ds_read2st64_b32 v[174:175], v68 offset0:20 offset1:22
  v_mfma_f32_16x16x32_bf16 v[84:87], v[160:163], a[176:179], v[84:87]
  v_cvt_pk_bf16_f32 v112, v88, v89
  v_cvt_pk_bf16_f32 v113, v90, v91
  v_mfma_f32_16x16x32_bf16 v[84:87], v[116:119], a[188:191], v[84:87]
  s_waitcnt lgkmcnt(2)
  ds_read2st64_b32 v[76:77], v54 offset0:16 offset1:18
  ds_read2st64_b32 v[80:81], v55 offset0:16 offset1:18
  v_mfma_f32_16x16x32_bf16 v[84:87], v[152:155], a[200:203], v[84:87]
  buffer_load_dwordx4 v6, s[8:11], s32 offen offset:128 nt lds
  v_mfma_f32_16x16x32_bf16 v[84:87], v[132:135], a[212:215], v[84:87]
  s_add_u32 m0, s30, 20224
  ds_read2st64_b32 v[78:79], v54 offset0:20 offset1:22
  ds_read2st64_b32 v[82:83], v55 offset0:20 offset1:22
  v_mfma_f32_16x16x32_bf16 v[68:71], a[132:135], a[244:247], 0
  s_waitcnt lgkmcnt(4)
  v_accvgpr_write_b32 a216, v104
  v_accvgpr_write_b32 a217, v105
  v_mfma_f32_16x16x32_bf16 v[68:71], a[120:123], a[252:255], v[68:71]
  s_mov_b32 s30, s5
  v_accvgpr_write_b32 a218, v106
  v_accvgpr_write_b32 a219, v107
  v_mfma_f32_16x16x32_bf16 v[68:71], a[108:111], v[180:183], v[68:71]
  buffer_load_dwordx4 v6, s[8:11], s32 offen offset:256 nt lds
  v_mfma_f32_16x16x32_bf16 v[68:71], a[96:99], v[164:167], v[68:71]
  s_add_u32 s32, s32, s43
  v_cvt_pk_bf16_f32 v116, v84, v85
  v_cvt_pk_bf16_f32 v117, v86, v87
  v_mfma_f32_16x16x32_bf16 v[68:71], a[84:87], v[168:171], v[68:71]
  s_waitcnt lgkmcnt(0)
  v_perm_b32 v54, v172, v96, s58
  v_perm_b32 v96, v172, v96, s59
  v_mfma_f32_16x16x32_bf16 v[68:71], a[72:75], a[248:251], v[68:71]
  v_accvgpr_write_b32 a224, v54
  v_accvgpr_write_b32 a228, v96
  v_mfma_f32_16x16x32_bf16 v[84:87], a[76:79], a[248:251], 0
  v_perm_b32 v55, v173, v97, s58
  v_perm_b32 v97, v173, v97, s59
  v_mfma_f32_16x16x32_bf16 v[84:87], a[88:91], v[168:171], v[84:87]
  v_accvgpr_write_b32 a225, v55
  v_accvgpr_write_b32 a229, v97
  v_mfma_f32_16x16x32_bf16 v[84:87], a[100:103], v[164:167], v[84:87]
  v_cvt_pk_bf16_f32 v150, v68, v69
  v_cvt_pk_bf16_f32 v151, v70, v71
  v_mfma_f32_16x16x32_bf16 v[84:87], a[112:115], v[180:183], v[84:87]
  v_perm_b32 v54, v174, v98, s58
  v_perm_b32 v98, v174, v98, s59
  v_mfma_f32_16x16x32_bf16 v[84:87], a[124:127], a[252:255], v[84:87]
  v_accvgpr_write_b32 a226, v54
  v_accvgpr_write_b32 a230, v98
  v_mfma_f32_16x16x32_bf16 v[84:87], a[136:139], a[244:247], v[84:87]
  v_perm_b32 v55, v175, v99, s58
  v_perm_b32 v99, v175, v99, s59
  v_mfma_f32_16x16x32_bf16 v[68:71], a[140:143], a[244:247], 0
  v_accvgpr_write_b32 a227, v55
  v_accvgpr_write_b32 a231, v99
  v_mfma_f32_16x16x32_bf16 v[68:71], a[128:131], a[252:255], v[68:71]
  v_perm_b32 v54, v80, v76, s58
  v_perm_b32 v76, v80, v76, s59
  v_mfma_f32_16x16x32_bf16 v[68:71], a[116:119], v[180:183], v[68:71]
  v_cvt_pk_bf16_f32 v152, v84, v85
  v_cvt_pk_bf16_f32 v153, v86, v87
  v_mfma_f32_16x16x32_bf16 v[68:71], a[104:107], v[164:167], v[68:71]
  v_accvgpr_write_b32 a232, v54
  v_accvgpr_write_b32 a236, v76
  v_mfma_f32_16x16x32_bf16 v[68:71], a[92:95], v[168:171], v[68:71]
  v_perm_b32 v55, v81, v77, s58
  v_perm_b32 v77, v81, v77, s59
  v_mfma_f32_16x16x32_bf16 v[68:71], a[80:83], a[248:251], v[68:71]
  v_accvgpr_write_b32 a233, v55
  v_accvgpr_write_b32 a237, v77
  v_mfma_f32_16x16x32_bf16 v[92:95], v[122:125], v[72:75], v[36:39]
  v_perm_b32 v54, v82, v78, s58
  v_perm_b32 v78, v82, v78, s59
  v_mfma_f32_16x16x32_bf16 v[92:95], v[120:123], v[12:15], v[92:95]
  v_accvgpr_write_b32 a234, v54
  v_accvgpr_write_b32 a238, v78
  v_mfma_f32_16x16x32_bf16 v[96:99], v[138:141], v[72:75], v[32:35]
  v_perm_b32 v55, v83, v79, s58
  v_perm_b32 v79, v83, v79, s59
  v_mfma_f32_16x16x32_bf16 v[96:99], v[136:139], v[12:15], v[96:99]
  v_accvgpr_write_b32 a235, v55
  v_accvgpr_write_b32 a239, v79
  v_mfma_f32_16x16x32_bf16 v[104:107], v[146:149], v[72:75], v[28:31]
  v_cvt_pk_bf16_f32 v154, v68, v69
  v_cvt_pk_bf16_f32 v155, v70, v71
  v_mfma_f32_16x16x32_bf16 v[104:107], v[144:147], v[12:15], v[104:107]
  v_exp_f32 v92, v92
  v_mfma_f32_16x16x32_bf16 v[132:135], v[152:155], v[72:75], v[24:27]
  s_lshr_b32 s44, s2, 3
  v_exp_f32 v93, v93
  v_mfma_f32_16x16x32_bf16 v[132:135], v[150:153], v[12:15], v[132:135]
  s_lshl_b32 s44, s44, 9
  v_exp_f32 v94, v94
  v_mfma_f32_16x16x32_bf16 v[84:87], v[120:123], v[128:131], v[40:43]
  s_add_u32 s44, s44, 1048576
  v_exp_f32 v95, v95
  v_mfma_f32_16x16x32_bf16 v[84:87], v[122:125], v[14:17], v[84:87]
  s_mov_b32 s45, 0
  v_exp_f32 v96, v96
  v_mfma_f32_16x16x32_bf16 v[88:91], v[136:139], v[128:131], v[36:39]
  s_mov_b32 s59, 1
  v_exp_f32 v97, v97
  v_mfma_f32_16x16x32_bf16 v[88:91], v[138:141], v[14:17], v[88:91]
  s_mov_b32 s58, 0
  v_exp_f32 v98, v98
  v_mfma_f32_16x16x32_bf16 v[172:175], v[144:147], v[128:131], v[32:35]
  s_mov_b64 s[12:13], 0
  v_exp_f32 v99, v99
  v_mfma_f32_16x16x32_bf16 v[172:175], v[146:149], v[14:17], v[172:175]
  s_mov_b64 s[16:17], 0
  v_exp_f32 v104, v104
  v_mfma_f32_16x16x32_bf16 v[68:71], v[150:153], v[128:131], v[28:31]
  s_mov_b64 s[18:19], 0
  v_exp_f32 v105, v105
  v_mfma_f32_16x16x32_bf16 v[68:71], v[152:155], v[14:17], v[68:71]
  s_mov_b64 s[60:61], 0
  v_exp_f32 v106, v106
  v_mfma_f32_16x16x32_bf16 v[76:79], v[146:149], v[100:103], v[36:39]
  s_mov_b32 s15, 0
  v_exp_f32 v107, v107
  v_mfma_f32_16x16x32_bf16 v[76:79], v[144:147], v[18:21], v[76:79]
  s_mov_b32 s99, 0
  v_exp_f32 v132, v132
  v_mfma_f32_16x16x32_bf16 v[80:83], v[152:155], v[100:103], v[32:35]
  s_mov_b64 s[100:101], 0
  v_exp_f32 v133, v133
  v_mfma_f32_16x16x32_bf16 v[80:83], v[150:153], v[18:21], v[80:83]
  s_mov_b32 s14, 0
  v_exp_f32 v134, v134
  v_mfma_f32_16x16x32_bf16 v[160:163], v[122:125], v[100:103], v[44:47]
  s_mov_b32 s7, s22
  v_exp_f32 v135, v135
  v_mfma_f32_16x16x32_bf16 v[160:163], v[120:123], v[18:21], v[160:163]
  v_cvt_pk_bf16_f32 v92, v92, v93
  v_cvt_pk_bf16_f32 v93, v94, v95
  v_mfma_f32_16x16x32_bf16 v[156:159], v[138:141], v[100:103], v[40:43]
  v_cvt_pk_bf16_f32 v94, v96, v97
  v_cvt_pk_bf16_f32 v95, v98, v99
  v_mfma_f32_16x16x32_bf16 v[156:159], v[136:139], v[18:21], v[156:159]
  v_cvt_pk_bf16_f32 v96, v104, v105
  v_cvt_pk_bf16_f32 v97, v106, v107
  v_mfma_f32_16x16x32_bf16 v[128:131], a[0:3], a[248:251], 0
  v_cvt_pk_bf16_f32 v98, v132, v133
  v_cvt_pk_bf16_f32 v99, v134, v135
  v_mfma_f32_16x16x32_bf16 v[128:131], a[12:15], v[168:171], v[128:131]
  v_exp_f32 v84, v84
  v_mfma_f32_16x16x32_bf16 v[128:131], a[24:27], v[164:167], v[128:131]
  v_exp_f32 v85, v85
  v_mfma_f32_16x16x32_bf16 v[128:131], a[36:39], v[180:183], v[128:131]
  v_exp_f32 v86, v86
  v_mfma_f32_16x16x32_bf16 v[128:131], a[48:51], a[252:255], v[128:131]
  v_exp_f32 v87, v87
  v_mfma_f32_16x16x32_bf16 v[128:131], a[60:63], a[244:247], v[128:131]
  v_exp_f32 v88, v88
  v_mfma_f32_16x16x32_bf16 v[100:103], a[64:67], a[244:247], 0
  v_exp_f32 v89, v89
  v_mfma_f32_16x16x32_bf16 v[100:103], a[52:55], a[252:255], v[100:103]
  v_exp_f32 v90, v90
  v_mfma_f32_16x16x32_bf16 v[100:103], a[40:43], v[180:183], v[100:103]
  v_exp_f32 v91, v91
  v_mfma_f32_16x16x32_bf16 v[100:103], a[28:31], v[164:167], v[100:103]
  v_mul_f32 v128, s42, v128
  v_mul_f32 v129, s42, v129
  v_mfma_f32_16x16x32_bf16 v[100:103], a[16:19], v[168:171], v[100:103]
  v_mul_f32 v130, s42, v130
  v_mul_f32 v131, s42, v131
  v_mfma_f32_16x16x32_bf16 v[100:103], a[4:7], a[248:251], v[100:103]
  v_cvt_pk_bf16_f32 v72, v128, v129
  v_cvt_pk_bf16_f32 v73, v130, v131
  v_mfma_f32_16x16x32_bf16 v[104:107], a[8:11], a[248:251], 0
  v_exp_f32 v172, v172
  v_mfma_f32_16x16x32_bf16 v[104:107], a[20:23], v[168:171], v[104:107]
  v_exp_f32 v173, v173
  v_mfma_f32_16x16x32_bf16 v[104:107], a[32:35], v[164:167], v[104:107]
  v_exp_f32 v174, v174
  v_mfma_f32_16x16x32_bf16 v[104:107], a[44:47], v[180:183], v[104:107]
  v_mul_f32 v100, s42, v100
  v_mul_f32 v101, s42, v101
  v_mfma_f32_16x16x32_bf16 v[104:107], a[56:59], a[252:255], v[104:107]
  v_mul_f32 v102, s42, v102
  v_mul_f32 v103, s42, v103
  v_mfma_f32_16x16x32_bf16 v[104:107], a[68:71], a[244:247], v[104:107]
  v_cvt_pk_bf16_f32 v74, v100, v101
  v_cvt_pk_bf16_f32 v75, v102, v103
  v_mfma_f32_16x16x32_bf16 v[128:131], a[248:251], a[144:147], 0
  v_exp_f32 v175, v175
  v_mfma_f32_16x16x32_bf16 v[128:131], v[168:171], a[156:159], v[128:131]
  v_exp_f32 v68, v68
  v_mfma_f32_16x16x32_bf16 v[128:131], v[164:167], a[168:171], v[128:131]
  v_mul_f32 v104, s42, v104
  v_mul_f32 v105, s42, v105
  v_mfma_f32_16x16x32_bf16 v[128:131], v[180:183], a[180:183], v[128:131]
  v_mul_f32 v106, s42, v106
  v_mul_f32 v107, s42, v107
  v_cvt_pk_bf16_f32 v22, v104, v105
  v_cvt_pk_bf16_f32 v23, v106, v107
  v_mfma_f32_16x16x32_bf16 v[128:131], a[252:255], a[192:195], v[128:131]
  s_waitcnt vmcnt(6) lgkmcnt(0)
  s_barrier
  v_mfma_f32_16x16x32_bf16 v[128:131], a[244:247], a[204:207], v[128:131]
  v_exp_f32 v69, v69
  v_mfma_f32_16x16x32_bf16 v[100:103], v[144:147], v[72:75], v[40:43]
  v_exp_f32 v70, v70
  v_mfma_f32_16x16x32_bf16 v[100:103], v[146:149], v[20:23], v[100:103]
  v_exp_f32 v71, v71
  v_mfma_f32_16x16x32_bf16 v[104:107], v[150:153], v[72:75], v[36:39]
  v_cvt_pk_bf16_f32 v84, v84, v85
  v_cvt_pk_bf16_f32 v85, v86, v87
  v_mfma_f32_16x16x32_bf16 v[104:107], v[152:155], v[20:23], v[104:107]
  v_cvt_pk_bf16_f32 v110, v128, v129
  v_cvt_pk_bf16_f32 v111, v130, v131
  v_mfma_f32_16x16x32_bf16 v[132:135], v[120:123], v[72:75], v[48:51]
  v_cvt_pk_bf16_f32 v86, v88, v89
  v_cvt_pk_bf16_f32 v87, v90, v91
  v_mfma_f32_16x16x32_bf16 v[132:135], v[122:125], v[20:23], v[132:135]
  v_cvt_pk_bf16_f32 v88, v172, v173
  v_cvt_pk_bf16_f32 v89, v174, v175
  v_mfma_f32_16x16x32_bf16 v[128:131], v[136:139], v[72:75], v[44:47]
  v_cvt_pk_bf16_f32 v90, v68, v69
  v_cvt_pk_bf16_f32 v91, v70, v71
  v_mfma_f32_16x16x32_bf16 v[128:131], v[138:141], v[20:23], v[128:131]
  v_exp_f32 v76, v76
  v_mfma_f32_16x16x32_bf16 v[144:147], a[244:247], a[208:211], 0
  ds_read_b128 v[172:175], v3 offset:0
  ds_read_b128 v[136:139], v3 offset:4096
  v_mfma_f32_16x16x32_bf16 v[144:147], a[252:255], a[196:199], v[144:147]
  ds_read_b128 v[140:143], v3 offset:8192
  ds_read_b128 v[68:71], v3 offset:12288
  v_mfma_f32_16x16x32_bf16 v[144:147], v[180:183], a[184:187], v[144:147]
  ds_read_b128 v[72:75], v3 offset:16384
  ds_read_b128 v[120:123], v3 offset:20480
  v_mfma_f32_16x16x32_bf16 v[144:147], v[164:167], a[172:175], v[144:147]
  v_exp_f32 v77, v77
  v_mfma_f32_16x16x32_bf16 v[144:147], v[168:171], a[160:163], v[144:147]
  v_exp_f32 v78, v78
  v_mfma_f32_16x16x32_bf16 v[144:147], a[248:251], a[148:151], v[144:147]
  v_exp_f32 v79, v79
  v_mfma_f32_16x16x32_bf16 v[124:127], a[248:251], a[152:155], 0
  v_exp_f32 v80, v80
  v_mfma_f32_16x16x32_bf16 v[124:127], v[168:171], a[164:167], v[124:127]
  v_exp_f32 v81, v81
  v_mfma_f32_16x16x32_bf16 v[124:127], v[164:167], a[176:179], v[124:127]
  v_exp_f32 v82, v82
  v_mfma_f32_16x16x32_bf16 v[124:127], v[180:183], a[188:191], v[124:127]
  v_exp_f32 v83, v83
  v_mfma_f32_16x16x32_bf16 v[124:127], a[252:255], a[200:203], v[124:127]
  v_exp_f32 v160, v160
  v_mfma_f32_16x16x32_bf16 v[124:127], a[244:247], a[212:215], v[124:127]
  v_cvt_pk_bf16_f32 v114, v144, v145
  v_cvt_pk_bf16_f32 v115, v146, v147
  v_add_u32 v0, s28, v2
  v_xor_b32 v1, 64, v0
  s_waitcnt lgkmcnt(0)
  s_branch L_mid
  .fill 878, 4, 0xbf800000
L_hop_3_0:
  s_cbranch_execz L_hop_3_1
L_pad2121:
L_loop:
  v_mfma_f32_16x16x32_bf16 v[104:107], a[0:3], v[88:91], 0
L_r208:
  v_mfma_f32_16x16x32_bf16 v[104:107], a[12:15], v[92:95], v[104:107]
L_r209:
  v_mfma_f32_16x16x32_bf16 v[104:107], a[24:27], v[96:99], v[104:107]
  v_cvt_pk_bf16_f32 v66, v128, v129
  v_cvt_pk_bf16_f32 v67, v130, v131
L_r210:
  v_mfma_f32_16x16x32_bf16 v[104:107], a[36:39], v[136:139], v[104:107]
L_r211:
  v_mfma_f32_16x16x32_bf16 v[104:107], a[48:51], v[140:143], v[104:107]
  s_waitcnt lgkmcnt(0)
L_r212:
  v_mfma_f32_16x16x32_bf16 v[104:107], a[60:63], v[80:83], v[104:107]
L_r213:
  v_mfma_f32_16x16x32_bf16 v[84:87], a[64:67], v[80:83], 0
L_r214:
  v_mfma_f32_16x16x32_bf16 v[84:87], a[52:55], v[140:143], v[84:87]
L_r215:
  v_mfma_f32_16x16x32_bf16 v[84:87], a[40:43], v[136:139], v[84:87]
  v_mul_f32 v104, s42, v104
  v_mul_f32 v105, s42, v105
L_r216:
  v_mfma_f32_16x16x32_bf16 v[84:87], a[28:31], v[96:99], v[84:87]
  v_mul_f32 v106, s42, v106
  v_mul_f32 v107, s42, v107
L_r217:
  v_mfma_f32_16x16x32_bf16 v[84:87], a[16:19], v[92:95], v[84:87]
  v_cvt_pk_bf16_f32 v18, v104, v105
  v_cvt_pk_bf16_f32 v19, v106, v107
L_r218:
  v_mfma_f32_16x16x32_bf16 v[84:87], a[4:7], v[88:91], v[84:87]
L_r219:
  v_mfma_f32_16x16x32_bf16 v[108:111], a[8:11], v[88:91], 0
L_r220:
  v_mfma_f32_16x16x32_bf16 v[108:111], a[20:23], v[92:95], v[108:111]
L_r221:
  v_mfma_f32_16x16x32_bf16 v[108:111], a[32:35], v[96:99], v[108:111]
  v_mul_f32 v84, s42, v84
  v_mul_f32 v85, s42, v85
L_r222:
  v_mfma_f32_16x16x32_bf16 v[108:111], a[44:47], v[136:139], v[108:111]
  v_mul_f32 v86, s42, v86
  v_mul_f32 v87, s42, v87
L_r223:
  v_mfma_f32_16x16x32_bf16 v[108:111], a[56:59], v[140:143], v[108:111]
  v_cvt_pk_bf16_f32 v104, v84, v85
  v_cvt_pk_bf16_f32 v105, v86, v87
L_r224:
  v_mfma_f32_16x16x32_bf16 v[108:111], a[68:71], v[80:83], v[108:111]
L_r225:
  v_mfma_f32_16x16x32_bf16 v[112:115], a[132:135], v[80:83], 0
L_r226:
  v_mfma_f32_16x16x32_bf16 v[112:115], a[120:123], v[140:143], v[112:115]
L_r227:
  v_mfma_f32_16x16x32_bf16 v[112:115], a[108:111], v[136:139], v[112:115]
  v_mul_f32 v108, s42, v108
  v_mul_f32 v109, s42, v109
L_r228:
  v_mfma_f32_16x16x32_bf16 v[112:115], a[96:99], v[96:99], v[112:115]
  v_mul_f32 v110, s42, v110
  v_mul_f32 v111, s42, v111
L_r229:
  v_mfma_f32_16x16x32_bf16 v[112:115], a[84:87], v[92:95], v[112:115]
  v_cvt_pk_bf16_f32 v106, v108, v109
  v_cvt_pk_bf16_f32 v107, v110, v111
L_r230:
  v_mfma_f32_16x16x32_bf16 v[112:115], a[72:75], v[88:91], v[112:115]
L_r231:
  v_mfma_f32_16x16x32_bf16 v[84:87], a[76:79], v[88:91], 0
L_r232:
  v_mfma_f32_16x16x32_bf16 v[84:87], a[88:91], v[92:95], v[84:87]
L_r233:
  v_mfma_f32_16x16x32_bf16 v[84:87], a[100:103], v[96:99], v[84:87]
  v_cvt_pk_bf16_f32 v128, v112, v113
  v_cvt_pk_bf16_f32 v129, v114, v115
L_r234:
  v_mfma_f32_16x16x32_bf16 v[84:87], a[112:115], v[136:139], v[84:87]
L_r235:
  v_mfma_f32_16x16x32_bf16 v[84:87], a[124:127], v[140:143], v[84:87]
L_r236:
  v_mfma_f32_16x16x32_bf16 v[84:87], a[136:139], v[80:83], v[84:87]
L_r237:
  v_mfma_f32_16x16x32_bf16 v[108:111], a[140:143], v[80:83], 0
L_r238:
  v_mfma_f32_16x16x32_bf16 v[108:111], a[128:131], v[140:143], v[108:111]
L_r239:
  v_mfma_f32_16x16x32_bf16 v[108:111], a[116:119], v[136:139], v[108:111]
  v_cvt_pk_bf16_f32 v130, v84, v85
  v_cvt_pk_bf16_f32 v131, v86, v87
L_r240:
  v_mfma_f32_16x16x32_bf16 v[108:111], a[104:107], v[96:99], v[108:111]
L_r241:
  v_mfma_f32_16x16x32_bf16 v[108:111], a[92:95], v[92:95], v[108:111]
L_r242:
  v_mfma_f32_16x16x32_bf16 v[108:111], a[80:83], v[88:91], v[108:111]
L_r243:
  v_mfma_f32_16x16x32_bf16 v[84:87], v[88:91], a[144:147], 0
L_r244:
  v_mfma_f32_16x16x32_bf16 v[84:87], v[92:95], a[156:159], v[84:87]
  ds_read_b128 a[244:247], v1 offset:22528
L_r245:
  v_mfma_f32_16x16x32_bf16 v[84:87], v[96:99], a[168:171], v[84:87]
  v_cvt_pk_bf16_f32 v132, v108, v109
  v_cvt_pk_bf16_f32 v133, v110, v111
L_r246:
  v_mfma_f32_16x16x32_bf16 v[84:87], v[136:139], a[180:183], v[84:87]
  ds_read_b128 a[248:251], v0 offset:22528
L_r247:
  v_mfma_f32_16x16x32_bf16 v[84:87], v[140:143], a[192:195], v[84:87]
  ds_read_b128 a[252:255], v1 offset:14336
L_r248:
  v_mfma_f32_16x16x32_bf16 v[84:87], v[80:83], a[204:207], v[84:87]
  ds_read_b128 v[144:147], v0 offset:14336
L_r249:
  v_mfma_f32_16x16x32_bf16 v[116:119], v[80:83], a[208:211], 0
  ds_read_b128 v[148:151], v1 offset:6144
L_r250:
  v_mfma_f32_16x16x32_bf16 v[116:119], v[140:143], a[196:199], v[116:119]
  ds_read_b128 v[152:155], v0 offset:6144
L_r251:
  v_mfma_f32_16x16x32_bf16 v[116:119], v[136:139], a[184:187], v[116:119]
  v_cvt_pk_bf16_f32 v108, v84, v85
  v_cvt_pk_bf16_f32 v109, v86, v87
L_r252:
  v_mfma_f32_16x16x32_bf16 v[116:119], v[96:99], a[172:175], v[116:119]
L_r253:
  v_mfma_f32_16x16x32_bf16 v[116:119], v[92:95], a[160:163], v[116:119]
L_r254:
  v_mfma_f32_16x16x32_bf16 v[116:119], v[88:91], a[148:151], v[116:119]
L_r255:
  v_mfma_f32_16x16x32_bf16 v[156:159], v[88:91], a[152:155], 0
L_r256:
  v_mfma_f32_16x16x32_bf16 v[156:159], v[92:95], a[164:167], v[156:159]
L_r257:
  v_mfma_f32_16x16x32_bf16 v[156:159], v[96:99], a[176:179], v[156:159]
  v_cvt_pk_bf16_f32 v112, v116, v117
  v_cvt_pk_bf16_f32 v113, v118, v119
L_r258:
  v_mfma_f32_16x16x32_bf16 v[156:159], v[136:139], a[188:191], v[156:159]
L_r259:
  v_mfma_f32_16x16x32_bf16 v[156:159], v[140:143], a[200:203], v[156:159]
  buffer_load_dwordx2 v[52:53], v11, s[20:23], s7 offen sc1
  v_mfma_f32_16x16x32_bf16 v[156:159], v[80:83], a[212:215], v[156:159]
  s_waitcnt lgkmcnt(0)
  v_mfma_f32_16x16x32_bf16 v[84:87], a[132:135], a[244:247], 0
  v_mfma_f32_16x16x32_bf16 v[84:87], a[120:123], a[248:251], v[84:87]
  v_mfma_f32_16x16x32_bf16 v[84:87], a[108:111], a[252:255], v[84:87]
  v_cvt_pk_bf16_f32 v116, v156, v157
  v_cvt_pk_bf16_f32 v117, v158, v159
  v_mfma_f32_16x16x32_bf16 v[84:87], a[96:99], v[144:147], v[84:87]
  v_mfma_f32_16x16x32_bf16 v[84:87], a[84:87], v[148:151], v[84:87]
  s_waitcnt vmcnt(31)
  s_barrier
  v_mfma_f32_16x16x32_bf16 v[84:87], a[72:75], v[152:155], v[84:87]
  v_add_u32 v0, s28, v2
  v_xor_b32 v1, 64, v0
  v_mfma_f32_16x16x32_bf16 v[80:83], a[76:79], v[152:155], 0
  s_cmp_eq_u32 s59, 3
  v_mfma_f32_16x16x32_bf16 v[80:83], a[88:91], v[148:151], v[80:83]
  s_cselect_b32 s18, s16, s18
  v_mfma_f32_16x16x32_bf16 v[80:83], a[100:103], v[144:147], v[80:83]
  s_cselect_b32 s15, s60, s15
  v_cvt_pk_bf16_f32 v136, v84, v85
  v_cvt_pk_bf16_f32 v137, v86, v87
  v_mfma_f32_16x16x32_bf16 v[80:83], a[112:115], a[252:255], v[80:83]
  s_cmp_eq_u32 s59, 7
  v_mfma_f32_16x16x32_bf16 v[80:83], a[124:127], a[248:251], v[80:83]
  s_cselect_b32 s19, s16, s19
  v_mfma_f32_16x16x32_bf16 v[80:83], a[136:139], a[244:247], v[80:83]
  s_cselect_b32 s99, s60, s99
  v_mfma_f32_16x16x32_bf16 v[84:87], a[140:143], a[244:247], 0
  s_memrealtime s[16:17]
  v_mfma_f32_16x16x32_bf16 v[84:87], a[128:131], a[248:251], v[84:87]
  s_memtime s[60:61]
  v_mfma_f32_16x16x32_bf16 v[84:87], a[116:119], a[252:255], v[84:87]
  s_add_u32 s59, s59, 1
  v_cvt_pk_bf16_f32 v138, v80, v81
  v_cvt_pk_bf16_f32 v139, v82, v83
  v_mfma_f32_16x16x32_bf16 v[84:87], a[104:107], v[144:147], v[84:87]
  s_bitcmp1_b32 2560, s59
  v_mfma_f32_16x16x32_bf16 v[84:87], a[92:95], v[148:151], v[84:87]
  s_cselect_b32 s7, s44, s22
  v_mfma_f32_16x16x32_bf16 v[84:87], a[80:83], v[152:155], v[84:87]
  v_mfma_f32_16x16x32_bf16 v[92:95], v[70:73], v[76:79], v[36:39]
  v_mfma_f32_16x16x32_bf16 v[92:95], v[68:71], v[12:15], v[92:95]
  v_mfma_f32_16x16x32_bf16 v[96:99], v[122:125], v[76:79], v[32:35]
  v_cvt_pk_bf16_f32 v140, v84, v85
  v_cvt_pk_bf16_f32 v141, v86, v87
  v_mfma_f32_16x16x32_bf16 v[96:99], v[120:123], v[12:15], v[96:99]
  v_mfma_f32_16x16x32_bf16 v[172:175], v[130:133], v[76:79], v[28:31]
  v_exp_f32 v92, v92
  v_mfma_f32_16x16x32_bf16 v[172:175], v[128:131], v[12:15], v[172:175]
  v_exp_f32 v93, v93
  v_mfma_f32_16x16x32_bf16 v[176:179], v[138:141], v[76:79], v[24:27]
  v_exp_f32 v94, v94
  v_mfma_f32_16x16x32_bf16 v[176:179], v[136:139], v[12:15], v[176:179]
  v_exp_f32 v95, v95
  v_mfma_f32_16x16x32_bf16 v[84:87], v[68:71], v[100:103], v[40:43]
  v_exp_f32 v96, v96
  v_mfma_f32_16x16x32_bf16 v[84:87], v[70:73], v[14:17], v[84:87]
  v_exp_f32 v97, v97
  v_mfma_f32_16x16x32_bf16 v[88:91], v[120:123], v[100:103], v[36:39]
  v_exp_f32 v98, v98
  v_mfma_f32_16x16x32_bf16 v[88:91], v[122:125], v[14:17], v[88:91]
  v_exp_f32 v99, v99
  v_mfma_f32_16x16x32_bf16 v[168:171], v[128:131], v[100:103], v[32:35]
  v_exp_f32 v172, v172
  v_mfma_f32_16x16x32_bf16 v[168:171], v[130:133], v[14:17], v[168:171]
  v_exp_f32 v173, v173
  v_mfma_f32_16x16x32_bf16 v[164:167], v[136:139], v[100:103], v[28:31]
  v_exp_f32 v174, v174
  v_mfma_f32_16x16x32_bf16 v[164:167], v[138:141], v[14:17], v[164:167]
  v_exp_f32 v175, v175
  v_mfma_f32_16x16x32_bf16 v[76:79], v[130:133], v[104:107], v[36:39]
  v_exp_f32 v176, v176
  v_mfma_f32_16x16x32_bf16 v[76:79], v[128:131], v[18:21], v[76:79]
  v_exp_f32 v177, v177
  v_mfma_f32_16x16x32_bf16 v[80:83], v[138:141], v[104:107], v[32:35]
  v_exp_f32 v178, v178
  v_mfma_f32_16x16x32_bf16 v[80:83], v[136:139], v[18:21], v[80:83]
  v_exp_f32 v179, v179
  v_mfma_f32_16x16x32_bf16 v[160:163], v[70:73], v[104:107], v[44:47]
  v_cvt_pk_bf16_f32 v92, v92, v93
  v_cvt_pk_bf16_f32 v93, v94, v95
  v_mfma_f32_16x16x32_bf16 v[160:163], v[68:71], v[18:21], v[160:163]
  v_cvt_pk_bf16_f32 v94, v96, v97
  v_cvt_pk_bf16_f32 v95, v98, v99
  v_mfma_f32_16x16x32_bf16 v[156:159], v[122:125], v[104:107], v[40:43]
  v_cvt_pk_bf16_f32 v96, v172, v173
  v_cvt_pk_bf16_f32 v97, v174, v175
  v_mfma_f32_16x16x32_bf16 v[156:159], v[120:123], v[18:21], v[156:159]
  v_cvt_pk_bf16_f32 v98, v176, v177
  v_cvt_pk_bf16_f32 v99, v178, v179
  v_mfma_f32_16x16x32_bf16 v[172:175], a[0:3], v[152:155], 0
  v_exp_f32 v84, v84
  v_mfma_f32_16x16x32_bf16 v[172:175], a[12:15], v[148:151], v[172:175]
  v_exp_f32 v85, v85
  v_mfma_f32_16x16x32_bf16 v[172:175], a[24:27], v[144:147], v[172:175]
  v_exp_f32 v86, v86
  v_mfma_f32_16x16x32_bf16 v[172:175], a[36:39], a[252:255], v[172:175]
  v_exp_f32 v87, v87
  v_mfma_f32_16x16x32_bf16 v[172:175], a[48:51], a[248:251], v[172:175]
  v_exp_f32 v88, v88
  v_mfma_f32_16x16x32_bf16 v[172:175], a[60:63], a[244:247], v[172:175]
  v_exp_f32 v89, v89
  v_mfma_f32_16x16x32_bf16 v[100:103], a[64:67], a[244:247], 0
  v_exp_f32 v90, v90
  v_mfma_f32_16x16x32_bf16 v[100:103], a[52:55], a[248:251], v[100:103]
  v_exp_f32 v91, v91
  v_mfma_f32_16x16x32_bf16 v[100:103], a[40:43], a[252:255], v[100:103]
  v_mul_f32 v172, s42, v172
  v_mul_f32 v173, s42, v173
  v_mfma_f32_16x16x32_bf16 v[100:103], a[28:31], v[144:147], v[100:103]
  v_mul_f32 v174, s42, v174
  v_mul_f32 v175, s42, v175
  v_mfma_f32_16x16x32_bf16 v[100:103], a[16:19], v[148:151], v[100:103]
  v_cvt_pk_bf16_f32 v176, v172, v173
  v_cvt_pk_bf16_f32 v177, v174, v175
  v_mfma_f32_16x16x32_bf16 v[100:103], a[4:7], v[152:155], v[100:103]
  v_exp_f32 v168, v168
  v_mfma_f32_16x16x32_bf16 v[104:107], a[8:11], v[152:155], 0
  v_exp_f32 v169, v169
  v_mfma_f32_16x16x32_bf16 v[104:107], a[20:23], v[148:151], v[104:107]
  v_exp_f32 v170, v170
  v_mfma_f32_16x16x32_bf16 v[104:107], a[32:35], v[144:147], v[104:107]
  v_mul_f32 v100, s42, v100
  v_mul_f32 v101, s42, v101
  v_mfma_f32_16x16x32_bf16 v[104:107], a[44:47], a[252:255], v[104:107]
  v_mul_f32 v102, s42, v102
  v_mul_f32 v103, s42, v103
  v_mfma_f32_16x16x32_bf16 v[104:107], a[56:59], a[248:251], v[104:107]
  v_cvt_pk_bf16_f32 v178, v100, v101
  v_cvt_pk_bf16_f32 v179, v102, v103
  v_mfma_f32_16x16x32_bf16 v[104:107], a[68:71], a[244:247], v[104:107]
  v_exp_f32 v171, v171
  v_mfma_f32_16x16x32_bf16 v[180:183], v[152:155], a[144:147], 0
  v_exp_f32 v164, v164
  v_mfma_f32_16x16x32_bf16 v[180:183], v[148:151], a[156:159], v[180:183]
  v_exp_f32 v165, v165
  v_mfma_f32_16x16x32_bf16 v[180:183], v[144:147], a[168:171], v[180:183]
  v_mul_f32 v104, s42, v104
  v_mul_f32 v105, s42, v105
  v_mfma_f32_16x16x32_bf16 v[180:183], a[252:255], a[180:183], v[180:183]
  v_mul_f32 v106, s42, v106
  v_mul_f32 v107, s42, v107
  v_mfma_f32_16x16x32_bf16 v[180:183], a[248:251], a[192:195], v[180:183]
  v_cvt_pk_bf16_f32 v22, v104, v105
  v_cvt_pk_bf16_f32 v23, v106, v107
  v_mfma_f32_16x16x32_bf16 v[180:183], a[244:247], a[204:207], v[180:183]
  v_exp_f32 v166, v166
  v_mfma_f32_16x16x32_bf16 v[100:103], v[128:131], v[176:179], v[40:43]
  v_exp_f32 v167, v167
  v_mfma_f32_16x16x32_bf16 v[100:103], v[130:133], v[20:23], v[100:103]
  v_cvt_pk_bf16_f32 v84, v84, v85
  v_cvt_pk_bf16_f32 v85, v86, v87
  v_mfma_f32_16x16x32_bf16 v[104:107], v[136:139], v[176:179], v[36:39]
  v_cvt_pk_bf16_f32 v110, v180, v181
  v_cvt_pk_bf16_f32 v111, v182, v183
  v_mfma_f32_16x16x32_bf16 v[104:107], v[138:141], v[20:23], v[104:107]
  ds_read_b128 v[172:175], v3 offset:0
  v_cvt_pk_bf16_f32 v86, v88, v89
  v_mfma_f32_16x16x32_bf16 v[132:135], v[68:71], v[176:179], v[48:51]
  ds_read_b128 v[136:139], v3 offset:4096
  v_cvt_pk_bf16_f32 v87, v90, v91
  v_mfma_f32_16x16x32_bf16 v[132:135], v[70:73], v[20:23], v[132:135]
  ds_read_b128 v[140:143], v3 offset:8192
  v_cvt_pk_bf16_f32 v88, v168, v169
  v_mfma_f32_16x16x32_bf16 v[128:131], v[120:123], v[176:179], v[44:47]
  ds_read_b128 v[68:71], v3 offset:12288
  v_cvt_pk_bf16_f32 v89, v170, v171
  v_mfma_f32_16x16x32_bf16 v[128:131], v[122:125], v[20:23], v[128:131]
  ds_read_b128 v[72:75], v3 offset:16384
  v_cvt_pk_bf16_f32 v90, v164, v165
  v_mfma_f32_16x16x32_bf16 v[168:171], a[244:247], a[208:211], 0
  ds_read_b128 v[120:123], v3 offset:20480
  v_cvt_pk_bf16_f32 v91, v166, v167
  v_mfma_f32_16x16x32_bf16 v[168:171], a[248:251], a[196:199], v[168:171]
  v_exp_f32 v76, v76
  v_mfma_f32_16x16x32_bf16 v[168:171], a[252:255], a[184:187], v[168:171]
  v_exp_f32 v77, v77
  v_mfma_f32_16x16x32_bf16 v[168:171], v[144:147], a[172:175], v[168:171]
  v_exp_f32 v78, v78
  v_mfma_f32_16x16x32_bf16 v[168:171], v[148:151], a[160:163], v[168:171]
  v_exp_f32 v79, v79
  v_mfma_f32_16x16x32_bf16 v[168:171], v[152:155], a[148:151], v[168:171]
  v_exp_f32 v80, v80
  v_mfma_f32_16x16x32_bf16 v[124:127], v[152:155], a[152:155], 0
  v_exp_f32 v81, v81
  v_mfma_f32_16x16x32_bf16 v[124:127], v[148:151], a[164:167], v[124:127]
  v_exp_f32 v82, v82
  v_mfma_f32_16x16x32_bf16 v[124:127], v[144:147], a[176:179], v[124:127]
  v_cvt_pk_bf16_f32 v114, v168, v169
  v_cvt_pk_bf16_f32 v115, v170, v171
  v_mfma_f32_16x16x32_bf16 v[124:127], a[252:255], a[188:191], v[124:127]
  v_exp_f32 v83, v83
  v_mfma_f32_16x16x32_bf16 v[124:127], a[248:251], a[200:203], v[124:127]
  s_waitcnt lgkmcnt(0)
  v_exp_f32 v160, v160
  v_mfma_f32_16x16x32_bf16 v[124:127], a[244:247], a[212:215], v[124:127]
L_hop_0_1:
  s_cbranch_execz L_hop_0_2
L_mid:
  v_mfma_f32_16x16x32_bf16 v[148:151], v[172:175], v[184:187], 0
  v_exp_f32 v161, v161
  v_mfma_f32_16x16x32_bf16 v[148:151], v[136:139], v[200:203], v[148:151]
  v_exp_f32 v162, v162
  v_mfma_f32_16x16x32_bf16 v[148:151], v[140:143], v[216:219], v[148:151]
  v_cvt_pk_bf16_f32 v118, v124, v125
  v_cvt_pk_bf16_f32 v119, v126, v127
  v_mfma_f32_16x16x32_bf16 v[148:151], v[68:71], v[232:235], v[148:151]
  v_exp_f32 v163, v163
  v_mfma_f32_16x16x32_bf16 v[148:151], v[72:75], v[248:251], v[148:151]
  v_exp_f32 v156, v156
  v_mfma_f32_16x16x32_bf16 v[148:151], v[120:123], a[224:227], v[148:151]
  v_exp_f32 v157, v157
  v_mfma_f32_16x16x32_bf16 v[168:171], v[120:123], a[228:231], 0
  v_exp_f32 v158, v158
  v_mfma_f32_16x16x32_bf16 v[168:171], v[72:75], v[252:255], v[168:171]
  ds_read_b128 v[124:127], v4 offset:0
  v_cvt_pk_bf16_f32 v76, v76, v77
  v_mfma_f32_16x16x32_bf16 v[168:171], v[68:71], v[236:239], v[168:171]
  ds_read_b128 v[180:183], v4 offset:4096
  v_cvt_pk_bf16_f32 v77, v78, v79
  v_mfma_f32_16x16x32_bf16 v[168:171], v[140:143], v[220:223], v[168:171]
  ds_read_b128 a[248:251], v4 offset:8192
  v_cvt_pk_bf16_f32 v78, v80, v81
  v_mfma_f32_16x16x32_bf16 v[168:171], v[136:139], v[204:207], v[168:171]
  ds_read_b128 v[164:167], v4 offset:12288
  v_cvt_pk_bf16_f32 v79, v82, v83
  v_mfma_f32_16x16x32_bf16 v[168:171], v[172:175], v[188:191], v[168:171]
  ds_read_b128 v[144:147], v4 offset:16384
  v_cvt_pk_bf16_f32 v80, v160, v161
  v_mfma_f32_16x16x32_bf16 v[152:155], v[172:175], v[192:195], 0
  ds_read_b128 v[176:179], v4 offset:20480
  v_cvt_pk_bf16_f32 v81, v162, v163
  v_mfma_f32_16x16x32_bf16 v[152:155], v[136:139], v[208:211], v[152:155]
  v_exp_f32 v159, v159
  v_mfma_f32_16x16x32_bf16 v[152:155], v[140:143], v[224:227], v[152:155]
  v_cvt_pk_bf16_f32 v148, v148, v168
  v_cvt_pk_bf16_f32 v149, v149, v169
  v_mfma_f32_16x16x32_bf16 v[152:155], v[68:71], v[240:243], v[152:155]
  v_cvt_pk_bf16_f32 v150, v150, v170
  v_cvt_pk_bf16_f32 v151, v151, v171
  v_mfma_f32_16x16x32_bf16 v[152:155], v[72:75], a[216:219], v[152:155]
  buffer_store_dword v148, v7, s[24:27], s33 offen offset:0 nt
  v_mfma_f32_16x16x32_bf16 v[152:155], v[120:123], a[232:235], v[152:155]
  v_cvt_pk_bf16_f32 v82, v156, v157
  v_cvt_pk_bf16_f32 v83, v158, v159
  v_mfma_f32_16x16x32_bf16 v[160:163], v[120:123], a[236:239], 0
  v_exp_f32 v100, v100
  v_mfma_f32_16x16x32_bf16 v[160:163], v[72:75], a[220:223], v[160:163]
  buffer_store_dword v149, v7, s[24:27], s33 offen offset:384 nt
  v_mfma_f32_16x16x32_bf16 v[160:163], v[68:71], v[244:247], v[160:163]
  ds_read_b128 a[244:247], v3 offset:512
  v_mfma_f32_16x16x32_bf16 v[160:163], v[140:143], v[228:231], v[160:163]
  ds_read_b128 v[168:171], v3 offset:4608
  v_mfma_f32_16x16x32_bf16 v[160:163], v[136:139], v[212:215], v[160:163]
  buffer_store_dword v150, v7, s[24:27], s33 offen offset:768 nt
  v_mfma_f32_16x16x32_bf16 v[160:163], v[172:175], v[196:199], v[160:163]
  s_waitcnt lgkmcnt(2)
  ds_read_b128 a[252:255], v3 offset:8704
  v_mfma_f32_16x16x32_bf16 v[136:139], v[124:127], v[184:187], 0
  ds_read_b128 v[68:71], v3 offset:12800
  v_mfma_f32_16x16x32_bf16 v[136:139], v[180:183], v[200:203], v[136:139]
  buffer_store_dword v151, v7, s[24:27], s33 offen offset:1152 nt
  v_mfma_f32_16x16x32_bf16 v[136:139], a[248:251], v[216:219], v[136:139]
  v_cvt_pk_bf16_f32 v152, v152, v160
  v_cvt_pk_bf16_f32 v153, v153, v161
  v_mfma_f32_16x16x32_bf16 v[136:139], v[164:167], v[232:235], v[136:139]
  v_cvt_pk_bf16_f32 v154, v154, v162
  v_cvt_pk_bf16_f32 v155, v155, v163
  v_mfma_f32_16x16x32_bf16 v[136:139], v[144:147], v[248:251], v[136:139]
  buffer_store_dword v152, v8, s[24:27], s33 offen offset:0 nt
  v_mfma_f32_16x16x32_bf16 v[136:139], v[176:179], a[224:227], v[136:139]
  ds_read_b128 v[72:75], v3 offset:16896
  v_mfma_f32_16x16x32_bf16 v[120:123], v[176:179], a[228:231], 0
  ds_read_b128 v[140:143], v3 offset:20992
  v_xor_b32 v3, 40960, v3
  v_mfma_f32_16x16x32_bf16 v[120:123], v[144:147], v[252:255], v[120:123]
  buffer_store_dword v153, v8, s[24:27], s33 offen offset:384 nt
  v_mfma_f32_16x16x32_bf16 v[120:123], v[164:167], v[236:239], v[120:123]
  v_exp_f32 v101, v101
  v_mfma_f32_16x16x32_bf16 v[120:123], a[248:251], v[220:223], v[120:123]
  v_exp_f32 v102, v102
  v_mfma_f32_16x16x32_bf16 v[120:123], v[180:183], v[204:207], v[120:123]
  buffer_store_dword v154, v8, s[24:27], s33 offen offset:768 nt
  v_mfma_f32_16x16x32_bf16 v[120:123], v[124:127], v[188:191], v[120:123]
  s_waitcnt lgkmcnt(1)
  v_exp_f32 v103, v103
  v_mfma_f32_16x16x32_bf16 v[144:147], a[244:247], v[184:187], 0
  v_exp_f32 v104, v104
  v_mfma_f32_16x16x32_bf16 v[144:147], v[168:171], v[200:203], v[144:147]
  buffer_store_dword v155, v8, s[24:27], s33 offen offset:1152 nt
  v_mfma_f32_16x16x32_bf16 v[144:147], a[252:255], v[216:219], v[144:147]
  v_cvt_pk_bf16_f32 v136, v136, v120
  v_cvt_pk_bf16_f32 v137, v137, v121
  v_mfma_f32_16x16x32_bf16 v[144:147], v[68:71], v[232:235], v[144:147]
  s_waitcnt lgkmcnt(0)
  v_cvt_pk_bf16_f32 v138, v138, v122
  v_cvt_pk_bf16_f32 v139, v139, v123
  v_mfma_f32_16x16x32_bf16 v[144:147], v[72:75], v[248:251], v[144:147]
  buffer_store_dword v136, v7, s[24:27], s34 offen offset:0 nt
  v_mfma_f32_16x16x32_bf16 v[144:147], v[140:143], a[224:227], v[144:147]
  v_exp_f32 v105, v105
  v_mfma_f32_16x16x32_bf16 v[160:163], v[140:143], a[228:231], 0
  v_exp_f32 v106, v106
  v_mfma_f32_16x16x32_bf16 v[160:163], v[72:75], v[252:255], v[160:163]
  buffer_store_dword v137, v7, s[24:27], s34 offen offset:384 nt
  v_mfma_f32_16x16x32_bf16 v[160:163], v[68:71], v[236:239], v[160:163]
  ds_read_b128 v[120:123], v4 offset:512
  v_cvt_pk_bf16_f32 v100, v100, v101
  v_mfma_f32_16x16x32_bf16 v[160:163], a[252:255], v[220:223], v[160:163]
  ds_read_b128 v[124:127], v4 offset:4608
  v_cvt_pk_bf16_f32 v101, v102, v103
  v_mfma_f32_16x16x32_bf16 v[160:163], v[168:171], v[204:207], v[160:163]
  buffer_store_dword v138, v7, s[24:27], s34 offen offset:768 nt
  v_mfma_f32_16x16x32_bf16 v[160:163], a[244:247], v[188:191], v[160:163]
  ds_read_b128 v[152:155], v4 offset:8704
  v_cvt_pk_bf16_f32 v102, v104, v105
  v_mfma_f32_16x16x32_bf16 v[148:151], a[244:247], v[192:195], 0
  ds_read_b128 v[156:159], v4 offset:12800
  v_mfma_f32_16x16x32_bf16 v[148:151], v[168:171], v[208:211], v[148:151]
  buffer_store_dword v139, v7, s[24:27], s34 offen offset:1152 nt
  v_mfma_f32_16x16x32_bf16 v[148:151], a[252:255], v[224:227], v[148:151]
  v_cvt_pk_bf16_f32 v144, v144, v160
  v_cvt_pk_bf16_f32 v145, v145, v161
  v_mfma_f32_16x16x32_bf16 v[148:151], v[68:71], v[240:243], v[148:151]
  v_cvt_pk_bf16_f32 v146, v146, v162
  v_cvt_pk_bf16_f32 v147, v147, v163
  v_mfma_f32_16x16x32_bf16 v[148:151], v[72:75], a[216:219], v[148:151]
  buffer_store_dword v144, v7, s[24:27], s35 offen offset:0 nt
  v_mfma_f32_16x16x32_bf16 v[148:151], v[140:143], a[232:235], v[148:151]
  ds_read_b128 v[136:139], v4 offset:16896
  v_mfma_f32_16x16x32_bf16 v[164:167], v[140:143], a[236:239], 0
  ds_read_b128 v[160:163], v4 offset:20992
  v_xor_b32 v4, 40960, v4
  v_mfma_f32_16x16x32_bf16 v[164:167], v[72:75], a[220:223], v[164:167]
  buffer_store_dword v145, v7, s[24:27], s35 offen offset:384 nt
  v_mfma_f32_16x16x32_bf16 v[164:167], v[68:71], v[244:247], v[164:167]
  v_exp_f32 v107, v107
  v_mfma_f32_16x16x32_bf16 v[164:167], a[252:255], v[228:231], v[164:167]
  v_exp_f32 v132, v132
  v_mfma_f32_16x16x32_bf16 v[164:167], v[168:171], v[212:215], v[164:167]
  buffer_store_dword v146, v7, s[24:27], s35 offen offset:768 nt
  v_mfma_f32_16x16x32_bf16 v[164:167], a[244:247], v[196:199], v[164:167]
  s_waitcnt lgkmcnt(1)
  v_exp_f32 v133, v133
  v_mfma_f32_16x16x32_bf16 v[140:143], v[120:123], v[184:187], 0
  v_exp_f32 v134, v134
  v_mfma_f32_16x16x32_bf16 v[140:143], v[124:127], v[200:203], v[140:143]
  buffer_store_dword v147, v7, s[24:27], s35 offen offset:1152 nt
  v_mfma_f32_16x16x32_bf16 v[140:143], v[152:155], v[216:219], v[140:143]
  v_cvt_pk_bf16_f32 v148, v148, v164
  v_cvt_pk_bf16_f32 v149, v149, v165
  v_mfma_f32_16x16x32_bf16 v[140:143], v[156:159], v[232:235], v[140:143]
  s_waitcnt lgkmcnt(0)
  v_cvt_pk_bf16_f32 v150, v150, v166
  v_cvt_pk_bf16_f32 v151, v151, v167
  v_mfma_f32_16x16x32_bf16 v[140:143], v[136:139], v[248:251], v[140:143]
  buffer_store_dword v148, v8, s[24:27], s35 offen offset:0 nt
  v_mfma_f32_16x16x32_bf16 v[140:143], v[160:163], a[224:227], v[140:143]
  v_mov_b64 v[164:165], 0
  v_cvt_pk_bf16_f32 v103, v106, v107
  v_mfma_f32_16x16x32_bf16 v[144:147], v[160:163], a[228:231], 0
  v_exp_f32 v135, v135
  v_mfma_f32_16x16x32_bf16 v[144:147], v[136:139], v[252:255], v[144:147]
  buffer_store_dword v149, v8, s[24:27], s35 offen offset:384 nt
  v_mfma_f32_16x16x32_bf16 v[144:147], v[156:159], v[236:239], v[144:147]
  v_exp_f32 v128, v128
  v_mfma_f32_16x16x32_bf16 v[144:147], v[152:155], v[220:223], v[144:147]
  v_mov_b64 v[72:73], 0
  v_cvt_pk_bf16_f32 v104, v132, v133
  v_mfma_f32_16x16x32_bf16 v[144:147], v[124:127], v[204:207], v[144:147]
  buffer_store_dword v150, v8, s[24:27], s35 offen offset:768 nt
  v_mfma_f32_16x16x32_bf16 v[144:147], v[120:123], v[188:191], v[144:147]
  v_exp_f32 v129, v129
  v_smfmac_f32_16x16x64_bf16 v[164:167], a[240:243], v[92:99], v10
  v_exp_f32 v130, v130
  v_mfma_f32_16x16x32_bf16 v[168:171], v[108:111], v[96:99], 0
  buffer_store_dword v151, v8, s[24:27], s35 offen offset:1152 nt
  v_mfma_f32_16x16x32_bf16 v[168:171], v[56:59], v[92:95], v[168:171]
  v_cvt_pk_bf16_f32 v140, v140, v144
  v_cvt_pk_bf16_f32 v141, v141, v145
  v_mfma_f32_16x16x32_bf16 v[160:163], v[60:63], v[92:95], 0
  v_cvt_pk_bf16_f32 v142, v142, v146
  v_cvt_pk_bf16_f32 v143, v143, v147
  v_mfma_f32_16x16x32_bf16 v[160:163], v[112:115], v[96:99], v[160:163]
  buffer_store_dword v140, v7, s[24:27], s36 offen offset:0 nt
  v_mfma_f32_16x16x32_bf16 v[68:71], v[116:119], v[96:99], 0
  v_mov_b64 v[124:125], 0
  v_cvt_pk_bf16_f32 v105, v134, v135
  v_mfma_f32_16x16x32_bf16 v[68:71], v[64:67], v[92:95], v[68:71]
  v_exp_f32 v131, v131
  v_smfmac_f32_16x16x64_bf16 v[72:75], a[240:243], v[84:91], v10
  buffer_store_dword v141, v7, s[24:27], s36 offen offset:384 nt
  v_mfma_f32_16x16x32_bf16 v[156:159], v[108:111], v[88:91], 0
  v_cvt_pk_bf16_f32 v106, v128, v129
  v_cvt_pk_bf16_f32 v107, v130, v131
  v_mfma_f32_16x16x32_bf16 v[156:159], v[56:59], v[84:87], v[156:159]
  v_add_f32 v164, v164, v165
  v_mfma_f32_16x16x32_bf16 v[148:151], v[60:63], v[84:87], 0
  buffer_store_dword v142, v7, s[24:27], s36 offen offset:768 nt
  v_mfma_f32_16x16x32_bf16 v[148:151], v[112:115], v[88:91], v[148:151]
  ds_read_b128 a[244:247], v0 offset:0
  v_mov_b64 v[92:93], 0
  v_mfma_f32_16x16x32_bf16 v[132:135], v[116:119], v[88:91], 0
  ds_read_b128 a[248:251], v1 offset:0
  v_add_f32 v72, v72, v73
  v_mfma_f32_16x16x32_bf16 v[132:135], v[64:67], v[84:87], v[132:135]
  buffer_store_dword v143, v7, s[24:27], s36 offen offset:1152 nt
  v_smfmac_f32_16x16x64_bf16 v[124:127], a[240:243], v[76:83], v10
  ds_read_b128 v[136:139], v0 offset:8192
  v_cndmask_b32 v7, v7, v52, s[62:63]
  v_mfma_f32_16x16x32_bf16 v[128:131], v[56:59], v[80:83], 0
  ds_read_b128 v[140:143], v1 offset:8192
  v_cndmask_b32 v8, v8, v53, s[62:63]
  v_mfma_f32_16x16x32_bf16 v[128:131], v[108:111], v[76:79], v[128:131]
  s_mov_b64 s[62:63], 0
  ds_read_b128 v[152:155], v0 offset:16384
  v_mfma_f32_16x16x32_bf16 v[120:123], v[112:115], v[76:79], 0
  ds_read_b128 v[144:147], v1 offset:16384
  v_mfma_f32_16x16x32_bf16 v[120:123], v[60:63], v[80:83], v[120:123]
  v_rcp_f32 v166, v164
  v_mfma_f32_16x16x32_bf16 v[96:99], v[64:67], v[80:83], 0
  v_mul_f32 v168, v166, v168
  v_mul_f32 v169, v166, v169
  v_mfma_f32_16x16x32_bf16 v[96:99], v[116:119], v[76:79], v[96:99]
  v_mul_f32 v170, v166, v170
  v_mul_f32 v171, v166, v171
  v_smfmac_f32_16x16x64_bf16 v[92:95], a[240:243], v[100:107], v10
  v_cvt_pk_bf16_f32 v168, v168, v169
  v_cvt_pk_bf16_f32 v169, v170, v171
  v_mfma_f32_16x16x32_bf16 v[88:91], v[56:59], v[104:107], 0
  v_mul_f32 v160, v166, v160
  v_mul_f32 v161, v166, v161
  v_mfma_f32_16x16x32_bf16 v[88:91], v[108:111], v[100:103], v[88:91]
  v_mul_f32 v162, v166, v162
  v_mul_f32 v163, v166, v163
  v_mfma_f32_16x16x32_bf16 v[80:83], v[112:115], v[100:103], 0
  v_cvt_pk_bf16_f32 v160, v160, v161
  v_cvt_pk_bf16_f32 v161, v162, v163
  v_mfma_f32_16x16x32_bf16 v[80:83], v[60:63], v[104:107], v[80:83]
  v_mul_f32 v68, v166, v68
  v_mul_f32 v69, v166, v69
  v_mfma_f32_16x16x32_bf16 v[84:87], v[64:67], v[104:107], 0
  v_mul_f32 v70, v166, v70
  v_mul_f32 v71, v166, v71
  v_mfma_f32_16x16x32_bf16 v[84:87], v[116:119], v[100:103], v[84:87]
  s_waitcnt lgkmcnt(0)
  v_cvt_pk_bf16_f32 v68, v68, v69
  v_cvt_pk_bf16_f32 v69, v70, v71
  v_mfma_f32_16x16x32_bf16 v[64:67], a[0:3], a[244:247], 0
  v_max3_f32 v9, v164, v166, v9
  v_add_f32 v124, v124, v125
  v_mfma_f32_16x16x32_bf16 v[64:67], a[12:15], a[248:251], v[64:67]
  ds_write_b32 v5, v168 offset:0
  v_mfma_f32_16x16x32_bf16 v[64:67], a[24:27], v[136:139], v[64:67]
  v_rcp_f32 v74, v72
  v_mfma_f32_16x16x32_bf16 v[64:67], a[36:39], v[140:143], v[64:67]
  ds_write_b32 v5, v169 offset:1024
  v_mfma_f32_16x16x32_bf16 v[64:67], a[48:51], v[152:155], v[64:67]
  s_add_u32 m0, s30, 0
  v_mul_f32 v156, v74, v156
  v_mul_f32 v157, v74, v157
  v_mfma_f32_16x16x32_bf16 v[64:67], a[60:63], v[144:147], v[64:67]
  buffer_load_dwordx4 v6, s[8:11], s31 offen offset:0 nt lds
  v_mfma_f32_16x16x32_bf16 v[60:63], a[64:67], v[144:147], 0
  v_mul_f32 v158, v74, v158
  v_mul_f32 v159, v74, v159
  v_mfma_f32_16x16x32_bf16 v[60:63], a[52:55], v[152:155], v[60:63]
  ds_write_b32 v5, v160 offset:2048
  v_mfma_f32_16x16x32_bf16 v[60:63], a[40:43], v[140:143], v[60:63]
  v_mul_f32 v64, s42, v64
  v_mul_f32 v65, s42, v65
  v_mfma_f32_16x16x32_bf16 v[60:63], a[28:31], v[136:139], v[60:63]
  v_mul_f32 v66, s42, v66
  v_mul_f32 v67, s42, v67
  v_mfma_f32_16x16x32_bf16 v[60:63], a[16:19], a[248:251], v[60:63]
  v_cvt_pk_bf16_f32 v12, v64, v65
  v_cvt_pk_bf16_f32 v13, v66, v67
  v_mfma_f32_16x16x32_bf16 v[60:63], a[4:7], a[244:247], v[60:63]
  ds_write_b32 v5, v161 offset:3072
  v_mfma_f32_16x16x32_bf16 v[56:59], a[8:11], a[244:247], 0
  v_cvt_pk_bf16_f32 v156, v156, v157
  v_cvt_pk_bf16_f32 v157, v158, v159
  v_mfma_f32_16x16x32_bf16 v[56:59], a[20:23], a[248:251], v[56:59]
  ds_write_b32 v5, v68 offset:4096
  v_mfma_f32_16x16x32_bf16 v[56:59], a[32:35], v[136:139], v[56:59]
  v_mul_f32 v60, s42, v60
  v_mul_f32 v61, s42, v61
  v_mfma_f32_16x16x32_bf16 v[56:59], a[44:47], v[140:143], v[56:59]
  v_mul_f32 v62, s42, v62
  v_mul_f32 v63, s42, v63
  v_mfma_f32_16x16x32_bf16 v[56:59], a[56:59], v[152:155], v[56:59]
  v_cvt_pk_bf16_f32 v76, v60, v61
  v_cvt_pk_bf16_f32 v77, v62, v63
  v_mfma_f32_16x16x32_bf16 v[56:59], a[68:71], v[144:147], v[56:59]
  ds_write_b32 v5, v69 offset:5120
  v_mfma_f32_16x16x32_bf16 v[64:67], a[132:135], v[144:147], 0
  v_mul_f32 v148, v74, v148
  v_mul_f32 v149, v74, v149
  v_mfma_f32_16x16x32_bf16 v[64:67], a[120:123], v[152:155], v[64:67]
  v_mul_f32 v150, v74, v150
  v_mul_f32 v151, v74, v151
  v_mfma_f32_16x16x32_bf16 v[64:67], a[108:111], v[140:143], v[64:67]
  v_mul_f32 v56, s42, v56
  v_mul_f32 v57, s42, v57
  v_mfma_f32_16x16x32_bf16 v[64:67], a[96:99], v[136:139], v[64:67]
  v_mul_f32 v58, s42, v58
  v_mul_f32 v59, s42, v59
  v_mfma_f32_16x16x32_bf16 v[64:67], a[84:87], a[248:251], v[64:67]
  s_add_u32 m0, s30, 8064
  v_cvt_pk_bf16_f32 v78, v56, v57
  v_cvt_pk_bf16_f32 v79, v58, v59
  v_mfma_f32_16x16x32_bf16 v[64:67], a[72:75], a[244:247], v[64:67]
  buffer_load_dwordx4 v6, s[8:11], s31 offen offset:128 nt lds
  v_mfma_f32_16x16x32_bf16 v[60:63], a[76:79], a[244:247], 0
  v_cvt_pk_bf16_f32 v148, v148, v149
  v_cvt_pk_bf16_f32 v149, v150, v151
  v_mfma_f32_16x16x32_bf16 v[60:63], a[88:91], a[248:251], v[60:63]
  v_mul_f32 v132, v74, v132
  v_mul_f32 v133, v74, v133
  v_mfma_f32_16x16x32_bf16 v[60:63], a[100:103], v[136:139], v[60:63]
  v_cvt_pk_bf16_f32 v68, v64, v65
  v_cvt_pk_bf16_f32 v69, v66, v67
  v_mfma_f32_16x16x32_bf16 v[60:63], a[112:115], v[140:143], v[60:63]
  v_mul_f32 v134, v74, v134
  v_mul_f32 v135, v74, v135
  v_mfma_f32_16x16x32_bf16 v[60:63], a[124:127], v[152:155], v[60:63]
  v_cvt_pk_bf16_f32 v132, v132, v133
  v_cvt_pk_bf16_f32 v133, v134, v135
  v_mfma_f32_16x16x32_bf16 v[60:63], a[136:139], v[144:147], v[60:63]
  v_max3_f32 v9, v72, v74, v9
  v_add_f32 v92, v92, v93
  v_mfma_f32_16x16x32_bf16 v[56:59], a[140:143], v[144:147], 0
  ds_write_b32 v5, v156 offset:256
  v_mfma_f32_16x16x32_bf16 v[56:59], a[128:131], v[152:155], v[56:59]
  v_rcp_f32 v126, v124
  v_mfma_f32_16x16x32_bf16 v[56:59], a[116:119], v[140:143], v[56:59]
  v_cvt_pk_bf16_f32 v70, v60, v61
  v_cvt_pk_bf16_f32 v71, v62, v63
  v_mfma_f32_16x16x32_bf16 v[56:59], a[104:107], v[136:139], v[56:59]
  ds_write_b32 v5, v157 offset:1280
  v_mfma_f32_16x16x32_bf16 v[56:59], a[92:95], a[248:251], v[56:59]
  v_mul_f32 v128, v126, v128
  v_mul_f32 v129, v126, v129
  v_mfma_f32_16x16x32_bf16 v[56:59], a[80:83], a[244:247], v[56:59]
  ds_write_b32 v5, v148 offset:2304
  v_mfma_f32_16x16x32_bf16 v[60:63], a[244:247], a[144:147], 0
  v_mul_f32 v130, v126, v130
  v_mul_f32 v131, v126, v131
  v_mfma_f32_16x16x32_bf16 v[60:63], a[248:251], a[156:159], v[60:63]
  ds_read_b128 a[252:255], v0 offset:2048
  v_cvt_pk_bf16_f32 v128, v128, v129
  v_mfma_f32_16x16x32_bf16 v[60:63], v[136:139], a[168:171], v[60:63]
  v_cvt_pk_bf16_f32 v72, v56, v57
  v_cvt_pk_bf16_f32 v73, v58, v59
  v_mfma_f32_16x16x32_bf16 v[60:63], v[140:143], a[180:183], v[60:63]
  ds_read_b128 v[104:107], v1 offset:2048
  v_cvt_pk_bf16_f32 v129, v130, v131
  v_mfma_f32_16x16x32_bf16 v[60:63], v[152:155], a[192:195], v[60:63]
  s_add_u32 m0, s30, 16128
  ds_read_b128 v[108:111], v0 offset:10240
  v_mul_f32 v120, v126, v120
  v_mfma_f32_16x16x32_bf16 v[60:63], v[144:147], a[204:207], v[60:63]
  buffer_load_dwordx4 v6, s[8:11], s31 offen offset:256 nt lds
  v_mfma_f32_16x16x32_bf16 v[64:67], v[144:147], a[208:211], 0
  ds_read_b128 v[116:119], v1 offset:10240
  v_mul_f32 v121, v126, v121
  v_mfma_f32_16x16x32_bf16 v[64:67], v[152:155], a[196:199], v[64:67]
  ds_read_b128 v[112:115], v0 offset:18432
  v_mul_f32 v122, v126, v122
  v_mfma_f32_16x16x32_bf16 v[64:67], v[140:143], a[184:187], v[64:67]
  v_cvt_pk_bf16_f32 v56, v60, v61
  v_cvt_pk_bf16_f32 v57, v62, v63
  v_mfma_f32_16x16x32_bf16 v[64:67], v[136:139], a[172:175], v[64:67]
  ds_write_b32 v5, v149 offset:3328
  v_mfma_f32_16x16x32_bf16 v[64:67], a[248:251], a[160:163], v[64:67]
  v_mul_f32 v123, v126, v123
  v_cvt_pk_bf16_f32 v120, v120, v121
  v_mfma_f32_16x16x32_bf16 v[64:67], a[244:247], a[148:151], v[64:67]
  ds_write_b32 v5, v132 offset:4352
  v_mfma_f32_16x16x32_bf16 v[100:103], a[244:247], a[152:155], 0
  ds_write_b32 v5, v133 offset:5376
  v_mfma_f32_16x16x32_bf16 v[100:103], a[248:251], a[164:167], v[100:103]
  v_cvt_pk_bf16_f32 v121, v122, v123
  v_mul_f32 v96, v126, v96
  v_mfma_f32_16x16x32_bf16 v[100:103], v[136:139], a[176:179], v[100:103]
  ds_read_b128 a[244:247], v1 offset:18432
  v_cvt_pk_bf16_f32 v60, v64, v65
  v_mfma_f32_16x16x32_bf16 v[100:103], v[140:143], a[188:191], v[100:103]
  v_cvt_pk_bf16_f32 v61, v66, v67
  v_mul_f32 v97, v126, v97
  v_mfma_f32_16x16x32_bf16 v[100:103], v[152:155], a[200:203], v[100:103]
  v_mul_f32 v98, v126, v98
  v_mul_f32 v99, v126, v99
  v_mfma_f32_16x16x32_bf16 v[100:103], v[144:147], a[212:215], v[100:103]
  s_waitcnt lgkmcnt(4)
  v_cvt_pk_bf16_f32 v96, v96, v97
  v_cvt_pk_bf16_f32 v97, v98, v99
  v_mfma_f32_16x16x32_bf16 v[132:135], a[0:3], a[252:255], 0
  v_max3_f32 v9, v124, v126, v9
  v_mfma_f32_16x16x32_bf16 v[132:135], a[12:15], v[104:107], v[132:135]
  ds_write_b32 v5, v128 offset:512
  v_mfma_f32_16x16x32_bf16 v[132:135], a[24:27], v[108:111], v[132:135]
  v_cvt_pk_bf16_f32 v64, v100, v101
  v_cvt_pk_bf16_f32 v65, v102, v103
  v_mfma_f32_16x16x32_bf16 v[132:135], a[36:39], v[116:119], v[132:135]
  s_waitcnt lgkmcnt(1)
  ds_write_b32 v5, v129 offset:1536
  v_mfma_f32_16x16x32_bf16 v[132:135], a[48:51], v[112:115], v[132:135]
  s_add_u32 m0, s30, 4096
  v_rcp_f32 v94, v92
  v_mfma_f32_16x16x32_bf16 v[132:135], a[60:63], a[244:247], v[132:135]
  buffer_load_dwordx4 v6, s[8:11], s32 offen offset:0 nt lds
  v_mfma_f32_16x16x32_bf16 v[124:127], a[64:67], a[244:247], 0
  s_add_u32 s33, s31, s37
  v_mul_f32 v88, v94, v88
  v_mul_f32 v89, v94, v89
  v_mfma_f32_16x16x32_bf16 v[124:127], a[52:55], v[112:115], v[124:127]
  s_add_u32 s34, s31, s38
  ds_write_b32 v5, v120 offset:2560
  v_mfma_f32_16x16x32_bf16 v[124:127], a[40:43], v[116:119], v[124:127]
  s_add_u32 s35, s31, s39
  v_mul_f32 v132, s42, v132
  v_mul_f32 v133, s42, v133
  v_mfma_f32_16x16x32_bf16 v[124:127], a[28:31], v[108:111], v[124:127]
  s_add_u32 s36, s31, s40
  v_mul_f32 v134, s42, v134
  v_mul_f32 v135, s42, v135
  v_mfma_f32_16x16x32_bf16 v[124:127], a[16:19], v[104:107], v[124:127]
  s_add_u32 s31, s31, s43
  v_cvt_pk_bf16_f32 v100, v132, v133
  v_cvt_pk_bf16_f32 v101, v134, v135
  v_mfma_f32_16x16x32_bf16 v[124:127], a[4:7], a[252:255], v[124:127]
  s_mov_b32 s5, s28
  ds_write_b32 v5, v121 offset:3584
  v_mfma_f32_16x16x32_bf16 v[128:131], a[8:11], a[252:255], 0
  s_mov_b32 s28, s29
  v_mul_f32 v90, v94, v90
  v_mul_f32 v91, v94, v91
  v_mfma_f32_16x16x32_bf16 v[128:131], a[20:23], v[104:107], v[128:131]
  s_mov_b32 s29, s30
  ds_write_b32 v5, v96 offset:4608
  v_mfma_f32_16x16x32_bf16 v[128:131], a[32:35], v[108:111], v[128:131]
  v_mul_f32 v124, s42, v124
  v_mul_f32 v125, s42, v125
  v_mfma_f32_16x16x32_bf16 v[128:131], a[44:47], v[116:119], v[128:131]
  v_mul_f32 v126, s42, v126
  v_mul_f32 v127, s42, v127
  v_mfma_f32_16x16x32_bf16 v[128:131], a[56:59], v[112:115], v[128:131]
  v_cvt_pk_bf16_f32 v102, v124, v125
  v_cvt_pk_bf16_f32 v103, v126, v127
  v_mfma_f32_16x16x32_bf16 v[128:131], a[68:71], a[244:247], v[128:131]
  ds_write_b32 v5, v97 offset:5632
  v_mfma_f32_16x16x32_bf16 v[132:135], a[132:135], a[244:247], 0
  v_cvt_pk_bf16_f32 v88, v88, v89
  v_cvt_pk_bf16_f32 v89, v90, v91
  v_mfma_f32_16x16x32_bf16 v[132:135], a[120:123], v[112:115], v[132:135]
  v_mul_f32 v80, v94, v80
  v_mul_f32 v81, v94, v81
  v_mfma_f32_16x16x32_bf16 v[132:135], a[108:111], v[116:119], v[132:135]
  v_mul_f32 v128, s42, v128
  v_mul_f32 v129, s42, v129
  v_mfma_f32_16x16x32_bf16 v[132:135], a[96:99], v[108:111], v[132:135]
  v_mul_f32 v130, s42, v130
  v_mul_f32 v131, s42, v131
  v_mfma_f32_16x16x32_bf16 v[132:135], a[84:87], v[104:107], v[132:135]
  s_add_u32 m0, s30, 12160
  v_cvt_pk_bf16_f32 v16, v128, v129
  v_cvt_pk_bf16_f32 v17, v130, v131
  v_mfma_f32_16x16x32_bf16 v[132:135], a[72:75], a[252:255], v[132:135]
  buffer_load_dwordx4 v6, s[8:11], s32 offen offset:128 nt lds
  v_mfma_f32_16x16x32_bf16 v[96:99], a[76:79], a[252:255], 0
  v_mul_f32 v82, v94, v82
  v_mul_f32 v83, v94, v83
  v_mfma_f32_16x16x32_bf16 v[96:99], a[88:91], v[104:107], v[96:99]
  v_cvt_pk_bf16_f32 v80, v80, v81
  v_cvt_pk_bf16_f32 v81, v82, v83
  v_mfma_f32_16x16x32_bf16 v[96:99], a[100:103], v[108:111], v[96:99]
  v_cvt_pk_bf16_f32 v120, v132, v133
  v_cvt_pk_bf16_f32 v121, v134, v135
  v_mfma_f32_16x16x32_bf16 v[96:99], a[112:115], v[116:119], v[96:99]
  v_mul_f32 v84, v94, v84
  v_mul_f32 v85, v94, v85
  v_mfma_f32_16x16x32_bf16 v[96:99], a[124:127], v[112:115], v[96:99]
  v_mul_f32 v86, v94, v86
  v_mul_f32 v87, v94, v87
  v_mfma_f32_16x16x32_bf16 v[96:99], a[136:139], a[244:247], v[96:99]
  v_cvt_pk_bf16_f32 v84, v84, v85
  v_cvt_pk_bf16_f32 v85, v86, v87
  v_mfma_f32_16x16x32_bf16 v[132:135], a[140:143], a[244:247], 0
  v_max3_f32 v9, v92, v94, v9
  v_mfma_f32_16x16x32_bf16 v[132:135], a[128:131], v[112:115], v[132:135]
  ds_write_b32 v5, v88 offset:768
  v_mfma_f32_16x16x32_bf16 v[132:135], a[116:119], v[116:119], v[132:135]
  v_cvt_pk_bf16_f32 v122, v96, v97
  v_cvt_pk_bf16_f32 v123, v98, v99
  v_mfma_f32_16x16x32_bf16 v[132:135], a[104:107], v[108:111], v[132:135]
  ds_write_b32 v5, v89 offset:1792
  v_mfma_f32_16x16x32_bf16 v[132:135], a[92:95], v[104:107], v[132:135]
  v_mfma_f32_16x16x32_bf16 v[132:135], a[80:83], a[252:255], v[132:135]
  ds_write_b32 v5, v80 offset:2816
  v_mfma_f32_16x16x32_bf16 v[128:131], a[252:255], a[144:147], 0
  v_mfma_f32_16x16x32_bf16 v[128:131], v[104:107], a[156:159], v[128:131]
  ds_read_b128 v[88:91], v0 offset:4096
  v_mfma_f32_16x16x32_bf16 v[128:131], v[108:111], a[168:171], v[128:131]
  v_cvt_pk_bf16_f32 v124, v132, v133
  v_cvt_pk_bf16_f32 v125, v134, v135
  v_mfma_f32_16x16x32_bf16 v[128:131], v[116:119], a[180:183], v[128:131]
  ds_read_b128 v[92:95], v1 offset:4096
  v_mfma_f32_16x16x32_bf16 v[128:131], v[112:115], a[192:195], v[128:131]
  s_add_u32 m0, s30, 20224
  ds_read_b128 v[96:99], v0 offset:12288
  v_mfma_f32_16x16x32_bf16 v[128:131], a[244:247], a[204:207], v[128:131]
  buffer_load_dwordx4 v6, s[8:11], s32 offen offset:256 nt lds
  v_mfma_f32_16x16x32_bf16 v[132:135], a[244:247], a[208:211], 0
  s_add_u32 s32, s32, s43
  ds_read_b128 v[136:139], v1 offset:12288
  v_mfma_f32_16x16x32_bf16 v[132:135], v[112:115], a[196:199], v[132:135]
  s_mov_b32 s30, s5
  ds_read_b128 v[140:143], v0 offset:20480
  v_mfma_f32_16x16x32_bf16 v[132:135], v[116:119], a[184:187], v[132:135]
  v_cvt_pk_bf16_f32 v58, v128, v129
  v_cvt_pk_bf16_f32 v59, v130, v131
  v_mfma_f32_16x16x32_bf16 v[132:135], v[108:111], a[172:175], v[132:135]
  ds_write_b32 v5, v81 offset:3840
  v_mfma_f32_16x16x32_bf16 v[132:135], v[104:107], a[160:163], v[132:135]
  v_mfma_f32_16x16x32_bf16 v[132:135], a[252:255], a[148:151], v[132:135]
  ds_write_b32 v5, v84 offset:4864
  v_mfma_f32_16x16x32_bf16 v[128:131], a[252:255], a[152:155], 0
  v_mfma_f32_16x16x32_bf16 v[128:131], v[104:107], a[164:167], v[128:131]
  ds_write_b32 v5, v85 offset:5888
  v_mfma_f32_16x16x32_bf16 v[128:131], v[108:111], a[176:179], v[128:131]
  v_cvt_pk_bf16_f32 v62, v132, v133
  v_cvt_pk_bf16_f32 v63, v134, v135
  v_mfma_f32_16x16x32_bf16 v[128:131], v[116:119], a[188:191], v[128:131]
  s_waitcnt lgkmcnt(3)
  ds_read_b128 v[80:83], v1 offset:20480
  v_xor_b32 v5, s41, v5
  v_mfma_f32_16x16x32_bf16 v[128:131], v[112:115], a[200:203], v[128:131]
  s_bitcmp1_b32 s96, s59
  v_mfma_f32_16x16x32_bf16 v[128:131], a[244:247], a[212:215], v[128:131]
  s_cbranch_scc0 L_loop
L_epi:
  s_cmp_lg_u32 s59, s97
  s_cbranch_scc1 L_k2
L_full:
  v_mfma_f32_16x16x32_bf16 v[104:107], a[76:79], v[88:91], 0
  s_lshl_b32 s5, s3, 3
  v_mfma_f32_16x16x32_bf16 v[104:107], a[88:91], v[92:95], v[104:107]
  s_add_u32 s5, s5, 159744
  v_mov_b32 v11, s5
  v_mfma_f32_16x16x32_bf16 v[104:107], a[100:103], v[96:99], v[104:107]
  v_cvt_pk_bf16_f32 v66, v128, v129
  v_cvt_pk_bf16_f32 v67, v130, v131
  v_mfma_f32_16x16x32_bf16 v[104:107], a[112:115], v[136:139], v[104:107]
  ds_read_b128 v[160:163], v1 offset:22528
  v_mfma_f32_16x16x32_bf16 v[104:107], a[124:127], v[140:143], v[104:107]
  ds_read_b128 v[164:167], v0 offset:22528
  s_waitcnt lgkmcnt(2)
  v_mfma_f32_16x16x32_bf16 v[104:107], a[136:139], v[80:83], v[104:107]
  ds_read_b128 a[244:247], v1 offset:14336
  v_mfma_f32_16x16x32_bf16 v[108:111], a[132:135], v[80:83], 0
  ds_read_b128 a[252:255], v0 offset:14336
  v_mfma_f32_16x16x32_bf16 v[108:111], a[120:123], v[140:143], v[108:111]
  ds_read_b128 a[248:251], v1 offset:6144
  v_mfma_f32_16x16x32_bf16 v[108:111], a[108:111], v[136:139], v[108:111]
  v_cvt_pk_bf16_f32 v146, v104, v105
  v_cvt_pk_bf16_f32 v147, v106, v107
  v_mfma_f32_16x16x32_bf16 v[108:111], a[96:99], v[96:99], v[108:111]
  ds_read_b128 v[84:87], v0 offset:6144
  v_mfma_f32_16x16x32_bf16 v[108:111], a[84:87], v[92:95], v[108:111]
  v_mfma_f32_16x16x32_bf16 v[108:111], a[72:75], v[88:91], v[108:111]
  v_mfma_f32_16x16x32_bf16 v[112:115], a[140:143], v[80:83], 0
  v_mfma_f32_16x16x32_bf16 v[112:115], a[128:131], v[140:143], v[112:115]
  v_mfma_f32_16x16x32_bf16 v[112:115], a[116:119], v[136:139], v[112:115]
  v_cvt_pk_bf16_f32 v144, v108, v109
  v_cvt_pk_bf16_f32 v145, v110, v111
  v_mfma_f32_16x16x32_bf16 v[112:115], a[104:107], v[96:99], v[112:115]
  v_mfma_f32_16x16x32_bf16 v[112:115], a[92:95], v[92:95], v[112:115]
  v_mfma_f32_16x16x32_bf16 v[112:115], a[80:83], v[88:91], v[112:115]
  s_waitcnt lgkmcnt(0)
  v_mfma_f32_16x16x32_bf16 v[104:107], a[132:135], v[160:163], 0
L_hop_1_1:
  s_cbranch_execz L_hop_1_2
  v_mfma_f32_16x16x32_bf16 v[104:107], a[120:123], v[164:167], v[104:107]
  v_mfma_f32_16x16x32_bf16 v[104:107], a[108:111], a[244:247], v[104:107]
  v_cvt_pk_bf16_f32 v148, v112, v113
  v_cvt_pk_bf16_f32 v149, v114, v115
  v_mfma_f32_16x16x32_bf16 v[104:107], a[96:99], a[252:255], v[104:107]
  v_mfma_f32_16x16x32_bf16 v[104:107], a[84:87], a[248:251], v[104:107]
  s_waitcnt lgkmcnt(0)
  s_barrier
  v_mfma_f32_16x16x32_bf16 v[104:107], a[72:75], v[84:87], v[104:107]
  v_mfma_f32_16x16x32_bf16 v[108:111], a[76:79], v[84:87], 0
  v_mfma_f32_16x16x32_bf16 v[108:111], a[88:91], a[248:251], v[108:111]
  v_mfma_f32_16x16x32_bf16 v[108:111], a[100:103], a[252:255], v[108:111]
  v_cvt_pk_bf16_f32 v150, v104, v105
  v_cvt_pk_bf16_f32 v151, v106, v107
  v_mfma_f32_16x16x32_bf16 v[108:111], a[112:115], a[244:247], v[108:111]
  v_mfma_f32_16x16x32_bf16 v[108:111], a[124:127], v[164:167], v[108:111]
  v_mfma_f32_16x16x32_bf16 v[108:111], a[136:139], v[160:163], v[108:111]
  v_mfma_f32_16x16x32_bf16 v[104:107], a[140:143], v[160:163], 0
  v_mfma_f32_16x16x32_bf16 v[104:107], a[128:131], v[164:167], v[104:107]
  v_mfma_f32_16x16x32_bf16 v[104:107], a[116:119], a[244:247], v[104:107]
  v_cvt_pk_bf16_f32 v152, v108, v109
  v_cvt_pk_bf16_f32 v153, v110, v111
  v_mfma_f32_16x16x32_bf16 v[104:107], a[104:107], a[252:255], v[104:107]
  v_mfma_f32_16x16x32_bf16 v[104:107], a[92:95], a[248:251], v[104:107]
  v_mfma_f32_16x16x32_bf16 v[104:107], a[80:83], v[84:87], v[104:107]
  v_mfma_f32_16x16x32_bf16 v[112:115], v[70:73], v[76:79], v[36:39]
  v_mfma_f32_16x16x32_bf16 v[112:115], v[68:71], v[12:15], v[112:115]
  v_mfma_f32_16x16x32_bf16 v[116:119], v[122:125], v[76:79], v[32:35]
  v_cvt_pk_bf16_f32 v154, v104, v105
  v_cvt_pk_bf16_f32 v155, v106, v107
  v_mfma_f32_16x16x32_bf16 v[116:119], v[120:123], v[12:15], v[116:119]
  v_mfma_f32_16x16x32_bf16 v[128:131], v[146:149], v[76:79], v[28:31]
  v_exp_f32 v112, v112
  v_mfma_f32_16x16x32_bf16 v[128:131], v[144:147], v[12:15], v[128:131]
  v_exp_f32 v113, v113
  v_mfma_f32_16x16x32_bf16 v[132:135], v[152:155], v[76:79], v[24:27]
  v_exp_f32 v114, v114
  v_mfma_f32_16x16x32_bf16 v[132:135], v[150:153], v[12:15], v[132:135]
  v_exp_f32 v115, v115
  v_mfma_f32_16x16x32_bf16 v[104:107], v[68:71], v[100:103], v[40:43]
  v_exp_f32 v116, v116
  v_mfma_f32_16x16x32_bf16 v[104:107], v[70:73], v[14:17], v[104:107]
  v_exp_f32 v117, v117
  v_mfma_f32_16x16x32_bf16 v[108:111], v[120:123], v[100:103], v[36:39]
  v_exp_f32 v118, v118
  v_mfma_f32_16x16x32_bf16 v[108:111], v[122:125], v[14:17], v[108:111]
  v_exp_f32 v119, v119
  v_mfma_f32_16x16x32_bf16 v[74:77], v[144:147], v[100:103], v[32:35]
  v_exp_f32 v128, v128
  v_mfma_f32_16x16x32_bf16 v[74:77], v[146:149], v[14:17], v[74:77]
  v_exp_f32 v129, v129
  v_mfma_f32_16x16x32_bf16 v[168:171], v[150:153], v[100:103], v[28:31]
  v_exp_f32 v130, v130
  v_mfma_f32_16x16x32_bf16 v[168:171], v[152:155], v[14:17], v[168:171]
  v_exp_f32 v131, v131
  v_mfma_f32_16x16x32_bf16 v[100:103], a[0:3], v[88:91], 0
  v_exp_f32 v132, v132
  v_mfma_f32_16x16x32_bf16 v[100:103], a[12:15], v[92:95], v[100:103]
  v_exp_f32 v133, v133
  v_mfma_f32_16x16x32_bf16 v[100:103], a[24:27], v[96:99], v[100:103]
  v_exp_f32 v134, v134
  v_mfma_f32_16x16x32_bf16 v[100:103], a[36:39], v[136:139], v[100:103]
  v_exp_f32 v135, v135
  v_mfma_f32_16x16x32_bf16 v[100:103], a[48:51], v[140:143], v[100:103]
  v_cvt_pk_bf16_f32 v112, v112, v113
  v_cvt_pk_bf16_f32 v113, v114, v115
  v_mfma_f32_16x16x32_bf16 v[100:103], a[60:63], v[80:83], v[100:103]
  v_cvt_pk_bf16_f32 v114, v116, v117
  v_cvt_pk_bf16_f32 v115, v118, v119
  v_mfma_f32_16x16x32_bf16 v[172:175], a[64:67], v[80:83], 0
  v_cvt_pk_bf16_f32 v116, v128, v129
  v_cvt_pk_bf16_f32 v117, v130, v131
  v_mfma_f32_16x16x32_bf16 v[172:175], a[52:55], v[140:143], v[172:175]
  v_cvt_pk_bf16_f32 v118, v132, v133
  v_cvt_pk_bf16_f32 v119, v134, v135
  v_mfma_f32_16x16x32_bf16 v[172:175], a[40:43], v[136:139], v[172:175]
  v_mul_f32 v100, s42, v100
  v_mul_f32 v101, s42, v101
  v_mfma_f32_16x16x32_bf16 v[172:175], a[28:31], v[96:99], v[172:175]
  v_mul_f32 v102, s42, v102
  v_mul_f32 v103, s42, v103
  v_mfma_f32_16x16x32_bf16 v[172:175], a[16:19], v[92:95], v[172:175]
  v_cvt_pk_bf16_f32 v18, v100, v101
  v_cvt_pk_bf16_f32 v19, v102, v103
  v_mfma_f32_16x16x32_bf16 v[172:175], a[4:7], v[88:91], v[172:175]
  v_exp_f32 v104, v104
  v_mfma_f32_16x16x32_bf16 v[128:131], a[8:11], v[88:91], 0
  v_exp_f32 v105, v105
  v_mfma_f32_16x16x32_bf16 v[128:131], a[20:23], v[92:95], v[128:131]
  v_exp_f32 v106, v106
  v_mfma_f32_16x16x32_bf16 v[128:131], a[32:35], v[96:99], v[128:131]
  v_mul_f32 v172, s42, v172
  v_mul_f32 v173, s42, v173
  v_mfma_f32_16x16x32_bf16 v[128:131], a[44:47], v[136:139], v[128:131]
  v_mul_f32 v174, s42, v174
  v_mul_f32 v175, s42, v175
  v_mfma_f32_16x16x32_bf16 v[128:131], a[56:59], v[140:143], v[128:131]
  v_cvt_pk_bf16_f32 v176, v172, v173
  v_cvt_pk_bf16_f32 v177, v174, v175
  v_mfma_f32_16x16x32_bf16 v[128:131], a[68:71], v[80:83], v[128:131]
  v_exp_f32 v107, v107
  v_mfma_f32_16x16x32_bf16 v[132:135], a[0:3], v[84:87], 0
  v_exp_f32 v108, v108
  v_mfma_f32_16x16x32_bf16 v[132:135], a[12:15], a[248:251], v[132:135]
  v_exp_f32 v109, v109
  v_mfma_f32_16x16x32_bf16 v[132:135], a[24:27], a[252:255], v[132:135]
  v_mul_f32 v128, s42, v128
  v_mul_f32 v129, s42, v129
  v_mfma_f32_16x16x32_bf16 v[132:135], a[36:39], a[244:247], v[132:135]
  v_mul_f32 v130, s42, v130
  v_mul_f32 v131, s42, v131
  v_mfma_f32_16x16x32_bf16 v[132:135], a[48:51], v[164:167], v[132:135]
  v_cvt_pk_bf16_f32 v178, v128, v129
  v_cvt_pk_bf16_f32 v179, v130, v131
  v_mfma_f32_16x16x32_bf16 v[132:135], a[60:63], v[160:163], v[132:135]
  v_exp_f32 v110, v110
  v_mfma_f32_16x16x32_bf16 v[172:175], a[64:67], v[160:163], 0
  v_exp_f32 v111, v111
  v_mfma_f32_16x16x32_bf16 v[172:175], a[52:55], v[164:167], v[172:175]
  v_exp_f32 v74, v74
  v_mfma_f32_16x16x32_bf16 v[172:175], a[40:43], a[244:247], v[172:175]
  v_mul_f32 v132, s42, v132
  v_mul_f32 v133, s42, v133
  v_mfma_f32_16x16x32_bf16 v[172:175], a[28:31], a[252:255], v[172:175]
  v_mul_f32 v134, s42, v134
  v_mul_f32 v135, s42, v135
  v_mfma_f32_16x16x32_bf16 v[172:175], a[16:19], a[248:251], v[172:175]
  v_cvt_pk_bf16_f32 v180, v132, v133
  v_cvt_pk_bf16_f32 v181, v134, v135
  v_mfma_f32_16x16x32_bf16 v[172:175], a[4:7], v[84:87], v[172:175]
  v_exp_f32 v75, v75
  v_mfma_f32_16x16x32_bf16 v[100:103], a[8:11], v[84:87], 0
  v_exp_f32 v76, v76
  v_mfma_f32_16x16x32_bf16 v[100:103], a[20:23], a[248:251], v[100:103]
  v_exp_f32 v77, v77
  v_mfma_f32_16x16x32_bf16 v[100:103], a[32:35], a[252:255], v[100:103]
  v_mul_f32 v172, s42, v172
  v_mul_f32 v173, s42, v173
  v_mfma_f32_16x16x32_bf16 v[100:103], a[44:47], a[244:247], v[100:103]
  v_mul_f32 v174, s42, v174
  v_mul_f32 v175, s42, v175
  v_mfma_f32_16x16x32_bf16 v[100:103], a[56:59], v[164:167], v[100:103]
  v_cvt_pk_bf16_f32 v182, v172, v173
  v_cvt_pk_bf16_f32 v183, v174, v175
  v_mfma_f32_16x16x32_bf16 v[100:103], a[68:71], v[160:163], v[100:103]
  v_exp_f32 v168, v168
  v_mfma_f32_16x16x32_bf16 v[128:131], v[146:149], v[176:179], v[36:39]
  v_exp_f32 v169, v169
  v_mfma_f32_16x16x32_bf16 v[128:131], v[144:147], v[18:21], v[128:131]
  v_exp_f32 v170, v170
  v_mfma_f32_16x16x32_bf16 v[132:135], v[152:155], v[176:179], v[32:35]
  v_mul_f32 v100, s42, v100
  v_mul_f32 v101, s42, v101
  v_mfma_f32_16x16x32_bf16 v[132:135], v[150:153], v[18:21], v[132:135]
  v_mul_f32 v102, s42, v102
  v_mul_f32 v103, s42, v103
  v_mfma_f32_16x16x32_bf16 v[156:159], v[70:73], v[176:179], v[44:47]
  v_cvt_pk_bf16_f32 v22, v100, v101
  v_cvt_pk_bf16_f32 v23, v102, v103
  v_mfma_f32_16x16x32_bf16 v[156:159], v[68:71], v[18:21], v[156:159]
  v_exp_f32 v171, v171
  v_mfma_f32_16x16x32_bf16 v[172:175], v[122:125], v[176:179], v[40:43]
  v_cvt_pk_bf16_f32 v104, v104, v105
  v_cvt_pk_bf16_f32 v105, v106, v107
  v_mfma_f32_16x16x32_bf16 v[172:175], v[120:123], v[18:21], v[172:175]
  v_cvt_pk_bf16_f32 v106, v108, v109
  v_cvt_pk_bf16_f32 v107, v110, v111
  v_mfma_f32_16x16x32_bf16 v[176:179], v[88:91], a[144:147], 0
  v_cvt_pk_bf16_f32 v108, v74, v75
  v_cvt_pk_bf16_f32 v109, v76, v77
  v_mfma_f32_16x16x32_bf16 v[176:179], v[92:95], a[156:159], v[176:179]
  v_cvt_pk_bf16_f32 v110, v168, v169
  v_cvt_pk_bf16_f32 v111, v170, v171
  v_mfma_f32_16x16x32_bf16 v[176:179], v[96:99], a[168:171], v[176:179]
  v_exp_f32 v128, v128
  v_mfma_f32_16x16x32_bf16 v[176:179], v[136:139], a[180:183], v[176:179]
  v_exp_f32 v129, v129
  v_mfma_f32_16x16x32_bf16 v[176:179], v[140:143], a[192:195], v[176:179]
  v_exp_f32 v130, v130
  v_mfma_f32_16x16x32_bf16 v[176:179], v[80:83], a[204:207], v[176:179]
  v_exp_f32 v131, v131
  v_mfma_f32_16x16x32_bf16 v[76:79], v[80:83], a[208:211], 0
  v_exp_f32 v132, v132
  v_mfma_f32_16x16x32_bf16 v[76:79], v[140:143], a[196:199], v[76:79]
  v_exp_f32 v133, v133
  v_mfma_f32_16x16x32_bf16 v[76:79], v[136:139], a[184:187], v[76:79]
  v_cvt_pk_bf16_f32 v100, v176, v177
  v_cvt_pk_bf16_f32 v101, v178, v179
  v_mfma_f32_16x16x32_bf16 v[76:79], v[96:99], a[172:175], v[76:79]
  v_exp_f32 v134, v134
  v_mfma_f32_16x16x32_bf16 v[76:79], v[92:95], a[160:163], v[76:79]
  v_exp_f32 v135, v135
  v_mfma_f32_16x16x32_bf16 v[76:79], v[88:91], a[148:151], v[76:79]
  v_exp_f32 v156, v156
  v_mfma_f32_16x16x32_bf16 v[168:171], v[88:91], a[152:155], 0
  v_exp_f32 v157, v157
  v_mfma_f32_16x16x32_bf16 v[168:171], v[92:95], a[164:167], v[168:171]
  v_exp_f32 v158, v158
  v_mfma_f32_16x16x32_bf16 v[168:171], v[96:99], a[176:179], v[168:171]
  v_cvt_pk_bf16_f32 v88, v76, v77
  v_cvt_pk_bf16_f32 v89, v78, v79
  v_mfma_f32_16x16x32_bf16 v[168:171], v[136:139], a[188:191], v[168:171]
  v_exp_f32 v159, v159
  v_mfma_f32_16x16x32_bf16 v[168:171], v[140:143], a[200:203], v[168:171]
  v_exp_f32 v172, v172
  v_mfma_f32_16x16x32_bf16 v[168:171], v[80:83], a[212:215], v[168:171]
  v_exp_f32 v173, v173
  v_mfma_f32_16x16x32_bf16 v[76:79], v[144:147], v[180:183], v[40:43]
  v_exp_f32 v174, v174
  v_mfma_f32_16x16x32_bf16 v[76:79], v[146:149], v[20:23], v[76:79]
  v_exp_f32 v175, v175
  v_mfma_f32_16x16x32_bf16 v[80:83], v[150:153], v[180:183], v[36:39]
  v_cvt_pk_bf16_f32 v92, v168, v169
  v_cvt_pk_bf16_f32 v93, v170, v171
  v_mfma_f32_16x16x32_bf16 v[80:83], v[152:155], v[20:23], v[80:83]
  v_cvt_pk_bf16_f32 v128, v128, v129
  v_cvt_pk_bf16_f32 v129, v130, v131
  v_mfma_f32_16x16x32_bf16 v[144:147], v[68:71], v[180:183], v[48:51]
  v_cvt_pk_bf16_f32 v130, v132, v133
  v_cvt_pk_bf16_f32 v131, v134, v135
  v_mfma_f32_16x16x32_bf16 v[144:147], v[70:73], v[20:23], v[144:147]
  v_cvt_pk_bf16_f32 v132, v156, v157
  v_cvt_pk_bf16_f32 v133, v158, v159
  v_mfma_f32_16x16x32_bf16 v[152:155], v[120:123], v[180:183], v[44:47]
  v_cvt_pk_bf16_f32 v134, v172, v173
  v_cvt_pk_bf16_f32 v135, v174, v175
  v_mfma_f32_16x16x32_bf16 v[152:155], v[122:125], v[20:23], v[152:155]
  v_exp_f32 v76, v76
  v_mfma_f32_16x16x32_bf16 v[140:143], v[84:87], a[144:147], 0
  v_exp_f32 v77, v77
  v_mfma_f32_16x16x32_bf16 v[140:143], a[248:251], a[156:159], v[140:143]
  v_exp_f32 v78, v78
  v_mfma_f32_16x16x32_bf16 v[140:143], a[252:255], a[168:171], v[140:143]
  ds_read_b128 v[68:71], v3 offset:0
  v_cvt_pk_bf16_f32 v76, v76, v77
  v_mfma_f32_16x16x32_bf16 v[140:143], a[244:247], a[180:183], v[140:143]
  ds_read_b128 v[72:75], v3 offset:4096
  v_mfma_f32_16x16x32_bf16 v[140:143], v[164:167], a[192:195], v[140:143]
  ds_read_b128 v[96:99], v3 offset:8192
  v_mfma_f32_16x16x32_bf16 v[140:143], v[160:163], a[204:207], v[140:143]
  ds_read_b128 v[120:123], v3 offset:12288
  v_mfma_f32_16x16x32_bf16 v[148:151], v[160:163], a[208:211], 0
  ds_read_b128 v[124:127], v3 offset:16384
  v_mfma_f32_16x16x32_bf16 v[148:151], v[164:167], a[196:199], v[148:151]
  ds_read_b128 v[136:139], v3 offset:20480
  v_mfma_f32_16x16x32_bf16 v[148:151], a[244:247], a[184:187], v[148:151]
  v_cvt_pk_bf16_f32 v102, v140, v141
  v_cvt_pk_bf16_f32 v103, v142, v143
  v_mfma_f32_16x16x32_bf16 v[148:151], a[252:255], a[172:175], v[148:151]
  v_exp_f32 v79, v79
  v_mfma_f32_16x16x32_bf16 v[148:151], a[248:251], a[160:163], v[148:151]
  v_exp_f32 v80, v80
  v_mfma_f32_16x16x32_bf16 v[148:151], v[84:87], a[148:151], v[148:151]
  v_exp_f32 v81, v81
  v_mfma_f32_16x16x32_bf16 v[156:159], v[84:87], a[152:155], 0
  v_exp_f32 v82, v82
  v_mfma_f32_16x16x32_bf16 v[156:159], a[248:251], a[164:167], v[156:159]
  v_exp_f32 v83, v83
  v_mfma_f32_16x16x32_bf16 v[156:159], a[252:255], a[176:179], v[156:159]
  v_cvt_pk_bf16_f32 v90, v148, v149
  v_cvt_pk_bf16_f32 v91, v150, v151
  v_mfma_f32_16x16x32_bf16 v[156:159], a[244:247], a[188:191], v[156:159]
  v_mov_b64 v[168:169], 0
  v_cvt_pk_bf16_f32 v77, v78, v79
  v_mfma_f32_16x16x32_bf16 v[156:159], v[164:167], a[200:203], v[156:159]
  v_exp_f32 v144, v144
  v_mfma_f32_16x16x32_bf16 v[156:159], v[160:163], a[212:215], v[156:159]
  s_waitcnt lgkmcnt(0)
  v_exp_f32 v145, v145
  v_mfma_f32_16x16x32_bf16 v[140:143], v[68:71], v[184:187], 0
  v_exp_f32 v146, v146
  v_mfma_f32_16x16x32_bf16 v[140:143], v[72:75], v[200:203], v[140:143]
  v_exp_f32 v147, v147
  v_mfma_f32_16x16x32_bf16 v[140:143], v[96:99], v[216:219], v[140:143]
  v_cvt_pk_bf16_f32 v94, v156, v157
  v_cvt_pk_bf16_f32 v95, v158, v159
  v_mfma_f32_16x16x32_bf16 v[140:143], v[120:123], v[232:235], v[140:143]
  v_mov_b64 v[148:149], 0
  v_cvt_pk_bf16_f32 v78, v80, v81
  v_mfma_f32_16x16x32_bf16 v[140:143], v[124:127], v[248:251], v[140:143]
  v_exp_f32 v152, v152
  v_mfma_f32_16x16x32_bf16 v[140:143], v[136:139], a[224:227], v[140:143]
  v_exp_f32 v153, v153
  v_smfmac_f32_16x16x64_bf16 v[168:171], a[240:243], v[112:119], v10
  v_exp_f32 v154, v154
  v_mfma_f32_16x16x32_bf16 v[156:159], v[100:103], v[116:119], 0
  v_exp_f32 v155, v155
  v_mfma_f32_16x16x32_bf16 v[156:159], v[56:59], v[112:115], v[156:159]
  v_cvt_pk_bf16_f32 v79, v82, v83
  v_cvt_pk_bf16_f32 v80, v144, v145
  v_mfma_f32_16x16x32_bf16 v[160:163], v[60:63], v[112:115], 0
  v_cvt_pk_bf16_f32 v81, v146, v147
  v_cvt_pk_bf16_f32 v82, v152, v153
  v_mfma_f32_16x16x32_bf16 v[160:163], v[88:91], v[116:119], v[160:163]
  v_cvt_pk_bf16_f32 v83, v154, v155
  v_mfma_f32_16x16x32_bf16 v[164:167], v[92:95], v[116:119], 0
  v_add_f32 v168, v168, v169
  v_rcp_f32 v170, v168
  v_mfma_f32_16x16x32_bf16 v[164:167], v[64:67], v[112:115], v[164:167]
  v_max3_f32 v9, v168, v170, v9
  v_mul_f32 v156, v170, v156
  v_mul_f32 v157, v170, v157
  v_smfmac_f32_16x16x64_bf16 v[148:151], a[240:243], v[104:111], v10
  v_mul_f32 v158, v170, v158
  v_mul_f32 v159, v170, v159
  v_cvt_pk_bf16_f32 v156, v156, v157
  v_mfma_f32_16x16x32_bf16 v[144:147], v[100:103], v[108:111], 0
  v_cvt_pk_bf16_f32 v157, v158, v159
  v_mul_f32 v160, v170, v160
  v_mul_f32 v161, v170, v161
  v_mfma_f32_16x16x32_bf16 v[144:147], v[56:59], v[104:107], v[144:147]
  v_mul_f32 v162, v170, v162
  v_mul_f32 v163, v170, v163
  v_cvt_pk_bf16_f32 v160, v160, v161
  v_mfma_f32_16x16x32_bf16 v[112:115], v[60:63], v[104:107], 0
  v_cvt_pk_bf16_f32 v161, v162, v163
  v_mul_f32 v164, v170, v164
  v_mul_f32 v165, v170, v165
  v_mfma_f32_16x16x32_bf16 v[112:115], v[88:91], v[108:111], v[112:115]
  v_mul_f32 v166, v170, v166
  v_mul_f32 v167, v170, v167
  v_cvt_pk_bf16_f32 v164, v164, v165
  v_mfma_f32_16x16x32_bf16 v[84:87], v[92:95], v[108:111], 0
  v_add_f32 v148, v148, v149
  v_rcp_f32 v150, v148
  v_mfma_f32_16x16x32_bf16 v[84:87], v[64:67], v[104:107], v[84:87]
  v_cvt_pk_bf16_f32 v165, v166, v167
  v_max3_f32 v9, v148, v150, v9
  v_mul_f32 v144, v150, v144
  v_mfma_f32_16x16x32_bf16 v[104:107], v[136:139], a[228:231], 0
  v_mul_f32 v145, v150, v145
  v_mul_f32 v146, v150, v146
  v_mul_f32 v147, v150, v147
  v_mfma_f32_16x16x32_bf16 v[104:107], v[124:127], v[252:255], v[104:107]
  v_cvt_pk_bf16_f32 v144, v144, v145
  v_cvt_pk_bf16_f32 v145, v146, v147
  v_mul_f32 v112, v150, v112
  v_mfma_f32_16x16x32_bf16 v[104:107], v[120:123], v[236:239], v[104:107]
  v_mov_b64 v[172:173], 0
  v_mul_f32 v113, v150, v113
  v_mul_f32 v114, v150, v114
  v_mfma_f32_16x16x32_bf16 v[104:107], v[96:99], v[220:223], v[104:107]
  v_mul_f32 v115, v150, v115
  v_cvt_pk_bf16_f32 v112, v112, v113
  v_cvt_pk_bf16_f32 v113, v114, v115
  v_mfma_f32_16x16x32_bf16 v[104:107], v[72:75], v[204:207], v[104:107]
  v_mul_f32 v84, v150, v84
  v_mul_f32 v85, v150, v85
  v_mul_f32 v86, v150, v86
  v_mfma_f32_16x16x32_bf16 v[104:107], v[68:71], v[188:191], v[104:107]
  v_mul_f32 v87, v150, v87
  v_cvt_pk_bf16_f32 v84, v84, v85
  v_cvt_pk_bf16_f32 v85, v86, v87
  v_mfma_f32_16x16x32_bf16 v[152:155], v[68:71], v[192:195], 0
  ds_write2st64_b32 v5, v156, v157 offset0:0 offset1:4
  v_mfma_f32_16x16x32_bf16 v[152:155], v[72:75], v[208:211], v[152:155]
  ds_write2st64_b32 v5, v160, v161 offset0:8 offset1:12
  v_mfma_f32_16x16x32_bf16 v[152:155], v[96:99], v[224:227], v[152:155]
  v_cvt_pk_bf16_f32 v140, v140, v104
  v_cvt_pk_bf16_f32 v141, v141, v105
  v_mfma_f32_16x16x32_bf16 v[152:155], v[120:123], v[240:243], v[152:155]
  ds_read_b128 a[248:251], v4 offset:0
  v_cvt_pk_bf16_f32 v142, v142, v106
  v_cvt_pk_bf16_f32 v143, v143, v107
  v_mfma_f32_16x16x32_bf16 v[152:155], v[124:127], a[216:219], v[152:155]
  buffer_store_dword v140, v7, s[24:27], s33 offen offset:0 nt
  v_mfma_f32_16x16x32_bf16 v[152:155], v[136:139], a[232:235], v[152:155]
  ds_read_b128 v[148:151], v4 offset:4096
  ds_read_b128 v[156:159], v4 offset:8192
  v_smfmac_f32_16x16x64_bf16 v[172:175], a[240:243], v[128:135], v10
  ds_read_b128 v[160:163], v4 offset:12288
  ds_read_b128 v[168:171], v4 offset:16384
  v_mfma_f32_16x16x32_bf16 v[108:111], v[56:59], v[132:135], 0
  buffer_store_dword v141, v7, s[24:27], s33 offen offset:384 nt
  v_mfma_f32_16x16x32_bf16 v[108:111], v[100:103], v[128:131], v[108:111]
  ds_read_b128 v[176:179], v4 offset:20480
  v_mfma_f32_16x16x32_bf16 v[116:119], v[88:91], v[128:131], 0
  ds_write2st64_b32 v5, v164, v165 offset0:16 offset1:20
  v_mfma_f32_16x16x32_bf16 v[116:119], v[60:63], v[132:135], v[116:119]
  buffer_store_dword v142, v7, s[24:27], s33 offen offset:768 nt
  v_mfma_f32_16x16x32_bf16 v[104:107], v[64:67], v[132:135], 0
  v_add_f32 v172, v172, v173
  v_rcp_f32 v174, v172
  v_mfma_f32_16x16x32_bf16 v[104:107], v[92:95], v[128:131], v[104:107]
  v_max3_f32 v9, v172, v174, v9
  v_mul_f32 v108, v174, v108
  v_mul_f32 v109, v174, v109
  v_mfma_f32_16x16x32_bf16 v[132:135], v[136:139], a[236:239], 0
  buffer_store_dword v143, v7, s[24:27], s33 offen offset:1152 nt
  v_mul_f32 v110, v174, v110
  v_mfma_f32_16x16x32_bf16 v[132:135], v[124:127], a[220:223], v[132:135]
  v_mul_f32 v111, v174, v111
  v_cvt_pk_bf16_f32 v108, v108, v109
  v_cvt_pk_bf16_f32 v109, v110, v111
  v_mfma_f32_16x16x32_bf16 v[132:135], v[120:123], v[244:247], v[132:135]
  v_mov_b64 v[128:129], 0
  v_mul_f32 v116, v174, v116
  v_mul_f32 v117, v174, v117
  v_mfma_f32_16x16x32_bf16 v[132:135], v[96:99], v[228:231], v[132:135]
  v_mul_f32 v118, v174, v118
  v_mul_f32 v119, v174, v119
  v_cvt_pk_bf16_f32 v116, v116, v117
  v_mfma_f32_16x16x32_bf16 v[132:135], v[72:75], v[212:215], v[132:135]
  v_cvt_pk_bf16_f32 v117, v118, v119
  v_mul_f32 v104, v174, v104
  v_mul_f32 v105, v174, v105
  v_mfma_f32_16x16x32_bf16 v[132:135], v[68:71], v[196:199], v[132:135]
  s_waitcnt lgkmcnt(1)
  v_mul_f32 v106, v174, v106
  v_mul_f32 v107, v174, v107
  v_cvt_pk_bf16_f32 v104, v104, v105
  v_mfma_f32_16x16x32_bf16 v[96:99], a[248:251], v[184:187], 0
  v_cvt_pk_bf16_f32 v105, v106, v107
  v_mfma_f32_16x16x32_bf16 v[96:99], v[148:151], v[200:203], v[96:99]
  ds_write2st64_b32 v5, v144, v145 offset0:1 offset1:5
  v_mfma_f32_16x16x32_bf16 v[96:99], v[156:159], v[216:219], v[96:99]
  v_cvt_pk_bf16_f32 v152, v152, v132
  v_cvt_pk_bf16_f32 v153, v153, v133
  v_mfma_f32_16x16x32_bf16 v[96:99], v[160:163], v[232:235], v[96:99]
  ds_read_b128 a[244:247], v3 offset:512
  v_cvt_pk_bf16_f32 v154, v154, v134
  v_cvt_pk_bf16_f32 v155, v155, v135
  v_mfma_f32_16x16x32_bf16 v[96:99], v[168:171], v[248:251], v[96:99]
  buffer_store_dword v152, v8, s[24:27], s33 offen offset:0 nt
  v_mfma_f32_16x16x32_bf16 v[96:99], v[176:179], a[224:227], v[96:99]
  ds_read_b128 a[252:255], v3 offset:4608
  ds_read_b128 v[68:71], v3 offset:8704
  v_smfmac_f32_16x16x64_bf16 v[128:131], a[240:243], v[76:83], v10
  ds_read_b128 v[72:75], v3 offset:12800
  ds_read_b128 v[120:123], v3 offset:16896
  v_mfma_f32_16x16x32_bf16 v[132:135], v[56:59], v[80:83], 0
  buffer_store_dword v153, v8, s[24:27], s33 offen offset:384 nt
  v_mfma_f32_16x16x32_bf16 v[132:135], v[100:103], v[76:79], v[132:135]
  ds_read_b128 v[124:127], v3 offset:20992
  v_xor_b32 v3, 40960, v3
  v_mfma_f32_16x16x32_bf16 v[136:139], v[88:91], v[76:79], 0
  ds_write2st64_b32 v5, v112, v113 offset0:9 offset1:13
  v_mfma_f32_16x16x32_bf16 v[136:139], v[60:63], v[80:83], v[136:139]
  buffer_store_dword v154, v8, s[24:27], s33 offen offset:768 nt
  v_mfma_f32_16x16x32_bf16 v[56:59], v[64:67], v[80:83], 0
  v_add_f32 v128, v128, v129
  v_rcp_f32 v130, v128
  v_mfma_f32_16x16x32_bf16 v[56:59], v[92:95], v[76:79], v[56:59]
  v_max3_f32 v9, v128, v130, v9
  v_mul_f32 v132, v130, v132
  v_mul_f32 v133, v130, v133
  v_mfma_f32_16x16x32_bf16 v[60:63], v[176:179], a[228:231], 0
  buffer_store_dword v155, v8, s[24:27], s33 offen offset:1152 nt
  v_mul_f32 v134, v130, v134
  v_mfma_f32_16x16x32_bf16 v[60:63], v[168:171], v[252:255], v[60:63]
  s_add_u32 s33, s33, s98
  v_mul_f32 v135, v130, v135
  v_cvt_pk_bf16_f32 v132, v132, v133
  v_cvt_pk_bf16_f32 v133, v134, v135
  v_mfma_f32_16x16x32_bf16 v[60:63], v[160:163], v[236:239], v[60:63]
  v_mul_f32 v136, v130, v136
  v_mul_f32 v137, v130, v137
  v_mul_f32 v138, v130, v138
  v_mfma_f32_16x16x32_bf16 v[60:63], v[156:159], v[220:223], v[60:63]
  v_mul_f32 v139, v130, v139
  v_cvt_pk_bf16_f32 v136, v136, v137
  v_cvt_pk_bf16_f32 v137, v138, v139
  v_mfma_f32_16x16x32_bf16 v[60:63], v[148:151], v[204:207], v[60:63]
  v_mul_f32 v56, v130, v56
  v_mul_f32 v57, v130, v57
  v_mul_f32 v58, v130, v58
  v_mfma_f32_16x16x32_bf16 v[60:63], a[248:251], v[188:191], v[60:63]
  s_waitcnt lgkmcnt(1)
  v_mul_f32 v59, v130, v59
  v_cvt_pk_bf16_f32 v56, v56, v57
  v_cvt_pk_bf16_f32 v57, v58, v59
  v_mfma_f32_16x16x32_bf16 v[76:79], a[244:247], v[184:187], 0
  v_cmp_nge_f32 vcc, 0x53800000, v9
  v_mfma_f32_16x16x32_bf16 v[76:79], a[252:255], v[200:203], v[76:79]
  ds_write2st64_b32 v5, v84, v85 offset0:17 offset1:21
  v_mfma_f32_16x16x32_bf16 v[76:79], v[68:71], v[216:219], v[76:79]
  s_or_b32 s6, vcc_lo, vcc_hi
  v_cvt_pk_bf16_f32 v96, v96, v60
  v_cvt_pk_bf16_f32 v97, v97, v61
  v_mov_b32 v54, s6
  v_mfma_f32_16x16x32_bf16 v[76:79], v[72:75], v[232:235], v[76:79]
  v_cvt_pk_bf16_f32 v98, v98, v62
  v_cvt_pk_bf16_f32 v99, v99, v63
  v_mfma_f32_16x16x32_bf16 v[76:79], v[120:123], v[248:251], v[76:79]
  buffer_store_dword v96, v7, s[24:27], s34 offen offset:0 nt
  v_mfma_f32_16x16x32_bf16 v[76:79], v[124:127], a[224:227], v[76:79]
  ds_write2st64_b32 v5, v108, v109 offset0:2 offset1:6
  v_mfma_f32_16x16x32_bf16 v[80:83], v[124:127], a[228:231], 0
  ds_write2st64_b32 v5, v116, v117 offset0:10 offset1:14
  v_mfma_f32_16x16x32_bf16 v[80:83], v[120:123], v[252:255], v[80:83]
  buffer_store_dword v97, v7, s[24:27], s34 offen offset:384 nt
  v_mfma_f32_16x16x32_bf16 v[80:83], v[72:75], v[236:239], v[80:83]
  ds_read_b128 a[248:251], v4 offset:512
  ds_read_b128 v[60:63], v4 offset:4608
  v_mfma_f32_16x16x32_bf16 v[80:83], v[68:71], v[220:223], v[80:83]
  ds_write2st64_b32 v5, v104, v105 offset0:18 offset1:22
  v_mfma_f32_16x16x32_bf16 v[80:83], a[252:255], v[204:207], v[80:83]
  buffer_store_dword v98, v7, s[24:27], s34 offen offset:768 nt
  v_mfma_f32_16x16x32_bf16 v[80:83], a[244:247], v[188:191], v[80:83]
  ds_write2st64_b32 v5, v132, v133 offset0:3 offset1:7
  v_mfma_f32_16x16x32_bf16 v[64:67], a[244:247], v[192:195], 0
  ds_write2st64_b32 v5, v136, v137 offset0:11 offset1:15
  v_mfma_f32_16x16x32_bf16 v[64:67], a[252:255], v[208:211], v[64:67]
  buffer_store_dword v99, v7, s[24:27], s34 offen offset:1152 nt
  v_mfma_f32_16x16x32_bf16 v[64:67], v[68:71], v[224:227], v[64:67]
  s_add_u32 s34, s34, s98
  ds_read_b128 v[84:87], v4 offset:8704
  v_cvt_pk_bf16_f32 v76, v76, v80
  v_cvt_pk_bf16_f32 v77, v77, v81
  v_mfma_f32_16x16x32_bf16 v[64:67], v[72:75], v[240:243], v[64:67]
  ds_read_b128 v[92:95], v4 offset:12800
  v_cvt_pk_bf16_f32 v78, v78, v82
  v_cvt_pk_bf16_f32 v79, v79, v83
  v_mfma_f32_16x16x32_bf16 v[64:67], v[120:123], a[216:219], v[64:67]
  buffer_store_dword v76, v7, s[24:27], s35 offen offset:0 nt
  v_mfma_f32_16x16x32_bf16 v[64:67], v[124:127], a[232:235], v[64:67]
  ds_write2st64_b32 v5, v56, v57 offset0:19 offset1:23
  v_mfma_f32_16x16x32_bf16 v[96:99], v[124:127], a[236:239], 0
  ds_read_b128 v[88:91], v4 offset:16896
  ds_write_b32 v11, v54
  v_mfma_f32_16x16x32_bf16 v[96:99], v[120:123], a[220:223], v[96:99]
  buffer_store_dword v77, v7, s[24:27], s35 offen offset:384 nt
  v_mov_b32 v11, 159744
  v_mfma_f32_16x16x32_bf16 v[96:99], v[72:75], v[244:247], v[96:99]
  ds_read_b128 v[100:103], v4 offset:20992
  v_xor_b32 v4, 40960, v4
  v_mfma_f32_16x16x32_bf16 v[96:99], v[68:71], v[228:231], v[96:99]
  v_mfma_f32_16x16x32_bf16 v[96:99], a[252:255], v[212:215], v[96:99]
  buffer_store_dword v78, v7, s[24:27], s35 offen offset:768 nt
  v_mfma_f32_16x16x32_bf16 v[96:99], a[244:247], v[196:199], v[96:99]
  s_waitcnt lgkmcnt(9)
  v_mfma_f32_16x16x32_bf16 v[80:83], a[248:251], v[184:187], 0
  s_waitcnt lgkmcnt(1)
  s_barrier
  v_mfma_f32_16x16x32_bf16 v[80:83], v[60:63], v[200:203], v[80:83]
  buffer_store_dword v79, v7, s[24:27], s35 offen offset:1152 nt
  v_mfma_f32_16x16x32_bf16 v[80:83], v[84:87], v[216:219], v[80:83]
  s_waitcnt lgkmcnt(0)
  v_cvt_pk_bf16_f32 v64, v64, v96
  v_cvt_pk_bf16_f32 v65, v65, v97
  v_mfma_f32_16x16x32_bf16 v[80:83], v[92:95], v[232:235], v[80:83]
  v_cvt_pk_bf16_f32 v66, v66, v98
  v_cvt_pk_bf16_f32 v67, v67, v99
  v_mfma_f32_16x16x32_bf16 v[80:83], v[88:91], v[248:251], v[80:83]
  buffer_store_dword v64, v8, s[24:27], s35 offen offset:0 nt
  v_mfma_f32_16x16x32_bf16 v[80:83], v[100:103], a[224:227], v[80:83]
  ds_read_b128 a[252:255], v3 offset:0
  ds_read_b128 v[56:59], v3 offset:4096
  v_mfma_f32_16x16x32_bf16 v[76:79], v[100:103], a[228:231], 0
  ds_read_b128 v[68:71], v3 offset:8192
  ds_read_b128 v[72:75], v3 offset:12288
  v_mfma_f32_16x16x32_bf16 v[76:79], v[88:91], v[252:255], v[76:79]
  buffer_store_dword v65, v8, s[24:27], s35 offen offset:384 nt
  v_mfma_f32_16x16x32_bf16 v[76:79], v[92:95], v[236:239], v[76:79]
  ds_read_b128 a[244:247], v3 offset:16384
  ds_read_b128 v[88:91], v3 offset:20480
  v_mfma_f32_16x16x32_bf16 v[76:79], v[84:87], v[220:223], v[76:79]
  ds_read2_b32 v[92:93], v11 offset0:0 offset1:2
  ds_read2_b32 v[94:95], v11 offset0:4 offset1:6
  v_mfma_f32_16x16x32_bf16 v[76:79], v[60:63], v[204:207], v[76:79]
  buffer_store_dword v66, v8, s[24:27], s35 offen offset:768 nt
  v_mfma_f32_16x16x32_bf16 v[76:79], a[248:251], v[188:191], v[76:79]
  s_waitcnt lgkmcnt(4)
  v_mfma_f32_16x16x32_bf16 v[60:63], a[252:255], v[184:187], 0
  buffer_store_dword v67, v8, s[24:27], s35 offen offset:1152 nt
  v_mfma_f32_16x16x32_bf16 v[60:63], v[56:59], v[200:203], v[60:63]
  s_add_u32 s35, s35, s98
  v_mfma_f32_16x16x32_bf16 v[60:63], v[68:71], v[216:219], v[60:63]
  s_waitcnt lgkmcnt(0)
  v_cvt_pk_bf16_f32 v80, v80, v76
  v_cvt_pk_bf16_f32 v81, v81, v77
  v_mfma_f32_16x16x32_bf16 v[60:63], v[72:75], v[232:235], v[60:63]
  v_cvt_pk_bf16_f32 v82, v82, v78
  v_cvt_pk_bf16_f32 v83, v83, v79
  v_mfma_f32_16x16x32_bf16 v[60:63], a[244:247], v[248:251], v[60:63]
  buffer_store_dword v80, v7, s[24:27], s36 offen offset:0 nt
  v_mfma_f32_16x16x32_bf16 v[60:63], v[88:91], a[224:227], v[60:63]
  v_or3_b32 v92, v92, v93, v94
  v_or_b32 v92, v92, v95
  v_mfma_f32_16x16x32_bf16 v[64:67], v[88:91], a[228:231], 0
  buffer_store_dword v81, v7, s[24:27], s36 offen offset:384 nt
  v_mfma_f32_16x16x32_bf16 v[64:67], a[244:247], v[252:255], v[64:67]
  v_readfirstlane_b32 s49, v92
  v_mfma_f32_16x16x32_bf16 v[64:67], v[72:75], v[236:239], v[64:67]
  buffer_store_dword v82, v7, s[24:27], s36 offen offset:768 nt
  v_mfma_f32_16x16x32_bf16 v[64:67], v[68:71], v[220:223], v[64:67]
  ds_read_b128 v[76:79], v4 offset:0
  ds_read_b128 v[84:87], v4 offset:4096
  v_mfma_f32_16x16x32_bf16 v[64:67], v[56:59], v[204:207], v[64:67]
  buffer_store_dword v83, v7, s[24:27], s36 offen offset:1152 nt
  v_mfma_f32_16x16x32_bf16 v[64:67], a[252:255], v[188:191], v[64:67]
  s_add_u32 s36, s36, s98
  ds_read_b128 v[92:95], v4 offset:8192
  ds_read_b128 v[96:99], v4 offset:12288
  v_mfma_f32_16x16x32_bf16 v[80:83], a[252:255], v[192:195], 0
  ds_read_b128 v[100:103], v4 offset:16384
  ds_read_b128 v[104:107], v4 offset:20480
  v_mfma_f32_16x16x32_bf16 v[80:83], v[56:59], v[208:211], v[80:83]
L_hop_2_1:
  s_cbranch_execz L_hop_2_2
  v_mfma_f32_16x16x32_bf16 v[80:83], v[68:71], v[224:227], v[80:83]
  v_cvt_pk_bf16_f32 v60, v60, v64
  v_cvt_pk_bf16_f32 v61, v61, v65
  v_mfma_f32_16x16x32_bf16 v[80:83], v[72:75], v[240:243], v[80:83]
  v_cvt_pk_bf16_f32 v62, v62, v66
  v_cvt_pk_bf16_f32 v63, v63, v67
  v_mfma_f32_16x16x32_bf16 v[80:83], a[244:247], a[216:219], v[80:83]
  buffer_store_dword v60, v7, s[24:27], s33 offen offset:0 nt
  v_mfma_f32_16x16x32_bf16 v[80:83], v[88:91], a[232:235], v[80:83]
  v_mfma_f32_16x16x32_bf16 v[108:111], v[88:91], a[236:239], 0
  buffer_store_dword v61, v7, s[24:27], s33 offen offset:384 nt
  v_mfma_f32_16x16x32_bf16 v[108:111], a[244:247], a[220:223], v[108:111]
  v_mfma_f32_16x16x32_bf16 v[108:111], v[72:75], v[244:247], v[108:111]
  buffer_store_dword v62, v7, s[24:27], s33 offen offset:768 nt
  v_mfma_f32_16x16x32_bf16 v[108:111], v[68:71], v[228:231], v[108:111]
  ds_read_b128 a[244:247], v3 offset:512
  ds_read_b128 a[248:251], v3 offset:4608
  v_mfma_f32_16x16x32_bf16 v[108:111], v[56:59], v[212:215], v[108:111]
  buffer_store_dword v63, v7, s[24:27], s33 offen offset:1152 nt
  v_mfma_f32_16x16x32_bf16 v[108:111], a[252:255], v[196:199], v[108:111]
  s_waitcnt lgkmcnt(2)
  ds_read_b128 v[56:59], v3 offset:8704
  ds_read_b128 v[60:63], v3 offset:12800
  v_mfma_f32_16x16x32_bf16 v[88:91], v[76:79], v[184:187], 0
  ds_read_b128 a[252:255], v3 offset:16896
  ds_read_b128 v[64:67], v3 offset:20992
  v_mfma_f32_16x16x32_bf16 v[88:91], v[84:87], v[200:203], v[88:91]
  v_mfma_f32_16x16x32_bf16 v[88:91], v[92:95], v[216:219], v[88:91]
  v_cvt_pk_bf16_f32 v80, v80, v108
  v_cvt_pk_bf16_f32 v81, v81, v109
  v_mfma_f32_16x16x32_bf16 v[88:91], v[96:99], v[232:235], v[88:91]
  v_cvt_pk_bf16_f32 v82, v82, v110
  v_cvt_pk_bf16_f32 v83, v83, v111
  v_mfma_f32_16x16x32_bf16 v[88:91], v[100:103], v[248:251], v[88:91]
  buffer_store_dword v80, v8, s[24:27], s33 offen offset:0 nt
  v_mfma_f32_16x16x32_bf16 v[88:91], v[104:107], a[224:227], v[88:91]
  v_mfma_f32_16x16x32_bf16 v[68:71], v[104:107], a[228:231], 0
  buffer_store_dword v81, v8, s[24:27], s33 offen offset:384 nt
  v_mfma_f32_16x16x32_bf16 v[68:71], v[100:103], v[252:255], v[68:71]
  v_mfma_f32_16x16x32_bf16 v[68:71], v[96:99], v[236:239], v[68:71]
  buffer_store_dword v82, v8, s[24:27], s33 offen offset:768 nt
  v_mfma_f32_16x16x32_bf16 v[68:71], v[92:95], v[220:223], v[68:71]
  v_mfma_f32_16x16x32_bf16 v[68:71], v[84:87], v[204:207], v[68:71]
  buffer_store_dword v83, v8, s[24:27], s33 offen offset:1152 nt
  v_mfma_f32_16x16x32_bf16 v[68:71], v[76:79], v[188:191], v[68:71]
  s_waitcnt lgkmcnt(0)
  v_mfma_f32_16x16x32_bf16 v[84:87], a[244:247], v[184:187], 0
  v_mfma_f32_16x16x32_bf16 v[84:87], a[248:251], v[200:203], v[84:87]
  v_mfma_f32_16x16x32_bf16 v[84:87], v[56:59], v[216:219], v[84:87]
  v_cvt_pk_bf16_f32 v88, v88, v68
  v_cvt_pk_bf16_f32 v89, v89, v69
  v_mfma_f32_16x16x32_bf16 v[84:87], v[60:63], v[232:235], v[84:87]
  v_cvt_pk_bf16_f32 v90, v90, v70
  v_cvt_pk_bf16_f32 v91, v91, v71
  v_mfma_f32_16x16x32_bf16 v[84:87], a[252:255], v[248:251], v[84:87]
  buffer_store_dword v88, v7, s[24:27], s34 offen offset:0 nt
  v_mfma_f32_16x16x32_bf16 v[84:87], v[64:67], a[224:227], v[84:87]
  v_mfma_f32_16x16x32_bf16 v[100:103], v[64:67], a[228:231], 0
  buffer_store_dword v89, v7, s[24:27], s34 offen offset:384 nt
  v_mfma_f32_16x16x32_bf16 v[100:103], a[252:255], v[252:255], v[100:103]
  v_mfma_f32_16x16x32_bf16 v[100:103], v[60:63], v[236:239], v[100:103]
  buffer_store_dword v90, v7, s[24:27], s34 offen offset:768 nt
  v_mfma_f32_16x16x32_bf16 v[100:103], v[56:59], v[220:223], v[100:103]
  ds_read_b128 v[68:71], v4 offset:512
  ds_read_b128 v[72:75], v4 offset:4608
  v_mfma_f32_16x16x32_bf16 v[100:103], a[248:251], v[204:207], v[100:103]
  buffer_store_dword v91, v7, s[24:27], s34 offen offset:1152 nt
  v_mfma_f32_16x16x32_bf16 v[100:103], a[244:247], v[188:191], v[100:103]
  ds_read_b128 v[76:79], v4 offset:8704
  ds_read_b128 v[92:95], v4 offset:12800
  v_mfma_f32_16x16x32_bf16 v[80:83], a[244:247], v[192:195], 0
  ds_read_b128 v[88:91], v4 offset:16896
  ds_read_b128 v[96:99], v4 offset:20992
  v_mfma_f32_16x16x32_bf16 v[80:83], a[248:251], v[208:211], v[80:83]
  v_mfma_f32_16x16x32_bf16 v[80:83], v[56:59], v[224:227], v[80:83]
  v_cvt_pk_bf16_f32 v84, v84, v100
  v_cvt_pk_bf16_f32 v85, v85, v101
  v_mfma_f32_16x16x32_bf16 v[80:83], v[60:63], v[240:243], v[80:83]
  v_cvt_pk_bf16_f32 v86, v86, v102
  v_cvt_pk_bf16_f32 v87, v87, v103
  v_mfma_f32_16x16x32_bf16 v[80:83], a[252:255], a[216:219], v[80:83]
  buffer_store_dword v84, v7, s[24:27], s35 offen offset:0 nt
  v_mfma_f32_16x16x32_bf16 v[80:83], v[64:67], a[232:235], v[80:83]
  v_mfma_f32_16x16x32_bf16 v[100:103], v[64:67], a[236:239], 0
  buffer_store_dword v85, v7, s[24:27], s35 offen offset:384 nt
  v_mfma_f32_16x16x32_bf16 v[100:103], a[252:255], a[220:223], v[100:103]
  v_mfma_f32_16x16x32_bf16 v[100:103], v[60:63], v[244:247], v[100:103]
  buffer_store_dword v86, v7, s[24:27], s35 offen offset:768 nt
  v_mfma_f32_16x16x32_bf16 v[100:103], v[56:59], v[228:231], v[100:103]
  v_mfma_f32_16x16x32_bf16 v[100:103], a[248:251], v[212:215], v[100:103]
  buffer_store_dword v87, v7, s[24:27], s35 offen offset:1152 nt
  v_mfma_f32_16x16x32_bf16 v[100:103], a[244:247], v[196:199], v[100:103]
  s_waitcnt lgkmcnt(0)
  v_mfma_f32_16x16x32_bf16 v[56:59], v[68:71], v[184:187], 0
  v_mfma_f32_16x16x32_bf16 v[56:59], v[72:75], v[200:203], v[56:59]
  v_mfma_f32_16x16x32_bf16 v[56:59], v[76:79], v[216:219], v[56:59]
  v_cvt_pk_bf16_f32 v80, v80, v100
  v_cvt_pk_bf16_f32 v81, v81, v101
  v_mfma_f32_16x16x32_bf16 v[56:59], v[92:95], v[232:235], v[56:59]
  v_cvt_pk_bf16_f32 v82, v82, v102
  v_cvt_pk_bf16_f32 v83, v83, v103
  v_mfma_f32_16x16x32_bf16 v[56:59], v[88:91], v[248:251], v[56:59]
  buffer_store_dword v80, v8, s[24:27], s35 offen offset:0 nt
  v_mfma_f32_16x16x32_bf16 v[56:59], v[96:99], a[224:227], v[56:59]
  v_mfma_f32_16x16x32_bf16 v[60:63], v[96:99], a[228:231], 0
  buffer_store_dword v81, v8, s[24:27], s35 offen offset:384 nt
  v_mfma_f32_16x16x32_bf16 v[60:63], v[88:91], v[252:255], v[60:63]
  v_mfma_f32_16x16x32_bf16 v[60:63], v[92:95], v[236:239], v[60:63]
  buffer_store_dword v82, v8, s[24:27], s35 offen offset:768 nt
  v_mfma_f32_16x16x32_bf16 v[60:63], v[76:79], v[220:223], v[60:63]
  v_mfma_f32_16x16x32_bf16 v[60:63], v[72:75], v[204:207], v[60:63]
  buffer_store_dword v83, v8, s[24:27], s35 offen offset:1152 nt
  v_mfma_f32_16x16x32_bf16 v[60:63], v[68:71], v[188:191], v[60:63]
  s_nop 7
  v_cvt_pk_bf16_f32 v56, v56, v60
  v_cvt_pk_bf16_f32 v57, v57, v61
  v_cvt_pk_bf16_f32 v58, v58, v62
  v_cvt_pk_bf16_f32 v59, v59, v63
  buffer_store_dword v56, v7, s[24:27], s36 offen offset:0 nt
  buffer_store_dword v57, v7, s[24:27], s36 offen offset:384 nt
  buffer_store_dword v58, v7, s[24:27], s36 offen offset:768 nt
  buffer_store_dword v59, v7, s[24:27], s36 offen offset:1152 nt
  s_cmp_lg_u32 s49, 0
  s_cbranch_scc1 L_safe
L_fin:
L_end:
  s_endpgm
L_hop_3_1:
  s_cbranch_execz L_walk
L_pad3771:
L_k7:
  s_cmp_lg_u32 s59, 7
  s_cbranch_scc1 L_kh
  v_mfma_f32_16x16x32_bf16 v[104:107], a[0:3], v[88:91], 0
  s_waitcnt lgkmcnt(0)
  s_sub_u32 s49, s16, s18
  s_sub_u32 s50, s15, s60
  v_mfma_f32_16x16x32_bf16 v[104:107], a[12:15], v[92:95], v[104:107]
  s_add_u32 s50, s50, 45360
  s_mul_i32 s49, s49, s50
  s_mul_hi_u32 s49, s49, 415817
  v_mfma_f32_16x16x32_bf16 v[104:107], a[24:27], v[96:99], v[104:107]
  s_add_u32 s49, s49, s16
  v_cvt_pk_bf16_f32 v66, v128, v129
  v_cvt_pk_bf16_f32 v67, v130, v131
  v_mfma_f32_16x16x32_bf16 v[104:107], a[36:39], v[136:139], v[104:107]
  s_and_b32 s51, s2, 7
  s_lshl_b32 s51, s51, 3
  v_and_b32 v74, 56, v11
  v_mfma_f32_16x16x32_bf16 v[104:107], a[48:51], v[140:143], v[104:107]
  v_lshl_add_u32 v54, v74, 3, s51
  s_lshl_b32 s51, s51, 3
  v_mfma_f32_16x16x32_bf16 v[104:107], a[60:63], v[80:83], v[104:107]
  v_add_u32 v55, s51, v74
  v_mov_b32 v74, s49
  v_mfma_f32_16x16x32_bf16 v[84:87], a[64:67], v[80:83], 0
  buffer_store_dword v74, v54, s[20:23], s44 offen sc1
  v_mfma_f32_16x16x32_bf16 v[84:87], a[52:55], v[140:143], v[84:87]
  v_mfma_f32_16x16x32_bf16 v[84:87], a[40:43], v[136:139], v[84:87]
  v_mul_f32 v104, s42, v104
  v_mul_f32 v105, s42, v105
  v_mfma_f32_16x16x32_bf16 v[84:87], a[28:31], v[96:99], v[84:87]
  v_mul_f32 v106, s42, v106
  v_mul_f32 v107, s42, v107
  v_mfma_f32_16x16x32_bf16 v[84:87], a[16:19], v[92:95], v[84:87]
  v_cvt_pk_bf16_f32 v18, v104, v105
  v_cvt_pk_bf16_f32 v19, v106, v107
  v_mfma_f32_16x16x32_bf16 v[84:87], a[4:7], v[88:91], v[84:87]
  buffer_store_dword v74, v55, s[20:23], s44 offen offset:4 sc1
  v_mfma_f32_16x16x32_bf16 v[108:111], a[8:11], v[88:91], 0
  s_branch L_r220
L_k2:
  s_cmp_lg_u32 s59, 10
  s_cbranch_scc1 L_k7
  s_waitcnt vmcnt(30)
  v_mfma_f32_16x16x32_bf16 v[104:107], a[0:3], v[88:91], 0
  s_sub_u32 s49, s19, s18
  s_sub_u32 s50, s15, s99
  s_add_u32 s50, s50, 45360
  v_mfma_f32_16x16x32_bf16 v[104:107], a[12:15], v[92:95], v[104:107]
  s_mul_i32 s49, s49, s50
  s_mul_hi_u32 s49, s49, 415817
  s_add_u32 s49, s49, s19
  v_mfma_f32_16x16x32_bf16 v[104:107], a[24:27], v[96:99], v[104:107]
  s_and_b32 s50, s2, 7
  v_cvt_pk_bf16_f32 v66, v128, v129
  v_cvt_pk_bf16_f32 v67, v130, v131
  v_mfma_f32_16x16x32_bf16 v[104:107], a[36:39], v[136:139], v[104:107]
  s_sub_u32 s49, s49, 1024
  v_subrev_u32 v54, s49, v52
  v_subrev_u32 v55, s49, v53
  v_mfma_f32_16x16x32_bf16 v[104:107], a[48:51], v[140:143], v[104:107]
  s_waitcnt lgkmcnt(0)
  v_max_u32 v116, v54, v55
  v_bfe_u32 v74, v11, 3, 3
  v_mfma_f32_16x16x32_bf16 v[104:107], a[60:63], v[80:83], v[104:107]
  v_lshrrev_b32 v75, 6, v11
  v_lshl_add_u32 v54, v54, 3, v74
  v_mfma_f32_16x16x32_bf16 v[84:87], a[64:67], v[80:83], 0
  v_lshl_add_u32 v55, v55, 3, v75
  v_mfma_f32_16x16x32_bf16 v[84:87], a[52:55], v[140:143], v[84:87]
  v_readlane_b32 s12, v52, s50
  v_cmp_lt_u32 vcc, 2047, v116
  v_mfma_f32_16x16x32_bf16 v[84:87], a[40:43], v[136:139], v[84:87]
  v_mul_f32 v104, s42, v104
  v_mul_f32 v105, s42, v105
  v_mfma_f32_16x16x32_bf16 v[84:87], a[28:31], v[96:99], v[84:87]
  v_mul_f32 v106, s42, v106
  v_mul_f32 v107, s42, v107
  v_mfma_f32_16x16x32_bf16 v[84:87], a[16:19], v[92:95], v[84:87]
  v_cvt_pk_bf16_f32 v18, v104, v105
  v_cvt_pk_bf16_f32 v19, v106, v107
  v_mfma_f32_16x16x32_bf16 v[84:87], a[4:7], v[88:91], v[84:87]
  v_and_b32 v116, 56, v11
  v_mfma_f32_16x16x32_bf16 v[108:111], a[8:11], v[88:91], 0
  s_or_b32 s51, vcc_lo, vcc_hi
  v_cmp_lt_u32 vcc, v54, v55
  v_mfma_f32_16x16x32_bf16 v[108:111], a[20:23], v[92:95], v[108:111]
  s_sub_u32 s52, s12, s49
  s_sub_u32 s52, s52, 960
  s_lshr_b32 s52, s52, 7
  v_mfma_f32_16x16x32_bf16 v[108:111], a[32:35], v[96:99], v[108:111]
  s_or_b32 s51, s51, s52
  v_mul_f32 v84, s42, v84
  v_mul_f32 v85, s42, v85
  v_mfma_f32_16x16x32_bf16 v[108:111], a[44:47], v[136:139], v[108:111]
  v_mul_f32 v86, s42, v86
  v_mul_f32 v87, s42, v87
  v_mfma_f32_16x16x32_bf16 v[108:111], a[56:59], v[140:143], v[108:111]
  v_cvt_pk_bf16_f32 v104, v84, v85
  v_cvt_pk_bf16_f32 v105, v86, v87
  v_mfma_f32_16x16x32_bf16 v[108:111], a[68:71], v[80:83], v[108:111]
  v_lshrrev_b64 v[74:75], v116, vcc
  v_and_b32 v55, 0xff, v74
  v_mfma_f32_16x16x32_bf16 v[112:115], a[132:135], v[80:83], 0
  v_bcnt_u32_b32 v55, v55, 0
  v_mfma_f32_16x16x32_bf16 v[112:115], a[120:123], v[140:143], v[112:115]
  v_readlane_b32 s52, v55, s50
  v_mfma_f32_16x16x32_bf16 v[112:115], a[108:111], v[136:139], v[112:115]
  v_mul_f32 v108, s42, v108
  v_mul_f32 v109, s42, v109
  v_mfma_f32_16x16x32_bf16 v[112:115], a[96:99], v[96:99], v[112:115]
  s_sub_u32 s52, 7, s52
  v_mul_f32 v110, s42, v110
  v_mul_f32 v111, s42, v111
  v_mfma_f32_16x16x32_bf16 v[112:115], a[84:87], v[92:95], v[112:115]
  v_cvt_pk_bf16_f32 v106, v108, v109
  v_cvt_pk_bf16_f32 v107, v110, v111
  v_mfma_f32_16x16x32_bf16 v[112:115], a[72:75], v[88:91], v[112:115]
  v_cmp_eq_u32 vcc, s52, v55
  v_mfma_f32_16x16x32_bf16 v[84:87], a[76:79], v[88:91], 0
  v_mfma_f32_16x16x32_bf16 v[84:87], a[88:91], v[92:95], v[84:87]
  s_ff1_i32_b32 s52, vcc_lo
  s_and_b32 s52, s52, 7
  v_readlane_b32 s53, v54, s52
  v_mfma_f32_16x16x32_bf16 v[84:87], a[100:103], v[96:99], v[84:87]
  v_cvt_pk_bf16_f32 v128, v112, v113
  v_cvt_pk_bf16_f32 v129, v114, v115
  v_mfma_f32_16x16x32_bf16 v[84:87], a[112:115], v[136:139], v[84:87]
  s_lshr_b32 s53, s53, 3
  s_add_u32 s53, s53, s49
  s_sub_u32 s49, s53, s12
  v_mfma_f32_16x16x32_bf16 v[84:87], a[124:127], v[140:143], v[84:87]
  s_cmp_gt_i32 s49, 0
  s_cselect_b32 s45, 2, 1
  s_cselect_b32 s12, s53, s12
  v_mfma_f32_16x16x32_bf16 v[84:87], a[136:139], v[80:83], v[84:87]
  s_cselect_b32 s53, s52, s50
  s_cselect_b32 s96, 1, 6
  s_lshl_b32 s96, s96, 11
  v_mfma_f32_16x16x32_bf16 v[108:111], a[140:143], v[80:83], 0
  s_abs_i32 s49, s49
  s_cmp_lt_u32 s49, 235
  s_cselect_b32 s51, 1, s51
  v_mfma_f32_16x16x32_bf16 v[108:111], a[128:131], v[140:143], v[108:111]
  s_cmp_lt_u32 s49, 400
  s_cselect_b32 s14, 8, 0
  s_xnor_b32 s13, s12, s14
  v_mfma_f32_16x16x32_bf16 v[108:111], a[116:119], v[136:139], v[108:111]
  s_cmp_eq_u32 s51, 0
  v_cvt_pk_bf16_f32 v130, v84, v85
  v_cvt_pk_bf16_f32 v131, v86, v87
  v_mfma_f32_16x16x32_bf16 v[108:111], a[104:107], v[96:99], v[108:111]
  s_cselect_b32 s45, s45, 0
  s_cselect_b32 s96, s96, 0
  s_bitset1_b32 s96, 14
  v_mfma_f32_16x16x32_bf16 v[108:111], a[92:95], v[92:95], v[108:111]
  s_andn2_b32 s51, s2, 7
  s_add_u32 s51, s51, s53
  s_lshl_b32 s51, s51, 9
  v_mfma_f32_16x16x32_bf16 v[108:111], a[80:83], v[88:91], v[108:111]
  s_add_u32 s44, s51, 2097152
  s_lshr_b32 s49, s45, 1
  s_lshl_b32 s49, s49, s52
  v_mfma_f32_16x16x32_bf16 v[84:87], v[88:91], a[144:147], 0
  s_lshl_b32 s49, s49, s14
  s_lshl_b32 s54, s3, 2
  s_add_u32 s54, s54, 159808
  v_mfma_f32_16x16x32_bf16 v[84:87], v[92:95], a[156:159], v[84:87]
  ds_read_b128 a[244:247], v1 offset:22528
  v_mov_b32 v54, s54
  v_mfma_f32_16x16x32_bf16 v[84:87], v[96:99], a[168:171], v[84:87]
  v_cvt_pk_bf16_f32 v132, v108, v109
  v_cvt_pk_bf16_f32 v133, v110, v111
  v_mfma_f32_16x16x32_bf16 v[84:87], v[136:139], a[180:183], v[84:87]
  ds_read_b128 a[248:251], v0 offset:22528
  v_mov_b32 v55, s49
  v_mfma_f32_16x16x32_bf16 v[84:87], v[140:143], a[192:195], v[84:87]
  ds_read_b128 a[252:255], v1 offset:14336
  v_mfma_f32_16x16x32_bf16 v[84:87], v[80:83], a[204:207], v[84:87]
  ds_read_b128 v[144:147], v0 offset:14336
  v_mfma_f32_16x16x32_bf16 v[116:119], v[80:83], a[208:211], 0
  ds_read_b128 v[148:151], v1 offset:6144
  v_mfma_f32_16x16x32_bf16 v[116:119], v[140:143], a[196:199], v[116:119]
  ds_read_b128 v[152:155], v0 offset:6144
  v_mfma_f32_16x16x32_bf16 v[116:119], v[136:139], a[184:187], v[116:119]
  v_cvt_pk_bf16_f32 v108, v84, v85
  v_cvt_pk_bf16_f32 v109, v86, v87
  v_mfma_f32_16x16x32_bf16 v[116:119], v[96:99], a[172:175], v[116:119]
  ds_write_b32 v54, v55
  v_mfma_f32_16x16x32_bf16 v[116:119], v[92:95], a[160:163], v[116:119]
  v_mfma_f32_16x16x32_bf16 v[116:119], v[88:91], a[148:151], v[116:119]
  v_mfma_f32_16x16x32_bf16 v[156:159], v[88:91], a[152:155], 0
  v_mfma_f32_16x16x32_bf16 v[156:159], v[92:95], a[164:167], v[156:159]
  s_waitcnt lgkmcnt(0)
  v_mfma_f32_16x16x32_bf16 v[156:159], v[96:99], a[176:179], v[156:159]
  v_cvt_pk_bf16_f32 v112, v116, v117
  v_cvt_pk_bf16_f32 v113, v118, v119
  v_mfma_f32_16x16x32_bf16 v[156:159], v[136:139], a[188:191], v[156:159]
  s_branch L_r259
L_hop_0_2:
  s_cbranch_execz L_walk
L_pad3972:
L_kh:
  s_cmp_lt_u32 s59, 14
  s_cbranch_scc1 L_k11
  v_mfma_f32_16x16x32_bf16 v[104:107], a[76:79], v[88:91], 0
  s_lshl_b32 s5, s3, 3
  v_mfma_f32_16x16x32_bf16 v[104:107], a[88:91], v[92:95], v[104:107]
  s_add_u32 s5, s5, 159744
  v_mov_b32 v11, s5
  v_mfma_f32_16x16x32_bf16 v[104:107], a[100:103], v[96:99], v[104:107]
  v_cvt_pk_bf16_f32 v66, v128, v129
  v_cvt_pk_bf16_f32 v67, v130, v131
  v_mfma_f32_16x16x32_bf16 v[104:107], a[112:115], v[136:139], v[104:107]
  ds_read_b128 a[244:247], v1 offset:22528
  v_mfma_f32_16x16x32_bf16 v[104:107], a[124:127], v[140:143], v[104:107]
  ds_read_b128 a[248:251], v0 offset:22528
  s_waitcnt lgkmcnt(2)
  v_mfma_f32_16x16x32_bf16 v[104:107], a[136:139], v[80:83], v[104:107]
  ds_read_b128 a[252:255], v1 offset:14336
  v_mfma_f32_16x16x32_bf16 v[108:111], a[132:135], v[80:83], 0
  ds_read_b128 v[84:87], v0 offset:14336
  v_mfma_f32_16x16x32_bf16 v[108:111], a[120:123], v[140:143], v[108:111]
  ds_read_b128 v[128:131], v1 offset:6144
  v_mfma_f32_16x16x32_bf16 v[108:111], a[108:111], v[136:139], v[108:111]
  v_cvt_pk_bf16_f32 v146, v104, v105
  v_cvt_pk_bf16_f32 v147, v106, v107
  v_mfma_f32_16x16x32_bf16 v[108:111], a[96:99], v[96:99], v[108:111]
  ds_read_b128 v[132:135], v0 offset:6144
  v_cndmask_b32 v160, v32, v48, s[100:101]
  v_mfma_f32_16x16x32_bf16 v[108:111], a[84:87], v[92:95], v[108:111]
  v_cndmask_b32 v161, v33, v49, s[100:101]
  v_cndmask_b32 v162, v34, v50, s[100:101]
  v_mfma_f32_16x16x32_bf16 v[108:111], a[72:75], v[88:91], v[108:111]
  v_cndmask_b32 v163, v35, v51, s[100:101]
  v_cndmask_b32 v164, v28, v44, s[100:101]
  v_mfma_f32_16x16x32_bf16 v[112:115], a[140:143], v[80:83], 0
  v_cndmask_b32 v165, v29, v45, s[100:101]
  v_cndmask_b32 v166, v30, v46, s[100:101]
  v_mfma_f32_16x16x32_bf16 v[112:115], a[128:131], v[140:143], v[112:115]
  v_cndmask_b32 v167, v31, v47, s[100:101]
  v_cndmask_b32 v104, v24, v40, s[100:101]
  v_mfma_f32_16x16x32_bf16 v[112:115], a[116:119], v[136:139], v[112:115]
  v_cvt_pk_bf16_f32 v144, v108, v109
  v_cvt_pk_bf16_f32 v145, v110, v111
  v_mfma_f32_16x16x32_bf16 v[112:115], a[104:107], v[96:99], v[112:115]
  v_cndmask_b32 v105, v25, v41, s[100:101]
  v_cndmask_b32 v106, v26, v42, s[100:101]
  v_mfma_f32_16x16x32_bf16 v[112:115], a[92:95], v[92:95], v[112:115]
  v_cndmask_b32 v107, v27, v43, s[100:101]
  v_mfma_f32_16x16x32_bf16 v[112:115], a[80:83], v[88:91], v[112:115]
  s_waitcnt lgkmcnt(0)
  v_mfma_f32_16x16x32_bf16 v[108:111], a[132:135], a[244:247], 0
  v_mfma_f32_16x16x32_bf16 v[108:111], a[120:123], a[248:251], v[108:111]
  v_mfma_f32_16x16x32_bf16 v[108:111], a[108:111], a[252:255], v[108:111]
  v_cvt_pk_bf16_f32 v148, v112, v113
  v_cvt_pk_bf16_f32 v149, v114, v115
  v_mfma_f32_16x16x32_bf16 v[108:111], a[96:99], v[84:87], v[108:111]
  v_mfma_f32_16x16x32_bf16 v[108:111], a[84:87], v[128:131], v[108:111]
  s_waitcnt lgkmcnt(0)
  s_barrier
  v_mfma_f32_16x16x32_bf16 v[108:111], a[72:75], v[132:135], v[108:111]
  v_mfma_f32_16x16x32_bf16 v[112:115], a[76:79], v[132:135], 0
  v_mfma_f32_16x16x32_bf16 v[112:115], a[88:91], v[128:131], v[112:115]
  v_mfma_f32_16x16x32_bf16 v[112:115], a[100:103], v[84:87], v[112:115]
  v_cvt_pk_bf16_f32 v152, v108, v109
  v_cvt_pk_bf16_f32 v153, v110, v111
  v_mfma_f32_16x16x32_bf16 v[112:115], a[112:115], a[252:255], v[112:115]
  v_mfma_f32_16x16x32_bf16 v[112:115], a[124:127], a[248:251], v[112:115]
  v_mfma_f32_16x16x32_bf16 v[112:115], a[136:139], a[244:247], v[112:115]
  v_mfma_f32_16x16x32_bf16 v[108:111], a[140:143], a[244:247], 0
  v_mfma_f32_16x16x32_bf16 v[108:111], a[128:131], a[248:251], v[108:111]
  v_mfma_f32_16x16x32_bf16 v[108:111], a[116:119], a[252:255], v[108:111]
  v_cvt_pk_bf16_f32 v154, v112, v113
  v_cvt_pk_bf16_f32 v155, v114, v115
  v_mfma_f32_16x16x32_bf16 v[108:111], a[104:107], v[84:87], v[108:111]
  v_mfma_f32_16x16x32_bf16 v[108:111], a[92:95], v[128:131], v[108:111]
  v_mfma_f32_16x16x32_bf16 v[108:111], a[80:83], v[132:135], v[108:111]
  v_mfma_f32_16x16x32_bf16 v[112:115], v[70:73], v[76:79], v[36:39]
  v_mfma_f32_16x16x32_bf16 v[112:115], v[68:71], v[12:15], v[112:115]
  v_mfma_f32_16x16x32_bf16 v[116:119], v[122:125], v[76:79], v[32:35]
  v_cvt_pk_bf16_f32 v156, v108, v109
  v_cvt_pk_bf16_f32 v157, v110, v111
  v_mfma_f32_16x16x32_bf16 v[116:119], v[120:123], v[12:15], v[116:119]
  v_mfma_f32_16x16x32_bf16 v[168:171], v[146:149], v[76:79], v[164:167]
  v_exp_f32 v112, v112
  v_mfma_f32_16x16x32_bf16 v[168:171], v[144:147], v[12:15], v[168:171]
  v_exp_f32 v113, v113
  v_mfma_f32_16x16x32_bf16 v[172:175], v[154:157], v[76:79], v[104:107]
  v_exp_f32 v114, v114
  v_mfma_f32_16x16x32_bf16 v[172:175], v[152:155], v[12:15], v[172:175]
  v_exp_f32 v115, v115
  v_mfma_f32_16x16x32_bf16 v[104:107], v[68:71], v[100:103], v[40:43]
  v_exp_f32 v116, v116
  v_mfma_f32_16x16x32_bf16 v[104:107], v[70:73], v[14:17], v[104:107]
  v_exp_f32 v117, v117
  v_mfma_f32_16x16x32_bf16 v[108:111], v[120:123], v[100:103], v[36:39]
  v_exp_f32 v118, v118
  v_mfma_f32_16x16x32_bf16 v[108:111], v[122:125], v[14:17], v[108:111]
  v_exp_f32 v119, v119
  v_mfma_f32_16x16x32_bf16 v[72:75], v[144:147], v[100:103], v[160:163]
  v_exp_f32 v168, v168
  v_mfma_f32_16x16x32_bf16 v[72:75], v[146:149], v[14:17], v[72:75]
  v_exp_f32 v169, v169
  v_mfma_f32_16x16x32_bf16 v[68:71], v[152:155], v[100:103], v[164:167]
  v_exp_f32 v170, v170
  v_mfma_f32_16x16x32_bf16 v[68:71], v[154:157], v[14:17], v[68:71]
  v_exp_f32 v171, v171
  v_mfma_f32_16x16x32_bf16 v[76:79], v[88:91], a[144:147], 0
  v_exp_f32 v172, v172
  v_mfma_f32_16x16x32_bf16 v[76:79], v[92:95], a[156:159], v[76:79]
  v_exp_f32 v173, v173
  v_mfma_f32_16x16x32_bf16 v[76:79], v[96:99], a[168:171], v[76:79]
  v_exp_f32 v174, v174
  v_mfma_f32_16x16x32_bf16 v[76:79], v[136:139], a[180:183], v[76:79]
  v_exp_f32 v175, v175
  v_mfma_f32_16x16x32_bf16 v[76:79], v[140:143], a[192:195], v[76:79]
  v_cvt_pk_bf16_f32 v112, v112, v113
  v_cvt_pk_bf16_f32 v113, v114, v115
  v_mfma_f32_16x16x32_bf16 v[76:79], v[80:83], a[204:207], v[76:79]
  v_cvt_pk_bf16_f32 v114, v116, v117
  v_cvt_pk_bf16_f32 v115, v118, v119
  v_mfma_f32_16x16x32_bf16 v[100:103], v[80:83], a[208:211], 0
  v_cvt_pk_bf16_f32 v116, v168, v169
  v_cvt_pk_bf16_f32 v117, v170, v171
  v_mfma_f32_16x16x32_bf16 v[100:103], v[140:143], a[196:199], v[100:103]
  v_cvt_pk_bf16_f32 v118, v172, v173
  v_cvt_pk_bf16_f32 v119, v174, v175
  v_mfma_f32_16x16x32_bf16 v[100:103], v[136:139], a[184:187], v[100:103]
  v_cvt_pk_bf16_f32 v144, v76, v77
  v_cvt_pk_bf16_f32 v145, v78, v79
  v_mfma_f32_16x16x32_bf16 v[100:103], v[96:99], a[172:175], v[100:103]
  v_exp_f32 v104, v104
  v_mfma_f32_16x16x32_bf16 v[100:103], v[92:95], a[160:163], v[100:103]
  v_exp_f32 v105, v105
  v_mfma_f32_16x16x32_bf16 v[100:103], v[88:91], a[148:151], v[100:103]
  v_exp_f32 v106, v106
  v_mfma_f32_16x16x32_bf16 v[120:123], v[88:91], a[152:155], 0
  v_exp_f32 v107, v107
  v_mfma_f32_16x16x32_bf16 v[120:123], v[92:95], a[164:167], v[120:123]
  v_exp_f32 v108, v108
  v_mfma_f32_16x16x32_bf16 v[120:123], v[96:99], a[176:179], v[120:123]
  v_cvt_pk_bf16_f32 v148, v100, v101
  v_cvt_pk_bf16_f32 v149, v102, v103
  v_mfma_f32_16x16x32_bf16 v[120:123], v[136:139], a[188:191], v[120:123]
  v_exp_f32 v109, v109
  v_mfma_f32_16x16x32_bf16 v[120:123], v[140:143], a[200:203], v[120:123]
  v_exp_f32 v110, v110
  v_mfma_f32_16x16x32_bf16 v[120:123], v[80:83], a[212:215], v[120:123]
  v_exp_f32 v111, v111
  v_mfma_f32_16x16x32_bf16 v[76:79], v[132:135], a[144:147], 0
  v_exp_f32 v72, v72
  v_mfma_f32_16x16x32_bf16 v[76:79], v[128:131], a[156:159], v[76:79]
  v_exp_f32 v73, v73
  v_mfma_f32_16x16x32_bf16 v[76:79], v[84:87], a[168:171], v[76:79]
  v_cvt_pk_bf16_f32 v140, v120, v121
  v_cvt_pk_bf16_f32 v141, v122, v123
  v_mfma_f32_16x16x32_bf16 v[76:79], a[252:255], a[180:183], v[76:79]
  ds_read_b128 v[88:91], v3 offset:0
  v_cvt_pk_bf16_f32 v104, v104, v105
  v_mfma_f32_16x16x32_bf16 v[76:79], a[248:251], a[192:195], v[76:79]
  ds_read_b128 v[92:95], v3 offset:4096
  v_cvt_pk_bf16_f32 v105, v106, v107
  v_mfma_f32_16x16x32_bf16 v[76:79], a[244:247], a[204:207], v[76:79]
  ds_read_b128 v[100:103], v3 offset:8192
  v_cvt_pk_bf16_f32 v106, v108, v109
  v_mfma_f32_16x16x32_bf16 v[80:83], a[244:247], a[208:211], 0
  ds_read_b128 v[120:123], v3 offset:12288
  v_cvt_pk_bf16_f32 v107, v110, v111
  v_mfma_f32_16x16x32_bf16 v[80:83], a[248:251], a[196:199], v[80:83]
  ds_read_b128 v[124:127], v3 offset:16384
  v_cvt_pk_bf16_f32 v108, v72, v73
  v_mfma_f32_16x16x32_bf16 v[80:83], a[252:255], a[184:187], v[80:83]
  v_cvt_pk_bf16_f32 v146, v76, v77
  v_cvt_pk_bf16_f32 v147, v78, v79
  v_mfma_f32_16x16x32_bf16 v[80:83], v[84:87], a[172:175], v[80:83]
  ds_read_b128 v[136:139], v3 offset:20480
  v_mfma_f32_16x16x32_bf16 v[80:83], v[128:131], a[160:163], v[80:83]
  v_exp_f32 v74, v74
  v_mfma_f32_16x16x32_bf16 v[80:83], v[132:135], a[148:151], v[80:83]
  v_exp_f32 v75, v75
  v_mfma_f32_16x16x32_bf16 v[76:79], v[132:135], a[152:155], 0
  v_exp_f32 v68, v68
  v_mfma_f32_16x16x32_bf16 v[76:79], v[128:131], a[164:167], v[76:79]
  v_exp_f32 v69, v69
  v_mfma_f32_16x16x32_bf16 v[76:79], v[84:87], a[176:179], v[76:79]
  v_cvt_pk_bf16_f32 v150, v80, v81
  v_cvt_pk_bf16_f32 v151, v82, v83
  v_mfma_f32_16x16x32_bf16 v[76:79], a[252:255], a[188:191], v[76:79]
  v_mov_b64 v[132:133], 0
  v_cvt_pk_bf16_f32 v109, v74, v75
  v_mfma_f32_16x16x32_bf16 v[76:79], a[248:251], a[200:203], v[76:79]
  v_exp_f32 v70, v70
  v_mfma_f32_16x16x32_bf16 v[76:79], a[244:247], a[212:215], v[76:79]
  s_waitcnt lgkmcnt(0)
  v_exp_f32 v71, v71
  v_mfma_f32_16x16x32_bf16 v[128:131], v[88:91], v[184:187], 0
  v_cvt_pk_bf16_f32 v110, v68, v69
  v_cvt_pk_bf16_f32 v111, v70, v71
  v_mfma_f32_16x16x32_bf16 v[128:131], v[92:95], v[200:203], v[128:131]
  v_mfma_f32_16x16x32_bf16 v[128:131], v[100:103], v[216:219], v[128:131]
  v_cvt_pk_bf16_f32 v142, v76, v77
  v_cvt_pk_bf16_f32 v143, v78, v79
  v_mfma_f32_16x16x32_bf16 v[128:131], v[120:123], v[232:235], v[128:131]
  v_mov_b64 v[96:97], 0
  v_mfma_f32_16x16x32_bf16 v[128:131], v[124:127], v[248:251], v[128:131]
  v_mfma_f32_16x16x32_bf16 v[128:131], v[136:139], a[224:227], v[128:131]
  v_smfmac_f32_16x16x64_bf16 v[132:135], a[240:243], v[112:119], v10
  v_mfma_f32_16x16x32_bf16 v[76:79], v[144:147], v[116:119], 0
  v_mfma_f32_16x16x32_bf16 v[76:79], v[56:59], v[112:115], v[76:79]
  v_mfma_f32_16x16x32_bf16 v[80:83], v[60:63], v[112:115], 0
  v_mfma_f32_16x16x32_bf16 v[80:83], v[148:151], v[116:119], v[80:83]
  v_mfma_f32_16x16x32_bf16 v[68:71], v[140:143], v[116:119], 0
  v_add_f32 v132, v132, v133
  v_mfma_f32_16x16x32_bf16 v[68:71], v[64:67], v[112:115], v[68:71]
  v_rcp_f32 v134, v132
  v_smfmac_f32_16x16x64_bf16 v[96:99], a[240:243], v[104:111], v10
  v_max3_f32 v9, v132, v134, v9
  v_mul_f32 v76, v134, v76
  v_mfma_f32_16x16x32_bf16 v[72:75], v[144:147], v[108:111], 0
  v_mul_f32 v77, v134, v77
  v_mul_f32 v78, v134, v78
  v_mfma_f32_16x16x32_bf16 v[72:75], v[56:59], v[104:107], v[72:75]
  v_mul_f32 v79, v134, v79
  v_cvt_pk_bf16_f32 v76, v76, v77
  v_mfma_f32_16x16x32_bf16 v[84:87], v[60:63], v[104:107], 0
  v_cvt_pk_bf16_f32 v77, v78, v79
  v_mul_f32 v80, v134, v80
  v_mfma_f32_16x16x32_bf16 v[84:87], v[148:151], v[108:111], v[84:87]
  v_mul_f32 v81, v134, v81
  v_mul_f32 v82, v134, v82
  v_mfma_f32_16x16x32_bf16 v[56:59], v[140:143], v[108:111], 0
  v_add_f32 v96, v96, v97
  v_mul_f32 v83, v134, v83
  v_mfma_f32_16x16x32_bf16 v[56:59], v[64:67], v[104:107], v[56:59]
  v_rcp_f32 v98, v96
  v_mfma_f32_16x16x32_bf16 v[60:63], v[136:139], a[228:231], 0
  v_cvt_pk_bf16_f32 v80, v80, v81
  v_cvt_pk_bf16_f32 v81, v82, v83
  v_mfma_f32_16x16x32_bf16 v[60:63], v[124:127], v[252:255], v[60:63]
  v_mul_f32 v68, v134, v68
  v_mul_f32 v69, v134, v69
  v_mfma_f32_16x16x32_bf16 v[60:63], v[120:123], v[236:239], v[60:63]
  ds_read_b128 v[104:107], v4 offset:0
  ds_read_b128 v[108:111], v4 offset:4096
  v_mfma_f32_16x16x32_bf16 v[60:63], v[100:103], v[220:223], v[60:63]
  ds_read_b128 v[116:119], v4 offset:8192
  ds_read_b128 v[140:143], v4 offset:12288
  v_mfma_f32_16x16x32_bf16 v[60:63], v[92:95], v[204:207], v[60:63]
  ds_read_b128 v[144:147], v4 offset:16384
  ds_read_b128 v[148:151], v4 offset:20480
  v_mfma_f32_16x16x32_bf16 v[60:63], v[88:91], v[188:191], v[60:63]
  v_mul_f32 v70, v134, v70
  v_mul_f32 v71, v134, v71
  v_mfma_f32_16x16x32_bf16 v[112:115], v[88:91], v[192:195], 0
  v_cvt_pk_bf16_f32 v68, v68, v69
  v_cvt_pk_bf16_f32 v69, v70, v71
  v_mfma_f32_16x16x32_bf16 v[112:115], v[92:95], v[208:211], v[112:115]
  v_max3_f32 v9, v96, v98, v9
  v_mul_f32 v72, v98, v72
  v_mfma_f32_16x16x32_bf16 v[112:115], v[100:103], v[224:227], v[112:115]
  v_cvt_pk_bf16_f32 v128, v128, v60
  v_cvt_pk_bf16_f32 v129, v129, v61
  v_mfma_f32_16x16x32_bf16 v[112:115], v[120:123], v[240:243], v[112:115]
  v_cvt_pk_bf16_f32 v130, v130, v62
  v_cvt_pk_bf16_f32 v131, v131, v63
  v_mfma_f32_16x16x32_bf16 v[112:115], v[124:127], a[216:219], v[112:115]
L_hop_1_2:
  s_cbranch_execz L_walk
  buffer_store_dword v128, v7, s[24:27], s33 offen offset:0 nt
  v_mfma_f32_16x16x32_bf16 v[112:115], v[136:139], a[232:235], v[112:115]
  v_mul_f32 v73, v98, v73
  v_mul_f32 v74, v98, v74
  v_mfma_f32_16x16x32_bf16 v[132:135], v[136:139], a[236:239], 0
  v_mul_f32 v75, v98, v75
  v_cvt_pk_bf16_f32 v72, v72, v73
  v_mfma_f32_16x16x32_bf16 v[132:135], v[124:127], a[220:223], v[132:135]
  buffer_store_dword v129, v7, s[24:27], s33 offen offset:384 nt
  v_mfma_f32_16x16x32_bf16 v[132:135], v[120:123], v[244:247], v[132:135]
  ds_read_b128 a[244:247], v3 offset:512
  ds_read_b128 a[248:251], v3 offset:4608
  v_mfma_f32_16x16x32_bf16 v[132:135], v[100:103], v[228:231], v[132:135]
  ds_read_b128 a[252:255], v3 offset:8704
  ds_read_b128 v[60:63], v3 offset:12800
  v_mfma_f32_16x16x32_bf16 v[132:135], v[92:95], v[212:215], v[132:135]
  buffer_store_dword v130, v7, s[24:27], s33 offen offset:768 nt
  v_mfma_f32_16x16x32_bf16 v[132:135], v[88:91], v[196:199], v[132:135]
  s_waitcnt lgkmcnt(4)
  ds_read_b128 v[64:67], v3 offset:16896
  ds_read_b128 v[92:95], v3 offset:20992
  v_mfma_f32_16x16x32_bf16 v[88:91], v[104:107], v[184:187], 0
  v_cvt_pk_bf16_f32 v73, v74, v75
  v_mul_f32 v84, v98, v84
  v_mfma_f32_16x16x32_bf16 v[88:91], v[108:111], v[200:203], v[88:91]
  buffer_store_dword v131, v7, s[24:27], s33 offen offset:1152 nt
  v_mfma_f32_16x16x32_bf16 v[88:91], v[116:119], v[216:219], v[88:91]
  v_cvt_pk_bf16_f32 v112, v112, v132
  v_cvt_pk_bf16_f32 v113, v113, v133
  v_mfma_f32_16x16x32_bf16 v[88:91], v[140:143], v[232:235], v[88:91]
  v_cvt_pk_bf16_f32 v114, v114, v134
  v_cvt_pk_bf16_f32 v115, v115, v135
  v_mfma_f32_16x16x32_bf16 v[88:91], v[144:147], v[248:251], v[88:91]
  buffer_store_dword v112, v8, s[24:27], s33 offen offset:0 nt
  v_mfma_f32_16x16x32_bf16 v[88:91], v[148:151], a[224:227], v[88:91]
  v_mul_f32 v85, v98, v85
  v_mul_f32 v86, v98, v86
  v_mfma_f32_16x16x32_bf16 v[120:123], v[148:151], a[228:231], 0
  v_mul_f32 v87, v98, v87
  v_cvt_pk_bf16_f32 v84, v84, v85
  v_mfma_f32_16x16x32_bf16 v[120:123], v[144:147], v[252:255], v[120:123]
  buffer_store_dword v113, v8, s[24:27], s33 offen offset:384 nt
  v_mfma_f32_16x16x32_bf16 v[120:123], v[140:143], v[236:239], v[120:123]
  v_cvt_pk_bf16_f32 v85, v86, v87
  v_mul_f32 v56, v98, v56
  v_mfma_f32_16x16x32_bf16 v[120:123], v[116:119], v[220:223], v[120:123]
  v_mul_f32 v57, v98, v57
  v_mul_f32 v58, v98, v58
  v_mfma_f32_16x16x32_bf16 v[120:123], v[108:111], v[204:207], v[120:123]
  buffer_store_dword v114, v8, s[24:27], s33 offen offset:768 nt
  v_mfma_f32_16x16x32_bf16 v[120:123], v[104:107], v[188:191], v[120:123]
  s_waitcnt lgkmcnt(0)
  v_mul_f32 v59, v98, v59
  v_cvt_pk_bf16_f32 v56, v56, v57
  v_mfma_f32_16x16x32_bf16 v[100:103], a[244:247], v[184:187], 0
  v_cvt_pk_bf16_f32 v57, v58, v59
  v_cmp_nge_f32 vcc, 0x53800000, v9
  v_mfma_f32_16x16x32_bf16 v[100:103], a[248:251], v[200:203], v[100:103]
  buffer_store_dword v115, v8, s[24:27], s33 offen offset:1152 nt
  v_mfma_f32_16x16x32_bf16 v[100:103], a[252:255], v[216:219], v[100:103]
  s_add_u32 s33, s33, s98
  v_cvt_pk_bf16_f32 v88, v88, v120
  v_cvt_pk_bf16_f32 v89, v89, v121
  v_mfma_f32_16x16x32_bf16 v[100:103], v[60:63], v[232:235], v[100:103]
  s_or_b32 s6, vcc_lo, vcc_hi
  v_cvt_pk_bf16_f32 v90, v90, v122
  v_cvt_pk_bf16_f32 v91, v91, v123
  v_mfma_f32_16x16x32_bf16 v[100:103], v[64:67], v[248:251], v[100:103]
  buffer_store_dword v88, v7, s[24:27], s34 offen offset:0 nt
  v_mfma_f32_16x16x32_bf16 v[100:103], v[92:95], a[224:227], v[100:103]
  ds_write2st64_b32 v5, v76, v77 offset0:0 offset1:4
  v_mfma_f32_16x16x32_bf16 v[96:99], v[92:95], a[228:231], 0
  ds_write2st64_b32 v5, v80, v81 offset0:8 offset1:12
  v_mfma_f32_16x16x32_bf16 v[96:99], v[64:67], v[252:255], v[96:99]
  buffer_store_dword v89, v7, s[24:27], s34 offen offset:384 nt
  v_mfma_f32_16x16x32_bf16 v[96:99], v[60:63], v[236:239], v[96:99]
  ds_read_b128 v[76:79], v4 offset:512
  ds_read_b128 v[80:83], v4 offset:4608
  v_mfma_f32_16x16x32_bf16 v[96:99], a[252:255], v[220:223], v[96:99]
  ds_write2st64_b32 v5, v68, v69 offset0:16 offset1:20
  v_mfma_f32_16x16x32_bf16 v[96:99], a[248:251], v[204:207], v[96:99]
  buffer_store_dword v90, v7, s[24:27], s34 offen offset:768 nt
  v_mfma_f32_16x16x32_bf16 v[96:99], a[244:247], v[188:191], v[96:99]
  ds_write2st64_b32 v5, v72, v73 offset0:1 offset1:5
  v_mfma_f32_16x16x32_bf16 v[68:71], a[244:247], v[192:195], 0
  ds_write2st64_b32 v5, v84, v85 offset0:9 offset1:13
  v_mfma_f32_16x16x32_bf16 v[68:71], a[248:251], v[208:211], v[68:71]
  buffer_store_dword v91, v7, s[24:27], s34 offen offset:1152 nt
  v_mfma_f32_16x16x32_bf16 v[68:71], a[252:255], v[224:227], v[68:71]
  s_add_u32 s34, s34, s98
  v_cvt_pk_bf16_f32 v100, v100, v96
  v_cvt_pk_bf16_f32 v101, v101, v97
  v_mfma_f32_16x16x32_bf16 v[68:71], v[60:63], v[240:243], v[68:71]
  v_cvt_pk_bf16_f32 v102, v102, v98
  v_cvt_pk_bf16_f32 v103, v103, v99
  v_mfma_f32_16x16x32_bf16 v[68:71], v[64:67], a[216:219], v[68:71]
  buffer_store_dword v100, v7, s[24:27], s35 offen offset:0 nt
  v_mfma_f32_16x16x32_bf16 v[68:71], v[92:95], a[232:235], v[68:71]
  ds_write2st64_b32 v5, v56, v57 offset0:17 offset1:21
  v_mfma_f32_16x16x32_bf16 v[96:99], v[92:95], a[236:239], 0
  ds_read_b128 v[84:87], v4 offset:8704
  v_mov_b32 v54, s6
  v_mfma_f32_16x16x32_bf16 v[96:99], v[64:67], a[220:223], v[96:99]
  buffer_store_dword v101, v7, s[24:27], s35 offen offset:384 nt
  v_mfma_f32_16x16x32_bf16 v[96:99], v[60:63], v[244:247], v[96:99]
  ds_read_b128 v[88:91], v4 offset:12800
  ds_read_b128 v[72:75], v4 offset:16896
  v_mfma_f32_16x16x32_bf16 v[96:99], a[252:255], v[228:231], v[96:99]
  ds_write_b32 v11, v54
  v_mfma_f32_16x16x32_bf16 v[96:99], a[248:251], v[212:215], v[96:99]
  buffer_store_dword v102, v7, s[24:27], s35 offen offset:768 nt
  v_mfma_f32_16x16x32_bf16 v[96:99], a[244:247], v[196:199], v[96:99]
  s_waitcnt lgkmcnt(8)
  ds_read_b128 v[64:67], v4 offset:20992
  v_xor_b32 v3, 40960, v3
  v_xor_b32 v4, 40960, v4
  v_mfma_f32_16x16x32_bf16 v[60:63], v[76:79], v[184:187], 0
  s_waitcnt lgkmcnt(1)
  s_barrier
  v_mfma_f32_16x16x32_bf16 v[60:63], v[80:83], v[200:203], v[60:63]
  buffer_store_dword v103, v7, s[24:27], s35 offen offset:1152 nt
  v_mfma_f32_16x16x32_bf16 v[60:63], v[84:87], v[216:219], v[60:63]
  v_cvt_pk_bf16_f32 v68, v68, v96
  v_cvt_pk_bf16_f32 v69, v69, v97
  v_mfma_f32_16x16x32_bf16 v[60:63], v[88:91], v[232:235], v[60:63]
  s_waitcnt lgkmcnt(0)
  v_cvt_pk_bf16_f32 v70, v70, v98
  v_cvt_pk_bf16_f32 v71, v71, v99
  v_mfma_f32_16x16x32_bf16 v[60:63], v[72:75], v[248:251], v[60:63]
  buffer_store_dword v68, v8, s[24:27], s35 offen offset:0 nt
  v_mfma_f32_16x16x32_bf16 v[60:63], v[64:67], a[224:227], v[60:63]
  ds_read_b128 a[244:247], v3 offset:0
  ds_read_b128 a[248:251], v3 offset:4096
  v_mfma_f32_16x16x32_bf16 v[92:95], v[64:67], a[228:231], 0
  ds_read_b128 a[252:255], v3 offset:8192
  ds_read_b128 v[56:59], v3 offset:12288
  v_mfma_f32_16x16x32_bf16 v[92:95], v[72:75], v[252:255], v[92:95]
  buffer_store_dword v69, v8, s[24:27], s35 offen offset:384 nt
  v_mfma_f32_16x16x32_bf16 v[92:95], v[88:91], v[236:239], v[92:95]
  ds_read_b128 v[64:67], v3 offset:16384
  ds_read_b128 v[72:75], v3 offset:20480
  v_mfma_f32_16x16x32_bf16 v[92:95], v[84:87], v[220:223], v[92:95]
  v_mov_b32 v11, 159744
  v_mfma_f32_16x16x32_bf16 v[92:95], v[80:83], v[204:207], v[92:95]
  buffer_store_dword v70, v8, s[24:27], s35 offen offset:768 nt
  v_mfma_f32_16x16x32_bf16 v[92:95], v[76:79], v[188:191], v[92:95]
  s_waitcnt lgkmcnt(2)
  ds_read2_b32 v[80:81], v11 offset0:0 offset1:2
  ds_read2_b32 v[82:83], v11 offset0:4 offset1:6
  v_mfma_f32_16x16x32_bf16 v[76:79], a[244:247], v[184:187], 0
  buffer_store_dword v71, v8, s[24:27], s35 offen offset:1152 nt
  v_mfma_f32_16x16x32_bf16 v[76:79], a[248:251], v[200:203], v[76:79]
  v_mfma_f32_16x16x32_bf16 v[76:79], a[252:255], v[216:219], v[76:79]
  v_cvt_pk_bf16_f32 v60, v60, v92
  v_cvt_pk_bf16_f32 v61, v61, v93
  v_mfma_f32_16x16x32_bf16 v[76:79], v[56:59], v[232:235], v[76:79]
  s_waitcnt lgkmcnt(2)
  v_cvt_pk_bf16_f32 v62, v62, v94
  v_cvt_pk_bf16_f32 v63, v63, v95
  v_mfma_f32_16x16x32_bf16 v[76:79], v[64:67], v[248:251], v[76:79]
  buffer_store_dword v60, v7, s[24:27], s36 offen offset:0 nt
  v_mfma_f32_16x16x32_bf16 v[76:79], v[72:75], a[224:227], v[76:79]
  s_waitcnt lgkmcnt(0)
  v_or3_b32 v80, v80, v81, v82
  v_or_b32 v80, v80, v83
  v_mfma_f32_16x16x32_bf16 v[100:103], v[72:75], a[228:231], 0
  buffer_store_dword v61, v7, s[24:27], s36 offen offset:384 nt
  v_mfma_f32_16x16x32_bf16 v[100:103], v[64:67], v[252:255], v[100:103]
  v_readfirstlane_b32 s49, v80
  v_mfma_f32_16x16x32_bf16 v[100:103], v[56:59], v[236:239], v[100:103]
  buffer_store_dword v62, v7, s[24:27], s36 offen offset:768 nt
  v_mfma_f32_16x16x32_bf16 v[100:103], a[252:255], v[220:223], v[100:103]
  ds_read_b128 v[68:71], v4 offset:0
  ds_read_b128 v[80:83], v4 offset:4096
  v_mfma_f32_16x16x32_bf16 v[100:103], a[248:251], v[204:207], v[100:103]
  buffer_store_dword v63, v7, s[24:27], s36 offen offset:1152 nt
  v_mfma_f32_16x16x32_bf16 v[100:103], a[244:247], v[188:191], v[100:103]
  ds_read_b128 v[84:87], v4 offset:8192
  ds_read_b128 v[88:91], v4 offset:12288
  v_mfma_f32_16x16x32_bf16 v[60:63], a[244:247], v[192:195], 0
  ds_read_b128 v[92:95], v4 offset:16384
  ds_read_b128 v[96:99], v4 offset:20480
  v_mfma_f32_16x16x32_bf16 v[60:63], a[248:251], v[208:211], v[60:63]
  v_mfma_f32_16x16x32_bf16 v[60:63], a[252:255], v[224:227], v[60:63]
  v_cvt_pk_bf16_f32 v76, v76, v100
  v_cvt_pk_bf16_f32 v77, v77, v101
  v_mfma_f32_16x16x32_bf16 v[60:63], v[56:59], v[240:243], v[60:63]
  v_cvt_pk_bf16_f32 v78, v78, v102
  v_cvt_pk_bf16_f32 v79, v79, v103
  v_mfma_f32_16x16x32_bf16 v[60:63], v[64:67], a[216:219], v[60:63]
  buffer_store_dword v76, v7, s[24:27], s33 offen offset:0 nt
  v_mfma_f32_16x16x32_bf16 v[60:63], v[72:75], a[232:235], v[60:63]
  v_mfma_f32_16x16x32_bf16 v[100:103], v[72:75], a[236:239], 0
  buffer_store_dword v77, v7, s[24:27], s33 offen offset:384 nt
  v_mfma_f32_16x16x32_bf16 v[100:103], v[64:67], a[220:223], v[100:103]
  v_mfma_f32_16x16x32_bf16 v[100:103], v[56:59], v[244:247], v[100:103]
  buffer_store_dword v78, v7, s[24:27], s33 offen offset:768 nt
  v_mfma_f32_16x16x32_bf16 v[100:103], a[252:255], v[228:231], v[100:103]
  v_mfma_f32_16x16x32_bf16 v[100:103], a[248:251], v[212:215], v[100:103]
  buffer_store_dword v79, v7, s[24:27], s33 offen offset:1152 nt
  v_mfma_f32_16x16x32_bf16 v[100:103], a[244:247], v[196:199], v[100:103]
  s_waitcnt lgkmcnt(0)
  v_mfma_f32_16x16x32_bf16 v[56:59], v[68:71], v[184:187], 0
  v_mfma_f32_16x16x32_bf16 v[56:59], v[80:83], v[200:203], v[56:59]
  v_mfma_f32_16x16x32_bf16 v[56:59], v[84:87], v[216:219], v[56:59]
  v_cvt_pk_bf16_f32 v60, v60, v100
  v_cvt_pk_bf16_f32 v61, v61, v101
  v_mfma_f32_16x16x32_bf16 v[56:59], v[88:91], v[232:235], v[56:59]
  v_cvt_pk_bf16_f32 v62, v62, v102
  v_cvt_pk_bf16_f32 v63, v63, v103
  v_mfma_f32_16x16x32_bf16 v[56:59], v[92:95], v[248:251], v[56:59]
  buffer_store_dword v60, v8, s[24:27], s33 offen offset:0 nt
  v_mfma_f32_16x16x32_bf16 v[56:59], v[96:99], a[224:227], v[56:59]
  v_mfma_f32_16x16x32_bf16 v[64:67], v[96:99], a[228:231], 0
  buffer_store_dword v61, v8, s[24:27], s33 offen offset:384 nt
  v_mfma_f32_16x16x32_bf16 v[64:67], v[92:95], v[252:255], v[64:67]
  v_mfma_f32_16x16x32_bf16 v[64:67], v[88:91], v[236:239], v[64:67]
  buffer_store_dword v62, v8, s[24:27], s33 offen offset:768 nt
  v_mfma_f32_16x16x32_bf16 v[64:67], v[84:87], v[220:223], v[64:67]
  v_mfma_f32_16x16x32_bf16 v[64:67], v[80:83], v[204:207], v[64:67]
  buffer_store_dword v63, v8, s[24:27], s33 offen offset:1152 nt
  v_mfma_f32_16x16x32_bf16 v[64:67], v[68:71], v[188:191], v[64:67]
  s_nop 7
  v_cvt_pk_bf16_f32 v56, v56, v64
  v_cvt_pk_bf16_f32 v57, v57, v65
  v_cvt_pk_bf16_f32 v58, v58, v66
  v_cvt_pk_bf16_f32 v59, v59, v67
  buffer_store_dword v56, v7, s[24:27], s34 offen offset:0 nt
  buffer_store_dword v57, v7, s[24:27], s34 offen offset:384 nt
  buffer_store_dword v58, v7, s[24:27], s34 offen offset:768 nt
  buffer_store_dword v59, v7, s[24:27], s34 offen offset:1152 nt
  s_cmp_lg_u32 s49, 0
  s_cbranch_scc1 L_safe
  s_endpgm
L_hop_2_2:
  s_cbranch_execz L_walk
L_pad4472:
L_k11:
  s_cmp_lg_u32 s59, 11
  s_cbranch_scc1 L_k12
  v_mfma_f32_16x16x32_bf16 v[104:107], a[0:3], v[88:91], 0
  v_mov_b32 v54, s12
  v_mov_b32 v55, s13
  v_mfma_f32_16x16x32_bf16 v[104:107], a[12:15], v[92:95], v[104:107]
  v_mov_b32 v74, 159808
  v_mfma_f32_16x16x32_bf16 v[104:107], a[24:27], v[96:99], v[104:107]
  v_cvt_pk_bf16_f32 v66, v128, v129
  v_cvt_pk_bf16_f32 v67, v130, v131
  v_mfma_f32_16x16x32_bf16 v[104:107], a[36:39], v[136:139], v[104:107]
  ds_read_b128 v[112:115], v74
  v_mfma_f32_16x16x32_bf16 v[104:107], a[48:51], v[140:143], v[104:107]
  s_waitcnt lgkmcnt(1)
  v_mfma_f32_16x16x32_bf16 v[104:107], a[60:63], v[80:83], v[104:107]
  v_mfma_f32_16x16x32_bf16 v[84:87], a[64:67], v[80:83], 0
  v_mfma_f32_16x16x32_bf16 v[84:87], a[52:55], v[140:143], v[84:87]
  v_mfma_f32_16x16x32_bf16 v[84:87], a[40:43], v[136:139], v[84:87]
  s_waitcnt lgkmcnt(0)
  v_mul_f32 v104, s42, v104
  v_mul_f32 v105, s42, v105
  v_mfma_f32_16x16x32_bf16 v[84:87], a[28:31], v[96:99], v[84:87]
  v_mul_f32 v106, s42, v106
  v_mul_f32 v107, s42, v107
  v_mfma_f32_16x16x32_bf16 v[84:87], a[16:19], v[92:95], v[84:87]
  v_cvt_pk_bf16_f32 v18, v104, v105
  v_cvt_pk_bf16_f32 v19, v106, v107
  v_mfma_f32_16x16x32_bf16 v[84:87], a[4:7], v[88:91], v[84:87]
  v_and_b32 v112, v112, v113
  v_and_b32 v114, v114, v115
  v_mfma_f32_16x16x32_bf16 v[108:111], a[8:11], v[88:91], 0
  v_and_b32 v112, v112, v114
  v_mfma_f32_16x16x32_bf16 v[108:111], a[20:23], v[92:95], v[108:111]
  v_readfirstlane_b32 s49, v112
  v_mfma_f32_16x16x32_bf16 v[108:111], a[32:35], v[96:99], v[108:111]
  v_mul_f32 v84, s42, v84
  v_mul_f32 v85, s42, v85
  v_mfma_f32_16x16x32_bf16 v[108:111], a[44:47], v[136:139], v[108:111]
  s_cmp_lg_u32 s49, 0
  v_mul_f32 v86, s42, v86
  v_mul_f32 v87, s42, v87
  v_mfma_f32_16x16x32_bf16 v[108:111], a[56:59], v[140:143], v[108:111]
  s_cselect_b32 s49, s44, s22
  v_cvt_pk_bf16_f32 v104, v84, v85
  v_cvt_pk_bf16_f32 v105, v86, v87
  v_mfma_f32_16x16x32_bf16 v[108:111], a[68:71], v[80:83], v[108:111]
  s_cselect_b32 s96, 4096, s96
  v_mfma_f32_16x16x32_bf16 v[112:115], a[132:135], v[80:83], 0
  buffer_store_dwordx2 v[54:55], off, s[20:23], s49 sc1
  v_mfma_f32_16x16x32_bf16 v[112:115], a[120:123], v[140:143], v[112:115]
  s_branch L_r227
L_k12:
  s_cmp_lg_u32 s45, 2
  s_cbranch_scc1 L_k12g
  v_mfma_f32_16x16x32_bf16 v[104:107], a[0:3], v[88:91], 0
  s_sub_u32 s49, s44, 2097152
  s_lshr_b32 s49, s49, 9
  s_lshr_b32 s52, s49, 6
  v_mfma_f32_16x16x32_bf16 v[104:107], a[12:15], v[92:95], v[104:107]
  s_and_b32 s53, s49, 63
  s_mul_i32 s50, s52, 15
  s_lshl_b32 s51, s57, 5
  v_mfma_f32_16x16x32_bf16 v[104:107], a[24:27], v[96:99], v[104:107]
  s_cmp_eq_u32 s53, 63
  v_cvt_pk_bf16_f32 v66, v128, v129
  v_cvt_pk_bf16_f32 v67, v130, v131
  v_mfma_f32_16x16x32_bf16 v[104:107], a[36:39], v[136:139], v[104:107]
  s_cselect_b32 s53, s50, s53
  s_cselect_b32 s52, 60, s52
  s_cselect_b32 s51, 3072, s51
  v_mfma_f32_16x16x32_bf16 v[104:107], a[48:51], v[140:143], v[104:107]
  s_waitcnt lgkmcnt(0)
  s_mul_i32 s52, s52, 1572864
  s_mul_i32 s53, s53, 3072
  v_mfma_f32_16x16x32_bf16 v[104:107], a[60:63], v[80:83], v[104:107]
  s_add_u32 s52, s52, s53
  s_add_u32 s50, s52, 787968
  s_cmp_eq_u32 s51, 3072
  v_mfma_f32_16x16x32_bf16 v[84:87], a[64:67], v[80:83], 0
  s_cselect_b32 s10, 100663296, s10
  s_sub_u32 s51, s51, s43
  s_mul_i32 s51, s51, 14
  v_mfma_f32_16x16x32_bf16 v[84:87], a[52:55], v[140:143], v[84:87]
  s_sub_u32 s50, s50, s56
  s_add_u32 s58, s50, s51
  s_mul_i32 s50, s14, 98304
  v_mfma_f32_16x16x32_bf16 v[84:87], a[40:43], v[136:139], v[84:87]
  s_add_u32 s98, s58, s50
  v_mul_f32 v104, s42, v104
  v_mul_f32 v105, s42, v105
  v_mfma_f32_16x16x32_bf16 v[84:87], a[28:31], v[96:99], v[84:87]
  s_sub_u32 s49, s98, s43
  v_mul_f32 v106, s42, v106
  v_mul_f32 v107, s42, v107
  v_mfma_f32_16x16x32_bf16 v[84:87], a[16:19], v[92:95], v[84:87]
  s_add_u32 s31, s31, s49
  v_cvt_pk_bf16_f32 v18, v104, v105
  v_cvt_pk_bf16_f32 v19, v106, v107
  v_mfma_f32_16x16x32_bf16 v[84:87], a[4:7], v[88:91], v[84:87]
  s_add_u32 s32, s32, s49
  s_lshl_b32 s50, s50, 1
  s_sub_u32 s32, s32, s50
  v_mfma_f32_16x16x32_bf16 v[108:111], a[8:11], v[88:91], 0
  s_sub_u32 s37, s37, s49
  s_sub_u32 s38, s38, s49
  s_sub_u32 s39, s39, s49
  v_mfma_f32_16x16x32_bf16 v[108:111], a[20:23], v[92:95], v[108:111]
  s_sub_u32 s40, s40, s49
  s_lshl_b32 s49, s14, 2
  s_add_u32 s97, s49, 15
  v_mfma_f32_16x16x32_bf16 v[108:111], a[32:35], v[96:99], v[108:111]
  s_mov_b32 s45, 4
  v_mul_f32 v84, s42, v84
  v_mul_f32 v85, s42, v85
  v_mfma_f32_16x16x32_bf16 v[108:111], a[44:47], v[136:139], v[108:111]
  s_mov_b32 s96, 32768
  v_mul_f32 v86, s42, v86
  v_mul_f32 v87, s42, v87
  v_mfma_f32_16x16x32_bf16 v[108:111], a[56:59], v[140:143], v[108:111]
  s_mov_b64 s[100:101], -1
  v_cvt_pk_bf16_f32 v104, v84, v85
  v_cvt_pk_bf16_f32 v105, v86, v87
  v_mfma_f32_16x16x32_bf16 v[108:111], a[68:71], v[80:83], v[108:111]
  s_branch L_r225
L_k12g:
  s_cmp_lg_u32 s59, 12
  s_cbranch_scc1 L_k13
  s_waitcnt vmcnt(30)
  v_mfma_f32_16x16x32_bf16 v[104:107], a[0:3], v[88:91], 0
  v_cmp_eq_u64 vcc, s[12:13], v[52:53]
  v_mfma_f32_16x16x32_bf16 v[104:107], a[12:15], v[92:95], v[104:107]
  v_mfma_f32_16x16x32_bf16 v[104:107], a[24:27], v[96:99], v[104:107]
  s_and_b32 s49, vcc_lo, 1
  v_cvt_pk_bf16_f32 v66, v128, v129
  v_cvt_pk_bf16_f32 v67, v130, v131
  v_mfma_f32_16x16x32_bf16 v[104:107], a[36:39], v[136:139], v[104:107]
  s_lshl_b32 s49, s49, s14
  s_lshl_b32 s54, s3, 2
  s_add_u32 s54, s54, 159824
  v_mfma_f32_16x16x32_bf16 v[104:107], a[48:51], v[140:143], v[104:107]
  s_waitcnt lgkmcnt(0)
  v_mov_b32 v54, s54
  v_mov_b32 v55, s49
  v_mfma_f32_16x16x32_bf16 v[104:107], a[60:63], v[80:83], v[104:107]
  ds_write_b32 v54, v55
  v_mfma_f32_16x16x32_bf16 v[84:87], a[64:67], v[80:83], 0
  v_mfma_f32_16x16x32_bf16 v[84:87], a[52:55], v[140:143], v[84:87]
  v_mfma_f32_16x16x32_bf16 v[84:87], a[40:43], v[136:139], v[84:87]
  v_mul_f32 v104, s42, v104
  v_mul_f32 v105, s42, v105
  v_mfma_f32_16x16x32_bf16 v[84:87], a[28:31], v[96:99], v[84:87]
  s_waitcnt lgkmcnt(0)
  v_mul_f32 v106, s42, v106
  v_mul_f32 v107, s42, v107
  v_mfma_f32_16x16x32_bf16 v[84:87], a[16:19], v[92:95], v[84:87]
  v_cvt_pk_bf16_f32 v18, v104, v105
  v_cvt_pk_bf16_f32 v19, v106, v107
  v_mfma_f32_16x16x32_bf16 v[84:87], a[4:7], v[88:91], v[84:87]
  s_branch L_r219
L_k13:
  v_mov_b32 v54, 159824
  ds_read_b128 v[84:87], v54
  s_waitcnt lgkmcnt(0)
  v_and_b32 v84, v84, v85
  v_and_b32 v86, v86, v87
  v_and_b32 v84, v84, v86
  s_nop 0
  v_readfirstlane_b32 s49, v84
  s_nop 3
  s_lshr_b32 s50, s49, 3
  s_add_u32 s97, s97, s50
  s_cmp_eq_u32 s49, 1
  s_cselect_b32 s45, 3, 0
  s_cbranch_scc1 L_full
  s_branch L_loop
L_safe:
  s_nop 15
  s_waitcnt vmcnt(0) lgkmcnt(0)
  s_mov_b32 s10, 100663296
  v_mbcnt_lo_u32_b32 v58, -1, 0
  v_mbcnt_hi_u32_b32 v58, -1, v58
  v_lshrrev_b32 v59, 2, v58
  v_and_b32 v59, 4, v59
  v_xor_b32 v60, v59, v58
  s_cmp_eq_u32 s47, 63
  s_cselect_b32 s5, 4, 0
  v_and_b32 v60, s5, v60
  v_cmp_eq_u32 vcc, 0, v60
  s_cmp_eq_u32 s48, 63
  s_cselect_b32 s5, 0xc31044fe, 0
  v_mov_b32 v55, s5
  v_mov_b32 v54, 0xc31044fe
  v_cndmask_b32 v55, 0, v55, vcc
  v_cndmask_b32 v54, v54, 0, vcc
  v_add_u32 v0, s46, v2
  v_xor_b32 v1, 64, v0
  s_lshl_b32 s5, s48, 3
  s_add_u32 s5, s5, s3
  s_add_u32 s5, s5, 4
  s_mul_i32 s31, s5, s57
  s_add_u32 s5, s5, 4
  s_and_b32 s5, s5, 511
  s_mul_i32 s32, s5, s57
  v_lshrrev_b32 v59, 2, v59
  s_lshl_b32 s5, s47, 3
  s_add_u32 s5, s5, 4
  s_mul_i32 s5, s5, 384
  s_cmp_eq_u32 s47, 63
  s_cselect_b32 s49, 0, s5
  s_cselect_b32 s5, s5, 0
  s_cselect_b32 s6, s57, 0
  v_mul_u32_u24 v57, s6, v59
  v_sub_u32 v57, s5, v57
  s_lshl_b32 s50, s48, 3
  s_add_u32 s50, s50, 4
  s_xor_b32 s6, s4, 0
  s_lshl_b32 s6, s6, 1
  s_add_u32 s6, s6, s50
  s_and_b32 s6, s6, 511
  s_mul_i32 s6, s6, s57
  s_add_u32 s33, s6, s49
  s_xor_b32 s6, s4, 1
  s_lshl_b32 s6, s6, 1
  s_add_u32 s6, s6, s50
  s_and_b32 s6, s6, 511
  s_mul_i32 s6, s6, s57
  s_add_u32 s34, s6, s49
  s_xor_b32 s6, s4, 2
  s_lshl_b32 s6, s6, 1
  s_add_u32 s6, s6, s50
  s_and_b32 s6, s6, 511
  s_mul_i32 s6, s6, s57
  s_add_u32 s35, s6, s49
  s_xor_b32 s6, s4, 3
  s_lshl_b32 s6, s6, 1
  s_add_u32 s6, s6, s50
  s_and_b32 s6, s6, 511
  s_mul_i32 s6, s6, s57
  s_add_u32 s36, s6, s49
  s_lshl_b32 s5, s47, 3
  s_add_u32 s5, s5, 4
  v_lshrrev_b32 v59, 3, v58
  v_add_u32 v60, s5, v59
  v_and_b32 v60, 511, v60
  v_sub_u32 v60, v60, v59
  v_mul_i32_i24 v56, 0x180, v60
  v_add_u32 v6, v6, v56
  v_add_u32 v7, v7, v57
  v_add_u32 v8, v8, v57
  v_add_f32 v55, v54, v55
  s_cmp_eq_u32 s45, 3
  s_cselect_b32 s49, 15, 16
  s_cmp_eq_u32 s45, 4
  s_cselect_b32 s49, 17, s49
  s_mov_b32 s50, 0
  s_sub_u32 s56, s56, s43
  s_nop 7
L_sloop:
  s_barrier
  s_add_u32 m0, s46, 0
  s_nop 0
  buffer_load_dwordx4 v6, s[8:11], s31 offen offset:0 nt lds
  s_add_u32 m0, s46, 8064
  s_nop 0
  buffer_load_dwordx4 v6, s[8:11], s31 offen offset:128 nt lds
  s_add_u32 m0, s46, 16128
  s_nop 0
  buffer_load_dwordx4 v6, s[8:11], s31 offen offset:256 nt lds
  s_add_u32 m0, s46, 4096
  s_nop 0
  buffer_load_dwordx4 v6, s[8:11], s32 offen offset:0 nt lds
  s_add_u32 m0, s46, 12160
  s_nop 0
  buffer_load_dwordx4 v6, s[8:11], s32 offen offset:128 nt lds
  s_add_u32 m0, s46, 20224
  s_nop 0
  buffer_load_dwordx4 v6, s[8:11], s32 offen offset:256 nt lds
  s_waitcnt vmcnt(0)
  s_barrier
  ds_read_b128 a[244:247], v0 offset:0
  ds_read_b128 a[248:251], v1 offset:0
  ds_read_b128 a[252:255], v0 offset:8192
  ds_read_b128 v[76:79], v1 offset:8192
  ds_read_b128 v[80:83], v0 offset:16384
  ds_read_b128 v[84:87], v1 offset:16384
  s_waitcnt lgkmcnt(5)
  v_mfma_f32_16x16x32_bf16 v[68:71], a[0:3], a[244:247], 0
  s_waitcnt lgkmcnt(4)
  v_mfma_f32_16x16x32_bf16 v[68:71], a[12:15], a[248:251], v[68:71]
  s_waitcnt lgkmcnt(3)
  v_mfma_f32_16x16x32_bf16 v[68:71], a[24:27], a[252:255], v[68:71]
  s_waitcnt lgkmcnt(2)
  v_mfma_f32_16x16x32_bf16 v[68:71], a[36:39], v[76:79], v[68:71]
  s_waitcnt lgkmcnt(1)
  v_mfma_f32_16x16x32_bf16 v[68:71], a[48:51], v[80:83], v[68:71]
  s_waitcnt lgkmcnt(0)
  v_mfma_f32_16x16x32_bf16 v[68:71], a[60:63], v[84:87], v[68:71]
  v_mfma_f32_16x16x32_bf16 v[60:63], a[64:67], v[84:87], 0
  v_mfma_f32_16x16x32_bf16 v[60:63], a[52:55], v[80:83], v[60:63]
  v_mfma_f32_16x16x32_bf16 v[60:63], a[40:43], v[76:79], v[60:63]
  v_mfma_f32_16x16x32_bf16 v[60:63], a[28:31], a[252:255], v[60:63]
  v_mfma_f32_16x16x32_bf16 v[60:63], a[16:19], a[248:251], v[60:63]
  v_mfma_f32_16x16x32_bf16 v[60:63], a[4:7], a[244:247], v[60:63]
  v_mul_f32 v68, s42, v68
  v_mul_f32 v69, s42, v69
  v_mul_f32 v70, s42, v70
  v_mul_f32 v71, s42, v71
  v_cvt_pk_bf16_f32 v12, v68, v69
  v_cvt_pk_bf16_f32 v13, v70, v71
  v_mfma_f32_16x16x32_bf16 v[64:67], a[8:11], a[244:247], 0
  v_mfma_f32_16x16x32_bf16 v[64:67], a[20:23], a[248:251], v[64:67]
  v_mfma_f32_16x16x32_bf16 v[64:67], a[32:35], a[252:255], v[64:67]
  v_mfma_f32_16x16x32_bf16 v[64:67], a[44:47], v[76:79], v[64:67]
  v_mfma_f32_16x16x32_bf16 v[64:67], a[56:59], v[80:83], v[64:67]
  v_mfma_f32_16x16x32_bf16 v[64:67], a[68:71], v[84:87], v[64:67]
  v_mul_f32 v60, s42, v60
  v_mul_f32 v61, s42, v61
  v_mul_f32 v62, s42, v62
  v_mul_f32 v63, s42, v63
  v_cvt_pk_bf16_f32 v128, v60, v61
  v_cvt_pk_bf16_f32 v129, v62, v63
  v_mfma_f32_16x16x32_bf16 v[68:71], a[132:135], v[84:87], 0
  v_mfma_f32_16x16x32_bf16 v[68:71], a[120:123], v[80:83], v[68:71]
  v_mfma_f32_16x16x32_bf16 v[68:71], a[108:111], v[76:79], v[68:71]
  v_mfma_f32_16x16x32_bf16 v[68:71], a[96:99], a[252:255], v[68:71]
  v_mfma_f32_16x16x32_bf16 v[68:71], a[84:87], a[248:251], v[68:71]
  v_mfma_f32_16x16x32_bf16 v[68:71], a[72:75], a[244:247], v[68:71]
  v_mul_f32 v64, s42, v64
  v_mul_f32 v65, s42, v65
  v_mul_f32 v66, s42, v66
  v_mul_f32 v67, s42, v67
  v_cvt_pk_bf16_f32 v130, v64, v65
  v_cvt_pk_bf16_f32 v131, v66, v67
  v_mfma_f32_16x16x32_bf16 v[72:75], a[76:79], a[244:247], 0
  v_mfma_f32_16x16x32_bf16 v[72:75], a[88:91], a[248:251], v[72:75]
  v_mfma_f32_16x16x32_bf16 v[72:75], a[100:103], a[252:255], v[72:75]
  v_mfma_f32_16x16x32_bf16 v[72:75], a[112:115], v[76:79], v[72:75]
  v_mfma_f32_16x16x32_bf16 v[72:75], a[124:127], v[80:83], v[72:75]
  v_mfma_f32_16x16x32_bf16 v[72:75], a[136:139], v[84:87], v[72:75]
  v_cvt_pk_bf16_f32 v60, v68, v69
  v_cvt_pk_bf16_f32 v61, v70, v71
  v_mfma_f32_16x16x32_bf16 v[88:91], a[140:143], v[84:87], 0
  v_mfma_f32_16x16x32_bf16 v[88:91], a[128:131], v[80:83], v[88:91]
  v_mfma_f32_16x16x32_bf16 v[88:91], a[116:119], v[76:79], v[88:91]
  v_mfma_f32_16x16x32_bf16 v[88:91], a[104:107], a[252:255], v[88:91]
  v_mfma_f32_16x16x32_bf16 v[88:91], a[92:95], a[248:251], v[88:91]
  v_mfma_f32_16x16x32_bf16 v[88:91], a[80:83], a[244:247], v[88:91]
  v_cvt_pk_bf16_f32 v62, v72, v73
  v_cvt_pk_bf16_f32 v63, v74, v75
  v_mfma_f32_16x16x32_bf16 v[92:95], a[244:247], a[144:147], 0
  v_mfma_f32_16x16x32_bf16 v[92:95], a[248:251], a[156:159], v[92:95]
  v_mfma_f32_16x16x32_bf16 v[92:95], a[252:255], a[168:171], v[92:95]
  v_mfma_f32_16x16x32_bf16 v[92:95], v[76:79], a[180:183], v[92:95]
  v_mfma_f32_16x16x32_bf16 v[92:95], v[80:83], a[192:195], v[92:95]
  v_mfma_f32_16x16x32_bf16 v[92:95], v[84:87], a[204:207], v[92:95]
  v_cvt_pk_bf16_f32 v64, v88, v89
  v_cvt_pk_bf16_f32 v65, v90, v91
  v_mfma_f32_16x16x32_bf16 v[96:99], v[84:87], a[208:211], 0
  v_mfma_f32_16x16x32_bf16 v[96:99], v[80:83], a[196:199], v[96:99]
  v_mfma_f32_16x16x32_bf16 v[96:99], v[76:79], a[184:187], v[96:99]
  v_mfma_f32_16x16x32_bf16 v[96:99], a[252:255], a[172:175], v[96:99]
  v_mfma_f32_16x16x32_bf16 v[96:99], a[248:251], a[160:163], v[96:99]
  v_mfma_f32_16x16x32_bf16 v[96:99], a[244:247], a[148:151], v[96:99]
  v_cvt_pk_bf16_f32 v68, v92, v93
  v_cvt_pk_bf16_f32 v69, v94, v95
  v_mfma_f32_16x16x32_bf16 v[104:107], a[244:247], a[152:155], 0
  v_mfma_f32_16x16x32_bf16 v[104:107], a[248:251], a[164:167], v[104:107]
  v_mfma_f32_16x16x32_bf16 v[104:107], a[252:255], a[176:179], v[104:107]
  v_mfma_f32_16x16x32_bf16 v[104:107], v[76:79], a[188:191], v[104:107]
  v_mfma_f32_16x16x32_bf16 v[104:107], v[80:83], a[200:203], v[104:107]
  v_mfma_f32_16x16x32_bf16 v[104:107], v[84:87], a[212:215], v[104:107]
  v_cvt_pk_bf16_f32 v72, v96, v97
  v_cvt_pk_bf16_f32 v73, v98, v99
  s_nop 5
  v_cvt_pk_bf16_f32 v76, v104, v105
  v_cvt_pk_bf16_f32 v77, v106, v107
  ds_read_b128 a[244:247], v0 offset:2048
  ds_read_b128 a[248:251], v1 offset:2048
  ds_read_b128 a[252:255], v0 offset:10240
  ds_read_b128 v[88:91], v1 offset:10240
  ds_read_b128 v[92:95], v0 offset:18432
  ds_read_b128 v[96:99], v1 offset:18432
  s_waitcnt lgkmcnt(5)
  v_mfma_f32_16x16x32_bf16 v[100:103], a[0:3], a[244:247], 0
  s_waitcnt lgkmcnt(4)
  v_mfma_f32_16x16x32_bf16 v[100:103], a[12:15], a[248:251], v[100:103]
  s_waitcnt lgkmcnt(3)
  v_mfma_f32_16x16x32_bf16 v[100:103], a[24:27], a[252:255], v[100:103]
  s_waitcnt lgkmcnt(2)
  v_mfma_f32_16x16x32_bf16 v[100:103], a[36:39], v[88:91], v[100:103]
  s_waitcnt lgkmcnt(1)
  v_mfma_f32_16x16x32_bf16 v[100:103], a[48:51], v[92:95], v[100:103]
  s_waitcnt lgkmcnt(0)
  v_mfma_f32_16x16x32_bf16 v[100:103], a[60:63], v[96:99], v[100:103]
  v_mfma_f32_16x16x32_bf16 v[80:83], a[64:67], v[96:99], 0
  v_mfma_f32_16x16x32_bf16 v[80:83], a[52:55], v[92:95], v[80:83]
  v_mfma_f32_16x16x32_bf16 v[80:83], a[40:43], v[88:91], v[80:83]
  v_mfma_f32_16x16x32_bf16 v[80:83], a[28:31], a[252:255], v[80:83]
  v_mfma_f32_16x16x32_bf16 v[80:83], a[16:19], a[248:251], v[80:83]
  v_mfma_f32_16x16x32_bf16 v[80:83], a[4:7], a[244:247], v[80:83]
  v_mul_f32 v100, s42, v100
  v_mul_f32 v101, s42, v101
  v_mul_f32 v102, s42, v102
  v_mul_f32 v103, s42, v103
  v_cvt_pk_bf16_f32 v124, v100, v101
  v_cvt_pk_bf16_f32 v125, v102, v103
  v_mfma_f32_16x16x32_bf16 v[84:87], a[8:11], a[244:247], 0
  v_mfma_f32_16x16x32_bf16 v[84:87], a[20:23], a[248:251], v[84:87]
  v_mfma_f32_16x16x32_bf16 v[84:87], a[32:35], a[252:255], v[84:87]
  v_mfma_f32_16x16x32_bf16 v[84:87], a[44:47], v[88:91], v[84:87]
  v_mfma_f32_16x16x32_bf16 v[84:87], a[56:59], v[92:95], v[84:87]
  v_mfma_f32_16x16x32_bf16 v[84:87], a[68:71], v[96:99], v[84:87]
  v_mul_f32 v80, s42, v80
  v_mul_f32 v81, s42, v81
  v_mul_f32 v82, s42, v82
  v_mul_f32 v83, s42, v83
  v_cvt_pk_bf16_f32 v126, v80, v81
  v_cvt_pk_bf16_f32 v127, v82, v83
  v_mfma_f32_16x16x32_bf16 v[100:103], a[132:135], v[96:99], 0
  v_mfma_f32_16x16x32_bf16 v[100:103], a[120:123], v[92:95], v[100:103]
  v_mfma_f32_16x16x32_bf16 v[100:103], a[108:111], v[88:91], v[100:103]
  v_mfma_f32_16x16x32_bf16 v[100:103], a[96:99], a[252:255], v[100:103]
  v_mfma_f32_16x16x32_bf16 v[100:103], a[84:87], a[248:251], v[100:103]
  v_mfma_f32_16x16x32_bf16 v[100:103], a[72:75], a[244:247], v[100:103]
  v_mul_f32 v84, s42, v84
  v_mul_f32 v85, s42, v85
  v_mul_f32 v86, s42, v86
  v_mul_f32 v87, s42, v87
  v_cvt_pk_bf16_f32 v16, v84, v85
  v_cvt_pk_bf16_f32 v17, v86, v87
  v_mfma_f32_16x16x32_bf16 v[104:107], a[76:79], a[244:247], 0
  v_mfma_f32_16x16x32_bf16 v[104:107], a[88:91], a[248:251], v[104:107]
  v_mfma_f32_16x16x32_bf16 v[104:107], a[100:103], a[252:255], v[104:107]
  v_mfma_f32_16x16x32_bf16 v[104:107], a[112:115], v[88:91], v[104:107]
  v_mfma_f32_16x16x32_bf16 v[104:107], a[124:127], v[92:95], v[104:107]
  v_mfma_f32_16x16x32_bf16 v[104:107], a[136:139], v[96:99], v[104:107]
  v_cvt_pk_bf16_f32 v80, v100, v101
  v_cvt_pk_bf16_f32 v81, v102, v103
  v_mfma_f32_16x16x32_bf16 v[108:111], a[140:143], v[96:99], 0
  v_mfma_f32_16x16x32_bf16 v[108:111], a[128:131], v[92:95], v[108:111]
  v_mfma_f32_16x16x32_bf16 v[108:111], a[116:119], v[88:91], v[108:111]
  v_mfma_f32_16x16x32_bf16 v[108:111], a[104:107], a[252:255], v[108:111]
  v_mfma_f32_16x16x32_bf16 v[108:111], a[92:95], a[248:251], v[108:111]
  v_mfma_f32_16x16x32_bf16 v[108:111], a[80:83], a[244:247], v[108:111]
  v_cvt_pk_bf16_f32 v82, v104, v105
  v_cvt_pk_bf16_f32 v83, v106, v107
  v_mfma_f32_16x16x32_bf16 v[100:103], a[244:247], a[144:147], 0
  v_mfma_f32_16x16x32_bf16 v[100:103], a[248:251], a[156:159], v[100:103]
  v_mfma_f32_16x16x32_bf16 v[100:103], a[252:255], a[168:171], v[100:103]
  v_mfma_f32_16x16x32_bf16 v[100:103], v[88:91], a[180:183], v[100:103]
  v_mfma_f32_16x16x32_bf16 v[100:103], v[92:95], a[192:195], v[100:103]
  v_mfma_f32_16x16x32_bf16 v[100:103], v[96:99], a[204:207], v[100:103]
  v_cvt_pk_bf16_f32 v84, v108, v109
  v_cvt_pk_bf16_f32 v85, v110, v111
  v_mfma_f32_16x16x32_bf16 v[104:107], v[96:99], a[208:211], 0
  v_mfma_f32_16x16x32_bf16 v[104:107], v[92:95], a[196:199], v[104:107]
  v_mfma_f32_16x16x32_bf16 v[104:107], v[88:91], a[184:187], v[104:107]
  v_mfma_f32_16x16x32_bf16 v[104:107], a[252:255], a[172:175], v[104:107]
  v_mfma_f32_16x16x32_bf16 v[104:107], a[248:251], a[160:163], v[104:107]
  v_mfma_f32_16x16x32_bf16 v[104:107], a[244:247], a[148:151], v[104:107]
  v_cvt_pk_bf16_f32 v70, v100, v101
  v_cvt_pk_bf16_f32 v71, v102, v103
  v_mfma_f32_16x16x32_bf16 v[116:119], a[244:247], a[152:155], 0
  v_mfma_f32_16x16x32_bf16 v[116:119], a[248:251], a[164:167], v[116:119]
  v_mfma_f32_16x16x32_bf16 v[116:119], a[252:255], a[176:179], v[116:119]
  v_mfma_f32_16x16x32_bf16 v[116:119], v[88:91], a[188:191], v[116:119]
  v_mfma_f32_16x16x32_bf16 v[116:119], v[92:95], a[200:203], v[116:119]
  v_mfma_f32_16x16x32_bf16 v[116:119], v[96:99], a[212:215], v[116:119]
  v_cvt_pk_bf16_f32 v74, v104, v105
  v_cvt_pk_bf16_f32 v75, v106, v107
  s_nop 5
  v_cvt_pk_bf16_f32 v78, v116, v117
  v_cvt_pk_bf16_f32 v79, v118, v119
  ds_read_b128 a[244:247], v0 offset:4096
  ds_read_b128 a[248:251], v1 offset:4096
  ds_read_b128 a[252:255], v0 offset:12288
  ds_read_b128 v[100:103], v1 offset:12288
  ds_read_b128 v[108:111], v0 offset:20480
  ds_read_b128 v[112:115], v1 offset:20480
  s_waitcnt lgkmcnt(5)
  v_mfma_f32_16x16x32_bf16 v[96:99], a[0:3], a[244:247], 0
  s_waitcnt lgkmcnt(4)
  v_mfma_f32_16x16x32_bf16 v[96:99], a[12:15], a[248:251], v[96:99]
  s_waitcnt lgkmcnt(3)
  v_mfma_f32_16x16x32_bf16 v[96:99], a[24:27], a[252:255], v[96:99]
  s_waitcnt lgkmcnt(2)
  v_mfma_f32_16x16x32_bf16 v[96:99], a[36:39], v[100:103], v[96:99]
  s_waitcnt lgkmcnt(1)
  v_mfma_f32_16x16x32_bf16 v[96:99], a[48:51], v[108:111], v[96:99]
  s_waitcnt lgkmcnt(0)
  v_mfma_f32_16x16x32_bf16 v[96:99], a[60:63], v[112:115], v[96:99]
  v_mfma_f32_16x16x32_bf16 v[88:91], a[64:67], v[112:115], 0
  v_mfma_f32_16x16x32_bf16 v[88:91], a[52:55], v[108:111], v[88:91]
  v_mfma_f32_16x16x32_bf16 v[88:91], a[40:43], v[100:103], v[88:91]
  v_mfma_f32_16x16x32_bf16 v[88:91], a[28:31], a[252:255], v[88:91]
  v_mfma_f32_16x16x32_bf16 v[88:91], a[16:19], a[248:251], v[88:91]
  v_mfma_f32_16x16x32_bf16 v[88:91], a[4:7], a[244:247], v[88:91]
  v_mul_f32 v96, s42, v96
  v_mul_f32 v97, s42, v97
  v_mul_f32 v98, s42, v98
  v_mul_f32 v99, s42, v99
  v_cvt_pk_bf16_f32 v18, v96, v97
  v_cvt_pk_bf16_f32 v19, v98, v99
  v_mfma_f32_16x16x32_bf16 v[92:95], a[8:11], a[244:247], 0
  v_mfma_f32_16x16x32_bf16 v[92:95], a[20:23], a[248:251], v[92:95]
  v_mfma_f32_16x16x32_bf16 v[92:95], a[32:35], a[252:255], v[92:95]
  v_mfma_f32_16x16x32_bf16 v[92:95], a[44:47], v[100:103], v[92:95]
  v_mfma_f32_16x16x32_bf16 v[92:95], a[56:59], v[108:111], v[92:95]
  v_mfma_f32_16x16x32_bf16 v[92:95], a[68:71], v[112:115], v[92:95]
  v_mul_f32 v88, s42, v88
  v_mul_f32 v89, s42, v89
  v_mul_f32 v90, s42, v90
  v_mul_f32 v91, s42, v91
  v_cvt_pk_bf16_f32 v120, v88, v89
  v_cvt_pk_bf16_f32 v121, v90, v91
  v_mfma_f32_16x16x32_bf16 v[96:99], a[132:135], v[112:115], 0
  v_mfma_f32_16x16x32_bf16 v[96:99], a[120:123], v[108:111], v[96:99]
  v_mfma_f32_16x16x32_bf16 v[96:99], a[108:111], v[100:103], v[96:99]
  v_mfma_f32_16x16x32_bf16 v[96:99], a[96:99], a[252:255], v[96:99]
  v_mfma_f32_16x16x32_bf16 v[96:99], a[84:87], a[248:251], v[96:99]
  v_mfma_f32_16x16x32_bf16 v[96:99], a[72:75], a[244:247], v[96:99]
  v_mul_f32 v92, s42, v92
  v_mul_f32 v93, s42, v93
  v_mul_f32 v94, s42, v94
  v_mul_f32 v95, s42, v95
  v_cvt_pk_bf16_f32 v122, v92, v93
  v_cvt_pk_bf16_f32 v123, v94, v95
  v_mfma_f32_16x16x32_bf16 v[104:107], a[76:79], a[244:247], 0
  v_mfma_f32_16x16x32_bf16 v[104:107], a[88:91], a[248:251], v[104:107]
  v_mfma_f32_16x16x32_bf16 v[104:107], a[100:103], a[252:255], v[104:107]
  v_mfma_f32_16x16x32_bf16 v[104:107], a[112:115], v[100:103], v[104:107]
  v_mfma_f32_16x16x32_bf16 v[104:107], a[124:127], v[108:111], v[104:107]
  v_mfma_f32_16x16x32_bf16 v[104:107], a[136:139], v[112:115], v[104:107]
  v_cvt_pk_bf16_f32 v88, v96, v97
  v_cvt_pk_bf16_f32 v89, v98, v99
  v_mfma_f32_16x16x32_bf16 v[116:119], a[140:143], v[112:115], 0
  v_mfma_f32_16x16x32_bf16 v[116:119], a[128:131], v[108:111], v[116:119]
  v_mfma_f32_16x16x32_bf16 v[116:119], a[116:119], v[100:103], v[116:119]
  v_mfma_f32_16x16x32_bf16 v[116:119], a[104:107], a[252:255], v[116:119]
  v_mfma_f32_16x16x32_bf16 v[116:119], a[92:95], a[248:251], v[116:119]
  v_mfma_f32_16x16x32_bf16 v[116:119], a[80:83], a[244:247], v[116:119]
  v_cvt_pk_bf16_f32 v90, v104, v105
  v_cvt_pk_bf16_f32 v91, v106, v107
  v_mfma_f32_16x16x32_bf16 v[132:135], a[244:247], a[144:147], 0
  v_mfma_f32_16x16x32_bf16 v[132:135], a[248:251], a[156:159], v[132:135]
  v_mfma_f32_16x16x32_bf16 v[132:135], a[252:255], a[168:171], v[132:135]
  v_mfma_f32_16x16x32_bf16 v[132:135], v[100:103], a[180:183], v[132:135]
  v_mfma_f32_16x16x32_bf16 v[132:135], v[108:111], a[192:195], v[132:135]
  v_mfma_f32_16x16x32_bf16 v[132:135], v[112:115], a[204:207], v[132:135]
  v_cvt_pk_bf16_f32 v92, v116, v117
  v_cvt_pk_bf16_f32 v93, v118, v119
  v_mfma_f32_16x16x32_bf16 v[136:139], v[112:115], a[208:211], 0
  v_mfma_f32_16x16x32_bf16 v[136:139], v[108:111], a[196:199], v[136:139]
  v_mfma_f32_16x16x32_bf16 v[136:139], v[100:103], a[184:187], v[136:139]
  v_mfma_f32_16x16x32_bf16 v[136:139], a[252:255], a[172:175], v[136:139]
  v_mfma_f32_16x16x32_bf16 v[136:139], a[248:251], a[160:163], v[136:139]
  v_mfma_f32_16x16x32_bf16 v[136:139], a[244:247], a[148:151], v[136:139]
  v_cvt_pk_bf16_f32 v96, v132, v133
  v_cvt_pk_bf16_f32 v97, v134, v135
  v_mfma_f32_16x16x32_bf16 v[116:119], a[244:247], a[152:155], 0
  v_mfma_f32_16x16x32_bf16 v[116:119], a[248:251], a[164:167], v[116:119]
  v_mfma_f32_16x16x32_bf16 v[116:119], a[252:255], a[176:179], v[116:119]
  v_mfma_f32_16x16x32_bf16 v[116:119], v[100:103], a[188:191], v[116:119]
  v_mfma_f32_16x16x32_bf16 v[116:119], v[108:111], a[200:203], v[116:119]
  v_mfma_f32_16x16x32_bf16 v[116:119], v[112:115], a[212:215], v[116:119]
  v_cvt_pk_bf16_f32 v104, v136, v137
  v_cvt_pk_bf16_f32 v105, v138, v139
  s_nop 5
  v_cvt_pk_bf16_f32 v100, v116, v117
  v_cvt_pk_bf16_f32 v101, v118, v119
  ds_read_b128 a[244:247], v0 offset:6144
  ds_read_b128 a[248:251], v1 offset:6144
  ds_read_b128 a[252:255], v0 offset:14336
  ds_read_b128 v[132:135], v1 offset:14336
  ds_read_b128 v[136:139], v0 offset:22528
  ds_read_b128 v[140:143], v1 offset:22528
  s_waitcnt lgkmcnt(5)
  v_mfma_f32_16x16x32_bf16 v[144:147], a[0:3], a[244:247], 0
  s_waitcnt lgkmcnt(4)
  v_mfma_f32_16x16x32_bf16 v[144:147], a[12:15], a[248:251], v[144:147]
  s_waitcnt lgkmcnt(3)
  v_mfma_f32_16x16x32_bf16 v[144:147], a[24:27], a[252:255], v[144:147]
  s_waitcnt lgkmcnt(2)
  v_mfma_f32_16x16x32_bf16 v[144:147], a[36:39], v[132:135], v[144:147]
  s_waitcnt lgkmcnt(1)
  v_mfma_f32_16x16x32_bf16 v[144:147], a[48:51], v[136:139], v[144:147]
  s_waitcnt lgkmcnt(0)
  v_mfma_f32_16x16x32_bf16 v[144:147], a[60:63], v[140:143], v[144:147]
  v_mfma_f32_16x16x32_bf16 v[108:111], a[64:67], v[140:143], 0
  v_mfma_f32_16x16x32_bf16 v[108:111], a[52:55], v[136:139], v[108:111]
  v_mfma_f32_16x16x32_bf16 v[108:111], a[40:43], v[132:135], v[108:111]
  v_mfma_f32_16x16x32_bf16 v[108:111], a[28:31], a[252:255], v[108:111]
  v_mfma_f32_16x16x32_bf16 v[108:111], a[16:19], a[248:251], v[108:111]
  v_mfma_f32_16x16x32_bf16 v[108:111], a[4:7], a[244:247], v[108:111]
  v_mul_f32 v144, s42, v144
  v_mul_f32 v145, s42, v145
  v_mul_f32 v146, s42, v146
  v_mul_f32 v147, s42, v147
  v_cvt_pk_bf16_f32 v116, v144, v145
  v_cvt_pk_bf16_f32 v117, v146, v147
  v_mfma_f32_16x16x32_bf16 v[112:115], a[8:11], a[244:247], 0
  v_mfma_f32_16x16x32_bf16 v[112:115], a[20:23], a[248:251], v[112:115]
  v_mfma_f32_16x16x32_bf16 v[112:115], a[32:35], a[252:255], v[112:115]
  v_mfma_f32_16x16x32_bf16 v[112:115], a[44:47], v[132:135], v[112:115]
  v_mfma_f32_16x16x32_bf16 v[112:115], a[56:59], v[136:139], v[112:115]
  v_mfma_f32_16x16x32_bf16 v[112:115], a[68:71], v[140:143], v[112:115]
  v_mul_f32 v108, s42, v108
  v_mul_f32 v109, s42, v109
  v_mul_f32 v110, s42, v110
  v_mul_f32 v111, s42, v111
  v_cvt_pk_bf16_f32 v118, v108, v109
  v_cvt_pk_bf16_f32 v119, v110, v111
  v_mfma_f32_16x16x32_bf16 v[144:147], a[132:135], v[140:143], 0
  v_mfma_f32_16x16x32_bf16 v[144:147], a[120:123], v[136:139], v[144:147]
  v_mfma_f32_16x16x32_bf16 v[144:147], a[108:111], v[132:135], v[144:147]
  v_mfma_f32_16x16x32_bf16 v[144:147], a[96:99], a[252:255], v[144:147]
  v_mfma_f32_16x16x32_bf16 v[144:147], a[84:87], a[248:251], v[144:147]
  v_mfma_f32_16x16x32_bf16 v[144:147], a[72:75], a[244:247], v[144:147]
  v_mul_f32 v112, s42, v112
  v_mul_f32 v113, s42, v113
  v_mul_f32 v114, s42, v114
  v_mul_f32 v115, s42, v115
  v_cvt_pk_bf16_f32 v22, v112, v113
  v_cvt_pk_bf16_f32 v23, v114, v115
  v_mfma_f32_16x16x32_bf16 v[148:151], a[76:79], a[244:247], 0
  v_mfma_f32_16x16x32_bf16 v[148:151], a[88:91], a[248:251], v[148:151]
  v_mfma_f32_16x16x32_bf16 v[148:151], a[100:103], a[252:255], v[148:151]
  v_mfma_f32_16x16x32_bf16 v[148:151], a[112:115], v[132:135], v[148:151]
  v_mfma_f32_16x16x32_bf16 v[148:151], a[124:127], v[136:139], v[148:151]
  v_mfma_f32_16x16x32_bf16 v[148:151], a[136:139], v[140:143], v[148:151]
  v_cvt_pk_bf16_f32 v108, v144, v145
  v_cvt_pk_bf16_f32 v109, v146, v147
  v_mfma_f32_16x16x32_bf16 v[152:155], a[140:143], v[140:143], 0
  v_mfma_f32_16x16x32_bf16 v[152:155], a[128:131], v[136:139], v[152:155]
  v_mfma_f32_16x16x32_bf16 v[152:155], a[116:119], v[132:135], v[152:155]
  v_mfma_f32_16x16x32_bf16 v[152:155], a[104:107], a[252:255], v[152:155]
  v_mfma_f32_16x16x32_bf16 v[152:155], a[92:95], a[248:251], v[152:155]
  v_mfma_f32_16x16x32_bf16 v[152:155], a[80:83], a[244:247], v[152:155]
  v_cvt_pk_bf16_f32 v110, v148, v149
  v_cvt_pk_bf16_f32 v111, v150, v151
  v_mfma_f32_16x16x32_bf16 v[144:147], a[244:247], a[144:147], 0
  v_mfma_f32_16x16x32_bf16 v[144:147], a[248:251], a[156:159], v[144:147]
  v_mfma_f32_16x16x32_bf16 v[144:147], a[252:255], a[168:171], v[144:147]
  v_mfma_f32_16x16x32_bf16 v[144:147], v[132:135], a[180:183], v[144:147]
  v_mfma_f32_16x16x32_bf16 v[144:147], v[136:139], a[192:195], v[144:147]
  v_mfma_f32_16x16x32_bf16 v[144:147], v[140:143], a[204:207], v[144:147]
  v_cvt_pk_bf16_f32 v112, v152, v153
  v_cvt_pk_bf16_f32 v113, v154, v155
  v_mfma_f32_16x16x32_bf16 v[148:151], v[140:143], a[208:211], 0
  v_mfma_f32_16x16x32_bf16 v[148:151], v[136:139], a[196:199], v[148:151]
  v_mfma_f32_16x16x32_bf16 v[148:151], v[132:135], a[184:187], v[148:151]
  v_mfma_f32_16x16x32_bf16 v[148:151], a[252:255], a[172:175], v[148:151]
  v_mfma_f32_16x16x32_bf16 v[148:151], a[248:251], a[160:163], v[148:151]
  v_mfma_f32_16x16x32_bf16 v[148:151], a[244:247], a[148:151], v[148:151]
  v_cvt_pk_bf16_f32 v98, v144, v145
  v_cvt_pk_bf16_f32 v99, v146, v147
  v_mfma_f32_16x16x32_bf16 v[152:155], a[244:247], a[152:155], 0
  v_mfma_f32_16x16x32_bf16 v[152:155], a[248:251], a[164:167], v[152:155]
  v_mfma_f32_16x16x32_bf16 v[152:155], a[252:255], a[176:179], v[152:155]
  v_mfma_f32_16x16x32_bf16 v[152:155], v[132:135], a[188:191], v[152:155]
  v_mfma_f32_16x16x32_bf16 v[152:155], v[136:139], a[200:203], v[152:155]
  v_mfma_f32_16x16x32_bf16 v[152:155], v[140:143], a[212:215], v[152:155]
  v_cvt_pk_bf16_f32 v106, v148, v149
  v_cvt_pk_bf16_f32 v107, v150, v151
  s_nop 5
  v_cvt_pk_bf16_f32 v102, v152, v153
  v_cvt_pk_bf16_f32 v103, v154, v155
  v_mfma_f32_16x16x32_bf16 v[132:135], v[62:65], v[128:131], v[36:39]
  v_mfma_f32_16x16x32_bf16 v[132:135], v[60:63], v[12:15], v[132:135]
  v_mfma_f32_16x16x32_bf16 v[136:139], v[82:85], v[128:131], v[32:35]
  v_mfma_f32_16x16x32_bf16 v[136:139], v[80:83], v[12:15], v[136:139]
  v_mfma_f32_16x16x32_bf16 v[140:143], v[90:93], v[128:131], v[28:31]
  v_mfma_f32_16x16x32_bf16 v[140:143], v[88:91], v[12:15], v[140:143]
  v_mfma_f32_16x16x32_bf16 v[144:147], v[110:113], v[128:131], v[24:27]
  v_mfma_f32_16x16x32_bf16 v[144:147], v[108:111], v[12:15], v[144:147]
  v_add_f32 v132, v54, v132
  v_add_f32 v133, v54, v133
  v_add_f32 v134, v54, v134
  v_add_f32 v135, v54, v135
  v_add_f32 v136, v54, v136
  v_add_f32 v137, v54, v137
  v_add_f32 v138, v54, v138
  v_add_f32 v139, v54, v139
  v_add_f32 v140, v55, v140
  v_add_f32 v141, v55, v141
  v_add_f32 v142, v55, v142
  v_add_f32 v143, v55, v143
  v_add_f32 v144, v55, v144
  v_add_f32 v145, v55, v145
  v_add_f32 v146, v55, v146
  v_add_f32 v147, v55, v147
  v_max_f32 v58, v132, v133
  v_max3_f32 v58, v134, v135, v58
  v_max3_f32 v58, v136, v137, v58
  v_max3_f32 v58, v138, v139, v58
  v_max3_f32 v58, v140, v141, v58
  v_max3_f32 v58, v142, v143, v58
  v_max3_f32 v58, v144, v145, v58
  v_max3_f32 v58, v146, v147, v58
  v_mov_b32 v59, v58
  s_nop 1
  v_permlane32_swap_b32 v58, v59
  v_max_f32 v58, v58, v59
  v_mov_b32 v59, v58
  s_nop 1
  v_permlane16_swap_b32 v58, v59
  v_max_f32 v58, v58, v59
  v_sub_f32 v132, v132, v58
  v_sub_f32 v133, v133, v58
  v_sub_f32 v134, v134, v58
  v_sub_f32 v135, v135, v58
  v_sub_f32 v136, v136, v58
  v_sub_f32 v137, v137, v58
  v_sub_f32 v138, v138, v58
  v_sub_f32 v139, v139, v58
  v_sub_f32 v140, v140, v58
  v_sub_f32 v141, v141, v58
  v_sub_f32 v142, v142, v58
  v_sub_f32 v143, v143, v58
  v_sub_f32 v144, v144, v58
  v_sub_f32 v145, v145, v58
  v_sub_f32 v146, v146, v58
  v_sub_f32 v147, v147, v58
  v_exp_f32 v132, v132
  v_exp_f32 v133, v133
  v_exp_f32 v134, v134
  v_exp_f32 v135, v135
  v_cvt_pk_bf16_f32 v132, v132, v133
  v_cvt_pk_bf16_f32 v133, v134, v135
  v_exp_f32 v136, v136
  v_exp_f32 v137, v137
  v_exp_f32 v138, v138
  v_exp_f32 v139, v139
  v_cvt_pk_bf16_f32 v134, v136, v137
  v_cvt_pk_bf16_f32 v135, v138, v139
  v_exp_f32 v140, v140
  v_exp_f32 v141, v141
  v_exp_f32 v142, v142
  v_exp_f32 v143, v143
  v_cvt_pk_bf16_f32 v136, v140, v141
  v_cvt_pk_bf16_f32 v137, v142, v143
  v_exp_f32 v144, v144
  v_exp_f32 v145, v145
  v_exp_f32 v146, v146
  v_exp_f32 v147, v147
  v_cvt_pk_bf16_f32 v138, v144, v145
  v_cvt_pk_bf16_f32 v139, v146, v147
  v_mov_b64 v[128:129], 0
  s_nop 1
  v_smfmac_f32_16x16x64_bf16 v[128:131], a[240:243], v[132:139], v10
  v_mfma_f32_16x16x32_bf16 v[148:151], v[96:99], v[136:139], 0
  v_mfma_f32_16x16x32_bf16 v[148:151], v[68:71], v[132:135], v[148:151]
  v_mfma_f32_16x16x32_bf16 v[140:143], v[72:75], v[132:135], 0
  v_mfma_f32_16x16x32_bf16 v[140:143], v[104:107], v[136:139], v[140:143]
  v_mfma_f32_16x16x32_bf16 v[144:147], v[100:103], v[136:139], 0
  v_mfma_f32_16x16x32_bf16 v[144:147], v[76:79], v[132:135], v[144:147]
  v_add_f32 v128, v128, v129
  v_rcp_f32 v130, v128
  s_nop 0
  v_mul_f32 v148, v130, v148
  v_mul_f32 v149, v130, v149
  v_mul_f32 v150, v130, v150
  v_mul_f32 v151, v130, v151
  v_cvt_pk_bf16_f32 v148, v148, v149
  v_cvt_pk_bf16_f32 v149, v150, v151
  ds_write_b32 v5, v148 offset:0
  ds_write_b32 v5, v149 offset:1024
  v_mul_f32 v140, v130, v140
  v_mul_f32 v141, v130, v141
  v_mul_f32 v142, v130, v142
  v_mul_f32 v143, v130, v143
  v_cvt_pk_bf16_f32 v140, v140, v141
  v_cvt_pk_bf16_f32 v141, v142, v143
  ds_write_b32 v5, v140 offset:2048
  ds_write_b32 v5, v141 offset:3072
  v_mul_f32 v144, v130, v144
  v_mul_f32 v145, v130, v145
  v_mul_f32 v146, v130, v146
  v_mul_f32 v147, v130, v147
  v_cvt_pk_bf16_f32 v144, v144, v145
  v_cvt_pk_bf16_f32 v145, v146, v147
  ds_write_b32 v5, v144 offset:4096
  ds_write_b32 v5, v145 offset:5120
  v_mfma_f32_16x16x32_bf16 v[128:131], v[60:63], v[124:127], v[40:43]
  v_mfma_f32_16x16x32_bf16 v[128:131], v[62:65], v[14:17], v[128:131]
  v_mfma_f32_16x16x32_bf16 v[132:135], v[80:83], v[124:127], v[36:39]
  v_mfma_f32_16x16x32_bf16 v[132:135], v[82:85], v[14:17], v[132:135]
  v_mfma_f32_16x16x32_bf16 v[136:139], v[88:91], v[124:127], v[32:35]
  v_mfma_f32_16x16x32_bf16 v[136:139], v[90:93], v[14:17], v[136:139]
  v_mfma_f32_16x16x32_bf16 v[140:143], v[108:111], v[124:127], v[28:31]
  v_mfma_f32_16x16x32_bf16 v[140:143], v[110:113], v[14:17], v[140:143]
  v_add_f32 v128, v54, v128
  v_add_f32 v129, v54, v129
  v_add_f32 v130, v54, v130
  v_add_f32 v131, v54, v131
  v_add_f32 v132, v54, v132
  v_add_f32 v133, v54, v133
  v_add_f32 v134, v54, v134
  v_add_f32 v135, v54, v135
  v_add_f32 v136, v55, v136
  v_add_f32 v137, v55, v137
  v_add_f32 v138, v55, v138
  v_add_f32 v139, v55, v139
  v_add_f32 v140, v55, v140
  v_add_f32 v141, v55, v141
  v_add_f32 v142, v55, v142
  v_add_f32 v143, v55, v143
  v_max_f32 v58, v128, v129
  v_max3_f32 v58, v130, v131, v58
  v_max3_f32 v58, v132, v133, v58
  v_max3_f32 v58, v134, v135, v58
  v_max3_f32 v58, v136, v137, v58
  v_max3_f32 v58, v138, v139, v58
  v_max3_f32 v58, v140, v141, v58
  v_max3_f32 v58, v142, v143, v58
  v_mov_b32 v59, v58
  s_nop 1
  v_permlane32_swap_b32 v58, v59
  v_max_f32 v58, v58, v59
  v_mov_b32 v59, v58
  s_nop 1
  v_permlane16_swap_b32 v58, v59
  v_max_f32 v58, v58, v59
  v_sub_f32 v128, v128, v58
  v_sub_f32 v129, v129, v58
  v_sub_f32 v130, v130, v58
  v_sub_f32 v131, v131, v58
  v_sub_f32 v132, v132, v58
  v_sub_f32 v133, v133, v58
  v_sub_f32 v134, v134, v58
  v_sub_f32 v135, v135, v58
  v_sub_f32 v136, v136, v58
  v_sub_f32 v137, v137, v58
  v_sub_f32 v138, v138, v58
  v_sub_f32 v139, v139, v58
  v_sub_f32 v140, v140, v58
  v_sub_f32 v141, v141, v58
  v_sub_f32 v142, v142, v58
  v_sub_f32 v143, v143, v58
  v_exp_f32 v128, v128
  v_exp_f32 v129, v129
  v_exp_f32 v130, v130
  v_exp_f32 v131, v131
  v_cvt_pk_bf16_f32 v128, v128, v129
  v_cvt_pk_bf16_f32 v129, v130, v131
  v_exp_f32 v132, v132
  v_exp_f32 v133, v133
  v_exp_f32 v134, v134
  v_exp_f32 v135, v135
  v_cvt_pk_bf16_f32 v130, v132, v133
  v_cvt_pk_bf16_f32 v131, v134, v135
  v_exp_f32 v136, v136
  v_exp_f32 v137, v137
  v_exp_f32 v138, v138
  v_exp_f32 v139, v139
  v_cvt_pk_bf16_f32 v132, v136, v137
  v_cvt_pk_bf16_f32 v133, v138, v139
  v_exp_f32 v140, v140
  v_exp_f32 v141, v141
  v_exp_f32 v142, v142
  v_exp_f32 v143, v143
  v_cvt_pk_bf16_f32 v134, v140, v141
  v_cvt_pk_bf16_f32 v135, v142, v143
  v_mov_b64 v[124:125], 0
  s_nop 1
  v_smfmac_f32_16x16x64_bf16 v[124:127], a[240:243], v[128:135], v10
  v_mfma_f32_16x16x32_bf16 v[144:147], v[96:99], v[132:135], 0
  v_mfma_f32_16x16x32_bf16 v[144:147], v[68:71], v[128:131], v[144:147]
  v_mfma_f32_16x16x32_bf16 v[136:139], v[72:75], v[128:131], 0
  v_mfma_f32_16x16x32_bf16 v[136:139], v[104:107], v[132:135], v[136:139]
  v_mfma_f32_16x16x32_bf16 v[140:143], v[100:103], v[132:135], 0
  v_mfma_f32_16x16x32_bf16 v[140:143], v[76:79], v[128:131], v[140:143]
  v_add_f32 v124, v124, v125
  v_rcp_f32 v126, v124
  s_nop 0
  v_mul_f32 v144, v126, v144
  v_mul_f32 v145, v126, v145
  v_mul_f32 v146, v126, v146
  v_mul_f32 v147, v126, v147
  v_cvt_pk_bf16_f32 v144, v144, v145
  v_cvt_pk_bf16_f32 v145, v146, v147
  ds_write_b32 v5, v144 offset:256
  ds_write_b32 v5, v145 offset:1280
  v_mul_f32 v136, v126, v136
  v_mul_f32 v137, v126, v137
  v_mul_f32 v138, v126, v138
  v_mul_f32 v139, v126, v139
  v_cvt_pk_bf16_f32 v136, v136, v137
  v_cvt_pk_bf16_f32 v137, v138, v139
  ds_write_b32 v5, v136 offset:2304
  ds_write_b32 v5, v137 offset:3328
  v_mul_f32 v140, v126, v140
  v_mul_f32 v141, v126, v141
  v_mul_f32 v142, v126, v142
  v_mul_f32 v143, v126, v143
  v_cvt_pk_bf16_f32 v140, v140, v141
  v_cvt_pk_bf16_f32 v141, v142, v143
  ds_write_b32 v5, v140 offset:4352
  ds_write_b32 v5, v141 offset:5376
  v_mfma_f32_16x16x32_bf16 v[124:127], v[90:93], v[120:123], v[36:39]
  v_mfma_f32_16x16x32_bf16 v[124:127], v[88:91], v[18:21], v[124:127]
  v_mfma_f32_16x16x32_bf16 v[128:131], v[110:113], v[120:123], v[32:35]
  v_mfma_f32_16x16x32_bf16 v[128:131], v[108:111], v[18:21], v[128:131]
  v_mfma_f32_16x16x32_bf16 v[132:135], v[62:65], v[120:123], v[44:47]
  v_mfma_f32_16x16x32_bf16 v[132:135], v[60:63], v[18:21], v[132:135]
  v_mfma_f32_16x16x32_bf16 v[136:139], v[82:85], v[120:123], v[40:43]
  v_mfma_f32_16x16x32_bf16 v[136:139], v[80:83], v[18:21], v[136:139]
  v_add_f32 v124, v54, v124
  v_add_f32 v125, v54, v125
  v_add_f32 v126, v54, v126
  v_add_f32 v127, v54, v127
  v_add_f32 v128, v54, v128
  v_add_f32 v129, v54, v129
  v_add_f32 v130, v54, v130
  v_add_f32 v131, v54, v131
  v_add_f32 v132, v55, v132
  v_add_f32 v133, v55, v133
  v_add_f32 v134, v55, v134
  v_add_f32 v135, v55, v135
  v_add_f32 v136, v55, v136
  v_add_f32 v137, v55, v137
  v_add_f32 v138, v55, v138
  v_add_f32 v139, v55, v139
  v_max_f32 v58, v124, v125
  v_max3_f32 v58, v126, v127, v58
  v_max3_f32 v58, v128, v129, v58
  v_max3_f32 v58, v130, v131, v58
  v_max3_f32 v58, v132, v133, v58
  v_max3_f32 v58, v134, v135, v58
  v_max3_f32 v58, v136, v137, v58
  v_max3_f32 v58, v138, v139, v58
  v_mov_b32 v59, v58
  s_nop 1
  v_permlane32_swap_b32 v58, v59
  v_max_f32 v58, v58, v59
  v_mov_b32 v59, v58
  s_nop 1
  v_permlane16_swap_b32 v58, v59
  v_max_f32 v58, v58, v59
  v_sub_f32 v124, v124, v58
  v_sub_f32 v125, v125, v58
  v_sub_f32 v126, v126, v58
  v_sub_f32 v127, v127, v58
  v_sub_f32 v128, v128, v58
  v_sub_f32 v129, v129, v58
  v_sub_f32 v130, v130, v58
  v_sub_f32 v131, v131, v58
  v_sub_f32 v132, v132, v58
  v_sub_f32 v133, v133, v58
  v_sub_f32 v134, v134, v58
  v_sub_f32 v135, v135, v58
  v_sub_f32 v136, v136, v58
  v_sub_f32 v137, v137, v58
  v_sub_f32 v138, v138, v58
  v_sub_f32 v139, v139, v58
  v_exp_f32 v124, v124
  v_exp_f32 v125, v125
  v_exp_f32 v126, v126
  v_exp_f32 v127, v127
  v_cvt_pk_bf16_f32 v124, v124, v125
  v_cvt_pk_bf16_f32 v125, v126, v127
  v_exp_f32 v128, v128
  v_exp_f32 v129, v129
  v_exp_f32 v130, v130
  v_exp_f32 v131, v131
  v_cvt_pk_bf16_f32 v126, v128, v129
  v_cvt_pk_bf16_f32 v127, v130, v131
  v_exp_f32 v132, v132
  v_exp_f32 v133, v133
  v_exp_f32 v134, v134
  v_exp_f32 v135, v135
  v_cvt_pk_bf16_f32 v128, v132, v133
  v_cvt_pk_bf16_f32 v129, v134, v135
  v_exp_f32 v136, v136
  v_exp_f32 v137, v137
  v_exp_f32 v138, v138
  v_exp_f32 v139, v139
  v_cvt_pk_bf16_f32 v130, v136, v137
  v_cvt_pk_bf16_f32 v131, v138, v139
  v_mov_b64 v[120:121], 0
  s_nop 1
  v_smfmac_f32_16x16x64_bf16 v[120:123], a[240:243], v[124:131], v10
  v_mfma_f32_16x16x32_bf16 v[140:143], v[68:71], v[128:131], 0
  v_mfma_f32_16x16x32_bf16 v[140:143], v[96:99], v[124:127], v[140:143]
  v_mfma_f32_16x16x32_bf16 v[132:135], v[104:107], v[124:127], 0
  v_mfma_f32_16x16x32_bf16 v[132:135], v[72:75], v[128:131], v[132:135]
  v_mfma_f32_16x16x32_bf16 v[136:139], v[76:79], v[128:131], 0
  v_mfma_f32_16x16x32_bf16 v[136:139], v[100:103], v[124:127], v[136:139]
  v_add_f32 v120, v120, v121
  v_rcp_f32 v122, v120
  s_nop 0
  v_mul_f32 v140, v122, v140
  v_mul_f32 v141, v122, v141
  v_mul_f32 v142, v122, v142
  v_mul_f32 v143, v122, v143
  v_cvt_pk_bf16_f32 v140, v140, v141
  v_cvt_pk_bf16_f32 v141, v142, v143
  ds_write_b32 v5, v140 offset:512
  ds_write_b32 v5, v141 offset:1536
  v_mul_f32 v132, v122, v132
  v_mul_f32 v133, v122, v133
  v_mul_f32 v134, v122, v134
  v_mul_f32 v135, v122, v135
  v_cvt_pk_bf16_f32 v132, v132, v133
  v_cvt_pk_bf16_f32 v133, v134, v135
  ds_write_b32 v5, v132 offset:2560
  s_waitcnt lgkmcnt(12)
  ds_write_b32 v5, v133 offset:3584
  v_mul_f32 v136, v122, v136
  v_mul_f32 v137, v122, v137
  v_mul_f32 v138, v122, v138
  v_mul_f32 v139, v122, v139
  v_cvt_pk_bf16_f32 v136, v136, v137
  v_cvt_pk_bf16_f32 v137, v138, v139
  ds_write_b32 v5, v136 offset:4608
  ds_write_b32 v5, v137 offset:5632
  v_mfma_f32_16x16x32_bf16 v[120:123], v[88:91], v[116:119], v[40:43]
  v_mfma_f32_16x16x32_bf16 v[120:123], v[90:93], v[20:23], v[120:123]
  v_mfma_f32_16x16x32_bf16 v[124:127], v[108:111], v[116:119], v[36:39]
  v_mfma_f32_16x16x32_bf16 v[124:127], v[110:113], v[20:23], v[124:127]
  v_mfma_f32_16x16x32_bf16 v[128:131], v[60:63], v[116:119], v[48:51]
  v_mfma_f32_16x16x32_bf16 v[128:131], v[62:65], v[20:23], v[128:131]
  v_mfma_f32_16x16x32_bf16 v[88:91], v[80:83], v[116:119], v[44:47]
  v_mfma_f32_16x16x32_bf16 v[88:91], v[82:85], v[20:23], v[88:91]
  v_add_f32 v120, v54, v120
  v_add_f32 v121, v54, v121
  v_add_f32 v122, v54, v122
  v_add_f32 v123, v54, v123
  v_add_f32 v124, v54, v124
  v_add_f32 v125, v54, v125
  v_add_f32 v126, v54, v126
  v_add_f32 v127, v54, v127
  v_add_f32 v128, v55, v128
  v_add_f32 v129, v55, v129
  v_add_f32 v130, v55, v130
  v_add_f32 v131, v55, v131
  v_add_f32 v88, v55, v88
  v_add_f32 v89, v55, v89
  v_add_f32 v90, v55, v90
  v_add_f32 v91, v55, v91
  v_max_f32 v58, v120, v121
  v_max3_f32 v58, v122, v123, v58
  v_max3_f32 v58, v124, v125, v58
  v_max3_f32 v58, v126, v127, v58
  v_max3_f32 v58, v128, v129, v58
  v_max3_f32 v58, v130, v131, v58
  v_max3_f32 v58, v88, v89, v58
  v_max3_f32 v58, v90, v91, v58
  v_mov_b32 v59, v58
  s_nop 1
  v_permlane32_swap_b32 v58, v59
  v_max_f32 v58, v58, v59
  v_mov_b32 v59, v58
  s_nop 1
  v_permlane16_swap_b32 v58, v59
  v_max_f32 v58, v58, v59
  v_sub_f32 v120, v120, v58
  v_sub_f32 v121, v121, v58
  v_sub_f32 v122, v122, v58
  v_sub_f32 v123, v123, v58
  v_sub_f32 v124, v124, v58
  v_sub_f32 v125, v125, v58
  v_sub_f32 v126, v126, v58
  v_sub_f32 v127, v127, v58
  v_sub_f32 v128, v128, v58
  v_sub_f32 v129, v129, v58
  v_sub_f32 v130, v130, v58
  v_sub_f32 v131, v131, v58
  v_sub_f32 v88, v88, v58
  v_sub_f32 v89, v89, v58
  v_sub_f32 v90, v90, v58
  v_sub_f32 v91, v91, v58
  v_exp_f32 v120, v120
  v_exp_f32 v121, v121
  v_exp_f32 v122, v122
  v_exp_f32 v123, v123
  v_cvt_pk_bf16_f32 v120, v120, v121
  v_cvt_pk_bf16_f32 v121, v122, v123
  v_exp_f32 v124, v124
  v_exp_f32 v125, v125
  v_exp_f32 v126, v126
  v_exp_f32 v127, v127
  v_cvt_pk_bf16_f32 v122, v124, v125
  v_cvt_pk_bf16_f32 v123, v126, v127
  v_exp_f32 v128, v128
  v_exp_f32 v129, v129
  v_exp_f32 v130, v130
  v_exp_f32 v131, v131
  v_cvt_pk_bf16_f32 v124, v128, v129
  v_cvt_pk_bf16_f32 v125, v130, v131
  v_exp_f32 v88, v88
  v_exp_f32 v89, v89
  v_exp_f32 v90, v90
  v_exp_f32 v91, v91
  v_cvt_pk_bf16_f32 v126, v88, v89
  v_cvt_pk_bf16_f32 v127, v90, v91
  v_mov_b64 v[80:81], 0
  s_nop 1
  v_smfmac_f32_16x16x64_bf16 v[80:83], a[240:243], v[120:127], v10
  v_mfma_f32_16x16x32_bf16 v[84:87], v[68:71], v[124:127], 0
  v_mfma_f32_16x16x32_bf16 v[84:87], v[96:99], v[120:123], v[84:87]
  v_mfma_f32_16x16x32_bf16 v[60:63], v[104:107], v[120:123], 0
  v_mfma_f32_16x16x32_bf16 v[60:63], v[72:75], v[124:127], v[60:63]
  v_mfma_f32_16x16x32_bf16 v[64:67], v[76:79], v[124:127], 0
  v_mfma_f32_16x16x32_bf16 v[64:67], v[100:103], v[120:123], v[64:67]
  v_add_f32 v80, v80, v81
  v_rcp_f32 v82, v80
  s_nop 0
  v_mul_f32 v84, v82, v84
  v_mul_f32 v85, v82, v85
  v_mul_f32 v86, v82, v86
  v_mul_f32 v87, v82, v87
  v_cvt_pk_bf16_f32 v84, v84, v85
  v_cvt_pk_bf16_f32 v85, v86, v87
  s_waitcnt lgkmcnt(12)
  ds_write_b32 v5, v84 offset:768
  ds_write_b32 v5, v85 offset:1792
  v_mul_f32 v60, v82, v60
  v_mul_f32 v61, v82, v61
  v_mul_f32 v62, v82, v62
  v_mul_f32 v63, v82, v63
  v_cvt_pk_bf16_f32 v60, v60, v61
  v_cvt_pk_bf16_f32 v61, v62, v63
  ds_write_b32 v5, v60 offset:2816
  s_waitcnt lgkmcnt(12)
  ds_write_b32 v5, v61 offset:3840
  v_mul_f32 v64, v82, v64
  v_mul_f32 v65, v82, v65
  v_mul_f32 v66, v82, v66
  v_mul_f32 v67, v82, v67
  v_cvt_pk_bf16_f32 v64, v64, v65
  v_cvt_pk_bf16_f32 v65, v66, v67
  ds_write_b32 v5, v64 offset:4864
  ds_write_b32 v5, v65 offset:5888
  s_waitcnt lgkmcnt(0)
  s_barrier
  ds_read_b128 a[244:247], v3 offset:0
  ds_read_b128 a[248:251], v3 offset:4096
  ds_read_b128 a[252:255], v3 offset:8192
  ds_read_b128 v[72:75], v3 offset:12288
  ds_read_b128 v[76:79], v3 offset:16384
  ds_read_b128 v[84:87], v3 offset:20480
  s_waitcnt lgkmcnt(5)
  v_mfma_f32_16x16x32_bf16 v[68:71], a[244:247], v[184:187], 0
  s_waitcnt lgkmcnt(4)
  v_mfma_f32_16x16x32_bf16 v[68:71], a[248:251], v[200:203], v[68:71]
  s_waitcnt lgkmcnt(3)
  v_mfma_f32_16x16x32_bf16 v[68:71], a[252:255], v[216:219], v[68:71]
  s_waitcnt lgkmcnt(2)
  v_mfma_f32_16x16x32_bf16 v[68:71], v[72:75], v[232:235], v[68:71]
  s_waitcnt lgkmcnt(1)
  v_mfma_f32_16x16x32_bf16 v[68:71], v[76:79], v[248:251], v[68:71]
  s_waitcnt lgkmcnt(0)
  v_mfma_f32_16x16x32_bf16 v[68:71], v[84:87], a[224:227], v[68:71]
  v_mfma_f32_16x16x32_bf16 v[80:83], v[84:87], a[228:231], 0
  v_mfma_f32_16x16x32_bf16 v[80:83], v[76:79], v[252:255], v[80:83]
  v_mfma_f32_16x16x32_bf16 v[80:83], v[72:75], v[236:239], v[80:83]
  v_mfma_f32_16x16x32_bf16 v[80:83], a[252:255], v[220:223], v[80:83]
  v_mfma_f32_16x16x32_bf16 v[80:83], a[248:251], v[204:207], v[80:83]
  v_mfma_f32_16x16x32_bf16 v[80:83], a[244:247], v[188:191], v[80:83]
  v_mfma_f32_16x16x32_bf16 v[60:63], a[244:247], v[192:195], 0
  v_mfma_f32_16x16x32_bf16 v[60:63], a[248:251], v[208:211], v[60:63]
  v_mfma_f32_16x16x32_bf16 v[60:63], a[252:255], v[224:227], v[60:63]
  v_mfma_f32_16x16x32_bf16 v[60:63], v[72:75], v[240:243], v[60:63]
  v_mfma_f32_16x16x32_bf16 v[60:63], v[76:79], a[216:219], v[60:63]
  v_mfma_f32_16x16x32_bf16 v[60:63], v[84:87], a[232:235], v[60:63]
  v_mfma_f32_16x16x32_bf16 v[64:67], v[84:87], a[236:239], 0
  v_mfma_f32_16x16x32_bf16 v[64:67], v[76:79], a[220:223], v[64:67]
  v_mfma_f32_16x16x32_bf16 v[64:67], v[72:75], v[244:247], v[64:67]
  v_mfma_f32_16x16x32_bf16 v[64:67], a[252:255], v[228:231], v[64:67]
  v_mfma_f32_16x16x32_bf16 v[64:67], a[248:251], v[212:215], v[64:67]
  v_mfma_f32_16x16x32_bf16 v[64:67], a[244:247], v[196:199], v[64:67]
  v_cvt_pk_bf16_f32 v68, v68, v80
  v_cvt_pk_bf16_f32 v69, v69, v81
  v_cvt_pk_bf16_f32 v70, v70, v82
  v_cvt_pk_bf16_f32 v71, v71, v83
  buffer_store_dword v68, v7, s[24:27], s33 offen offset:0 nt
  buffer_store_dword v69, v7, s[24:27], s33 offen offset:384 nt
  buffer_store_dword v70, v7, s[24:27], s33 offen offset:768 nt
  buffer_store_dword v71, v7, s[24:27], s33 offen offset:1152 nt
  v_cvt_pk_bf16_f32 v60, v60, v64
  v_cvt_pk_bf16_f32 v61, v61, v65
  v_cvt_pk_bf16_f32 v62, v62, v66
  v_cvt_pk_bf16_f32 v63, v63, v67
  buffer_store_dword v60, v8, s[24:27], s33 offen offset:0 nt
  buffer_store_dword v61, v8, s[24:27], s33 offen offset:384 nt
  buffer_store_dword v62, v8, s[24:27], s33 offen offset:768 nt
  buffer_store_dword v63, v8, s[24:27], s33 offen offset:1152 nt
  ds_read_b128 a[244:247], v4 offset:0
  ds_read_b128 a[248:251], v4 offset:4096
  ds_read_b128 a[252:255], v4 offset:8192
  ds_read_b128 v[68:71], v4 offset:12288
  ds_read_b128 v[72:75], v4 offset:16384
  ds_read_b128 v[76:79], v4 offset:20480
  s_waitcnt lgkmcnt(5)
  v_mfma_f32_16x16x32_bf16 v[60:63], a[244:247], v[184:187], 0
  s_waitcnt lgkmcnt(4)
  v_mfma_f32_16x16x32_bf16 v[60:63], a[248:251], v[200:203], v[60:63]
  s_waitcnt lgkmcnt(3)
  v_mfma_f32_16x16x32_bf16 v[60:63], a[252:255], v[216:219], v[60:63]
  s_waitcnt lgkmcnt(2)
  v_mfma_f32_16x16x32_bf16 v[60:63], v[68:71], v[232:235], v[60:63]
  s_waitcnt lgkmcnt(1)
  v_mfma_f32_16x16x32_bf16 v[60:63], v[72:75], v[248:251], v[60:63]
  s_waitcnt lgkmcnt(0)
  v_mfma_f32_16x16x32_bf16 v[60:63], v[76:79], a[224:227], v[60:63]
  v_mfma_f32_16x16x32_bf16 v[64:67], v[76:79], a[228:231], 0
  v_mfma_f32_16x16x32_bf16 v[64:67], v[72:75], v[252:255], v[64:67]
  v_mfma_f32_16x16x32_bf16 v[64:67], v[68:71], v[236:239], v[64:67]
  v_mfma_f32_16x16x32_bf16 v[64:67], a[252:255], v[220:223], v[64:67]
  v_mfma_f32_16x16x32_bf16 v[64:67], a[248:251], v[204:207], v[64:67]
  v_mfma_f32_16x16x32_bf16 v[64:67], a[244:247], v[188:191], v[64:67]
  s_nop 7
  v_cvt_pk_bf16_f32 v60, v60, v64
  v_cvt_pk_bf16_f32 v61, v61, v65
  v_cvt_pk_bf16_f32 v62, v62, v66
  v_cvt_pk_bf16_f32 v63, v63, v67
  buffer_store_dword v60, v7, s[24:27], s34 offen offset:0 nt
  buffer_store_dword v61, v7, s[24:27], s34 offen offset:384 nt
  buffer_store_dword v62, v7, s[24:27], s34 offen offset:768 nt
  buffer_store_dword v63, v7, s[24:27], s34 offen offset:1152 nt
  ds_read_b128 a[244:247], v3 offset:512
  ds_read_b128 a[248:251], v3 offset:4608
  ds_read_b128 a[252:255], v3 offset:8704
  ds_read_b128 v[72:75], v3 offset:12800
  ds_read_b128 v[76:79], v3 offset:16896
  ds_read_b128 v[84:87], v3 offset:20992
  s_waitcnt lgkmcnt(5)
  v_mfma_f32_16x16x32_bf16 v[60:63], a[244:247], v[184:187], 0
  s_waitcnt lgkmcnt(4)
  v_mfma_f32_16x16x32_bf16 v[60:63], a[248:251], v[200:203], v[60:63]
  s_waitcnt lgkmcnt(3)
  v_mfma_f32_16x16x32_bf16 v[60:63], a[252:255], v[216:219], v[60:63]
  s_waitcnt lgkmcnt(2)
  v_mfma_f32_16x16x32_bf16 v[60:63], v[72:75], v[232:235], v[60:63]
  s_waitcnt lgkmcnt(1)
  v_mfma_f32_16x16x32_bf16 v[60:63], v[76:79], v[248:251], v[60:63]
  s_waitcnt lgkmcnt(0)
  v_mfma_f32_16x16x32_bf16 v[60:63], v[84:87], a[224:227], v[60:63]
  v_mfma_f32_16x16x32_bf16 v[80:83], v[84:87], a[228:231], 0
  v_mfma_f32_16x16x32_bf16 v[80:83], v[76:79], v[252:255], v[80:83]
  v_mfma_f32_16x16x32_bf16 v[80:83], v[72:75], v[236:239], v[80:83]
  v_mfma_f32_16x16x32_bf16 v[80:83], a[252:255], v[220:223], v[80:83]
  v_mfma_f32_16x16x32_bf16 v[80:83], a[248:251], v[204:207], v[80:83]
  v_mfma_f32_16x16x32_bf16 v[80:83], a[244:247], v[188:191], v[80:83]
  v_mfma_f32_16x16x32_bf16 v[64:67], a[244:247], v[192:195], 0
  v_mfma_f32_16x16x32_bf16 v[64:67], a[248:251], v[208:211], v[64:67]
  v_mfma_f32_16x16x32_bf16 v[64:67], a[252:255], v[224:227], v[64:67]
  v_mfma_f32_16x16x32_bf16 v[64:67], v[72:75], v[240:243], v[64:67]
  v_mfma_f32_16x16x32_bf16 v[64:67], v[76:79], a[216:219], v[64:67]
  v_mfma_f32_16x16x32_bf16 v[64:67], v[84:87], a[232:235], v[64:67]
  v_mfma_f32_16x16x32_bf16 v[68:71], v[84:87], a[236:239], 0
  v_mfma_f32_16x16x32_bf16 v[68:71], v[76:79], a[220:223], v[68:71]
  v_mfma_f32_16x16x32_bf16 v[68:71], v[72:75], v[244:247], v[68:71]
  v_mfma_f32_16x16x32_bf16 v[68:71], a[252:255], v[228:231], v[68:71]
  v_mfma_f32_16x16x32_bf16 v[68:71], a[248:251], v[212:215], v[68:71]
  v_mfma_f32_16x16x32_bf16 v[68:71], a[244:247], v[196:199], v[68:71]
  v_cvt_pk_bf16_f32 v60, v60, v80
  v_cvt_pk_bf16_f32 v61, v61, v81
  v_cvt_pk_bf16_f32 v62, v62, v82
  v_cvt_pk_bf16_f32 v63, v63, v83
  buffer_store_dword v60, v7, s[24:27], s35 offen offset:0 nt
  buffer_store_dword v61, v7, s[24:27], s35 offen offset:384 nt
  buffer_store_dword v62, v7, s[24:27], s35 offen offset:768 nt
  buffer_store_dword v63, v7, s[24:27], s35 offen offset:1152 nt
  v_cvt_pk_bf16_f32 v64, v64, v68
  v_cvt_pk_bf16_f32 v65, v65, v69
  v_cvt_pk_bf16_f32 v66, v66, v70
  v_cvt_pk_bf16_f32 v67, v67, v71
  buffer_store_dword v64, v8, s[24:27], s35 offen offset:0 nt
  buffer_store_dword v65, v8, s[24:27], s35 offen offset:384 nt
  buffer_store_dword v66, v8, s[24:27], s35 offen offset:768 nt
  buffer_store_dword v67, v8, s[24:27], s35 offen offset:1152 nt
  ds_read_b128 a[244:247], v4 offset:512
  ds_read_b128 a[248:251], v4 offset:4608
  ds_read_b128 a[252:255], v4 offset:8704
  ds_read_b128 v[72:75], v4 offset:12800
  ds_read_b128 v[76:79], v4 offset:16896
  ds_read_b128 v[80:83], v4 offset:20992
  s_waitcnt lgkmcnt(5)
  v_mfma_f32_16x16x32_bf16 v[60:63], a[244:247], v[184:187], 0
  s_waitcnt lgkmcnt(4)
  v_mfma_f32_16x16x32_bf16 v[60:63], a[248:251], v[200:203], v[60:63]
  s_waitcnt lgkmcnt(3)
  v_mfma_f32_16x16x32_bf16 v[60:63], a[252:255], v[216:219], v[60:63]
  s_waitcnt lgkmcnt(2)
  v_mfma_f32_16x16x32_bf16 v[60:63], v[72:75], v[232:235], v[60:63]
  s_waitcnt lgkmcnt(1)
  v_mfma_f32_16x16x32_bf16 v[60:63], v[76:79], v[248:251], v[60:63]
  s_waitcnt lgkmcnt(0)
  v_mfma_f32_16x16x32_bf16 v[60:63], v[80:83], a[224:227], v[60:63]
  v_mfma_f32_16x16x32_bf16 v[64:67], v[80:83], a[228:231], 0
  v_mfma_f32_16x16x32_bf16 v[64:67], v[76:79], v[252:255], v[64:67]
  v_mfma_f32_16x16x32_bf16 v[64:67], v[72:75], v[236:239], v[64:67]
  v_mfma_f32_16x16x32_bf16 v[64:67], a[252:255], v[220:223], v[64:67]
  v_mfma_f32_16x16x32_bf16 v[64:67], a[248:251], v[204:207], v[64:67]
  v_mfma_f32_16x16x32_bf16 v[64:67], a[244:247], v[188:191], v[64:67]
  s_nop 7
  v_cvt_pk_bf16_f32 v60, v60, v64
  v_cvt_pk_bf16_f32 v61, v61, v65
  v_cvt_pk_bf16_f32 v62, v62, v66
  v_cvt_pk_bf16_f32 v63, v63, v67
  buffer_store_dword v60, v7, s[24:27], s36 offen offset:0 nt
  buffer_store_dword v61, v7, s[24:27], s36 offen offset:384 nt
  buffer_store_dword v62, v7, s[24:27], s36 offen offset:768 nt
  buffer_store_dword v63, v7, s[24:27], s36 offen offset:1152 nt
  v_sub_u32 v6, v6, v56
  v_sub_u32 v7, v7, v57
  v_sub_u32 v8, v8, v57
  v_mov_b32 v54, 0
  v_mov_b32 v55, 0
  v_mov_b32 v56, 0
  v_mov_b32 v57, 0
  s_add_u32 s50, s50, 1
  s_cmp_eq_u32 s50, 16
  s_cselect_b32 s5, s58, s43
  s_add_u32 s56, s56, s5
  s_mul_i32 s5, s3, s57
  s_add_u32 s31, s56, s5
  s_add_u32 s32, s31, 786432
  s_xor_b32 s5, s4, 0
  s_mul_i32 s5, s5, 393216
  s_add_u32 s33, s5, s56
  s_xor_b32 s5, s4, 1
  s_mul_i32 s5, s5, 393216
  s_add_u32 s34, s5, s56
  s_xor_b32 s5, s4, 2
  s_mul_i32 s5, s5, 393216
  s_add_u32 s35, s5, s56
  s_xor_b32 s5, s4, 3
  s_mul_i32 s5, s5, 393216
  s_add_u32 s36, s5, s56
  s_cmp_lt_u32 s50, s49
  s_nop 7
  s_cbranch_scc1 L_sloop
  s_branch L_fin
.section .rodata,"a"
.p2align 6
.amdhsa_kernel standalone__window_attn_swin__vision_kernel
  .amdhsa_next_free_vgpr 512
  .amdhsa_next_free_sgpr 102
  .amdhsa_accum_offset 256
  .amdhsa_group_segment_fixed_size 0
  .amdhsa_kernarg_size 72
  .amdhsa_user_sgpr_count 2
  .amdhsa_user_sgpr_kernarg_segment_ptr 1
  .amdhsa_system_sgpr_workgroup_id_x 1
.end_amdhsa_kernel
```

```asm
; @launch grid=(256,1,1) block=(256,1,1) lds=163840
.amdgcn_target "amdgcn-amd-amdhsa--gfx950"
.text
.globl standalone__window_attn_swin__vision_kernel
.p2align 12
.p2align 8
.type standalone__window_attn_swin__vision_kernel,@function
standalone__window_attn_swin__vision_kernel:
  s_cmpk_ge_u32 s2, 256
  s_cbranch_scc1 L_end
  s_load_dwordx2 s[8:9], s[0:1], 0
  s_load_dwordx2 s[20:21], s[0:1], 24
  s_load_dwordx2 s[12:13], s[0:1], 8
  s_load_dwordx2 s[16:17], s[0:1], 16
  s_load_dwordx2 s[24:25], s[0:1], 48
  s_load_dwordx2 s[62:63], s[0:1], 64
  v_lshrrev_b32 v72, 6, v0
  s_lshr_b32 s49, s2, 3
  v_readfirstlane_b32 s3, v72
  s_getpc_b64 s[50:51]
  v_and_b32 v72, 15, v0
  v_mad_u32_u24 v72, s49, 9, v72
  v_lshlrev_b32 v72, 7, v72
  v_min_u32 v72, L_safe-standalone__window_attn_swin__vision_kernel-256, v72
  v_mov_b32 v59, s51
  v_add_co_u32 v58, vcc, s50, v72
  s_and_b32 s47, s2, 63
  s_lshr_b32 s48, s2, 6
  v_addc_co_u32 v59, vcc, 0, v59, vcc
  global_load_dword v88, v[58:59], off
  v_bfe_u32 v56, v0, 3, 4
  v_and_b32 v54, 7, v0
  v_lshrrev_b32 v73, 1, v56
  v_lshlrev_b32 v77, 2, v56
  v_and_b32 v77, 4, v77
  v_xor_b32 v73, v73, v77
  v_xor_b32 v73, v54, v73
  v_and_b32 v57, 7, v56
  s_add_u32 s48, s48, 60
  s_cmp_lt_u32 s2, 60
  s_cselect_b32 s48, s2, s48
  s_cselect_b32 s47, 63, s47
  s_lshl_b32 s5, s47, 3
  s_add_u32 s5, s5, 4
  v_add_u32 v77, s5, v57
  v_and_b32 v77, 511, v77
  v_mul_u32_u24 v77, 0x180, v77
  v_lshlrev_b32 v58, 4, v73
  v_add_u32 v59, v58, v77
  v_and_b32 v65, 63, v0
  v_lshlrev_b32 v55, 4, v65
  s_mov_b32 s57, 196608
  s_lshl_b32 s5, s48, 3
  s_add_u32 s5, s5, s3
  s_add_u32 s5, s5, 4
  s_mul_i32 s53, s5, s57
  s_add_u32 s5, s5, 4
  s_and_b32 s5, s5, 511
  s_mul_i32 s54, s5, s57
  s_lshl_b32 s46, s3, 10
  s_lshl_b32 s5, s3, 11
  s_add_u32 m0, s5, 151552
  s_mov_b32 s11, 0x20000
  s_mov_b32 s10, 100663296
  s_mov_b32 s23, s11
  s_movk_i32 s22, 1800
  s_mov_b32 s15, s11
  s_mov_b32 s14, 221184
  s_lshl_b32 s49, s49, 2
  s_add_u32 s51, s49, s3
  s_mul_i32 s50, s51, 1728
  v_min_u32 v60, 13, v65
  v_lshlrev_b32 v60, 7, v60
  s_waitcnt lgkmcnt(0)
  buffer_load_dword v67, v60, s[12:15], s50 offen
  buffer_load_dwordx4 v55, s[20:23], 0 offen lds
  buffer_load_dwordx4 v55, s[20:23], 0 offen offset:1024 lds
  s_add_u32 m0, s46, 0
  v_and_b32 v73, 2, v56
  buffer_load_dwordx4 v59, s[8:11], s53 offen offset:0 nt lds
  s_add_u32 m0, s46, 8064
  v_lshrrev_b32 v77, 1, v56
  buffer_load_dwordx4 v59, s[8:11], s53 offen offset:128 nt lds
  s_add_u32 m0, s46, 16128
  v_and_b32 v77, 4, v77
  buffer_load_dwordx4 v59, s[8:11], s53 offen offset:256 nt lds
  s_add_u32 m0, s46, 4096
  v_or_b32 v77, v73, v77
  buffer_load_dwordx4 v59, s[8:11], s54 offen offset:0 nt lds
  s_add_u32 m0, s46, 12160
  v_xor_b32 v77, v54, v77
  buffer_load_dwordx4 v59, s[8:11], s54 offen offset:128 nt lds
  s_add_u32 m0, s46, 20224
  v_lshlrev_b32 v77, 4, v77
  buffer_load_dwordx4 v59, s[8:11], s54 offen offset:256 nt lds
  v_mul_u32_u24 v62, 1152, v57
  v_add_u32 v61, v77, v62
  s_mul_i32 s44, s3, 9216
  v_lshlrev_b32 v73, 1, v73
  v_xor_b32 v73, v54, v73
  v_mul_u32_u24 v77, 0x180, v57
  v_lshl_add_u32 v56, v73, 4, v77
  s_mul_i32 s45, s3, 3072
  s_mov_b32 s19, s11
  s_mov_b32 s18, 73728
  s_mul_i32 s51, s51, 576
  v_min_u32 v57, 512, v60
  v_add_u32 v6, v58, v77
  s_mov_b32 s27, s11
  s_mov_b32 s26, 100663296
  v_and_b32 v54, 15, v65
  v_lshrrev_b32 v55, 4, v65
  v_lshrrev_b32 v72, 1, v54
  v_lshlrev_b32 v73, 2, v54
  v_and_b32 v73, 4, v73
  v_xor_b32 v72, v72, v73
  v_xor_b32 v72, v55, v72
  v_lshlrev_b32 v72, 4, v72
  v_lshl_add_u32 v0, v54, 7, v72
  v_xor_b32 v1, 64, v0
  v_subrev_u32 v2, s46, v0
  s_add_u32 s28, s46, 28672
  s_add_u32 s29, s46, 53248
  s_mov_b32 s30, s46
  s_and_b32 s4, s3, 1
  v_lshlrev_b32 v72, 4, v54
  v_lshl_add_u32 v73, v55, 10, v72
  s_lshl_b32 s5, s4, 8
  s_add_u32 s5, s5, 77824
  v_add_u32 v3, s5, v73
  v_xor_b32 v4, 0x100, v3
  s_mul_i32 s5, s3, 6144
  s_add_u32 s6, s5, 102400
  s_add_u32 s5, s5, 77824
  s_xor_b32 s41, s5, s6
  v_lshl_add_u32 v73, v55, 2, v72
  v_add_u32 v5, s5, v73
  v_and_b32 v66, 7, v54
  v_lshrrev_b32 v75, 3, v54
  v_and_b32 v74, 1, v55
  v_lshrrev_b32 v76, 1, v55
  v_mul_u32_u24 v72, 0x600, v74
  v_mul_u32_u24 v73, s57, v76
  v_add_u32 v72, v72, v73
  v_lshl_add_u32 v72, v54, 2, v72
  s_lshr_b32 s49, s3, 1
  s_lshl_b32 s5, s49, 6
  s_add_u32 s6, s5, 256
  v_add_u32 v53, s6, v72
  s_lshl_b32 s6, s4, 7
  s_add_u32 s5, s5, s6
  v_add_u32 v52, s5, v72
  s_lshl_b32 s5, s47, 3
  s_add_u32 s5, s5, 4
  s_mul_i32 s5, s5, 384
  s_cmp_eq_u32 s47, 63
  s_cselect_b32 s37, 0, s5
  s_cselect_b32 s5, s5, 0
  s_cselect_b32 s6, s57, 0
  v_mul_u32_u24 v73, s6, v74
  v_sub_u32 v73, s5, v73
  v_add_u32 v7, v52, v73
  v_add_u32 v8, v53, v73
  s_lshr_b32 s31, s2, 6
  s_and_b32 s32, s2, 63
  s_mul_i32 s56, s31, 15
  s_lshl_b32 s43, s57, 5
  s_cmp_eq_u32 s32, 63
  s_cselect_b32 s32, s56, s32
  s_cselect_b32 s31, 60, s31
  s_cselect_b32 s43, 3072, s43
  s_mov_b32 s97, 14
  s_mov_b32 s42, 0x3e553b95
  v_lshrrev_b32 v72, 2, v54
  v_lshl_add_u32 v73, v74, 1, v75
  v_lshl_add_u32 v72, v55, 3, v72
  v_lshlrev_b32 v72, 7, v72
  v_lshl_add_u32 v72, v73, 5, v72
  v_and_b32 v78, 3, v54
  v_lshl_add_u32 v72, v78, 3, v72
  v_bfe_u32 v77, v54, 1, 2
  v_and_b32 v55, 12, v54
  v_lshl_add_u32 v55, v55, 1, v78
  v_lshl_add_u32 v55, v55, 2, v77
  v_lshl_add_u32 v55, v55, 1, v74
  v_lshlrev_b32 v55, 4, v55
  v_cmp_eq_u32 vcc, 0, v76
  v_mov_b32 v77, 14702
  v_mov_b32 v62, 15957
  v_cndmask_b32 v77, v77, v62, vcc
  v_cmp_eq_u32 vcc, v75, v74
  v_and_b32 v62, 1, v54
  v_lshlrev_b32 v62, 4, v62
  v_cndmask_b32 v77, 0, v77, vcc
  v_lshlrev_b32 v77, v62, v77
  v_bfe_u32 v62, v54, 1, 2
  v_cmp_eq_u32 vcc, 0, v62
  s_nop 1
  v_cndmask_b32 v84, 0, v77, vcc
  v_cmp_eq_u32 vcc, 1, v62
  s_nop 1
  v_cndmask_b32 v85, 0, v77, vcc
  v_cmp_eq_u32 vcc, 2, v62
  s_nop 1
  v_cndmask_b32 v86, 0, v77, vcc
  v_cmp_eq_u32 vcc, 3, v62
  s_nop 1
  v_cndmask_b32 v87, 0, v77, vcc
  s_mul_i32 s5, s3, 3
  s_and_b32 s6, s5, 3
  s_lshl_b32 s6, s6, 5
  s_lshr_b32 s7, s5, 2
  s_lshl_b32 s7, s7, 13
  s_add_u32 s7, s7, 28672
  v_xor_b32 v73, s6, v72
  v_add_u32 v62, s7, v73
  v_add_u32 v58, 73728, v62
  v_xor_b32 v73, s6, v55
  v_add_u32 v136, s7, v73
  s_add_u32 s5, s5, 1
  s_and_b32 s6, s5, 3
  s_lshl_b32 s6, s6, 5
  s_lshr_b32 s7, s5, 2
  s_lshl_b32 s7, s7, 13
  s_add_u32 s7, s7, 28672
  v_xor_b32 v73, s6, v72
  v_add_u32 v63, s7, v73
  v_add_u32 v59, 73728, v63
  v_xor_b32 v73, s6, v55
  v_add_u32 v64, s7, v73
  s_add_u32 s5, s5, 1
  s_and_b32 s6, s5, 3
  s_lshl_b32 s6, s6, 5
  s_lshr_b32 s7, s5, 2
  s_lshl_b32 s7, s7, 13
  s_add_u32 s7, s7, 28672
  v_xor_b32 v73, s6, v72
  v_add_u32 v71, s7, v73
  v_add_u32 v60, 73728, v71
  v_xor_b32 v73, s6, v55
  v_add_u32 v70, s7, v73
  v_xor_b32 v73, s49, v74
  s_lshl_b32 s5, s4, 13
  v_lshl_add_u32 v72, v76, 3, v74
  v_lshl_add_u32 v72, v72, 2, v73
  v_lshl_add_u32 v72, v72, 4, v54
  v_lshlrev_b32 v72, 2, v72
  s_add_u32 s5, s5, 126976
  v_add_u32 v68, s5, v72
  v_add_u32 v69, 128, v68
  v_add_u32 v54, 143360, v72
  v_add_u32 v55, 128, v54
  s_mov_b32 s58, 0x05040100
  s_mov_b32 s59, 0x07060302
  v_cmp_gt_u32 vcc, 2, v78
  v_mov_b32 v72, 0x3f803f80
  v_mov_b32 v73, 0x44444444
  v_cndmask_b32 v72, 0, v72, vcc
  v_cmp_eq_u32 vcc, 1, v78
  v_mov_b32 v77, 0xeeeeeeee
  v_accvgpr_write_b32 a240, v72
  v_accvgpr_write_b32 a241, v72
  v_accvgpr_write_b32 a242, v72
  v_accvgpr_write_b32 a243, v72
  v_cndmask_b32 v10, v73, v77, vcc
  v_mov_b32 v9, 1.0
  s_mov_b32 s98, s43
  s_mov_b64 s[20:21], s[62:63]
  s_mov_b32 s22, 402653184
  s_min_u32 s96, s3, 1
  s_lshl_b32 s96, s96, 7
  s_xor_b32 s96, s96, 1152
  s_bitset1_b32 s96, s97
  s_mov_b64 s[62:63], -1
  v_lshlrev_b32 v11, 3, v65
  v_lshlrev_b32 v72, 2, v66
  v_add_u32 v72, 159808, v72
  v_mov_b32 v73, 0
  ds_write_b32 v72, v73
  s_lshl_b32 m0, s3, 8
  s_nop 0
  ds_write_addtid_b32 v73 offset:24576
  v_mov_b64 v[14:15], 0
  v_mov_b64 v[20:21], 0
  v_sub_u32 v72, v75, v76
  v_mul_i32_i24 v72, 15, v72
  v_lshlrev_b32 v73, 2, v74
  v_sub_u32 v77, v66, v73
  v_add3_u32 v72, v72, v77, 19
  s_mul_i32 s5, s3, 2050
  s_add_u32 s5, s5, 151552
  v_lshl_add_u32 v74, v72, 3, s5
  v_mov_b64 v[24:25], 0
  v_mov_b64 v[26:27], 0
  v_mov_b64 v[28:29], 0
  v_mov_b64 v[30:31], 0
  v_mov_b64 v[32:33], 0
  v_mov_b64 v[34:35], 0
  v_mov_b64 v[36:37], 0
  v_mov_b64 v[38:39], 0
  v_mov_b64 v[40:41], 0
  v_mov_b64 v[42:43], 0
  v_mov_b64 v[44:45], 0
  v_mov_b64 v[46:47], 0
  v_mov_b64 v[48:49], 0
  v_mov_b64 v[50:51], 0
  v_xor_b32 v72, v73, v66
  s_cmp_eq_u32 s47, 63
  s_cselect_b32 s5, 4, 0
  v_and_b32 v72, s5, v72
  v_cmp_eq_u32 vcc, 0, v72
  s_cmp_eq_u32 s48, 63
  s_cselect_b32 s5, 0xc31044fe, 0
  v_mov_b32 v65, s5
  v_mov_b32 v66, 0xc31044fe
  v_cndmask_b32 v65, 0, v65, vcc
  v_cndmask_b32 v66, v66, 0, vcc
  s_mov_b64 exec, 0
  s_cmp_eq_u32 s3, 0
  s_cbranch_scc1 L_hop_0_0
  s_cmp_eq_u32 s3, 1
  s_cbranch_scc1 L_hop_1_0
  s_cmp_eq_u32 s3, 2
  s_cbranch_scc1 L_hop_2_0
  s_branch L_hop_3_0
L_walk:
  s_mov_b64 exec, -1
L_walked:
  s_add_u32 s5, s44, 0
  s_add_u32 m0, s46, 28672
  s_nop 0
  buffer_load_dwordx4 v61, s[12:15], s5 offen offset:0 lds
  s_add_u32 m0, s46, 36736
  s_nop 0
  buffer_load_dwordx4 v61, s[12:15], s5 offen offset:128 lds
  s_add_u32 m0, s46, 44800
  s_nop 0
  buffer_load_dwordx4 v61, s[12:15], s5 offen offset:256 lds
  s_add_u32 s5, s44, 36864
  s_add_u32 m0, s46, 32768
  s_nop 0
  buffer_load_dwordx4 v61, s[12:15], s5 offen offset:0 lds
  s_add_u32 m0, s46, 40832
  s_nop 0
  buffer_load_dwordx4 v61, s[12:15], s5 offen offset:128 lds
  s_add_u32 m0, s46, 48896
  s_nop 0
  buffer_load_dwordx4 v61, s[12:15], s5 offen offset:256 lds
  s_waitcnt vmcnt(12)
  ds_read_u16_d16_hi v24, v74 offset:24
  ds_read_u16_d16_hi v25, v74 offset:16
  ds_read_u16_d16_hi v26, v74 offset:8
  ds_read_u16_d16_hi v27, v74 offset:0
  ds_read_u16_d16_hi v28, v74 offset:264
  ds_read_u16_d16_hi v29, v74 offset:256
  ds_read_u16_d16_hi v30, v74 offset:248
  ds_read_u16_d16_hi v31, v74 offset:240
  ds_read_u16_d16_hi v32, v74 offset:504
  ds_read_u16_d16_hi v33, v74 offset:496
  ds_read_u16_d16_hi v34, v74 offset:488
  ds_read_u16_d16_hi v35, v74 offset:480
  ds_read_u16_d16_hi v36, v74 offset:744
  ds_read_u16_d16_hi v37, v74 offset:736
  ds_read_u16_d16_hi v38, v74 offset:728
  ds_read_u16_d16_hi v39, v74 offset:720
  ds_read_u16_d16_hi v40, v74 offset:984
  ds_read_u16_d16_hi v41, v74 offset:976
  ds_read_u16_d16_hi v42, v74 offset:968
  ds_read_u16_d16_hi v43, v74 offset:960
  ds_read_u16_d16_hi v44, v74 offset:1224
  ds_read_u16_d16_hi v45, v74 offset:1216
  ds_read_u16_d16_hi v46, v74 offset:1208
  ds_read_u16_d16_hi v47, v74 offset:1200
  ds_read_u16_d16_hi v48, v74 offset:1464
  ds_read_u16_d16_hi v49, v74 offset:1456
  ds_read_u16_d16_hi v50, v74 offset:1448
  ds_read_u16_d16_hi v51, v74 offset:1440
  s_mov_b32 s5, 0x3fb8aa3b
  v_add_f32 v65, v66, v65
  s_waitcnt lgkmcnt(15)
  v_mul_f32 v24, s5, v24
  v_mul_f32 v25, s5, v25
  v_mul_f32 v26, s5, v26
  v_mul_f32 v27, s5, v27
  v_mul_f32 v28, s5, v28
  v_mul_f32 v29, s5, v29
  v_mul_f32 v30, s5, v30
  v_mul_f32 v31, s5, v31
  v_mul_f32 v32, s5, v32
  v_mul_f32 v33, s5, v33
  v_mul_f32 v34, s5, v34
  v_mul_f32 v35, s5, v35
  v_mul_f32 v36, s5, v36
  s_waitcnt lgkmcnt(14)
  v_mul_f32 v37, s5, v37
  s_waitcnt lgkmcnt(13)
  v_mul_f32 v38, s5, v38
  s_waitcnt lgkmcnt(12)
  v_mul_f32 v39, s5, v39
  s_waitcnt lgkmcnt(11)
  v_mul_f32 v40, s5, v40
  s_waitcnt lgkmcnt(10)
  v_mul_f32 v41, s5, v41
  s_waitcnt lgkmcnt(9)
  v_mul_f32 v42, s5, v42
  s_waitcnt lgkmcnt(8)
  v_mul_f32 v43, s5, v43
  s_waitcnt lgkmcnt(7)
  v_mul_f32 v44, s5, v44
  s_waitcnt lgkmcnt(6)
  v_mul_f32 v45, s5, v45
  s_waitcnt lgkmcnt(5)
  v_mul_f32 v46, s5, v46
  s_waitcnt lgkmcnt(4)
  v_mul_f32 v47, s5, v47
  s_waitcnt lgkmcnt(3)
  v_mul_f32 v48, s5, v48
  s_waitcnt lgkmcnt(2)
  v_mul_f32 v49, s5, v49
  s_waitcnt lgkmcnt(1)
  v_mul_f32 v50, s5, v50
  s_waitcnt lgkmcnt(0)
  v_mul_f32 v51, s5, v51
  v_add_f32 v72, v65, v32
  v_add_f32 v73, v65, v33
  v_add_f32 v74, v65, v34
  v_add_f32 v75, v65, v35
  v_add_f32 v76, v65, v28
  v_add_f32 v77, v65, v29
  v_add_f32 v78, v65, v30
  v_add_f32 v79, v65, v31
  v_add_f32 v80, v65, v24
  v_add_f32 v81, v65, v25
  v_add_f32 v82, v65, v26
  v_add_f32 v83, v65, v27
  s_add_u32 s5, s44, 73728
  s_add_u32 m0, s46, 53248
  s_nop 0
  buffer_load_dwordx4 v61, s[12:15], s5 offen offset:0 lds
  s_add_u32 m0, s46, 61312
  s_nop 0
  buffer_load_dwordx4 v61, s[12:15], s5 offen offset:128 lds
  s_add_u32 m0, s46, 69376
  s_nop 0
  buffer_load_dwordx4 v61, s[12:15], s5 offen offset:256 lds
  s_add_u32 s5, s44, 110592
  s_add_u32 m0, s46, 57344
  s_nop 0
  buffer_load_dwordx4 v61, s[12:15], s5 offen offset:0 lds
  s_add_u32 m0, s46, 65408
  s_nop 0
  buffer_load_dwordx4 v61, s[12:15], s5 offen offset:128 lds
  s_add_u32 m0, s46, 73472
  s_nop 0
  buffer_load_dwordx4 v61, s[12:15], s5 offen offset:256 lds
  s_cmp_eq_u32 s43, 3072
  s_cselect_b32 s10, s10, 95158272
  s_waitcnt vmcnt(12)
  s_barrier
  ds_read_b128 v[184:187], v0 offset:0
  ds_read_b128 v[188:191], v1 offset:0
  ds_read_b128 v[208:211], v0 offset:2048
  ds_read_b128 v[212:215], v1 offset:2048
  ds_read_b128 v[232:235], v0 offset:4096
  ds_read_b128 v[236:239], v1 offset:4096
  ds_read_b128 a[216:219], v0 offset:6144
  ds_read_b128 a[220:223], v1 offset:6144
  s_add_u32 s5, s44, 147456
  s_add_u32 m0, s46, 77824
  s_nop 0
  buffer_load_dwordx4 v61, s[12:15], s5 offen offset:0 lds
  s_add_u32 m0, s46, 85888
  s_nop 0
  buffer_load_dwordx4 v61, s[12:15], s5 offen offset:128 lds
  s_add_u32 m0, s46, 93952
  s_nop 0
  buffer_load_dwordx4 v61, s[12:15], s5 offen offset:256 lds
  s_waitcnt vmcnt(9)
  s_barrier
  ds_read_b128 a[72:75], v136 offset:0
  ds_read_b128 a[76:79], v136 offset:512
  ds_read_b128 a[80:83], v136 offset:4096
  ds_read_b128 a[84:87], v136 offset:4608
  ds_read_b128 a[88:91], v64 offset:0
  ds_read_b128 a[92:95], v64 offset:512
  ds_read_b128 a[96:99], v64 offset:4096
  ds_read_b128 a[100:103], v64 offset:4608
  s_waitcnt lgkmcnt(7)
  v_mfma_f32_16x16x32_bf16 v[92:95], a[72:75], v[84:87], 0
  s_add_u32 s5, s44, 184320
  s_add_u32 m0, s46, 81920
  ds_read_b128 a[104:107], v70 offset:0
  s_waitcnt lgkmcnt(7)
  v_mfma_f32_16x16x32_bf16 v[112:115], a[76:79], v[84:87], 0
  buffer_load_dwordx4 v61, s[12:15], s5 offen offset:0 lds
  s_waitcnt lgkmcnt(6)
  v_mfma_f32_16x16x32_bf16 v[100:103], a[80:83], v[84:87], 0
  s_add_u32 m0, s46, 89984
  ds_read_b128 a[108:111], v70 offset:512
  ds_read_b128 a[112:115], v70 offset:4096
  s_waitcnt lgkmcnt(7)
  v_mfma_f32_16x16x32_bf16 v[108:111], a[84:87], v[84:87], 0
  buffer_load_dwordx4 v61, s[12:15], s5 offen offset:128 lds
  s_waitcnt lgkmcnt(6)
  v_mfma_f32_16x16x32_bf16 v[96:99], a[88:91], v[84:87], 0
  s_add_u32 m0, s46, 98048
  ds_read_b128 a[116:119], v70 offset:4608
  v_cvt_pk_bf16_f32 v104, v92, v93
  s_waitcnt lgkmcnt(6)
  v_mfma_f32_16x16x32_bf16 v[132:135], a[92:95], v[84:87], 0
  buffer_load_dwordx4 v61, s[12:15], s5 offen offset:256 lds
  s_waitcnt lgkmcnt(5)
  v_mfma_f32_16x16x32_bf16 v[88:91], a[96:99], v[84:87], 0
  s_add_u32 s5, s44, 384
  s_add_u32 m0, s46, 102400
  v_cvt_pk_bf16_f32 v105, v94, v95
  s_waitcnt lgkmcnt(4)
  v_mfma_f32_16x16x32_bf16 v[116:119], a[100:103], v[84:87], 0
  s_waitcnt lgkmcnt(1)
  v_cvt_pk_bf16_f32 v106, v112, v113
  v_cvt_pk_bf16_f32 v107, v114, v115
  v_mfma_f32_16x16x32_bf16 v[128:131], a[104:107], v[84:87], 0
  buffer_load_dwordx4 v61, s[12:15], s5 offen offset:0 lds
  v_mfma_f32_16x16x32_bf16 v[120:123], a[108:111], v[84:87], 0
  s_add_u32 m0, s46, 110464
  v_cvt_pk_bf16_f32 v124, v100, v101
  v_cvt_pk_bf16_f32 v125, v102, v103
  v_mfma_f32_16x16x32_bf16 v[92:95], a[112:115], v[84:87], 0
  s_waitcnt lgkmcnt(0)
  v_cvt_pk_bf16_f32 v126, v108, v109
  v_cvt_pk_bf16_f32 v127, v110, v111
  v_mfma_f32_16x16x32_bf16 v[112:115], a[116:119], v[84:87], 0
  v_cvt_pk_bf16_f32 v160, v96, v97
  v_cvt_pk_bf16_f32 v161, v98, v99
  v_mfma_f32_16x16x32_bf16 v[108:111], v[104:107], v[184:187], 0
  v_cvt_pk_bf16_f32 v162, v132, v133
  v_cvt_pk_bf16_f32 v163, v134, v135
  v_mfma_f32_16x16x32_bf16 v[108:111], v[124:127], v[188:191], v[108:111]
  buffer_load_dwordx4 v61, s[12:15], s5 offen offset:128 lds
  v_mfma_f32_16x16x32_bf16 v[96:99], v[104:107], v[208:211], 0
  s_add_u32 m0, s46, 118528
  v_cvt_pk_bf16_f32 v156, v88, v89
  v_cvt_pk_bf16_f32 v157, v90, v91
  v_mfma_f32_16x16x32_bf16 v[96:99], v[124:127], v[212:215], v[96:99]
  v_cvt_pk_bf16_f32 v158, v116, v117
  v_cvt_pk_bf16_f32 v159, v118, v119
  v_mfma_f32_16x16x32_bf16 v[132:135], v[104:107], v[232:235], 0
  v_cvt_pk_bf16_f32 v140, v128, v129
  v_cvt_pk_bf16_f32 v141, v130, v131
  v_mfma_f32_16x16x32_bf16 v[132:135], v[124:127], v[236:239], v[132:135]
  v_cvt_pk_bf16_f32 v142, v120, v121
  v_cvt_pk_bf16_f32 v143, v122, v123
  v_mfma_f32_16x16x32_bf16 v[88:91], v[104:107], a[216:219], 0
  buffer_load_dwordx4 v61, s[12:15], s5 offen offset:256 lds
  v_mfma_f32_16x16x32_bf16 v[88:91], v[124:127], a[220:223], v[88:91]
  s_waitcnt vmcnt(9)
  s_barrier
  v_mfma_f32_16x16x32_bf16 v[100:103], v[160:163], v[184:187], 0
  s_add_u32 s5, s44, 37248
  v_cvt_pk_bf16_f32 v144, v92, v93
  v_cvt_pk_bf16_f32 v145, v94, v95
  v_cvt_pk_bf16_f32 v146, v112, v113
  v_cvt_pk_bf16_f32 v147, v114, v115
  v_mfma_f32_16x16x32_bf16 v[100:103], v[156:159], v[188:191], v[100:103]
  s_add_u32 m0, s46, 106496
  ds_read_b128 a[120:123], v136 offset:24576
  ds_read_b128 a[124:127], v136 offset:25088
  v_mfma_f32_16x16x32_bf16 v[112:115], v[160:163], v[208:211], 0
  buffer_load_dwordx4 v61, s[12:15], s5 offen offset:0 lds
  v_mfma_f32_16x16x32_bf16 v[112:115], v[156:159], v[212:215], v[112:115]
  s_add_u32 m0, s46, 114560
  ds_read_b128 a[128:131], v136 offset:28672
  ds_read_b128 a[132:135], v136 offset:29184
  v_mfma_f32_16x16x32_bf16 v[116:119], v[160:163], v[232:235], 0
  buffer_load_dwordx4 v61, s[12:15], s5 offen offset:128 lds
  v_mfma_f32_16x16x32_bf16 v[116:119], v[156:159], v[236:239], v[116:119]
  s_add_u32 m0, s46, 122624
  ds_read_b128 a[136:139], v64 offset:24576
  v_accvgpr_write_b32 a0, v104
  v_mfma_f32_16x16x32_bf16 v[92:95], v[160:163], a[216:219], 0
  v_accvgpr_write_b32 a1, v105
  v_accvgpr_write_b32 a2, v106
  v_mfma_f32_16x16x32_bf16 v[92:95], v[156:159], a[220:223], v[92:95]
L_hop_0_0:
  s_cbranch_execz L_hop_0_1
  s_waitcnt lgkmcnt(3)
  ds_read_b128 a[140:143], v64 offset:25088
  v_accvgpr_write_b32 a3, v107
  v_mfma_f32_16x16x32_bf16 v[128:131], a[120:123], v[84:87], 0
  buffer_load_dwordx4 v61, s[12:15], s5 offen offset:256 lds
  v_mfma_f32_16x16x32_bf16 v[152:155], a[124:127], v[84:87], 0
  s_waitcnt lgkmcnt(2)
  v_accvgpr_write_b32 a12, v124
  v_accvgpr_write_b32 a13, v125
  v_mfma_f32_16x16x32_bf16 v[104:107], a[128:131], v[84:87], 0
  v_accvgpr_write_b32 a14, v126
  v_accvgpr_write_b32 a15, v127
  v_mfma_f32_16x16x32_bf16 v[164:167], a[132:135], v[84:87], 0
  ds_read_b128 a[144:147], v64 offset:28672
  v_cvt_pk_bf16_f32 v148, v128, v129
  v_mfma_f32_16x16x32_bf16 v[120:123], v[140:143], v[184:187], 0
  v_cvt_pk_bf16_f32 v149, v130, v131
  v_cvt_pk_bf16_f32 v150, v152, v153
  v_mfma_f32_16x16x32_bf16 v[120:123], v[144:147], v[188:191], v[120:123]
  ds_read_b128 v[192:195], v0 offset:8192
  v_cvt_pk_bf16_f32 v151, v154, v155
  v_mfma_f32_16x16x32_bf16 v[128:131], v[140:143], v[208:211], 0
  ds_read_b128 a[148:151], v64 offset:29184
  ds_read_b128 v[196:199], v1 offset:8192
  v_mfma_f32_16x16x32_bf16 v[128:131], v[144:147], v[212:215], v[128:131]
  v_cvt_pk_bf16_f32 v152, v104, v105
  v_cvt_pk_bf16_f32 v153, v106, v107
  v_mfma_f32_16x16x32_bf16 v[124:127], v[140:143], v[232:235], 0
  v_cvt_pk_bf16_f32 v154, v164, v165
  v_cvt_pk_bf16_f32 v155, v166, v167
  v_mfma_f32_16x16x32_bf16 v[124:127], v[144:147], v[236:239], v[124:127]
  ds_read_b128 v[216:219], v0 offset:10240
  ds_read_b128 v[220:223], v1 offset:10240
  v_mfma_f32_16x16x32_bf16 v[104:107], v[140:143], a[216:219], 0
  ds_read_b128 v[240:243], v0 offset:12288
  ds_read_b128 v[244:247], v1 offset:12288
  v_mfma_f32_16x16x32_bf16 v[104:107], v[144:147], a[220:223], v[104:107]
  s_waitcnt lgkmcnt(4)
  v_accvgpr_write_b32 a4, v160
  v_accvgpr_write_b32 a5, v161
  v_mfma_f32_16x16x32_bf16 v[176:179], a[136:139], v[84:87], 0
  v_accvgpr_write_b32 a6, v162
  v_accvgpr_write_b32 a7, v163
  v_mfma_f32_16x16x32_bf16 v[172:175], a[140:143], v[84:87], 0
  s_add_u32 s5, s44, 74112
  ds_read_b128 a[224:227], v0 offset:14336
  v_accvgpr_write_b32 a16, v156
  v_mfma_f32_16x16x32_bf16 v[164:167], a[144:147], v[84:87], 0
  s_add_u32 m0, s46, 126976
  v_accvgpr_write_b32 a17, v157
  v_accvgpr_write_b32 a18, v158
  v_mfma_f32_16x16x32_bf16 v[168:171], a[148:151], v[84:87], 0
  s_waitcnt lgkmcnt(1)
  ds_read_b128 a[228:231], v1 offset:14336
  v_accvgpr_write_b32 a19, v159
  v_mfma_f32_16x16x32_bf16 v[108:111], v[148:151], v[192:195], v[108:111]
  buffer_load_dwordx4 v61, s[12:15], s5 offen offset:0 lds
  v_mfma_f32_16x16x32_bf16 v[108:111], v[152:155], v[196:199], v[108:111]
  s_add_u32 m0, s46, 135040
  ds_read_b128 a[152:155], v70 offset:24576
  ds_read_b128 a[156:159], v70 offset:25088
  v_mfma_f32_16x16x32_bf16 v[96:99], v[148:151], v[216:219], v[96:99]
  ds_read_b128 a[160:163], v70 offset:28672
  v_cvt_pk_bf16_f32 v156, v176, v177
  v_mfma_f32_16x16x32_bf16 v[96:99], v[152:155], v[220:223], v[96:99]
  v_cvt_pk_bf16_f32 v157, v178, v179
  v_cvt_pk_bf16_f32 v158, v172, v173
  v_mfma_f32_16x16x32_bf16 v[132:135], v[148:151], v[240:243], v[132:135]
  s_waitcnt lgkmcnt(3)
  ds_read_b128 a[164:167], v70 offset:29184
  v_cvt_pk_bf16_f32 v159, v174, v175
  v_mfma_f32_16x16x32_bf16 v[132:135], v[152:155], v[244:247], v[132:135]
  buffer_load_dwordx4 v61, s[12:15], s5 offen offset:128 lds
  v_mfma_f32_16x16x32_bf16 v[88:91], v[148:151], a[224:227], v[88:91]
  s_add_u32 m0, s46, 143104
  v_cvt_pk_bf16_f32 v160, v164, v165
  v_cvt_pk_bf16_f32 v161, v166, v167
  v_mfma_f32_16x16x32_bf16 v[88:91], v[152:155], a[228:231], v[88:91]
  s_waitcnt lgkmcnt(1)
  v_cvt_pk_bf16_f32 v162, v168, v169
  v_cvt_pk_bf16_f32 v163, v170, v171
  v_mfma_f32_16x16x32_bf16 v[176:179], a[152:155], v[84:87], 0
  buffer_load_dwordx4 v61, s[12:15], s5 offen offset:256 lds
  v_mfma_f32_16x16x32_bf16 v[164:167], a[156:159], v[84:87], 0
  s_add_u32 s5, s44, 110976
  v_accvgpr_write_b32 a8, v140
  v_accvgpr_write_b32 a9, v141
  v_mfma_f32_16x16x32_bf16 v[168:171], a[160:163], v[84:87], 0
  s_add_u32 m0, s46, 131072
  v_accvgpr_write_b32 a10, v142
  v_accvgpr_write_b32 a11, v143
  s_waitcnt lgkmcnt(0)
  v_mfma_f32_16x16x32_bf16 v[172:175], a[164:167], v[84:87], 0
  s_waitcnt vmcnt(9)
  s_barrier
  v_mfma_f32_16x16x32_bf16 v[100:103], v[156:159], v[192:195], v[100:103]
  v_accvgpr_write_b32 a20, v144
  v_accvgpr_write_b32 a21, v145
  v_mfma_f32_16x16x32_bf16 v[100:103], v[160:163], v[196:199], v[100:103]
  v_accvgpr_write_b32 a22, v146
  v_accvgpr_write_b32 a23, v147
  v_mfma_f32_16x16x32_bf16 v[112:115], v[156:159], v[216:219], v[112:115]
  buffer_load_dwordx4 v61, s[12:15], s5 offen offset:0 lds
  v_mfma_f32_16x16x32_bf16 v[112:115], v[160:163], v[220:223], v[112:115]
  s_add_u32 m0, s46, 139136
  ds_read_b128 a[168:171], v136 offset:49152
  ds_read_b128 a[172:175], v136 offset:49664
  v_mfma_f32_16x16x32_bf16 v[116:119], v[156:159], v[240:243], v[116:119]
  ds_read_b128 a[176:179], v136 offset:53248
  v_cvt_pk_bf16_f32 v140, v176, v177
  v_mfma_f32_16x16x32_bf16 v[116:119], v[160:163], v[244:247], v[116:119]
  v_cvt_pk_bf16_f32 v141, v178, v179
  v_cvt_pk_bf16_f32 v142, v164, v165
  v_mfma_f32_16x16x32_bf16 v[92:95], v[156:159], a[224:227], v[92:95]
  s_waitcnt lgkmcnt(2)
  ds_read_b128 a[180:183], v136 offset:53760
  v_cvt_pk_bf16_f32 v143, v166, v167
  buffer_load_dwordx4 v61, s[12:15], s5 offen offset:128 lds
  v_mfma_f32_16x16x32_bf16 v[92:95], v[160:163], a[228:231], v[92:95]
  s_add_u32 m0, s46, 147200
  v_cvt_pk_bf16_f32 v164, v168, v169
  v_cvt_pk_bf16_f32 v165, v170, v171
  v_mfma_f32_16x16x32_bf16 v[144:147], a[168:171], v[84:87], 0
  s_waitcnt lgkmcnt(2)
  v_cvt_pk_bf16_f32 v166, v172, v173
  v_cvt_pk_bf16_f32 v167, v174, v175
  v_mfma_f32_16x16x32_bf16 v[176:179], a[172:175], v[84:87], 0
  buffer_load_dwordx4 v61, s[12:15], s5 offen offset:256 lds
  s_waitcnt lgkmcnt(1)
  v_mfma_f32_16x16x32_bf16 v[168:171], a[176:179], v[84:87], 0
  s_waitcnt lgkmcnt(0)
  v_accvgpr_write_b32 a24, v148
  v_accvgpr_write_b32 a25, v149
  v_mfma_f32_16x16x32_bf16 v[172:175], a[180:183], v[84:87], 0
  v_accvgpr_write_b32 a26, v150
  v_accvgpr_write_b32 a27, v151
  v_mfma_f32_16x16x32_bf16 v[120:123], v[140:143], v[192:195], v[120:123]
  v_accvgpr_write_b32 a36, v152
  v_accvgpr_write_b32 a37, v153
  v_mfma_f32_16x16x32_bf16 v[120:123], v[164:167], v[196:199], v[120:123]
  v_accvgpr_write_b32 a38, v154
  v_accvgpr_write_b32 a39, v155
  v_mfma_f32_16x16x32_bf16 v[128:131], v[140:143], v[216:219], v[128:131]
  ds_read_b128 a[184:187], v64 offset:49152
  ds_read_b128 a[188:191], v64 offset:49664
  v_mfma_f32_16x16x32_bf16 v[128:131], v[164:167], v[220:223], v[128:131]
  ds_read_b128 a[192:195], v64 offset:53248
  v_cvt_pk_bf16_f32 v136, v144, v145
  v_mfma_f32_16x16x32_bf16 v[124:127], v[140:143], v[240:243], v[124:127]
  v_cvt_pk_bf16_f32 v137, v146, v147
  v_cvt_pk_bf16_f32 v138, v176, v177
  v_mfma_f32_16x16x32_bf16 v[124:127], v[164:167], v[244:247], v[124:127]
  ds_read_b128 v[200:203], v0 offset:16384
  v_cvt_pk_bf16_f32 v139, v178, v179
  v_mfma_f32_16x16x32_bf16 v[104:107], v[140:143], a[224:227], v[104:107]
  ds_read_b128 a[196:199], v64 offset:53760
  ds_read_b128 v[204:207], v1 offset:16384
  v_mfma_f32_16x16x32_bf16 v[104:107], v[164:167], a[228:231], v[104:107]
  s_waitcnt lgkmcnt(4)
  v_cvt_pk_bf16_f32 v144, v168, v169
  v_cvt_pk_bf16_f32 v145, v170, v171
  v_mfma_f32_16x16x32_bf16 v[176:179], a[184:187], v[84:87], 0
  ds_read_b128 v[224:227], v0 offset:18432
  v_cvt_pk_bf16_f32 v146, v172, v173
  v_cvt_pk_bf16_f32 v147, v174, v175
  v_mfma_f32_16x16x32_bf16 v[152:155], a[188:191], v[84:87], 0
  s_waitcnt lgkmcnt(4)
  ds_read_b128 v[228:231], v1 offset:18432
  ds_read_b128 v[248:251], v0 offset:20480
  v_mfma_f32_16x16x32_bf16 v[168:171], a[192:195], v[84:87], 0
  s_waitcnt lgkmcnt(4)
  ds_read_b128 v[252:255], v1 offset:20480
  v_accvgpr_write_b32 a28, v156
  v_mfma_f32_16x16x32_bf16 v[172:175], a[196:199], v[84:87], 0
  v_accvgpr_write_b32 a29, v157
  v_accvgpr_write_b32 a30, v158
  v_mfma_f32_16x16x32_bf16 v[108:111], v[136:139], v[200:203], v[108:111]
  s_waitcnt lgkmcnt(4)
  ds_read_b128 a[232:235], v0 offset:22528
  v_accvgpr_write_b32 a31, v159
  v_mfma_f32_16x16x32_bf16 v[108:111], v[144:147], v[204:207], v[108:111]
  s_waitcnt lgkmcnt(4)
  ds_read_b128 a[236:239], v1 offset:22528
  v_accvgpr_write_b32 a40, v160
  v_accvgpr_write_b32 a41, v161
  v_accvgpr_write_b32 a42, v162
  v_accvgpr_write_b32 a43, v163
  v_mfma_f32_16x16x32_bf16 v[96:99], v[136:139], v[224:227], v[96:99]
  s_waitcnt lgkmcnt(3)
  ds_read_b128 a[200:203], v70 offset:49152
  ds_read_b128 a[204:207], v70 offset:49664
  v_mfma_f32_16x16x32_bf16 v[96:99], v[144:147], v[228:231], v[96:99]
  s_waitcnt lgkmcnt(3)
  ds_read_b128 a[208:211], v70 offset:53248
  v_cvt_pk_bf16_f32 v148, v176, v177
  v_mfma_f32_16x16x32_bf16 v[132:135], v[136:139], v[248:251], v[132:135]
  v_cvt_pk_bf16_f32 v149, v178, v179
  v_cvt_pk_bf16_f32 v150, v152, v153
  v_mfma_f32_16x16x32_bf16 v[132:135], v[144:147], v[252:255], v[132:135]
  s_add_u32 s5, s44, 147840
  ds_read_b128 a[212:215], v70 offset:53760
  v_cvt_pk_bf16_f32 v151, v154, v155
  v_mfma_f32_16x16x32_bf16 v[88:91], v[136:139], a[232:235], v[88:91]
  s_add_u32 m0, s46, 28672
  v_cvt_pk_bf16_f32 v152, v168, v169
  v_cvt_pk_bf16_f32 v153, v170, v171
  s_waitcnt lgkmcnt(4)
  v_mfma_f32_16x16x32_bf16 v[88:91], v[144:147], a[236:239], v[88:91]
  s_waitcnt lgkmcnt(2)
  v_cvt_pk_bf16_f32 v154, v172, v173
  v_cvt_pk_bf16_f32 v155, v174, v175
  v_mfma_f32_16x16x32_bf16 v[180:183], a[200:203], v[84:87], 0
  buffer_load_dwordx4 v61, s[12:15], s5 offen offset:0 lds
  v_mfma_f32_16x16x32_bf16 v[176:179], a[204:207], v[84:87], 0
  s_add_u32 m0, s46, 36736
  v_accvgpr_write_b32 a32, v140
  v_accvgpr_write_b32 a33, v141
  s_waitcnt lgkmcnt(1)
  v_mfma_f32_16x16x32_bf16 v[160:163], a[208:211], v[84:87], 0
  s_waitcnt lgkmcnt(0)
  v_accvgpr_write_b32 a34, v142
  v_accvgpr_write_b32 a35, v143
  v_mfma_f32_16x16x32_bf16 v[168:171], a[212:215], v[84:87], 0
  v_accvgpr_write_b32 a44, v164
  v_accvgpr_write_b32 a45, v165
  v_mfma_f32_16x16x32_bf16 v[100:103], v[148:151], v[200:203], v[100:103]
  v_accvgpr_write_b32 a46, v166
  v_accvgpr_write_b32 a47, v167
  v_mfma_f32_16x16x32_bf16 v[100:103], v[152:155], v[204:207], v[100:103]
  buffer_load_dwordx4 v61, s[12:15], s5 offen offset:128 lds
  v_mfma_f32_16x16x32_bf16 v[112:115], v[148:151], v[224:227], v[112:115]
  s_add_u32 m0, s46, 44800
  v_cvt_pk_bf16_f32 v156, v180, v181
  v_cvt_pk_bf16_f32 v157, v182, v183
  v_mfma_f32_16x16x32_bf16 v[112:115], v[152:155], v[228:231], v[112:115]
  v_cvt_pk_bf16_f32 v158, v176, v177
  v_cvt_pk_bf16_f32 v159, v178, v179
  v_mfma_f32_16x16x32_bf16 v[116:119], v[148:151], v[248:251], v[116:119]
  buffer_load_dwordx4 v61, s[12:15], s5 offen offset:256 lds
  v_mfma_f32_16x16x32_bf16 v[116:119], v[152:155], v[252:255], v[116:119]
  s_add_u32 s5, s44, 184704
  v_cvt_pk_bf16_f32 v84, v160, v161
  v_cvt_pk_bf16_f32 v85, v162, v163
  v_mfma_f32_16x16x32_bf16 v[92:95], v[148:151], a[232:235], v[92:95]
  s_add_u32 m0, s46, 32768
  v_cvt_pk_bf16_f32 v86, v168, v169
  v_cvt_pk_bf16_f32 v87, v170, v171
  v_mfma_f32_16x16x32_bf16 v[92:95], v[152:155], a[236:239], v[92:95]
  s_waitcnt vmcnt(9)
  s_barrier
  v_mfma_f32_16x16x32_bf16 v[120:123], v[156:159], v[200:203], v[120:123]
  buffer_load_dwordx4 v61, s[12:15], s5 offen offset:0 lds
  v_mfma_f32_16x16x32_bf16 v[120:123], v[84:87], v[204:207], v[120:123]
  s_add_u32 m0, s46, 40832
  ds_read_b64_tr_b16 a[72:73], v58 offset:0
  ds_read_b64_tr_b16 a[74:75], v58 offset:512
  v_mfma_f32_16x16x32_bf16 v[128:131], v[156:159], v[224:227], v[128:131]
  v_accvgpr_write_b32 a48, v136
  v_accvgpr_write_b32 a49, v137
  v_mfma_f32_16x16x32_bf16 v[128:131], v[84:87], v[228:231], v[128:131]
  v_accvgpr_write_b32 a50, v138
  v_accvgpr_write_b32 a51, v139
  v_mfma_f32_16x16x32_bf16 v[124:127], v[156:159], v[248:251], v[124:127]
  ds_read_b64_tr_b16 a[84:85], v58 offset:4096
  ds_read_b64_tr_b16 a[86:87], v58 offset:4608
  v_mfma_f32_16x16x32_bf16 v[124:127], v[84:87], v[252:255], v[124:127]
  s_waitcnt lgkmcnt(2)
  v_accvgpr_write_b32 a60, v144
  v_accvgpr_write_b32 a61, v145
  v_accvgpr_write_b32 a62, v146
  v_accvgpr_write_b32 a63, v147
  v_mfma_f32_16x16x32_bf16 v[104:107], v[156:159], a[232:235], v[104:107]
  buffer_load_dwordx4 v61, s[12:15], s5 offen offset:128 lds
  v_mfma_f32_16x16x32_bf16 v[104:107], v[84:87], a[236:239], v[104:107]
  s_add_u32 m0, s46, 48896
  ds_read_b64_tr_b16 a[76:77], v59 offset:0
  ds_read_b64_tr_b16 a[78:79], v59 offset:512
  v_mfma_f32_16x16x32_bf16 v[144:147], a[72:75], v[184:187], 0
  buffer_load_dwordx4 v61, s[12:15], s5 offen offset:256 lds
  s_waitcnt lgkmcnt(2)
  v_mfma_f32_16x16x32_bf16 v[144:147], a[84:87], v[188:191], v[144:147]
  s_add_u32 s5, s44, 768
  ds_read_b64_tr_b16 a[88:89], v59 offset:4096
  ds_read_b64_tr_b16 a[90:91], v59 offset:4608
  v_mfma_f32_16x16x32_bf16 v[172:175], a[72:75], v[208:211], 0
  s_add_u32 m0, s46, 53248
  v_accvgpr_write_b32 a52, v148
  v_accvgpr_write_b32 a53, v149
  v_mfma_f32_16x16x32_bf16 v[172:175], a[84:87], v[212:215], v[172:175]
  v_accvgpr_write_b32 a54, v150
  v_accvgpr_write_b32 a55, v151
  v_mfma_f32_16x16x32_bf16 v[136:139], a[72:75], v[232:235], 0
  buffer_load_dwordx4 v61, s[12:15], s5 offen offset:0 lds
  v_mfma_f32_16x16x32_bf16 v[136:139], a[84:87], v[236:239], v[136:139]
  s_add_u32 m0, s46, 61312
  v_accvgpr_write_b32 a64, v152
  v_accvgpr_write_b32 a65, v153
  v_mfma_f32_16x16x32_bf16 v[140:143], a[72:75], a[216:219], 0
  v_accvgpr_write_b32 a66, v154
  v_accvgpr_write_b32 a67, v155
  v_mfma_f32_16x16x32_bf16 v[140:143], a[84:87], a[220:223], v[140:143]
  s_waitcnt lgkmcnt(0)
  ds_read_b64_tr_b16 a[80:81], v60 offset:0
  ds_read_b64_tr_b16 a[82:83], v60 offset:512
  v_mfma_f32_16x16x32_bf16 v[176:179], a[76:79], v[184:187], 0
  buffer_load_dwordx4 v61, s[12:15], s5 offen offset:128 lds
  v_mfma_f32_16x16x32_bf16 v[176:179], a[88:91], v[188:191], v[176:179]
  s_add_u32 m0, s46, 69376
  ds_read_b64_tr_b16 a[92:93], v60 offset:4096
  ds_read_b64_tr_b16 a[94:95], v60 offset:4608
  v_mfma_f32_16x16x32_bf16 v[180:183], a[76:79], v[208:211], 0
  v_accvgpr_write_b32 a56, v156
  v_accvgpr_write_b32 a57, v157
  v_mfma_f32_16x16x32_bf16 v[180:183], a[88:91], v[212:215], v[180:183]
  v_accvgpr_write_b32 a58, v158
  v_accvgpr_write_b32 a59, v159
  v_mfma_f32_16x16x32_bf16 v[168:171], a[76:79], v[232:235], 0
  buffer_load_dwordx4 v61, s[12:15], s5 offen offset:256 lds
  v_mfma_f32_16x16x32_bf16 v[168:171], a[88:91], v[236:239], v[168:171]
  s_add_u32 s5, s44, 37632
  v_accvgpr_write_b32 a68, v84
  v_accvgpr_write_b32 a69, v85
  v_mfma_f32_16x16x32_bf16 v[148:151], a[76:79], a[216:219], 0
  s_add_u32 m0, s46, 57344
  v_accvgpr_write_b32 a70, v86
  v_accvgpr_write_b32 a71, v87
  v_mfma_f32_16x16x32_bf16 v[148:151], a[88:91], a[220:223], v[148:151]
  s_waitcnt vmcnt(9)
  s_barrier
  s_waitcnt lgkmcnt(2)
  v_mfma_f32_16x16x32_bf16 v[156:159], a[80:83], v[184:187], 0
  buffer_load_dwordx4 v61, s[12:15], s5 offen offset:0 lds
  s_waitcnt lgkmcnt(0)
  v_mfma_f32_16x16x32_bf16 v[156:159], a[92:95], v[188:191], v[156:159]
  s_add_u32 m0, s46, 65408
  ds_read_b64_tr_b16 a[96:97], v58 offset:24576
  ds_read_b64_tr_b16 a[98:99], v58 offset:25088
  v_mfma_f32_16x16x32_bf16 v[84:87], a[80:83], v[208:211], 0
  ds_read_b64_tr_b16 a[108:109], v58 offset:28672
  ds_read_b64_tr_b16 a[110:111], v58 offset:29184
  v_mfma_f32_16x16x32_bf16 v[84:87], a[92:95], v[212:215], v[84:87]
  ds_read_b64_tr_b16 a[100:101], v59 offset:24576
  ds_read_b64_tr_b16 a[102:103], v59 offset:25088
  v_mfma_f32_16x16x32_bf16 v[164:167], a[80:83], v[232:235], 0
  buffer_load_dwordx4 v61, s[12:15], s5 offen offset:128 lds
  v_mfma_f32_16x16x32_bf16 v[164:167], a[92:95], v[236:239], v[164:167]
  s_add_u32 m0, s46, 73472
  ds_read_b64_tr_b16 a[112:113], v59 offset:28672
  ds_read_b64_tr_b16 a[114:115], v59 offset:29184
  v_mfma_f32_16x16x32_bf16 v[152:155], a[80:83], a[216:219], 0
  ds_read_b64_tr_b16 a[104:105], v60 offset:24576
  ds_read_b64_tr_b16 a[106:107], v60 offset:25088
  v_mfma_f32_16x16x32_bf16 v[152:155], a[92:95], a[220:223], v[152:155]
  s_waitcnt lgkmcnt(6)
  ds_read_b64_tr_b16 a[116:117], v60 offset:28672
  ds_read_b64_tr_b16 a[118:119], v60 offset:29184
  v_mfma_f32_16x16x32_bf16 v[144:147], a[96:99], v[192:195], v[144:147]
  buffer_load_dwordx4 v61, s[12:15], s5 offen offset:256 lds
  v_mfma_f32_16x16x32_bf16 v[144:147], a[108:111], v[196:199], v[144:147]
  s_add_u32 s5, s44, 74496
  s_add_u32 m0, s46, 77824
  v_cvt_pk_bf16_f32 v12, v108, v109
  v_mfma_f32_16x16x32_bf16 v[172:175], a[96:99], v[216:219], v[172:175]
  v_cvt_pk_bf16_f32 v13, v110, v111
  v_cvt_pk_bf16_f32 v160, v100, v101
  v_mfma_f32_16x16x32_bf16 v[172:175], a[108:111], v[220:223], v[172:175]
  v_cvt_pk_bf16_f32 v161, v102, v103
  v_cvt_pk_bf16_f32 v162, v120, v121
  v_mfma_f32_16x16x32_bf16 v[136:139], a[96:99], v[240:243], v[136:139]
  buffer_load_dwordx4 v61, s[12:15], s5 offen offset:0 lds
  v_mfma_f32_16x16x32_bf16 v[136:139], a[108:111], v[244:247], v[136:139]
  s_add_u32 m0, s46, 85888
  v_cvt_pk_bf16_f32 v163, v122, v123
  v_cvt_pk_bf16_f32 v120, v96, v97
  v_mfma_f32_16x16x32_bf16 v[140:143], a[96:99], a[224:227], v[140:143]
  v_cvt_pk_bf16_f32 v121, v98, v99
  v_cvt_pk_bf16_f32 v122, v112, v113
  v_mfma_f32_16x16x32_bf16 v[140:143], a[108:111], a[228:231], v[140:143]
  s_waitcnt lgkmcnt(0)
  v_cvt_pk_bf16_f32 v123, v114, v115
  v_cvt_pk_bf16_f32 v16, v128, v129
  v_mfma_f32_16x16x32_bf16 v[176:179], a[100:103], v[192:195], v[176:179]
  buffer_load_dwordx4 v61, s[12:15], s5 offen offset:128 lds
  v_mfma_f32_16x16x32_bf16 v[176:179], a[112:115], v[196:199], v[176:179]
  s_add_u32 m0, s46, 93952
  v_cvt_pk_bf16_f32 v17, v130, v131
  v_cvt_pk_bf16_f32 v18, v132, v133
  v_mfma_f32_16x16x32_bf16 v[180:183], a[100:103], v[216:219], v[180:183]
  v_cvt_pk_bf16_f32 v19, v134, v135
  v_cvt_pk_bf16_f32 v130, v116, v117
  v_mfma_f32_16x16x32_bf16 v[180:183], a[112:115], v[220:223], v[180:183]
  v_cvt_pk_bf16_f32 v131, v118, v119
  v_cvt_pk_bf16_f32 v132, v124, v125
  v_mfma_f32_16x16x32_bf16 v[168:171], a[100:103], v[240:243], v[168:171]
  buffer_load_dwordx4 v61, s[12:15], s5 offen offset:256 lds
  v_mfma_f32_16x16x32_bf16 v[168:171], a[112:115], v[244:247], v[168:171]
  s_add_u32 s5, s44, 111360
  s_add_u32 m0, s46, 81920
  v_cvt_pk_bf16_f32 v133, v126, v127
  v_mfma_f32_16x16x32_bf16 v[148:151], a[100:103], a[224:227], v[148:151]
  v_add_f32 v112, v66, v36
  v_add_f32 v113, v66, v37
  v_mfma_f32_16x16x32_bf16 v[148:151], a[112:115], a[228:231], v[148:151]
  s_waitcnt vmcnt(9)
  s_barrier
  v_mfma_f32_16x16x32_bf16 v[156:159], a[104:107], v[192:195], v[156:159]
  buffer_load_dwordx4 v61, s[12:15], s5 offen offset:0 lds
  v_mfma_f32_16x16x32_bf16 v[156:159], a[116:119], v[196:199], v[156:159]
  s_add_u32 m0, s46, 89984
  ds_read_b64_tr_b16 a[120:121], v62 offset:0
  ds_read_b64_tr_b16 a[122:123], v62 offset:512
  v_mfma_f32_16x16x32_bf16 v[84:87], a[104:107], v[216:219], v[84:87]
  ds_read_b64_tr_b16 a[132:133], v62 offset:4096
  ds_read_b64_tr_b16 a[134:135], v62 offset:4608
  v_mfma_f32_16x16x32_bf16 v[84:87], a[116:119], v[220:223], v[84:87]
  ds_read_b64_tr_b16 a[124:125], v63 offset:0
  ds_read_b64_tr_b16 a[126:127], v63 offset:512
  v_mfma_f32_16x16x32_bf16 v[164:167], a[104:107], v[240:243], v[164:167]
  buffer_load_dwordx4 v61, s[12:15], s5 offen offset:128 lds
  v_mfma_f32_16x16x32_bf16 v[164:167], a[116:119], v[244:247], v[164:167]
  s_add_u32 m0, s46, 98048
  ds_read_b64_tr_b16 a[136:137], v63 offset:4096
  ds_read_b64_tr_b16 a[138:139], v63 offset:4608
  v_mfma_f32_16x16x32_bf16 v[152:155], a[104:107], a[224:227], v[152:155]
  ds_read_b64_tr_b16 a[128:129], v71 offset:0
  ds_read_b64_tr_b16 a[130:131], v71 offset:512
  v_mfma_f32_16x16x32_bf16 v[152:155], a[116:119], a[228:231], v[152:155]
  s_waitcnt lgkmcnt(6)
  ds_read_b64_tr_b16 a[140:141], v71 offset:4096
  ds_read_b64_tr_b16 a[142:143], v71 offset:4608
  v_mfma_f32_16x16x32_bf16 v[144:147], a[120:123], v[200:203], v[144:147]
  buffer_load_dwordx4 v61, s[12:15], s5 offen offset:256 lds
  v_mfma_f32_16x16x32_bf16 v[144:147], a[132:135], v[204:207], v[144:147]
  s_add_u32 s5, s44, 148224
  s_add_u32 m0, s46, 102400
  v_add_f32 v114, v66, v38
  v_mfma_f32_16x16x32_bf16 v[172:175], a[120:123], v[224:227], v[172:175]
  v_add_f32 v115, v66, v39
  v_add_f32 v108, v66, v32
  v_mfma_f32_16x16x32_bf16 v[172:175], a[132:135], v[228:231], v[172:175]
  v_add_f32 v109, v66, v33
  v_add_f32 v110, v66, v34
  v_mfma_f32_16x16x32_bf16 v[136:139], a[120:123], v[248:251], v[136:139]
  buffer_load_dwordx4 v61, s[12:15], s5 offen offset:0 lds
  v_mfma_f32_16x16x32_bf16 v[136:139], a[132:135], v[252:255], v[136:139]
  s_add_u32 m0, s46, 110464
  v_cvt_pk_bf16_f32 v134, v144, v145
  v_cvt_pk_bf16_f32 v135, v146, v147
  v_mfma_f32_16x16x32_bf16 v[140:143], a[120:123], a[232:235], v[140:143]
  v_add_f32 v111, v66, v35
  v_cvt_pk_bf16_f32 v144, v172, v173
  v_mfma_f32_16x16x32_bf16 v[140:143], a[132:135], a[236:239], v[140:143]
  s_waitcnt lgkmcnt(0)
  v_cvt_pk_bf16_f32 v145, v174, v175
  v_add_f32 v116, v66, v40
  v_mfma_f32_16x16x32_bf16 v[176:179], a[124:127], v[200:203], v[176:179]
  buffer_load_dwordx4 v61, s[12:15], s5 offen offset:128 lds
  v_mfma_f32_16x16x32_bf16 v[176:179], a[136:139], v[204:207], v[176:179]
  s_add_u32 m0, s46, 118528
  v_cvt_pk_bf16_f32 v174, v136, v137
  v_cvt_pk_bf16_f32 v175, v138, v139
  v_mfma_f32_16x16x32_bf16 v[180:183], a[124:127], v[224:227], v[180:183]
  v_cvt_pk_bf16_f32 v124, v140, v141
  v_cvt_pk_bf16_f32 v125, v142, v143
  v_mfma_f32_16x16x32_bf16 v[180:183], a[136:139], v[228:231], v[180:183]
  v_add_f32 v117, v66, v41
  v_add_f32 v118, v66, v42
  v_mfma_f32_16x16x32_bf16 v[168:171], a[124:127], v[248:251], v[168:171]
  buffer_load_dwordx4 v61, s[12:15], s5 offen offset:256 lds
  v_mfma_f32_16x16x32_bf16 v[168:171], a[136:139], v[252:255], v[168:171]
  s_add_u32 s5, s44, 185088
  s_add_u32 m0, s46, 106496
  v_cvt_pk_bf16_f32 v136, v176, v177
  v_mfma_f32_16x16x32_bf16 v[148:151], a[124:127], a[232:235], v[148:151]
  v_cvt_pk_bf16_f32 v137, v178, v179
  v_cvt_pk_bf16_f32 v146, v180, v181
  v_mfma_f32_16x16x32_bf16 v[148:151], a[136:139], a[236:239], v[148:151]
  v_cvt_pk_bf16_f32 v147, v182, v183
  v_add_f32 v119, v66, v43
  v_mfma_f32_16x16x32_bf16 v[156:159], a[128:131], v[200:203], v[156:159]
  buffer_load_dwordx4 v61, s[12:15], s5 offen offset:0 lds
  v_mfma_f32_16x16x32_bf16 v[156:159], a[140:143], v[204:207], v[156:159]
  s_add_u32 m0, s46, 114560
  v_cvt_pk_bf16_f32 v176, v168, v169
  v_cvt_pk_bf16_f32 v177, v170, v171
  v_mfma_f32_16x16x32_bf16 v[84:87], a[128:131], v[224:227], v[84:87]
  v_cvt_pk_bf16_f32 v126, v148, v149
  v_cvt_pk_bf16_f32 v127, v150, v151
  v_mfma_f32_16x16x32_bf16 v[84:87], a[140:143], v[228:231], v[84:87]
  v_add_f32 v170, v65, v44
  v_add_f32 v171, v65, v45
  v_mfma_f32_16x16x32_bf16 v[164:167], a[128:131], v[248:251], v[164:167]
  buffer_load_dwordx4 v61, s[12:15], s5 offen offset:128 lds
  v_mfma_f32_16x16x32_bf16 v[164:167], a[140:143], v[252:255], v[164:167]
  s_add_u32 m0, s46, 122624
  v_cvt_pk_bf16_f32 v138, v156, v157
  v_cvt_pk_bf16_f32 v139, v158, v159
  v_mfma_f32_16x16x32_bf16 v[152:155], a[128:131], a[232:235], v[152:155]
  s_mul_i32 s31, s31, 1572864
  v_cvt_pk_bf16_f32 v148, v84, v85
  v_cvt_pk_bf16_f32 v149, v86, v87
  v_mfma_f32_16x16x32_bf16 v[152:155], a[140:143], a[236:239], v[152:155]
  s_mul_i32 s32, s32, 3072
  v_add_f32 v172, v65, v46
  v_add_f32 v173, v65, v47
  v_mfma_f32_16x16x32_bf16 v[96:99], v[136:139], v[160:163], v[112:115]
  buffer_load_dwordx4 v61, s[12:15], s5 offen offset:256 lds
  v_mfma_f32_16x16x32_bf16 v[96:99], v[134:137], v[12:15], v[96:99]
  s_add_u32 s31, s31, s32
  v_cvt_pk_bf16_f32 v178, v164, v165
  v_cvt_pk_bf16_f32 v179, v166, v167
  v_mfma_f32_16x16x32_bf16 v[100:103], v[146:149], v[160:163], v[108:111]
  s_add_u32 s56, s31, 787968
  v_cvt_pk_bf16_f32 v128, v152, v153
  v_cvt_pk_bf16_f32 v129, v154, v155
  v_mfma_f32_16x16x32_bf16 v[100:103], v[144:147], v[12:15], v[100:103]
  s_mul_i32 s52, s3, s57
  v_add_f32 v84, v65, v40
  v_add_f32 v85, v65, v41
  v_mfma_f32_16x16x32_bf16 v[156:159], v[176:179], v[160:163], v[76:79]
  s_add_u32 s31, s56, s52
  v_add_f32 v86, v65, v42
  v_add_f32 v87, v65, v43
  v_mfma_f32_16x16x32_bf16 v[156:159], v[174:177], v[12:15], v[156:159]
  s_add_u32 s32, s31, 786432
  v_cvt_pk_bf16_f32 v150, v88, v89
  v_cvt_pk_bf16_f32 v151, v90, v91
  v_mfma_f32_16x16x32_bf16 v[180:183], v[126:129], v[160:163], v[80:83]
  v_cvt_pk_bf16_f32 v152, v92, v93
  v_cvt_pk_bf16_f32 v153, v94, v95
  v_mfma_f32_16x16x32_bf16 v[180:183], v[124:127], v[12:15], v[180:183]
  v_cvt_pk_bf16_f32 v22, v104, v105
  v_cvt_pk_bf16_f32 v23, v106, v107
  v_mfma_f32_16x16x32_bf16 v[88:91], v[134:137], v[120:123], v[116:119]
  v_add_f32 v140, v65, v48
  v_add_f32 v141, v65, v49
  v_mfma_f32_16x16x32_bf16 v[88:91], v[136:139], v[14:17], v[88:91]
  v_add_f32 v142, v65, v50
  v_add_f32 v143, v65, v51
  v_mfma_f32_16x16x32_bf16 v[92:95], v[144:147], v[120:123], v[112:115]
  v_exp_f32 v96, v96
  v_mfma_f32_16x16x32_bf16 v[92:95], v[146:149], v[14:17], v[92:95]
  v_exp_f32 v97, v97
  v_mfma_f32_16x16x32_bf16 v[160:163], v[174:177], v[120:123], v[72:75]
  v_exp_f32 v98, v98
  v_mfma_f32_16x16x32_bf16 v[160:163], v[176:179], v[14:17], v[160:163]
  v_exp_f32 v99, v99
  v_mfma_f32_16x16x32_bf16 v[104:107], v[124:127], v[120:123], v[76:79]
L_hop_1_0:
  s_cbranch_execz L_hop_1_1
  v_exp_f32 v100, v100
  v_mfma_f32_16x16x32_bf16 v[104:107], v[126:129], v[14:17], v[104:107]
  v_exp_f32 v101, v101
  v_mfma_f32_16x16x32_bf16 v[72:75], v[176:179], v[130:133], v[112:115]
  v_exp_f32 v102, v102
  v_mfma_f32_16x16x32_bf16 v[72:75], v[174:177], v[18:21], v[72:75]
  buffer_load_dword v70, v57, s[16:19], s51 offen
  v_mfma_f32_16x16x32_bf16 v[76:79], v[126:129], v[130:133], v[108:111]
  s_add_u32 m0, s28, 0
  v_exp_f32 v103, v103
  v_mfma_f32_16x16x32_bf16 v[76:79], v[124:127], v[18:21], v[76:79]
  v_exp_f32 v156, v156
  v_mfma_f32_16x16x32_bf16 v[164:167], v[136:139], v[130:133], v[170:173]
  s_waitcnt vmcnt(7)
  s_barrier
  v_mfma_f32_16x16x32_bf16 v[164:167], v[134:137], v[18:21], v[164:167]
  buffer_load_dwordx4 v6, s[8:11], s31 offen offset:0 nt lds
  v_mfma_f32_16x16x32_bf16 v[64:67], v[146:149], v[130:133], v[84:87]
  s_add_u32 m0, s28, 8064
  ds_read_b64_tr_b16 a[144:145], v62 offset:24576
  ds_read_b64_tr_b16 a[146:147], v62 offset:25088
  v_mfma_f32_16x16x32_bf16 v[64:67], v[144:147], v[18:21], v[64:67]
  ds_read_b64_tr_b16 a[156:157], v62 offset:28672
  ds_read_b64_tr_b16 a[158:159], v62 offset:29184
  v_mfma_f32_16x16x32_bf16 v[80:83], v[174:177], v[150:153], v[116:119]
  buffer_load_dwordx4 v6, s[8:11], s31 offen offset:128 nt lds
  v_mfma_f32_16x16x32_bf16 v[80:83], v[176:179], v[20:23], v[80:83]
  s_add_u32 m0, s28, 16128
  ds_read_b64_tr_b16 a[148:149], v63 offset:24576
  ds_read_b64_tr_b16 a[150:151], v63 offset:25088
  v_mfma_f32_16x16x32_bf16 v[84:87], v[124:127], v[150:153], v[112:115]
  ds_read_b64_tr_b16 a[160:161], v63 offset:28672
  ds_read_b64_tr_b16 a[162:163], v63 offset:29184
  v_mfma_f32_16x16x32_bf16 v[84:87], v[126:129], v[20:23], v[84:87]
  buffer_load_dwordx4 v6, s[8:11], s31 offen offset:256 nt lds
  v_mfma_f32_16x16x32_bf16 v[176:179], v[134:137], v[150:153], v[140:143]
  s_add_u32 s31, s31, s43
  ds_read_b64_tr_b16 a[152:153], v71 offset:24576
  ds_read_b64_tr_b16 a[154:155], v71 offset:25088
  v_mfma_f32_16x16x32_bf16 v[176:179], v[136:139], v[20:23], v[176:179]
  ds_read_b64_tr_b16 a[164:165], v71 offset:28672
  ds_read_b64_tr_b16 a[166:167], v71 offset:29184
  v_mfma_f32_16x16x32_bf16 v[140:143], v[144:147], v[150:153], v[170:173]
  ds_read_b64_tr_b16 a[168:169], v62 offset:49152
  ds_read_b64_tr_b16 a[170:171], v62 offset:49664
  v_mfma_f32_16x16x32_bf16 v[140:143], v[146:149], v[20:23], v[140:143]
  s_waitcnt lgkmcnt(6)
  ds_read_b64_tr_b16 a[180:181], v62 offset:53248
  ds_read_b64_tr_b16 a[182:183], v62 offset:53760
  v_mfma_f32_16x16x32_bf16 v[144:147], v[184:187], a[144:147], 0
  ds_read_b64_tr_b16 a[172:173], v63 offset:49152
  ds_read_b64_tr_b16 a[174:175], v63 offset:49664
  v_mfma_f32_16x16x32_bf16 v[144:147], v[188:191], a[156:159], v[144:147]
  ds_read_b64_tr_b16 a[184:185], v63 offset:53248
  ds_read_b64_tr_b16 a[186:187], v63 offset:53760
  v_mfma_f32_16x16x32_bf16 v[148:151], v[184:187], a[148:151], 0
  ds_read_b64_tr_b16 a[176:177], v71 offset:49152
  ds_read_b64_tr_b16 a[178:179], v71 offset:49664
  v_mfma_f32_16x16x32_bf16 v[148:151], v[188:191], a[160:163], v[148:151]
  s_waitcnt lgkmcnt(8)
  ds_read_b64_tr_b16 a[188:189], v71 offset:53248
  ds_read_b64_tr_b16 a[190:191], v71 offset:53760
  v_mfma_f32_16x16x32_bf16 v[152:155], v[184:187], a[152:155], 0
  v_exp_f32 v157, v157
  v_mfma_f32_16x16x32_bf16 v[152:155], v[188:191], a[164:167], v[152:155]
  v_exp_f32 v158, v158
  v_mfma_f32_16x16x32_bf16 v[128:131], v[208:211], a[144:147], 0
  v_exp_f32 v159, v159
  v_mfma_f32_16x16x32_bf16 v[128:131], v[212:215], a[156:159], v[128:131]
  v_exp_f32 v180, v180
  v_mfma_f32_16x16x32_bf16 v[132:135], v[208:211], a[148:151], 0
  v_exp_f32 v181, v181
  v_mfma_f32_16x16x32_bf16 v[132:135], v[212:215], a[160:163], v[132:135]
  v_exp_f32 v182, v182
  v_mfma_f32_16x16x32_bf16 v[124:127], v[208:211], a[152:155], 0
  v_exp_f32 v183, v183
  v_mfma_f32_16x16x32_bf16 v[124:127], v[212:215], a[164:167], v[124:127]
  v_cvt_pk_bf16_f32 v96, v96, v97
  v_cvt_pk_bf16_f32 v97, v98, v99
  v_mfma_f32_16x16x32_bf16 v[144:147], v[192:195], a[168:171], v[144:147]
  s_waitcnt lgkmcnt(0)
  v_cvt_pk_bf16_f32 v98, v100, v101
  v_cvt_pk_bf16_f32 v99, v102, v103
  v_mfma_f32_16x16x32_bf16 v[144:147], v[196:199], a[180:183], v[144:147]
  v_cvt_pk_bf16_f32 v100, v156, v157
  v_cvt_pk_bf16_f32 v101, v158, v159
  v_mfma_f32_16x16x32_bf16 v[148:151], v[192:195], a[172:175], v[148:151]
  v_cvt_pk_bf16_f32 v102, v180, v181
  v_cvt_pk_bf16_f32 v103, v182, v183
  v_mfma_f32_16x16x32_bf16 v[148:151], v[196:199], a[184:187], v[148:151]
  v_exp_f32 v88, v88
  v_mfma_f32_16x16x32_bf16 v[152:155], v[192:195], a[176:179], v[152:155]
  v_exp_f32 v89, v89
  v_mfma_f32_16x16x32_bf16 v[152:155], v[196:199], a[188:191], v[152:155]
  s_waitcnt vmcnt(4)
  s_barrier
  v_mfma_f32_16x16x32_bf16 v[128:131], v[216:219], a[168:171], v[128:131]
  ds_read_b64_tr_b16 a[192:193], v58 offset:0
  ds_read_b64_tr_b16 a[194:195], v58 offset:512
  v_mfma_f32_16x16x32_bf16 v[128:131], v[220:223], a[180:183], v[128:131]
  ds_read_b64_tr_b16 a[204:205], v58 offset:4096
  ds_read_b64_tr_b16 a[206:207], v58 offset:4608
  v_mfma_f32_16x16x32_bf16 v[132:135], v[216:219], a[172:175], v[132:135]
  ds_read_b64_tr_b16 a[196:197], v59 offset:0
  ds_read_b64_tr_b16 a[198:199], v59 offset:512
  v_mfma_f32_16x16x32_bf16 v[132:135], v[220:223], a[184:187], v[132:135]
  s_waitcnt lgkmcnt(4)
  ds_read_b64_tr_b16 a[208:209], v59 offset:4096
  ds_read_b64_tr_b16 a[210:211], v59 offset:4608
  v_mfma_f32_16x16x32_bf16 v[124:127], v[216:219], a[176:179], v[124:127]
  s_add_u32 s5, s45, 0
  ds_read_b64_tr_b16 a[200:201], v60 offset:0
  ds_read_b64_tr_b16 a[202:203], v60 offset:512
  v_mfma_f32_16x16x32_bf16 v[124:127], v[220:223], a[188:191], v[124:127]
  s_add_u32 m0, s46, 126976
  ds_read_b64_tr_b16 a[212:213], v60 offset:4096
  ds_read_b64_tr_b16 a[214:215], v60 offset:4608
  v_mfma_f32_16x16x32_bf16 v[144:147], v[200:203], a[192:195], v[144:147]
  s_waitcnt lgkmcnt(8)
  v_exp_f32 v90, v90
  v_mfma_f32_16x16x32_bf16 v[144:147], v[204:207], a[204:207], v[144:147]
  buffer_load_dwordx4 v56, s[16:19], s5 offen offset:0 lds
  s_waitcnt lgkmcnt(6)
  v_mfma_f32_16x16x32_bf16 v[148:151], v[200:203], a[196:199], v[148:151]
  s_add_u32 m0, s46, 135040
  v_exp_f32 v91, v91
  s_waitcnt lgkmcnt(4)
  v_mfma_f32_16x16x32_bf16 v[148:151], v[204:207], a[208:211], v[148:151]
  s_waitcnt lgkmcnt(2)
  v_exp_f32 v92, v92
  v_mfma_f32_16x16x32_bf16 v[152:155], v[200:203], a[200:203], v[152:155]
  buffer_load_dwordx4 v56, s[16:19], s5 offen offset:128 lds
  s_waitcnt lgkmcnt(0)
  v_mfma_f32_16x16x32_bf16 v[152:155], v[204:207], a[212:215], v[152:155]
  s_add_u32 m0, s46, 143104
  v_cvt_pk_bf16_f32 v156, v144, v145
  v_cvt_pk_bf16_f32 v157, v146, v147
  v_mfma_f32_16x16x32_bf16 v[128:131], v[224:227], a[192:195], v[128:131]
  v_cvt_pk_bf16_f32 v116, v148, v149
  v_cvt_pk_bf16_f32 v117, v150, v151
  v_mfma_f32_16x16x32_bf16 v[128:131], v[228:231], a[204:207], v[128:131]
  buffer_load_dwordx4 v56, s[16:19], s5 offen offset:256 lds
  v_mfma_f32_16x16x32_bf16 v[132:135], v[224:227], a[196:199], v[132:135]
  s_add_u32 s5, s45, 12288
  v_cvt_pk_bf16_f32 v120, v152, v153
  v_cvt_pk_bf16_f32 v121, v154, v155
  v_mfma_f32_16x16x32_bf16 v[132:135], v[228:231], a[208:211], v[132:135]
  s_add_u32 m0, s46, 131072
  v_exp_f32 v93, v93
  v_mfma_f32_16x16x32_bf16 v[124:127], v[224:227], a[200:203], v[124:127]
  buffer_load_dwordx4 v56, s[16:19], s5 offen offset:0 lds
  v_mfma_f32_16x16x32_bf16 v[124:127], v[228:231], a[212:215], v[124:127]
  s_add_u32 m0, s46, 139136
  v_cvt_pk_bf16_f32 v158, v128, v129
  v_cvt_pk_bf16_f32 v159, v130, v131
  v_mfma_f32_16x16x32_bf16 v[144:147], v[232:235], a[144:147], 0
  s_lshl_b32 s38, s48, 3
  v_cvt_pk_bf16_f32 v118, v132, v133
  v_cvt_pk_bf16_f32 v119, v134, v135
  v_mfma_f32_16x16x32_bf16 v[144:147], v[236:239], a[156:159], v[144:147]
  buffer_load_dwordx4 v56, s[16:19], s5 offen offset:128 lds
  v_mfma_f32_16x16x32_bf16 v[144:147], v[240:243], a[168:171], v[144:147]
  s_add_u32 m0, s46, 147200
  v_cvt_pk_bf16_f32 v122, v124, v125
  v_cvt_pk_bf16_f32 v123, v126, v127
  v_mfma_f32_16x16x32_bf16 v[144:147], v[244:247], a[180:183], v[144:147]
  s_add_u32 s38, s38, 4
  v_exp_f32 v94, v94
  v_mfma_f32_16x16x32_bf16 v[144:147], v[248:251], a[192:195], v[144:147]
  buffer_load_dwordx4 v56, s[16:19], s5 offen offset:256 lds
  v_mfma_f32_16x16x32_bf16 v[144:147], v[252:255], a[204:207], v[144:147]
  s_xor_b32 s6, s4, 0
  v_exp_f32 v95, v95
  v_mfma_f32_16x16x32_bf16 v[128:131], v[232:235], a[148:151], 0
  s_lshl_b32 s6, s6, 1
  v_exp_f32 v160, v160
  v_mfma_f32_16x16x32_bf16 v[128:131], v[236:239], a[160:163], v[128:131]
  s_add_u32 s6, s6, s38
  v_exp_f32 v161, v161
  v_mfma_f32_16x16x32_bf16 v[128:131], v[240:243], a[172:175], v[128:131]
  s_and_b32 s6, s6, 511
  v_cvt_pk_bf16_f32 v112, v144, v145
  v_cvt_pk_bf16_f32 v113, v146, v147
  v_mfma_f32_16x16x32_bf16 v[128:131], v[244:247], a[184:187], v[128:131]
  s_mul_i32 s6, s6, s57
  v_exp_f32 v162, v162
  v_mfma_f32_16x16x32_bf16 v[128:131], v[248:251], a[196:199], v[128:131]
  s_add_u32 s33, s6, s37
  v_exp_f32 v163, v163
  v_mfma_f32_16x16x32_bf16 v[128:131], v[252:255], a[208:211], v[128:131]
  s_xor_b32 s6, s4, 1
  v_exp_f32 v104, v104
  v_mfma_f32_16x16x32_bf16 v[124:127], v[232:235], a[152:155], 0
  s_lshl_b32 s6, s6, 1
  v_exp_f32 v105, v105
  v_mfma_f32_16x16x32_bf16 v[124:127], v[236:239], a[164:167], v[124:127]
  s_add_u32 s6, s6, s38
  v_exp_f32 v106, v106
  v_mfma_f32_16x16x32_bf16 v[124:127], v[240:243], a[176:179], v[124:127]
  s_and_b32 s6, s6, 511
  v_cvt_pk_bf16_f32 v180, v128, v129
  v_cvt_pk_bf16_f32 v181, v130, v131
  v_cvt_pk_bf16_f32 v88, v88, v89
  v_mfma_f32_16x16x32_bf16 v[124:127], v[244:247], a[188:191], v[124:127]
  s_mul_i32 s6, s6, s57
  v_exp_f32 v107, v107
  v_cvt_pk_bf16_f32 v89, v90, v91
  v_mfma_f32_16x16x32_bf16 v[124:127], v[248:251], a[200:203], v[124:127]
  s_add_u32 s34, s6, s37
  v_cvt_pk_bf16_f32 v90, v92, v93
  v_cvt_pk_bf16_f32 v91, v94, v95
  v_cvt_pk_bf16_f32 v92, v160, v161
  v_mfma_f32_16x16x32_bf16 v[124:127], v[252:255], a[212:215], v[124:127]
  s_xor_b32 s6, s4, 2
  v_cvt_pk_bf16_f32 v93, v162, v163
  v_cvt_pk_bf16_f32 v94, v104, v105
  v_cvt_pk_bf16_f32 v95, v106, v107
  v_mfma_f32_16x16x32_bf16 v[128:131], a[216:219], a[144:147], 0
  s_lshl_b32 s6, s6, 1
  v_exp_f32 v72, v72
  v_add_u32 v0, s28, v2
  v_mfma_f32_16x16x32_bf16 v[128:131], a[220:223], a[156:159], v[128:131]
  s_add_u32 s5, s45, 24576
  s_add_u32 m0, s46, 0
  v_exp_f32 v73, v73
  v_mfma_f32_16x16x32_bf16 v[128:131], a[224:227], a[168:171], v[128:131]
  s_add_u32 s6, s6, s38
  v_cvt_pk_bf16_f32 v160, v124, v125
  v_cvt_pk_bf16_f32 v161, v126, v127
  v_cvt_pk_bf16_f32 v72, v72, v73
  v_mfma_f32_16x16x32_bf16 v[128:131], a[228:231], a[180:183], v[128:131]
  s_and_b32 s6, s6, 511
  v_exp_f32 v74, v74
  v_xor_b32 v1, 64, v0
  v_mfma_f32_16x16x32_bf16 v[128:131], a[232:235], a[192:195], v[128:131]
  buffer_load_dwordx4 v56, s[16:19], s5 offen offset:0 lds
  v_mfma_f32_16x16x32_bf16 v[128:131], a[236:239], a[204:207], v[128:131]
  s_add_u32 m0, s46, 8064
  v_exp_f32 v75, v75
  v_mfma_f32_16x16x32_bf16 v[132:135], a[216:219], a[148:151], 0
  s_mul_i32 s6, s6, s57
  v_exp_f32 v76, v76
  v_cvt_pk_bf16_f32 v73, v74, v75
  v_mfma_f32_16x16x32_bf16 v[132:135], a[220:223], a[160:163], v[132:135]
  buffer_load_dwordx4 v56, s[16:19], s5 offen offset:128 lds
  v_mfma_f32_16x16x32_bf16 v[132:135], a[224:227], a[172:175], v[132:135]
  s_add_u32 m0, s46, 16128
  v_cvt_pk_bf16_f32 v114, v128, v129
  v_cvt_pk_bf16_f32 v115, v130, v131
  v_mfma_f32_16x16x32_bf16 v[132:135], a[228:231], a[184:187], v[132:135]
  s_add_u32 s35, s6, s37
  v_exp_f32 v77, v77
  v_mfma_f32_16x16x32_bf16 v[132:135], a[232:235], a[196:199], v[132:135]
  buffer_load_dwordx4 v56, s[16:19], s5 offen offset:256 lds
  v_mov_b64 v[124:125], 0
  v_mfma_f32_16x16x32_bf16 v[132:135], a[236:239], a[208:211], v[132:135]
  s_add_u32 s5, s45, 36864
  s_add_u32 m0, s46, 4096
  v_exp_f32 v78, v78
  v_mfma_f32_16x16x32_bf16 v[136:139], a[216:219], a[152:155], 0
  s_xor_b32 s6, s4, 3
  v_exp_f32 v79, v79
  v_cvt_pk_bf16_f32 v74, v76, v77
  v_mfma_f32_16x16x32_bf16 v[136:139], a[220:223], a[164:167], v[136:139]
  buffer_load_dwordx4 v56, s[16:19], s5 offen offset:0 lds
  v_cvt_pk_bf16_f32 v75, v78, v79
  v_mfma_f32_16x16x32_bf16 v[136:139], a[224:227], a[176:179], v[136:139]
  s_add_u32 m0, s46, 12160
  v_cvt_pk_bf16_f32 v182, v132, v133
  v_cvt_pk_bf16_f32 v183, v134, v135
  v_mfma_f32_16x16x32_bf16 v[136:139], a[228:231], a[188:191], v[136:139]
  s_lshl_b32 s6, s6, 1
  v_exp_f32 v164, v164
  v_mfma_f32_16x16x32_bf16 v[136:139], a[232:235], a[200:203], v[136:139]
  buffer_load_dwordx4 v56, s[16:19], s5 offen offset:128 lds
  v_mfma_f32_16x16x32_bf16 v[136:139], a[236:239], a[212:215], v[136:139]
  s_add_u32 m0, s46, 20224
  v_mov_b64 v[148:149], 0
  v_exp_f32 v165, v165
  v_smfmac_f32_16x16x64_bf16 v[124:127], a[240:243], v[96:103], v10
  s_add_u32 s6, s6, s38
  v_exp_f32 v166, v166
  v_cvt_pk_bf16_f32 v76, v164, v165
  v_mfma_f32_16x16x32_bf16 v[168:171], v[112:115], v[100:103], 0
  buffer_load_dwordx4 v56, s[16:19], s5 offen offset:256 lds
  v_mfma_f32_16x16x32_bf16 v[168:171], v[156:159], v[96:99], v[168:171]
  s_and_b32 s6, s6, 511
  v_cvt_pk_bf16_f32 v162, v136, v137
  v_cvt_pk_bf16_f32 v163, v138, v139
  v_mfma_f32_16x16x32_bf16 v[172:175], v[116:119], v[96:99], 0
  s_mul_i32 s6, s6, s57
  v_exp_f32 v167, v167
  v_mfma_f32_16x16x32_bf16 v[172:175], v[180:183], v[100:103], v[172:175]
  s_add_u32 s36, s6, s37
  v_exp_f32 v64, v64
  v_cvt_pk_bf16_f32 v77, v166, v167
  v_mfma_f32_16x16x32_bf16 v[108:111], v[160:163], v[100:103], 0
  s_mul_i32 s6, s43, 3
  v_exp_f32 v65, v65
  v_add_f32 v124, v124, v125
  v_mfma_f32_16x16x32_bf16 v[108:111], v[120:123], v[96:99], v[108:111]
  s_add_u32 s52, s52, s6
  v_exp_f32 v66, v66
  v_cvt_pk_bf16_f32 v78, v64, v65
  v_smfmac_f32_16x16x64_bf16 v[148:151], a[240:243], v[88:95], v10
  s_xor_b32 s6, s4, 0
  v_exp_f32 v67, v67
  v_mov_b64 v[136:137], 0
  v_mfma_f32_16x16x32_bf16 v[144:147], v[112:115], v[92:95], 0
  s_mul_i32 s6, s6, 393216
  v_cvt_pk_bf16_f32 v79, v66, v67
  v_exp_f32 v80, v80
  v_mfma_f32_16x16x32_bf16 v[144:147], v[156:159], v[88:91], v[144:147]
  s_sub_u32 s37, s6, s52
  v_exp_f32 v81, v81
  v_mfma_f32_16x16x32_bf16 v[128:131], v[116:119], v[88:91], 0
  s_xor_b32 s6, s4, 1
  v_exp_f32 v82, v82
  v_cvt_pk_bf16_f32 v80, v80, v81
  v_mfma_f32_16x16x32_bf16 v[128:131], v[180:183], v[92:95], v[128:131]
  s_mul_i32 s6, s6, 393216
  v_exp_f32 v83, v83
  v_mfma_f32_16x16x32_bf16 v[152:155], v[160:163], v[92:95], 0
  s_sub_u32 s38, s6, s52
  v_exp_f32 v84, v84
  v_cvt_pk_bf16_f32 v81, v82, v83
  v_mfma_f32_16x16x32_bf16 v[152:155], v[120:123], v[88:91], v[152:155]
  s_xor_b32 s6, s4, 2
  v_exp_f32 v85, v85
  v_mov_b64 v[100:101], 0
  v_smfmac_f32_16x16x64_bf16 v[136:139], a[240:243], v[72:79], v10
  s_mul_i32 s6, s6, 393216
  v_exp_f32 v86, v86
  v_exp_f32 v87, v87
  v_exp_f32 v176, v176
  v_exp_f32 v177, v177
  v_exp_f32 v178, v178
  v_exp_f32 v179, v179
  v_exp_f32 v140, v140
  v_exp_f32 v141, v141
  v_exp_f32 v142, v142
  v_exp_f32 v143, v143
  v_mfma_f32_16x16x32_bf16 v[92:95], v[156:159], v[76:79], 0
  s_add_u32 s5, s45, 49152
  v_cvt_pk_bf16_f32 v82, v84, v85
  v_cvt_pk_bf16_f32 v83, v86, v87
  v_cvt_pk_bf16_f32 v84, v176, v177
  v_cvt_pk_bf16_f32 v85, v178, v179
  v_cvt_pk_bf16_f32 v86, v140, v141
  v_cvt_pk_bf16_f32 v87, v142, v143
  v_mfma_f32_16x16x32_bf16 v[92:95], v[112:115], v[72:75], v[92:95]
  s_waitcnt vmcnt(6) lgkmcnt(0)
  s_barrier
  v_mfma_f32_16x16x32_bf16 v[104:107], v[180:183], v[72:75], 0
  s_add_u32 m0, s46, 102400
  ds_read_b128 a[252:255], v0 offset:0
  ds_read_b128 v[60:63], v1 offset:0
  v_mfma_f32_16x16x32_bf16 v[104:107], v[116:119], v[76:79], v[104:107]
  buffer_load_dwordx4 v56, s[16:19], s5 offen offset:0 lds
  v_mfma_f32_16x16x32_bf16 v[132:135], v[120:123], v[76:79], 0
  s_add_u32 m0, s46, 110464
  ds_read_b128 v[64:67], v0 offset:8192
  ds_read_b128 v[164:167], v1 offset:8192
  v_mfma_f32_16x16x32_bf16 v[132:135], v[160:163], v[72:75], v[132:135]
  s_sub_u32 s39, s6, s52
  ds_read_b128 v[140:143], v0 offset:16384
  ds_read_b128 a[248:251], v1 offset:16384
  v_smfmac_f32_16x16x64_bf16 v[100:103], a[240:243], v[80:87], v10
  buffer_load_dwordx4 v56, s[16:19], s5 offen offset:128 lds
  v_mfma_f32_16x16x32_bf16 v[70:73], v[156:159], v[84:87], 0
  s_add_u32 m0, s46, 118528
  ds_read2st64_b32 v[76:77], v68 offset0:0 offset1:2
  ds_read2st64_b32 v[88:89], v69 offset0:0 offset1:2
  v_mfma_f32_16x16x32_bf16 v[70:73], v[112:115], v[80:83], v[70:73]
  s_xor_b32 s6, s4, 3
  ds_read2st64_b32 v[78:79], v68 offset0:4 offset1:6
  ds_read2st64_b32 v[90:91], v69 offset0:4 offset1:6
  v_mfma_f32_16x16x32_bf16 v[112:115], v[180:183], v[80:83], 0
  buffer_load_dwordx4 v56, s[16:19], s5 offen offset:256 lds
  v_mfma_f32_16x16x32_bf16 v[112:115], v[116:119], v[84:87], v[112:115]
  s_add_u32 s5, s45, 61440
  s_add_u32 m0, s46, 106496
  ds_read2st64_b32 v[156:157], v54 offset0:0 offset1:2
  v_mfma_f32_16x16x32_bf16 v[180:183], v[120:123], v[84:87], 0
  s_mul_i32 s6, s6, 393216
  ds_read2st64_b32 v[96:97], v55 offset0:0 offset1:2
  ds_read2st64_b32 v[158:159], v54 offset0:4 offset1:6
  v_mfma_f32_16x16x32_bf16 v[180:183], v[160:163], v[80:83], v[180:183]
  buffer_load_dwordx4 v56, s[16:19], s5 offen offset:0 lds
  s_waitcnt lgkmcnt(12)
  v_mfma_f32_16x16x32_bf16 v[84:87], a[0:3], a[252:255], 0
  s_add_u32 m0, s46, 114560
  ds_read2st64_b32 v[98:99], v55 offset0:4 offset1:6
  v_add_f32 v148, v148, v149
  s_waitcnt lgkmcnt(12)
  v_mfma_f32_16x16x32_bf16 v[84:87], a[12:15], v[60:63], v[84:87]
  s_sub_u32 s40, s6, s52
  v_rcp_f32 v126, v124
  s_waitcnt lgkmcnt(11)
  v_mfma_f32_16x16x32_bf16 v[84:87], a[24:27], v[64:67], v[84:87]
  buffer_load_dwordx4 v56, s[16:19], s5 offen offset:128 lds
  s_waitcnt lgkmcnt(10)
  v_mfma_f32_16x16x32_bf16 v[84:87], a[36:39], v[164:167], v[84:87]
  s_add_u32 m0, s46, 122624
  v_mul_f32 v168, v126, v168
  v_mul_f32 v169, v126, v169
  s_waitcnt lgkmcnt(9)
  v_mfma_f32_16x16x32_bf16 v[84:87], a[48:51], v[140:143], v[84:87]
  s_waitcnt lgkmcnt(4)
  v_perm_b32 v184, v88, v76, s58
  v_perm_b32 v188, v88, v76, s59
  v_mfma_f32_16x16x32_bf16 v[84:87], a[60:63], a[248:251], v[84:87]
  buffer_load_dwordx4 v56, s[16:19], s5 offen offset:256 lds
  v_mfma_f32_16x16x32_bf16 v[80:83], a[64:67], a[248:251], 0
  s_waitcnt lgkmcnt(0)
  v_perm_b32 v185, v89, v77, s58
  v_perm_b32 v189, v89, v77, s59
  v_mfma_f32_16x16x32_bf16 v[80:83], a[52:55], v[140:143], v[80:83]
  s_add_u32 m0, s28, 4096
  v_perm_b32 v186, v90, v78, s58
  v_perm_b32 v190, v90, v78, s59
  v_mfma_f32_16x16x32_bf16 v[80:83], a[40:43], v[164:167], v[80:83]
  s_mov_b32 s5, s28
  v_cvt_pk_bf16_f32 v12, v84, v85
  v_cvt_pk_bf16_f32 v13, v86, v87
  v_mfma_f32_16x16x32_bf16 v[80:83], a[28:31], v[64:67], v[80:83]
  v_perm_b32 v187, v91, v79, s58
  v_perm_b32 v191, v91, v79, s59
  v_mfma_f32_16x16x32_bf16 v[80:83], a[16:19], v[60:63], v[80:83]
  buffer_load_dwordx4 v6, s[8:11], s32 offen offset:0 nt lds
  v_mfma_f32_16x16x32_bf16 v[80:83], a[4:7], a[252:255], v[80:83]
  s_add_u32 m0, s28, 12160
  v_perm_b32 v192, v96, v156, s58
  v_perm_b32 v196, v96, v156, s59
  v_mfma_f32_16x16x32_bf16 v[84:87], a[8:11], a[252:255], 0
  v_perm_b32 v193, v97, v157, s58
  v_perm_b32 v197, v97, v157, s59
  v_mfma_f32_16x16x32_bf16 v[84:87], a[20:23], v[60:63], v[84:87]
  buffer_load_dwordx4 v6, s[8:11], s32 offen offset:128 nt lds
  v_mfma_f32_16x16x32_bf16 v[84:87], a[32:35], v[64:67], v[84:87]
  s_add_u32 m0, s28, 20224
  v_cvt_pk_bf16_f32 v160, v80, v81
  v_cvt_pk_bf16_f32 v161, v82, v83
  v_mfma_f32_16x16x32_bf16 v[84:87], a[44:47], v[164:167], v[84:87]
  s_mov_b32 s28, s29
  v_perm_b32 v194, v98, v158, s58
  v_perm_b32 v198, v98, v158, s59
  v_mfma_f32_16x16x32_bf16 v[84:87], a[56:59], v[140:143], v[84:87]
  buffer_load_dwordx4 v6, s[8:11], s32 offen offset:256 nt lds
  v_mfma_f32_16x16x32_bf16 v[84:87], a[68:71], a[248:251], v[84:87]
  s_add_u32 s32, s32, s43
  v_perm_b32 v195, v99, v159, s58
  v_perm_b32 v199, v99, v159, s59
  v_mfma_f32_16x16x32_bf16 v[56:59], a[132:135], a[248:251], 0
  ds_read2st64_b32 v[76:77], v68 offset0:16 offset1:18
  ds_read2st64_b32 v[88:89], v69 offset0:16 offset1:18
  v_mfma_f32_16x16x32_bf16 v[56:59], a[120:123], v[140:143], v[56:59]
  ds_read2st64_b32 v[78:79], v68 offset0:20 offset1:22
  ds_read2st64_b32 v[90:91], v69 offset0:20 offset1:22
  v_mfma_f32_16x16x32_bf16 v[56:59], a[108:111], v[164:167], v[56:59]
  v_cvt_pk_bf16_f32 v162, v84, v85
  v_cvt_pk_bf16_f32 v163, v86, v87
  v_mfma_f32_16x16x32_bf16 v[56:59], a[96:99], v[64:67], v[56:59]
  ds_read2st64_b32 v[156:157], v54 offset0:16 offset1:18
  ds_read2st64_b32 v[96:97], v55 offset0:16 offset1:18
  v_mfma_f32_16x16x32_bf16 v[56:59], a[84:87], v[60:63], v[56:59]
  ds_read2st64_b32 v[158:159], v54 offset0:20 offset1:22
  ds_read2st64_b32 v[98:99], v55 offset0:20 offset1:22
  v_mul_f32 v170, v126, v170
  v_mfma_f32_16x16x32_bf16 v[56:59], a[72:75], a[252:255], v[56:59]
  v_mul_f32 v171, v126, v171
  v_cvt_pk_bf16_f32 v168, v168, v169
  v_cvt_pk_bf16_f32 v169, v170, v171
  v_mfma_f32_16x16x32_bf16 v[80:83], a[76:79], a[252:255], 0
  s_waitcnt lgkmcnt(4)
  v_mul_f32 v172, v126, v172
  v_mul_f32 v173, v126, v173
  v_mul_f32 v174, v126, v174
  v_mfma_f32_16x16x32_bf16 v[80:83], a[88:91], v[60:63], v[80:83]
  v_mul_f32 v175, v126, v175
  v_cvt_pk_bf16_f32 v172, v172, v173
  v_cvt_pk_bf16_f32 v173, v174, v175
  v_mfma_f32_16x16x32_bf16 v[80:83], a[100:103], v[64:67], v[80:83]
  v_cvt_pk_bf16_f32 v120, v56, v57
  v_cvt_pk_bf16_f32 v121, v58, v59
  v_mul_f32 v108, v126, v108
  v_mfma_f32_16x16x32_bf16 v[80:83], a[112:115], v[164:167], v[80:83]
  s_waitcnt lgkmcnt(0)
  v_mul_f32 v109, v126, v109
  v_mul_f32 v110, v126, v110
  v_mul_f32 v111, v126, v111
  v_mfma_f32_16x16x32_bf16 v[80:83], a[124:127], v[140:143], v[80:83]
  v_cvt_pk_bf16_f32 v108, v108, v109
  v_cvt_pk_bf16_f32 v109, v110, v111
  v_max3_f32 v9, v124, v126, v9
  v_mfma_f32_16x16x32_bf16 v[80:83], a[136:139], a[248:251], v[80:83]
  ds_write2st64_b32 v5, v168, v169 offset0:0 offset1:4
  v_mfma_f32_16x16x32_bf16 v[56:59], a[140:143], a[248:251], 0
  ds_write2st64_b32 v5, v172, v173 offset0:8 offset1:12
  v_mfma_f32_16x16x32_bf16 v[56:59], a[128:131], v[140:143], v[56:59]
  ds_write2st64_b32 v5, v108, v109 offset0:16 offset1:20
  v_mfma_f32_16x16x32_bf16 v[56:59], a[116:119], v[164:167], v[56:59]
  v_cvt_pk_bf16_f32 v122, v80, v81
  v_cvt_pk_bf16_f32 v123, v82, v83
  v_perm_b32 v200, v88, v76, s58
  v_mfma_f32_16x16x32_bf16 v[56:59], a[104:107], v[64:67], v[56:59]
  v_perm_b32 v204, v88, v76, s59
  v_perm_b32 v201, v89, v77, s58
  v_perm_b32 v205, v89, v77, s59
  v_mfma_f32_16x16x32_bf16 v[56:59], a[92:95], v[60:63], v[56:59]
  v_perm_b32 v202, v90, v78, s58
  v_perm_b32 v206, v90, v78, s59
  v_perm_b32 v203, v91, v79, s58
  v_mfma_f32_16x16x32_bf16 v[56:59], a[80:83], a[252:255], v[56:59]
  v_perm_b32 v207, v91, v79, s59
  v_perm_b32 v208, v96, v156, s58
  v_perm_b32 v212, v96, v156, s59
  v_mfma_f32_16x16x32_bf16 v[168:171], a[252:255], a[144:147], 0
  v_perm_b32 v209, v97, v157, s58
  v_perm_b32 v213, v97, v157, s59
  v_perm_b32 v210, v98, v158, s58
  v_mfma_f32_16x16x32_bf16 v[168:171], v[60:63], a[156:159], v[168:171]
  v_perm_b32 v214, v98, v158, s59
  v_perm_b32 v211, v99, v159, s58
  v_perm_b32 v215, v99, v159, s59
  v_mfma_f32_16x16x32_bf16 v[168:171], v[64:67], a[168:171], v[168:171]
  ds_read_b128 a[244:247], v0 offset:2048
  v_cvt_pk_bf16_f32 v124, v56, v57
  v_cvt_pk_bf16_f32 v125, v58, v59
  v_mfma_f32_16x16x32_bf16 v[168:171], v[164:167], a[180:183], v[168:171]
  ds_read_b128 v[108:111], v1 offset:2048
  ds_read_b128 v[172:175], v0 offset:10240
  v_add_u32 v68, 4294840320, v68
  v_mfma_f32_16x16x32_bf16 v[168:171], v[140:143], a[192:195], v[168:171]
  s_add_u32 m0, s29, 0
  ds_read_b128 v[116:119], v1 offset:10240
  ds_read_b128 v[176:179], v0 offset:18432
  v_add_u32 v69, 4294840320, v69
  v_mfma_f32_16x16x32_bf16 v[168:171], a[248:251], a[204:207], v[168:171]
  ds_read_b128 v[84:87], v1 offset:18432
  v_add_u32 v54, 4294840320, v54
  v_add_u32 v55, 4294840320, v55
  v_mfma_f32_16x16x32_bf16 v[80:83], a[248:251], a[208:211], 0
  s_waitcnt vmcnt(3)
  s_barrier
  v_mfma_f32_16x16x32_bf16 v[80:83], v[140:143], a[196:199], v[80:83]
  buffer_load_dwordx4 v6, s[8:11], s31 offen offset:0 nt lds
  v_add_f32 v136, v136, v137
  v_mfma_f32_16x16x32_bf16 v[80:83], v[164:167], a[184:187], v[80:83]
  s_add_u32 m0, s29, 8064
  ds_read2st64_b32 v[76:77], v68 offset0:0 offset1:2
  v_cvt_pk_bf16_f32 v56, v168, v169
  v_cvt_pk_bf16_f32 v57, v170, v171
  v_mfma_f32_16x16x32_bf16 v[80:83], v[64:67], a[172:175], v[80:83]
  ds_read2st64_b32 v[88:89], v69 offset0:0 offset1:2
  ds_read2st64_b32 v[78:79], v68 offset0:4 offset1:6
  v_add_f32 v100, v100, v101
  v_mfma_f32_16x16x32_bf16 v[80:83], v[60:63], a[160:163], v[80:83]
  ds_read2st64_b32 v[90:91], v69 offset0:4 offset1:6
  ds_read2st64_b32 v[156:157], v54 offset0:0 offset1:2
  v_mfma_f32_16x16x32_bf16 v[80:83], a[252:255], a[148:151], v[80:83]
  buffer_load_dwordx4 v6, s[8:11], s31 offen offset:128 nt lds
  v_mfma_f32_16x16x32_bf16 v[168:171], a[252:255], a[152:155], 0
  s_add_u32 m0, s29, 16128
  ds_read2st64_b32 v[96:97], v55 offset0:0 offset1:2
  ds_read2st64_b32 v[158:159], v54 offset0:4 offset1:6
  v_mfma_f32_16x16x32_bf16 v[168:171], v[60:63], a[164:167], v[168:171]
  ds_read2st64_b32 v[98:99], v55 offset0:4 offset1:6
  v_rcp_f32 v150, v148
  v_mfma_f32_16x16x32_bf16 v[168:171], v[64:67], a[176:179], v[168:171]
  v_cvt_pk_bf16_f32 v60, v80, v81
  v_cvt_pk_bf16_f32 v61, v82, v83
  v_mul_f32 v144, v150, v144
  v_mfma_f32_16x16x32_bf16 v[168:171], v[164:167], a[188:191], v[168:171]
  buffer_load_dwordx4 v6, s[8:11], s31 offen offset:256 nt lds
  v_mul_f32 v145, v150, v145
  v_mfma_f32_16x16x32_bf16 v[168:171], v[140:143], a[200:203], v[168:171]
  s_add_u32 m0, s29, 4096
  v_mul_f32 v146, v150, v146
  v_mul_f32 v147, v150, v147
  v_cvt_pk_bf16_f32 v144, v144, v145
  v_mfma_f32_16x16x32_bf16 v[168:171], a[248:251], a[212:215], v[168:171]
  s_waitcnt lgkmcnt(4)
  v_perm_b32 v216, v88, v76, s58
  v_perm_b32 v220, v88, v76, s59
  v_perm_b32 v217, v89, v77, s58
  v_mfma_f32_16x16x32_bf16 v[164:167], a[0:3], a[244:247], 0
L_hop_2_0:
  s_cbranch_execz L_hop_2_1
  s_waitcnt lgkmcnt(0)
  v_perm_b32 v221, v89, v77, s59
  v_perm_b32 v218, v90, v78, s58
  v_perm_b32 v222, v90, v78, s59
  v_mfma_f32_16x16x32_bf16 v[164:167], a[12:15], v[108:111], v[164:167]
  buffer_load_dwordx4 v6, s[8:11], s32 offen offset:0 nt lds
  v_perm_b32 v219, v91, v79, s58
  v_mfma_f32_16x16x32_bf16 v[164:167], a[24:27], v[172:175], v[164:167]
  s_add_u32 m0, s29, 12160
  v_cvt_pk_bf16_f32 v64, v168, v169
  v_cvt_pk_bf16_f32 v65, v170, v171
  v_perm_b32 v223, v91, v79, s59
  v_mfma_f32_16x16x32_bf16 v[164:167], a[36:39], v[116:119], v[164:167]
  s_add_u32 s31, s31, s43
  v_perm_b32 v224, v96, v156, s58
  v_perm_b32 v228, v96, v156, s59
  v_perm_b32 v225, v97, v157, s58
  v_mfma_f32_16x16x32_bf16 v[164:167], a[48:51], v[176:179], v[164:167]
  v_perm_b32 v229, v97, v157, s59
  v_perm_b32 v226, v98, v158, s58
  v_perm_b32 v230, v98, v158, s59
  v_mfma_f32_16x16x32_bf16 v[164:167], a[60:63], v[84:87], v[164:167]
  buffer_load_dwordx4 v6, s[8:11], s32 offen offset:128 nt lds
  v_perm_b32 v227, v99, v159, s58
  v_mfma_f32_16x16x32_bf16 v[168:171], a[64:67], v[84:87], 0
  s_add_u32 m0, s29, 20224
  ds_read2st64_b32 v[76:77], v68 offset0:16 offset1:18
  ds_read2st64_b32 v[88:89], v69 offset0:16 offset1:18
  v_perm_b32 v231, v99, v159, s59
  v_mfma_f32_16x16x32_bf16 v[168:171], a[52:55], v[176:179], v[168:171]
  s_mov_b32 s29, s30
  ds_read2st64_b32 v[78:79], v68 offset0:20 offset1:22
  ds_read2st64_b32 v[90:91], v69 offset0:20 offset1:22
  v_cvt_pk_bf16_f32 v145, v146, v147
  v_mfma_f32_16x16x32_bf16 v[168:171], a[40:43], v[116:119], v[168:171]
  ds_read2st64_b32 v[156:157], v54 offset0:16 offset1:18
  v_cvt_pk_bf16_f32 v80, v164, v165
  v_cvt_pk_bf16_f32 v81, v166, v167
  v_mfma_f32_16x16x32_bf16 v[168:171], a[28:31], v[172:175], v[168:171]
  buffer_load_dwordx4 v6, s[8:11], s32 offen offset:256 nt lds
  v_mul_f32 v128, v150, v128
  v_mfma_f32_16x16x32_bf16 v[168:171], a[16:19], v[108:111], v[168:171]
  s_add_u32 s32, s32, s43
  ds_read2st64_b32 v[96:97], v55 offset0:16 offset1:18
  ds_read2st64_b32 v[158:159], v54 offset0:20 offset1:22
  v_mul_f32 v129, v150, v129
  v_mfma_f32_16x16x32_bf16 v[168:171], a[4:7], a[244:247], v[168:171]
  ds_read2st64_b32 v[98:99], v55 offset0:20 offset1:22
  v_mul_f32 v130, v150, v130
  v_mul_f32 v131, v150, v131
  v_mfma_f32_16x16x32_bf16 v[164:167], a[8:11], a[244:247], 0
  s_waitcnt lgkmcnt(4)
  v_cvt_pk_bf16_f32 v128, v128, v129
  v_cvt_pk_bf16_f32 v129, v130, v131
  v_mul_f32 v152, v150, v152
  v_mfma_f32_16x16x32_bf16 v[164:167], a[20:23], v[108:111], v[164:167]
  v_mul_f32 v153, v150, v153
  v_mul_f32 v154, v150, v154
  v_mfma_f32_16x16x32_bf16 v[164:167], a[32:35], v[172:175], v[164:167]
  v_cvt_pk_bf16_f32 v82, v168, v169
  v_cvt_pk_bf16_f32 v83, v170, v171
  v_mfma_f32_16x16x32_bf16 v[164:167], a[44:47], v[116:119], v[164:167]
  v_mul_f32 v155, v150, v155
  v_cvt_pk_bf16_f32 v152, v152, v153
  v_mfma_f32_16x16x32_bf16 v[164:167], a[56:59], v[176:179], v[164:167]
  s_waitcnt lgkmcnt(0)
  v_cvt_pk_bf16_f32 v153, v154, v155
  v_max3_f32 v9, v148, v150, v9
  v_mfma_f32_16x16x32_bf16 v[164:167], a[68:71], v[84:87], v[164:167]
  ds_write2st64_b32 v5, v144, v145 offset0:1 offset1:5
  v_mfma_f32_16x16x32_bf16 v[168:171], a[132:135], v[84:87], 0
  ds_write2st64_b32 v5, v128, v129 offset0:9 offset1:13
  v_mfma_f32_16x16x32_bf16 v[168:171], a[120:123], v[176:179], v[168:171]
  ds_write2st64_b32 v5, v152, v153 offset0:17 offset1:21
  v_mfma_f32_16x16x32_bf16 v[168:171], a[108:111], v[116:119], v[168:171]
  v_cvt_pk_bf16_f32 v16, v164, v165
  v_cvt_pk_bf16_f32 v17, v166, v167
  v_mfma_f32_16x16x32_bf16 v[168:171], a[96:99], v[172:175], v[168:171]
  v_rcp_f32 v138, v136
  v_mfma_f32_16x16x32_bf16 v[168:171], a[84:87], v[108:111], v[168:171]
  v_mul_f32 v92, v138, v92
  v_mul_f32 v93, v138, v93
  v_mfma_f32_16x16x32_bf16 v[168:171], a[72:75], a[244:247], v[168:171]
  v_mul_f32 v94, v138, v94
  v_mul_f32 v95, v138, v95
  v_mfma_f32_16x16x32_bf16 v[128:131], a[76:79], a[244:247], 0
  v_cvt_pk_bf16_f32 v92, v92, v93
  v_cvt_pk_bf16_f32 v93, v94, v95
  v_mfma_f32_16x16x32_bf16 v[128:131], a[88:91], v[108:111], v[128:131]
  v_mul_f32 v104, v138, v104
  v_mul_f32 v105, v138, v105
  v_mfma_f32_16x16x32_bf16 v[128:131], a[100:103], v[172:175], v[128:131]
  v_cvt_pk_bf16_f32 v144, v168, v169
  v_cvt_pk_bf16_f32 v145, v170, v171
  v_mfma_f32_16x16x32_bf16 v[128:131], a[112:115], v[116:119], v[128:131]
  v_mul_f32 v106, v138, v106
  v_mul_f32 v107, v138, v107
  v_mfma_f32_16x16x32_bf16 v[128:131], a[124:127], v[176:179], v[128:131]
  v_cvt_pk_bf16_f32 v104, v104, v105
  v_cvt_pk_bf16_f32 v105, v106, v107
  v_mfma_f32_16x16x32_bf16 v[128:131], a[136:139], v[84:87], v[128:131]
  v_mul_f32 v132, v138, v132
  v_mul_f32 v133, v138, v133
  v_mfma_f32_16x16x32_bf16 v[140:143], a[140:143], v[84:87], 0
  v_mul_f32 v134, v138, v134
  v_mul_f32 v135, v138, v135
  v_mfma_f32_16x16x32_bf16 v[140:143], a[128:131], v[176:179], v[140:143]
  v_cvt_pk_bf16_f32 v132, v132, v133
  v_cvt_pk_bf16_f32 v133, v134, v135
  v_mfma_f32_16x16x32_bf16 v[140:143], a[116:119], v[116:119], v[140:143]
  v_cvt_pk_bf16_f32 v146, v128, v129
  v_cvt_pk_bf16_f32 v147, v130, v131
  v_mfma_f32_16x16x32_bf16 v[140:143], a[104:107], v[172:175], v[140:143]
  v_max3_f32 v9, v136, v138, v9
  v_perm_b32 v232, v88, v76, s58
  v_mfma_f32_16x16x32_bf16 v[140:143], a[92:95], v[108:111], v[140:143]
  ds_write2st64_b32 v5, v92, v93 offset0:2 offset1:6
  v_mfma_f32_16x16x32_bf16 v[140:143], a[80:83], a[244:247], v[140:143]
  ds_write2st64_b32 v5, v104, v105 offset0:10 offset1:14
  v_mfma_f32_16x16x32_bf16 v[152:155], a[244:247], a[144:147], 0
  ds_write2st64_b32 v5, v132, v133 offset0:18 offset1:22
  v_mfma_f32_16x16x32_bf16 v[152:155], v[108:111], a[156:159], v[152:155]
  v_rcp_f32 v102, v100
  v_mfma_f32_16x16x32_bf16 v[152:155], v[172:175], a[168:171], v[152:155]
  v_cvt_pk_bf16_f32 v148, v140, v141
  v_cvt_pk_bf16_f32 v149, v142, v143
  v_mfma_f32_16x16x32_bf16 v[152:155], v[116:119], a[180:183], v[152:155]
  v_mul_f32 v70, v102, v70
  v_mul_f32 v71, v102, v71
  v_mfma_f32_16x16x32_bf16 v[152:155], v[176:179], a[192:195], v[152:155]
  s_waitcnt vmcnt(6) lgkmcnt(0)
  s_barrier
  v_mfma_f32_16x16x32_bf16 v[152:155], v[84:87], a[204:207], v[152:155]
  ds_read_b128 v[140:143], v0 offset:4096
  ds_read_b128 v[104:107], v1 offset:4096
  v_mfma_f32_16x16x32_bf16 v[128:131], v[84:87], a[208:211], 0
  ds_read_b128 a[252:255], v0 offset:12288
  ds_read_b128 v[164:167], v1 offset:12288
  v_mfma_f32_16x16x32_bf16 v[128:131], v[176:179], a[196:199], v[128:131]
  ds_read_b128 v[136:139], v0 offset:20480
  ds_read_b128 v[168:171], v1 offset:20480
  v_mfma_f32_16x16x32_bf16 v[128:131], v[116:119], a[184:187], v[128:131]
  v_cvt_pk_bf16_f32 v58, v152, v153
  v_cvt_pk_bf16_f32 v59, v154, v155
  v_mfma_f32_16x16x32_bf16 v[128:131], v[172:175], a[172:175], v[128:131]
  v_mul_f32 v72, v102, v72
  v_mul_f32 v73, v102, v73
  v_mfma_f32_16x16x32_bf16 v[128:131], v[108:111], a[160:163], v[128:131]
  v_cvt_pk_bf16_f32 v70, v70, v71
  v_cvt_pk_bf16_f32 v71, v72, v73
  v_mfma_f32_16x16x32_bf16 v[128:131], a[244:247], a[148:151], v[128:131]
  v_mul_f32 v112, v102, v112
  v_mul_f32 v113, v102, v113
  v_mfma_f32_16x16x32_bf16 v[132:135], a[244:247], a[152:155], 0
  v_mul_f32 v114, v102, v114
  v_mul_f32 v115, v102, v115
  v_mfma_f32_16x16x32_bf16 v[132:135], v[108:111], a[164:167], v[132:135]
  v_cvt_pk_bf16_f32 v112, v112, v113
  v_cvt_pk_bf16_f32 v113, v114, v115
  v_mfma_f32_16x16x32_bf16 v[132:135], v[172:175], a[176:179], v[132:135]
  v_cvt_pk_bf16_f32 v62, v128, v129
  v_cvt_pk_bf16_f32 v63, v130, v131
  v_mfma_f32_16x16x32_bf16 v[132:135], v[116:119], a[188:191], v[132:135]
  v_mul_f32 v180, v102, v180
  v_mul_f32 v181, v102, v181
  v_mfma_f32_16x16x32_bf16 v[132:135], v[176:179], a[200:203], v[132:135]
  v_mul_f32 v182, v102, v182
  v_mul_f32 v183, v102, v183
  v_mfma_f32_16x16x32_bf16 v[132:135], v[84:87], a[212:215], v[132:135]
  s_waitcnt lgkmcnt(0)
  v_cvt_pk_bf16_f32 v180, v180, v181
  v_cvt_pk_bf16_f32 v181, v182, v183
  v_mfma_f32_16x16x32_bf16 v[128:131], a[0:3], v[140:143], 0
  v_max3_f32 v9, v100, v102, v9
  v_perm_b32 v236, v88, v76, s59
  v_mfma_f32_16x16x32_bf16 v[128:131], a[12:15], v[104:107], v[128:131]
  ds_write2st64_b32 v5, v70, v71 offset0:3 offset1:7
  v_mfma_f32_16x16x32_bf16 v[128:131], a[24:27], a[252:255], v[128:131]
  v_cvt_pk_bf16_f32 v66, v132, v133
  v_cvt_pk_bf16_f32 v67, v134, v135
  v_mfma_f32_16x16x32_bf16 v[128:131], a[36:39], v[164:167], v[128:131]
  ds_write2st64_b32 v5, v112, v113 offset0:11 offset1:15
  v_mfma_f32_16x16x32_bf16 v[128:131], a[48:51], v[136:139], v[128:131]
  ds_write2st64_b32 v5, v180, v181 offset0:19 offset1:23
  v_mfma_f32_16x16x32_bf16 v[128:131], a[60:63], v[168:171], v[128:131]
  v_perm_b32 v233, v89, v77, s58
  v_perm_b32 v237, v89, v77, s59
  v_mfma_f32_16x16x32_bf16 v[84:87], a[64:67], v[168:171], 0
  v_perm_b32 v234, v90, v78, s58
  v_perm_b32 v238, v90, v78, s59
  v_mfma_f32_16x16x32_bf16 v[84:87], a[52:55], v[136:139], v[84:87]
  v_perm_b32 v235, v91, v79, s58
  v_perm_b32 v239, v91, v79, s59
  v_mfma_f32_16x16x32_bf16 v[84:87], a[40:43], v[164:167], v[84:87]
  v_cvt_pk_bf16_f32 v18, v128, v129
  v_cvt_pk_bf16_f32 v19, v130, v131
  v_mfma_f32_16x16x32_bf16 v[84:87], a[28:31], a[252:255], v[84:87]
  v_perm_b32 v240, v96, v156, s58
  v_perm_b32 v244, v96, v156, s59
  v_mfma_f32_16x16x32_bf16 v[84:87], a[16:19], v[104:107], v[84:87]
  v_perm_b32 v241, v97, v157, s58
  v_perm_b32 v245, v97, v157, s59
  v_mfma_f32_16x16x32_bf16 v[84:87], a[4:7], v[140:143], v[84:87]
  v_perm_b32 v242, v98, v158, s58
  v_perm_b32 v246, v98, v158, s59
  v_mfma_f32_16x16x32_bf16 v[108:111], a[8:11], v[140:143], 0
  v_perm_b32 v243, v99, v159, s58
  v_perm_b32 v247, v99, v159, s59
  v_mfma_f32_16x16x32_bf16 v[108:111], a[20:23], v[104:107], v[108:111]
  v_add_u32 v68, 102400, v68
  v_add_u32 v69, 102400, v69
  v_mfma_f32_16x16x32_bf16 v[108:111], a[32:35], a[252:255], v[108:111]
  v_cvt_pk_bf16_f32 v100, v84, v85
  v_cvt_pk_bf16_f32 v101, v86, v87
  v_mfma_f32_16x16x32_bf16 v[108:111], a[44:47], v[164:167], v[108:111]
  v_add_u32 v54, 102400, v54
  v_add_u32 v55, 102400, v55
  v_mfma_f32_16x16x32_bf16 v[108:111], a[56:59], v[136:139], v[108:111]
  ds_read2st64_b32 v[76:77], v68 offset0:0 offset1:2
  ds_read2st64_b32 v[88:89], v69 offset0:0 offset1:2
  v_mfma_f32_16x16x32_bf16 v[108:111], a[68:71], v[168:171], v[108:111]
  ds_read2st64_b32 v[78:79], v68 offset0:4 offset1:6
  ds_read2st64_b32 v[90:91], v69 offset0:4 offset1:6
  v_mfma_f32_16x16x32_bf16 v[84:87], a[132:135], v[168:171], 0
  ds_read2st64_b32 v[156:157], v54 offset0:0 offset1:2
  ds_read2st64_b32 v[96:97], v55 offset0:0 offset1:2
  v_mfma_f32_16x16x32_bf16 v[84:87], a[120:123], v[136:139], v[84:87]
  ds_read2st64_b32 v[158:159], v54 offset0:4 offset1:6
  ds_read2st64_b32 v[98:99], v55 offset0:4 offset1:6
  v_mfma_f32_16x16x32_bf16 v[84:87], a[108:111], v[164:167], v[84:87]
  v_cvt_pk_bf16_f32 v102, v108, v109
  v_cvt_pk_bf16_f32 v103, v110, v111
  v_mfma_f32_16x16x32_bf16 v[84:87], a[96:99], a[252:255], v[84:87]
  v_xor_b32 v5, s41, v5
  v_mfma_f32_16x16x32_bf16 v[84:87], a[84:87], v[104:107], v[84:87]
  s_waitcnt lgkmcnt(4)
  v_perm_b32 v248, v88, v76, s58
  v_perm_b32 v252, v88, v76, s59
  v_mfma_f32_16x16x32_bf16 v[84:87], a[72:75], v[140:143], v[84:87]
  v_perm_b32 v249, v89, v77, s58
  v_perm_b32 v253, v89, v77, s59
  v_mfma_f32_16x16x32_bf16 v[108:111], a[76:79], v[140:143], 0
  s_waitcnt lgkmcnt(0)
  v_perm_b32 v250, v90, v78, s58
  v_perm_b32 v254, v90, v78, s59
  v_mfma_f32_16x16x32_bf16 v[108:111], a[88:91], v[104:107], v[108:111]
  v_perm_b32 v251, v91, v79, s58
  v_perm_b32 v255, v91, v79, s59
  v_mfma_f32_16x16x32_bf16 v[108:111], a[100:103], a[252:255], v[108:111]
  v_cvt_pk_bf16_f32 v128, v84, v85
  v_cvt_pk_bf16_f32 v129, v86, v87
  v_mfma_f32_16x16x32_bf16 v[108:111], a[112:115], v[164:167], v[108:111]
  v_perm_b32 v70, v96, v156, s58
  v_perm_b32 v156, v96, v156, s59
  v_mfma_f32_16x16x32_bf16 v[108:111], a[124:127], v[136:139], v[108:111]
  v_accvgpr_write_b32 a220, v156
  v_perm_b32 v71, v97, v157, s58
  v_mfma_f32_16x16x32_bf16 v[108:111], a[136:139], v[168:171], v[108:111]
  v_perm_b32 v157, v97, v157, s59
  v_accvgpr_write_b32 a221, v157
  v_mfma_f32_16x16x32_bf16 v[112:115], a[140:143], v[168:171], 0
  v_perm_b32 v126, v98, v158, s58
  v_perm_b32 v158, v98, v158, s59
  v_mfma_f32_16x16x32_bf16 v[112:115], a[128:131], v[136:139], v[112:115]
  v_accvgpr_write_b32 a222, v158
  v_perm_b32 v127, v99, v159, s58
  v_mfma_f32_16x16x32_bf16 v[112:115], a[116:119], v[164:167], v[112:115]
  v_cvt_pk_bf16_f32 v130, v108, v109
  v_cvt_pk_bf16_f32 v131, v110, v111
  v_mfma_f32_16x16x32_bf16 v[112:115], a[104:107], a[252:255], v[112:115]
  s_add_u32 m0, s30, 0
  v_perm_b32 v159, v99, v159, s59
  v_accvgpr_write_b32 a223, v159
  v_mfma_f32_16x16x32_bf16 v[112:115], a[92:95], v[104:107], v[112:115]
  ds_read2st64_b32 v[76:77], v68 offset0:16 offset1:18
  ds_read2st64_b32 v[88:89], v69 offset0:16 offset1:18
  v_mfma_f32_16x16x32_bf16 v[112:115], a[80:83], v[140:143], v[112:115]
  ds_read2st64_b32 v[78:79], v68 offset0:20 offset1:22
  ds_read2st64_b32 v[90:91], v69 offset0:20 offset1:22
  v_mfma_f32_16x16x32_bf16 v[84:87], v[140:143], a[144:147], 0
  buffer_load_dwordx4 v6, s[8:11], s31 offen offset:0 nt lds
  v_mfma_f32_16x16x32_bf16 v[84:87], v[104:107], a[156:159], v[84:87]
  s_add_u32 m0, s30, 8064
  ds_read2st64_b32 v[156:157], v54 offset0:16 offset1:18
  ds_read2st64_b32 v[96:97], v55 offset0:16 offset1:18
  v_mfma_f32_16x16x32_bf16 v[84:87], a[252:255], a[168:171], v[84:87]
  v_cvt_pk_bf16_f32 v132, v112, v113
  v_cvt_pk_bf16_f32 v133, v114, v115
  v_mfma_f32_16x16x32_bf16 v[84:87], v[164:167], a[180:183], v[84:87]
  ds_read_b128 a[244:247], v1 offset:22528
  ds_read_b128 a[248:251], v0 offset:22528
  v_mfma_f32_16x16x32_bf16 v[84:87], v[136:139], a[192:195], v[84:87]
  buffer_load_dwordx4 v6, s[8:11], s31 offen offset:128 nt lds
  v_mfma_f32_16x16x32_bf16 v[84:87], v[168:171], a[204:207], v[84:87]
  s_add_u32 m0, s30, 16128
  ds_read_b128 v[180:183], v1 offset:14336
  ds_read_b128 v[152:155], v0 offset:14336
  v_mfma_f32_16x16x32_bf16 v[116:119], v[168:171], a[208:211], 0
  s_waitcnt lgkmcnt(6)
  ds_read_b128 v[172:175], v1 offset:6144
  ds_read_b128 v[176:179], v0 offset:6144
  v_mfma_f32_16x16x32_bf16 v[116:119], v[136:139], a[196:199], v[116:119]
  ds_read2st64_b32 v[158:159], v54 offset0:20 offset1:22
  ds_read2st64_b32 v[98:99], v55 offset0:20 offset1:22
  v_mfma_f32_16x16x32_bf16 v[116:119], v[164:167], a[184:187], v[116:119]
  buffer_load_dwordx4 v6, s[8:11], s31 offen offset:256 nt lds
  v_mfma_f32_16x16x32_bf16 v[116:119], a[252:255], a[172:175], v[116:119]
  s_add_u32 m0, s30, 4096
  v_cvt_pk_bf16_f32 v108, v84, v85
  v_cvt_pk_bf16_f32 v109, v86, v87
  v_mfma_f32_16x16x32_bf16 v[116:119], v[104:107], a[160:163], v[116:119]
  s_add_u32 s31, s31, s43
  v_accvgpr_write_b32 a216, v70
  v_accvgpr_write_b32 a217, v71
  v_mfma_f32_16x16x32_bf16 v[116:119], v[140:143], a[148:151], v[116:119]
  v_accvgpr_write_b32 a218, v126
  v_accvgpr_write_b32 a219, v127
  v_mfma_f32_16x16x32_bf16 v[68:71], v[140:143], a[152:155], 0
  buffer_load_dwordx4 v6, s[8:11], s32 offen offset:0 nt lds
  v_mfma_f32_16x16x32_bf16 v[68:71], v[104:107], a[164:167], v[68:71]
  s_add_u32 m0, s30, 12160
  v_perm_b32 v54, v88, v76, s58
  v_perm_b32 v76, v88, v76, s59
  v_mfma_f32_16x16x32_bf16 v[68:71], a[252:255], a[176:179], v[68:71]
  s_waitcnt lgkmcnt(0)
  v_cvt_pk_bf16_f32 v112, v116, v117
  v_cvt_pk_bf16_f32 v113, v118, v119
  v_mfma_f32_16x16x32_bf16 v[68:71], v[164:167], a[188:191], v[68:71]
  v_accvgpr_write_b32 a224, v54
  v_accvgpr_write_b32 a228, v76
  v_mfma_f32_16x16x32_bf16 v[68:71], v[136:139], a[200:203], v[68:71]
  buffer_load_dwordx4 v6, s[8:11], s32 offen offset:128 nt lds
  v_mfma_f32_16x16x32_bf16 v[68:71], v[168:171], a[212:215], v[68:71]
  s_add_u32 m0, s30, 20224
  v_perm_b32 v55, v89, v77, s58
  v_perm_b32 v77, v89, v77, s59
  v_mfma_f32_16x16x32_bf16 v[84:87], a[132:135], a[244:247], 0
  s_mov_b32 s30, s5
  v_accvgpr_write_b32 a225, v55
  v_accvgpr_write_b32 a229, v77
  v_mfma_f32_16x16x32_bf16 v[84:87], a[120:123], a[248:251], v[84:87]
  v_perm_b32 v54, v90, v78, s58
  v_perm_b32 v78, v90, v78, s59
  v_mfma_f32_16x16x32_bf16 v[84:87], a[108:111], v[180:183], v[84:87]
  buffer_load_dwordx4 v6, s[8:11], s32 offen offset:256 nt lds
  v_mfma_f32_16x16x32_bf16 v[84:87], a[96:99], v[152:155], v[84:87]
  s_add_u32 s32, s32, s43
  v_cvt_pk_bf16_f32 v116, v68, v69
  v_cvt_pk_bf16_f32 v117, v70, v71
  v_mfma_f32_16x16x32_bf16 v[84:87], a[84:87], v[172:175], v[84:87]
  v_accvgpr_write_b32 a226, v54
  v_accvgpr_write_b32 a230, v78
  v_mfma_f32_16x16x32_bf16 v[84:87], a[72:75], v[176:179], v[84:87]
  v_perm_b32 v55, v91, v79, s58
  v_perm_b32 v79, v91, v79, s59
  v_mfma_f32_16x16x32_bf16 v[68:71], a[76:79], v[176:179], 0
  v_accvgpr_write_b32 a227, v55
  v_accvgpr_write_b32 a231, v79
  v_mfma_f32_16x16x32_bf16 v[68:71], a[88:91], v[172:175], v[68:71]
  v_perm_b32 v54, v96, v156, s58
  v_perm_b32 v156, v96, v156, s59
  v_mfma_f32_16x16x32_bf16 v[68:71], a[100:103], v[152:155], v[68:71]
  v_cvt_pk_bf16_f32 v136, v84, v85
  v_cvt_pk_bf16_f32 v137, v86, v87
  v_mfma_f32_16x16x32_bf16 v[68:71], a[112:115], v[180:183], v[68:71]
  v_accvgpr_write_b32 a232, v54
  v_accvgpr_write_b32 a236, v156
  v_mfma_f32_16x16x32_bf16 v[68:71], a[124:127], a[248:251], v[68:71]
  v_perm_b32 v55, v97, v157, s58
  v_perm_b32 v157, v97, v157, s59
  v_mfma_f32_16x16x32_bf16 v[68:71], a[136:139], a[244:247], v[68:71]
  v_accvgpr_write_b32 a233, v55
  v_accvgpr_write_b32 a237, v157
  v_mfma_f32_16x16x32_bf16 v[84:87], a[140:143], a[244:247], 0
  v_perm_b32 v54, v98, v158, s58
  v_perm_b32 v158, v98, v158, s59
  v_mfma_f32_16x16x32_bf16 v[84:87], a[128:131], a[248:251], v[84:87]
  v_accvgpr_write_b32 a234, v54
  v_accvgpr_write_b32 a238, v158
  v_mfma_f32_16x16x32_bf16 v[84:87], a[116:119], v[180:183], v[84:87]
  v_cvt_pk_bf16_f32 v138, v68, v69
  v_cvt_pk_bf16_f32 v139, v70, v71
  v_mfma_f32_16x16x32_bf16 v[84:87], a[104:107], v[152:155], v[84:87]
  v_perm_b32 v54, v99, v159, s58
  v_perm_b32 v159, v99, v159, s59
  v_mfma_f32_16x16x32_bf16 v[84:87], a[92:95], v[172:175], v[84:87]
  v_accvgpr_write_b32 a235, v54
  v_accvgpr_write_b32 a239, v159
  v_mfma_f32_16x16x32_bf16 v[84:87], a[80:83], v[176:179], v[84:87]
  v_add_u32 v0, s28, v2
  v_xor_b32 v1, 64, v0
  v_mfma_f32_16x16x32_bf16 v[92:95], v[122:125], v[160:163], v[36:39]
  v_mfma_f32_16x16x32_bf16 v[92:95], v[120:123], v[12:15], v[92:95]
  v_mfma_f32_16x16x32_bf16 v[96:99], v[146:149], v[160:163], v[32:35]
  v_cvt_pk_bf16_f32 v140, v84, v85
  v_cvt_pk_bf16_f32 v141, v86, v87
  v_mfma_f32_16x16x32_bf16 v[96:99], v[144:147], v[12:15], v[96:99]
  v_mfma_f32_16x16x32_bf16 v[104:107], v[130:133], v[160:163], v[28:31]
  v_exp_f32 v92, v92
  v_mfma_f32_16x16x32_bf16 v[104:107], v[128:131], v[12:15], v[104:107]
  v_exp_f32 v93, v93
  v_mfma_f32_16x16x32_bf16 v[168:171], v[138:141], v[160:163], v[24:27]
  s_lshr_b32 s44, s2, 3
  v_exp_f32 v94, v94
  v_mfma_f32_16x16x32_bf16 v[168:171], v[136:139], v[12:15], v[168:171]
  s_lshl_b32 s44, s44, 9
  v_exp_f32 v95, v95
  v_mfma_f32_16x16x32_bf16 v[84:87], v[120:123], v[80:83], v[40:43]
  s_add_u32 s44, s44, 1048576
  v_exp_f32 v96, v96
  v_mfma_f32_16x16x32_bf16 v[84:87], v[122:125], v[14:17], v[84:87]
  s_mov_b32 s45, 0
  v_exp_f32 v97, v97
  v_mfma_f32_16x16x32_bf16 v[88:91], v[144:147], v[80:83], v[36:39]
  s_mov_b32 s59, 1
  v_exp_f32 v98, v98
  v_mfma_f32_16x16x32_bf16 v[88:91], v[146:149], v[14:17], v[88:91]
  s_mov_b32 s58, 0
  v_exp_f32 v99, v99
  v_mfma_f32_16x16x32_bf16 v[68:71], v[128:131], v[80:83], v[32:35]
  s_mov_b64 s[12:13], 0
  v_exp_f32 v104, v104
  v_mfma_f32_16x16x32_bf16 v[68:71], v[130:133], v[14:17], v[68:71]
  s_mov_b64 s[16:17], 0
  v_exp_f32 v105, v105
  v_mfma_f32_16x16x32_bf16 v[164:167], v[136:139], v[80:83], v[28:31]
  s_mov_b64 s[18:19], 0
  v_exp_f32 v106, v106
  v_mfma_f32_16x16x32_bf16 v[164:167], v[138:141], v[14:17], v[164:167]
  s_mov_b64 s[60:61], 0
  v_exp_f32 v107, v107
  v_mfma_f32_16x16x32_bf16 v[76:79], v[130:133], v[100:103], v[36:39]
  s_mov_b32 s15, 0
  v_exp_f32 v168, v168
  v_mfma_f32_16x16x32_bf16 v[76:79], v[128:131], v[18:21], v[76:79]
  s_mov_b32 s99, 0
  v_exp_f32 v169, v169
  v_mfma_f32_16x16x32_bf16 v[80:83], v[138:141], v[100:103], v[32:35]
  s_mov_b64 s[100:101], 0
  v_exp_f32 v170, v170
  v_mfma_f32_16x16x32_bf16 v[80:83], v[136:139], v[18:21], v[80:83]
  s_mov_b32 s14, 0
  v_exp_f32 v171, v171
  v_mfma_f32_16x16x32_bf16 v[156:159], v[122:125], v[100:103], v[44:47]
  s_mov_b32 s7, s22
  v_cvt_pk_bf16_f32 v92, v92, v93
  v_cvt_pk_bf16_f32 v93, v94, v95
  v_mfma_f32_16x16x32_bf16 v[156:159], v[120:123], v[18:21], v[156:159]
  v_cvt_pk_bf16_f32 v94, v96, v97
  v_cvt_pk_bf16_f32 v95, v98, v99
  v_mfma_f32_16x16x32_bf16 v[160:163], v[146:149], v[100:103], v[40:43]
  v_cvt_pk_bf16_f32 v96, v104, v105
  v_cvt_pk_bf16_f32 v97, v106, v107
  v_mfma_f32_16x16x32_bf16 v[160:163], v[144:147], v[18:21], v[160:163]
  v_cvt_pk_bf16_f32 v98, v168, v169
  v_cvt_pk_bf16_f32 v99, v170, v171
  v_mfma_f32_16x16x32_bf16 v[100:103], a[0:3], v[176:179], 0
  v_exp_f32 v84, v84
  v_mfma_f32_16x16x32_bf16 v[100:103], a[12:15], v[172:175], v[100:103]
  v_exp_f32 v85, v85
  v_mfma_f32_16x16x32_bf16 v[100:103], a[24:27], v[152:155], v[100:103]
  v_exp_f32 v86, v86
  v_mfma_f32_16x16x32_bf16 v[100:103], a[36:39], v[180:183], v[100:103]
  v_exp_f32 v87, v87
  v_mfma_f32_16x16x32_bf16 v[100:103], a[48:51], a[248:251], v[100:103]
  v_exp_f32 v88, v88
  v_mfma_f32_16x16x32_bf16 v[100:103], a[60:63], a[244:247], v[100:103]
  v_exp_f32 v89, v89
  v_mfma_f32_16x16x32_bf16 v[104:107], a[64:67], a[244:247], 0
  v_exp_f32 v90, v90
  v_mfma_f32_16x16x32_bf16 v[104:107], a[52:55], a[248:251], v[104:107]
  v_exp_f32 v91, v91
  v_mfma_f32_16x16x32_bf16 v[104:107], a[40:43], v[180:183], v[104:107]
  v_cvt_pk_bf16_f32 v168, v100, v101
  v_cvt_pk_bf16_f32 v169, v102, v103
  v_mfma_f32_16x16x32_bf16 v[104:107], a[28:31], v[152:155], v[104:107]
  v_exp_f32 v68, v68
  v_mfma_f32_16x16x32_bf16 v[104:107], a[16:19], v[172:175], v[104:107]
  v_exp_f32 v69, v69
  v_mfma_f32_16x16x32_bf16 v[104:107], a[4:7], v[176:179], v[104:107]
  v_exp_f32 v70, v70
  v_mfma_f32_16x16x32_bf16 v[100:103], a[8:11], v[176:179], 0
  v_exp_f32 v71, v71
  v_mfma_f32_16x16x32_bf16 v[100:103], a[20:23], v[172:175], v[100:103]
  v_exp_f32 v164, v164
  v_mfma_f32_16x16x32_bf16 v[100:103], a[32:35], v[152:155], v[100:103]
  v_cvt_pk_bf16_f32 v170, v104, v105
  v_cvt_pk_bf16_f32 v171, v106, v107
  v_mfma_f32_16x16x32_bf16 v[100:103], a[44:47], v[180:183], v[100:103]
  v_exp_f32 v165, v165
  v_mfma_f32_16x16x32_bf16 v[100:103], a[56:59], a[248:251], v[100:103]
  v_exp_f32 v166, v166
  v_mfma_f32_16x16x32_bf16 v[100:103], a[68:71], a[244:247], v[100:103]
  v_exp_f32 v167, v167
  v_mfma_f32_16x16x32_bf16 v[72:75], v[176:179], a[144:147], 0
  v_cvt_pk_bf16_f32 v84, v84, v85
  v_cvt_pk_bf16_f32 v85, v86, v87
  v_mfma_f32_16x16x32_bf16 v[72:75], v[172:175], a[156:159], v[72:75]
  v_cvt_pk_bf16_f32 v86, v88, v89
  v_cvt_pk_bf16_f32 v87, v90, v91
  v_mfma_f32_16x16x32_bf16 v[72:75], v[152:155], a[168:171], v[72:75]
  v_cvt_pk_bf16_f32 v22, v100, v101
  v_cvt_pk_bf16_f32 v23, v102, v103
  v_mfma_f32_16x16x32_bf16 v[72:75], v[180:183], a[180:183], v[72:75]
  v_cvt_pk_bf16_f32 v88, v68, v69
  v_cvt_pk_bf16_f32 v89, v70, v71
  v_mfma_f32_16x16x32_bf16 v[72:75], a[248:251], a[192:195], v[72:75]
  s_waitcnt vmcnt(6) lgkmcnt(0)
  s_barrier
  v_mfma_f32_16x16x32_bf16 v[72:75], a[244:247], a[204:207], v[72:75]
  v_cvt_pk_bf16_f32 v90, v164, v165
  v_cvt_pk_bf16_f32 v91, v166, v167
  v_mfma_f32_16x16x32_bf16 v[100:103], v[128:131], v[168:171], v[40:43]
  v_exp_f32 v76, v76
  v_mfma_f32_16x16x32_bf16 v[100:103], v[130:133], v[20:23], v[100:103]
  v_exp_f32 v77, v77
  v_mfma_f32_16x16x32_bf16 v[104:107], v[136:139], v[168:171], v[36:39]
  v_exp_f32 v78, v78
  v_mfma_f32_16x16x32_bf16 v[104:107], v[138:141], v[20:23], v[104:107]
  v_cvt_pk_bf16_f32 v110, v72, v73
  v_cvt_pk_bf16_f32 v111, v74, v75
  v_mfma_f32_16x16x32_bf16 v[132:135], v[120:123], v[168:171], v[48:51]
  ds_read_b128 v[164:167], v3 offset:0
  v_cvt_pk_bf16_f32 v76, v76, v77
  v_mfma_f32_16x16x32_bf16 v[132:135], v[122:125], v[20:23], v[132:135]
  v_exp_f32 v79, v79
  v_mfma_f32_16x16x32_bf16 v[128:131], v[144:147], v[168:171], v[44:47]
  ds_read_b128 v[136:139], v3 offset:4096
  ds_read_b128 v[140:143], v3 offset:8192
  v_mfma_f32_16x16x32_bf16 v[128:131], v[146:149], v[20:23], v[128:131]
  ds_read_b128 v[168:171], v3 offset:12288
  ds_read_b128 v[68:71], v3 offset:16384
  v_mfma_f32_16x16x32_bf16 v[124:127], a[244:247], a[208:211], 0
  ds_read_b128 v[72:75], v3 offset:20480
  v_mfma_f32_16x16x32_bf16 v[124:127], a[248:251], a[196:199], v[124:127]
  v_exp_f32 v80, v80
  v_mfma_f32_16x16x32_bf16 v[124:127], v[180:183], a[184:187], v[124:127]
  v_exp_f32 v81, v81
  v_mfma_f32_16x16x32_bf16 v[124:127], v[152:155], a[172:175], v[124:127]
  v_exp_f32 v82, v82
  v_mfma_f32_16x16x32_bf16 v[124:127], v[172:175], a[160:163], v[124:127]
  v_exp_f32 v83, v83
  v_mfma_f32_16x16x32_bf16 v[124:127], v[176:179], a[148:151], v[124:127]
  v_exp_f32 v156, v156
  v_mfma_f32_16x16x32_bf16 v[120:123], v[176:179], a[152:155], 0
  v_exp_f32 v157, v157
  v_mfma_f32_16x16x32_bf16 v[120:123], v[172:175], a[164:167], v[120:123]
  v_exp_f32 v158, v158
  v_mfma_f32_16x16x32_bf16 v[120:123], v[152:155], a[176:179], v[120:123]
  v_exp_f32 v159, v159
  v_mfma_f32_16x16x32_bf16 v[120:123], v[180:183], a[188:191], v[120:123]
  v_cvt_pk_bf16_f32 v114, v124, v125
  v_cvt_pk_bf16_f32 v115, v126, v127
  v_mfma_f32_16x16x32_bf16 v[120:123], a[248:251], a[200:203], v[120:123]
  v_mfma_f32_16x16x32_bf16 v[120:123], a[244:247], a[212:215], v[120:123]
  s_waitcnt lgkmcnt(0)
  s_branch L_mid
  .fill 576, 4, 0xbf800000
L_hop_3_0:
  s_cbranch_execz L_hop_3_1
L_pad2267:
L_loop:
  v_mfma_f32_16x16x32_bf16 v[100:103], a[0:3], v[84:87], 0
L_r208:
  v_mfma_f32_16x16x32_bf16 v[100:103], a[12:15], v[88:91], v[100:103]
L_r209:
  v_mfma_f32_16x16x32_bf16 v[100:103], a[24:27], v[92:95], v[100:103]
  v_cvt_pk_bf16_f32 v66, v128, v129
  v_cvt_pk_bf16_f32 v67, v130, v131
L_r210:
  v_mfma_f32_16x16x32_bf16 v[100:103], a[36:39], v[96:99], v[100:103]
L_r211:
  v_mfma_f32_16x16x32_bf16 v[100:103], a[48:51], v[136:139], v[100:103]
L_r212:
  v_mfma_f32_16x16x32_bf16 v[100:103], a[60:63], v[140:143], v[100:103]
L_r213:
  v_mfma_f32_16x16x32_bf16 v[104:107], a[64:67], v[140:143], 0
L_r214:
  v_mfma_f32_16x16x32_bf16 v[104:107], a[52:55], v[136:139], v[104:107]
L_r215:
  v_mfma_f32_16x16x32_bf16 v[104:107], a[40:43], v[96:99], v[104:107]
  v_cvt_pk_bf16_f32 v18, v100, v101
  v_cvt_pk_bf16_f32 v19, v102, v103
L_r216:
  v_mfma_f32_16x16x32_bf16 v[104:107], a[28:31], v[92:95], v[104:107]
L_r217:
  v_mfma_f32_16x16x32_bf16 v[104:107], a[16:19], v[88:91], v[104:107]
L_r218:
  v_mfma_f32_16x16x32_bf16 v[104:107], a[4:7], v[84:87], v[104:107]
L_r219:
  v_mfma_f32_16x16x32_bf16 v[108:111], a[8:11], v[84:87], 0
L_r220:
  v_mfma_f32_16x16x32_bf16 v[108:111], a[20:23], v[88:91], v[108:111]
L_r221:
  v_mfma_f32_16x16x32_bf16 v[108:111], a[32:35], v[92:95], v[108:111]
  v_cvt_pk_bf16_f32 v100, v104, v105
  v_cvt_pk_bf16_f32 v101, v106, v107
L_r222:
  v_mfma_f32_16x16x32_bf16 v[108:111], a[44:47], v[96:99], v[108:111]
L_r223:
  v_mfma_f32_16x16x32_bf16 v[108:111], a[56:59], v[136:139], v[108:111]
L_r224:
  v_mfma_f32_16x16x32_bf16 v[108:111], a[68:71], v[140:143], v[108:111]
L_r225:
  v_mfma_f32_16x16x32_bf16 v[104:107], a[132:135], v[140:143], 0
L_r226:
  v_mfma_f32_16x16x32_bf16 v[104:107], a[120:123], v[136:139], v[104:107]
L_r227:
  v_mfma_f32_16x16x32_bf16 v[104:107], a[108:111], v[96:99], v[104:107]
  v_cvt_pk_bf16_f32 v102, v108, v109
  v_cvt_pk_bf16_f32 v103, v110, v111
L_r228:
  v_mfma_f32_16x16x32_bf16 v[104:107], a[96:99], v[92:95], v[104:107]
L_r229:
  v_mfma_f32_16x16x32_bf16 v[104:107], a[84:87], v[88:91], v[104:107]
L_r230:
  v_mfma_f32_16x16x32_bf16 v[104:107], a[72:75], v[84:87], v[104:107]
L_r231:
  v_mfma_f32_16x16x32_bf16 v[112:115], a[76:79], v[84:87], 0
L_r232:
  v_mfma_f32_16x16x32_bf16 v[112:115], a[88:91], v[88:91], v[112:115]
L_r233:
  v_mfma_f32_16x16x32_bf16 v[112:115], a[100:103], v[92:95], v[112:115]
  v_cvt_pk_bf16_f32 v128, v104, v105
  v_cvt_pk_bf16_f32 v129, v106, v107
L_r234:
  v_mfma_f32_16x16x32_bf16 v[112:115], a[112:115], v[96:99], v[112:115]
L_r235:
  v_mfma_f32_16x16x32_bf16 v[112:115], a[124:127], v[136:139], v[112:115]
L_r236:
  v_mfma_f32_16x16x32_bf16 v[112:115], a[136:139], v[140:143], v[112:115]
L_r237:
  v_mfma_f32_16x16x32_bf16 v[108:111], a[140:143], v[140:143], 0
L_r238:
  v_mfma_f32_16x16x32_bf16 v[108:111], a[128:131], v[136:139], v[108:111]
L_r239:
  v_mfma_f32_16x16x32_bf16 v[108:111], a[116:119], v[96:99], v[108:111]
  v_cvt_pk_bf16_f32 v130, v112, v113
  v_cvt_pk_bf16_f32 v131, v114, v115
L_r240:
  v_mfma_f32_16x16x32_bf16 v[108:111], a[104:107], v[92:95], v[108:111]
L_r241:
  v_mfma_f32_16x16x32_bf16 v[108:111], a[92:95], v[88:91], v[108:111]
L_r242:
  v_mfma_f32_16x16x32_bf16 v[108:111], a[80:83], v[84:87], v[108:111]
L_r243:
  v_mfma_f32_16x16x32_bf16 v[104:107], v[84:87], a[144:147], 0
L_r244:
  v_mfma_f32_16x16x32_bf16 v[104:107], v[88:91], a[156:159], v[104:107]
  ds_read_b128 a[244:247], v1 offset:22528
L_r245:
  v_mfma_f32_16x16x32_bf16 v[104:107], v[92:95], a[168:171], v[104:107]
  v_cvt_pk_bf16_f32 v132, v108, v109
  v_cvt_pk_bf16_f32 v133, v110, v111
L_r246:
  v_mfma_f32_16x16x32_bf16 v[104:107], v[96:99], a[180:183], v[104:107]
  ds_read_b128 a[248:251], v0 offset:22528
L_r247:
  v_mfma_f32_16x16x32_bf16 v[104:107], v[136:139], a[192:195], v[104:107]
  ds_read_b128 a[252:255], v1 offset:14336
L_r248:
  v_mfma_f32_16x16x32_bf16 v[104:107], v[140:143], a[204:207], v[104:107]
  ds_read_b128 v[144:147], v0 offset:14336
L_r249:
  v_mfma_f32_16x16x32_bf16 v[116:119], v[140:143], a[208:211], 0
  ds_read_b128 v[148:151], v1 offset:6144
L_r250:
  v_mfma_f32_16x16x32_bf16 v[116:119], v[136:139], a[196:199], v[116:119]
  ds_read_b128 v[152:155], v0 offset:6144
L_r251:
  v_mfma_f32_16x16x32_bf16 v[116:119], v[96:99], a[184:187], v[116:119]
  v_cvt_pk_bf16_f32 v108, v104, v105
  v_cvt_pk_bf16_f32 v109, v106, v107
L_r252:
  v_mfma_f32_16x16x32_bf16 v[116:119], v[92:95], a[172:175], v[116:119]
L_r253:
  v_mfma_f32_16x16x32_bf16 v[116:119], v[88:91], a[160:163], v[116:119]
L_r254:
  v_mfma_f32_16x16x32_bf16 v[116:119], v[84:87], a[148:151], v[116:119]
L_r255:
  v_mfma_f32_16x16x32_bf16 v[104:107], v[84:87], a[152:155], 0
L_r256:
  v_mfma_f32_16x16x32_bf16 v[104:107], v[88:91], a[164:167], v[104:107]
L_r257:
  v_mfma_f32_16x16x32_bf16 v[104:107], v[92:95], a[176:179], v[104:107]
  v_cvt_pk_bf16_f32 v112, v116, v117
  v_cvt_pk_bf16_f32 v113, v118, v119
L_r258:
  v_mfma_f32_16x16x32_bf16 v[104:107], v[96:99], a[188:191], v[104:107]
L_r259:
  v_mfma_f32_16x16x32_bf16 v[104:107], v[136:139], a[200:203], v[104:107]
  buffer_load_dwordx2 v[52:53], v11, s[20:23], s7 offen sc1
  v_mfma_f32_16x16x32_bf16 v[104:107], v[140:143], a[212:215], v[104:107]
  s_waitcnt lgkmcnt(0)
  v_mfma_f32_16x16x32_bf16 v[88:91], a[132:135], a[244:247], 0
  v_mfma_f32_16x16x32_bf16 v[88:91], a[120:123], a[248:251], v[88:91]
  v_mfma_f32_16x16x32_bf16 v[88:91], a[108:111], a[252:255], v[88:91]
  v_cvt_pk_bf16_f32 v116, v104, v105
  v_cvt_pk_bf16_f32 v117, v106, v107
  v_mfma_f32_16x16x32_bf16 v[88:91], a[96:99], v[144:147], v[88:91]
  v_mfma_f32_16x16x32_bf16 v[88:91], a[84:87], v[148:151], v[88:91]
  s_waitcnt vmcnt(31)
  s_barrier
  v_mfma_f32_16x16x32_bf16 v[88:91], a[72:75], v[152:155], v[88:91]
  v_add_u32 v0, s28, v2
  v_xor_b32 v1, 64, v0
  v_mfma_f32_16x16x32_bf16 v[84:87], a[76:79], v[152:155], 0
  s_cmp_eq_u32 s59, 3
  v_mfma_f32_16x16x32_bf16 v[84:87], a[88:91], v[148:151], v[84:87]
  s_cselect_b32 s18, s16, s18
  v_mfma_f32_16x16x32_bf16 v[84:87], a[100:103], v[144:147], v[84:87]
  s_cselect_b32 s15, s60, s15
  v_cvt_pk_bf16_f32 v136, v88, v89
  v_cvt_pk_bf16_f32 v137, v90, v91
  v_mfma_f32_16x16x32_bf16 v[84:87], a[112:115], a[252:255], v[84:87]
  s_cmp_eq_u32 s59, 7
  v_mfma_f32_16x16x32_bf16 v[84:87], a[124:127], a[248:251], v[84:87]
  s_cselect_b32 s19, s16, s19
  v_mfma_f32_16x16x32_bf16 v[84:87], a[136:139], a[244:247], v[84:87]
  s_cselect_b32 s99, s60, s99
  v_mfma_f32_16x16x32_bf16 v[88:91], a[140:143], a[244:247], 0
  s_memrealtime s[16:17]
  v_mfma_f32_16x16x32_bf16 v[88:91], a[128:131], a[248:251], v[88:91]
  s_memtime s[60:61]
  v_mfma_f32_16x16x32_bf16 v[88:91], a[116:119], a[252:255], v[88:91]
  s_add_u32 s59, s59, 1
  v_cvt_pk_bf16_f32 v138, v84, v85
  v_cvt_pk_bf16_f32 v139, v86, v87
  v_mfma_f32_16x16x32_bf16 v[88:91], a[104:107], v[144:147], v[88:91]
  s_bitcmp1_b32 2560, s59
  v_mfma_f32_16x16x32_bf16 v[88:91], a[92:95], v[148:151], v[88:91]
  s_cselect_b32 s7, s44, s22
  v_mfma_f32_16x16x32_bf16 v[88:91], a[80:83], v[152:155], v[88:91]
  v_mfma_f32_16x16x32_bf16 v[92:95], v[70:73], v[76:79], v[36:39]
  v_mfma_f32_16x16x32_bf16 v[92:95], v[68:71], v[12:15], v[92:95]
  v_mfma_f32_16x16x32_bf16 v[96:99], v[122:125], v[76:79], v[32:35]
  v_cvt_pk_bf16_f32 v140, v88, v89
  v_cvt_pk_bf16_f32 v141, v90, v91
  v_mfma_f32_16x16x32_bf16 v[96:99], v[120:123], v[12:15], v[96:99]
  v_mfma_f32_16x16x32_bf16 v[168:171], v[130:133], v[76:79], v[28:31]
  v_exp_f32 v92, v92
  v_mfma_f32_16x16x32_bf16 v[168:171], v[128:131], v[12:15], v[168:171]
  v_exp_f32 v93, v93
  v_mfma_f32_16x16x32_bf16 v[172:175], v[138:141], v[76:79], v[24:27]
  v_exp_f32 v94, v94
  v_mfma_f32_16x16x32_bf16 v[172:175], v[136:139], v[12:15], v[172:175]
  v_exp_f32 v95, v95
  v_mfma_f32_16x16x32_bf16 v[84:87], v[68:71], v[80:83], v[40:43]
  v_exp_f32 v96, v96
  v_mfma_f32_16x16x32_bf16 v[84:87], v[70:73], v[14:17], v[84:87]
  v_exp_f32 v97, v97
  v_mfma_f32_16x16x32_bf16 v[88:91], v[120:123], v[80:83], v[36:39]
  v_exp_f32 v98, v98
  v_mfma_f32_16x16x32_bf16 v[88:91], v[122:125], v[14:17], v[88:91]
  v_exp_f32 v99, v99
  v_mfma_f32_16x16x32_bf16 v[104:107], v[128:131], v[80:83], v[32:35]
  v_exp_f32 v168, v168
  v_mfma_f32_16x16x32_bf16 v[104:107], v[130:133], v[14:17], v[104:107]
  v_exp_f32 v169, v169
  v_mfma_f32_16x16x32_bf16 v[164:167], v[136:139], v[80:83], v[28:31]
  v_exp_f32 v170, v170
  v_mfma_f32_16x16x32_bf16 v[164:167], v[138:141], v[14:17], v[164:167]
  v_exp_f32 v171, v171
  v_mfma_f32_16x16x32_bf16 v[76:79], v[130:133], v[100:103], v[36:39]
  v_exp_f32 v172, v172
  v_mfma_f32_16x16x32_bf16 v[76:79], v[128:131], v[18:21], v[76:79]
  v_exp_f32 v173, v173
  v_mfma_f32_16x16x32_bf16 v[80:83], v[138:141], v[100:103], v[32:35]
  v_exp_f32 v174, v174
  v_mfma_f32_16x16x32_bf16 v[80:83], v[136:139], v[18:21], v[80:83]
  v_exp_f32 v175, v175
  v_mfma_f32_16x16x32_bf16 v[156:159], v[70:73], v[100:103], v[44:47]
  v_cvt_pk_bf16_f32 v92, v92, v93
  v_cvt_pk_bf16_f32 v93, v94, v95
  v_mfma_f32_16x16x32_bf16 v[156:159], v[68:71], v[18:21], v[156:159]
  v_cvt_pk_bf16_f32 v94, v96, v97
  v_cvt_pk_bf16_f32 v95, v98, v99
  v_mfma_f32_16x16x32_bf16 v[160:163], v[122:125], v[100:103], v[40:43]
  v_cvt_pk_bf16_f32 v96, v168, v169
  v_cvt_pk_bf16_f32 v97, v170, v171
  v_mfma_f32_16x16x32_bf16 v[160:163], v[120:123], v[18:21], v[160:163]
  v_cvt_pk_bf16_f32 v98, v172, v173
  v_cvt_pk_bf16_f32 v99, v174, v175
  v_mfma_f32_16x16x32_bf16 v[100:103], a[0:3], v[152:155], 0
  v_exp_f32 v84, v84
  v_mfma_f32_16x16x32_bf16 v[100:103], a[12:15], v[148:151], v[100:103]
  v_exp_f32 v85, v85
  v_mfma_f32_16x16x32_bf16 v[100:103], a[24:27], v[144:147], v[100:103]
  v_exp_f32 v86, v86
  v_mfma_f32_16x16x32_bf16 v[100:103], a[36:39], a[252:255], v[100:103]
  v_exp_f32 v87, v87
  v_mfma_f32_16x16x32_bf16 v[100:103], a[48:51], a[248:251], v[100:103]
  v_exp_f32 v88, v88
  v_mfma_f32_16x16x32_bf16 v[100:103], a[60:63], a[244:247], v[100:103]
  v_exp_f32 v89, v89
  v_mfma_f32_16x16x32_bf16 v[168:171], a[64:67], a[244:247], 0
  v_exp_f32 v90, v90
  v_mfma_f32_16x16x32_bf16 v[168:171], a[52:55], a[248:251], v[168:171]
  v_exp_f32 v91, v91
  v_mfma_f32_16x16x32_bf16 v[168:171], a[40:43], a[252:255], v[168:171]
  v_cvt_pk_bf16_f32 v172, v100, v101
  v_cvt_pk_bf16_f32 v173, v102, v103
  v_mfma_f32_16x16x32_bf16 v[168:171], a[28:31], v[144:147], v[168:171]
  v_exp_f32 v104, v104
  v_mfma_f32_16x16x32_bf16 v[168:171], a[16:19], v[148:151], v[168:171]
  v_exp_f32 v105, v105
  v_mfma_f32_16x16x32_bf16 v[168:171], a[4:7], v[152:155], v[168:171]
  v_exp_f32 v106, v106
  v_mfma_f32_16x16x32_bf16 v[100:103], a[8:11], v[152:155], 0
  v_exp_f32 v107, v107
  v_mfma_f32_16x16x32_bf16 v[100:103], a[20:23], v[148:151], v[100:103]
  v_exp_f32 v164, v164
  v_mfma_f32_16x16x32_bf16 v[100:103], a[32:35], v[144:147], v[100:103]
  v_cvt_pk_bf16_f32 v174, v168, v169
  v_cvt_pk_bf16_f32 v175, v170, v171
  v_mfma_f32_16x16x32_bf16 v[100:103], a[44:47], a[252:255], v[100:103]
  v_exp_f32 v165, v165
  v_mfma_f32_16x16x32_bf16 v[100:103], a[56:59], a[248:251], v[100:103]
  v_exp_f32 v166, v166
  v_mfma_f32_16x16x32_bf16 v[100:103], a[68:71], a[244:247], v[100:103]
  v_exp_f32 v167, v167
  v_mfma_f32_16x16x32_bf16 v[168:171], v[152:155], a[144:147], 0
  v_cvt_pk_bf16_f32 v84, v84, v85
  v_cvt_pk_bf16_f32 v85, v86, v87
  v_mfma_f32_16x16x32_bf16 v[168:171], v[148:151], a[156:159], v[168:171]
  v_cvt_pk_bf16_f32 v86, v88, v89
  v_cvt_pk_bf16_f32 v87, v90, v91
  v_mfma_f32_16x16x32_bf16 v[168:171], v[144:147], a[168:171], v[168:171]
  v_cvt_pk_bf16_f32 v22, v100, v101
  v_cvt_pk_bf16_f32 v23, v102, v103
  v_mfma_f32_16x16x32_bf16 v[168:171], a[252:255], a[180:183], v[168:171]
  v_cvt_pk_bf16_f32 v88, v104, v105
  v_cvt_pk_bf16_f32 v89, v106, v107
  v_mfma_f32_16x16x32_bf16 v[168:171], a[248:251], a[192:195], v[168:171]
  v_cvt_pk_bf16_f32 v90, v164, v165
  v_cvt_pk_bf16_f32 v91, v166, v167
  v_mfma_f32_16x16x32_bf16 v[168:171], a[244:247], a[204:207], v[168:171]
  v_exp_f32 v76, v76
  v_mfma_f32_16x16x32_bf16 v[100:103], v[128:131], v[172:175], v[40:43]
  v_exp_f32 v77, v77
  v_mfma_f32_16x16x32_bf16 v[100:103], v[130:133], v[20:23], v[100:103]
  v_exp_f32 v78, v78
  v_mfma_f32_16x16x32_bf16 v[104:107], v[136:139], v[172:175], v[36:39]
  v_cvt_pk_bf16_f32 v110, v168, v169
  v_cvt_pk_bf16_f32 v111, v170, v171
  v_mfma_f32_16x16x32_bf16 v[104:107], v[138:141], v[20:23], v[104:107]
  ds_read_b128 v[164:167], v3 offset:0
  v_cvt_pk_bf16_f32 v76, v76, v77
  v_mfma_f32_16x16x32_bf16 v[132:135], v[68:71], v[172:175], v[48:51]
  ds_read_b128 v[136:139], v3 offset:4096
  v_mfma_f32_16x16x32_bf16 v[132:135], v[70:73], v[20:23], v[132:135]
  ds_read_b128 v[140:143], v3 offset:8192
  v_mfma_f32_16x16x32_bf16 v[128:131], v[120:123], v[172:175], v[44:47]
  ds_read_b128 v[168:171], v3 offset:12288
  v_mfma_f32_16x16x32_bf16 v[128:131], v[122:125], v[20:23], v[128:131]
  ds_read_b128 v[68:71], v3 offset:16384
  v_mfma_f32_16x16x32_bf16 v[172:175], a[244:247], a[208:211], 0
  ds_read_b128 v[72:75], v3 offset:20480
  v_mfma_f32_16x16x32_bf16 v[172:175], a[248:251], a[196:199], v[172:175]
  v_exp_f32 v79, v79
  v_mfma_f32_16x16x32_bf16 v[172:175], a[252:255], a[184:187], v[172:175]
  v_exp_f32 v80, v80
  v_mfma_f32_16x16x32_bf16 v[172:175], v[144:147], a[172:175], v[172:175]
  v_exp_f32 v81, v81
  v_mfma_f32_16x16x32_bf16 v[172:175], v[148:151], a[160:163], v[172:175]
  v_exp_f32 v82, v82
  v_mfma_f32_16x16x32_bf16 v[172:175], v[152:155], a[148:151], v[172:175]
  v_exp_f32 v83, v83
  v_mfma_f32_16x16x32_bf16 v[120:123], v[152:155], a[152:155], 0
  v_exp_f32 v156, v156
  v_mfma_f32_16x16x32_bf16 v[120:123], v[148:151], a[164:167], v[120:123]
  v_exp_f32 v157, v157
  v_mfma_f32_16x16x32_bf16 v[120:123], v[144:147], a[176:179], v[120:123]
  v_cvt_pk_bf16_f32 v114, v172, v173
  v_cvt_pk_bf16_f32 v115, v174, v175
  v_mfma_f32_16x16x32_bf16 v[120:123], a[252:255], a[188:191], v[120:123]
  v_exp_f32 v158, v158
  v_mfma_f32_16x16x32_bf16 v[120:123], a[248:251], a[200:203], v[120:123]
  s_waitcnt lgkmcnt(0)
  v_exp_f32 v159, v159
  v_mfma_f32_16x16x32_bf16 v[120:123], a[244:247], a[212:215], v[120:123]
L_hop_0_1:
  s_cbranch_execz L_hop_0_2
L_mid:
  v_mfma_f32_16x16x32_bf16 v[124:127], v[164:167], v[184:187], 0
  v_exp_f32 v160, v160
  v_mfma_f32_16x16x32_bf16 v[124:127], v[136:139], v[200:203], v[124:127]
  v_exp_f32 v161, v161
  v_mfma_f32_16x16x32_bf16 v[124:127], v[140:143], v[216:219], v[124:127]
  v_cvt_pk_bf16_f32 v118, v120, v121
  v_cvt_pk_bf16_f32 v119, v122, v123
  v_mfma_f32_16x16x32_bf16 v[124:127], v[168:171], v[232:235], v[124:127]
  v_exp_f32 v162, v162
  v_mfma_f32_16x16x32_bf16 v[124:127], v[68:71], v[248:251], v[124:127]
  v_exp_f32 v163, v163
  v_mfma_f32_16x16x32_bf16 v[124:127], v[72:75], a[224:227], v[124:127]
  v_cvt_pk_bf16_f32 v77, v78, v79
  v_cvt_pk_bf16_f32 v78, v80, v81
  v_mfma_f32_16x16x32_bf16 v[152:155], v[72:75], a[228:231], 0
  v_cvt_pk_bf16_f32 v79, v82, v83
  v_cvt_pk_bf16_f32 v80, v156, v157
  v_mfma_f32_16x16x32_bf16 v[152:155], v[68:71], v[252:255], v[152:155]
  ds_read_b128 v[120:123], v4 offset:0
  v_cvt_pk_bf16_f32 v81, v158, v159
  v_mfma_f32_16x16x32_bf16 v[152:155], v[168:171], v[236:239], v[152:155]
  ds_read_b128 v[144:147], v4 offset:4096
  v_cvt_pk_bf16_f32 v82, v160, v161
  v_mfma_f32_16x16x32_bf16 v[152:155], v[140:143], v[220:223], v[152:155]
  ds_read_b128 v[156:159], v4 offset:8192
  v_cvt_pk_bf16_f32 v83, v162, v163
  v_mfma_f32_16x16x32_bf16 v[152:155], v[136:139], v[204:207], v[152:155]
  ds_read_b128 v[172:175], v4 offset:12288
  v_mfma_f32_16x16x32_bf16 v[152:155], v[164:167], v[188:191], v[152:155]
  ds_read_b128 v[160:163], v4 offset:16384
  v_mfma_f32_16x16x32_bf16 v[148:151], v[164:167], v[192:195], 0
  ds_read_b128 v[176:179], v4 offset:20480
  v_mfma_f32_16x16x32_bf16 v[148:151], v[136:139], v[208:211], v[148:151]
  v_exp_f32 v100, v100
  v_mfma_f32_16x16x32_bf16 v[148:151], v[140:143], v[224:227], v[148:151]
  v_cvt_pk_bf16_f32 v124, v124, v152
  v_cvt_pk_bf16_f32 v125, v125, v153
  v_mfma_f32_16x16x32_bf16 v[148:151], v[168:171], v[240:243], v[148:151]
  v_cvt_pk_bf16_f32 v126, v126, v154
  v_cvt_pk_bf16_f32 v127, v127, v155
  v_mfma_f32_16x16x32_bf16 v[148:151], v[68:71], a[216:219], v[148:151]
  buffer_store_dword v124, v7, s[24:27], s33 offen offset:0 nt
  v_mfma_f32_16x16x32_bf16 v[148:151], v[72:75], a[232:235], v[148:151]
  v_exp_f32 v101, v101
  v_mfma_f32_16x16x32_bf16 v[152:155], v[72:75], a[236:239], 0
  v_exp_f32 v102, v102
  v_mfma_f32_16x16x32_bf16 v[152:155], v[68:71], a[220:223], v[152:155]
  buffer_store_dword v125, v7, s[24:27], s33 offen offset:384 nt
  v_mfma_f32_16x16x32_bf16 v[152:155], v[168:171], v[244:247], v[152:155]
  ds_read_b128 a[244:247], v3 offset:512
  v_cvt_pk_bf16_f32 v100, v100, v101
  v_mfma_f32_16x16x32_bf16 v[152:155], v[140:143], v[228:231], v[152:155]
  ds_read_b128 a[248:251], v3 offset:4608
  v_mfma_f32_16x16x32_bf16 v[152:155], v[136:139], v[212:215], v[152:155]
  buffer_store_dword v126, v7, s[24:27], s33 offen offset:768 nt
  v_mfma_f32_16x16x32_bf16 v[152:155], v[164:167], v[196:199], v[152:155]
  s_waitcnt lgkmcnt(2)
  ds_read_b128 a[252:255], v3 offset:8704
  v_mfma_f32_16x16x32_bf16 v[136:139], v[120:123], v[184:187], 0
  ds_read_b128 v[68:71], v3 offset:12800
  v_mfma_f32_16x16x32_bf16 v[136:139], v[144:147], v[200:203], v[136:139]
  buffer_store_dword v127, v7, s[24:27], s33 offen offset:1152 nt
  v_mfma_f32_16x16x32_bf16 v[136:139], v[156:159], v[216:219], v[136:139]
  v_cvt_pk_bf16_f32 v148, v148, v152
  v_cvt_pk_bf16_f32 v149, v149, v153
  v_mfma_f32_16x16x32_bf16 v[136:139], v[172:175], v[232:235], v[136:139]
  v_cvt_pk_bf16_f32 v150, v150, v154
  v_cvt_pk_bf16_f32 v151, v151, v155
  v_mfma_f32_16x16x32_bf16 v[136:139], v[160:163], v[248:251], v[136:139]
  buffer_store_dword v148, v8, s[24:27], s33 offen offset:0 nt
  v_mfma_f32_16x16x32_bf16 v[136:139], v[176:179], a[224:227], v[136:139]
  ds_read_b128 v[124:127], v3 offset:16896
  v_mfma_f32_16x16x32_bf16 v[72:75], v[176:179], a[228:231], 0
  ds_read_b128 v[152:155], v3 offset:20992
  v_xor_b32 v3, 40960, v3
  v_mfma_f32_16x16x32_bf16 v[72:75], v[160:163], v[252:255], v[72:75]
  buffer_store_dword v149, v8, s[24:27], s33 offen offset:384 nt
  v_mfma_f32_16x16x32_bf16 v[72:75], v[172:175], v[236:239], v[72:75]
  v_exp_f32 v103, v103
  v_mfma_f32_16x16x32_bf16 v[72:75], v[156:159], v[220:223], v[72:75]
  v_exp_f32 v104, v104
  v_mfma_f32_16x16x32_bf16 v[72:75], v[144:147], v[204:207], v[72:75]
  buffer_store_dword v150, v8, s[24:27], s33 offen offset:768 nt
  v_mfma_f32_16x16x32_bf16 v[72:75], v[120:123], v[188:191], v[72:75]
  s_waitcnt lgkmcnt(1)
  v_exp_f32 v105, v105
  v_mfma_f32_16x16x32_bf16 v[140:143], a[244:247], v[184:187], 0
  v_exp_f32 v106, v106
  v_mfma_f32_16x16x32_bf16 v[140:143], a[248:251], v[200:203], v[140:143]
  buffer_store_dword v151, v8, s[24:27], s33 offen offset:1152 nt
  v_mfma_f32_16x16x32_bf16 v[140:143], a[252:255], v[216:219], v[140:143]
  v_cvt_pk_bf16_f32 v136, v136, v72
  v_cvt_pk_bf16_f32 v137, v137, v73
  v_mfma_f32_16x16x32_bf16 v[140:143], v[68:71], v[232:235], v[140:143]
  s_waitcnt lgkmcnt(0)
  v_cvt_pk_bf16_f32 v138, v138, v74
  v_cvt_pk_bf16_f32 v139, v139, v75
  v_mfma_f32_16x16x32_bf16 v[140:143], v[124:127], v[248:251], v[140:143]
  buffer_store_dword v136, v7, s[24:27], s34 offen offset:0 nt
  v_mfma_f32_16x16x32_bf16 v[140:143], v[152:155], a[224:227], v[140:143]
  v_exp_f32 v107, v107
  v_mfma_f32_16x16x32_bf16 v[120:123], v[152:155], a[228:231], 0
  v_exp_f32 v132, v132
  v_mfma_f32_16x16x32_bf16 v[120:123], v[124:127], v[252:255], v[120:123]
  buffer_store_dword v137, v7, s[24:27], s34 offen offset:384 nt
  v_mfma_f32_16x16x32_bf16 v[120:123], v[68:71], v[236:239], v[120:123]
  ds_read_b128 v[72:75], v4 offset:512
  v_cvt_pk_bf16_f32 v101, v102, v103
  v_mfma_f32_16x16x32_bf16 v[120:123], a[252:255], v[220:223], v[120:123]
  ds_read_b128 v[148:151], v4 offset:4608
  v_cvt_pk_bf16_f32 v102, v104, v105
  v_mfma_f32_16x16x32_bf16 v[120:123], a[248:251], v[204:207], v[120:123]
  buffer_store_dword v138, v7, s[24:27], s34 offen offset:768 nt
  v_mfma_f32_16x16x32_bf16 v[120:123], a[244:247], v[188:191], v[120:123]
  ds_read_b128 v[156:159], v4 offset:8704
  v_cvt_pk_bf16_f32 v103, v106, v107
  v_mfma_f32_16x16x32_bf16 v[144:147], a[244:247], v[192:195], 0
  ds_read_b128 v[164:167], v4 offset:12800
  v_mfma_f32_16x16x32_bf16 v[144:147], a[248:251], v[208:211], v[144:147]
  buffer_store_dword v139, v7, s[24:27], s34 offen offset:1152 nt
  v_mfma_f32_16x16x32_bf16 v[144:147], a[252:255], v[224:227], v[144:147]
  v_cvt_pk_bf16_f32 v140, v140, v120
  v_cvt_pk_bf16_f32 v141, v141, v121
  v_mfma_f32_16x16x32_bf16 v[144:147], v[68:71], v[240:243], v[144:147]
  v_cvt_pk_bf16_f32 v142, v142, v122
  v_cvt_pk_bf16_f32 v143, v143, v123
  v_mfma_f32_16x16x32_bf16 v[144:147], v[124:127], a[216:219], v[144:147]
  buffer_store_dword v140, v7, s[24:27], s35 offen offset:0 nt
  v_mfma_f32_16x16x32_bf16 v[144:147], v[152:155], a[232:235], v[144:147]
  ds_read_b128 v[136:139], v4 offset:16896
  v_mfma_f32_16x16x32_bf16 v[104:107], v[152:155], a[236:239], 0
  ds_read_b128 v[168:171], v4 offset:20992
  v_xor_b32 v4, 40960, v4
  v_mfma_f32_16x16x32_bf16 v[104:107], v[124:127], a[220:223], v[104:107]
  buffer_store_dword v141, v7, s[24:27], s35 offen offset:384 nt
  v_mfma_f32_16x16x32_bf16 v[104:107], v[68:71], v[244:247], v[104:107]
  v_exp_f32 v133, v133
  v_mfma_f32_16x16x32_bf16 v[104:107], a[252:255], v[228:231], v[104:107]
  v_exp_f32 v134, v134
  v_mfma_f32_16x16x32_bf16 v[104:107], a[248:251], v[212:215], v[104:107]
  buffer_store_dword v142, v7, s[24:27], s35 offen offset:768 nt
  v_mfma_f32_16x16x32_bf16 v[104:107], a[244:247], v[196:199], v[104:107]
  s_waitcnt lgkmcnt(1)
  v_exp_f32 v135, v135
  v_mfma_f32_16x16x32_bf16 v[120:123], v[72:75], v[184:187], 0
  v_exp_f32 v128, v128
  v_mfma_f32_16x16x32_bf16 v[120:123], v[148:151], v[200:203], v[120:123]
  buffer_store_dword v143, v7, s[24:27], s35 offen offset:1152 nt
  v_mfma_f32_16x16x32_bf16 v[120:123], v[156:159], v[216:219], v[120:123]
  v_cvt_pk_bf16_f32 v144, v144, v104
  v_cvt_pk_bf16_f32 v145, v145, v105
  v_mfma_f32_16x16x32_bf16 v[120:123], v[164:167], v[232:235], v[120:123]
  s_waitcnt lgkmcnt(0)
  v_cvt_pk_bf16_f32 v146, v146, v106
  v_cvt_pk_bf16_f32 v147, v147, v107
  v_mfma_f32_16x16x32_bf16 v[120:123], v[136:139], v[248:251], v[120:123]
  buffer_store_dword v144, v8, s[24:27], s35 offen offset:0 nt
  v_mfma_f32_16x16x32_bf16 v[120:123], v[168:171], a[224:227], v[120:123]
  v_mov_b64 v[160:161], 0
  v_cvt_pk_bf16_f32 v104, v132, v133
  v_mfma_f32_16x16x32_bf16 v[124:127], v[168:171], a[228:231], 0
  v_exp_f32 v129, v129
  v_mfma_f32_16x16x32_bf16 v[124:127], v[136:139], v[252:255], v[124:127]
  buffer_store_dword v145, v8, s[24:27], s35 offen offset:384 nt
  v_mfma_f32_16x16x32_bf16 v[124:127], v[164:167], v[236:239], v[124:127]
  v_exp_f32 v130, v130
  v_mfma_f32_16x16x32_bf16 v[124:127], v[156:159], v[220:223], v[124:127]
  v_mov_b64 v[68:69], 0
  v_cvt_pk_bf16_f32 v105, v134, v135
  v_mfma_f32_16x16x32_bf16 v[124:127], v[148:151], v[204:207], v[124:127]
  buffer_store_dword v146, v8, s[24:27], s35 offen offset:768 nt
  v_mfma_f32_16x16x32_bf16 v[124:127], v[72:75], v[188:191], v[124:127]
  v_exp_f32 v131, v131
  v_smfmac_f32_16x16x64_bf16 v[160:163], a[240:243], v[92:99], v10
  v_cvt_pk_bf16_f32 v106, v128, v129
  v_cvt_pk_bf16_f32 v107, v130, v131
  v_mfma_f32_16x16x32_bf16 v[168:171], v[108:111], v[96:99], 0
  buffer_store_dword v147, v8, s[24:27], s35 offen offset:1152 nt
  v_mfma_f32_16x16x32_bf16 v[168:171], v[56:59], v[92:95], v[168:171]
  v_cvt_pk_bf16_f32 v120, v120, v124
  v_cvt_pk_bf16_f32 v121, v121, v125
  v_mfma_f32_16x16x32_bf16 v[164:167], v[60:63], v[92:95], 0
  v_cvt_pk_bf16_f32 v122, v122, v126
  v_cvt_pk_bf16_f32 v123, v123, v127
  v_mfma_f32_16x16x32_bf16 v[164:167], v[112:115], v[96:99], v[164:167]
  buffer_store_dword v120, v7, s[24:27], s36 offen offset:0 nt
  v_mfma_f32_16x16x32_bf16 v[156:159], v[116:119], v[96:99], 0
  v_mov_b64 v[72:73], 0
  v_add_f32 v160, v160, v161
  v_mfma_f32_16x16x32_bf16 v[156:159], v[64:67], v[92:95], v[156:159]
  v_rcp_f32 v162, v160
  v_smfmac_f32_16x16x64_bf16 v[68:71], a[240:243], v[84:91], v10
  buffer_store_dword v121, v7, s[24:27], s36 offen offset:384 nt
  v_mfma_f32_16x16x32_bf16 v[152:155], v[108:111], v[88:91], 0
  v_mul_f32 v168, v162, v168
  v_mul_f32 v169, v162, v169
  v_mfma_f32_16x16x32_bf16 v[152:155], v[56:59], v[84:87], v[152:155]
  v_mul_f32 v170, v162, v170
  v_mul_f32 v171, v162, v171
  v_mfma_f32_16x16x32_bf16 v[148:151], v[60:63], v[84:87], 0
  buffer_store_dword v122, v7, s[24:27], s36 offen offset:768 nt
  v_mfma_f32_16x16x32_bf16 v[148:151], v[112:115], v[88:91], v[148:151]
  ds_read_b128 a[244:247], v0 offset:0
  v_mov_b64 v[92:93], 0
  v_mfma_f32_16x16x32_bf16 v[144:147], v[116:119], v[88:91], 0
  ds_read_b128 a[248:251], v1 offset:0
  v_cvt_pk_bf16_f32 v168, v168, v169
  v_mfma_f32_16x16x32_bf16 v[144:147], v[64:67], v[84:87], v[144:147]
  buffer_store_dword v123, v7, s[24:27], s36 offen offset:1152 nt
  v_smfmac_f32_16x16x64_bf16 v[72:75], a[240:243], v[76:83], v10
  ds_read_b128 a[252:255], v0 offset:8192
  v_cvt_pk_bf16_f32 v169, v170, v171
  v_mfma_f32_16x16x32_bf16 v[140:143], v[56:59], v[80:83], 0
  ds_read_b128 v[128:131], v1 offset:8192
  v_mul_f32 v164, v162, v164
  v_mfma_f32_16x16x32_bf16 v[140:143], v[108:111], v[76:79], v[140:143]
  ds_read_b128 v[132:135], v0 offset:16384
  v_mul_f32 v165, v162, v165
  v_mfma_f32_16x16x32_bf16 v[124:127], v[112:115], v[76:79], 0
  ds_read_b128 v[136:139], v1 offset:16384
  v_mul_f32 v166, v162, v166
  v_mfma_f32_16x16x32_bf16 v[124:127], v[60:63], v[80:83], v[124:127]
  v_mul_f32 v167, v162, v167
  v_cvt_pk_bf16_f32 v164, v164, v165
  v_mfma_f32_16x16x32_bf16 v[120:123], v[64:67], v[80:83], 0
  v_cvt_pk_bf16_f32 v165, v166, v167
  v_mul_f32 v156, v162, v156
  v_mfma_f32_16x16x32_bf16 v[120:123], v[116:119], v[76:79], v[120:123]
  v_mul_f32 v157, v162, v157
  v_mul_f32 v158, v162, v158
  v_smfmac_f32_16x16x64_bf16 v[92:95], a[240:243], v[100:107], v10
  v_mul_f32 v159, v162, v159
  v_cvt_pk_bf16_f32 v156, v156, v157
  v_mfma_f32_16x16x32_bf16 v[96:99], v[56:59], v[104:107], 0
  v_cvt_pk_bf16_f32 v157, v158, v159
  v_max3_f32 v9, v160, v162, v9
  v_mfma_f32_16x16x32_bf16 v[96:99], v[108:111], v[100:103], v[96:99]
  ds_write_b32 v5, v168 offset:0
  v_mfma_f32_16x16x32_bf16 v[88:91], v[112:115], v[100:103], 0
  v_add_f32 v68, v68, v69
  v_add_f32 v72, v72, v73
  v_mfma_f32_16x16x32_bf16 v[88:91], v[60:63], v[104:107], v[88:91]
  ds_write_b32 v5, v169 offset:1024
  v_mfma_f32_16x16x32_bf16 v[84:87], v[64:67], v[104:107], 0
  v_rcp_f32 v70, v68
  v_mfma_f32_16x16x32_bf16 v[84:87], v[116:119], v[100:103], v[84:87]
  s_waitcnt lgkmcnt(2)
  ds_write_b32 v5, v164 offset:2048
  v_mfma_f32_16x16x32_bf16 v[60:63], a[0:3], a[244:247], 0
  v_mul_f32 v152, v70, v152
  v_mul_f32 v153, v70, v153
  v_mfma_f32_16x16x32_bf16 v[60:63], a[12:15], a[248:251], v[60:63]
  ds_write_b32 v5, v165 offset:3072
  v_mfma_f32_16x16x32_bf16 v[60:63], a[24:27], a[252:255], v[60:63]
  v_mul_f32 v154, v70, v154
  v_mul_f32 v155, v70, v155
  v_mfma_f32_16x16x32_bf16 v[60:63], a[36:39], v[128:131], v[60:63]
  ds_write_b32 v5, v156 offset:4096
  v_mfma_f32_16x16x32_bf16 v[60:63], a[48:51], v[132:135], v[60:63]
  s_add_u32 m0, s30, 0
  v_cvt_pk_bf16_f32 v152, v152, v153
  v_cvt_pk_bf16_f32 v153, v154, v155
  v_mfma_f32_16x16x32_bf16 v[60:63], a[60:63], v[136:139], v[60:63]
  buffer_load_dwordx4 v6, s[8:11], s31 offen offset:0 nt lds
  v_mfma_f32_16x16x32_bf16 v[56:59], a[64:67], v[136:139], 0
  v_mul_f32 v148, v70, v148
  v_mul_f32 v149, v70, v149
  v_mfma_f32_16x16x32_bf16 v[56:59], a[52:55], v[132:135], v[56:59]
  ds_write_b32 v5, v157 offset:5120
  v_mfma_f32_16x16x32_bf16 v[56:59], a[40:43], v[128:131], v[56:59]
  v_cvt_pk_bf16_f32 v12, v60, v61
  v_cvt_pk_bf16_f32 v13, v62, v63
  v_mfma_f32_16x16x32_bf16 v[56:59], a[28:31], a[252:255], v[56:59]
  v_mul_f32 v150, v70, v150
  v_mul_f32 v151, v70, v151
  v_mfma_f32_16x16x32_bf16 v[56:59], a[16:19], a[248:251], v[56:59]
  v_cvt_pk_bf16_f32 v148, v148, v149
  v_cvt_pk_bf16_f32 v149, v150, v151
  v_mfma_f32_16x16x32_bf16 v[56:59], a[4:7], a[244:247], v[56:59]
  v_mul_f32 v144, v70, v144
  v_mul_f32 v145, v70, v145
  v_mfma_f32_16x16x32_bf16 v[60:63], a[8:11], a[244:247], 0
  v_mul_f32 v146, v70, v146
  v_mul_f32 v147, v70, v147
  v_mfma_f32_16x16x32_bf16 v[60:63], a[20:23], a[248:251], v[60:63]
  v_cvt_pk_bf16_f32 v144, v144, v145
  v_cvt_pk_bf16_f32 v145, v146, v147
  v_mfma_f32_16x16x32_bf16 v[60:63], a[32:35], a[252:255], v[60:63]
  v_cvt_pk_bf16_f32 v76, v56, v57
  v_cvt_pk_bf16_f32 v77, v58, v59
  v_mfma_f32_16x16x32_bf16 v[60:63], a[44:47], v[128:131], v[60:63]
  v_max3_f32 v9, v68, v70, v9
  v_add_f32 v92, v92, v93
  v_mfma_f32_16x16x32_bf16 v[60:63], a[56:59], v[132:135], v[60:63]
  ds_write_b32 v5, v152 offset:256
  v_mfma_f32_16x16x32_bf16 v[60:63], a[68:71], v[136:139], v[60:63]
  v_rcp_f32 v74, v72
  v_mfma_f32_16x16x32_bf16 v[56:59], a[132:135], v[136:139], 0
  ds_write_b32 v5, v153 offset:1280
  v_mfma_f32_16x16x32_bf16 v[56:59], a[120:123], v[132:135], v[56:59]
  v_mul_f32 v140, v74, v140
  v_mul_f32 v141, v74, v141
  v_mfma_f32_16x16x32_bf16 v[56:59], a[108:111], v[128:131], v[56:59]
  v_cvt_pk_bf16_f32 v78, v60, v61
  v_cvt_pk_bf16_f32 v79, v62, v63
  v_mfma_f32_16x16x32_bf16 v[56:59], a[96:99], a[252:255], v[56:59]
  ds_write_b32 v5, v148 offset:2304
  v_mfma_f32_16x16x32_bf16 v[56:59], a[84:87], a[248:251], v[56:59]
  s_add_u32 m0, s30, 8064
  v_mul_f32 v142, v74, v142
  v_mul_f32 v143, v74, v143
  v_mfma_f32_16x16x32_bf16 v[56:59], a[72:75], a[244:247], v[56:59]
  buffer_load_dwordx4 v6, s[8:11], s31 offen offset:128 nt lds
  v_mfma_f32_16x16x32_bf16 v[60:63], a[76:79], a[244:247], 0
  v_cvt_pk_bf16_f32 v140, v140, v141
  v_cvt_pk_bf16_f32 v141, v142, v143
  v_mfma_f32_16x16x32_bf16 v[60:63], a[88:91], a[248:251], v[60:63]
  ds_write_b32 v5, v149 offset:3328
  v_mfma_f32_16x16x32_bf16 v[60:63], a[100:103], a[252:255], v[60:63]
  v_cvt_pk_bf16_f32 v68, v56, v57
  v_cvt_pk_bf16_f32 v69, v58, v59
  v_mfma_f32_16x16x32_bf16 v[60:63], a[112:115], v[128:131], v[60:63]
  ds_write_b32 v5, v144 offset:4352
  v_mfma_f32_16x16x32_bf16 v[60:63], a[124:127], v[132:135], v[60:63]
  v_mul_f32 v124, v74, v124
  v_mul_f32 v125, v74, v125
  v_mfma_f32_16x16x32_bf16 v[60:63], a[136:139], v[136:139], v[60:63]
  ds_write_b32 v5, v145 offset:5376
  v_mfma_f32_16x16x32_bf16 v[56:59], a[140:143], v[136:139], 0
  v_mul_f32 v126, v74, v126
  v_mul_f32 v127, v74, v127
  v_mfma_f32_16x16x32_bf16 v[56:59], a[128:131], v[132:135], v[56:59]
  v_cvt_pk_bf16_f32 v124, v124, v125
  v_cvt_pk_bf16_f32 v125, v126, v127
  v_mfma_f32_16x16x32_bf16 v[56:59], a[116:119], v[128:131], v[56:59]
  v_cvt_pk_bf16_f32 v70, v60, v61
  v_cvt_pk_bf16_f32 v71, v62, v63
  v_mfma_f32_16x16x32_bf16 v[56:59], a[104:107], a[252:255], v[56:59]
  v_mul_f32 v120, v74, v120
  v_mul_f32 v121, v74, v121
  v_mfma_f32_16x16x32_bf16 v[56:59], a[92:95], a[248:251], v[56:59]
  v_mul_f32 v122, v74, v122
  v_mul_f32 v123, v74, v123
  v_mfma_f32_16x16x32_bf16 v[56:59], a[80:83], a[244:247], v[56:59]
  v_cvt_pk_bf16_f32 v120, v120, v121
  v_cvt_pk_bf16_f32 v121, v122, v123
  v_mfma_f32_16x16x32_bf16 v[60:63], a[244:247], a[144:147], 0
  v_max3_f32 v9, v72, v74, v9
  v_cndmask_b32 v7, v7, v52, s[62:63]
  v_mfma_f32_16x16x32_bf16 v[60:63], a[248:251], a[156:159], v[60:63]
  ds_read_b128 v[100:103], v0 offset:2048
  v_cndmask_b32 v8, v8, v53, s[62:63]
  v_mfma_f32_16x16x32_bf16 v[60:63], a[252:255], a[168:171], v[60:63]
  s_mov_b64 s[62:63], 0
  v_cvt_pk_bf16_f32 v72, v56, v57
  v_cvt_pk_bf16_f32 v73, v58, v59
  v_mfma_f32_16x16x32_bf16 v[60:63], v[128:131], a[180:183], v[60:63]
  ds_read_b128 v[104:107], v1 offset:2048
  v_mfma_f32_16x16x32_bf16 v[60:63], v[132:135], a[192:195], v[60:63]
  s_add_u32 m0, s30, 16128
  ds_read_b128 v[108:111], v0 offset:10240
  v_mfma_f32_16x16x32_bf16 v[60:63], v[136:139], a[204:207], v[60:63]
  buffer_load_dwordx4 v6, s[8:11], s31 offen offset:256 nt lds
  v_mfma_f32_16x16x32_bf16 v[64:67], v[136:139], a[208:211], 0
  ds_read_b128 v[112:115], v1 offset:10240
  v_mfma_f32_16x16x32_bf16 v[64:67], v[132:135], a[196:199], v[64:67]
  ds_read_b128 v[116:119], v0 offset:18432
  v_mfma_f32_16x16x32_bf16 v[64:67], v[128:131], a[184:187], v[64:67]
  v_cvt_pk_bf16_f32 v56, v60, v61
  v_cvt_pk_bf16_f32 v57, v62, v63
  v_mfma_f32_16x16x32_bf16 v[64:67], a[252:255], a[172:175], v[64:67]
  ds_read_b128 v[144:147], v1 offset:18432
  v_mfma_f32_16x16x32_bf16 v[64:67], a[248:251], a[160:163], v[64:67]
  v_rcp_f32 v94, v92
  v_mfma_f32_16x16x32_bf16 v[64:67], a[244:247], a[148:151], v[64:67]
  ds_write_b32 v5, v140 offset:512
  v_mfma_f32_16x16x32_bf16 v[80:83], a[244:247], a[152:155], 0
  v_mul_f32 v96, v94, v96
  v_mul_f32 v97, v94, v97
  v_mfma_f32_16x16x32_bf16 v[80:83], a[248:251], a[164:167], v[80:83]
  ds_write_b32 v5, v141 offset:1536
  v_mfma_f32_16x16x32_bf16 v[80:83], a[252:255], a[176:179], v[80:83]
  v_cvt_pk_bf16_f32 v60, v64, v65
  v_cvt_pk_bf16_f32 v61, v66, v67
  v_mfma_f32_16x16x32_bf16 v[80:83], v[128:131], a[188:191], v[80:83]
  ds_write_b32 v5, v124 offset:2560
  v_mfma_f32_16x16x32_bf16 v[80:83], v[132:135], a[200:203], v[80:83]
  v_mul_f32 v98, v94, v98
  v_mul_f32 v99, v94, v99
  v_mfma_f32_16x16x32_bf16 v[80:83], v[136:139], a[212:215], v[80:83]
  s_waitcnt lgkmcnt(3)
  ds_write_b32 v5, v125 offset:3584
  v_mfma_f32_16x16x32_bf16 v[128:131], a[0:3], v[100:103], 0
  v_cvt_pk_bf16_f32 v96, v96, v97
  v_cvt_pk_bf16_f32 v97, v98, v99
  v_mfma_f32_16x16x32_bf16 v[128:131], a[12:15], v[104:107], v[128:131]
  ds_write_b32 v5, v120 offset:4608
  v_mfma_f32_16x16x32_bf16 v[128:131], a[24:27], v[108:111], v[128:131]
  v_cvt_pk_bf16_f32 v64, v80, v81
  v_cvt_pk_bf16_f32 v65, v82, v83
  v_mfma_f32_16x16x32_bf16 v[128:131], a[36:39], v[112:115], v[128:131]
  ds_write_b32 v5, v121 offset:5632
  v_mfma_f32_16x16x32_bf16 v[128:131], a[48:51], v[116:119], v[128:131]
  s_add_u32 m0, s30, 4096
  v_mul_f32 v88, v94, v88
  v_mul_f32 v89, v94, v89
  v_mfma_f32_16x16x32_bf16 v[128:131], a[60:63], v[144:147], v[128:131]
  buffer_load_dwordx4 v6, s[8:11], s32 offen offset:0 nt lds
  v_mfma_f32_16x16x32_bf16 v[120:123], a[64:67], v[144:147], 0
  s_add_u32 s33, s31, s37
  v_mul_f32 v90, v94, v90
  v_mul_f32 v91, v94, v91
  v_mfma_f32_16x16x32_bf16 v[120:123], a[52:55], v[116:119], v[120:123]
  s_add_u32 s34, s31, s38
  v_cvt_pk_bf16_f32 v88, v88, v89
  v_cvt_pk_bf16_f32 v89, v90, v91
  v_mfma_f32_16x16x32_bf16 v[120:123], a[40:43], v[112:115], v[120:123]
  s_add_u32 s35, s31, s39
  v_cvt_pk_bf16_f32 v80, v128, v129
  v_cvt_pk_bf16_f32 v81, v130, v131
  v_mfma_f32_16x16x32_bf16 v[120:123], a[28:31], v[108:111], v[120:123]
  s_add_u32 s36, s31, s40
  v_mul_f32 v84, v94, v84
  v_mul_f32 v85, v94, v85
  v_mfma_f32_16x16x32_bf16 v[120:123], a[16:19], v[104:107], v[120:123]
  s_add_u32 s31, s31, s43
  v_mul_f32 v86, v94, v86
  v_mul_f32 v87, v94, v87
  v_mfma_f32_16x16x32_bf16 v[120:123], a[4:7], v[100:103], v[120:123]
  s_mov_b32 s5, s28
  v_cvt_pk_bf16_f32 v84, v84, v85
  v_cvt_pk_bf16_f32 v85, v86, v87
  v_mfma_f32_16x16x32_bf16 v[124:127], a[8:11], v[100:103], 0
  s_mov_b32 s28, s29
  v_max3_f32 v9, v92, v94, v9
  v_mfma_f32_16x16x32_bf16 v[124:127], a[20:23], v[104:107], v[124:127]
  s_mov_b32 s29, s30
  ds_write_b32 v5, v96 offset:768
  v_mfma_f32_16x16x32_bf16 v[124:127], a[32:35], v[108:111], v[124:127]
  v_cvt_pk_bf16_f32 v82, v120, v121
  v_cvt_pk_bf16_f32 v83, v122, v123
  v_mfma_f32_16x16x32_bf16 v[124:127], a[44:47], v[112:115], v[124:127]
  ds_write_b32 v5, v97 offset:1792
  v_mfma_f32_16x16x32_bf16 v[124:127], a[56:59], v[116:119], v[124:127]
  v_mfma_f32_16x16x32_bf16 v[124:127], a[68:71], v[144:147], v[124:127]
  ds_write_b32 v5, v88 offset:2816
  v_mfma_f32_16x16x32_bf16 v[92:95], a[132:135], v[144:147], 0
  v_mfma_f32_16x16x32_bf16 v[92:95], a[120:123], v[116:119], v[92:95]
  ds_write_b32 v5, v89 offset:3840
  v_mfma_f32_16x16x32_bf16 v[92:95], a[108:111], v[112:115], v[92:95]
  v_cvt_pk_bf16_f32 v16, v124, v125
  v_cvt_pk_bf16_f32 v17, v126, v127
  v_mfma_f32_16x16x32_bf16 v[92:95], a[96:99], v[108:111], v[92:95]
  ds_write_b32 v5, v84 offset:4864
  v_mfma_f32_16x16x32_bf16 v[92:95], a[84:87], v[104:107], v[92:95]
  s_add_u32 m0, s30, 12160
  v_mfma_f32_16x16x32_bf16 v[92:95], a[72:75], v[100:103], v[92:95]
  buffer_load_dwordx4 v6, s[8:11], s32 offen offset:128 nt lds
  v_mfma_f32_16x16x32_bf16 v[88:91], a[76:79], v[100:103], 0
  v_mfma_f32_16x16x32_bf16 v[88:91], a[88:91], v[104:107], v[88:91]
  ds_write_b32 v5, v85 offset:5888
  v_mfma_f32_16x16x32_bf16 v[88:91], a[100:103], v[108:111], v[88:91]
  v_cvt_pk_bf16_f32 v120, v92, v93
  v_cvt_pk_bf16_f32 v121, v94, v95
  v_mfma_f32_16x16x32_bf16 v[88:91], a[112:115], v[112:115], v[88:91]
  v_xor_b32 v5, s41, v5
  v_mfma_f32_16x16x32_bf16 v[88:91], a[124:127], v[116:119], v[88:91]
  v_mfma_f32_16x16x32_bf16 v[88:91], a[136:139], v[144:147], v[88:91]
  v_mfma_f32_16x16x32_bf16 v[92:95], a[140:143], v[144:147], 0
  v_mfma_f32_16x16x32_bf16 v[92:95], a[128:131], v[116:119], v[92:95]
  v_mfma_f32_16x16x32_bf16 v[92:95], a[116:119], v[112:115], v[92:95]
  v_cvt_pk_bf16_f32 v122, v88, v89
  v_cvt_pk_bf16_f32 v123, v90, v91
  v_mfma_f32_16x16x32_bf16 v[92:95], a[104:107], v[108:111], v[92:95]
  v_mfma_f32_16x16x32_bf16 v[92:95], a[92:95], v[104:107], v[92:95]
  v_mfma_f32_16x16x32_bf16 v[92:95], a[80:83], v[100:103], v[92:95]
  v_mfma_f32_16x16x32_bf16 v[128:131], v[100:103], a[144:147], 0
  v_mfma_f32_16x16x32_bf16 v[128:131], v[104:107], a[156:159], v[128:131]
  ds_read_b128 v[84:87], v0 offset:4096
  v_mfma_f32_16x16x32_bf16 v[128:131], v[108:111], a[168:171], v[128:131]
  v_cvt_pk_bf16_f32 v124, v92, v93
  v_cvt_pk_bf16_f32 v125, v94, v95
  v_mfma_f32_16x16x32_bf16 v[128:131], v[112:115], a[180:183], v[128:131]
  ds_read_b128 v[88:91], v1 offset:4096
  v_mfma_f32_16x16x32_bf16 v[128:131], v[116:119], a[192:195], v[128:131]
  s_add_u32 m0, s30, 20224
  ds_read_b128 v[92:95], v0 offset:12288
  v_mfma_f32_16x16x32_bf16 v[128:131], v[144:147], a[204:207], v[128:131]
  buffer_load_dwordx4 v6, s[8:11], s32 offen offset:256 nt lds
  v_mfma_f32_16x16x32_bf16 v[132:135], v[144:147], a[208:211], 0
  s_add_u32 s32, s32, s43
  ds_read_b128 v[96:99], v1 offset:12288
  v_mfma_f32_16x16x32_bf16 v[132:135], v[116:119], a[196:199], v[132:135]
  s_mov_b32 s30, s5
  ds_read_b128 v[136:139], v0 offset:20480
  v_mfma_f32_16x16x32_bf16 v[132:135], v[112:115], a[184:187], v[132:135]
  v_cvt_pk_bf16_f32 v58, v128, v129
  v_cvt_pk_bf16_f32 v59, v130, v131
  v_mfma_f32_16x16x32_bf16 v[132:135], v[108:111], a[172:175], v[132:135]
  ds_read_b128 v[140:143], v1 offset:20480
  v_mfma_f32_16x16x32_bf16 v[132:135], v[104:107], a[160:163], v[132:135]
  v_mfma_f32_16x16x32_bf16 v[132:135], v[100:103], a[148:151], v[132:135]
  v_mfma_f32_16x16x32_bf16 v[128:131], v[100:103], a[152:155], 0
  v_mfma_f32_16x16x32_bf16 v[128:131], v[104:107], a[164:167], v[128:131]
  v_mfma_f32_16x16x32_bf16 v[128:131], v[108:111], a[176:179], v[128:131]
  v_cvt_pk_bf16_f32 v62, v132, v133
  v_cvt_pk_bf16_f32 v63, v134, v135
  v_mfma_f32_16x16x32_bf16 v[128:131], v[112:115], a[188:191], v[128:131]
  s_waitcnt lgkmcnt(0)
  v_mfma_f32_16x16x32_bf16 v[128:131], v[116:119], a[200:203], v[128:131]
  s_bitcmp1_b32 s96, s59
  v_mfma_f32_16x16x32_bf16 v[128:131], v[144:147], a[212:215], v[128:131]
  s_cbranch_scc0 L_loop
L_epi:
  s_cmp_lg_u32 s59, s97
  s_cbranch_scc1 L_k2
L_full:
  v_mfma_f32_16x16x32_bf16 v[100:103], a[76:79], v[84:87], 0
  s_lshl_b32 s5, s3, 3
  v_mfma_f32_16x16x32_bf16 v[100:103], a[88:91], v[88:91], v[100:103]
  s_add_u32 s5, s5, 159744
  v_mov_b32 v11, s5
  v_mfma_f32_16x16x32_bf16 v[100:103], a[100:103], v[92:95], v[100:103]
  v_cvt_pk_bf16_f32 v66, v128, v129
  v_cvt_pk_bf16_f32 v67, v130, v131
  v_mfma_f32_16x16x32_bf16 v[100:103], a[112:115], v[96:99], v[100:103]
  ds_read_b128 a[244:247], v1 offset:22528
  v_mfma_f32_16x16x32_bf16 v[100:103], a[124:127], v[136:139], v[100:103]
  ds_read_b128 a[248:251], v0 offset:22528
  v_mfma_f32_16x16x32_bf16 v[100:103], a[136:139], v[140:143], v[100:103]
  ds_read_b128 a[252:255], v1 offset:14336
  v_mfma_f32_16x16x32_bf16 v[104:107], a[132:135], v[140:143], 0
  ds_read_b128 v[116:119], v0 offset:14336
  v_mfma_f32_16x16x32_bf16 v[104:107], a[120:123], v[136:139], v[104:107]
  ds_read_b128 v[160:163], v1 offset:6144
  v_mfma_f32_16x16x32_bf16 v[104:107], a[108:111], v[96:99], v[104:107]
  v_cvt_pk_bf16_f32 v146, v100, v101
  v_cvt_pk_bf16_f32 v147, v102, v103
  v_mfma_f32_16x16x32_bf16 v[104:107], a[96:99], v[92:95], v[104:107]
  ds_read_b128 v[164:167], v0 offset:6144
  v_mfma_f32_16x16x32_bf16 v[104:107], a[84:87], v[88:91], v[104:107]
  v_mfma_f32_16x16x32_bf16 v[104:107], a[72:75], v[84:87], v[104:107]
  v_mfma_f32_16x16x32_bf16 v[108:111], a[140:143], v[140:143], 0
  v_mfma_f32_16x16x32_bf16 v[108:111], a[128:131], v[136:139], v[108:111]
  v_mfma_f32_16x16x32_bf16 v[108:111], a[116:119], v[96:99], v[108:111]
  v_cvt_pk_bf16_f32 v144, v104, v105
  v_cvt_pk_bf16_f32 v145, v106, v107
  v_mfma_f32_16x16x32_bf16 v[108:111], a[104:107], v[92:95], v[108:111]
  v_mfma_f32_16x16x32_bf16 v[108:111], a[92:95], v[88:91], v[108:111]
  v_mfma_f32_16x16x32_bf16 v[108:111], a[80:83], v[84:87], v[108:111]
  s_waitcnt lgkmcnt(0)
  v_mfma_f32_16x16x32_bf16 v[100:103], a[132:135], a[244:247], 0
  v_mfma_f32_16x16x32_bf16 v[100:103], a[120:123], a[248:251], v[100:103]
  v_mfma_f32_16x16x32_bf16 v[100:103], a[108:111], a[252:255], v[100:103]
  v_cvt_pk_bf16_f32 v148, v108, v109
  v_cvt_pk_bf16_f32 v149, v110, v111
  v_mfma_f32_16x16x32_bf16 v[100:103], a[96:99], v[116:119], v[100:103]
  v_mfma_f32_16x16x32_bf16 v[100:103], a[84:87], v[160:163], v[100:103]
  s_waitcnt lgkmcnt(0)
  s_barrier
  v_mfma_f32_16x16x32_bf16 v[100:103], a[72:75], v[164:167], v[100:103]
  v_mfma_f32_16x16x32_bf16 v[104:107], a[76:79], v[164:167], 0
  v_mfma_f32_16x16x32_bf16 v[104:107], a[88:91], v[160:163], v[104:107]
L_hop_1_1:
  s_cbranch_execz L_hop_1_2
  v_mfma_f32_16x16x32_bf16 v[104:107], a[100:103], v[116:119], v[104:107]
  v_cvt_pk_bf16_f32 v152, v100, v101
  v_cvt_pk_bf16_f32 v153, v102, v103
  v_mfma_f32_16x16x32_bf16 v[104:107], a[112:115], a[252:255], v[104:107]
  v_mfma_f32_16x16x32_bf16 v[104:107], a[124:127], a[248:251], v[104:107]
  v_mfma_f32_16x16x32_bf16 v[104:107], a[136:139], a[244:247], v[104:107]
  v_mfma_f32_16x16x32_bf16 v[100:103], a[140:143], a[244:247], 0
  v_mfma_f32_16x16x32_bf16 v[100:103], a[128:131], a[248:251], v[100:103]
  v_mfma_f32_16x16x32_bf16 v[100:103], a[116:119], a[252:255], v[100:103]
  v_cvt_pk_bf16_f32 v154, v104, v105
  v_cvt_pk_bf16_f32 v155, v106, v107
  v_mfma_f32_16x16x32_bf16 v[100:103], a[104:107], v[116:119], v[100:103]
  v_mfma_f32_16x16x32_bf16 v[100:103], a[92:95], v[160:163], v[100:103]
  v_mfma_f32_16x16x32_bf16 v[100:103], a[80:83], v[164:167], v[100:103]
  v_mfma_f32_16x16x32_bf16 v[108:111], v[70:73], v[76:79], v[36:39]
  v_mfma_f32_16x16x32_bf16 v[108:111], v[68:71], v[12:15], v[108:111]
  v_mfma_f32_16x16x32_bf16 v[112:115], v[122:125], v[76:79], v[32:35]
  v_cvt_pk_bf16_f32 v156, v100, v101
  v_cvt_pk_bf16_f32 v157, v102, v103
  v_mfma_f32_16x16x32_bf16 v[112:115], v[120:123], v[12:15], v[112:115]
  v_mfma_f32_16x16x32_bf16 v[132:135], v[146:149], v[76:79], v[28:31]
  v_exp_f32 v108, v108
  v_mfma_f32_16x16x32_bf16 v[132:135], v[144:147], v[12:15], v[132:135]
  v_exp_f32 v109, v109
  v_mfma_f32_16x16x32_bf16 v[168:171], v[154:157], v[76:79], v[24:27]
  v_exp_f32 v110, v110
  v_mfma_f32_16x16x32_bf16 v[168:171], v[152:155], v[12:15], v[168:171]
  v_exp_f32 v111, v111
  v_mfma_f32_16x16x32_bf16 v[100:103], v[68:71], v[80:83], v[40:43]
  v_exp_f32 v112, v112
  v_mfma_f32_16x16x32_bf16 v[100:103], v[70:73], v[14:17], v[100:103]
  v_exp_f32 v113, v113
  v_mfma_f32_16x16x32_bf16 v[104:107], v[120:123], v[80:83], v[36:39]
  v_exp_f32 v114, v114
  v_mfma_f32_16x16x32_bf16 v[104:107], v[122:125], v[14:17], v[104:107]
  v_exp_f32 v115, v115
  v_mfma_f32_16x16x32_bf16 v[76:79], v[144:147], v[80:83], v[32:35]
  v_exp_f32 v132, v132
  v_mfma_f32_16x16x32_bf16 v[76:79], v[146:149], v[14:17], v[76:79]
  v_exp_f32 v133, v133
  v_mfma_f32_16x16x32_bf16 v[128:131], v[152:155], v[80:83], v[28:31]
  v_exp_f32 v134, v134
  v_mfma_f32_16x16x32_bf16 v[128:131], v[154:157], v[14:17], v[128:131]
  v_exp_f32 v135, v135
  v_mfma_f32_16x16x32_bf16 v[80:83], a[0:3], v[84:87], 0
  v_exp_f32 v168, v168
  v_mfma_f32_16x16x32_bf16 v[80:83], a[12:15], v[88:91], v[80:83]
  v_exp_f32 v169, v169
  v_mfma_f32_16x16x32_bf16 v[80:83], a[24:27], v[92:95], v[80:83]
  v_exp_f32 v170, v170
  v_mfma_f32_16x16x32_bf16 v[80:83], a[36:39], v[96:99], v[80:83]
  v_exp_f32 v171, v171
  v_mfma_f32_16x16x32_bf16 v[80:83], a[48:51], v[136:139], v[80:83]
  v_cvt_pk_bf16_f32 v108, v108, v109
  v_cvt_pk_bf16_f32 v109, v110, v111
  v_mfma_f32_16x16x32_bf16 v[80:83], a[60:63], v[140:143], v[80:83]
  v_cvt_pk_bf16_f32 v110, v112, v113
  v_cvt_pk_bf16_f32 v111, v114, v115
  v_mfma_f32_16x16x32_bf16 v[172:175], a[64:67], v[140:143], 0
  v_cvt_pk_bf16_f32 v112, v132, v133
  v_cvt_pk_bf16_f32 v113, v134, v135
  v_mfma_f32_16x16x32_bf16 v[172:175], a[52:55], v[136:139], v[172:175]
  v_cvt_pk_bf16_f32 v114, v168, v169
  v_cvt_pk_bf16_f32 v115, v170, v171
  v_mfma_f32_16x16x32_bf16 v[172:175], a[40:43], v[96:99], v[172:175]
  v_cvt_pk_bf16_f32 v18, v80, v81
  v_cvt_pk_bf16_f32 v19, v82, v83
  v_mfma_f32_16x16x32_bf16 v[172:175], a[28:31], v[92:95], v[172:175]
  v_exp_f32 v100, v100
  v_mfma_f32_16x16x32_bf16 v[172:175], a[16:19], v[88:91], v[172:175]
  v_exp_f32 v101, v101
  v_mfma_f32_16x16x32_bf16 v[172:175], a[4:7], v[84:87], v[172:175]
  v_exp_f32 v102, v102
  v_mfma_f32_16x16x32_bf16 v[132:135], a[8:11], v[84:87], 0
  v_exp_f32 v103, v103
  v_mfma_f32_16x16x32_bf16 v[132:135], a[20:23], v[88:91], v[132:135]
  v_exp_f32 v104, v104
  v_mfma_f32_16x16x32_bf16 v[132:135], a[32:35], v[92:95], v[132:135]
  v_cvt_pk_bf16_f32 v80, v172, v173
  v_cvt_pk_bf16_f32 v81, v174, v175
  v_mfma_f32_16x16x32_bf16 v[132:135], a[44:47], v[96:99], v[132:135]
  v_exp_f32 v105, v105
  v_mfma_f32_16x16x32_bf16 v[132:135], a[56:59], v[136:139], v[132:135]
  v_exp_f32 v106, v106
  v_mfma_f32_16x16x32_bf16 v[132:135], a[68:71], v[140:143], v[132:135]
  v_exp_f32 v107, v107
  v_mfma_f32_16x16x32_bf16 v[168:171], a[0:3], v[164:167], 0
  v_exp_f32 v76, v76
  v_mfma_f32_16x16x32_bf16 v[168:171], a[12:15], v[160:163], v[168:171]
  v_exp_f32 v77, v77
  v_mfma_f32_16x16x32_bf16 v[168:171], a[24:27], v[116:119], v[168:171]
  v_cvt_pk_bf16_f32 v82, v132, v133
  v_cvt_pk_bf16_f32 v83, v134, v135
  v_mfma_f32_16x16x32_bf16 v[168:171], a[36:39], a[252:255], v[168:171]
  v_exp_f32 v78, v78
  v_mfma_f32_16x16x32_bf16 v[168:171], a[48:51], a[248:251], v[168:171]
  v_exp_f32 v79, v79
  v_mfma_f32_16x16x32_bf16 v[168:171], a[60:63], a[244:247], v[168:171]
  v_exp_f32 v128, v128
  v_mfma_f32_16x16x32_bf16 v[132:135], a[64:67], a[244:247], 0
  v_exp_f32 v129, v129
  v_mfma_f32_16x16x32_bf16 v[132:135], a[52:55], a[248:251], v[132:135]
  v_exp_f32 v130, v130
  v_mfma_f32_16x16x32_bf16 v[132:135], a[40:43], a[252:255], v[132:135]
  v_cvt_pk_bf16_f32 v172, v168, v169
  v_cvt_pk_bf16_f32 v173, v170, v171
  v_mfma_f32_16x16x32_bf16 v[132:135], a[28:31], v[116:119], v[132:135]
  v_exp_f32 v131, v131
  v_mfma_f32_16x16x32_bf16 v[132:135], a[16:19], v[160:163], v[132:135]
  v_cvt_pk_bf16_f32 v100, v100, v101
  v_cvt_pk_bf16_f32 v101, v102, v103
  v_mfma_f32_16x16x32_bf16 v[132:135], a[4:7], v[164:167], v[132:135]
  v_cvt_pk_bf16_f32 v102, v104, v105
  v_cvt_pk_bf16_f32 v103, v106, v107
  v_mfma_f32_16x16x32_bf16 v[168:171], a[8:11], v[164:167], 0
  v_cvt_pk_bf16_f32 v104, v76, v77
  v_cvt_pk_bf16_f32 v105, v78, v79
  v_mfma_f32_16x16x32_bf16 v[168:171], a[20:23], v[160:163], v[168:171]
  v_cvt_pk_bf16_f32 v106, v128, v129
  v_cvt_pk_bf16_f32 v107, v130, v131
  v_mfma_f32_16x16x32_bf16 v[168:171], a[32:35], v[116:119], v[168:171]
  v_cvt_pk_bf16_f32 v174, v132, v133
  v_cvt_pk_bf16_f32 v175, v134, v135
  v_mfma_f32_16x16x32_bf16 v[168:171], a[44:47], a[252:255], v[168:171]
  v_mfma_f32_16x16x32_bf16 v[168:171], a[56:59], a[248:251], v[168:171]
  v_mfma_f32_16x16x32_bf16 v[168:171], a[68:71], a[244:247], v[168:171]
  v_mfma_f32_16x16x32_bf16 v[128:131], v[146:149], v[80:83], v[36:39]
  v_mfma_f32_16x16x32_bf16 v[128:131], v[144:147], v[18:21], v[128:131]
  v_mfma_f32_16x16x32_bf16 v[132:135], v[154:157], v[80:83], v[32:35]
  v_cvt_pk_bf16_f32 v22, v168, v169
  v_cvt_pk_bf16_f32 v23, v170, v171
  v_mfma_f32_16x16x32_bf16 v[132:135], v[152:155], v[18:21], v[132:135]
  v_mfma_f32_16x16x32_bf16 v[76:79], v[70:73], v[80:83], v[44:47]
  v_exp_f32 v128, v128
  v_mfma_f32_16x16x32_bf16 v[76:79], v[68:71], v[18:21], v[76:79]
  v_exp_f32 v129, v129
  v_mfma_f32_16x16x32_bf16 v[176:179], v[122:125], v[80:83], v[40:43]
  v_exp_f32 v130, v130
  v_mfma_f32_16x16x32_bf16 v[176:179], v[120:123], v[18:21], v[176:179]
  v_exp_f32 v131, v131
  v_mfma_f32_16x16x32_bf16 v[180:183], v[84:87], a[144:147], 0
  v_exp_f32 v132, v132
  v_mfma_f32_16x16x32_bf16 v[180:183], v[88:91], a[156:159], v[180:183]
  v_exp_f32 v133, v133
  v_mfma_f32_16x16x32_bf16 v[180:183], v[92:95], a[168:171], v[180:183]
  v_exp_f32 v134, v134
  v_mfma_f32_16x16x32_bf16 v[180:183], v[96:99], a[180:183], v[180:183]
  v_exp_f32 v135, v135
  v_mfma_f32_16x16x32_bf16 v[180:183], v[136:139], a[192:195], v[180:183]
  v_exp_f32 v76, v76
  v_mfma_f32_16x16x32_bf16 v[180:183], v[140:143], a[204:207], v[180:183]
  v_exp_f32 v77, v77
  v_mfma_f32_16x16x32_bf16 v[80:83], v[140:143], a[208:211], 0
  v_exp_f32 v78, v78
  v_mfma_f32_16x16x32_bf16 v[80:83], v[136:139], a[196:199], v[80:83]
  v_exp_f32 v79, v79
  v_mfma_f32_16x16x32_bf16 v[80:83], v[96:99], a[184:187], v[80:83]
  v_cvt_pk_bf16_f32 v168, v180, v181
  v_cvt_pk_bf16_f32 v169, v182, v183
  v_mfma_f32_16x16x32_bf16 v[80:83], v[92:95], a[172:175], v[80:83]
  v_exp_f32 v176, v176
  v_mfma_f32_16x16x32_bf16 v[80:83], v[88:91], a[160:163], v[80:83]
  v_exp_f32 v177, v177
  v_mfma_f32_16x16x32_bf16 v[80:83], v[84:87], a[148:151], v[80:83]
  v_exp_f32 v178, v178
  v_mfma_f32_16x16x32_bf16 v[180:183], v[84:87], a[152:155], 0
  v_exp_f32 v179, v179
  v_mfma_f32_16x16x32_bf16 v[180:183], v[88:91], a[164:167], v[180:183]
  v_cvt_pk_bf16_f32 v128, v128, v129
  v_cvt_pk_bf16_f32 v129, v130, v131
  v_mfma_f32_16x16x32_bf16 v[180:183], v[92:95], a[176:179], v[180:183]
  v_cvt_pk_bf16_f32 v84, v80, v81
  v_cvt_pk_bf16_f32 v85, v82, v83
  v_mfma_f32_16x16x32_bf16 v[180:183], v[96:99], a[188:191], v[180:183]
  v_cvt_pk_bf16_f32 v130, v132, v133
  v_cvt_pk_bf16_f32 v131, v134, v135
  v_mfma_f32_16x16x32_bf16 v[180:183], v[136:139], a[200:203], v[180:183]
  v_cvt_pk_bf16_f32 v132, v76, v77
  v_cvt_pk_bf16_f32 v133, v78, v79
  v_mfma_f32_16x16x32_bf16 v[180:183], v[140:143], a[212:215], v[180:183]
  v_cvt_pk_bf16_f32 v134, v176, v177
  v_cvt_pk_bf16_f32 v135, v178, v179
  v_mfma_f32_16x16x32_bf16 v[76:79], v[144:147], v[172:175], v[40:43]
  v_mfma_f32_16x16x32_bf16 v[76:79], v[146:149], v[20:23], v[76:79]
  v_mfma_f32_16x16x32_bf16 v[80:83], v[152:155], v[172:175], v[36:39]
  v_cvt_pk_bf16_f32 v88, v180, v181
  v_cvt_pk_bf16_f32 v89, v182, v183
  v_mfma_f32_16x16x32_bf16 v[80:83], v[154:157], v[20:23], v[80:83]
  v_mfma_f32_16x16x32_bf16 v[96:99], v[68:71], v[172:175], v[48:51]
  v_exp_f32 v76, v76
  v_mfma_f32_16x16x32_bf16 v[96:99], v[70:73], v[20:23], v[96:99]
  v_exp_f32 v77, v77
  v_mfma_f32_16x16x32_bf16 v[140:143], v[120:123], v[172:175], v[44:47]
  v_exp_f32 v78, v78
  v_mfma_f32_16x16x32_bf16 v[140:143], v[122:125], v[20:23], v[140:143]
  v_exp_f32 v79, v79
  v_mfma_f32_16x16x32_bf16 v[144:147], v[164:167], a[144:147], 0
  v_exp_f32 v80, v80
  v_mfma_f32_16x16x32_bf16 v[144:147], v[160:163], a[156:159], v[144:147]
  v_exp_f32 v81, v81
  v_mfma_f32_16x16x32_bf16 v[144:147], v[116:119], a[168:171], v[144:147]
  ds_read_b128 v[68:71], v3 offset:0
  v_cvt_pk_bf16_f32 v76, v76, v77
  v_mfma_f32_16x16x32_bf16 v[144:147], a[252:255], a[180:183], v[144:147]
  ds_read_b128 v[72:75], v3 offset:4096
  v_cvt_pk_bf16_f32 v77, v78, v79
  v_mfma_f32_16x16x32_bf16 v[144:147], a[248:251], a[192:195], v[144:147]
  ds_read_b128 v[92:95], v3 offset:8192
  v_cvt_pk_bf16_f32 v78, v80, v81
  v_mfma_f32_16x16x32_bf16 v[144:147], a[244:247], a[204:207], v[144:147]
  ds_read_b128 v[120:123], v3 offset:12288
  v_mfma_f32_16x16x32_bf16 v[156:159], a[244:247], a[208:211], 0
  ds_read_b128 v[124:127], v3 offset:16384
  v_mfma_f32_16x16x32_bf16 v[156:159], a[248:251], a[196:199], v[156:159]
  ds_read_b128 v[136:139], v3 offset:20480
  v_mfma_f32_16x16x32_bf16 v[156:159], a[252:255], a[184:187], v[156:159]
  v_cvt_pk_bf16_f32 v170, v144, v145
  v_cvt_pk_bf16_f32 v171, v146, v147
  v_mfma_f32_16x16x32_bf16 v[156:159], v[116:119], a[172:175], v[156:159]
  v_exp_f32 v82, v82
  v_mfma_f32_16x16x32_bf16 v[156:159], v[160:163], a[160:163], v[156:159]
  v_exp_f32 v83, v83
  v_mfma_f32_16x16x32_bf16 v[156:159], v[164:167], a[148:151], v[156:159]
  v_exp_f32 v96, v96
  v_mfma_f32_16x16x32_bf16 v[152:155], v[164:167], a[152:155], 0
  v_exp_f32 v97, v97
  v_mfma_f32_16x16x32_bf16 v[152:155], v[160:163], a[164:167], v[152:155]
  v_exp_f32 v98, v98
  v_mfma_f32_16x16x32_bf16 v[152:155], v[116:119], a[176:179], v[152:155]
  v_cvt_pk_bf16_f32 v86, v156, v157
  v_cvt_pk_bf16_f32 v87, v158, v159
  v_mfma_f32_16x16x32_bf16 v[152:155], a[252:255], a[188:191], v[152:155]
  v_mov_b64 v[148:149], 0
  v_cvt_pk_bf16_f32 v79, v82, v83
  v_mfma_f32_16x16x32_bf16 v[152:155], a[248:251], a[200:203], v[152:155]
  v_exp_f32 v99, v99
  v_mfma_f32_16x16x32_bf16 v[152:155], a[244:247], a[212:215], v[152:155]
  s_waitcnt lgkmcnt(0)
  v_exp_f32 v140, v140
  v_mfma_f32_16x16x32_bf16 v[116:119], v[68:71], v[184:187], 0
  v_exp_f32 v141, v141
  v_mfma_f32_16x16x32_bf16 v[116:119], v[72:75], v[200:203], v[116:119]
  v_exp_f32 v142, v142
  v_mfma_f32_16x16x32_bf16 v[116:119], v[92:95], v[216:219], v[116:119]
  v_cvt_pk_bf16_f32 v90, v152, v153
  v_cvt_pk_bf16_f32 v91, v154, v155
  v_mfma_f32_16x16x32_bf16 v[116:119], v[120:123], v[232:235], v[116:119]
  v_mov_b64 v[144:145], 0
  v_cvt_pk_bf16_f32 v80, v96, v97
  v_mfma_f32_16x16x32_bf16 v[116:119], v[124:127], v[248:251], v[116:119]
  v_exp_f32 v143, v143
  v_mfma_f32_16x16x32_bf16 v[116:119], v[136:139], a[224:227], v[116:119]
  v_cvt_pk_bf16_f32 v81, v98, v99
  v_cvt_pk_bf16_f32 v82, v140, v141
  v_smfmac_f32_16x16x64_bf16 v[148:151], a[240:243], v[108:115], v10
  v_cvt_pk_bf16_f32 v83, v142, v143
  v_mfma_f32_16x16x32_bf16 v[152:155], v[168:171], v[112:115], 0
  v_mfma_f32_16x16x32_bf16 v[152:155], v[56:59], v[108:111], v[152:155]
  v_mfma_f32_16x16x32_bf16 v[156:159], v[60:63], v[108:111], 0
  v_mfma_f32_16x16x32_bf16 v[156:159], v[84:87], v[112:115], v[156:159]
  v_mfma_f32_16x16x32_bf16 v[160:163], v[88:91], v[112:115], 0
  v_add_f32 v148, v148, v149
  v_rcp_f32 v150, v148
  v_mfma_f32_16x16x32_bf16 v[160:163], v[64:67], v[108:111], v[160:163]
  v_max3_f32 v9, v148, v150, v9
  v_mul_f32 v152, v150, v152
  v_mul_f32 v153, v150, v153
  v_smfmac_f32_16x16x64_bf16 v[144:147], a[240:243], v[100:107], v10
  v_mul_f32 v154, v150, v154
  v_mul_f32 v155, v150, v155
  v_cvt_pk_bf16_f32 v152, v152, v153
  v_mfma_f32_16x16x32_bf16 v[140:143], v[168:171], v[104:107], 0
  v_cvt_pk_bf16_f32 v153, v154, v155
  v_mul_f32 v156, v150, v156
  v_mul_f32 v157, v150, v157
  v_mfma_f32_16x16x32_bf16 v[140:143], v[56:59], v[100:103], v[140:143]
  v_mul_f32 v158, v150, v158
  v_mul_f32 v159, v150, v159
  v_cvt_pk_bf16_f32 v156, v156, v157
  v_mfma_f32_16x16x32_bf16 v[108:111], v[60:63], v[100:103], 0
  v_cvt_pk_bf16_f32 v157, v158, v159
  v_mul_f32 v160, v150, v160
  v_mul_f32 v161, v150, v161
  v_mfma_f32_16x16x32_bf16 v[108:111], v[84:87], v[104:107], v[108:111]
  v_mul_f32 v162, v150, v162
  v_mul_f32 v163, v150, v163
  v_cvt_pk_bf16_f32 v160, v160, v161
  v_mfma_f32_16x16x32_bf16 v[96:99], v[88:91], v[104:107], 0
  v_add_f32 v144, v144, v145
  v_rcp_f32 v146, v144
  v_mfma_f32_16x16x32_bf16 v[96:99], v[64:67], v[100:103], v[96:99]
  v_cvt_pk_bf16_f32 v161, v162, v163
  v_max3_f32 v9, v144, v146, v9
  v_mul_f32 v140, v146, v140
  v_mfma_f32_16x16x32_bf16 v[100:103], v[136:139], a[228:231], 0
  v_mul_f32 v141, v146, v141
  v_mul_f32 v142, v146, v142
  v_mul_f32 v143, v146, v143
  v_mfma_f32_16x16x32_bf16 v[100:103], v[124:127], v[252:255], v[100:103]
  v_cvt_pk_bf16_f32 v140, v140, v141
  v_cvt_pk_bf16_f32 v141, v142, v143
  v_mul_f32 v108, v146, v108
  v_mfma_f32_16x16x32_bf16 v[100:103], v[120:123], v[236:239], v[100:103]
  v_mov_b64 v[172:173], 0
  v_mul_f32 v109, v146, v109
  v_mul_f32 v110, v146, v110
  v_mfma_f32_16x16x32_bf16 v[100:103], v[92:95], v[220:223], v[100:103]
  v_mul_f32 v111, v146, v111
  v_cvt_pk_bf16_f32 v108, v108, v109
  v_cvt_pk_bf16_f32 v109, v110, v111
  v_mfma_f32_16x16x32_bf16 v[100:103], v[72:75], v[204:207], v[100:103]
  v_mul_f32 v96, v146, v96
  v_mul_f32 v97, v146, v97
  v_mul_f32 v98, v146, v98
  v_mfma_f32_16x16x32_bf16 v[100:103], v[68:71], v[188:191], v[100:103]
  v_mul_f32 v99, v146, v99
  v_cvt_pk_bf16_f32 v96, v96, v97
  v_cvt_pk_bf16_f32 v97, v98, v99
  v_mfma_f32_16x16x32_bf16 v[148:151], v[68:71], v[192:195], 0
  ds_write2st64_b32 v5, v152, v153 offset0:0 offset1:4
  v_mfma_f32_16x16x32_bf16 v[148:151], v[72:75], v[208:211], v[148:151]
  ds_write2st64_b32 v5, v156, v157 offset0:8 offset1:12
  v_mfma_f32_16x16x32_bf16 v[148:151], v[92:95], v[224:227], v[148:151]
  v_cvt_pk_bf16_f32 v116, v116, v100
  v_cvt_pk_bf16_f32 v117, v117, v101
  v_mfma_f32_16x16x32_bf16 v[148:151], v[120:123], v[240:243], v[148:151]
  ds_read_b128 a[248:251], v4 offset:0
  v_cvt_pk_bf16_f32 v118, v118, v102
  v_cvt_pk_bf16_f32 v119, v119, v103
  v_mfma_f32_16x16x32_bf16 v[148:151], v[124:127], a[216:219], v[148:151]
  buffer_store_dword v116, v7, s[24:27], s33 offen offset:0 nt
  v_mfma_f32_16x16x32_bf16 v[148:151], v[136:139], a[232:235], v[148:151]
  ds_read_b128 v[144:147], v4 offset:4096
  ds_read_b128 v[152:155], v4 offset:8192
  v_smfmac_f32_16x16x64_bf16 v[172:175], a[240:243], v[128:135], v10
  ds_read_b128 v[156:159], v4 offset:12288
  ds_read_b128 v[164:167], v4 offset:16384
  v_mfma_f32_16x16x32_bf16 v[104:107], v[56:59], v[132:135], 0
  buffer_store_dword v117, v7, s[24:27], s33 offen offset:384 nt
  v_mfma_f32_16x16x32_bf16 v[104:107], v[168:171], v[128:131], v[104:107]
  ds_read_b128 v[176:179], v4 offset:20480
  v_mfma_f32_16x16x32_bf16 v[112:115], v[84:87], v[128:131], 0
  ds_write2st64_b32 v5, v160, v161 offset0:16 offset1:20
  v_mfma_f32_16x16x32_bf16 v[112:115], v[60:63], v[132:135], v[112:115]
  buffer_store_dword v118, v7, s[24:27], s33 offen offset:768 nt
  v_mfma_f32_16x16x32_bf16 v[100:103], v[64:67], v[132:135], 0
  v_add_f32 v172, v172, v173
  v_rcp_f32 v174, v172
  v_mfma_f32_16x16x32_bf16 v[100:103], v[88:91], v[128:131], v[100:103]
  v_max3_f32 v9, v172, v174, v9
  v_mul_f32 v104, v174, v104
  v_mul_f32 v105, v174, v105
  v_mfma_f32_16x16x32_bf16 v[128:131], v[136:139], a[236:239], 0
  buffer_store_dword v119, v7, s[24:27], s33 offen offset:1152 nt
  v_mul_f32 v106, v174, v106
  v_mfma_f32_16x16x32_bf16 v[128:131], v[124:127], a[220:223], v[128:131]
  v_mul_f32 v107, v174, v107
  v_cvt_pk_bf16_f32 v104, v104, v105
  v_cvt_pk_bf16_f32 v105, v106, v107
  v_mfma_f32_16x16x32_bf16 v[128:131], v[120:123], v[244:247], v[128:131]
  v_mov_b64 v[124:125], 0
  v_mul_f32 v112, v174, v112
  v_mul_f32 v113, v174, v113
  v_mfma_f32_16x16x32_bf16 v[128:131], v[92:95], v[228:231], v[128:131]
  v_mul_f32 v114, v174, v114
  v_mul_f32 v115, v174, v115
  v_cvt_pk_bf16_f32 v112, v112, v113
  v_mfma_f32_16x16x32_bf16 v[128:131], v[72:75], v[212:215], v[128:131]
  v_cvt_pk_bf16_f32 v113, v114, v115
  v_mul_f32 v100, v174, v100
  v_mul_f32 v101, v174, v101
  v_mfma_f32_16x16x32_bf16 v[128:131], v[68:71], v[196:199], v[128:131]
  s_waitcnt lgkmcnt(1)
  v_mul_f32 v102, v174, v102
  v_mul_f32 v103, v174, v103
  v_cvt_pk_bf16_f32 v100, v100, v101
  v_mfma_f32_16x16x32_bf16 v[92:95], a[248:251], v[184:187], 0
  v_cvt_pk_bf16_f32 v101, v102, v103
  v_mfma_f32_16x16x32_bf16 v[92:95], v[144:147], v[200:203], v[92:95]
  ds_write2st64_b32 v5, v140, v141 offset0:1 offset1:5
  v_mfma_f32_16x16x32_bf16 v[92:95], v[152:155], v[216:219], v[92:95]
  v_cvt_pk_bf16_f32 v148, v148, v128
  v_cvt_pk_bf16_f32 v149, v149, v129
  v_mfma_f32_16x16x32_bf16 v[92:95], v[156:159], v[232:235], v[92:95]
  ds_read_b128 a[244:247], v3 offset:512
  v_cvt_pk_bf16_f32 v150, v150, v130
  v_cvt_pk_bf16_f32 v151, v151, v131
  v_mfma_f32_16x16x32_bf16 v[92:95], v[164:167], v[248:251], v[92:95]
  buffer_store_dword v148, v8, s[24:27], s33 offen offset:0 nt
  v_mfma_f32_16x16x32_bf16 v[92:95], v[176:179], a[224:227], v[92:95]
  ds_read_b128 a[252:255], v3 offset:4608
  ds_read_b128 v[68:71], v3 offset:8704
  v_smfmac_f32_16x16x64_bf16 v[124:127], a[240:243], v[76:83], v10
  ds_read_b128 v[72:75], v3 offset:12800
  ds_read_b128 v[116:119], v3 offset:16896
  v_mfma_f32_16x16x32_bf16 v[128:131], v[56:59], v[80:83], 0
  buffer_store_dword v149, v8, s[24:27], s33 offen offset:384 nt
  v_mfma_f32_16x16x32_bf16 v[128:131], v[168:171], v[76:79], v[128:131]
  ds_read_b128 v[120:123], v3 offset:20992
  v_xor_b32 v3, 40960, v3
  v_mfma_f32_16x16x32_bf16 v[132:135], v[84:87], v[76:79], 0
  ds_write2st64_b32 v5, v108, v109 offset0:9 offset1:13
  v_mfma_f32_16x16x32_bf16 v[132:135], v[60:63], v[80:83], v[132:135]
  buffer_store_dword v150, v8, s[24:27], s33 offen offset:768 nt
  v_mfma_f32_16x16x32_bf16 v[56:59], v[64:67], v[80:83], 0
  v_add_f32 v124, v124, v125
  v_rcp_f32 v126, v124
  v_mfma_f32_16x16x32_bf16 v[56:59], v[88:91], v[76:79], v[56:59]
  v_max3_f32 v9, v124, v126, v9
  v_mul_f32 v128, v126, v128
  v_mul_f32 v129, v126, v129
  v_mfma_f32_16x16x32_bf16 v[60:63], v[176:179], a[228:231], 0
  buffer_store_dword v151, v8, s[24:27], s33 offen offset:1152 nt
  v_mul_f32 v130, v126, v130
  v_mfma_f32_16x16x32_bf16 v[60:63], v[164:167], v[252:255], v[60:63]
  s_add_u32 s33, s33, s98
  v_mul_f32 v131, v126, v131
  v_cvt_pk_bf16_f32 v128, v128, v129
  v_cvt_pk_bf16_f32 v129, v130, v131
  v_mfma_f32_16x16x32_bf16 v[60:63], v[156:159], v[236:239], v[60:63]
  v_mul_f32 v132, v126, v132
  v_mul_f32 v133, v126, v133
  v_mul_f32 v134, v126, v134
  v_mfma_f32_16x16x32_bf16 v[60:63], v[152:155], v[220:223], v[60:63]
  v_mul_f32 v135, v126, v135
  v_cvt_pk_bf16_f32 v132, v132, v133
  v_cvt_pk_bf16_f32 v133, v134, v135
  v_mfma_f32_16x16x32_bf16 v[60:63], v[144:147], v[204:207], v[60:63]
  v_mul_f32 v56, v126, v56
  v_mul_f32 v57, v126, v57
  v_mul_f32 v58, v126, v58
  v_mfma_f32_16x16x32_bf16 v[60:63], a[248:251], v[188:191], v[60:63]
  s_waitcnt lgkmcnt(1)
  v_mul_f32 v59, v126, v59
  v_cvt_pk_bf16_f32 v56, v56, v57
  v_cvt_pk_bf16_f32 v57, v58, v59
  v_mfma_f32_16x16x32_bf16 v[76:79], a[244:247], v[184:187], 0
  v_cmp_nge_f32 vcc, 0x53800000, v9
  v_mfma_f32_16x16x32_bf16 v[76:79], a[252:255], v[200:203], v[76:79]
  ds_write2st64_b32 v5, v96, v97 offset0:17 offset1:21
  v_mfma_f32_16x16x32_bf16 v[76:79], v[68:71], v[216:219], v[76:79]
  s_or_b32 s6, vcc_lo, vcc_hi
  v_cvt_pk_bf16_f32 v92, v92, v60
  v_cvt_pk_bf16_f32 v93, v93, v61
  v_mov_b32 v54, s6
  v_mfma_f32_16x16x32_bf16 v[76:79], v[72:75], v[232:235], v[76:79]
  v_cvt_pk_bf16_f32 v94, v94, v62
  v_cvt_pk_bf16_f32 v95, v95, v63
  v_mfma_f32_16x16x32_bf16 v[76:79], v[116:119], v[248:251], v[76:79]
  buffer_store_dword v92, v7, s[24:27], s34 offen offset:0 nt
  v_mfma_f32_16x16x32_bf16 v[76:79], v[120:123], a[224:227], v[76:79]
  ds_write2st64_b32 v5, v104, v105 offset0:2 offset1:6
  v_mfma_f32_16x16x32_bf16 v[96:99], v[120:123], a[228:231], 0
  ds_write2st64_b32 v5, v112, v113 offset0:10 offset1:14
  v_mfma_f32_16x16x32_bf16 v[96:99], v[116:119], v[252:255], v[96:99]
  buffer_store_dword v93, v7, s[24:27], s34 offen offset:384 nt
  v_mfma_f32_16x16x32_bf16 v[96:99], v[72:75], v[236:239], v[96:99]
  ds_read_b128 v[60:63], v4 offset:512
  ds_read_b128 v[64:67], v4 offset:4608
  v_mfma_f32_16x16x32_bf16 v[96:99], v[68:71], v[220:223], v[96:99]
  ds_write2st64_b32 v5, v100, v101 offset0:18 offset1:22
  v_mfma_f32_16x16x32_bf16 v[96:99], a[252:255], v[204:207], v[96:99]
  buffer_store_dword v94, v7, s[24:27], s34 offen offset:768 nt
  v_mfma_f32_16x16x32_bf16 v[96:99], a[244:247], v[188:191], v[96:99]
  ds_write2st64_b32 v5, v128, v129 offset0:3 offset1:7
  v_mfma_f32_16x16x32_bf16 v[80:83], a[244:247], v[192:195], 0
  ds_write2st64_b32 v5, v132, v133 offset0:11 offset1:15
  v_mfma_f32_16x16x32_bf16 v[80:83], a[252:255], v[208:211], v[80:83]
  buffer_store_dword v95, v7, s[24:27], s34 offen offset:1152 nt
  v_mfma_f32_16x16x32_bf16 v[80:83], v[68:71], v[224:227], v[80:83]
  s_add_u32 s34, s34, s98
  ds_read_b128 v[88:91], v4 offset:8704
  v_cvt_pk_bf16_f32 v76, v76, v96
  v_cvt_pk_bf16_f32 v77, v77, v97
  v_mfma_f32_16x16x32_bf16 v[80:83], v[72:75], v[240:243], v[80:83]
  ds_read_b128 v[84:87], v4 offset:12800
  v_cvt_pk_bf16_f32 v78, v78, v98
  v_cvt_pk_bf16_f32 v79, v79, v99
  v_mfma_f32_16x16x32_bf16 v[80:83], v[116:119], a[216:219], v[80:83]
  buffer_store_dword v76, v7, s[24:27], s35 offen offset:0 nt
  v_mfma_f32_16x16x32_bf16 v[80:83], v[120:123], a[232:235], v[80:83]
  ds_write2st64_b32 v5, v56, v57 offset0:19 offset1:23
  v_mfma_f32_16x16x32_bf16 v[96:99], v[120:123], a[236:239], 0
  ds_read_b128 v[92:95], v4 offset:16896
  ds_write_b32 v11, v54
  v_mfma_f32_16x16x32_bf16 v[96:99], v[116:119], a[220:223], v[96:99]
  buffer_store_dword v77, v7, s[24:27], s35 offen offset:384 nt
  v_mov_b32 v11, 159744
  v_mfma_f32_16x16x32_bf16 v[96:99], v[72:75], v[244:247], v[96:99]
  ds_read_b128 v[100:103], v4 offset:20992
  v_xor_b32 v4, 40960, v4
  v_mfma_f32_16x16x32_bf16 v[96:99], v[68:71], v[228:231], v[96:99]
  v_mfma_f32_16x16x32_bf16 v[96:99], a[252:255], v[212:215], v[96:99]
  buffer_store_dword v78, v7, s[24:27], s35 offen offset:768 nt
  v_mfma_f32_16x16x32_bf16 v[96:99], a[244:247], v[196:199], v[96:99]
  s_waitcnt lgkmcnt(9)
  v_mfma_f32_16x16x32_bf16 v[72:75], v[60:63], v[184:187], 0
  s_waitcnt lgkmcnt(1)
  s_barrier
  v_mfma_f32_16x16x32_bf16 v[72:75], v[64:67], v[200:203], v[72:75]
  buffer_store_dword v79, v7, s[24:27], s35 offen offset:1152 nt
  v_mfma_f32_16x16x32_bf16 v[72:75], v[88:91], v[216:219], v[72:75]
  s_waitcnt lgkmcnt(0)
  v_cvt_pk_bf16_f32 v80, v80, v96
  v_cvt_pk_bf16_f32 v81, v81, v97
  v_mfma_f32_16x16x32_bf16 v[72:75], v[84:87], v[232:235], v[72:75]
  v_cvt_pk_bf16_f32 v82, v82, v98
  v_cvt_pk_bf16_f32 v83, v83, v99
  v_mfma_f32_16x16x32_bf16 v[72:75], v[92:95], v[248:251], v[72:75]
  buffer_store_dword v80, v8, s[24:27], s35 offen offset:0 nt
  v_mfma_f32_16x16x32_bf16 v[72:75], v[100:103], a[224:227], v[72:75]
  ds_read_b128 a[248:251], v3 offset:0
  ds_read_b128 v[56:59], v3 offset:4096
  v_mfma_f32_16x16x32_bf16 v[76:79], v[100:103], a[228:231], 0
  buffer_store_dword v81, v8, s[24:27], s35 offen offset:384 nt
  v_mfma_f32_16x16x32_bf16 v[76:79], v[92:95], v[252:255], v[76:79]
  ds_read_b128 v[68:71], v3 offset:8192
  ds_read_b128 a[252:255], v3 offset:12288
  v_mfma_f32_16x16x32_bf16 v[76:79], v[84:87], v[236:239], v[76:79]
  buffer_store_dword v82, v8, s[24:27], s35 offen offset:768 nt
  v_mfma_f32_16x16x32_bf16 v[76:79], v[88:91], v[220:223], v[76:79]
  s_waitcnt lgkmcnt(2)
  ds_read_b128 a[244:247], v3 offset:16384
  ds_read_b128 v[84:87], v3 offset:20480
  v_mfma_f32_16x16x32_bf16 v[76:79], v[64:67], v[204:207], v[76:79]
  buffer_store_dword v83, v8, s[24:27], s35 offen offset:1152 nt
  v_mfma_f32_16x16x32_bf16 v[76:79], v[60:63], v[188:191], v[76:79]
  s_add_u32 s35, s35, s98
  ds_read2_b32 v[80:81], v11 offset0:0 offset1:2
  ds_read2_b32 v[82:83], v11 offset0:4 offset1:6
  v_mfma_f32_16x16x32_bf16 v[60:63], a[248:251], v[184:187], 0
  v_mfma_f32_16x16x32_bf16 v[60:63], v[56:59], v[200:203], v[60:63]
  s_waitcnt lgkmcnt(4)
  v_mfma_f32_16x16x32_bf16 v[60:63], v[68:71], v[216:219], v[60:63]
  v_cvt_pk_bf16_f32 v72, v72, v76
  v_cvt_pk_bf16_f32 v73, v73, v77
  v_mfma_f32_16x16x32_bf16 v[60:63], a[252:255], v[232:235], v[60:63]
  s_waitcnt lgkmcnt(2)
  v_cvt_pk_bf16_f32 v74, v74, v78
  v_cvt_pk_bf16_f32 v75, v75, v79
  v_mfma_f32_16x16x32_bf16 v[60:63], a[244:247], v[248:251], v[60:63]
  buffer_store_dword v72, v7, s[24:27], s36 offen offset:0 nt
  v_mfma_f32_16x16x32_bf16 v[60:63], v[84:87], a[224:227], v[60:63]
  s_waitcnt lgkmcnt(0)
  v_or3_b32 v80, v80, v81, v82
  v_or_b32 v80, v80, v83
  v_mfma_f32_16x16x32_bf16 v[64:67], v[84:87], a[228:231], 0
  buffer_store_dword v73, v7, s[24:27], s36 offen offset:384 nt
  v_mfma_f32_16x16x32_bf16 v[64:67], a[244:247], v[252:255], v[64:67]
  v_readfirstlane_b32 s49, v80
  v_mfma_f32_16x16x32_bf16 v[64:67], a[252:255], v[236:239], v[64:67]
  buffer_store_dword v74, v7, s[24:27], s36 offen offset:768 nt
  v_mfma_f32_16x16x32_bf16 v[64:67], v[68:71], v[220:223], v[64:67]
  ds_read_b128 v[76:79], v4 offset:0
  ds_read_b128 v[80:83], v4 offset:4096
  v_mfma_f32_16x16x32_bf16 v[64:67], v[56:59], v[204:207], v[64:67]
  buffer_store_dword v75, v7, s[24:27], s36 offen offset:1152 nt
  v_mfma_f32_16x16x32_bf16 v[64:67], a[248:251], v[188:191], v[64:67]
  s_add_u32 s36, s36, s98
  ds_read_b128 v[88:91], v4 offset:8192
  ds_read_b128 v[92:95], v4 offset:12288
  v_mfma_f32_16x16x32_bf16 v[72:75], a[248:251], v[192:195], 0
  ds_read_b128 v[96:99], v4 offset:16384
  ds_read_b128 v[100:103], v4 offset:20480
  v_mfma_f32_16x16x32_bf16 v[72:75], v[56:59], v[208:211], v[72:75]
  v_mfma_f32_16x16x32_bf16 v[72:75], v[68:71], v[224:227], v[72:75]
  v_cvt_pk_bf16_f32 v60, v60, v64
  v_cvt_pk_bf16_f32 v61, v61, v65
  v_mfma_f32_16x16x32_bf16 v[72:75], a[252:255], v[240:243], v[72:75]
  v_cvt_pk_bf16_f32 v62, v62, v66
  v_cvt_pk_bf16_f32 v63, v63, v67
  v_mfma_f32_16x16x32_bf16 v[72:75], a[244:247], a[216:219], v[72:75]
  buffer_store_dword v60, v7, s[24:27], s33 offen offset:0 nt
  v_mfma_f32_16x16x32_bf16 v[72:75], v[84:87], a[232:235], v[72:75]
  v_mfma_f32_16x16x32_bf16 v[104:107], v[84:87], a[236:239], 0
  buffer_store_dword v61, v7, s[24:27], s33 offen offset:384 nt
  v_mfma_f32_16x16x32_bf16 v[104:107], a[244:247], a[220:223], v[104:107]
  v_mfma_f32_16x16x32_bf16 v[104:107], a[252:255], v[244:247], v[104:107]
  buffer_store_dword v62, v7, s[24:27], s33 offen offset:768 nt
  v_mfma_f32_16x16x32_bf16 v[104:107], v[68:71], v[228:231], v[104:107]
  ds_read_b128 a[244:247], v3 offset:512
  ds_read_b128 a[252:255], v3 offset:4608
  v_mfma_f32_16x16x32_bf16 v[104:107], v[56:59], v[212:215], v[104:107]
  buffer_store_dword v63, v7, s[24:27], s33 offen offset:1152 nt
  v_mfma_f32_16x16x32_bf16 v[104:107], a[248:251], v[196:199], v[104:107]
  s_waitcnt lgkmcnt(2)
  ds_read_b128 v[56:59], v3 offset:8704
  ds_read_b128 v[60:63], v3 offset:12800
  v_mfma_f32_16x16x32_bf16 v[84:87], v[76:79], v[184:187], 0
L_hop_2_1:
  s_cbranch_execz L_hop_2_2
  ds_read_b128 a[248:251], v3 offset:16896
  ds_read_b128 v[64:67], v3 offset:20992
  v_mfma_f32_16x16x32_bf16 v[84:87], v[80:83], v[200:203], v[84:87]
  v_mfma_f32_16x16x32_bf16 v[84:87], v[88:91], v[216:219], v[84:87]
  v_cvt_pk_bf16_f32 v72, v72, v104
  v_cvt_pk_bf16_f32 v73, v73, v105
  v_mfma_f32_16x16x32_bf16 v[84:87], v[92:95], v[232:235], v[84:87]
  v_cvt_pk_bf16_f32 v74, v74, v106
  v_cvt_pk_bf16_f32 v75, v75, v107
  v_mfma_f32_16x16x32_bf16 v[84:87], v[96:99], v[248:251], v[84:87]
  buffer_store_dword v72, v8, s[24:27], s33 offen offset:0 nt
  v_mfma_f32_16x16x32_bf16 v[84:87], v[100:103], a[224:227], v[84:87]
  v_mfma_f32_16x16x32_bf16 v[68:71], v[100:103], a[228:231], 0
  buffer_store_dword v73, v8, s[24:27], s33 offen offset:384 nt
  v_mfma_f32_16x16x32_bf16 v[68:71], v[96:99], v[252:255], v[68:71]
  v_mfma_f32_16x16x32_bf16 v[68:71], v[92:95], v[236:239], v[68:71]
  buffer_store_dword v74, v8, s[24:27], s33 offen offset:768 nt
  v_mfma_f32_16x16x32_bf16 v[68:71], v[88:91], v[220:223], v[68:71]
  v_mfma_f32_16x16x32_bf16 v[68:71], v[80:83], v[204:207], v[68:71]
  buffer_store_dword v75, v8, s[24:27], s33 offen offset:1152 nt
  v_mfma_f32_16x16x32_bf16 v[68:71], v[76:79], v[188:191], v[68:71]
  s_waitcnt lgkmcnt(0)
  v_mfma_f32_16x16x32_bf16 v[80:83], a[244:247], v[184:187], 0
  v_mfma_f32_16x16x32_bf16 v[80:83], a[252:255], v[200:203], v[80:83]
  v_mfma_f32_16x16x32_bf16 v[80:83], v[56:59], v[216:219], v[80:83]
  v_cvt_pk_bf16_f32 v84, v84, v68
  v_cvt_pk_bf16_f32 v85, v85, v69
  v_mfma_f32_16x16x32_bf16 v[80:83], v[60:63], v[232:235], v[80:83]
  v_cvt_pk_bf16_f32 v86, v86, v70
  v_cvt_pk_bf16_f32 v87, v87, v71
  v_mfma_f32_16x16x32_bf16 v[80:83], a[248:251], v[248:251], v[80:83]
  buffer_store_dword v84, v7, s[24:27], s34 offen offset:0 nt
  v_mfma_f32_16x16x32_bf16 v[80:83], v[64:67], a[224:227], v[80:83]
  v_mfma_f32_16x16x32_bf16 v[100:103], v[64:67], a[228:231], 0
  buffer_store_dword v85, v7, s[24:27], s34 offen offset:384 nt
  v_mfma_f32_16x16x32_bf16 v[100:103], a[248:251], v[252:255], v[100:103]
  v_mfma_f32_16x16x32_bf16 v[100:103], v[60:63], v[236:239], v[100:103]
  buffer_store_dword v86, v7, s[24:27], s34 offen offset:768 nt
  v_mfma_f32_16x16x32_bf16 v[100:103], v[56:59], v[220:223], v[100:103]
  ds_read_b128 v[68:71], v4 offset:512
  ds_read_b128 v[72:75], v4 offset:4608
  v_mfma_f32_16x16x32_bf16 v[100:103], a[252:255], v[204:207], v[100:103]
  buffer_store_dword v87, v7, s[24:27], s34 offen offset:1152 nt
  v_mfma_f32_16x16x32_bf16 v[100:103], a[244:247], v[188:191], v[100:103]
  ds_read_b128 v[76:79], v4 offset:8704
  ds_read_b128 v[88:91], v4 offset:12800
  v_mfma_f32_16x16x32_bf16 v[84:87], a[244:247], v[192:195], 0
  ds_read_b128 v[92:95], v4 offset:16896
  ds_read_b128 v[96:99], v4 offset:20992
  v_mfma_f32_16x16x32_bf16 v[84:87], a[252:255], v[208:211], v[84:87]
  v_mfma_f32_16x16x32_bf16 v[84:87], v[56:59], v[224:227], v[84:87]
  v_cvt_pk_bf16_f32 v80, v80, v100
  v_cvt_pk_bf16_f32 v81, v81, v101
  v_mfma_f32_16x16x32_bf16 v[84:87], v[60:63], v[240:243], v[84:87]
  v_cvt_pk_bf16_f32 v82, v82, v102
  v_cvt_pk_bf16_f32 v83, v83, v103
  v_mfma_f32_16x16x32_bf16 v[84:87], a[248:251], a[216:219], v[84:87]
  buffer_store_dword v80, v7, s[24:27], s35 offen offset:0 nt
  v_mfma_f32_16x16x32_bf16 v[84:87], v[64:67], a[232:235], v[84:87]
  v_mfma_f32_16x16x32_bf16 v[100:103], v[64:67], a[236:239], 0
  buffer_store_dword v81, v7, s[24:27], s35 offen offset:384 nt
  v_mfma_f32_16x16x32_bf16 v[100:103], a[248:251], a[220:223], v[100:103]
  v_mfma_f32_16x16x32_bf16 v[100:103], v[60:63], v[244:247], v[100:103]
  buffer_store_dword v82, v7, s[24:27], s35 offen offset:768 nt
  v_mfma_f32_16x16x32_bf16 v[100:103], v[56:59], v[228:231], v[100:103]
  v_mfma_f32_16x16x32_bf16 v[100:103], a[252:255], v[212:215], v[100:103]
  buffer_store_dword v83, v7, s[24:27], s35 offen offset:1152 nt
  v_mfma_f32_16x16x32_bf16 v[100:103], a[244:247], v[196:199], v[100:103]
  s_waitcnt lgkmcnt(0)
  v_mfma_f32_16x16x32_bf16 v[56:59], v[68:71], v[184:187], 0
  v_mfma_f32_16x16x32_bf16 v[56:59], v[72:75], v[200:203], v[56:59]
  v_mfma_f32_16x16x32_bf16 v[56:59], v[76:79], v[216:219], v[56:59]
  v_cvt_pk_bf16_f32 v84, v84, v100
  v_cvt_pk_bf16_f32 v85, v85, v101
  v_mfma_f32_16x16x32_bf16 v[56:59], v[88:91], v[232:235], v[56:59]
  v_cvt_pk_bf16_f32 v86, v86, v102
  v_cvt_pk_bf16_f32 v87, v87, v103
  v_mfma_f32_16x16x32_bf16 v[56:59], v[92:95], v[248:251], v[56:59]
  buffer_store_dword v84, v8, s[24:27], s35 offen offset:0 nt
  v_mfma_f32_16x16x32_bf16 v[56:59], v[96:99], a[224:227], v[56:59]
  v_mfma_f32_16x16x32_bf16 v[60:63], v[96:99], a[228:231], 0
  buffer_store_dword v85, v8, s[24:27], s35 offen offset:384 nt
  v_mfma_f32_16x16x32_bf16 v[60:63], v[92:95], v[252:255], v[60:63]
  v_mfma_f32_16x16x32_bf16 v[60:63], v[88:91], v[236:239], v[60:63]
  buffer_store_dword v86, v8, s[24:27], s35 offen offset:768 nt
  v_mfma_f32_16x16x32_bf16 v[60:63], v[76:79], v[220:223], v[60:63]
  v_mfma_f32_16x16x32_bf16 v[60:63], v[72:75], v[204:207], v[60:63]
  buffer_store_dword v87, v8, s[24:27], s35 offen offset:1152 nt
  v_mfma_f32_16x16x32_bf16 v[60:63], v[68:71], v[188:191], v[60:63]
  s_nop 7
  v_cvt_pk_bf16_f32 v56, v56, v60
  v_cvt_pk_bf16_f32 v57, v57, v61
  v_cvt_pk_bf16_f32 v58, v58, v62
  v_cvt_pk_bf16_f32 v59, v59, v63
  buffer_store_dword v56, v7, s[24:27], s36 offen offset:0 nt
  buffer_store_dword v57, v7, s[24:27], s36 offen offset:384 nt
  buffer_store_dword v58, v7, s[24:27], s36 offen offset:768 nt
  buffer_store_dword v59, v7, s[24:27], s36 offen offset:1152 nt
  s_cmp_lg_u32 s49, 0
  s_cbranch_scc1 L_safe
L_fin:
L_end:
  s_endpgm
L_hop_3_1:
  s_cbranch_execz L_walk
L_pad3844:
L_k7:
  s_cmp_lg_u32 s59, 7
  s_cbranch_scc1 L_kh
  v_mfma_f32_16x16x32_bf16 v[100:103], a[0:3], v[84:87], 0
  s_waitcnt lgkmcnt(0)
  s_sub_u32 s49, s16, s18
  s_sub_u32 s50, s15, s60
  v_mfma_f32_16x16x32_bf16 v[100:103], a[12:15], v[88:91], v[100:103]
  s_add_u32 s50, s50, 45360
  s_mul_i32 s49, s49, s50
  s_mul_hi_u32 s49, s49, 415817
  v_mfma_f32_16x16x32_bf16 v[100:103], a[24:27], v[92:95], v[100:103]
  s_add_u32 s49, s49, s16
  v_cvt_pk_bf16_f32 v66, v128, v129
  v_cvt_pk_bf16_f32 v67, v130, v131
  v_mfma_f32_16x16x32_bf16 v[100:103], a[36:39], v[96:99], v[100:103]
  s_and_b32 s51, s2, 7
  s_lshl_b32 s51, s51, 3
  v_and_b32 v74, 56, v11
  v_mfma_f32_16x16x32_bf16 v[100:103], a[48:51], v[136:139], v[100:103]
  v_lshl_add_u32 v54, v74, 3, s51
  s_lshl_b32 s51, s51, 3
  v_mfma_f32_16x16x32_bf16 v[100:103], a[60:63], v[140:143], v[100:103]
  v_add_u32 v55, s51, v74
  v_mov_b32 v74, s49
  v_mfma_f32_16x16x32_bf16 v[104:107], a[64:67], v[140:143], 0
  buffer_store_dword v74, v54, s[20:23], s44 offen sc1
  v_mfma_f32_16x16x32_bf16 v[104:107], a[52:55], v[136:139], v[104:107]
  v_mfma_f32_16x16x32_bf16 v[104:107], a[40:43], v[96:99], v[104:107]
  v_cvt_pk_bf16_f32 v18, v100, v101
  v_cvt_pk_bf16_f32 v19, v102, v103
  v_mfma_f32_16x16x32_bf16 v[104:107], a[28:31], v[92:95], v[104:107]
  buffer_store_dword v74, v55, s[20:23], s44 offen offset:4 sc1
  v_mfma_f32_16x16x32_bf16 v[104:107], a[16:19], v[88:91], v[104:107]
  s_branch L_r218
L_k2:
  s_cmp_lg_u32 s59, 10
  s_cbranch_scc1 L_k7
  s_waitcnt vmcnt(30)
  v_mfma_f32_16x16x32_bf16 v[100:103], a[0:3], v[84:87], 0
  s_sub_u32 s49, s19, s18
  s_sub_u32 s50, s15, s99
  s_add_u32 s50, s50, 45360
  v_mfma_f32_16x16x32_bf16 v[100:103], a[12:15], v[88:91], v[100:103]
  s_mul_i32 s49, s49, s50
  s_mul_hi_u32 s49, s49, 415817
  s_add_u32 s49, s49, s19
  v_mfma_f32_16x16x32_bf16 v[100:103], a[24:27], v[92:95], v[100:103]
  s_and_b32 s50, s2, 7
  v_cvt_pk_bf16_f32 v66, v128, v129
  v_cvt_pk_bf16_f32 v67, v130, v131
  v_mfma_f32_16x16x32_bf16 v[100:103], a[36:39], v[96:99], v[100:103]
  s_sub_u32 s49, s49, 1024
  v_subrev_u32 v54, s49, v52
  v_subrev_u32 v55, s49, v53
  v_mfma_f32_16x16x32_bf16 v[100:103], a[48:51], v[136:139], v[100:103]
  v_max_u32 v112, v54, v55
  v_bfe_u32 v74, v11, 3, 3
  v_mfma_f32_16x16x32_bf16 v[100:103], a[60:63], v[140:143], v[100:103]
  v_lshrrev_b32 v75, 6, v11
  v_lshl_add_u32 v54, v54, 3, v74
  v_mfma_f32_16x16x32_bf16 v[104:107], a[64:67], v[140:143], 0
  v_lshl_add_u32 v55, v55, 3, v75
  v_mfma_f32_16x16x32_bf16 v[104:107], a[52:55], v[136:139], v[104:107]
  v_readlane_b32 s12, v52, s50
  v_cmp_lt_u32 vcc, 2047, v112
  v_mfma_f32_16x16x32_bf16 v[104:107], a[40:43], v[96:99], v[104:107]
  v_cvt_pk_bf16_f32 v18, v100, v101
  v_cvt_pk_bf16_f32 v19, v102, v103
  v_mfma_f32_16x16x32_bf16 v[104:107], a[28:31], v[92:95], v[104:107]
  v_and_b32 v112, 56, v11
  v_mfma_f32_16x16x32_bf16 v[104:107], a[16:19], v[88:91], v[104:107]
  s_or_b32 s51, vcc_lo, vcc_hi
  v_cmp_lt_u32 vcc, v54, v55
  v_mfma_f32_16x16x32_bf16 v[104:107], a[4:7], v[84:87], v[104:107]
  s_sub_u32 s52, s12, s49
  s_sub_u32 s52, s52, 960
  s_lshr_b32 s52, s52, 7
  v_mfma_f32_16x16x32_bf16 v[108:111], a[8:11], v[84:87], 0
  s_or_b32 s51, s51, s52
  v_lshrrev_b64 v[74:75], v112, vcc
  v_and_b32 v55, 0xff, v74
  v_mfma_f32_16x16x32_bf16 v[108:111], a[20:23], v[88:91], v[108:111]
  v_bcnt_u32_b32 v55, v55, 0
  v_mfma_f32_16x16x32_bf16 v[108:111], a[32:35], v[92:95], v[108:111]
  v_cvt_pk_bf16_f32 v100, v104, v105
  v_cvt_pk_bf16_f32 v101, v106, v107
  v_mfma_f32_16x16x32_bf16 v[108:111], a[44:47], v[96:99], v[108:111]
  v_readlane_b32 s52, v55, s50
  v_mfma_f32_16x16x32_bf16 v[108:111], a[56:59], v[136:139], v[108:111]
  v_mfma_f32_16x16x32_bf16 v[108:111], a[68:71], v[140:143], v[108:111]
  s_sub_u32 s52, 7, s52
  v_cmp_eq_u32 vcc, s52, v55
  v_mfma_f32_16x16x32_bf16 v[104:107], a[132:135], v[140:143], 0
  v_mfma_f32_16x16x32_bf16 v[104:107], a[120:123], v[136:139], v[104:107]
  s_ff1_i32_b32 s52, vcc_lo
  s_and_b32 s52, s52, 7
  v_readlane_b32 s53, v54, s52
  v_mfma_f32_16x16x32_bf16 v[104:107], a[108:111], v[96:99], v[104:107]
  v_cvt_pk_bf16_f32 v102, v108, v109
  v_cvt_pk_bf16_f32 v103, v110, v111
  v_mfma_f32_16x16x32_bf16 v[104:107], a[96:99], v[92:95], v[104:107]
  s_lshr_b32 s53, s53, 3
  s_add_u32 s53, s53, s49
  s_sub_u32 s49, s53, s12
  v_mfma_f32_16x16x32_bf16 v[104:107], a[84:87], v[88:91], v[104:107]
  s_cmp_gt_i32 s49, 0
  s_cselect_b32 s45, 2, 1
  s_cselect_b32 s12, s53, s12
  v_mfma_f32_16x16x32_bf16 v[104:107], a[72:75], v[84:87], v[104:107]
  s_cselect_b32 s53, s52, s50
  s_cselect_b32 s96, 1, 6
  s_lshl_b32 s96, s96, 11
  v_mfma_f32_16x16x32_bf16 v[112:115], a[76:79], v[84:87], 0
  s_abs_i32 s49, s49
  s_cmp_lt_u32 s49, 235
  s_cselect_b32 s51, 1, s51
  v_mfma_f32_16x16x32_bf16 v[112:115], a[88:91], v[88:91], v[112:115]
  s_cmp_lt_u32 s49, 400
  s_cselect_b32 s14, 8, 0
  s_xnor_b32 s13, s12, s14
  v_mfma_f32_16x16x32_bf16 v[112:115], a[100:103], v[92:95], v[112:115]
  s_cmp_eq_u32 s51, 0
  v_cvt_pk_bf16_f32 v128, v104, v105
  v_cvt_pk_bf16_f32 v129, v106, v107
  v_mfma_f32_16x16x32_bf16 v[112:115], a[112:115], v[96:99], v[112:115]
  s_cselect_b32 s45, s45, 0
  s_cselect_b32 s96, s96, 0
  s_bitset1_b32 s96, 14
  v_mfma_f32_16x16x32_bf16 v[112:115], a[124:127], v[136:139], v[112:115]
  s_andn2_b32 s51, s2, 7
  s_add_u32 s51, s51, s53
  s_lshl_b32 s51, s51, 9
  v_mfma_f32_16x16x32_bf16 v[112:115], a[136:139], v[140:143], v[112:115]
  s_add_u32 s44, s51, 2097152
  s_lshr_b32 s49, s45, 1
  s_lshl_b32 s49, s49, s52
  v_mfma_f32_16x16x32_bf16 v[108:111], a[140:143], v[140:143], 0
  s_lshl_b32 s49, s49, s14
  s_lshl_b32 s54, s3, 2
  s_add_u32 s54, s54, 159808
  v_mfma_f32_16x16x32_bf16 v[108:111], a[128:131], v[136:139], v[108:111]
  v_mov_b32 v54, s54
  v_mov_b32 v55, s49
  v_mfma_f32_16x16x32_bf16 v[108:111], a[116:119], v[96:99], v[108:111]
  v_cvt_pk_bf16_f32 v130, v112, v113
  v_cvt_pk_bf16_f32 v131, v114, v115
  v_mfma_f32_16x16x32_bf16 v[108:111], a[104:107], v[92:95], v[108:111]
  ds_write_b32 v54, v55
  v_mfma_f32_16x16x32_bf16 v[108:111], a[92:95], v[88:91], v[108:111]
  v_mfma_f32_16x16x32_bf16 v[108:111], a[80:83], v[84:87], v[108:111]
  v_mfma_f32_16x16x32_bf16 v[104:107], v[84:87], a[144:147], 0
  v_mfma_f32_16x16x32_bf16 v[104:107], v[88:91], a[156:159], v[104:107]
  s_waitcnt lgkmcnt(0)
  ds_read_b128 a[244:247], v1 offset:22528
  v_mfma_f32_16x16x32_bf16 v[104:107], v[92:95], a[168:171], v[104:107]
  v_cvt_pk_bf16_f32 v132, v108, v109
  v_cvt_pk_bf16_f32 v133, v110, v111
  v_mfma_f32_16x16x32_bf16 v[104:107], v[96:99], a[180:183], v[104:107]
  ds_read_b128 a[248:251], v0 offset:22528
  v_mfma_f32_16x16x32_bf16 v[104:107], v[136:139], a[192:195], v[104:107]
  ds_read_b128 a[252:255], v1 offset:14336
  v_mfma_f32_16x16x32_bf16 v[104:107], v[140:143], a[204:207], v[104:107]
  ds_read_b128 v[144:147], v0 offset:14336
  v_mfma_f32_16x16x32_bf16 v[116:119], v[140:143], a[208:211], 0
  ds_read_b128 v[148:151], v1 offset:6144
  v_mfma_f32_16x16x32_bf16 v[116:119], v[136:139], a[196:199], v[116:119]
  ds_read_b128 v[152:155], v0 offset:6144
  v_mfma_f32_16x16x32_bf16 v[116:119], v[96:99], a[184:187], v[116:119]
  v_cvt_pk_bf16_f32 v108, v104, v105
  v_cvt_pk_bf16_f32 v109, v106, v107
  v_mfma_f32_16x16x32_bf16 v[116:119], v[92:95], a[172:175], v[116:119]
  s_branch L_r253
L_hop_0_2:
  s_cbranch_execz L_walk
L_pad4018:
L_kh:
  s_cmp_lt_u32 s59, 14
  s_cbranch_scc1 L_k11
  v_mfma_f32_16x16x32_bf16 v[100:103], a[76:79], v[84:87], 0
  s_lshl_b32 s5, s3, 3
  v_mfma_f32_16x16x32_bf16 v[100:103], a[88:91], v[88:91], v[100:103]
  s_add_u32 s5, s5, 159744
  v_mov_b32 v11, s5
  v_mfma_f32_16x16x32_bf16 v[100:103], a[100:103], v[92:95], v[100:103]
  v_cvt_pk_bf16_f32 v66, v128, v129
  v_cvt_pk_bf16_f32 v67, v130, v131
  v_mfma_f32_16x16x32_bf16 v[100:103], a[112:115], v[96:99], v[100:103]
  ds_read_b128 a[244:247], v1 offset:22528
  v_mfma_f32_16x16x32_bf16 v[100:103], a[124:127], v[136:139], v[100:103]
  ds_read_b128 a[248:251], v0 offset:22528
  v_mfma_f32_16x16x32_bf16 v[100:103], a[136:139], v[140:143], v[100:103]
  ds_read_b128 a[252:255], v1 offset:14336
  v_mfma_f32_16x16x32_bf16 v[104:107], a[132:135], v[140:143], 0
  ds_read_b128 v[116:119], v0 offset:14336
  v_mfma_f32_16x16x32_bf16 v[104:107], a[120:123], v[136:139], v[104:107]
  ds_read_b128 v[128:131], v1 offset:6144
  v_mfma_f32_16x16x32_bf16 v[104:107], a[108:111], v[96:99], v[104:107]
  v_cvt_pk_bf16_f32 v146, v100, v101
  v_cvt_pk_bf16_f32 v147, v102, v103
  v_mfma_f32_16x16x32_bf16 v[104:107], a[96:99], v[92:95], v[104:107]
  ds_read_b128 v[132:135], v0 offset:6144
  v_cndmask_b32 v160, v32, v48, s[100:101]
  v_mfma_f32_16x16x32_bf16 v[104:107], a[84:87], v[88:91], v[104:107]
  v_cndmask_b32 v161, v33, v49, s[100:101]
  v_cndmask_b32 v162, v34, v50, s[100:101]
  v_mfma_f32_16x16x32_bf16 v[104:107], a[72:75], v[84:87], v[104:107]
  v_cndmask_b32 v163, v35, v51, s[100:101]
  v_cndmask_b32 v164, v28, v44, s[100:101]
  v_mfma_f32_16x16x32_bf16 v[108:111], a[140:143], v[140:143], 0
  v_cndmask_b32 v165, v29, v45, s[100:101]
  v_cndmask_b32 v166, v30, v46, s[100:101]
  v_mfma_f32_16x16x32_bf16 v[108:111], a[128:131], v[136:139], v[108:111]
  v_cndmask_b32 v167, v31, v47, s[100:101]
  v_cndmask_b32 v100, v24, v40, s[100:101]
  v_mfma_f32_16x16x32_bf16 v[108:111], a[116:119], v[96:99], v[108:111]
  v_cvt_pk_bf16_f32 v144, v104, v105
  v_cvt_pk_bf16_f32 v145, v106, v107
  v_mfma_f32_16x16x32_bf16 v[108:111], a[104:107], v[92:95], v[108:111]
  v_cndmask_b32 v101, v25, v41, s[100:101]
  v_cndmask_b32 v102, v26, v42, s[100:101]
  v_mfma_f32_16x16x32_bf16 v[108:111], a[92:95], v[88:91], v[108:111]
  v_cndmask_b32 v103, v27, v43, s[100:101]
  v_mfma_f32_16x16x32_bf16 v[108:111], a[80:83], v[84:87], v[108:111]
  s_waitcnt lgkmcnt(0)
  v_mfma_f32_16x16x32_bf16 v[104:107], a[132:135], a[244:247], 0
  v_mfma_f32_16x16x32_bf16 v[104:107], a[120:123], a[248:251], v[104:107]
  v_mfma_f32_16x16x32_bf16 v[104:107], a[108:111], a[252:255], v[104:107]
  v_cvt_pk_bf16_f32 v148, v108, v109
  v_cvt_pk_bf16_f32 v149, v110, v111
  v_mfma_f32_16x16x32_bf16 v[104:107], a[96:99], v[116:119], v[104:107]
  v_mfma_f32_16x16x32_bf16 v[104:107], a[84:87], v[128:131], v[104:107]
  s_waitcnt lgkmcnt(0)
  s_barrier
  v_mfma_f32_16x16x32_bf16 v[104:107], a[72:75], v[132:135], v[104:107]
  v_mfma_f32_16x16x32_bf16 v[108:111], a[76:79], v[132:135], 0
  v_mfma_f32_16x16x32_bf16 v[108:111], a[88:91], v[128:131], v[108:111]
  v_mfma_f32_16x16x32_bf16 v[108:111], a[100:103], v[116:119], v[108:111]
  v_cvt_pk_bf16_f32 v152, v104, v105
  v_cvt_pk_bf16_f32 v153, v106, v107
  v_mfma_f32_16x16x32_bf16 v[108:111], a[112:115], a[252:255], v[108:111]
  v_mfma_f32_16x16x32_bf16 v[108:111], a[124:127], a[248:251], v[108:111]
  v_mfma_f32_16x16x32_bf16 v[108:111], a[136:139], a[244:247], v[108:111]
  v_mfma_f32_16x16x32_bf16 v[104:107], a[140:143], a[244:247], 0
  v_mfma_f32_16x16x32_bf16 v[104:107], a[128:131], a[248:251], v[104:107]
  v_mfma_f32_16x16x32_bf16 v[104:107], a[116:119], a[252:255], v[104:107]
  v_cvt_pk_bf16_f32 v154, v108, v109
  v_cvt_pk_bf16_f32 v155, v110, v111
  v_mfma_f32_16x16x32_bf16 v[104:107], a[104:107], v[116:119], v[104:107]
  v_mfma_f32_16x16x32_bf16 v[104:107], a[92:95], v[128:131], v[104:107]
  v_mfma_f32_16x16x32_bf16 v[104:107], a[80:83], v[132:135], v[104:107]
  v_mfma_f32_16x16x32_bf16 v[108:111], v[70:73], v[76:79], v[36:39]
  v_mfma_f32_16x16x32_bf16 v[108:111], v[68:71], v[12:15], v[108:111]
  v_mfma_f32_16x16x32_bf16 v[112:115], v[122:125], v[76:79], v[32:35]
  v_cvt_pk_bf16_f32 v156, v104, v105
  v_cvt_pk_bf16_f32 v157, v106, v107
  v_mfma_f32_16x16x32_bf16 v[112:115], v[120:123], v[12:15], v[112:115]
  v_mfma_f32_16x16x32_bf16 v[168:171], v[146:149], v[76:79], v[164:167]
  v_exp_f32 v108, v108
  v_mfma_f32_16x16x32_bf16 v[168:171], v[144:147], v[12:15], v[168:171]
  v_exp_f32 v109, v109
  v_mfma_f32_16x16x32_bf16 v[172:175], v[154:157], v[76:79], v[100:103]
  v_exp_f32 v110, v110
  v_mfma_f32_16x16x32_bf16 v[172:175], v[152:155], v[12:15], v[172:175]
  v_exp_f32 v111, v111
  v_mfma_f32_16x16x32_bf16 v[100:103], v[68:71], v[80:83], v[40:43]
  v_exp_f32 v112, v112
  v_mfma_f32_16x16x32_bf16 v[100:103], v[70:73], v[14:17], v[100:103]
  v_exp_f32 v113, v113
  v_mfma_f32_16x16x32_bf16 v[104:107], v[120:123], v[80:83], v[36:39]
  v_exp_f32 v114, v114
  v_mfma_f32_16x16x32_bf16 v[104:107], v[122:125], v[14:17], v[104:107]
  v_exp_f32 v115, v115
  v_mfma_f32_16x16x32_bf16 v[72:75], v[144:147], v[80:83], v[160:163]
  v_exp_f32 v168, v168
  v_mfma_f32_16x16x32_bf16 v[72:75], v[146:149], v[14:17], v[72:75]
  v_exp_f32 v169, v169
  v_mfma_f32_16x16x32_bf16 v[68:71], v[152:155], v[80:83], v[164:167]
  v_exp_f32 v170, v170
  v_mfma_f32_16x16x32_bf16 v[68:71], v[154:157], v[14:17], v[68:71]
  v_exp_f32 v171, v171
  v_mfma_f32_16x16x32_bf16 v[76:79], v[84:87], a[144:147], 0
  v_exp_f32 v172, v172
  v_mfma_f32_16x16x32_bf16 v[76:79], v[88:91], a[156:159], v[76:79]
  v_exp_f32 v173, v173
  v_mfma_f32_16x16x32_bf16 v[76:79], v[92:95], a[168:171], v[76:79]
  v_exp_f32 v174, v174
  v_mfma_f32_16x16x32_bf16 v[76:79], v[96:99], a[180:183], v[76:79]
  v_exp_f32 v175, v175
  v_mfma_f32_16x16x32_bf16 v[76:79], v[136:139], a[192:195], v[76:79]
  v_cvt_pk_bf16_f32 v108, v108, v109
  v_cvt_pk_bf16_f32 v109, v110, v111
  v_mfma_f32_16x16x32_bf16 v[76:79], v[140:143], a[204:207], v[76:79]
  v_cvt_pk_bf16_f32 v110, v112, v113
  v_cvt_pk_bf16_f32 v111, v114, v115
  v_mfma_f32_16x16x32_bf16 v[80:83], v[140:143], a[208:211], 0
  v_cvt_pk_bf16_f32 v112, v168, v169
  v_cvt_pk_bf16_f32 v113, v170, v171
  v_mfma_f32_16x16x32_bf16 v[80:83], v[136:139], a[196:199], v[80:83]
  v_cvt_pk_bf16_f32 v114, v172, v173
  v_cvt_pk_bf16_f32 v115, v174, v175
  v_mfma_f32_16x16x32_bf16 v[80:83], v[96:99], a[184:187], v[80:83]
  v_cvt_pk_bf16_f32 v144, v76, v77
  v_cvt_pk_bf16_f32 v145, v78, v79
  v_mfma_f32_16x16x32_bf16 v[80:83], v[92:95], a[172:175], v[80:83]
  v_exp_f32 v100, v100
  v_mfma_f32_16x16x32_bf16 v[80:83], v[88:91], a[160:163], v[80:83]
  v_exp_f32 v101, v101
  v_mfma_f32_16x16x32_bf16 v[80:83], v[84:87], a[148:151], v[80:83]
  v_exp_f32 v102, v102
  v_mfma_f32_16x16x32_bf16 v[120:123], v[84:87], a[152:155], 0
  v_exp_f32 v103, v103
  v_mfma_f32_16x16x32_bf16 v[120:123], v[88:91], a[164:167], v[120:123]
  v_exp_f32 v104, v104
  v_mfma_f32_16x16x32_bf16 v[120:123], v[92:95], a[176:179], v[120:123]
  v_cvt_pk_bf16_f32 v148, v80, v81
  v_cvt_pk_bf16_f32 v149, v82, v83
  v_mfma_f32_16x16x32_bf16 v[120:123], v[96:99], a[188:191], v[120:123]
  v_exp_f32 v105, v105
  v_mfma_f32_16x16x32_bf16 v[120:123], v[136:139], a[200:203], v[120:123]
  v_exp_f32 v106, v106
  v_mfma_f32_16x16x32_bf16 v[120:123], v[140:143], a[212:215], v[120:123]
  v_exp_f32 v107, v107
  v_mfma_f32_16x16x32_bf16 v[76:79], v[132:135], a[144:147], 0
  v_exp_f32 v72, v72
  v_mfma_f32_16x16x32_bf16 v[76:79], v[128:131], a[156:159], v[76:79]
  v_exp_f32 v73, v73
  v_mfma_f32_16x16x32_bf16 v[76:79], v[116:119], a[168:171], v[76:79]
  v_cvt_pk_bf16_f32 v152, v120, v121
  v_cvt_pk_bf16_f32 v153, v122, v123
  v_mfma_f32_16x16x32_bf16 v[76:79], a[252:255], a[180:183], v[76:79]
  ds_read_b128 v[88:91], v3 offset:0
  v_cvt_pk_bf16_f32 v100, v100, v101
  v_mfma_f32_16x16x32_bf16 v[76:79], a[248:251], a[192:195], v[76:79]
  ds_read_b128 v[92:95], v3 offset:4096
  v_cvt_pk_bf16_f32 v101, v102, v103
  v_mfma_f32_16x16x32_bf16 v[76:79], a[244:247], a[204:207], v[76:79]
  ds_read_b128 v[120:123], v3 offset:8192
  v_cvt_pk_bf16_f32 v102, v104, v105
  v_mfma_f32_16x16x32_bf16 v[80:83], a[244:247], a[208:211], 0
  ds_read_b128 v[124:127], v3 offset:12288
  v_cvt_pk_bf16_f32 v103, v106, v107
  v_mfma_f32_16x16x32_bf16 v[80:83], a[248:251], a[196:199], v[80:83]
  ds_read_b128 v[136:139], v3 offset:16384
  v_cvt_pk_bf16_f32 v104, v72, v73
  v_mfma_f32_16x16x32_bf16 v[80:83], a[252:255], a[184:187], v[80:83]
  v_cvt_pk_bf16_f32 v146, v76, v77
  v_cvt_pk_bf16_f32 v147, v78, v79
  v_mfma_f32_16x16x32_bf16 v[80:83], v[116:119], a[172:175], v[80:83]
  ds_read_b128 v[140:143], v3 offset:20480
  v_mfma_f32_16x16x32_bf16 v[80:83], v[128:131], a[160:163], v[80:83]
  v_exp_f32 v74, v74
  v_mfma_f32_16x16x32_bf16 v[80:83], v[132:135], a[148:151], v[80:83]
  v_exp_f32 v75, v75
  v_mfma_f32_16x16x32_bf16 v[76:79], v[132:135], a[152:155], 0
  v_exp_f32 v68, v68
  v_mfma_f32_16x16x32_bf16 v[76:79], v[128:131], a[164:167], v[76:79]
  v_exp_f32 v69, v69
  v_mfma_f32_16x16x32_bf16 v[76:79], v[116:119], a[176:179], v[76:79]
  v_cvt_pk_bf16_f32 v150, v80, v81
  v_cvt_pk_bf16_f32 v151, v82, v83
  v_mfma_f32_16x16x32_bf16 v[76:79], a[252:255], a[188:191], v[76:79]
  v_mov_b64 v[128:129], 0
  v_cvt_pk_bf16_f32 v105, v74, v75
  v_mfma_f32_16x16x32_bf16 v[76:79], a[248:251], a[200:203], v[76:79]
  v_exp_f32 v70, v70
  v_mfma_f32_16x16x32_bf16 v[76:79], a[244:247], a[212:215], v[76:79]
  s_waitcnt lgkmcnt(0)
  v_exp_f32 v71, v71
  v_mfma_f32_16x16x32_bf16 v[116:119], v[88:91], v[184:187], 0
  v_cvt_pk_bf16_f32 v106, v68, v69
  v_cvt_pk_bf16_f32 v107, v70, v71
  v_mfma_f32_16x16x32_bf16 v[116:119], v[92:95], v[200:203], v[116:119]
  v_mfma_f32_16x16x32_bf16 v[116:119], v[120:123], v[216:219], v[116:119]
  v_cvt_pk_bf16_f32 v154, v76, v77
  v_cvt_pk_bf16_f32 v155, v78, v79
  v_mfma_f32_16x16x32_bf16 v[116:119], v[124:127], v[232:235], v[116:119]
  v_mov_b64 v[96:97], 0
  v_mfma_f32_16x16x32_bf16 v[116:119], v[136:139], v[248:251], v[116:119]
  v_mfma_f32_16x16x32_bf16 v[116:119], v[140:143], a[224:227], v[116:119]
  v_smfmac_f32_16x16x64_bf16 v[128:131], a[240:243], v[108:115], v10
  v_mfma_f32_16x16x32_bf16 v[76:79], v[144:147], v[112:115], 0
  v_mfma_f32_16x16x32_bf16 v[76:79], v[56:59], v[108:111], v[76:79]
  v_mfma_f32_16x16x32_bf16 v[80:83], v[60:63], v[108:111], 0
  v_mfma_f32_16x16x32_bf16 v[80:83], v[148:151], v[112:115], v[80:83]
  v_mfma_f32_16x16x32_bf16 v[68:71], v[152:155], v[112:115], 0
  v_add_f32 v128, v128, v129
  v_mfma_f32_16x16x32_bf16 v[68:71], v[64:67], v[108:111], v[68:71]
  v_rcp_f32 v130, v128
  v_smfmac_f32_16x16x64_bf16 v[96:99], a[240:243], v[100:107], v10
  v_max3_f32 v9, v128, v130, v9
  v_mul_f32 v76, v130, v76
  v_mfma_f32_16x16x32_bf16 v[72:75], v[144:147], v[104:107], 0
  v_mul_f32 v77, v130, v77
  v_mul_f32 v78, v130, v78
  v_mfma_f32_16x16x32_bf16 v[72:75], v[56:59], v[100:103], v[72:75]
  v_mul_f32 v79, v130, v79
  v_cvt_pk_bf16_f32 v76, v76, v77
  v_mfma_f32_16x16x32_bf16 v[84:87], v[60:63], v[100:103], 0
  v_cvt_pk_bf16_f32 v77, v78, v79
  v_mul_f32 v80, v130, v80
  v_mfma_f32_16x16x32_bf16 v[84:87], v[148:151], v[104:107], v[84:87]
  v_mul_f32 v81, v130, v81
  v_mul_f32 v82, v130, v82
  v_mfma_f32_16x16x32_bf16 v[56:59], v[152:155], v[104:107], 0
  v_add_f32 v96, v96, v97
  v_mul_f32 v83, v130, v83
  v_mfma_f32_16x16x32_bf16 v[56:59], v[64:67], v[100:103], v[56:59]
  v_rcp_f32 v98, v96
  v_mfma_f32_16x16x32_bf16 v[60:63], v[140:143], a[228:231], 0
  v_cvt_pk_bf16_f32 v80, v80, v81
  v_cvt_pk_bf16_f32 v81, v82, v83
  v_mfma_f32_16x16x32_bf16 v[60:63], v[136:139], v[252:255], v[60:63]
  v_mul_f32 v68, v130, v68
  v_mul_f32 v69, v130, v69
  v_mfma_f32_16x16x32_bf16 v[60:63], v[124:127], v[236:239], v[60:63]
  ds_read_b128 v[100:103], v4 offset:0
  ds_read_b128 v[104:107], v4 offset:4096
  v_mfma_f32_16x16x32_bf16 v[60:63], v[120:123], v[220:223], v[60:63]
  ds_read_b128 v[112:115], v4 offset:8192
  ds_read_b128 v[132:135], v4 offset:12288
  v_mfma_f32_16x16x32_bf16 v[60:63], v[92:95], v[204:207], v[60:63]
  ds_read_b128 v[144:147], v4 offset:16384
  ds_read_b128 v[148:151], v4 offset:20480
  v_mfma_f32_16x16x32_bf16 v[60:63], v[88:91], v[188:191], v[60:63]
  v_mul_f32 v70, v130, v70
  v_mul_f32 v71, v130, v71
  v_mfma_f32_16x16x32_bf16 v[108:111], v[88:91], v[192:195], 0
  v_cvt_pk_bf16_f32 v68, v68, v69
  v_cvt_pk_bf16_f32 v69, v70, v71
  v_mfma_f32_16x16x32_bf16 v[108:111], v[92:95], v[208:211], v[108:111]
  v_max3_f32 v9, v96, v98, v9
  v_mul_f32 v72, v98, v72
  v_mfma_f32_16x16x32_bf16 v[108:111], v[120:123], v[224:227], v[108:111]
  v_cvt_pk_bf16_f32 v116, v116, v60
  v_cvt_pk_bf16_f32 v117, v117, v61
  v_mfma_f32_16x16x32_bf16 v[108:111], v[124:127], v[240:243], v[108:111]
  v_cvt_pk_bf16_f32 v118, v118, v62
  v_cvt_pk_bf16_f32 v119, v119, v63
  v_mfma_f32_16x16x32_bf16 v[108:111], v[136:139], a[216:219], v[108:111]
  buffer_store_dword v116, v7, s[24:27], s33 offen offset:0 nt
  v_mfma_f32_16x16x32_bf16 v[108:111], v[140:143], a[232:235], v[108:111]
  v_mul_f32 v73, v98, v73
  v_mul_f32 v74, v98, v74
  v_mfma_f32_16x16x32_bf16 v[128:131], v[140:143], a[236:239], 0
  v_mul_f32 v75, v98, v75
  v_cvt_pk_bf16_f32 v72, v72, v73
  v_mfma_f32_16x16x32_bf16 v[128:131], v[136:139], a[220:223], v[128:131]
  buffer_store_dword v117, v7, s[24:27], s33 offen offset:384 nt
  v_mfma_f32_16x16x32_bf16 v[128:131], v[124:127], v[244:247], v[128:131]
  ds_read_b128 a[244:247], v3 offset:512
  ds_read_b128 a[248:251], v3 offset:4608
  v_mfma_f32_16x16x32_bf16 v[128:131], v[120:123], v[228:231], v[128:131]
  ds_read_b128 a[252:255], v3 offset:8704
  ds_read_b128 v[60:63], v3 offset:12800
  v_mfma_f32_16x16x32_bf16 v[128:131], v[92:95], v[212:215], v[128:131]
  buffer_store_dword v118, v7, s[24:27], s33 offen offset:768 nt
  v_mfma_f32_16x16x32_bf16 v[128:131], v[88:91], v[196:199], v[128:131]
  s_waitcnt lgkmcnt(4)
  ds_read_b128 v[64:67], v3 offset:16896
  ds_read_b128 v[92:95], v3 offset:20992
  v_mfma_f32_16x16x32_bf16 v[88:91], v[100:103], v[184:187], 0
  v_cvt_pk_bf16_f32 v73, v74, v75
  v_mul_f32 v84, v98, v84
  v_mfma_f32_16x16x32_bf16 v[88:91], v[104:107], v[200:203], v[88:91]
  buffer_store_dword v119, v7, s[24:27], s33 offen offset:1152 nt
  v_mfma_f32_16x16x32_bf16 v[88:91], v[112:115], v[216:219], v[88:91]
  v_cvt_pk_bf16_f32 v108, v108, v128
  v_cvt_pk_bf16_f32 v109, v109, v129
  v_mfma_f32_16x16x32_bf16 v[88:91], v[132:135], v[232:235], v[88:91]
  v_cvt_pk_bf16_f32 v110, v110, v130
  v_cvt_pk_bf16_f32 v111, v111, v131
  v_mfma_f32_16x16x32_bf16 v[88:91], v[144:147], v[248:251], v[88:91]
  buffer_store_dword v108, v8, s[24:27], s33 offen offset:0 nt
  v_mfma_f32_16x16x32_bf16 v[88:91], v[148:151], a[224:227], v[88:91]
  v_mul_f32 v85, v98, v85
  v_mul_f32 v86, v98, v86
  v_mfma_f32_16x16x32_bf16 v[116:119], v[148:151], a[228:231], 0
  v_mul_f32 v87, v98, v87
  v_cvt_pk_bf16_f32 v84, v84, v85
  v_mfma_f32_16x16x32_bf16 v[116:119], v[144:147], v[252:255], v[116:119]
  buffer_store_dword v109, v8, s[24:27], s33 offen offset:384 nt
  v_mfma_f32_16x16x32_bf16 v[116:119], v[132:135], v[236:239], v[116:119]
L_hop_1_2:
  s_cbranch_execz L_walk
  v_cvt_pk_bf16_f32 v85, v86, v87
  v_mul_f32 v56, v98, v56
  v_mfma_f32_16x16x32_bf16 v[116:119], v[112:115], v[220:223], v[116:119]
  v_mul_f32 v57, v98, v57
  v_mul_f32 v58, v98, v58
  v_mfma_f32_16x16x32_bf16 v[116:119], v[104:107], v[204:207], v[116:119]
  buffer_store_dword v110, v8, s[24:27], s33 offen offset:768 nt
  v_mfma_f32_16x16x32_bf16 v[116:119], v[100:103], v[188:191], v[116:119]
  s_waitcnt lgkmcnt(0)
  v_mul_f32 v59, v98, v59
  v_cvt_pk_bf16_f32 v56, v56, v57
  v_mfma_f32_16x16x32_bf16 v[100:103], a[244:247], v[184:187], 0
  v_cvt_pk_bf16_f32 v57, v58, v59
  v_cmp_nge_f32 vcc, 0x53800000, v9
  v_mfma_f32_16x16x32_bf16 v[100:103], a[248:251], v[200:203], v[100:103]
  buffer_store_dword v111, v8, s[24:27], s33 offen offset:1152 nt
  v_mfma_f32_16x16x32_bf16 v[100:103], a[252:255], v[216:219], v[100:103]
  s_add_u32 s33, s33, s98
  v_cvt_pk_bf16_f32 v88, v88, v116
  v_cvt_pk_bf16_f32 v89, v89, v117
  v_mfma_f32_16x16x32_bf16 v[100:103], v[60:63], v[232:235], v[100:103]
  s_or_b32 s6, vcc_lo, vcc_hi
  v_cvt_pk_bf16_f32 v90, v90, v118
  v_cvt_pk_bf16_f32 v91, v91, v119
  v_mfma_f32_16x16x32_bf16 v[100:103], v[64:67], v[248:251], v[100:103]
  buffer_store_dword v88, v7, s[24:27], s34 offen offset:0 nt
  v_mfma_f32_16x16x32_bf16 v[100:103], v[92:95], a[224:227], v[100:103]
  ds_write2st64_b32 v5, v76, v77 offset0:0 offset1:4
  v_mfma_f32_16x16x32_bf16 v[96:99], v[92:95], a[228:231], 0
  ds_write2st64_b32 v5, v80, v81 offset0:8 offset1:12
  v_mfma_f32_16x16x32_bf16 v[96:99], v[64:67], v[252:255], v[96:99]
  buffer_store_dword v89, v7, s[24:27], s34 offen offset:384 nt
  v_mfma_f32_16x16x32_bf16 v[96:99], v[60:63], v[236:239], v[96:99]
  ds_read_b128 v[76:79], v4 offset:512
  ds_read_b128 v[80:83], v4 offset:4608
  v_mfma_f32_16x16x32_bf16 v[96:99], a[252:255], v[220:223], v[96:99]
  ds_write2st64_b32 v5, v68, v69 offset0:16 offset1:20
  v_mfma_f32_16x16x32_bf16 v[96:99], a[248:251], v[204:207], v[96:99]
  buffer_store_dword v90, v7, s[24:27], s34 offen offset:768 nt
  v_mfma_f32_16x16x32_bf16 v[96:99], a[244:247], v[188:191], v[96:99]
  ds_write2st64_b32 v5, v72, v73 offset0:1 offset1:5
  v_mfma_f32_16x16x32_bf16 v[68:71], a[244:247], v[192:195], 0
  ds_write2st64_b32 v5, v84, v85 offset0:9 offset1:13
  v_mfma_f32_16x16x32_bf16 v[68:71], a[248:251], v[208:211], v[68:71]
  buffer_store_dword v91, v7, s[24:27], s34 offen offset:1152 nt
  v_mfma_f32_16x16x32_bf16 v[68:71], a[252:255], v[224:227], v[68:71]
  s_add_u32 s34, s34, s98
  v_cvt_pk_bf16_f32 v100, v100, v96
  v_cvt_pk_bf16_f32 v101, v101, v97
  v_mfma_f32_16x16x32_bf16 v[68:71], v[60:63], v[240:243], v[68:71]
  v_cvt_pk_bf16_f32 v102, v102, v98
  v_cvt_pk_bf16_f32 v103, v103, v99
  v_mfma_f32_16x16x32_bf16 v[68:71], v[64:67], a[216:219], v[68:71]
  buffer_store_dword v100, v7, s[24:27], s35 offen offset:0 nt
  v_mfma_f32_16x16x32_bf16 v[68:71], v[92:95], a[232:235], v[68:71]
  ds_write2st64_b32 v5, v56, v57 offset0:17 offset1:21
  v_mfma_f32_16x16x32_bf16 v[88:91], v[92:95], a[236:239], 0
  ds_read_b128 v[84:87], v4 offset:8704
  v_mov_b32 v54, s6
  v_mfma_f32_16x16x32_bf16 v[88:91], v[64:67], a[220:223], v[88:91]
  buffer_store_dword v101, v7, s[24:27], s35 offen offset:384 nt
  v_mfma_f32_16x16x32_bf16 v[88:91], v[60:63], v[244:247], v[88:91]
  ds_read_b128 v[72:75], v4 offset:12800
  ds_read_b128 v[64:67], v4 offset:16896
  v_mfma_f32_16x16x32_bf16 v[88:91], a[252:255], v[228:231], v[88:91]
  ds_write_b32 v11, v54
  v_mfma_f32_16x16x32_bf16 v[88:91], a[248:251], v[212:215], v[88:91]
  buffer_store_dword v102, v7, s[24:27], s35 offen offset:768 nt
  v_mfma_f32_16x16x32_bf16 v[88:91], a[244:247], v[196:199], v[88:91]
  s_waitcnt lgkmcnt(8)
  ds_read_b128 v[60:63], v4 offset:20992
  v_xor_b32 v3, 40960, v3
  v_xor_b32 v4, 40960, v4
  v_mfma_f32_16x16x32_bf16 v[56:59], v[76:79], v[184:187], 0
  s_waitcnt lgkmcnt(1)
  s_barrier
  v_mfma_f32_16x16x32_bf16 v[56:59], v[80:83], v[200:203], v[56:59]
  buffer_store_dword v103, v7, s[24:27], s35 offen offset:1152 nt
  v_mfma_f32_16x16x32_bf16 v[56:59], v[84:87], v[216:219], v[56:59]
  v_cvt_pk_bf16_f32 v68, v68, v88
  v_cvt_pk_bf16_f32 v69, v69, v89
  v_mfma_f32_16x16x32_bf16 v[56:59], v[72:75], v[232:235], v[56:59]
  s_waitcnt lgkmcnt(0)
  v_cvt_pk_bf16_f32 v70, v70, v90
  v_cvt_pk_bf16_f32 v71, v71, v91
  v_mfma_f32_16x16x32_bf16 v[56:59], v[64:67], v[248:251], v[56:59]
  buffer_store_dword v68, v8, s[24:27], s35 offen offset:0 nt
  v_mfma_f32_16x16x32_bf16 v[56:59], v[60:63], a[224:227], v[56:59]
  ds_read_b128 a[244:247], v3 offset:0
  ds_read_b128 a[248:251], v3 offset:4096
  v_mfma_f32_16x16x32_bf16 v[88:91], v[60:63], a[228:231], 0
  buffer_store_dword v69, v8, s[24:27], s35 offen offset:384 nt
  v_mfma_f32_16x16x32_bf16 v[88:91], v[64:67], v[252:255], v[88:91]
  ds_read_b128 a[252:255], v3 offset:8192
  ds_read_b128 v[60:63], v3 offset:12288
  v_mfma_f32_16x16x32_bf16 v[88:91], v[72:75], v[236:239], v[88:91]
  buffer_store_dword v70, v8, s[24:27], s35 offen offset:768 nt
  v_mfma_f32_16x16x32_bf16 v[88:91], v[84:87], v[220:223], v[88:91]
  ds_read_b128 v[64:67], v3 offset:16384
  ds_read_b128 v[72:75], v3 offset:20480
  v_mfma_f32_16x16x32_bf16 v[88:91], v[80:83], v[204:207], v[88:91]
  buffer_store_dword v71, v8, s[24:27], s35 offen offset:1152 nt
  v_mfma_f32_16x16x32_bf16 v[88:91], v[76:79], v[188:191], v[88:91]
  s_waitcnt lgkmcnt(4)
  v_mov_b32 v11, 159744
  v_mfma_f32_16x16x32_bf16 v[68:71], a[244:247], v[184:187], 0
  ds_read2_b32 v[76:77], v11 offset0:0 offset1:2
  ds_read2_b32 v[78:79], v11 offset0:4 offset1:6
  v_mfma_f32_16x16x32_bf16 v[68:71], a[248:251], v[200:203], v[68:71]
  s_waitcnt lgkmcnt(4)
  v_mfma_f32_16x16x32_bf16 v[68:71], a[252:255], v[216:219], v[68:71]
  v_cvt_pk_bf16_f32 v56, v56, v88
  v_cvt_pk_bf16_f32 v57, v57, v89
  v_mfma_f32_16x16x32_bf16 v[68:71], v[60:63], v[232:235], v[68:71]
  s_waitcnt lgkmcnt(2)
  v_cvt_pk_bf16_f32 v58, v58, v90
  v_cvt_pk_bf16_f32 v59, v59, v91
  v_mfma_f32_16x16x32_bf16 v[68:71], v[64:67], v[248:251], v[68:71]
  buffer_store_dword v56, v7, s[24:27], s36 offen offset:0 nt
  v_mfma_f32_16x16x32_bf16 v[68:71], v[72:75], a[224:227], v[68:71]
  s_waitcnt lgkmcnt(0)
  v_or3_b32 v76, v76, v77, v78
  v_or_b32 v76, v76, v79
  v_mfma_f32_16x16x32_bf16 v[100:103], v[72:75], a[228:231], 0
  buffer_store_dword v57, v7, s[24:27], s36 offen offset:384 nt
  v_mfma_f32_16x16x32_bf16 v[100:103], v[64:67], v[252:255], v[100:103]
  v_readfirstlane_b32 s49, v76
  v_mfma_f32_16x16x32_bf16 v[100:103], v[60:63], v[236:239], v[100:103]
  buffer_store_dword v58, v7, s[24:27], s36 offen offset:768 nt
  v_mfma_f32_16x16x32_bf16 v[100:103], a[252:255], v[220:223], v[100:103]
  ds_read_b128 v[76:79], v4 offset:0
  ds_read_b128 v[80:83], v4 offset:4096
  v_mfma_f32_16x16x32_bf16 v[100:103], a[248:251], v[204:207], v[100:103]
  buffer_store_dword v59, v7, s[24:27], s36 offen offset:1152 nt
  v_mfma_f32_16x16x32_bf16 v[100:103], a[244:247], v[188:191], v[100:103]
  ds_read_b128 v[84:87], v4 offset:8192
  ds_read_b128 v[88:91], v4 offset:12288
  v_mfma_f32_16x16x32_bf16 v[56:59], a[244:247], v[192:195], 0
  ds_read_b128 v[92:95], v4 offset:16384
  ds_read_b128 v[96:99], v4 offset:20480
  v_mfma_f32_16x16x32_bf16 v[56:59], a[248:251], v[208:211], v[56:59]
  v_mfma_f32_16x16x32_bf16 v[56:59], a[252:255], v[224:227], v[56:59]
  v_cvt_pk_bf16_f32 v68, v68, v100
  v_cvt_pk_bf16_f32 v69, v69, v101
  v_mfma_f32_16x16x32_bf16 v[56:59], v[60:63], v[240:243], v[56:59]
  v_cvt_pk_bf16_f32 v70, v70, v102
  v_cvt_pk_bf16_f32 v71, v71, v103
  v_mfma_f32_16x16x32_bf16 v[56:59], v[64:67], a[216:219], v[56:59]
  buffer_store_dword v68, v7, s[24:27], s33 offen offset:0 nt
  v_mfma_f32_16x16x32_bf16 v[56:59], v[72:75], a[232:235], v[56:59]
  v_mfma_f32_16x16x32_bf16 v[100:103], v[72:75], a[236:239], 0
  buffer_store_dword v69, v7, s[24:27], s33 offen offset:384 nt
  v_mfma_f32_16x16x32_bf16 v[100:103], v[64:67], a[220:223], v[100:103]
  v_mfma_f32_16x16x32_bf16 v[100:103], v[60:63], v[244:247], v[100:103]
  buffer_store_dword v70, v7, s[24:27], s33 offen offset:768 nt
  v_mfma_f32_16x16x32_bf16 v[100:103], a[252:255], v[228:231], v[100:103]
  v_mfma_f32_16x16x32_bf16 v[100:103], a[248:251], v[212:215], v[100:103]
  buffer_store_dword v71, v7, s[24:27], s33 offen offset:1152 nt
  v_mfma_f32_16x16x32_bf16 v[100:103], a[244:247], v[196:199], v[100:103]
  s_waitcnt lgkmcnt(0)
  v_mfma_f32_16x16x32_bf16 v[60:63], v[76:79], v[184:187], 0
  v_mfma_f32_16x16x32_bf16 v[60:63], v[80:83], v[200:203], v[60:63]
  v_mfma_f32_16x16x32_bf16 v[60:63], v[84:87], v[216:219], v[60:63]
  v_cvt_pk_bf16_f32 v56, v56, v100
  v_cvt_pk_bf16_f32 v57, v57, v101
  v_mfma_f32_16x16x32_bf16 v[60:63], v[88:91], v[232:235], v[60:63]
  v_cvt_pk_bf16_f32 v58, v58, v102
  v_cvt_pk_bf16_f32 v59, v59, v103
  v_mfma_f32_16x16x32_bf16 v[60:63], v[92:95], v[248:251], v[60:63]
  buffer_store_dword v56, v8, s[24:27], s33 offen offset:0 nt
  v_mfma_f32_16x16x32_bf16 v[60:63], v[96:99], a[224:227], v[60:63]
  v_mfma_f32_16x16x32_bf16 v[64:67], v[96:99], a[228:231], 0
  buffer_store_dword v57, v8, s[24:27], s33 offen offset:384 nt
  v_mfma_f32_16x16x32_bf16 v[64:67], v[92:95], v[252:255], v[64:67]
  v_mfma_f32_16x16x32_bf16 v[64:67], v[88:91], v[236:239], v[64:67]
  buffer_store_dword v58, v8, s[24:27], s33 offen offset:768 nt
  v_mfma_f32_16x16x32_bf16 v[64:67], v[84:87], v[220:223], v[64:67]
  v_mfma_f32_16x16x32_bf16 v[64:67], v[80:83], v[204:207], v[64:67]
  buffer_store_dword v59, v8, s[24:27], s33 offen offset:1152 nt
  v_mfma_f32_16x16x32_bf16 v[64:67], v[76:79], v[188:191], v[64:67]
  s_nop 7
  v_cvt_pk_bf16_f32 v60, v60, v64
  v_cvt_pk_bf16_f32 v61, v61, v65
  v_cvt_pk_bf16_f32 v62, v62, v66
  v_cvt_pk_bf16_f32 v63, v63, v67
  buffer_store_dword v60, v7, s[24:27], s34 offen offset:0 nt
  buffer_store_dword v61, v7, s[24:27], s34 offen offset:384 nt
  buffer_store_dword v62, v7, s[24:27], s34 offen offset:768 nt
  buffer_store_dword v63, v7, s[24:27], s34 offen offset:1152 nt
  s_cmp_lg_u32 s49, 0
  s_cbranch_scc1 L_safe
  s_endpgm
L_hop_2_2:
  s_cbranch_execz L_walk
L_pad4518:
L_k11:
  s_cmp_lg_u32 s59, 11
  s_cbranch_scc1 L_k12
  v_mfma_f32_16x16x32_bf16 v[100:103], a[0:3], v[84:87], 0
  v_mov_b32 v54, s12
  v_mov_b32 v55, s13
  v_mfma_f32_16x16x32_bf16 v[100:103], a[12:15], v[88:91], v[100:103]
  v_mov_b32 v74, 159808
  v_mfma_f32_16x16x32_bf16 v[100:103], a[24:27], v[92:95], v[100:103]
  v_cvt_pk_bf16_f32 v66, v128, v129
  v_cvt_pk_bf16_f32 v67, v130, v131
  v_mfma_f32_16x16x32_bf16 v[100:103], a[36:39], v[96:99], v[100:103]
  ds_read_b128 v[112:115], v74
  v_mfma_f32_16x16x32_bf16 v[100:103], a[48:51], v[136:139], v[100:103]
  v_mfma_f32_16x16x32_bf16 v[100:103], a[60:63], v[140:143], v[100:103]
  v_mfma_f32_16x16x32_bf16 v[104:107], a[64:67], v[140:143], 0
  v_mfma_f32_16x16x32_bf16 v[104:107], a[52:55], v[136:139], v[104:107]
  v_mfma_f32_16x16x32_bf16 v[104:107], a[40:43], v[96:99], v[104:107]
  s_waitcnt lgkmcnt(0)
  v_cvt_pk_bf16_f32 v18, v100, v101
  v_cvt_pk_bf16_f32 v19, v102, v103
  v_mfma_f32_16x16x32_bf16 v[104:107], a[28:31], v[92:95], v[104:107]
  v_and_b32 v112, v112, v113
  v_and_b32 v114, v114, v115
  v_mfma_f32_16x16x32_bf16 v[104:107], a[16:19], v[88:91], v[104:107]
  v_and_b32 v112, v112, v114
  v_mfma_f32_16x16x32_bf16 v[104:107], a[4:7], v[84:87], v[104:107]
  v_readfirstlane_b32 s49, v112
  v_mfma_f32_16x16x32_bf16 v[108:111], a[8:11], v[84:87], 0
  v_mfma_f32_16x16x32_bf16 v[108:111], a[20:23], v[88:91], v[108:111]
  s_cmp_lg_u32 s49, 0
  s_cselect_b32 s49, s44, s22
  s_cselect_b32 s96, 4096, s96
  v_mfma_f32_16x16x32_bf16 v[108:111], a[32:35], v[92:95], v[108:111]
  v_cvt_pk_bf16_f32 v100, v104, v105
  v_cvt_pk_bf16_f32 v101, v106, v107
  v_mfma_f32_16x16x32_bf16 v[108:111], a[44:47], v[96:99], v[108:111]
  buffer_store_dwordx2 v[54:55], off, s[20:23], s49 sc1
  v_mfma_f32_16x16x32_bf16 v[108:111], a[56:59], v[136:139], v[108:111]
  s_branch L_r224
L_k12:
  s_cmp_lg_u32 s45, 2
  s_cbranch_scc1 L_k12g
  v_mfma_f32_16x16x32_bf16 v[100:103], a[0:3], v[84:87], 0
  s_sub_u32 s49, s44, 2097152
  s_lshr_b32 s49, s49, 9
  s_lshr_b32 s52, s49, 6
  v_mfma_f32_16x16x32_bf16 v[100:103], a[12:15], v[88:91], v[100:103]
  s_and_b32 s53, s49, 63
  s_mul_i32 s50, s52, 15
  s_lshl_b32 s51, s57, 5
  v_mfma_f32_16x16x32_bf16 v[100:103], a[24:27], v[92:95], v[100:103]
  s_cmp_eq_u32 s53, 63
  v_cvt_pk_bf16_f32 v66, v128, v129
  v_cvt_pk_bf16_f32 v67, v130, v131
  v_mfma_f32_16x16x32_bf16 v[100:103], a[36:39], v[96:99], v[100:103]
  s_cselect_b32 s53, s50, s53
  s_cselect_b32 s52, 60, s52
  s_cselect_b32 s51, 3072, s51
  v_mfma_f32_16x16x32_bf16 v[100:103], a[48:51], v[136:139], v[100:103]
  s_mul_i32 s52, s52, 1572864
  s_mul_i32 s53, s53, 3072
  s_add_u32 s52, s52, s53
  v_mfma_f32_16x16x32_bf16 v[100:103], a[60:63], v[140:143], v[100:103]
  s_add_u32 s50, s52, 787968
  s_cmp_eq_u32 s51, 3072
  s_cselect_b32 s10, 100663296, s10
  v_mfma_f32_16x16x32_bf16 v[104:107], a[64:67], v[140:143], 0
  s_sub_u32 s51, s51, s43
  s_mul_i32 s51, s51, 14
  s_sub_u32 s50, s50, s56
  v_mfma_f32_16x16x32_bf16 v[104:107], a[52:55], v[136:139], v[104:107]
  s_add_u32 s58, s50, s51
  s_mul_i32 s50, s14, 98304
  s_add_u32 s98, s58, s50
  v_mfma_f32_16x16x32_bf16 v[104:107], a[40:43], v[96:99], v[104:107]
  s_sub_u32 s49, s98, s43
  v_cvt_pk_bf16_f32 v18, v100, v101
  v_cvt_pk_bf16_f32 v19, v102, v103
  v_mfma_f32_16x16x32_bf16 v[104:107], a[28:31], v[92:95], v[104:107]
  s_add_u32 s31, s31, s49
  s_add_u32 s32, s32, s49
  s_lshl_b32 s50, s50, 1
  v_mfma_f32_16x16x32_bf16 v[104:107], a[16:19], v[88:91], v[104:107]
  s_sub_u32 s32, s32, s50
  s_sub_u32 s37, s37, s49
  s_sub_u32 s38, s38, s49
  v_mfma_f32_16x16x32_bf16 v[104:107], a[4:7], v[84:87], v[104:107]
  s_sub_u32 s39, s39, s49
  s_sub_u32 s40, s40, s49
  s_lshl_b32 s49, s14, 2
  v_mfma_f32_16x16x32_bf16 v[108:111], a[8:11], v[84:87], 0
  s_add_u32 s97, s49, 15
  s_mov_b32 s45, 4
  s_mov_b32 s96, 32768
  v_mfma_f32_16x16x32_bf16 v[108:111], a[20:23], v[88:91], v[108:111]
  s_mov_b64 s[100:101], -1
  v_mfma_f32_16x16x32_bf16 v[108:111], a[32:35], v[92:95], v[108:111]
  v_cvt_pk_bf16_f32 v100, v104, v105
  v_cvt_pk_bf16_f32 v101, v106, v107
  v_mfma_f32_16x16x32_bf16 v[108:111], a[44:47], v[96:99], v[108:111]
  s_branch L_r223
L_k12g:
  s_cmp_lg_u32 s59, 12
  s_cbranch_scc1 L_k13
  s_waitcnt vmcnt(30)
  v_mfma_f32_16x16x32_bf16 v[100:103], a[0:3], v[84:87], 0
  v_cmp_eq_u64 vcc, s[12:13], v[52:53]
  v_mfma_f32_16x16x32_bf16 v[100:103], a[12:15], v[88:91], v[100:103]
  v_mfma_f32_16x16x32_bf16 v[100:103], a[24:27], v[92:95], v[100:103]
  s_and_b32 s49, vcc_lo, 1
  v_cvt_pk_bf16_f32 v66, v128, v129
  v_cvt_pk_bf16_f32 v67, v130, v131
  v_mfma_f32_16x16x32_bf16 v[100:103], a[36:39], v[96:99], v[100:103]
  s_lshl_b32 s49, s49, s14
  s_lshl_b32 s54, s3, 2
  s_add_u32 s54, s54, 159824
  v_mfma_f32_16x16x32_bf16 v[100:103], a[48:51], v[136:139], v[100:103]
  v_mov_b32 v54, s54
  v_mov_b32 v55, s49
  v_mfma_f32_16x16x32_bf16 v[100:103], a[60:63], v[140:143], v[100:103]
  ds_write_b32 v54, v55
  v_mfma_f32_16x16x32_bf16 v[104:107], a[64:67], v[140:143], 0
  v_mfma_f32_16x16x32_bf16 v[104:107], a[52:55], v[136:139], v[104:107]
  v_mfma_f32_16x16x32_bf16 v[104:107], a[40:43], v[96:99], v[104:107]
  v_cvt_pk_bf16_f32 v18, v100, v101
  v_cvt_pk_bf16_f32 v19, v102, v103
  v_mfma_f32_16x16x32_bf16 v[104:107], a[28:31], v[92:95], v[104:107]
  s_waitcnt lgkmcnt(0)
  v_mfma_f32_16x16x32_bf16 v[104:107], a[16:19], v[88:91], v[104:107]
  s_branch L_r218
L_k13:
  v_mov_b32 v54, 159824
  ds_read_b128 v[100:103], v54
  s_waitcnt lgkmcnt(0)
  v_and_b32 v100, v100, v101
  v_and_b32 v102, v102, v103
  v_and_b32 v100, v100, v102
  s_nop 0
  v_readfirstlane_b32 s49, v100
  s_nop 3
  s_lshr_b32 s50, s49, 3
  s_add_u32 s97, s97, s50
  s_cmp_eq_u32 s49, 1
  s_cselect_b32 s45, 3, 0
  s_cbranch_scc1 L_full
  s_branch L_loop
L_safe:
  s_nop 15
  s_waitcnt vmcnt(0) lgkmcnt(0)
  s_mov_b32 s10, 100663296
  v_mbcnt_lo_u32_b32 v58, -1, 0
  v_mbcnt_hi_u32_b32 v58, -1, v58
  v_lshrrev_b32 v59, 2, v58
  v_and_b32 v59, 4, v59
  v_xor_b32 v60, v59, v58
  s_cmp_eq_u32 s47, 63
  s_cselect_b32 s5, 4, 0
  v_and_b32 v60, s5, v60
  v_cmp_eq_u32 vcc, 0, v60
  s_cmp_eq_u32 s48, 63
  s_cselect_b32 s5, 0xc31044fe, 0
  v_mov_b32 v55, s5
  v_mov_b32 v54, 0xc31044fe
  v_cndmask_b32 v55, 0, v55, vcc
  v_cndmask_b32 v54, v54, 0, vcc
  v_add_u32 v0, s46, v2
  v_xor_b32 v1, 64, v0
  s_lshl_b32 s5, s48, 3
  s_add_u32 s5, s5, s3
  s_add_u32 s5, s5, 4
  s_mul_i32 s31, s5, s57
  s_add_u32 s5, s5, 4
  s_and_b32 s5, s5, 511
  s_mul_i32 s32, s5, s57
  v_lshrrev_b32 v59, 2, v59
  s_lshl_b32 s5, s47, 3
  s_add_u32 s5, s5, 4
  s_mul_i32 s5, s5, 384
  s_cmp_eq_u32 s47, 63
  s_cselect_b32 s49, 0, s5
  s_cselect_b32 s5, s5, 0
  s_cselect_b32 s6, s57, 0
  v_mul_u32_u24 v57, s6, v59
  v_sub_u32 v57, s5, v57
  s_lshl_b32 s50, s48, 3
  s_add_u32 s50, s50, 4
  s_xor_b32 s6, s4, 0
  s_lshl_b32 s6, s6, 1
  s_add_u32 s6, s6, s50
  s_and_b32 s6, s6, 511
  s_mul_i32 s6, s6, s57
  s_add_u32 s33, s6, s49
  s_xor_b32 s6, s4, 1
  s_lshl_b32 s6, s6, 1
  s_add_u32 s6, s6, s50
  s_and_b32 s6, s6, 511
  s_mul_i32 s6, s6, s57
  s_add_u32 s34, s6, s49
  s_xor_b32 s6, s4, 2
  s_lshl_b32 s6, s6, 1
  s_add_u32 s6, s6, s50
  s_and_b32 s6, s6, 511
  s_mul_i32 s6, s6, s57
  s_add_u32 s35, s6, s49
  s_xor_b32 s6, s4, 3
  s_lshl_b32 s6, s6, 1
  s_add_u32 s6, s6, s50
  s_and_b32 s6, s6, 511
  s_mul_i32 s6, s6, s57
  s_add_u32 s36, s6, s49
  s_lshl_b32 s5, s47, 3
  s_add_u32 s5, s5, 4
  v_lshrrev_b32 v59, 3, v58
  v_add_u32 v60, s5, v59
  v_and_b32 v60, 511, v60
  v_sub_u32 v60, v60, v59
  v_mul_i32_i24 v56, 0x180, v60
  v_add_u32 v6, v6, v56
  v_add_u32 v7, v7, v57
  v_add_u32 v8, v8, v57
  v_add_f32 v55, v54, v55
  s_cmp_eq_u32 s45, 3
  s_cselect_b32 s49, 15, 16
  s_cmp_eq_u32 s45, 4
  s_cselect_b32 s49, 17, s49
  s_mov_b32 s50, 0
  s_sub_u32 s56, s56, s43
  s_nop 7
L_sloop:
  s_barrier
  s_add_u32 m0, s46, 0
  s_nop 0
  buffer_load_dwordx4 v6, s[8:11], s31 offen offset:0 nt lds
  s_add_u32 m0, s46, 8064
  s_nop 0
  buffer_load_dwordx4 v6, s[8:11], s31 offen offset:128 nt lds
  s_add_u32 m0, s46, 16128
  s_nop 0
  buffer_load_dwordx4 v6, s[8:11], s31 offen offset:256 nt lds
  s_add_u32 m0, s46, 4096
  s_nop 0
  buffer_load_dwordx4 v6, s[8:11], s32 offen offset:0 nt lds
  s_add_u32 m0, s46, 12160
  s_nop 0
  buffer_load_dwordx4 v6, s[8:11], s32 offen offset:128 nt lds
  s_add_u32 m0, s46, 20224
  s_nop 0
  buffer_load_dwordx4 v6, s[8:11], s32 offen offset:256 nt lds
  s_waitcnt vmcnt(0)
  s_barrier
  ds_read_b128 a[244:247], v0 offset:0
  ds_read_b128 a[248:251], v1 offset:0
  ds_read_b128 a[252:255], v0 offset:8192
  ds_read_b128 v[76:79], v1 offset:8192
  ds_read_b128 v[80:83], v0 offset:16384
  ds_read_b128 v[84:87], v1 offset:16384
  s_waitcnt lgkmcnt(5)
  v_mfma_f32_16x16x32_bf16 v[68:71], a[0:3], a[244:247], 0
  s_waitcnt lgkmcnt(4)
  v_mfma_f32_16x16x32_bf16 v[68:71], a[12:15], a[248:251], v[68:71]
  s_waitcnt lgkmcnt(3)
  v_mfma_f32_16x16x32_bf16 v[68:71], a[24:27], a[252:255], v[68:71]
  s_waitcnt lgkmcnt(2)
  v_mfma_f32_16x16x32_bf16 v[68:71], a[36:39], v[76:79], v[68:71]
  s_waitcnt lgkmcnt(1)
  v_mfma_f32_16x16x32_bf16 v[68:71], a[48:51], v[80:83], v[68:71]
  s_waitcnt lgkmcnt(0)
  v_mfma_f32_16x16x32_bf16 v[68:71], a[60:63], v[84:87], v[68:71]
  v_mfma_f32_16x16x32_bf16 v[60:63], a[64:67], v[84:87], 0
  v_mfma_f32_16x16x32_bf16 v[60:63], a[52:55], v[80:83], v[60:63]
  v_mfma_f32_16x16x32_bf16 v[60:63], a[40:43], v[76:79], v[60:63]
  v_mfma_f32_16x16x32_bf16 v[60:63], a[28:31], a[252:255], v[60:63]
  v_mfma_f32_16x16x32_bf16 v[60:63], a[16:19], a[248:251], v[60:63]
  v_mfma_f32_16x16x32_bf16 v[60:63], a[4:7], a[244:247], v[60:63]
  v_cvt_pk_bf16_f32 v12, v68, v69
  v_cvt_pk_bf16_f32 v13, v70, v71
  v_mfma_f32_16x16x32_bf16 v[64:67], a[8:11], a[244:247], 0
  v_mfma_f32_16x16x32_bf16 v[64:67], a[20:23], a[248:251], v[64:67]
  v_mfma_f32_16x16x32_bf16 v[64:67], a[32:35], a[252:255], v[64:67]
  v_mfma_f32_16x16x32_bf16 v[64:67], a[44:47], v[76:79], v[64:67]
  v_mfma_f32_16x16x32_bf16 v[64:67], a[56:59], v[80:83], v[64:67]
  v_mfma_f32_16x16x32_bf16 v[64:67], a[68:71], v[84:87], v[64:67]
  v_cvt_pk_bf16_f32 v128, v60, v61
  v_cvt_pk_bf16_f32 v129, v62, v63
  v_mfma_f32_16x16x32_bf16 v[68:71], a[132:135], v[84:87], 0
  v_mfma_f32_16x16x32_bf16 v[68:71], a[120:123], v[80:83], v[68:71]
  v_mfma_f32_16x16x32_bf16 v[68:71], a[108:111], v[76:79], v[68:71]
  v_mfma_f32_16x16x32_bf16 v[68:71], a[96:99], a[252:255], v[68:71]
  v_mfma_f32_16x16x32_bf16 v[68:71], a[84:87], a[248:251], v[68:71]
  v_mfma_f32_16x16x32_bf16 v[68:71], a[72:75], a[244:247], v[68:71]
  v_cvt_pk_bf16_f32 v130, v64, v65
  v_cvt_pk_bf16_f32 v131, v66, v67
  v_mfma_f32_16x16x32_bf16 v[72:75], a[76:79], a[244:247], 0
  v_mfma_f32_16x16x32_bf16 v[72:75], a[88:91], a[248:251], v[72:75]
  v_mfma_f32_16x16x32_bf16 v[72:75], a[100:103], a[252:255], v[72:75]
  v_mfma_f32_16x16x32_bf16 v[72:75], a[112:115], v[76:79], v[72:75]
  v_mfma_f32_16x16x32_bf16 v[72:75], a[124:127], v[80:83], v[72:75]
  v_mfma_f32_16x16x32_bf16 v[72:75], a[136:139], v[84:87], v[72:75]
  v_cvt_pk_bf16_f32 v60, v68, v69
  v_cvt_pk_bf16_f32 v61, v70, v71
  v_mfma_f32_16x16x32_bf16 v[88:91], a[140:143], v[84:87], 0
  v_mfma_f32_16x16x32_bf16 v[88:91], a[128:131], v[80:83], v[88:91]
  v_mfma_f32_16x16x32_bf16 v[88:91], a[116:119], v[76:79], v[88:91]
  v_mfma_f32_16x16x32_bf16 v[88:91], a[104:107], a[252:255], v[88:91]
  v_mfma_f32_16x16x32_bf16 v[88:91], a[92:95], a[248:251], v[88:91]
  v_mfma_f32_16x16x32_bf16 v[88:91], a[80:83], a[244:247], v[88:91]
  v_cvt_pk_bf16_f32 v62, v72, v73
  v_cvt_pk_bf16_f32 v63, v74, v75
  v_mfma_f32_16x16x32_bf16 v[92:95], a[244:247], a[144:147], 0
  v_mfma_f32_16x16x32_bf16 v[92:95], a[248:251], a[156:159], v[92:95]
  v_mfma_f32_16x16x32_bf16 v[92:95], a[252:255], a[168:171], v[92:95]
  v_mfma_f32_16x16x32_bf16 v[92:95], v[76:79], a[180:183], v[92:95]
  v_mfma_f32_16x16x32_bf16 v[92:95], v[80:83], a[192:195], v[92:95]
  v_mfma_f32_16x16x32_bf16 v[92:95], v[84:87], a[204:207], v[92:95]
  v_cvt_pk_bf16_f32 v64, v88, v89
  v_cvt_pk_bf16_f32 v65, v90, v91
  v_mfma_f32_16x16x32_bf16 v[96:99], v[84:87], a[208:211], 0
  v_mfma_f32_16x16x32_bf16 v[96:99], v[80:83], a[196:199], v[96:99]
  v_mfma_f32_16x16x32_bf16 v[96:99], v[76:79], a[184:187], v[96:99]
  v_mfma_f32_16x16x32_bf16 v[96:99], a[252:255], a[172:175], v[96:99]
  v_mfma_f32_16x16x32_bf16 v[96:99], a[248:251], a[160:163], v[96:99]
  v_mfma_f32_16x16x32_bf16 v[96:99], a[244:247], a[148:151], v[96:99]
  v_cvt_pk_bf16_f32 v68, v92, v93
  v_cvt_pk_bf16_f32 v69, v94, v95
  v_mfma_f32_16x16x32_bf16 v[100:103], a[244:247], a[152:155], 0
  v_mfma_f32_16x16x32_bf16 v[100:103], a[248:251], a[164:167], v[100:103]
  v_mfma_f32_16x16x32_bf16 v[100:103], a[252:255], a[176:179], v[100:103]
  v_mfma_f32_16x16x32_bf16 v[100:103], v[76:79], a[188:191], v[100:103]
  v_mfma_f32_16x16x32_bf16 v[100:103], v[80:83], a[200:203], v[100:103]
  v_mfma_f32_16x16x32_bf16 v[100:103], v[84:87], a[212:215], v[100:103]
  v_cvt_pk_bf16_f32 v72, v96, v97
  v_cvt_pk_bf16_f32 v73, v98, v99
  s_nop 5
  v_cvt_pk_bf16_f32 v76, v100, v101
  v_cvt_pk_bf16_f32 v77, v102, v103
  ds_read_b128 a[244:247], v0 offset:2048
  ds_read_b128 a[248:251], v1 offset:2048
  ds_read_b128 a[252:255], v0 offset:10240
  ds_read_b128 v[88:91], v1 offset:10240
  ds_read_b128 v[92:95], v0 offset:18432
  ds_read_b128 v[96:99], v1 offset:18432
  s_waitcnt lgkmcnt(5)
  v_mfma_f32_16x16x32_bf16 v[104:107], a[0:3], a[244:247], 0
  s_waitcnt lgkmcnt(4)
  v_mfma_f32_16x16x32_bf16 v[104:107], a[12:15], a[248:251], v[104:107]
  s_waitcnt lgkmcnt(3)
  v_mfma_f32_16x16x32_bf16 v[104:107], a[24:27], a[252:255], v[104:107]
  s_waitcnt lgkmcnt(2)
  v_mfma_f32_16x16x32_bf16 v[104:107], a[36:39], v[88:91], v[104:107]
  s_waitcnt lgkmcnt(1)
  v_mfma_f32_16x16x32_bf16 v[104:107], a[48:51], v[92:95], v[104:107]
  s_waitcnt lgkmcnt(0)
  v_mfma_f32_16x16x32_bf16 v[104:107], a[60:63], v[96:99], v[104:107]
  v_mfma_f32_16x16x32_bf16 v[80:83], a[64:67], v[96:99], 0
  v_mfma_f32_16x16x32_bf16 v[80:83], a[52:55], v[92:95], v[80:83]
  v_mfma_f32_16x16x32_bf16 v[80:83], a[40:43], v[88:91], v[80:83]
  v_mfma_f32_16x16x32_bf16 v[80:83], a[28:31], a[252:255], v[80:83]
  v_mfma_f32_16x16x32_bf16 v[80:83], a[16:19], a[248:251], v[80:83]
  v_mfma_f32_16x16x32_bf16 v[80:83], a[4:7], a[244:247], v[80:83]
  v_cvt_pk_bf16_f32 v124, v104, v105
  v_cvt_pk_bf16_f32 v125, v106, v107
  v_mfma_f32_16x16x32_bf16 v[84:87], a[8:11], a[244:247], 0
  v_mfma_f32_16x16x32_bf16 v[84:87], a[20:23], a[248:251], v[84:87]
  v_mfma_f32_16x16x32_bf16 v[84:87], a[32:35], a[252:255], v[84:87]
  v_mfma_f32_16x16x32_bf16 v[84:87], a[44:47], v[88:91], v[84:87]
  v_mfma_f32_16x16x32_bf16 v[84:87], a[56:59], v[92:95], v[84:87]
  v_mfma_f32_16x16x32_bf16 v[84:87], a[68:71], v[96:99], v[84:87]
  v_cvt_pk_bf16_f32 v126, v80, v81
  v_cvt_pk_bf16_f32 v127, v82, v83
  v_mfma_f32_16x16x32_bf16 v[100:103], a[132:135], v[96:99], 0
  v_mfma_f32_16x16x32_bf16 v[100:103], a[120:123], v[92:95], v[100:103]
  v_mfma_f32_16x16x32_bf16 v[100:103], a[108:111], v[88:91], v[100:103]
  v_mfma_f32_16x16x32_bf16 v[100:103], a[96:99], a[252:255], v[100:103]
  v_mfma_f32_16x16x32_bf16 v[100:103], a[84:87], a[248:251], v[100:103]
  v_mfma_f32_16x16x32_bf16 v[100:103], a[72:75], a[244:247], v[100:103]
  v_cvt_pk_bf16_f32 v16, v84, v85
  v_cvt_pk_bf16_f32 v17, v86, v87
  v_mfma_f32_16x16x32_bf16 v[104:107], a[76:79], a[244:247], 0
  v_mfma_f32_16x16x32_bf16 v[104:107], a[88:91], a[248:251], v[104:107]
  v_mfma_f32_16x16x32_bf16 v[104:107], a[100:103], a[252:255], v[104:107]
  v_mfma_f32_16x16x32_bf16 v[104:107], a[112:115], v[88:91], v[104:107]
  v_mfma_f32_16x16x32_bf16 v[104:107], a[124:127], v[92:95], v[104:107]
  v_mfma_f32_16x16x32_bf16 v[104:107], a[136:139], v[96:99], v[104:107]
  v_cvt_pk_bf16_f32 v80, v100, v101
  v_cvt_pk_bf16_f32 v81, v102, v103
  v_mfma_f32_16x16x32_bf16 v[108:111], a[140:143], v[96:99], 0
  v_mfma_f32_16x16x32_bf16 v[108:111], a[128:131], v[92:95], v[108:111]
  v_mfma_f32_16x16x32_bf16 v[108:111], a[116:119], v[88:91], v[108:111]
  v_mfma_f32_16x16x32_bf16 v[108:111], a[104:107], a[252:255], v[108:111]
  v_mfma_f32_16x16x32_bf16 v[108:111], a[92:95], a[248:251], v[108:111]
  v_mfma_f32_16x16x32_bf16 v[108:111], a[80:83], a[244:247], v[108:111]
  v_cvt_pk_bf16_f32 v82, v104, v105
  v_cvt_pk_bf16_f32 v83, v106, v107
  v_mfma_f32_16x16x32_bf16 v[100:103], a[244:247], a[144:147], 0
  v_mfma_f32_16x16x32_bf16 v[100:103], a[248:251], a[156:159], v[100:103]
  v_mfma_f32_16x16x32_bf16 v[100:103], a[252:255], a[168:171], v[100:103]
  v_mfma_f32_16x16x32_bf16 v[100:103], v[88:91], a[180:183], v[100:103]
  v_mfma_f32_16x16x32_bf16 v[100:103], v[92:95], a[192:195], v[100:103]
  v_mfma_f32_16x16x32_bf16 v[100:103], v[96:99], a[204:207], v[100:103]
  v_cvt_pk_bf16_f32 v84, v108, v109
  v_cvt_pk_bf16_f32 v85, v110, v111
  v_mfma_f32_16x16x32_bf16 v[104:107], v[96:99], a[208:211], 0
  v_mfma_f32_16x16x32_bf16 v[104:107], v[92:95], a[196:199], v[104:107]
  v_mfma_f32_16x16x32_bf16 v[104:107], v[88:91], a[184:187], v[104:107]
  v_mfma_f32_16x16x32_bf16 v[104:107], a[252:255], a[172:175], v[104:107]
  v_mfma_f32_16x16x32_bf16 v[104:107], a[248:251], a[160:163], v[104:107]
  v_mfma_f32_16x16x32_bf16 v[104:107], a[244:247], a[148:151], v[104:107]
  v_cvt_pk_bf16_f32 v70, v100, v101
  v_cvt_pk_bf16_f32 v71, v102, v103
  v_mfma_f32_16x16x32_bf16 v[116:119], a[244:247], a[152:155], 0
  v_mfma_f32_16x16x32_bf16 v[116:119], a[248:251], a[164:167], v[116:119]
  v_mfma_f32_16x16x32_bf16 v[116:119], a[252:255], a[176:179], v[116:119]
  v_mfma_f32_16x16x32_bf16 v[116:119], v[88:91], a[188:191], v[116:119]
  v_mfma_f32_16x16x32_bf16 v[116:119], v[92:95], a[200:203], v[116:119]
  v_mfma_f32_16x16x32_bf16 v[116:119], v[96:99], a[212:215], v[116:119]
  v_cvt_pk_bf16_f32 v74, v104, v105
  v_cvt_pk_bf16_f32 v75, v106, v107
  s_nop 5
  v_cvt_pk_bf16_f32 v78, v116, v117
  v_cvt_pk_bf16_f32 v79, v118, v119
  ds_read_b128 a[244:247], v0 offset:4096
  ds_read_b128 a[248:251], v1 offset:4096
  ds_read_b128 a[252:255], v0 offset:12288
  ds_read_b128 v[100:103], v1 offset:12288
  ds_read_b128 v[108:111], v0 offset:20480
  ds_read_b128 v[112:115], v1 offset:20480
  s_waitcnt lgkmcnt(5)
  v_mfma_f32_16x16x32_bf16 v[96:99], a[0:3], a[244:247], 0
  s_waitcnt lgkmcnt(4)
  v_mfma_f32_16x16x32_bf16 v[96:99], a[12:15], a[248:251], v[96:99]
  s_waitcnt lgkmcnt(3)
  v_mfma_f32_16x16x32_bf16 v[96:99], a[24:27], a[252:255], v[96:99]
  s_waitcnt lgkmcnt(2)
  v_mfma_f32_16x16x32_bf16 v[96:99], a[36:39], v[100:103], v[96:99]
  s_waitcnt lgkmcnt(1)
  v_mfma_f32_16x16x32_bf16 v[96:99], a[48:51], v[108:111], v[96:99]
  s_waitcnt lgkmcnt(0)
  v_mfma_f32_16x16x32_bf16 v[96:99], a[60:63], v[112:115], v[96:99]
  v_mfma_f32_16x16x32_bf16 v[88:91], a[64:67], v[112:115], 0
  v_mfma_f32_16x16x32_bf16 v[88:91], a[52:55], v[108:111], v[88:91]
  v_mfma_f32_16x16x32_bf16 v[88:91], a[40:43], v[100:103], v[88:91]
  v_mfma_f32_16x16x32_bf16 v[88:91], a[28:31], a[252:255], v[88:91]
  v_mfma_f32_16x16x32_bf16 v[88:91], a[16:19], a[248:251], v[88:91]
  v_mfma_f32_16x16x32_bf16 v[88:91], a[4:7], a[244:247], v[88:91]
  v_cvt_pk_bf16_f32 v18, v96, v97
  v_cvt_pk_bf16_f32 v19, v98, v99
  v_mfma_f32_16x16x32_bf16 v[92:95], a[8:11], a[244:247], 0
  v_mfma_f32_16x16x32_bf16 v[92:95], a[20:23], a[248:251], v[92:95]
  v_mfma_f32_16x16x32_bf16 v[92:95], a[32:35], a[252:255], v[92:95]
  v_mfma_f32_16x16x32_bf16 v[92:95], a[44:47], v[100:103], v[92:95]
  v_mfma_f32_16x16x32_bf16 v[92:95], a[56:59], v[108:111], v[92:95]
  v_mfma_f32_16x16x32_bf16 v[92:95], a[68:71], v[112:115], v[92:95]
  v_cvt_pk_bf16_f32 v120, v88, v89
  v_cvt_pk_bf16_f32 v121, v90, v91
  v_mfma_f32_16x16x32_bf16 v[96:99], a[132:135], v[112:115], 0
  v_mfma_f32_16x16x32_bf16 v[96:99], a[120:123], v[108:111], v[96:99]
  v_mfma_f32_16x16x32_bf16 v[96:99], a[108:111], v[100:103], v[96:99]
  v_mfma_f32_16x16x32_bf16 v[96:99], a[96:99], a[252:255], v[96:99]
  v_mfma_f32_16x16x32_bf16 v[96:99], a[84:87], a[248:251], v[96:99]
  v_mfma_f32_16x16x32_bf16 v[96:99], a[72:75], a[244:247], v[96:99]
  v_cvt_pk_bf16_f32 v122, v92, v93
  v_cvt_pk_bf16_f32 v123, v94, v95
  v_mfma_f32_16x16x32_bf16 v[104:107], a[76:79], a[244:247], 0
  v_mfma_f32_16x16x32_bf16 v[104:107], a[88:91], a[248:251], v[104:107]
  v_mfma_f32_16x16x32_bf16 v[104:107], a[100:103], a[252:255], v[104:107]
  v_mfma_f32_16x16x32_bf16 v[104:107], a[112:115], v[100:103], v[104:107]
  v_mfma_f32_16x16x32_bf16 v[104:107], a[124:127], v[108:111], v[104:107]
  v_mfma_f32_16x16x32_bf16 v[104:107], a[136:139], v[112:115], v[104:107]
  v_cvt_pk_bf16_f32 v88, v96, v97
  v_cvt_pk_bf16_f32 v89, v98, v99
  v_mfma_f32_16x16x32_bf16 v[116:119], a[140:143], v[112:115], 0
  v_mfma_f32_16x16x32_bf16 v[116:119], a[128:131], v[108:111], v[116:119]
  v_mfma_f32_16x16x32_bf16 v[116:119], a[116:119], v[100:103], v[116:119]
  v_mfma_f32_16x16x32_bf16 v[116:119], a[104:107], a[252:255], v[116:119]
  v_mfma_f32_16x16x32_bf16 v[116:119], a[92:95], a[248:251], v[116:119]
  v_mfma_f32_16x16x32_bf16 v[116:119], a[80:83], a[244:247], v[116:119]
  v_cvt_pk_bf16_f32 v90, v104, v105
  v_cvt_pk_bf16_f32 v91, v106, v107
  v_mfma_f32_16x16x32_bf16 v[132:135], a[244:247], a[144:147], 0
  v_mfma_f32_16x16x32_bf16 v[132:135], a[248:251], a[156:159], v[132:135]
  v_mfma_f32_16x16x32_bf16 v[132:135], a[252:255], a[168:171], v[132:135]
  v_mfma_f32_16x16x32_bf16 v[132:135], v[100:103], a[180:183], v[132:135]
  v_mfma_f32_16x16x32_bf16 v[132:135], v[108:111], a[192:195], v[132:135]
  v_mfma_f32_16x16x32_bf16 v[132:135], v[112:115], a[204:207], v[132:135]
  v_cvt_pk_bf16_f32 v92, v116, v117
  v_cvt_pk_bf16_f32 v93, v118, v119
  v_mfma_f32_16x16x32_bf16 v[136:139], v[112:115], a[208:211], 0
  v_mfma_f32_16x16x32_bf16 v[136:139], v[108:111], a[196:199], v[136:139]
  v_mfma_f32_16x16x32_bf16 v[136:139], v[100:103], a[184:187], v[136:139]
  v_mfma_f32_16x16x32_bf16 v[136:139], a[252:255], a[172:175], v[136:139]
  v_mfma_f32_16x16x32_bf16 v[136:139], a[248:251], a[160:163], v[136:139]
  v_mfma_f32_16x16x32_bf16 v[136:139], a[244:247], a[148:151], v[136:139]
  v_cvt_pk_bf16_f32 v96, v132, v133
  v_cvt_pk_bf16_f32 v97, v134, v135
  v_mfma_f32_16x16x32_bf16 v[116:119], a[244:247], a[152:155], 0
  v_mfma_f32_16x16x32_bf16 v[116:119], a[248:251], a[164:167], v[116:119]
  v_mfma_f32_16x16x32_bf16 v[116:119], a[252:255], a[176:179], v[116:119]
  v_mfma_f32_16x16x32_bf16 v[116:119], v[100:103], a[188:191], v[116:119]
  v_mfma_f32_16x16x32_bf16 v[116:119], v[108:111], a[200:203], v[116:119]
  v_mfma_f32_16x16x32_bf16 v[116:119], v[112:115], a[212:215], v[116:119]
  v_cvt_pk_bf16_f32 v104, v136, v137
  v_cvt_pk_bf16_f32 v105, v138, v139
  s_nop 5
  v_cvt_pk_bf16_f32 v100, v116, v117
  v_cvt_pk_bf16_f32 v101, v118, v119
  ds_read_b128 a[244:247], v0 offset:6144
  ds_read_b128 a[248:251], v1 offset:6144
  ds_read_b128 a[252:255], v0 offset:14336
  ds_read_b128 v[132:135], v1 offset:14336
  ds_read_b128 v[136:139], v0 offset:22528
  ds_read_b128 v[140:143], v1 offset:22528
  s_waitcnt lgkmcnt(5)
  v_mfma_f32_16x16x32_bf16 v[144:147], a[0:3], a[244:247], 0
  s_waitcnt lgkmcnt(4)
  v_mfma_f32_16x16x32_bf16 v[144:147], a[12:15], a[248:251], v[144:147]
  s_waitcnt lgkmcnt(3)
  v_mfma_f32_16x16x32_bf16 v[144:147], a[24:27], a[252:255], v[144:147]
  s_waitcnt lgkmcnt(2)
  v_mfma_f32_16x16x32_bf16 v[144:147], a[36:39], v[132:135], v[144:147]
  s_waitcnt lgkmcnt(1)
  v_mfma_f32_16x16x32_bf16 v[144:147], a[48:51], v[136:139], v[144:147]
  s_waitcnt lgkmcnt(0)
  v_mfma_f32_16x16x32_bf16 v[144:147], a[60:63], v[140:143], v[144:147]
  v_mfma_f32_16x16x32_bf16 v[108:111], a[64:67], v[140:143], 0
  v_mfma_f32_16x16x32_bf16 v[108:111], a[52:55], v[136:139], v[108:111]
  v_mfma_f32_16x16x32_bf16 v[108:111], a[40:43], v[132:135], v[108:111]
  v_mfma_f32_16x16x32_bf16 v[108:111], a[28:31], a[252:255], v[108:111]
  v_mfma_f32_16x16x32_bf16 v[108:111], a[16:19], a[248:251], v[108:111]
  v_mfma_f32_16x16x32_bf16 v[108:111], a[4:7], a[244:247], v[108:111]
  v_cvt_pk_bf16_f32 v116, v144, v145
  v_cvt_pk_bf16_f32 v117, v146, v147
  v_mfma_f32_16x16x32_bf16 v[112:115], a[8:11], a[244:247], 0
  v_mfma_f32_16x16x32_bf16 v[112:115], a[20:23], a[248:251], v[112:115]
  v_mfma_f32_16x16x32_bf16 v[112:115], a[32:35], a[252:255], v[112:115]
  v_mfma_f32_16x16x32_bf16 v[112:115], a[44:47], v[132:135], v[112:115]
  v_mfma_f32_16x16x32_bf16 v[112:115], a[56:59], v[136:139], v[112:115]
  v_mfma_f32_16x16x32_bf16 v[112:115], a[68:71], v[140:143], v[112:115]
  v_cvt_pk_bf16_f32 v118, v108, v109
  v_cvt_pk_bf16_f32 v119, v110, v111
  v_mfma_f32_16x16x32_bf16 v[144:147], a[132:135], v[140:143], 0
  v_mfma_f32_16x16x32_bf16 v[144:147], a[120:123], v[136:139], v[144:147]
  v_mfma_f32_16x16x32_bf16 v[144:147], a[108:111], v[132:135], v[144:147]
  v_mfma_f32_16x16x32_bf16 v[144:147], a[96:99], a[252:255], v[144:147]
  v_mfma_f32_16x16x32_bf16 v[144:147], a[84:87], a[248:251], v[144:147]
  v_mfma_f32_16x16x32_bf16 v[144:147], a[72:75], a[244:247], v[144:147]
  v_cvt_pk_bf16_f32 v22, v112, v113
  v_cvt_pk_bf16_f32 v23, v114, v115
  v_mfma_f32_16x16x32_bf16 v[148:151], a[76:79], a[244:247], 0
  v_mfma_f32_16x16x32_bf16 v[148:151], a[88:91], a[248:251], v[148:151]
  v_mfma_f32_16x16x32_bf16 v[148:151], a[100:103], a[252:255], v[148:151]
  v_mfma_f32_16x16x32_bf16 v[148:151], a[112:115], v[132:135], v[148:151]
  v_mfma_f32_16x16x32_bf16 v[148:151], a[124:127], v[136:139], v[148:151]
  v_mfma_f32_16x16x32_bf16 v[148:151], a[136:139], v[140:143], v[148:151]
  v_cvt_pk_bf16_f32 v108, v144, v145
  v_cvt_pk_bf16_f32 v109, v146, v147
  v_mfma_f32_16x16x32_bf16 v[152:155], a[140:143], v[140:143], 0
  v_mfma_f32_16x16x32_bf16 v[152:155], a[128:131], v[136:139], v[152:155]
  v_mfma_f32_16x16x32_bf16 v[152:155], a[116:119], v[132:135], v[152:155]
  v_mfma_f32_16x16x32_bf16 v[152:155], a[104:107], a[252:255], v[152:155]
  v_mfma_f32_16x16x32_bf16 v[152:155], a[92:95], a[248:251], v[152:155]
  v_mfma_f32_16x16x32_bf16 v[152:155], a[80:83], a[244:247], v[152:155]
  v_cvt_pk_bf16_f32 v110, v148, v149
  v_cvt_pk_bf16_f32 v111, v150, v151
  v_mfma_f32_16x16x32_bf16 v[144:147], a[244:247], a[144:147], 0
  v_mfma_f32_16x16x32_bf16 v[144:147], a[248:251], a[156:159], v[144:147]
  v_mfma_f32_16x16x32_bf16 v[144:147], a[252:255], a[168:171], v[144:147]
  v_mfma_f32_16x16x32_bf16 v[144:147], v[132:135], a[180:183], v[144:147]
  v_mfma_f32_16x16x32_bf16 v[144:147], v[136:139], a[192:195], v[144:147]
  v_mfma_f32_16x16x32_bf16 v[144:147], v[140:143], a[204:207], v[144:147]
  v_cvt_pk_bf16_f32 v112, v152, v153
  v_cvt_pk_bf16_f32 v113, v154, v155
  v_mfma_f32_16x16x32_bf16 v[148:151], v[140:143], a[208:211], 0
  v_mfma_f32_16x16x32_bf16 v[148:151], v[136:139], a[196:199], v[148:151]
  v_mfma_f32_16x16x32_bf16 v[148:151], v[132:135], a[184:187], v[148:151]
  v_mfma_f32_16x16x32_bf16 v[148:151], a[252:255], a[172:175], v[148:151]
  v_mfma_f32_16x16x32_bf16 v[148:151], a[248:251], a[160:163], v[148:151]
  v_mfma_f32_16x16x32_bf16 v[148:151], a[244:247], a[148:151], v[148:151]
  v_cvt_pk_bf16_f32 v98, v144, v145
  v_cvt_pk_bf16_f32 v99, v146, v147
  v_mfma_f32_16x16x32_bf16 v[152:155], a[244:247], a[152:155], 0
  v_mfma_f32_16x16x32_bf16 v[152:155], a[248:251], a[164:167], v[152:155]
  v_mfma_f32_16x16x32_bf16 v[152:155], a[252:255], a[176:179], v[152:155]
  v_mfma_f32_16x16x32_bf16 v[152:155], v[132:135], a[188:191], v[152:155]
  v_mfma_f32_16x16x32_bf16 v[152:155], v[136:139], a[200:203], v[152:155]
  v_mfma_f32_16x16x32_bf16 v[152:155], v[140:143], a[212:215], v[152:155]
  v_cvt_pk_bf16_f32 v106, v148, v149
  v_cvt_pk_bf16_f32 v107, v150, v151
  s_nop 5
  v_cvt_pk_bf16_f32 v102, v152, v153
  v_cvt_pk_bf16_f32 v103, v154, v155
  v_mfma_f32_16x16x32_bf16 v[132:135], v[62:65], v[128:131], v[36:39]
  v_mfma_f32_16x16x32_bf16 v[132:135], v[60:63], v[12:15], v[132:135]
  v_mfma_f32_16x16x32_bf16 v[136:139], v[82:85], v[128:131], v[32:35]
  v_mfma_f32_16x16x32_bf16 v[136:139], v[80:83], v[12:15], v[136:139]
  v_mfma_f32_16x16x32_bf16 v[140:143], v[90:93], v[128:131], v[28:31]
  v_mfma_f32_16x16x32_bf16 v[140:143], v[88:91], v[12:15], v[140:143]
  v_mfma_f32_16x16x32_bf16 v[144:147], v[110:113], v[128:131], v[24:27]
  v_mfma_f32_16x16x32_bf16 v[144:147], v[108:111], v[12:15], v[144:147]
  v_add_f32 v132, v54, v132
  v_add_f32 v133, v54, v133
  v_add_f32 v134, v54, v134
  v_add_f32 v135, v54, v135
  v_add_f32 v136, v54, v136
  v_add_f32 v137, v54, v137
  v_add_f32 v138, v54, v138
  v_add_f32 v139, v54, v139
  v_add_f32 v140, v55, v140
  v_add_f32 v141, v55, v141
  v_add_f32 v142, v55, v142
  v_add_f32 v143, v55, v143
  v_add_f32 v144, v55, v144
  v_add_f32 v145, v55, v145
  v_add_f32 v146, v55, v146
  v_add_f32 v147, v55, v147
  v_max_f32 v58, v132, v133
  v_max3_f32 v58, v134, v135, v58
  v_max3_f32 v58, v136, v137, v58
  v_max3_f32 v58, v138, v139, v58
  v_max3_f32 v58, v140, v141, v58
  v_max3_f32 v58, v142, v143, v58
  v_max3_f32 v58, v144, v145, v58
  v_max3_f32 v58, v146, v147, v58
  v_mov_b32 v59, v58
  s_nop 1
  v_permlane32_swap_b32 v58, v59
  v_max_f32 v58, v58, v59
  v_mov_b32 v59, v58
  s_nop 1
  v_permlane16_swap_b32 v58, v59
  v_max_f32 v58, v58, v59
  v_sub_f32 v132, v132, v58
  v_sub_f32 v133, v133, v58
  v_sub_f32 v134, v134, v58
  v_sub_f32 v135, v135, v58
  v_sub_f32 v136, v136, v58
  v_sub_f32 v137, v137, v58
  v_sub_f32 v138, v138, v58
  v_sub_f32 v139, v139, v58
  v_sub_f32 v140, v140, v58
  v_sub_f32 v141, v141, v58
  v_sub_f32 v142, v142, v58
  v_sub_f32 v143, v143, v58
  v_sub_f32 v144, v144, v58
  v_sub_f32 v145, v145, v58
  v_sub_f32 v146, v146, v58
  v_sub_f32 v147, v147, v58
  v_exp_f32 v132, v132
  v_exp_f32 v133, v133
  v_exp_f32 v134, v134
  v_exp_f32 v135, v135
  v_cvt_pk_bf16_f32 v132, v132, v133
  v_cvt_pk_bf16_f32 v133, v134, v135
  v_exp_f32 v136, v136
  v_exp_f32 v137, v137
  v_exp_f32 v138, v138
  v_exp_f32 v139, v139
  v_cvt_pk_bf16_f32 v134, v136, v137
  v_cvt_pk_bf16_f32 v135, v138, v139
  v_exp_f32 v140, v140
  v_exp_f32 v141, v141
  v_exp_f32 v142, v142
  v_exp_f32 v143, v143
  v_cvt_pk_bf16_f32 v136, v140, v141
  v_cvt_pk_bf16_f32 v137, v142, v143
  v_exp_f32 v144, v144
  v_exp_f32 v145, v145
  v_exp_f32 v146, v146
  v_exp_f32 v147, v147
  v_cvt_pk_bf16_f32 v138, v144, v145
  v_cvt_pk_bf16_f32 v139, v146, v147
  v_mov_b64 v[128:129], 0
  s_nop 1
  v_smfmac_f32_16x16x64_bf16 v[128:131], a[240:243], v[132:139], v10
  v_mfma_f32_16x16x32_bf16 v[148:151], v[96:99], v[136:139], 0
  v_mfma_f32_16x16x32_bf16 v[148:151], v[68:71], v[132:135], v[148:151]
  v_mfma_f32_16x16x32_bf16 v[140:143], v[72:75], v[132:135], 0
  v_mfma_f32_16x16x32_bf16 v[140:143], v[104:107], v[136:139], v[140:143]
  v_mfma_f32_16x16x32_bf16 v[144:147], v[100:103], v[136:139], 0
  v_mfma_f32_16x16x32_bf16 v[144:147], v[76:79], v[132:135], v[144:147]
  v_add_f32 v128, v128, v129
  v_rcp_f32 v130, v128
  s_nop 0
  v_mul_f32 v148, v130, v148
  v_mul_f32 v149, v130, v149
  v_mul_f32 v150, v130, v150
  v_mul_f32 v151, v130, v151
  v_cvt_pk_bf16_f32 v148, v148, v149
  v_cvt_pk_bf16_f32 v149, v150, v151
  ds_write_b32 v5, v148 offset:0
  ds_write_b32 v5, v149 offset:1024
  v_mul_f32 v140, v130, v140
  v_mul_f32 v141, v130, v141
  v_mul_f32 v142, v130, v142
  v_mul_f32 v143, v130, v143
  v_cvt_pk_bf16_f32 v140, v140, v141
  v_cvt_pk_bf16_f32 v141, v142, v143
  ds_write_b32 v5, v140 offset:2048
  ds_write_b32 v5, v141 offset:3072
  v_mul_f32 v144, v130, v144
  v_mul_f32 v145, v130, v145
  v_mul_f32 v146, v130, v146
  v_mul_f32 v147, v130, v147
  v_cvt_pk_bf16_f32 v144, v144, v145
  v_cvt_pk_bf16_f32 v145, v146, v147
  ds_write_b32 v5, v144 offset:4096
  ds_write_b32 v5, v145 offset:5120
  v_mfma_f32_16x16x32_bf16 v[128:131], v[60:63], v[124:127], v[40:43]
  v_mfma_f32_16x16x32_bf16 v[128:131], v[62:65], v[14:17], v[128:131]
  v_mfma_f32_16x16x32_bf16 v[132:135], v[80:83], v[124:127], v[36:39]
  v_mfma_f32_16x16x32_bf16 v[132:135], v[82:85], v[14:17], v[132:135]
  v_mfma_f32_16x16x32_bf16 v[136:139], v[88:91], v[124:127], v[32:35]
  v_mfma_f32_16x16x32_bf16 v[136:139], v[90:93], v[14:17], v[136:139]
  v_mfma_f32_16x16x32_bf16 v[140:143], v[108:111], v[124:127], v[28:31]
  v_mfma_f32_16x16x32_bf16 v[140:143], v[110:113], v[14:17], v[140:143]
  v_add_f32 v128, v54, v128
  v_add_f32 v129, v54, v129
  v_add_f32 v130, v54, v130
  v_add_f32 v131, v54, v131
  v_add_f32 v132, v54, v132
  v_add_f32 v133, v54, v133
  v_add_f32 v134, v54, v134
  v_add_f32 v135, v54, v135
  v_add_f32 v136, v55, v136
  v_add_f32 v137, v55, v137
  v_add_f32 v138, v55, v138
  v_add_f32 v139, v55, v139
  v_add_f32 v140, v55, v140
  v_add_f32 v141, v55, v141
  v_add_f32 v142, v55, v142
  v_add_f32 v143, v55, v143
  v_max_f32 v58, v128, v129
  v_max3_f32 v58, v130, v131, v58
  v_max3_f32 v58, v132, v133, v58
  v_max3_f32 v58, v134, v135, v58
  v_max3_f32 v58, v136, v137, v58
  v_max3_f32 v58, v138, v139, v58
  v_max3_f32 v58, v140, v141, v58
  v_max3_f32 v58, v142, v143, v58
  v_mov_b32 v59, v58
  s_nop 1
  v_permlane32_swap_b32 v58, v59
  v_max_f32 v58, v58, v59
  v_mov_b32 v59, v58
  s_nop 1
  v_permlane16_swap_b32 v58, v59
  v_max_f32 v58, v58, v59
  v_sub_f32 v128, v128, v58
  v_sub_f32 v129, v129, v58
  v_sub_f32 v130, v130, v58
  v_sub_f32 v131, v131, v58
  v_sub_f32 v132, v132, v58
  v_sub_f32 v133, v133, v58
  v_sub_f32 v134, v134, v58
  v_sub_f32 v135, v135, v58
  v_sub_f32 v136, v136, v58
  v_sub_f32 v137, v137, v58
  v_sub_f32 v138, v138, v58
  v_sub_f32 v139, v139, v58
  v_sub_f32 v140, v140, v58
  v_sub_f32 v141, v141, v58
  v_sub_f32 v142, v142, v58
  v_sub_f32 v143, v143, v58
  v_exp_f32 v128, v128
  v_exp_f32 v129, v129
  v_exp_f32 v130, v130
  v_exp_f32 v131, v131
  v_cvt_pk_bf16_f32 v128, v128, v129
  v_cvt_pk_bf16_f32 v129, v130, v131
  v_exp_f32 v132, v132
  v_exp_f32 v133, v133
  v_exp_f32 v134, v134
  v_exp_f32 v135, v135
  v_cvt_pk_bf16_f32 v130, v132, v133
  v_cvt_pk_bf16_f32 v131, v134, v135
  v_exp_f32 v136, v136
  v_exp_f32 v137, v137
  v_exp_f32 v138, v138
  v_exp_f32 v139, v139
  v_cvt_pk_bf16_f32 v132, v136, v137
  v_cvt_pk_bf16_f32 v133, v138, v139
  v_exp_f32 v140, v140
  v_exp_f32 v141, v141
  v_exp_f32 v142, v142
  v_exp_f32 v143, v143
  v_cvt_pk_bf16_f32 v134, v140, v141
  v_cvt_pk_bf16_f32 v135, v142, v143
  v_mov_b64 v[124:125], 0
  s_nop 1
  v_smfmac_f32_16x16x64_bf16 v[124:127], a[240:243], v[128:135], v10
  v_mfma_f32_16x16x32_bf16 v[144:147], v[96:99], v[132:135], 0
  v_mfma_f32_16x16x32_bf16 v[144:147], v[68:71], v[128:131], v[144:147]
  v_mfma_f32_16x16x32_bf16 v[136:139], v[72:75], v[128:131], 0
  v_mfma_f32_16x16x32_bf16 v[136:139], v[104:107], v[132:135], v[136:139]
  v_mfma_f32_16x16x32_bf16 v[140:143], v[100:103], v[132:135], 0
  v_mfma_f32_16x16x32_bf16 v[140:143], v[76:79], v[128:131], v[140:143]
  v_add_f32 v124, v124, v125
  v_rcp_f32 v126, v124
  s_nop 0
  v_mul_f32 v144, v126, v144
  v_mul_f32 v145, v126, v145
  v_mul_f32 v146, v126, v146
  v_mul_f32 v147, v126, v147
  v_cvt_pk_bf16_f32 v144, v144, v145
  v_cvt_pk_bf16_f32 v145, v146, v147
  ds_write_b32 v5, v144 offset:256
  ds_write_b32 v5, v145 offset:1280
  v_mul_f32 v136, v126, v136
  v_mul_f32 v137, v126, v137
  v_mul_f32 v138, v126, v138
  v_mul_f32 v139, v126, v139
  v_cvt_pk_bf16_f32 v136, v136, v137
  v_cvt_pk_bf16_f32 v137, v138, v139
  ds_write_b32 v5, v136 offset:2304
  ds_write_b32 v5, v137 offset:3328
  v_mul_f32 v140, v126, v140
  v_mul_f32 v141, v126, v141
  v_mul_f32 v142, v126, v142
  v_mul_f32 v143, v126, v143
  v_cvt_pk_bf16_f32 v140, v140, v141
  v_cvt_pk_bf16_f32 v141, v142, v143
  ds_write_b32 v5, v140 offset:4352
  ds_write_b32 v5, v141 offset:5376
  v_mfma_f32_16x16x32_bf16 v[124:127], v[90:93], v[120:123], v[36:39]
  v_mfma_f32_16x16x32_bf16 v[124:127], v[88:91], v[18:21], v[124:127]
  v_mfma_f32_16x16x32_bf16 v[128:131], v[110:113], v[120:123], v[32:35]
  v_mfma_f32_16x16x32_bf16 v[128:131], v[108:111], v[18:21], v[128:131]
  v_mfma_f32_16x16x32_bf16 v[132:135], v[62:65], v[120:123], v[44:47]
  v_mfma_f32_16x16x32_bf16 v[132:135], v[60:63], v[18:21], v[132:135]
  v_mfma_f32_16x16x32_bf16 v[136:139], v[82:85], v[120:123], v[40:43]
  v_mfma_f32_16x16x32_bf16 v[136:139], v[80:83], v[18:21], v[136:139]
  v_add_f32 v124, v54, v124
  v_add_f32 v125, v54, v125
  v_add_f32 v126, v54, v126
  v_add_f32 v127, v54, v127
  v_add_f32 v128, v54, v128
  v_add_f32 v129, v54, v129
  v_add_f32 v130, v54, v130
  v_add_f32 v131, v54, v131
  v_add_f32 v132, v55, v132
  v_add_f32 v133, v55, v133
  v_add_f32 v134, v55, v134
  v_add_f32 v135, v55, v135
  v_add_f32 v136, v55, v136
  v_add_f32 v137, v55, v137
  v_add_f32 v138, v55, v138
  v_add_f32 v139, v55, v139
  v_max_f32 v58, v124, v125
  v_max3_f32 v58, v126, v127, v58
  v_max3_f32 v58, v128, v129, v58
  v_max3_f32 v58, v130, v131, v58
  v_max3_f32 v58, v132, v133, v58
  v_max3_f32 v58, v134, v135, v58
  v_max3_f32 v58, v136, v137, v58
  v_max3_f32 v58, v138, v139, v58
  v_mov_b32 v59, v58
  s_nop 1
  v_permlane32_swap_b32 v58, v59
  v_max_f32 v58, v58, v59
  v_mov_b32 v59, v58
  s_nop 1
  v_permlane16_swap_b32 v58, v59
  v_max_f32 v58, v58, v59
  v_sub_f32 v124, v124, v58
  v_sub_f32 v125, v125, v58
  v_sub_f32 v126, v126, v58
  v_sub_f32 v127, v127, v58
  v_sub_f32 v128, v128, v58
  v_sub_f32 v129, v129, v58
  v_sub_f32 v130, v130, v58
  v_sub_f32 v131, v131, v58
  v_sub_f32 v132, v132, v58
  v_sub_f32 v133, v133, v58
  v_sub_f32 v134, v134, v58
  v_sub_f32 v135, v135, v58
  v_sub_f32 v136, v136, v58
  v_sub_f32 v137, v137, v58
  v_sub_f32 v138, v138, v58
  v_sub_f32 v139, v139, v58
  v_exp_f32 v124, v124
  v_exp_f32 v125, v125
  v_exp_f32 v126, v126
  v_exp_f32 v127, v127
  v_cvt_pk_bf16_f32 v124, v124, v125
  v_cvt_pk_bf16_f32 v125, v126, v127
  v_exp_f32 v128, v128
  v_exp_f32 v129, v129
  v_exp_f32 v130, v130
  v_exp_f32 v131, v131
  v_cvt_pk_bf16_f32 v126, v128, v129
  v_cvt_pk_bf16_f32 v127, v130, v131
  v_exp_f32 v132, v132
  v_exp_f32 v133, v133
  v_exp_f32 v134, v134
  v_exp_f32 v135, v135
  v_cvt_pk_bf16_f32 v128, v132, v133
  v_cvt_pk_bf16_f32 v129, v134, v135
  v_exp_f32 v136, v136
  v_exp_f32 v137, v137
  v_exp_f32 v138, v138
  v_exp_f32 v139, v139
  v_cvt_pk_bf16_f32 v130, v136, v137
  v_cvt_pk_bf16_f32 v131, v138, v139
  v_mov_b64 v[120:121], 0
  s_nop 1
  v_smfmac_f32_16x16x64_bf16 v[120:123], a[240:243], v[124:131], v10
  v_mfma_f32_16x16x32_bf16 v[140:143], v[68:71], v[128:131], 0
  v_mfma_f32_16x16x32_bf16 v[140:143], v[96:99], v[124:127], v[140:143]
  v_mfma_f32_16x16x32_bf16 v[132:135], v[104:107], v[124:127], 0
  v_mfma_f32_16x16x32_bf16 v[132:135], v[72:75], v[128:131], v[132:135]
  v_mfma_f32_16x16x32_bf16 v[136:139], v[76:79], v[128:131], 0
  v_mfma_f32_16x16x32_bf16 v[136:139], v[100:103], v[124:127], v[136:139]
  v_add_f32 v120, v120, v121
  v_rcp_f32 v122, v120
  s_nop 0
  v_mul_f32 v140, v122, v140
  v_mul_f32 v141, v122, v141
  v_mul_f32 v142, v122, v142
  v_mul_f32 v143, v122, v143
  v_cvt_pk_bf16_f32 v140, v140, v141
  v_cvt_pk_bf16_f32 v141, v142, v143
  ds_write_b32 v5, v140 offset:512
  ds_write_b32 v5, v141 offset:1536
  v_mul_f32 v132, v122, v132
  v_mul_f32 v133, v122, v133
  v_mul_f32 v134, v122, v134
  v_mul_f32 v135, v122, v135
  v_cvt_pk_bf16_f32 v132, v132, v133
  v_cvt_pk_bf16_f32 v133, v134, v135
  ds_write_b32 v5, v132 offset:2560
  s_waitcnt lgkmcnt(12)
  ds_write_b32 v5, v133 offset:3584
  v_mul_f32 v136, v122, v136
  v_mul_f32 v137, v122, v137
  v_mul_f32 v138, v122, v138
  v_mul_f32 v139, v122, v139
  v_cvt_pk_bf16_f32 v136, v136, v137
  v_cvt_pk_bf16_f32 v137, v138, v139
  ds_write_b32 v5, v136 offset:4608
  ds_write_b32 v5, v137 offset:5632
  v_mfma_f32_16x16x32_bf16 v[120:123], v[88:91], v[116:119], v[40:43]
  v_mfma_f32_16x16x32_bf16 v[120:123], v[90:93], v[20:23], v[120:123]
  v_mfma_f32_16x16x32_bf16 v[124:127], v[108:111], v[116:119], v[36:39]
  v_mfma_f32_16x16x32_bf16 v[124:127], v[110:113], v[20:23], v[124:127]
  v_mfma_f32_16x16x32_bf16 v[128:131], v[60:63], v[116:119], v[48:51]
  v_mfma_f32_16x16x32_bf16 v[128:131], v[62:65], v[20:23], v[128:131]
  v_mfma_f32_16x16x32_bf16 v[88:91], v[80:83], v[116:119], v[44:47]
  v_mfma_f32_16x16x32_bf16 v[88:91], v[82:85], v[20:23], v[88:91]
  v_add_f32 v120, v54, v120
  v_add_f32 v121, v54, v121
  v_add_f32 v122, v54, v122
  v_add_f32 v123, v54, v123
  v_add_f32 v124, v54, v124
  v_add_f32 v125, v54, v125
  v_add_f32 v126, v54, v126
  v_add_f32 v127, v54, v127
  v_add_f32 v128, v55, v128
  v_add_f32 v129, v55, v129
  v_add_f32 v130, v55, v130
  v_add_f32 v131, v55, v131
  v_add_f32 v88, v55, v88
  v_add_f32 v89, v55, v89
  v_add_f32 v90, v55, v90
  v_add_f32 v91, v55, v91
  v_max_f32 v58, v120, v121
  v_max3_f32 v58, v122, v123, v58
  v_max3_f32 v58, v124, v125, v58
  v_max3_f32 v58, v126, v127, v58
  v_max3_f32 v58, v128, v129, v58
  v_max3_f32 v58, v130, v131, v58
  v_max3_f32 v58, v88, v89, v58
  v_max3_f32 v58, v90, v91, v58
  v_mov_b32 v59, v58
  s_nop 1
  v_permlane32_swap_b32 v58, v59
  v_max_f32 v58, v58, v59
  v_mov_b32 v59, v58
  s_nop 1
  v_permlane16_swap_b32 v58, v59
  v_max_f32 v58, v58, v59
  v_sub_f32 v120, v120, v58
  v_sub_f32 v121, v121, v58
  v_sub_f32 v122, v122, v58
  v_sub_f32 v123, v123, v58
  v_sub_f32 v124, v124, v58
  v_sub_f32 v125, v125, v58
  v_sub_f32 v126, v126, v58
  v_sub_f32 v127, v127, v58
  v_sub_f32 v128, v128, v58
  v_sub_f32 v129, v129, v58
  v_sub_f32 v130, v130, v58
  v_sub_f32 v131, v131, v58
  v_sub_f32 v88, v88, v58
  v_sub_f32 v89, v89, v58
  v_sub_f32 v90, v90, v58
  v_sub_f32 v91, v91, v58
  v_exp_f32 v120, v120
  v_exp_f32 v121, v121
  v_exp_f32 v122, v122
  v_exp_f32 v123, v123
  v_cvt_pk_bf16_f32 v120, v120, v121
  v_cvt_pk_bf16_f32 v121, v122, v123
  v_exp_f32 v124, v124
  v_exp_f32 v125, v125
  v_exp_f32 v126, v126
  v_exp_f32 v127, v127
  v_cvt_pk_bf16_f32 v122, v124, v125
  v_cvt_pk_bf16_f32 v123, v126, v127
  v_exp_f32 v128, v128
  v_exp_f32 v129, v129
  v_exp_f32 v130, v130
  v_exp_f32 v131, v131
  v_cvt_pk_bf16_f32 v124, v128, v129
  v_cvt_pk_bf16_f32 v125, v130, v131
  v_exp_f32 v88, v88
  v_exp_f32 v89, v89
  v_exp_f32 v90, v90
  v_exp_f32 v91, v91
  v_cvt_pk_bf16_f32 v126, v88, v89
  v_cvt_pk_bf16_f32 v127, v90, v91
  v_mov_b64 v[80:81], 0
  s_nop 1
  v_smfmac_f32_16x16x64_bf16 v[80:83], a[240:243], v[120:127], v10
  v_mfma_f32_16x16x32_bf16 v[84:87], v[68:71], v[124:127], 0
  v_mfma_f32_16x16x32_bf16 v[84:87], v[96:99], v[120:123], v[84:87]
  v_mfma_f32_16x16x32_bf16 v[60:63], v[104:107], v[120:123], 0
  v_mfma_f32_16x16x32_bf16 v[60:63], v[72:75], v[124:127], v[60:63]
  v_mfma_f32_16x16x32_bf16 v[64:67], v[76:79], v[124:127], 0
  v_mfma_f32_16x16x32_bf16 v[64:67], v[100:103], v[120:123], v[64:67]
  v_add_f32 v80, v80, v81
  v_rcp_f32 v82, v80
  s_nop 0
  v_mul_f32 v84, v82, v84
  v_mul_f32 v85, v82, v85
  v_mul_f32 v86, v82, v86
  v_mul_f32 v87, v82, v87
  v_cvt_pk_bf16_f32 v84, v84, v85
  v_cvt_pk_bf16_f32 v85, v86, v87
  s_waitcnt lgkmcnt(12)
  ds_write_b32 v5, v84 offset:768
  ds_write_b32 v5, v85 offset:1792
  v_mul_f32 v60, v82, v60
  v_mul_f32 v61, v82, v61
  v_mul_f32 v62, v82, v62
  v_mul_f32 v63, v82, v63
  v_cvt_pk_bf16_f32 v60, v60, v61
  v_cvt_pk_bf16_f32 v61, v62, v63
  ds_write_b32 v5, v60 offset:2816
  s_waitcnt lgkmcnt(12)
  ds_write_b32 v5, v61 offset:3840
  v_mul_f32 v64, v82, v64
  v_mul_f32 v65, v82, v65
  v_mul_f32 v66, v82, v66
  v_mul_f32 v67, v82, v67
  v_cvt_pk_bf16_f32 v64, v64, v65
  v_cvt_pk_bf16_f32 v65, v66, v67
  ds_write_b32 v5, v64 offset:4864
  ds_write_b32 v5, v65 offset:5888
  s_waitcnt lgkmcnt(0)
  s_barrier
  ds_read_b128 a[244:247], v3 offset:0
  ds_read_b128 a[248:251], v3 offset:4096
  ds_read_b128 a[252:255], v3 offset:8192
  ds_read_b128 v[72:75], v3 offset:12288
  ds_read_b128 v[76:79], v3 offset:16384
  ds_read_b128 v[84:87], v3 offset:20480
  s_waitcnt lgkmcnt(5)
  v_mfma_f32_16x16x32_bf16 v[68:71], a[244:247], v[184:187], 0
  s_waitcnt lgkmcnt(4)
  v_mfma_f32_16x16x32_bf16 v[68:71], a[248:251], v[200:203], v[68:71]
  s_waitcnt lgkmcnt(3)
  v_mfma_f32_16x16x32_bf16 v[68:71], a[252:255], v[216:219], v[68:71]
  s_waitcnt lgkmcnt(2)
  v_mfma_f32_16x16x32_bf16 v[68:71], v[72:75], v[232:235], v[68:71]
  s_waitcnt lgkmcnt(1)
  v_mfma_f32_16x16x32_bf16 v[68:71], v[76:79], v[248:251], v[68:71]
  s_waitcnt lgkmcnt(0)
  v_mfma_f32_16x16x32_bf16 v[68:71], v[84:87], a[224:227], v[68:71]
  v_mfma_f32_16x16x32_bf16 v[80:83], v[84:87], a[228:231], 0
  v_mfma_f32_16x16x32_bf16 v[80:83], v[76:79], v[252:255], v[80:83]
  v_mfma_f32_16x16x32_bf16 v[80:83], v[72:75], v[236:239], v[80:83]
  v_mfma_f32_16x16x32_bf16 v[80:83], a[252:255], v[220:223], v[80:83]
  v_mfma_f32_16x16x32_bf16 v[80:83], a[248:251], v[204:207], v[80:83]
  v_mfma_f32_16x16x32_bf16 v[80:83], a[244:247], v[188:191], v[80:83]
  v_mfma_f32_16x16x32_bf16 v[60:63], a[244:247], v[192:195], 0
  v_mfma_f32_16x16x32_bf16 v[60:63], a[248:251], v[208:211], v[60:63]
  v_mfma_f32_16x16x32_bf16 v[60:63], a[252:255], v[224:227], v[60:63]
  v_mfma_f32_16x16x32_bf16 v[60:63], v[72:75], v[240:243], v[60:63]
  v_mfma_f32_16x16x32_bf16 v[60:63], v[76:79], a[216:219], v[60:63]
  v_mfma_f32_16x16x32_bf16 v[60:63], v[84:87], a[232:235], v[60:63]
  v_mfma_f32_16x16x32_bf16 v[64:67], v[84:87], a[236:239], 0
  v_mfma_f32_16x16x32_bf16 v[64:67], v[76:79], a[220:223], v[64:67]
  v_mfma_f32_16x16x32_bf16 v[64:67], v[72:75], v[244:247], v[64:67]
  v_mfma_f32_16x16x32_bf16 v[64:67], a[252:255], v[228:231], v[64:67]
  v_mfma_f32_16x16x32_bf16 v[64:67], a[248:251], v[212:215], v[64:67]
  v_mfma_f32_16x16x32_bf16 v[64:67], a[244:247], v[196:199], v[64:67]
  v_cvt_pk_bf16_f32 v68, v68, v80
  v_cvt_pk_bf16_f32 v69, v69, v81
  v_cvt_pk_bf16_f32 v70, v70, v82
  v_cvt_pk_bf16_f32 v71, v71, v83
  buffer_store_dword v68, v7, s[24:27], s33 offen offset:0 nt
  buffer_store_dword v69, v7, s[24:27], s33 offen offset:384 nt
  buffer_store_dword v70, v7, s[24:27], s33 offen offset:768 nt
  buffer_store_dword v71, v7, s[24:27], s33 offen offset:1152 nt
  v_cvt_pk_bf16_f32 v60, v60, v64
  v_cvt_pk_bf16_f32 v61, v61, v65
  v_cvt_pk_bf16_f32 v62, v62, v66
  v_cvt_pk_bf16_f32 v63, v63, v67
  buffer_store_dword v60, v8, s[24:27], s33 offen offset:0 nt
  buffer_store_dword v61, v8, s[24:27], s33 offen offset:384 nt
  buffer_store_dword v62, v8, s[24:27], s33 offen offset:768 nt
  buffer_store_dword v63, v8, s[24:27], s33 offen offset:1152 nt
  ds_read_b128 a[244:247], v4 offset:0
  ds_read_b128 a[248:251], v4 offset:4096
  ds_read_b128 a[252:255], v4 offset:8192
  ds_read_b128 v[68:71], v4 offset:12288
  ds_read_b128 v[72:75], v4 offset:16384
  ds_read_b128 v[76:79], v4 offset:20480
  s_waitcnt lgkmcnt(5)
  v_mfma_f32_16x16x32_bf16 v[60:63], a[244:247], v[184:187], 0
  s_waitcnt lgkmcnt(4)
  v_mfma_f32_16x16x32_bf16 v[60:63], a[248:251], v[200:203], v[60:63]
  s_waitcnt lgkmcnt(3)
  v_mfma_f32_16x16x32_bf16 v[60:63], a[252:255], v[216:219], v[60:63]
  s_waitcnt lgkmcnt(2)
  v_mfma_f32_16x16x32_bf16 v[60:63], v[68:71], v[232:235], v[60:63]
  s_waitcnt lgkmcnt(1)
  v_mfma_f32_16x16x32_bf16 v[60:63], v[72:75], v[248:251], v[60:63]
  s_waitcnt lgkmcnt(0)
  v_mfma_f32_16x16x32_bf16 v[60:63], v[76:79], a[224:227], v[60:63]
  v_mfma_f32_16x16x32_bf16 v[64:67], v[76:79], a[228:231], 0
  v_mfma_f32_16x16x32_bf16 v[64:67], v[72:75], v[252:255], v[64:67]
  v_mfma_f32_16x16x32_bf16 v[64:67], v[68:71], v[236:239], v[64:67]
  v_mfma_f32_16x16x32_bf16 v[64:67], a[252:255], v[220:223], v[64:67]
  v_mfma_f32_16x16x32_bf16 v[64:67], a[248:251], v[204:207], v[64:67]
  v_mfma_f32_16x16x32_bf16 v[64:67], a[244:247], v[188:191], v[64:67]
  s_nop 7
  v_cvt_pk_bf16_f32 v60, v60, v64
  v_cvt_pk_bf16_f32 v61, v61, v65
  v_cvt_pk_bf16_f32 v62, v62, v66
  v_cvt_pk_bf16_f32 v63, v63, v67
  buffer_store_dword v60, v7, s[24:27], s34 offen offset:0 nt
  buffer_store_dword v61, v7, s[24:27], s34 offen offset:384 nt
  buffer_store_dword v62, v7, s[24:27], s34 offen offset:768 nt
  buffer_store_dword v63, v7, s[24:27], s34 offen offset:1152 nt
  ds_read_b128 a[244:247], v3 offset:512
  ds_read_b128 a[248:251], v3 offset:4608
  ds_read_b128 a[252:255], v3 offset:8704
  ds_read_b128 v[72:75], v3 offset:12800
  ds_read_b128 v[76:79], v3 offset:16896
  ds_read_b128 v[84:87], v3 offset:20992
  s_waitcnt lgkmcnt(5)
  v_mfma_f32_16x16x32_bf16 v[60:63], a[244:247], v[184:187], 0
  s_waitcnt lgkmcnt(4)
  v_mfma_f32_16x16x32_bf16 v[60:63], a[248:251], v[200:203], v[60:63]
  s_waitcnt lgkmcnt(3)
  v_mfma_f32_16x16x32_bf16 v[60:63], a[252:255], v[216:219], v[60:63]
  s_waitcnt lgkmcnt(2)
  v_mfma_f32_16x16x32_bf16 v[60:63], v[72:75], v[232:235], v[60:63]
  s_waitcnt lgkmcnt(1)
  v_mfma_f32_16x16x32_bf16 v[60:63], v[76:79], v[248:251], v[60:63]
  s_waitcnt lgkmcnt(0)
  v_mfma_f32_16x16x32_bf16 v[60:63], v[84:87], a[224:227], v[60:63]
  v_mfma_f32_16x16x32_bf16 v[80:83], v[84:87], a[228:231], 0
  v_mfma_f32_16x16x32_bf16 v[80:83], v[76:79], v[252:255], v[80:83]
  v_mfma_f32_16x16x32_bf16 v[80:83], v[72:75], v[236:239], v[80:83]
  v_mfma_f32_16x16x32_bf16 v[80:83], a[252:255], v[220:223], v[80:83]
  v_mfma_f32_16x16x32_bf16 v[80:83], a[248:251], v[204:207], v[80:83]
  v_mfma_f32_16x16x32_bf16 v[80:83], a[244:247], v[188:191], v[80:83]
  v_mfma_f32_16x16x32_bf16 v[64:67], a[244:247], v[192:195], 0
  v_mfma_f32_16x16x32_bf16 v[64:67], a[248:251], v[208:211], v[64:67]
  v_mfma_f32_16x16x32_bf16 v[64:67], a[252:255], v[224:227], v[64:67]
  v_mfma_f32_16x16x32_bf16 v[64:67], v[72:75], v[240:243], v[64:67]
  v_mfma_f32_16x16x32_bf16 v[64:67], v[76:79], a[216:219], v[64:67]
  v_mfma_f32_16x16x32_bf16 v[64:67], v[84:87], a[232:235], v[64:67]
  v_mfma_f32_16x16x32_bf16 v[68:71], v[84:87], a[236:239], 0
  v_mfma_f32_16x16x32_bf16 v[68:71], v[76:79], a[220:223], v[68:71]
  v_mfma_f32_16x16x32_bf16 v[68:71], v[72:75], v[244:247], v[68:71]
  v_mfma_f32_16x16x32_bf16 v[68:71], a[252:255], v[228:231], v[68:71]
  v_mfma_f32_16x16x32_bf16 v[68:71], a[248:251], v[212:215], v[68:71]
  v_mfma_f32_16x16x32_bf16 v[68:71], a[244:247], v[196:199], v[68:71]
  v_cvt_pk_bf16_f32 v60, v60, v80
  v_cvt_pk_bf16_f32 v61, v61, v81
  v_cvt_pk_bf16_f32 v62, v62, v82
  v_cvt_pk_bf16_f32 v63, v63, v83
  buffer_store_dword v60, v7, s[24:27], s35 offen offset:0 nt
  buffer_store_dword v61, v7, s[24:27], s35 offen offset:384 nt
  buffer_store_dword v62, v7, s[24:27], s35 offen offset:768 nt
  buffer_store_dword v63, v7, s[24:27], s35 offen offset:1152 nt
  v_cvt_pk_bf16_f32 v64, v64, v68
  v_cvt_pk_bf16_f32 v65, v65, v69
  v_cvt_pk_bf16_f32 v66, v66, v70
  v_cvt_pk_bf16_f32 v67, v67, v71
  buffer_store_dword v64, v8, s[24:27], s35 offen offset:0 nt
  buffer_store_dword v65, v8, s[24:27], s35 offen offset:384 nt
  buffer_store_dword v66, v8, s[24:27], s35 offen offset:768 nt
  buffer_store_dword v67, v8, s[24:27], s35 offen offset:1152 nt
  ds_read_b128 a[244:247], v4 offset:512
  ds_read_b128 a[248:251], v4 offset:4608
  ds_read_b128 a[252:255], v4 offset:8704
  ds_read_b128 v[72:75], v4 offset:12800
  ds_read_b128 v[76:79], v4 offset:16896
  ds_read_b128 v[80:83], v4 offset:20992
  s_waitcnt lgkmcnt(5)
  v_mfma_f32_16x16x32_bf16 v[60:63], a[244:247], v[184:187], 0
  s_waitcnt lgkmcnt(4)
  v_mfma_f32_16x16x32_bf16 v[60:63], a[248:251], v[200:203], v[60:63]
  s_waitcnt lgkmcnt(3)
  v_mfma_f32_16x16x32_bf16 v[60:63], a[252:255], v[216:219], v[60:63]
  s_waitcnt lgkmcnt(2)
  v_mfma_f32_16x16x32_bf16 v[60:63], v[72:75], v[232:235], v[60:63]
  s_waitcnt lgkmcnt(1)
  v_mfma_f32_16x16x32_bf16 v[60:63], v[76:79], v[248:251], v[60:63]
  s_waitcnt lgkmcnt(0)
  v_mfma_f32_16x16x32_bf16 v[60:63], v[80:83], a[224:227], v[60:63]
  v_mfma_f32_16x16x32_bf16 v[64:67], v[80:83], a[228:231], 0
  v_mfma_f32_16x16x32_bf16 v[64:67], v[76:79], v[252:255], v[64:67]
  v_mfma_f32_16x16x32_bf16 v[64:67], v[72:75], v[236:239], v[64:67]
  v_mfma_f32_16x16x32_bf16 v[64:67], a[252:255], v[220:223], v[64:67]
  v_mfma_f32_16x16x32_bf16 v[64:67], a[248:251], v[204:207], v[64:67]
  v_mfma_f32_16x16x32_bf16 v[64:67], a[244:247], v[188:191], v[64:67]
  s_nop 7
  v_cvt_pk_bf16_f32 v60, v60, v64
  v_cvt_pk_bf16_f32 v61, v61, v65
  v_cvt_pk_bf16_f32 v62, v62, v66
  v_cvt_pk_bf16_f32 v63, v63, v67
  buffer_store_dword v60, v7, s[24:27], s36 offen offset:0 nt
  buffer_store_dword v61, v7, s[24:27], s36 offen offset:384 nt
  buffer_store_dword v62, v7, s[24:27], s36 offen offset:768 nt
  buffer_store_dword v63, v7, s[24:27], s36 offen offset:1152 nt
  v_sub_u32 v6, v6, v56
  v_sub_u32 v7, v7, v57
  v_sub_u32 v8, v8, v57
  v_mov_b32 v54, 0
  v_mov_b32 v55, 0
  v_mov_b32 v56, 0
  v_mov_b32 v57, 0
  s_add_u32 s50, s50, 1
  s_cmp_eq_u32 s50, 16
  s_cselect_b32 s5, s58, s43
  s_add_u32 s56, s56, s5
  s_mul_i32 s5, s3, s57
  s_add_u32 s31, s56, s5
  s_add_u32 s32, s31, 786432
  s_xor_b32 s5, s4, 0
  s_mul_i32 s5, s5, 393216
  s_add_u32 s33, s5, s56
  s_xor_b32 s5, s4, 1
  s_mul_i32 s5, s5, 393216
  s_add_u32 s34, s5, s56
  s_xor_b32 s5, s4, 2
  s_mul_i32 s5, s5, 393216
  s_add_u32 s35, s5, s56
  s_xor_b32 s5, s4, 3
  s_mul_i32 s5, s5, 393216
  s_add_u32 s36, s5, s56
  s_cmp_lt_u32 s50, s49
  s_nop 7
  s_cbranch_scc1 L_sloop
  s_branch L_fin
.section .rodata,"a"
.p2align 6
.amdhsa_kernel standalone__window_attn_swin__vision_kernel
  .amdhsa_next_free_vgpr 512
  .amdhsa_next_free_sgpr 102
  .amdhsa_accum_offset 256
  .amdhsa_group_segment_fixed_size 0
  .amdhsa_kernarg_size 72
  .amdhsa_user_sgpr_count 2
  .amdhsa_user_sgpr_kernarg_segment_ptr 1
  .amdhsa_system_sgpr_workgroup_id_x 1
.end_amdhsa_kernel
```
